```python
import torch

def _softmax(x, axis=-1):
    return torch.softmax(x, dim=axis)
def _gelu(x):
    return torch.nn.functional.gelu(x, approximate="tanh")
def _silu(x):
    return torch.nn.functional.silu(x)
def _sigmoid(x):
    return torch.sigmoid(x)
def _layernorm(x, axis=-1, eps=1e-5):
    m = x.mean(dim=axis, keepdim=True)
    v = x.var(dim=axis, keepdim=True, unbiased=False)
    return (x - m) / torch.sqrt(v + eps)
def _scatter_add(tgt, idx, src, axis=0):
    return tgt.clone().index_add_(axis, idx, src)
def _segment_sum(src, seg, n):
    out = torch.zeros((n,) + src.shape[1:], dtype=src.dtype)
    return out.index_add_(0, seg, src)
def _pad(x, pw):
    flat = tuple(v for pair in reversed(pw) for v in pair)
    return torch.nn.functional.pad(x, flat)

kernel_name = 'concat_heads__mha_block_cached__compressed_kv_cla__decode'

def setup_inputs():

    _w = (lambda a: (lambda t: t.to(torch.bfloat16) if t.is_floating_point() else t)(torch.as_tensor(a)))
    def _A_setup():
        B, Sq, D = 4, 1, 576
        H, Sk, Dh = 32, 4096, 128
        return {
            "x": _w((lambda *s: torch.randn(*s, dtype=torch.bfloat16) * 1.6)(B, Sq, D)),
            "k_cache": _w((lambda *s: torch.randn(*s, dtype=torch.bfloat16) * 1.6)(B, H, Sk, Dh)),
            "v_cache": _w((lambda *s: torch.randn(*s, dtype=torch.bfloat16) * 0.05)(B, H, Sk, Dh)),
            "wq": _w((lambda *s: torch.randn(*s, dtype=torch.bfloat16) * 1.6)(D, H * Dh) * (D ** -0.5)),
            "wo": _w((lambda *s: torch.randn(*s, dtype=torch.bfloat16) * 0.05)(H * Dh, D) * ((H * Dh) ** -0.5)),
        }
    _A_in = _A_setup()

    def _B_setup():
        B, H, Sq, Sk, D, M = 4, 32, 1, 4096, 128, 576
        Dc = 4 * D
        return {
            "x": _w((lambda *s: torch.randn(*s, dtype=torch.bfloat16) * 3.2)(B, Sq, M)),
            "c_kv": _w((lambda *s: torch.randn(*s, dtype=torch.bfloat16) * 0.1)(B, Sk, Dc)),
            "w_q": _w((lambda *s: torch.randn(*s, dtype=torch.bfloat16) * 6.4)(M, H, D) * (M ** -0.5)),
            "w_uk": _w((lambda *s: torch.randn(*s, dtype=torch.bfloat16) * 6.4)(Dc, H, D) * (Dc ** -0.5)),
            "w_uv": _w((lambda *s: torch.randn(*s, dtype=torch.bfloat16) * 0.1)(Dc, H, D) * (Dc ** -0.5)),
            "w_o": _w((lambda *s: torch.randn(*s, dtype=torch.bfloat16) * 0.1)(H, D, M) * ((H * D) ** -0.5)),
        }
    _B_in = _B_setup()

    return {
        "A_x": _A_in["x"],
        "A_k_cache": _A_in["k_cache"],
        "A_v_cache": _A_in["v_cache"],
        "A_wq": _A_in["wq"],
        "A_wo": _A_in["wo"],
        "B_x": _B_in["x"],
        "B_c_kv": _B_in["c_kv"],
        "B_w_q": _B_in["w_q"],
        "B_w_uk": _B_in["w_uk"],
        "B_w_uv": _B_in["w_uv"],
        "B_w_o": _B_in["w_o"],
    }

def reference(A_x, A_k_cache, A_v_cache, A_wq, A_wo, B_x, B_c_kv, B_w_q, B_w_uk, B_w_uv, B_w_o):
    def _A_ref(x, k_cache, v_cache, wq, wo):
        B, Sq, D = x.shape
        H, Dh = 32, 128
        q = (lambda x, *d: x.permute(*d))((x @ wq).reshape(B, Sq, H, Dh), 0, 2, 1, 3)
        scores = torch.einsum("bhqd,bhkd->bhqk", q, k_cache) * (Dh ** -0.5)
        p = _softmax(scores, axis=-1)
        o = torch.einsum("bhqk,bhkd->bhqd", p, v_cache)
        return (lambda x, *d: x.permute(*d))(o, 0, 2, 1, 3).reshape(B, Sq, H * Dh) @ wo

    def _B_ref(x, c_kv, w_q, w_uk, w_uv, w_o):
        B, Sq, M = x.shape[0], x.shape[1], x.shape[2]
        Sk = c_kv.shape[1]
        H, D = w_q.shape[1], w_q.shape[2]
        q = torch.einsum("bqm,mhd->bhqd", x, w_q)
        k = torch.einsum("bkc,chd->bhkd", c_kv, w_uk)
        v = torch.einsum("bkc,chd->bhkd", c_kv, w_uv)
        scores = torch.einsum("bhqd,bhkd->bhqk", q, k) * (D ** -0.5)
        off = Sk - Sq
        qi = torch.arange(Sq)[:, None]
        kj = torch.arange(Sk)[None, :]
        cmask = kj <= (qi + off)
        scores = torch.where(cmask[None, None], scores, -1e9)
        p = _softmax(scores, axis=-1)
        ctx = torch.einsum("bhqk,bhkd->bhqd", p, v)
        return torch.einsum("bhqd,hdm->bqm", ctx, w_o)

    a = _A_ref(A_x, A_k_cache, A_v_cache, A_wq, A_wo)
    b = _B_ref(B_x, B_c_kv, B_w_q, B_w_uk, B_w_uv, B_w_o)
    return torch.concatenate([a, b], axis=-1)
```

```asm
; @launch grid=(256,1,1) block=(256,1,1) lds=163840
.amdgcn_target "amdgcn-amd-amdhsa--gfx950"
.text
.globl concat_heads__mha_block_cached__compressed_kv_cla__decode_kernel
.p2align 8
.type concat_heads__mha_block_cached__compressed_kv_cla__decode_kernel,@function
concat_heads__mha_block_cached__compressed_kv_cla__decode_kernel:
s_cmp_ge_u32 s2, 256
s_cbranch_scc1 L_exit
s_load_dwordx16 s[16:31], s[0:1], 0
s_load_dwordx8 s[32:39], s[0:1], 64
s_load_dwordx4 s[40:43], s[0:1], 96
v_lshrrev_b32 v1, 6, v0
s_nop 0
v_readfirstlane_b32 s3, v1
s_and_b32 s6, s2, 7
s_bfe_u32 s7, s2, 0x20003
s_lshl_b32 s4, s6, 2
s_add_u32 s4, s4, s7
s_lshr_b32 s5, s2, 5
s_cmp_lt_u32 s5, 2
s_cbranch_scc1 B_role
A_role:
s_sub_u32 s8, s5, 2
s_cmp_ge_u32 s8, 3
s_cselect_b32 s9, 1, 0
s_cselect_b32 s6, 3, 0
s_sub_u32 s8, s8, s6
s_lshl_b32 s11, s8, 2
s_add_u32 s11, s11, s3
s_cmp_ge_u32 s11, 6
s_cselect_b32 s83, 1, 0
s_cselect_b32 s6, 6, 0
s_sub_u32 s11, s11, s6
s_lshl_b32 s10, s9, 1
s_add_u32 s10, s10, s83
v_and_b32 v1, 63, v0
v_lshlrev_b32 v2, 4, v1
s_lshl_b32 s12, s11, 12
s_mov_b32 s13, 24576
s_cmp_lt_u32 s11, 4
s_cselect_b32 s14, 43, 42
s_lshl_b32 s6, s10, 5
s_add_u32 s6, s6, s4
s_lshl_b32 s6, s6, 20
s_waitcnt lgkmcnt(0)
s_add_u32 s52, s18, s6
s_addc_u32 s53, s19, 0
s_mov_b32 s54, 0x100000
s_mov_b32 s55, 0x20000
s_add_u32 s56, s20, s6
s_addc_u32 s57, s21, 0
s_mov_b32 s58, 0x100000
s_mov_b32 s59, 0x20000
s_mul_i32 s6, s9, 2304
s_mul_i32 s7, s3, 288
s_add_u32 s6, s6, s7
s_sub_u32 s7, 4608, s6
s_add_u32 s44, s16, s6
s_addc_u32 s45, s17, 0
s_mov_b32 s46, s7
s_mov_b32 s47, 0x20000
s_mul_i32 s6, s3, 1179648
s_lshl_b32 s7, s4, 8
s_add_u32 s6, s6, s7
s_sub_u32 s7, 4718592, s6
s_add_u32 s48, s22, s6
s_addc_u32 s49, s23, 0
s_mov_b32 s50, s7
s_mov_b32 s51, 0x20000
v_lshrrev_b32 v5, 4, v1
v_and_b32 v6, 15, v1
v_mul_u32_u24 v3, 294912, v5
v_lshl_add_u32 v3, v6, 4, v3
v_mul_u32_u24 v4, 72, v5
v_lshrrev_b32 v6, 3, v6
v_mul_u32_u24 v6, 1152, v6
v_add_u32 v4, v4, v6
buffer_load_dwordx4 v[20:23], v4, s[44:47], 0 offen offset:0
buffer_load_dwordx4 v[24:27], v4, s[44:47], 0 offen offset:16
buffer_load_dwordx4 v[28:31], v4, s[44:47], 0 offen offset:32
buffer_load_dwordx4 v[32:35], v4, s[44:47], 0 offen offset:48
buffer_load_dwordx2 v[36:37], v4, s[44:47], 0 offen offset:64
s_mov_b32 s6, 0
buffer_load_dwordx4 a[96:99], v3, s[48:51], s6 offen nt
s_mov_b32 s6, 8192
buffer_load_dwordx4 a[100:103], v3, s[48:51], s6 offen nt
s_mov_b32 s6, 16384
buffer_load_dwordx4 a[104:107], v3, s[48:51], s6 offen nt
buffer_load_dwordx4 v[92:95], v2, s[52:55], s12 offen offset:0 nt
buffer_load_dwordx4 v[96:99], v2, s[52:55], s12 offen offset:1024 nt
buffer_load_dwordx4 v[100:103], v2, s[52:55], s12 offen offset:2048 nt
buffer_load_dwordx4 v[104:107], v2, s[52:55], s12 offen offset:3072 nt
s_mov_b32 s6, 24576
buffer_load_dwordx4 a[108:111], v3, s[48:51], s6 offen nt
s_mov_b32 s6, 32768
buffer_load_dwordx4 a[112:115], v3, s[48:51], s6 offen nt
s_mov_b32 s6, 40960
buffer_load_dwordx4 a[116:119], v3, s[48:51], s6 offen nt
buffer_load_dwordx4 a[0:3], v2, s[56:59], s12 offen offset:0 nt
buffer_load_dwordx4 a[4:7], v2, s[56:59], s12 offen offset:1024 nt
buffer_load_dwordx4 a[8:11], v2, s[56:59], s12 offen offset:2048 nt
buffer_load_dwordx4 a[12:15], v2, s[56:59], s12 offen offset:3072 nt
s_add_u32 s12, s12, s13
s_mov_b32 s6, 49152
buffer_load_dwordx4 a[120:123], v3, s[48:51], s6 offen nt
s_mov_b32 s6, 57344
buffer_load_dwordx4 a[124:127], v3, s[48:51], s6 offen nt
s_mov_b32 s6, 65536
buffer_load_dwordx4 a[128:131], v3, s[48:51], s6 offen nt
buffer_load_dwordx4 v[108:111], v2, s[52:55], s12 offen offset:0 nt
buffer_load_dwordx4 v[112:115], v2, s[52:55], s12 offen offset:1024 nt
buffer_load_dwordx4 v[116:119], v2, s[52:55], s12 offen offset:2048 nt
buffer_load_dwordx4 v[120:123], v2, s[52:55], s12 offen offset:3072 nt
s_mov_b32 s6, 73728
buffer_load_dwordx4 a[132:135], v3, s[48:51], s6 offen nt
s_mov_b32 s6, 81920
buffer_load_dwordx4 a[136:139], v3, s[48:51], s6 offen nt
s_mov_b32 s6, 90112
buffer_load_dwordx4 a[140:143], v3, s[48:51], s6 offen nt
buffer_load_dwordx4 a[16:19], v2, s[56:59], s12 offen offset:0 nt
buffer_load_dwordx4 a[20:23], v2, s[56:59], s12 offen offset:1024 nt
buffer_load_dwordx4 a[24:27], v2, s[56:59], s12 offen offset:2048 nt
buffer_load_dwordx4 a[28:31], v2, s[56:59], s12 offen offset:3072 nt
s_add_u32 s12, s12, s13
s_mov_b32 s6, 98304
buffer_load_dwordx4 a[144:147], v3, s[48:51], s6 offen nt
s_mov_b32 s6, 106496
buffer_load_dwordx4 a[148:151], v3, s[48:51], s6 offen nt
s_mov_b32 s6, 114688
buffer_load_dwordx4 a[152:155], v3, s[48:51], s6 offen nt
buffer_load_dwordx4 v[124:127], v2, s[52:55], s12 offen offset:0 nt
buffer_load_dwordx4 v[128:131], v2, s[52:55], s12 offen offset:1024 nt
buffer_load_dwordx4 v[132:135], v2, s[52:55], s12 offen offset:2048 nt
buffer_load_dwordx4 v[136:139], v2, s[52:55], s12 offen offset:3072 nt
s_mov_b32 s6, 122880
buffer_load_dwordx4 a[156:159], v3, s[48:51], s6 offen nt
s_mov_b32 s6, 131072
buffer_load_dwordx4 a[160:163], v3, s[48:51], s6 offen nt
s_mov_b32 s6, 139264
buffer_load_dwordx4 a[164:167], v3, s[48:51], s6 offen nt
buffer_load_dwordx4 a[32:35], v2, s[56:59], s12 offen offset:0 nt
buffer_load_dwordx4 a[36:39], v2, s[56:59], s12 offen offset:1024 nt
buffer_load_dwordx4 a[40:43], v2, s[56:59], s12 offen offset:2048 nt
buffer_load_dwordx4 a[44:47], v2, s[56:59], s12 offen offset:3072 nt
s_add_u32 s12, s12, s13
s_mov_b32 s6, 147456
buffer_load_dwordx4 a[168:171], v3, s[48:51], s6 offen nt
s_mov_b32 s6, 155648
buffer_load_dwordx4 a[172:175], v3, s[48:51], s6 offen nt
s_mov_b32 s6, 163840
buffer_load_dwordx4 a[176:179], v3, s[48:51], s6 offen nt
buffer_load_dwordx4 v[140:143], v2, s[52:55], s12 offen offset:0 nt
buffer_load_dwordx4 v[144:147], v2, s[52:55], s12 offen offset:1024 nt
buffer_load_dwordx4 v[148:151], v2, s[52:55], s12 offen offset:2048 nt
buffer_load_dwordx4 v[152:155], v2, s[52:55], s12 offen offset:3072 nt
s_mov_b32 s6, 172032
buffer_load_dwordx4 a[180:183], v3, s[48:51], s6 offen nt
s_mov_b32 s64, s42
s_mov_b32 s65, s43
s_mov_b32 s66, 6291456
s_mov_b32 s67, 0x20000
s_mov_b32 s68, s40
s_mov_b32 s69, s41
s_mov_b32 s70, 256
s_mov_b32 s71, 0x20000
s_mul_i32 s6, s4, 147456
s_add_u32 s60, s24, s6
s_addc_u32 s61, s25, 0
s_mov_b32 s62, 147456
s_mov_b32 s63, 0x20000
v_and_b32 v5, 1, v1
v_lshlrev_b32 v5, 4, v5
v_mov_b32 v6, 0xffff
v_lshlrev_b32 v5, v5, v6
v_bfe_u32 v6, v1, 1, 2
v_cmp_eq_u32 vcc, 0, v6
s_nop 1
v_cndmask_b32 v8, 0, v5, vcc
v_cmp_eq_u32 vcc, 1, v6
s_nop 1
v_cndmask_b32 v9, 0, v5, vcc
v_cmp_eq_u32 vcc, 2, v6
s_nop 1
v_cndmask_b32 v10, 0, v5, vcc
v_cmp_eq_u32 vcc, 3, v6
s_nop 1
v_cndmask_b32 v11, 0, v5, vcc
v_mov_b32 v5, 0x0c0c0c0c
s_mov_b32 s6, 0x01000100
s_mov_b32 s7, 0x03020302
v_bfi_b32 v12, v8, s6, v5
v_bfi_b32 v13, v9, s6, v5
v_bfi_b32 v14, v10, s6, v5
v_bfi_b32 v15, v11, s6, v5
v_bfi_b32 v16, v8, s7, v5
v_bfi_b32 v17, v9, s7, v5
v_bfi_b32 v18, v10, s7, v5
v_bfi_b32 v19, v11, s7, v5
v_mov_b32 v7, 0x3e0293ee
v_mov_b32 v73, 0xff800000
v_mov_b32 v76, 0
v_lshrrev_b32 v5, 4, v1
v_lshlrev_b32 v5, 3, v5
v_bfe_u32 v6, v1, 2, 2
v_add_u32 v5, v5, v6
v_mul_u32_u24 v5, 1152, v5
s_mul_i32 s6, s3, 288
v_add_u32 v5, s6, v5
v_and_b32 v6, 3, v1
v_lshl_add_u32 v78, v6, 5, v5
v_lshl_add_u32 v79, v6, 3, v5
v_add_u32 v79, 256, v79
v_add_u32 v80, 73728, v78
v_add_u32 v81, 73728, v79
v_bfe_u32 v5, v1, 4, 1
s_lshl_b32 s6, s9, 7
s_lshl_b32 s7, s4, 1
s_add_u32 s6, s6, s7
s_add_u32 s6, s6, s8
v_mul_u32_u24 v6, 63, v5
v_add_u32 v6, s6, v6
v_lshlrev_b32 v84, 3, v6
v_add_u32 v84, 327680, v84
v_mul_u32_u24 v82, 2304, v6
v_add_u32 v82, 4194304, v82
v_sub_u32 v6, s8, v5
v_cmp_lt_u32 vcc, 1, v6
v_mov_b32 v6, 2146435072
s_nop 0
v_cndmask_b32 v82, v82, v6, vcc
v_cndmask_b32 v84, v84, v6, vcc
s_cmp_lg_u32 s3, 0
s_cbranch_scc1 L_noclr_1
v_mov_b32 v188, -1
v_mov_b32 v189, -1
v_mov_b32 v190, -1
v_mov_b32 v191, -1
v_and_b32 v71, 15, v1
v_lshrrev_b32 v72, 5, v1
v_lshl_add_u32 v71, v72, 4, v71
v_lshl_add_u32 v71, v71, 4, v82
buffer_store_dwordx4 v[188:191], v71, s[64:67], 0 offen offset:0 sc1
buffer_store_dwordx4 v[188:191], v71, s[64:67], 0 offen offset:512 sc1
buffer_store_dwordx4 v[188:191], v71, s[64:67], 0 offen offset:1024 sc1
buffer_store_dwordx4 v[188:191], v71, s[64:67], 0 offen offset:1536 sc1
s_mov_b64 exec, 0xffffffff
buffer_store_dwordx4 v[188:191], v71, s[64:67], 0 offen offset:2048 sc1
s_mov_b64 exec, 0x10001
buffer_store_dwordx2 v[188:189], v84, s[64:67], 0 offen sc1
s_mov_b64 exec, -1
L_noclr_1:
s_mul_i32 s6, s3, 576
v_add_u32 v82, s6, v82
v_and_b32 v71, 3, v1
v_bfe_u32 v72, v1, 2, 2
v_lshl_add_u32 v71, v71, 2, v72
v_lshl_add_u32 v83, v71, 2, v82
v_and_b32 v71, 15, v1
v_lshrrev_b32 v72, 5, v1
v_lshl_add_u32 v71, v72, 4, v71
v_lshl_add_u32 v82, v71, 4, v82
v_mov_b32 v6, 0xff800000
s_lshl_b32 s6, s8, 2
s_add_u32 s6, s6, 0
s_cmp_ge_u32 s6, 6
s_cselect_b32 s6, 1, 0
v_cmp_eq_u32 vcc, s6, v5
s_nop 1
v_cndmask_b32 v86, v6, 0, vcc
s_lshl_b32 s6, s8, 2
s_add_u32 s6, s6, 1
s_cmp_ge_u32 s6, 6
s_cselect_b32 s6, 1, 0
v_cmp_eq_u32 vcc, s6, v5
s_nop 1
v_cndmask_b32 v87, v6, 0, vcc
s_lshl_b32 s6, s8, 2
s_add_u32 s6, s6, 2
s_cmp_ge_u32 s6, 6
s_cselect_b32 s6, 1, 0
v_cmp_eq_u32 vcc, s6, v5
s_nop 1
v_cndmask_b32 v88, v6, 0, vcc
s_lshl_b32 s6, s8, 2
s_add_u32 s6, s6, 3
s_cmp_ge_u32 s6, 6
s_cselect_b32 s6, 1, 0
v_cmp_eq_u32 vcc, s6, v5
s_nop 1
v_cndmask_b32 v89, v6, 0, vcc
v_and_b32 v71, 15, v1
v_lshlrev_b32 v71, 4, v71
v_lshl_add_u32 v90, v5, 3, v71
s_lshl_b32 s6, s3, 8
s_add_u32 s6, s6, 151552
v_add_u32 v90, s6, v90
v_and_b32 v71, 3, v1
v_lshlrev_b32 v71, 8, v71
v_lshrrev_b32 v72, 4, v1
v_lshl_add_u32 v91, v72, 4, v71
v_add_u32 v91, 151552, v91
s_mul_i32 s15, s3, 36864
s_mov_b32 s80, 0
s_mov_b32 s81, 0
s_cmp_eq_u32 s3, 0
s_cselect_b32 s82, 3, -1
s_waitcnt vmcnt(49)
v_perm_b32 v40, v20, v20, v12
v_perm_b32 v41, v20, v20, v13
v_perm_b32 v42, v20, v20, v14
v_perm_b32 v43, v20, v20, v15
s_nop 1
v_mfma_f32_16x16x32_bf16 v[56:59], v[40:43], a[96:99], 0
s_mov_b32 s6, 180224
buffer_load_dwordx4 a[184:187], v3, s[48:51], s6 offen nt
s_mov_b32 s6, 188416
buffer_load_dwordx4 a[188:191], v3, s[48:51], s6 offen nt
buffer_load_dwordx4 a[48:51], v2, s[56:59], s12 offen offset:0 nt
buffer_load_dwordx4 a[52:55], v2, s[56:59], s12 offen offset:1024 nt
buffer_load_dwordx4 a[56:59], v2, s[56:59], s12 offen offset:2048 nt
buffer_load_dwordx4 a[60:63], v2, s[56:59], s12 offen offset:3072 nt
s_add_u32 s12, s12, s13
s_waitcnt vmcnt(54)
v_perm_b32 v44, v20, v20, v16
v_perm_b32 v45, v20, v20, v17
v_perm_b32 v46, v20, v20, v18
v_perm_b32 v47, v20, v20, v19
s_nop 1
v_mfma_f32_16x16x32_bf16 v[56:59], v[44:47], a[100:103], v[56:59]
s_mov_b32 s6, 196608
buffer_load_dwordx4 a[192:195], v3, s[48:51], s6 offen nt
s_waitcnt vmcnt(54)
v_perm_b32 v48, v21, v21, v12
v_perm_b32 v49, v21, v21, v13
v_perm_b32 v50, v21, v21, v14
v_perm_b32 v51, v21, v21, v15
s_nop 1
v_mfma_f32_16x16x32_bf16 v[56:59], v[48:51], a[104:107], v[56:59]
s_mov_b32 s6, 204800
buffer_load_dwordx4 a[196:199], v3, s[48:51], s6 offen nt
s_waitcnt vmcnt(50)
v_perm_b32 v52, v21, v21, v16
v_perm_b32 v53, v21, v21, v17
v_perm_b32 v54, v21, v21, v18
v_perm_b32 v55, v21, v21, v19
s_nop 1
v_mfma_f32_16x16x32_bf16 v[56:59], v[52:55], a[108:111], v[56:59]
s_mov_b32 s6, 212992
buffer_load_dwordx4 a[200:203], v3, s[48:51], s6 offen nt
buffer_load_dwordx4 v[156:159], v2, s[52:55], s12 offen offset:0 nt
buffer_load_dwordx4 v[160:163], v2, s[52:55], s12 offen offset:1024 nt
buffer_load_dwordx4 v[164:167], v2, s[52:55], s12 offen offset:2048 nt
buffer_load_dwordx4 v[168:171], v2, s[52:55], s12 offen offset:3072 nt
s_waitcnt vmcnt(54)
v_perm_b32 v40, v22, v22, v12
v_perm_b32 v41, v22, v22, v13
v_perm_b32 v42, v22, v22, v14
v_perm_b32 v43, v22, v22, v15
s_nop 1
v_mfma_f32_16x16x32_bf16 v[56:59], v[40:43], a[112:115], v[56:59]
s_mov_b32 s6, 221184
buffer_load_dwordx4 a[204:207], v3, s[48:51], s6 offen nt
s_waitcnt vmcnt(54)
v_perm_b32 v44, v22, v22, v16
v_perm_b32 v45, v22, v22, v17
v_perm_b32 v46, v22, v22, v18
v_perm_b32 v47, v22, v22, v19
s_nop 1
v_mfma_f32_16x16x32_bf16 v[56:59], v[44:47], a[116:119], v[56:59]
s_mov_b32 s6, 229376
buffer_load_dwordx4 a[208:211], v3, s[48:51], s6 offen nt
s_waitcnt vmcnt(50)
v_perm_b32 v48, v23, v23, v12
v_perm_b32 v49, v23, v23, v13
v_perm_b32 v50, v23, v23, v14
v_perm_b32 v51, v23, v23, v15
s_nop 1
v_mfma_f32_16x16x32_bf16 v[56:59], v[48:51], a[120:123], v[56:59]
s_mov_b32 s6, 237568
buffer_load_dwordx4 a[212:215], v3, s[48:51], s6 offen nt
buffer_load_dwordx4 a[64:67], v2, s[56:59], s12 offen offset:0 nt
buffer_load_dwordx4 a[68:71], v2, s[56:59], s12 offen offset:1024 nt
buffer_load_dwordx4 a[72:75], v2, s[56:59], s12 offen offset:2048 nt
buffer_load_dwordx4 a[76:79], v2, s[56:59], s12 offen offset:3072 nt
s_add_u32 s12, s12, s13
s_waitcnt vmcnt(54)
v_perm_b32 v52, v23, v23, v16
v_perm_b32 v53, v23, v23, v17
v_perm_b32 v54, v23, v23, v18
v_perm_b32 v55, v23, v23, v19
s_nop 1
v_mfma_f32_16x16x32_bf16 v[56:59], v[52:55], a[124:127], v[56:59]
s_mov_b32 s6, 245760
buffer_load_dwordx4 a[216:219], v3, s[48:51], s6 offen nt
s_waitcnt vmcnt(54)
v_perm_b32 v40, v24, v24, v12
v_perm_b32 v41, v24, v24, v13
v_perm_b32 v42, v24, v24, v14
v_perm_b32 v43, v24, v24, v15
s_nop 1
v_mfma_f32_16x16x32_bf16 v[56:59], v[40:43], a[128:131], v[56:59]
s_mov_b32 s6, 253952
buffer_load_dwordx4 a[220:223], v3, s[48:51], s6 offen nt
s_waitcnt vmcnt(50)
v_perm_b32 v44, v24, v24, v16
v_perm_b32 v45, v24, v24, v17
v_perm_b32 v46, v24, v24, v18
v_perm_b32 v47, v24, v24, v19
s_nop 1
v_mfma_f32_16x16x32_bf16 v[56:59], v[44:47], a[132:135], v[56:59]
s_mov_b32 s6, 262144
buffer_load_dwordx4 a[224:227], v3, s[48:51], s6 offen nt
buffer_load_dwordx4 v[172:175], v2, s[52:55], s12 offen offset:0 nt
buffer_load_dwordx4 v[176:179], v2, s[52:55], s12 offen offset:1024 nt
buffer_load_dwordx4 v[180:183], v2, s[52:55], s12 offen offset:2048 nt
buffer_load_dwordx4 v[184:187], v2, s[52:55], s12 offen offset:3072 nt
s_waitcnt vmcnt(54)
v_perm_b32 v48, v25, v25, v12
v_perm_b32 v49, v25, v25, v13
v_perm_b32 v50, v25, v25, v14
v_perm_b32 v51, v25, v25, v15
s_nop 1
v_mfma_f32_16x16x32_bf16 v[56:59], v[48:51], a[136:139], v[56:59]
s_mov_b32 s6, 270336
buffer_load_dwordx4 a[228:231], v3, s[48:51], s6 offen nt
s_waitcnt vmcnt(54)
v_perm_b32 v52, v25, v25, v16
v_perm_b32 v53, v25, v25, v17
v_perm_b32 v54, v25, v25, v18
v_perm_b32 v55, v25, v25, v19
s_nop 1
v_mfma_f32_16x16x32_bf16 v[56:59], v[52:55], a[140:143], v[56:59]
s_mov_b32 s6, 278528
buffer_load_dwordx4 a[232:235], v3, s[48:51], s6 offen nt
s_waitcnt vmcnt(50)
v_perm_b32 v40, v26, v26, v12
v_perm_b32 v41, v26, v26, v13
v_perm_b32 v42, v26, v26, v14
v_perm_b32 v43, v26, v26, v15
s_nop 1
v_mfma_f32_16x16x32_bf16 v[56:59], v[40:43], a[144:147], v[56:59]
s_mov_b32 s6, 286720
buffer_load_dwordx4 a[236:239], v3, s[48:51], s6 offen nt
buffer_load_dwordx4 a[80:83], v2, s[56:59], s12 offen offset:0 nt
buffer_load_dwordx4 a[84:87], v2, s[56:59], s12 offen offset:1024 nt
buffer_load_dwordx4 a[88:91], v2, s[56:59], s12 offen offset:2048 nt
buffer_load_dwordx4 a[92:95], v2, s[56:59], s12 offen offset:3072 nt
s_add_u32 s12, s12, s13
s_waitcnt vmcnt(54)
v_perm_b32 v44, v26, v26, v16
v_perm_b32 v45, v26, v26, v17
v_perm_b32 v46, v26, v26, v18
v_perm_b32 v47, v26, v26, v19
s_nop 1
v_mfma_f32_16x16x32_bf16 v[56:59], v[44:47], a[148:151], v[56:59]
s_waitcnt vmcnt(53)
v_perm_b32 v48, v27, v27, v12
v_perm_b32 v49, v27, v27, v13
v_perm_b32 v50, v27, v27, v14
v_perm_b32 v51, v27, v27, v15
s_nop 1
v_mfma_f32_16x16x32_bf16 v[56:59], v[48:51], a[152:155], v[56:59]
s_waitcnt vmcnt(48)
v_perm_b32 v52, v27, v27, v16
v_perm_b32 v53, v27, v27, v17
v_perm_b32 v54, v27, v27, v18
v_perm_b32 v55, v27, v27, v19
s_nop 1
v_mfma_f32_16x16x32_bf16 v[56:59], v[52:55], a[156:159], v[56:59]
s_waitcnt vmcnt(47)
v_perm_b32 v40, v28, v28, v12
v_perm_b32 v41, v28, v28, v13
v_perm_b32 v42, v28, v28, v14
v_perm_b32 v43, v28, v28, v15
s_nop 1
v_mfma_f32_16x16x32_bf16 v[56:59], v[40:43], a[160:163], v[56:59]
s_waitcnt vmcnt(46)
v_perm_b32 v44, v28, v28, v16
v_perm_b32 v45, v28, v28, v17
v_perm_b32 v46, v28, v28, v18
v_perm_b32 v47, v28, v28, v19
s_nop 1
v_mfma_f32_16x16x32_bf16 v[56:59], v[44:47], a[164:167], v[56:59]
s_waitcnt vmcnt(41)
v_perm_b32 v48, v29, v29, v12
v_perm_b32 v49, v29, v29, v13
v_perm_b32 v50, v29, v29, v14
v_perm_b32 v51, v29, v29, v15
s_nop 1
v_mfma_f32_16x16x32_bf16 v[56:59], v[48:51], a[168:171], v[56:59]
s_waitcnt vmcnt(40)
v_perm_b32 v52, v29, v29, v16
v_perm_b32 v53, v29, v29, v17
v_perm_b32 v54, v29, v29, v18
v_perm_b32 v55, v29, v29, v19
s_nop 1
v_mfma_f32_16x16x32_bf16 v[56:59], v[52:55], a[172:175], v[56:59]
s_waitcnt vmcnt(39)
v_perm_b32 v40, v30, v30, v12
v_perm_b32 v41, v30, v30, v13
v_perm_b32 v42, v30, v30, v14
v_perm_b32 v43, v30, v30, v15
s_nop 1
v_mfma_f32_16x16x32_bf16 v[56:59], v[40:43], a[176:179], v[56:59]
s_waitcnt vmcnt(34)
v_perm_b32 v44, v30, v30, v16
v_perm_b32 v45, v30, v30, v17
v_perm_b32 v46, v30, v30, v18
v_perm_b32 v47, v30, v30, v19
s_nop 1
v_mfma_f32_16x16x32_bf16 v[56:59], v[44:47], a[180:183], v[56:59]
s_waitcnt vmcnt(33)
v_perm_b32 v48, v31, v31, v12
v_perm_b32 v49, v31, v31, v13
v_perm_b32 v50, v31, v31, v14
v_perm_b32 v51, v31, v31, v15
s_nop 1
v_mfma_f32_16x16x32_bf16 v[56:59], v[48:51], a[184:187], v[56:59]
s_waitcnt vmcnt(32)
v_perm_b32 v52, v31, v31, v16
v_perm_b32 v53, v31, v31, v17
v_perm_b32 v54, v31, v31, v18
v_perm_b32 v55, v31, v31, v19
s_nop 1
v_mfma_f32_16x16x32_bf16 v[56:59], v[52:55], a[188:191], v[56:59]
s_waitcnt vmcnt(27)
v_perm_b32 v40, v32, v32, v12
v_perm_b32 v41, v32, v32, v13
v_perm_b32 v42, v32, v32, v14
v_perm_b32 v43, v32, v32, v15
s_nop 1
v_mfma_f32_16x16x32_bf16 v[56:59], v[40:43], a[192:195], v[56:59]
s_waitcnt vmcnt(26)
v_perm_b32 v44, v32, v32, v16
v_perm_b32 v45, v32, v32, v17
v_perm_b32 v46, v32, v32, v18
v_perm_b32 v47, v32, v32, v19
s_nop 1
v_mfma_f32_16x16x32_bf16 v[56:59], v[44:47], a[196:199], v[56:59]
s_waitcnt vmcnt(25)
v_perm_b32 v48, v33, v33, v12
v_perm_b32 v49, v33, v33, v13
v_perm_b32 v50, v33, v33, v14
v_perm_b32 v51, v33, v33, v15
s_nop 1
v_mfma_f32_16x16x32_bf16 v[56:59], v[48:51], a[200:203], v[56:59]
s_waitcnt vmcnt(20)
v_perm_b32 v52, v33, v33, v16
v_perm_b32 v53, v33, v33, v17
v_perm_b32 v54, v33, v33, v18
v_perm_b32 v55, v33, v33, v19
s_nop 1
v_mfma_f32_16x16x32_bf16 v[56:59], v[52:55], a[204:207], v[56:59]
s_waitcnt vmcnt(19)
v_perm_b32 v40, v34, v34, v12
v_perm_b32 v41, v34, v34, v13
v_perm_b32 v42, v34, v34, v14
v_perm_b32 v43, v34, v34, v15
s_nop 1
v_mfma_f32_16x16x32_bf16 v[56:59], v[40:43], a[208:211], v[56:59]
s_waitcnt vmcnt(18)
v_perm_b32 v44, v34, v34, v16
v_perm_b32 v45, v34, v34, v17
v_perm_b32 v46, v34, v34, v18
v_perm_b32 v47, v34, v34, v19
s_nop 1
v_mfma_f32_16x16x32_bf16 v[56:59], v[44:47], a[212:215], v[56:59]
s_waitcnt vmcnt(13)
v_perm_b32 v48, v35, v35, v12
v_perm_b32 v49, v35, v35, v13
v_perm_b32 v50, v35, v35, v14
v_perm_b32 v51, v35, v35, v15
s_nop 1
v_mfma_f32_16x16x32_bf16 v[56:59], v[48:51], a[216:219], v[56:59]
s_waitcnt vmcnt(12)
v_perm_b32 v52, v35, v35, v16
v_perm_b32 v53, v35, v35, v17
v_perm_b32 v54, v35, v35, v18
v_perm_b32 v55, v35, v35, v19
s_nop 1
v_mfma_f32_16x16x32_bf16 v[56:59], v[52:55], a[220:223], v[56:59]
s_waitcnt vmcnt(11)
v_perm_b32 v40, v36, v36, v12
v_perm_b32 v41, v36, v36, v13
v_perm_b32 v42, v36, v36, v14
v_perm_b32 v43, v36, v36, v15
s_nop 1
v_mfma_f32_16x16x32_bf16 v[56:59], v[40:43], a[224:227], v[56:59]
s_waitcnt vmcnt(6)
v_perm_b32 v44, v36, v36, v16
v_perm_b32 v45, v36, v36, v17
v_perm_b32 v46, v36, v36, v18
v_perm_b32 v47, v36, v36, v19
s_nop 1
v_mfma_f32_16x16x32_bf16 v[56:59], v[44:47], a[228:231], v[56:59]
s_waitcnt vmcnt(5)
v_perm_b32 v48, v37, v37, v12
v_perm_b32 v49, v37, v37, v13
v_perm_b32 v50, v37, v37, v14
v_perm_b32 v51, v37, v37, v15
s_nop 1
v_mfma_f32_16x16x32_bf16 v[56:59], v[48:51], a[232:235], v[56:59]
s_waitcnt vmcnt(4)
v_perm_b32 v52, v37, v37, v16
v_perm_b32 v53, v37, v37, v17
v_perm_b32 v54, v37, v37, v18
v_perm_b32 v55, v37, v37, v19
s_nop 1
v_mfma_f32_16x16x32_bf16 v[56:59], v[52:55], a[236:239], v[56:59]
v_and_b32 v71, 15, v1
v_lshlrev_b32 v71, 5, v71
v_lshl_add_u32 v72, v5, 4, v71
v_lshrrev_b32 v6, 5, v1
v_lshl_add_u32 v72, v6, 9, v72
s_lshl_b32 s6, s3, 10
s_add_u32 s6, s6, 147456
v_add_u32 v72, s6, v72
ds_write_b128 v72, v[56:59]
s_lshl_b32 s6, s83, 9
s_add_u32 s6, s6, 147456
v_add_u32 v71, s6, v71
s_waitcnt lgkmcnt(0)
s_barrier
ds_read_b128 v[188:191], v71 offset:0
ds_read_b128 v[192:195], v71 offset:16
ds_read_b128 v[196:199], v71 offset:1024
ds_read_b128 v[200:203], v71 offset:1040
ds_read_b128 v[204:207], v71 offset:2048
ds_read_b128 v[208:211], v71 offset:2064
ds_read_b128 v[212:215], v71 offset:3072
ds_read_b128 v[216:219], v71 offset:3088
v_mov_b32 v56, 0
v_mov_b32 v57, 0
v_mov_b32 v58, 0
v_mov_b32 v59, 0
s_waitcnt lgkmcnt(0)
v_add_f32 v188, v188, v196
v_add_f32 v204, v204, v212
v_add_f32 v189, v189, v197
v_add_f32 v205, v205, v213
v_add_f32 v190, v190, v198
v_add_f32 v206, v206, v214
v_add_f32 v191, v191, v199
v_add_f32 v207, v207, v215
v_add_f32 v192, v192, v200
v_add_f32 v208, v208, v216
v_add_f32 v193, v193, v201
v_add_f32 v209, v209, v217
v_add_f32 v194, v194, v202
v_add_f32 v210, v210, v218
v_add_f32 v195, v195, v203
v_add_f32 v211, v211, v219
v_add_f32 v188, v188, v204
v_add_f32 v189, v189, v205
v_add_f32 v190, v190, v206
v_add_f32 v191, v191, v207
v_add_f32 v192, v192, v208
v_add_f32 v193, v193, v209
v_add_f32 v194, v194, v210
v_add_f32 v195, v195, v211
v_cvt_pk_bf16_f32 v60, v188, v189
v_cvt_pk_bf16_f32 v61, v190, v191
v_cvt_pk_bf16_f32 v62, v192, v193
v_cvt_pk_bf16_f32 v63, v194, v195
A_loop:
s_cmp_eq_u32 s81, 6
s_cbranch_scc1 A_wo_event
A_loop_in:
s_add_u32 s81, s81, 1
s_waitcnt vmcnt(44)
v_dot2_f32_bf16 v64, v92, v60, 0
v_dot2_f32_bf16 v65, v96, v60, 0
v_dot2_f32_bf16 v66, v100, v60, 0
v_dot2_f32_bf16 v67, v104, v60, 0
v_dot2_f32_bf16 v64, v93, v61, v64
v_dot2_f32_bf16 v65, v97, v61, v65
v_dot2_f32_bf16 v66, v101, v61, v66
v_dot2_f32_bf16 v67, v105, v61, v67
v_dot2_f32_bf16 v64, v94, v62, v64
v_dot2_f32_bf16 v65, v98, v62, v65
v_dot2_f32_bf16 v66, v102, v62, v66
v_dot2_f32_bf16 v67, v106, v62, v67
v_dot2_f32_bf16 v64, v95, v63, v64
v_dot2_f32_bf16 v65, v99, v63, v65
v_dot2_f32_bf16 v66, v103, v63, v66
v_dot2_f32_bf16 v67, v107, v63, v67
buffer_load_dwordx4 v[92:95], v2, s[52:55], s12 offen offset:0 nt
buffer_load_dwordx4 v[96:99], v2, s[52:55], s12 offen offset:1024 nt
buffer_load_dwordx4 v[100:103], v2, s[52:55], s12 offen offset:2048 nt
buffer_load_dwordx4 v[104:107], v2, s[52:55], s12 offen offset:3072 nt
v_add_f32_dpp v68, v64, v64 row_ror:8 row_mask:0xf bank_mask:0x3
v_add_f32_dpp v69, v65, v65 row_ror:8 row_mask:0xf bank_mask:0x3
v_add_f32_dpp v68, v66, v66 row_ror:8 row_mask:0xf bank_mask:0xc
v_add_f32_dpp v69, v67, v67 row_ror:8 row_mask:0xf bank_mask:0xc
s_nop 0
v_add_f32_dpp v70, v68, v68 row_half_mirror row_mask:0xf bank_mask:0x5
v_add_f32_dpp v70, v69, v69 row_half_mirror row_mask:0xf bank_mask:0xa
s_nop 1
v_add_f32_dpp v70, v70, v70 quad_perm:[1,0,3,2] row_mask:0xf bank_mask:0xf
s_nop 1
v_add_f32_dpp v70, v70, v70 quad_perm:[2,3,0,1] row_mask:0xf bank_mask:0xf
v_mul_f32 v70, v70, v7
s_nop 1
v_max_f32_dpp v71, v70, v70 row_ror:4 row_mask:0xf bank_mask:0xf
s_nop 1
v_max_f32_dpp v71, v71, v71 row_ror:8 row_mask:0xf bank_mask:0xf
v_mov_b32 v72, v71
s_nop 1
v_permlane16_swap_b32 v71, v72
v_max_f32 v71, v71, v72
v_mov_b32 v72, v71
s_nop 1
v_permlane32_swap_b32 v71, v72
v_max3_f32 v74, v71, v72, v73
v_sub_f32 v70, v70, v74
v_sub_f32 v75, v73, v74
v_exp_f32 v70, v70
v_exp_f32 v75, v75
v_mov_b32 v73, v74
v_cvt_pk_bf16_f32 v77, v70, v70
v_fma_f32 v76, v76, v75, v70
v_mul_f32 v56, v56, v75
v_mul_f32 v57, v57, v75
v_mul_f32 v58, v58, v75
v_mul_f32 v59, v59, v75
v_and_b32_dpp v40, v77, v8 row_newbcast:0 row_mask:0xf bank_mask:0xf
v_and_b32_dpp v41, v77, v9 row_newbcast:0 row_mask:0xf bank_mask:0xf
v_and_b32_dpp v42, v77, v10 row_newbcast:0 row_mask:0xf bank_mask:0xf
v_and_b32_dpp v43, v77, v11 row_newbcast:0 row_mask:0xf bank_mask:0xf
v_and_b32_dpp v44, v77, v8 row_newbcast:4 row_mask:0xf bank_mask:0xf
v_and_b32_dpp v45, v77, v9 row_newbcast:4 row_mask:0xf bank_mask:0xf
v_and_b32_dpp v46, v77, v10 row_newbcast:4 row_mask:0xf bank_mask:0xf
v_and_b32_dpp v47, v77, v11 row_newbcast:4 row_mask:0xf bank_mask:0xf
v_and_b32_dpp v48, v77, v8 row_newbcast:8 row_mask:0xf bank_mask:0xf
v_and_b32_dpp v49, v77, v9 row_newbcast:8 row_mask:0xf bank_mask:0xf
v_and_b32_dpp v50, v77, v10 row_newbcast:8 row_mask:0xf bank_mask:0xf
v_and_b32_dpp v51, v77, v11 row_newbcast:8 row_mask:0xf bank_mask:0xf
v_and_b32_dpp v52, v77, v8 row_newbcast:12 row_mask:0xf bank_mask:0xf
v_and_b32_dpp v53, v77, v9 row_newbcast:12 row_mask:0xf bank_mask:0xf
v_and_b32_dpp v54, v77, v10 row_newbcast:12 row_mask:0xf bank_mask:0xf
v_and_b32_dpp v55, v77, v11 row_newbcast:12 row_mask:0xf bank_mask:0xf
s_waitcnt vmcnt(44)
v_mfma_f32_16x16x32_bf16 v[56:59], v[40:43], a[0:3], v[56:59]
v_mfma_f32_16x16x32_bf16 v[56:59], v[44:47], a[4:7], v[56:59]
v_mfma_f32_16x16x32_bf16 v[56:59], v[48:51], a[8:11], v[56:59]
v_mfma_f32_16x16x32_bf16 v[56:59], v[52:55], a[12:15], v[56:59]
s_sub_u32 s14, s14, 1
s_cmp_eq_u32 s14, 0
s_cbranch_scc1 A_tail
buffer_load_dwordx4 a[0:3], v2, s[56:59], s12 offen offset:0 nt
buffer_load_dwordx4 a[4:7], v2, s[56:59], s12 offen offset:1024 nt
buffer_load_dwordx4 a[8:11], v2, s[56:59], s12 offen offset:2048 nt
buffer_load_dwordx4 a[12:15], v2, s[56:59], s12 offen offset:3072 nt
s_add_u32 s12, s12, s13
s_add_u32 s80, s80, 1
s_sub_u32 s6, s80, 7
s_cmp_ge_u32 s6, 18
s_cbranch_scc1 L_nodma_2
s_mov_b32 m0, s15
s_nop 0
buffer_load_dwordx4 v2, s[60:63], s15 offen nt lds
buffer_load_dwordx4 v2, s[60:63], s15 offen offset:1024 nt lds
s_add_u32 s15, s15, 2048
L_nodma_2:
s_waitcnt vmcnt(44)
v_dot2_f32_bf16 v64, v108, v60, 0
v_dot2_f32_bf16 v65, v112, v60, 0
v_dot2_f32_bf16 v66, v116, v60, 0
v_dot2_f32_bf16 v67, v120, v60, 0
v_dot2_f32_bf16 v64, v109, v61, v64
v_dot2_f32_bf16 v65, v113, v61, v65
v_dot2_f32_bf16 v66, v117, v61, v66
v_dot2_f32_bf16 v67, v121, v61, v67
v_dot2_f32_bf16 v64, v110, v62, v64
v_dot2_f32_bf16 v65, v114, v62, v65
v_dot2_f32_bf16 v66, v118, v62, v66
v_dot2_f32_bf16 v67, v122, v62, v67
v_dot2_f32_bf16 v64, v111, v63, v64
v_dot2_f32_bf16 v65, v115, v63, v65
v_dot2_f32_bf16 v66, v119, v63, v66
v_dot2_f32_bf16 v67, v123, v63, v67
buffer_load_dwordx4 v[108:111], v2, s[52:55], s12 offen offset:0 nt
buffer_load_dwordx4 v[112:115], v2, s[52:55], s12 offen offset:1024 nt
buffer_load_dwordx4 v[116:119], v2, s[52:55], s12 offen offset:2048 nt
buffer_load_dwordx4 v[120:123], v2, s[52:55], s12 offen offset:3072 nt
v_add_f32_dpp v68, v64, v64 row_ror:8 row_mask:0xf bank_mask:0x3
v_add_f32_dpp v69, v65, v65 row_ror:8 row_mask:0xf bank_mask:0x3
v_add_f32_dpp v68, v66, v66 row_ror:8 row_mask:0xf bank_mask:0xc
v_add_f32_dpp v69, v67, v67 row_ror:8 row_mask:0xf bank_mask:0xc
s_nop 0
v_add_f32_dpp v70, v68, v68 row_half_mirror row_mask:0xf bank_mask:0x5
v_add_f32_dpp v70, v69, v69 row_half_mirror row_mask:0xf bank_mask:0xa
s_nop 1
v_add_f32_dpp v70, v70, v70 quad_perm:[1,0,3,2] row_mask:0xf bank_mask:0xf
s_nop 1
v_add_f32_dpp v70, v70, v70 quad_perm:[2,3,0,1] row_mask:0xf bank_mask:0xf
v_mul_f32 v70, v70, v7
s_nop 1
v_max_f32_dpp v71, v70, v70 row_ror:4 row_mask:0xf bank_mask:0xf
s_nop 1
v_max_f32_dpp v71, v71, v71 row_ror:8 row_mask:0xf bank_mask:0xf
v_mov_b32 v72, v71
s_nop 1
v_permlane16_swap_b32 v71, v72
v_max_f32 v71, v71, v72
v_mov_b32 v72, v71
s_nop 1
v_permlane32_swap_b32 v71, v72
v_max3_f32 v74, v71, v72, v73
v_sub_f32 v70, v70, v74
v_sub_f32 v75, v73, v74
v_exp_f32 v70, v70
v_exp_f32 v75, v75
v_mov_b32 v73, v74
v_cvt_pk_bf16_f32 v77, v70, v70
v_fma_f32 v76, v76, v75, v70
v_mul_f32 v56, v56, v75
v_mul_f32 v57, v57, v75
v_mul_f32 v58, v58, v75
v_mul_f32 v59, v59, v75
v_and_b32_dpp v40, v77, v8 row_newbcast:0 row_mask:0xf bank_mask:0xf
v_and_b32_dpp v41, v77, v9 row_newbcast:0 row_mask:0xf bank_mask:0xf
v_and_b32_dpp v42, v77, v10 row_newbcast:0 row_mask:0xf bank_mask:0xf
v_and_b32_dpp v43, v77, v11 row_newbcast:0 row_mask:0xf bank_mask:0xf
v_and_b32_dpp v44, v77, v8 row_newbcast:4 row_mask:0xf bank_mask:0xf
v_and_b32_dpp v45, v77, v9 row_newbcast:4 row_mask:0xf bank_mask:0xf
v_and_b32_dpp v46, v77, v10 row_newbcast:4 row_mask:0xf bank_mask:0xf
v_and_b32_dpp v47, v77, v11 row_newbcast:4 row_mask:0xf bank_mask:0xf
v_and_b32_dpp v48, v77, v8 row_newbcast:8 row_mask:0xf bank_mask:0xf
v_and_b32_dpp v49, v77, v9 row_newbcast:8 row_mask:0xf bank_mask:0xf
v_and_b32_dpp v50, v77, v10 row_newbcast:8 row_mask:0xf bank_mask:0xf
v_and_b32_dpp v51, v77, v11 row_newbcast:8 row_mask:0xf bank_mask:0xf
v_and_b32_dpp v52, v77, v8 row_newbcast:12 row_mask:0xf bank_mask:0xf
v_and_b32_dpp v53, v77, v9 row_newbcast:12 row_mask:0xf bank_mask:0xf
v_and_b32_dpp v54, v77, v10 row_newbcast:12 row_mask:0xf bank_mask:0xf
v_and_b32_dpp v55, v77, v11 row_newbcast:12 row_mask:0xf bank_mask:0xf
s_waitcnt vmcnt(44)
v_mfma_f32_16x16x32_bf16 v[56:59], v[40:43], a[16:19], v[56:59]
v_mfma_f32_16x16x32_bf16 v[56:59], v[44:47], a[20:23], v[56:59]
v_mfma_f32_16x16x32_bf16 v[56:59], v[48:51], a[24:27], v[56:59]
v_mfma_f32_16x16x32_bf16 v[56:59], v[52:55], a[28:31], v[56:59]
s_sub_u32 s14, s14, 1
s_cmp_eq_u32 s14, 0
s_cbranch_scc1 A_tail
buffer_load_dwordx4 a[16:19], v2, s[56:59], s12 offen offset:0 nt
buffer_load_dwordx4 a[20:23], v2, s[56:59], s12 offen offset:1024 nt
buffer_load_dwordx4 a[24:27], v2, s[56:59], s12 offen offset:2048 nt
buffer_load_dwordx4 a[28:31], v2, s[56:59], s12 offen offset:3072 nt
s_add_u32 s12, s12, s13
s_add_u32 s80, s80, 1
s_sub_u32 s6, s80, 7
s_cmp_ge_u32 s6, 18
s_cbranch_scc1 L_nodma_3
s_mov_b32 m0, s15
s_nop 0
buffer_load_dwordx4 v2, s[60:63], s15 offen nt lds
buffer_load_dwordx4 v2, s[60:63], s15 offen offset:1024 nt lds
s_add_u32 s15, s15, 2048
L_nodma_3:
s_waitcnt vmcnt(44)
v_dot2_f32_bf16 v64, v124, v60, 0
v_dot2_f32_bf16 v65, v128, v60, 0
v_dot2_f32_bf16 v66, v132, v60, 0
v_dot2_f32_bf16 v67, v136, v60, 0
v_dot2_f32_bf16 v64, v125, v61, v64
v_dot2_f32_bf16 v65, v129, v61, v65
v_dot2_f32_bf16 v66, v133, v61, v66
v_dot2_f32_bf16 v67, v137, v61, v67
v_dot2_f32_bf16 v64, v126, v62, v64
v_dot2_f32_bf16 v65, v130, v62, v65
v_dot2_f32_bf16 v66, v134, v62, v66
v_dot2_f32_bf16 v67, v138, v62, v67
v_dot2_f32_bf16 v64, v127, v63, v64
v_dot2_f32_bf16 v65, v131, v63, v65
v_dot2_f32_bf16 v66, v135, v63, v66
v_dot2_f32_bf16 v67, v139, v63, v67
buffer_load_dwordx4 v[124:127], v2, s[52:55], s12 offen offset:0 nt
buffer_load_dwordx4 v[128:131], v2, s[52:55], s12 offen offset:1024 nt
buffer_load_dwordx4 v[132:135], v2, s[52:55], s12 offen offset:2048 nt
buffer_load_dwordx4 v[136:139], v2, s[52:55], s12 offen offset:3072 nt
v_add_f32_dpp v68, v64, v64 row_ror:8 row_mask:0xf bank_mask:0x3
v_add_f32_dpp v69, v65, v65 row_ror:8 row_mask:0xf bank_mask:0x3
v_add_f32_dpp v68, v66, v66 row_ror:8 row_mask:0xf bank_mask:0xc
v_add_f32_dpp v69, v67, v67 row_ror:8 row_mask:0xf bank_mask:0xc
s_nop 0
v_add_f32_dpp v70, v68, v68 row_half_mirror row_mask:0xf bank_mask:0x5
v_add_f32_dpp v70, v69, v69 row_half_mirror row_mask:0xf bank_mask:0xa
s_nop 1
v_add_f32_dpp v70, v70, v70 quad_perm:[1,0,3,2] row_mask:0xf bank_mask:0xf
s_nop 1
v_add_f32_dpp v70, v70, v70 quad_perm:[2,3,0,1] row_mask:0xf bank_mask:0xf
v_mul_f32 v70, v70, v7
s_nop 1
v_max_f32_dpp v71, v70, v70 row_ror:4 row_mask:0xf bank_mask:0xf
s_nop 1
v_max_f32_dpp v71, v71, v71 row_ror:8 row_mask:0xf bank_mask:0xf
v_mov_b32 v72, v71
s_nop 1
v_permlane16_swap_b32 v71, v72
v_max_f32 v71, v71, v72
v_mov_b32 v72, v71
s_nop 1
v_permlane32_swap_b32 v71, v72
v_max3_f32 v74, v71, v72, v73
v_sub_f32 v70, v70, v74
v_sub_f32 v75, v73, v74
v_exp_f32 v70, v70
v_exp_f32 v75, v75
v_mov_b32 v73, v74
v_cvt_pk_bf16_f32 v77, v70, v70
v_fma_f32 v76, v76, v75, v70
v_mul_f32 v56, v56, v75
v_mul_f32 v57, v57, v75
v_mul_f32 v58, v58, v75
v_mul_f32 v59, v59, v75
v_and_b32_dpp v40, v77, v8 row_newbcast:0 row_mask:0xf bank_mask:0xf
v_and_b32_dpp v41, v77, v9 row_newbcast:0 row_mask:0xf bank_mask:0xf
v_and_b32_dpp v42, v77, v10 row_newbcast:0 row_mask:0xf bank_mask:0xf
v_and_b32_dpp v43, v77, v11 row_newbcast:0 row_mask:0xf bank_mask:0xf
v_and_b32_dpp v44, v77, v8 row_newbcast:4 row_mask:0xf bank_mask:0xf
v_and_b32_dpp v45, v77, v9 row_newbcast:4 row_mask:0xf bank_mask:0xf
v_and_b32_dpp v46, v77, v10 row_newbcast:4 row_mask:0xf bank_mask:0xf
v_and_b32_dpp v47, v77, v11 row_newbcast:4 row_mask:0xf bank_mask:0xf
v_and_b32_dpp v48, v77, v8 row_newbcast:8 row_mask:0xf bank_mask:0xf
v_and_b32_dpp v49, v77, v9 row_newbcast:8 row_mask:0xf bank_mask:0xf
v_and_b32_dpp v50, v77, v10 row_newbcast:8 row_mask:0xf bank_mask:0xf
v_and_b32_dpp v51, v77, v11 row_newbcast:8 row_mask:0xf bank_mask:0xf
v_and_b32_dpp v52, v77, v8 row_newbcast:12 row_mask:0xf bank_mask:0xf
v_and_b32_dpp v53, v77, v9 row_newbcast:12 row_mask:0xf bank_mask:0xf
v_and_b32_dpp v54, v77, v10 row_newbcast:12 row_mask:0xf bank_mask:0xf
v_and_b32_dpp v55, v77, v11 row_newbcast:12 row_mask:0xf bank_mask:0xf
s_waitcnt vmcnt(44)
v_mfma_f32_16x16x32_bf16 v[56:59], v[40:43], a[32:35], v[56:59]
v_mfma_f32_16x16x32_bf16 v[56:59], v[44:47], a[36:39], v[56:59]
v_mfma_f32_16x16x32_bf16 v[56:59], v[48:51], a[40:43], v[56:59]
v_mfma_f32_16x16x32_bf16 v[56:59], v[52:55], a[44:47], v[56:59]
s_sub_u32 s14, s14, 1
s_cmp_eq_u32 s14, 0
s_cbranch_scc1 A_tail
buffer_load_dwordx4 a[32:35], v2, s[56:59], s12 offen offset:0 nt
buffer_load_dwordx4 a[36:39], v2, s[56:59], s12 offen offset:1024 nt
buffer_load_dwordx4 a[40:43], v2, s[56:59], s12 offen offset:2048 nt
buffer_load_dwordx4 a[44:47], v2, s[56:59], s12 offen offset:3072 nt
s_add_u32 s12, s12, s13
s_add_u32 s80, s80, 1
s_sub_u32 s6, s80, 7
s_cmp_ge_u32 s6, 18
s_cbranch_scc1 L_nodma_4
s_mov_b32 m0, s15
s_nop 0
buffer_load_dwordx4 v2, s[60:63], s15 offen nt lds
buffer_load_dwordx4 v2, s[60:63], s15 offen offset:1024 nt lds
s_add_u32 s15, s15, 2048
L_nodma_4:
s_cmp_lg_u32 s14, s82
s_cbranch_scc1 L_nosig_5
v_mov_b32 v5, 1
s_mov_b64 exec, 1
buffer_atomic_add v5, off, s[68:71], 0 offset:192
s_mov_b64 exec, -1
L_nosig_5:
s_waitcnt vmcnt(44)
v_dot2_f32_bf16 v64, v140, v60, 0
v_dot2_f32_bf16 v65, v144, v60, 0
v_dot2_f32_bf16 v66, v148, v60, 0
v_dot2_f32_bf16 v67, v152, v60, 0
v_dot2_f32_bf16 v64, v141, v61, v64
v_dot2_f32_bf16 v65, v145, v61, v65
v_dot2_f32_bf16 v66, v149, v61, v66
v_dot2_f32_bf16 v67, v153, v61, v67
v_dot2_f32_bf16 v64, v142, v62, v64
v_dot2_f32_bf16 v65, v146, v62, v65
v_dot2_f32_bf16 v66, v150, v62, v66
v_dot2_f32_bf16 v67, v154, v62, v67
v_dot2_f32_bf16 v64, v143, v63, v64
v_dot2_f32_bf16 v65, v147, v63, v65
v_dot2_f32_bf16 v66, v151, v63, v66
v_dot2_f32_bf16 v67, v155, v63, v67
buffer_load_dwordx4 v[140:143], v2, s[52:55], s12 offen offset:0 nt
buffer_load_dwordx4 v[144:147], v2, s[52:55], s12 offen offset:1024 nt
buffer_load_dwordx4 v[148:151], v2, s[52:55], s12 offen offset:2048 nt
buffer_load_dwordx4 v[152:155], v2, s[52:55], s12 offen offset:3072 nt
v_add_f32_dpp v68, v64, v64 row_ror:8 row_mask:0xf bank_mask:0x3
v_add_f32_dpp v69, v65, v65 row_ror:8 row_mask:0xf bank_mask:0x3
v_add_f32_dpp v68, v66, v66 row_ror:8 row_mask:0xf bank_mask:0xc
v_add_f32_dpp v69, v67, v67 row_ror:8 row_mask:0xf bank_mask:0xc
s_nop 0
v_add_f32_dpp v70, v68, v68 row_half_mirror row_mask:0xf bank_mask:0x5
v_add_f32_dpp v70, v69, v69 row_half_mirror row_mask:0xf bank_mask:0xa
s_nop 1
v_add_f32_dpp v70, v70, v70 quad_perm:[1,0,3,2] row_mask:0xf bank_mask:0xf
s_nop 1
v_add_f32_dpp v70, v70, v70 quad_perm:[2,3,0,1] row_mask:0xf bank_mask:0xf
v_mul_f32 v70, v70, v7
s_nop 1
v_max_f32_dpp v71, v70, v70 row_ror:4 row_mask:0xf bank_mask:0xf
s_nop 1
v_max_f32_dpp v71, v71, v71 row_ror:8 row_mask:0xf bank_mask:0xf
v_mov_b32 v72, v71
s_nop 1
v_permlane16_swap_b32 v71, v72
v_max_f32 v71, v71, v72
v_mov_b32 v72, v71
s_nop 1
v_permlane32_swap_b32 v71, v72
v_max3_f32 v74, v71, v72, v73
v_sub_f32 v70, v70, v74
v_sub_f32 v75, v73, v74
v_exp_f32 v70, v70
v_exp_f32 v75, v75
v_mov_b32 v73, v74
v_cvt_pk_bf16_f32 v77, v70, v70
v_fma_f32 v76, v76, v75, v70
v_mul_f32 v56, v56, v75
v_mul_f32 v57, v57, v75
v_mul_f32 v58, v58, v75
v_mul_f32 v59, v59, v75
v_and_b32_dpp v40, v77, v8 row_newbcast:0 row_mask:0xf bank_mask:0xf
v_and_b32_dpp v41, v77, v9 row_newbcast:0 row_mask:0xf bank_mask:0xf
v_and_b32_dpp v42, v77, v10 row_newbcast:0 row_mask:0xf bank_mask:0xf
v_and_b32_dpp v43, v77, v11 row_newbcast:0 row_mask:0xf bank_mask:0xf
v_and_b32_dpp v44, v77, v8 row_newbcast:4 row_mask:0xf bank_mask:0xf
v_and_b32_dpp v45, v77, v9 row_newbcast:4 row_mask:0xf bank_mask:0xf
v_and_b32_dpp v46, v77, v10 row_newbcast:4 row_mask:0xf bank_mask:0xf
v_and_b32_dpp v47, v77, v11 row_newbcast:4 row_mask:0xf bank_mask:0xf
v_and_b32_dpp v48, v77, v8 row_newbcast:8 row_mask:0xf bank_mask:0xf
v_and_b32_dpp v49, v77, v9 row_newbcast:8 row_mask:0xf bank_mask:0xf
v_and_b32_dpp v50, v77, v10 row_newbcast:8 row_mask:0xf bank_mask:0xf
v_and_b32_dpp v51, v77, v11 row_newbcast:8 row_mask:0xf bank_mask:0xf
v_and_b32_dpp v52, v77, v8 row_newbcast:12 row_mask:0xf bank_mask:0xf
v_and_b32_dpp v53, v77, v9 row_newbcast:12 row_mask:0xf bank_mask:0xf
v_and_b32_dpp v54, v77, v10 row_newbcast:12 row_mask:0xf bank_mask:0xf
v_and_b32_dpp v55, v77, v11 row_newbcast:12 row_mask:0xf bank_mask:0xf
s_waitcnt vmcnt(44)
v_mfma_f32_16x16x32_bf16 v[56:59], v[40:43], a[48:51], v[56:59]
v_mfma_f32_16x16x32_bf16 v[56:59], v[44:47], a[52:55], v[56:59]
v_mfma_f32_16x16x32_bf16 v[56:59], v[48:51], a[56:59], v[56:59]
v_mfma_f32_16x16x32_bf16 v[56:59], v[52:55], a[60:63], v[56:59]
s_sub_u32 s14, s14, 1
s_cmp_eq_u32 s14, 0
s_cbranch_scc1 A_tail
buffer_load_dwordx4 a[48:51], v2, s[56:59], s12 offen offset:0 nt
buffer_load_dwordx4 a[52:55], v2, s[56:59], s12 offen offset:1024 nt
buffer_load_dwordx4 a[56:59], v2, s[56:59], s12 offen offset:2048 nt
buffer_load_dwordx4 a[60:63], v2, s[56:59], s12 offen offset:3072 nt
s_add_u32 s12, s12, s13
s_add_u32 s80, s80, 1
s_sub_u32 s6, s80, 7
s_cmp_ge_u32 s6, 18
s_cbranch_scc1 L_nodma_6
s_mov_b32 m0, s15
s_nop 0
buffer_load_dwordx4 v2, s[60:63], s15 offen nt lds
buffer_load_dwordx4 v2, s[60:63], s15 offen offset:1024 nt lds
s_add_u32 s15, s15, 2048
L_nodma_6:
s_cmp_lg_u32 s14, s82
s_cbranch_scc1 L_nosig_7
v_mov_b32 v5, 1
s_mov_b64 exec, 1
buffer_atomic_add v5, off, s[68:71], 0 offset:192
s_mov_b64 exec, -1
L_nosig_7:
s_waitcnt vmcnt(44)
v_dot2_f32_bf16 v64, v156, v60, 0
v_dot2_f32_bf16 v65, v160, v60, 0
v_dot2_f32_bf16 v66, v164, v60, 0
v_dot2_f32_bf16 v67, v168, v60, 0
v_dot2_f32_bf16 v64, v157, v61, v64
v_dot2_f32_bf16 v65, v161, v61, v65
v_dot2_f32_bf16 v66, v165, v61, v66
v_dot2_f32_bf16 v67, v169, v61, v67
v_dot2_f32_bf16 v64, v158, v62, v64
v_dot2_f32_bf16 v65, v162, v62, v65
v_dot2_f32_bf16 v66, v166, v62, v66
v_dot2_f32_bf16 v67, v170, v62, v67
v_dot2_f32_bf16 v64, v159, v63, v64
v_dot2_f32_bf16 v65, v163, v63, v65
v_dot2_f32_bf16 v66, v167, v63, v66
v_dot2_f32_bf16 v67, v171, v63, v67
buffer_load_dwordx4 v[156:159], v2, s[52:55], s12 offen offset:0 nt
buffer_load_dwordx4 v[160:163], v2, s[52:55], s12 offen offset:1024 nt
buffer_load_dwordx4 v[164:167], v2, s[52:55], s12 offen offset:2048 nt
buffer_load_dwordx4 v[168:171], v2, s[52:55], s12 offen offset:3072 nt
v_add_f32_dpp v68, v64, v64 row_ror:8 row_mask:0xf bank_mask:0x3
v_add_f32_dpp v69, v65, v65 row_ror:8 row_mask:0xf bank_mask:0x3
v_add_f32_dpp v68, v66, v66 row_ror:8 row_mask:0xf bank_mask:0xc
v_add_f32_dpp v69, v67, v67 row_ror:8 row_mask:0xf bank_mask:0xc
s_nop 0
v_add_f32_dpp v70, v68, v68 row_half_mirror row_mask:0xf bank_mask:0x5
v_add_f32_dpp v70, v69, v69 row_half_mirror row_mask:0xf bank_mask:0xa
s_nop 1
v_add_f32_dpp v70, v70, v70 quad_perm:[1,0,3,2] row_mask:0xf bank_mask:0xf
s_nop 1
v_add_f32_dpp v70, v70, v70 quad_perm:[2,3,0,1] row_mask:0xf bank_mask:0xf
v_mul_f32 v70, v70, v7
s_nop 1
v_max_f32_dpp v71, v70, v70 row_ror:4 row_mask:0xf bank_mask:0xf
s_nop 1
v_max_f32_dpp v71, v71, v71 row_ror:8 row_mask:0xf bank_mask:0xf
v_mov_b32 v72, v71
s_nop 1
v_permlane16_swap_b32 v71, v72
v_max_f32 v71, v71, v72
v_mov_b32 v72, v71
s_nop 1
v_permlane32_swap_b32 v71, v72
v_max3_f32 v74, v71, v72, v73
v_sub_f32 v70, v70, v74
v_sub_f32 v75, v73, v74
v_exp_f32 v70, v70
v_exp_f32 v75, v75
v_mov_b32 v73, v74
v_cvt_pk_bf16_f32 v77, v70, v70
v_fma_f32 v76, v76, v75, v70
v_mul_f32 v56, v56, v75
v_mul_f32 v57, v57, v75
v_mul_f32 v58, v58, v75
v_mul_f32 v59, v59, v75
v_and_b32_dpp v40, v77, v8 row_newbcast:0 row_mask:0xf bank_mask:0xf
v_and_b32_dpp v41, v77, v9 row_newbcast:0 row_mask:0xf bank_mask:0xf
v_and_b32_dpp v42, v77, v10 row_newbcast:0 row_mask:0xf bank_mask:0xf
v_and_b32_dpp v43, v77, v11 row_newbcast:0 row_mask:0xf bank_mask:0xf
v_and_b32_dpp v44, v77, v8 row_newbcast:4 row_mask:0xf bank_mask:0xf
v_and_b32_dpp v45, v77, v9 row_newbcast:4 row_mask:0xf bank_mask:0xf
v_and_b32_dpp v46, v77, v10 row_newbcast:4 row_mask:0xf bank_mask:0xf
v_and_b32_dpp v47, v77, v11 row_newbcast:4 row_mask:0xf bank_mask:0xf
v_and_b32_dpp v48, v77, v8 row_newbcast:8 row_mask:0xf bank_mask:0xf
v_and_b32_dpp v49, v77, v9 row_newbcast:8 row_mask:0xf bank_mask:0xf
v_and_b32_dpp v50, v77, v10 row_newbcast:8 row_mask:0xf bank_mask:0xf
v_and_b32_dpp v51, v77, v11 row_newbcast:8 row_mask:0xf bank_mask:0xf
v_and_b32_dpp v52, v77, v8 row_newbcast:12 row_mask:0xf bank_mask:0xf
v_and_b32_dpp v53, v77, v9 row_newbcast:12 row_mask:0xf bank_mask:0xf
v_and_b32_dpp v54, v77, v10 row_newbcast:12 row_mask:0xf bank_mask:0xf
v_and_b32_dpp v55, v77, v11 row_newbcast:12 row_mask:0xf bank_mask:0xf
s_waitcnt vmcnt(44)
v_mfma_f32_16x16x32_bf16 v[56:59], v[40:43], a[64:67], v[56:59]
v_mfma_f32_16x16x32_bf16 v[56:59], v[44:47], a[68:71], v[56:59]
v_mfma_f32_16x16x32_bf16 v[56:59], v[48:51], a[72:75], v[56:59]
v_mfma_f32_16x16x32_bf16 v[56:59], v[52:55], a[76:79], v[56:59]
s_sub_u32 s14, s14, 1
s_cmp_eq_u32 s14, 0
s_cbranch_scc1 A_tail
buffer_load_dwordx4 a[64:67], v2, s[56:59], s12 offen offset:0 nt
buffer_load_dwordx4 a[68:71], v2, s[56:59], s12 offen offset:1024 nt
buffer_load_dwordx4 a[72:75], v2, s[56:59], s12 offen offset:2048 nt
buffer_load_dwordx4 a[76:79], v2, s[56:59], s12 offen offset:3072 nt
s_add_u32 s12, s12, s13
s_add_u32 s80, s80, 1
s_sub_u32 s6, s80, 7
s_cmp_ge_u32 s6, 18
s_cbranch_scc1 L_nodma_8
s_mov_b32 m0, s15
s_nop 0
buffer_load_dwordx4 v2, s[60:63], s15 offen nt lds
buffer_load_dwordx4 v2, s[60:63], s15 offen offset:1024 nt lds
s_add_u32 s15, s15, 2048
L_nodma_8:
s_cmp_lg_u32 s14, s82
s_cbranch_scc1 L_nosig_9
v_mov_b32 v5, 1
s_mov_b64 exec, 1
buffer_atomic_add v5, off, s[68:71], 0 offset:192
s_mov_b64 exec, -1
L_nosig_9:
s_waitcnt vmcnt(44)
v_dot2_f32_bf16 v64, v172, v60, 0
v_dot2_f32_bf16 v65, v176, v60, 0
v_dot2_f32_bf16 v66, v180, v60, 0
v_dot2_f32_bf16 v67, v184, v60, 0
v_dot2_f32_bf16 v64, v173, v61, v64
v_dot2_f32_bf16 v65, v177, v61, v65
v_dot2_f32_bf16 v66, v181, v61, v66
v_dot2_f32_bf16 v67, v185, v61, v67
v_dot2_f32_bf16 v64, v174, v62, v64
v_dot2_f32_bf16 v65, v178, v62, v65
v_dot2_f32_bf16 v66, v182, v62, v66
v_dot2_f32_bf16 v67, v186, v62, v67
v_dot2_f32_bf16 v64, v175, v63, v64
v_dot2_f32_bf16 v65, v179, v63, v65
v_dot2_f32_bf16 v66, v183, v63, v66
v_dot2_f32_bf16 v67, v187, v63, v67
buffer_load_dwordx4 v[172:175], v2, s[52:55], s12 offen offset:0 nt
buffer_load_dwordx4 v[176:179], v2, s[52:55], s12 offen offset:1024 nt
buffer_load_dwordx4 v[180:183], v2, s[52:55], s12 offen offset:2048 nt
buffer_load_dwordx4 v[184:187], v2, s[52:55], s12 offen offset:3072 nt
v_add_f32_dpp v68, v64, v64 row_ror:8 row_mask:0xf bank_mask:0x3
v_add_f32_dpp v69, v65, v65 row_ror:8 row_mask:0xf bank_mask:0x3
v_add_f32_dpp v68, v66, v66 row_ror:8 row_mask:0xf bank_mask:0xc
v_add_f32_dpp v69, v67, v67 row_ror:8 row_mask:0xf bank_mask:0xc
s_nop 0
v_add_f32_dpp v70, v68, v68 row_half_mirror row_mask:0xf bank_mask:0x5
v_add_f32_dpp v70, v69, v69 row_half_mirror row_mask:0xf bank_mask:0xa
s_nop 1
v_add_f32_dpp v70, v70, v70 quad_perm:[1,0,3,2] row_mask:0xf bank_mask:0xf
s_nop 1
v_add_f32_dpp v70, v70, v70 quad_perm:[2,3,0,1] row_mask:0xf bank_mask:0xf
v_mul_f32 v70, v70, v7
s_nop 1
v_max_f32_dpp v71, v70, v70 row_ror:4 row_mask:0xf bank_mask:0xf
s_nop 1
v_max_f32_dpp v71, v71, v71 row_ror:8 row_mask:0xf bank_mask:0xf
v_mov_b32 v72, v71
s_nop 1
v_permlane16_swap_b32 v71, v72
v_max_f32 v71, v71, v72
v_mov_b32 v72, v71
s_nop 1
v_permlane32_swap_b32 v71, v72
v_max3_f32 v74, v71, v72, v73
v_sub_f32 v70, v70, v74
v_sub_f32 v75, v73, v74
v_exp_f32 v70, v70
v_exp_f32 v75, v75
v_mov_b32 v73, v74
v_cvt_pk_bf16_f32 v77, v70, v70
v_fma_f32 v76, v76, v75, v70
v_mul_f32 v56, v56, v75
v_mul_f32 v57, v57, v75
v_mul_f32 v58, v58, v75
v_mul_f32 v59, v59, v75
v_and_b32_dpp v40, v77, v8 row_newbcast:0 row_mask:0xf bank_mask:0xf
v_and_b32_dpp v41, v77, v9 row_newbcast:0 row_mask:0xf bank_mask:0xf
v_and_b32_dpp v42, v77, v10 row_newbcast:0 row_mask:0xf bank_mask:0xf
v_and_b32_dpp v43, v77, v11 row_newbcast:0 row_mask:0xf bank_mask:0xf
v_and_b32_dpp v44, v77, v8 row_newbcast:4 row_mask:0xf bank_mask:0xf
v_and_b32_dpp v45, v77, v9 row_newbcast:4 row_mask:0xf bank_mask:0xf
v_and_b32_dpp v46, v77, v10 row_newbcast:4 row_mask:0xf bank_mask:0xf
v_and_b32_dpp v47, v77, v11 row_newbcast:4 row_mask:0xf bank_mask:0xf
v_and_b32_dpp v48, v77, v8 row_newbcast:8 row_mask:0xf bank_mask:0xf
v_and_b32_dpp v49, v77, v9 row_newbcast:8 row_mask:0xf bank_mask:0xf
v_and_b32_dpp v50, v77, v10 row_newbcast:8 row_mask:0xf bank_mask:0xf
v_and_b32_dpp v51, v77, v11 row_newbcast:8 row_mask:0xf bank_mask:0xf
v_and_b32_dpp v52, v77, v8 row_newbcast:12 row_mask:0xf bank_mask:0xf
v_and_b32_dpp v53, v77, v9 row_newbcast:12 row_mask:0xf bank_mask:0xf
v_and_b32_dpp v54, v77, v10 row_newbcast:12 row_mask:0xf bank_mask:0xf
v_and_b32_dpp v55, v77, v11 row_newbcast:12 row_mask:0xf bank_mask:0xf
s_waitcnt vmcnt(44)
v_mfma_f32_16x16x32_bf16 v[56:59], v[40:43], a[80:83], v[56:59]
v_mfma_f32_16x16x32_bf16 v[56:59], v[44:47], a[84:87], v[56:59]
v_mfma_f32_16x16x32_bf16 v[56:59], v[48:51], a[88:91], v[56:59]
v_mfma_f32_16x16x32_bf16 v[56:59], v[52:55], a[92:95], v[56:59]
s_sub_u32 s14, s14, 1
s_cmp_eq_u32 s14, 0
s_cbranch_scc1 A_tail
buffer_load_dwordx4 a[80:83], v2, s[56:59], s12 offen offset:0 nt
buffer_load_dwordx4 a[84:87], v2, s[56:59], s12 offen offset:1024 nt
buffer_load_dwordx4 a[88:91], v2, s[56:59], s12 offen offset:2048 nt
buffer_load_dwordx4 a[92:95], v2, s[56:59], s12 offen offset:3072 nt
s_add_u32 s12, s12, s13
s_add_u32 s80, s80, 1
s_sub_u32 s6, s80, 7
s_cmp_ge_u32 s6, 18
s_cbranch_scc1 L_nodma_10
s_mov_b32 m0, s15
s_nop 0
buffer_load_dwordx4 v2, s[60:63], s15 offen nt lds
buffer_load_dwordx4 v2, s[60:63], s15 offen offset:1024 nt lds
s_add_u32 s15, s15, 2048
L_nodma_10:
s_cmp_lg_u32 s14, s82
s_cbranch_scc1 L_nosig_11
v_mov_b32 v5, 1
s_mov_b64 exec, 1
buffer_atomic_add v5, off, s[68:71], 0 offset:192
s_mov_b64 exec, -1
L_nosig_11:
s_branch A_loop
A_wo_event:
s_barrier
ds_read_b64_tr_b16 a[96:97], v78 offset:0
ds_read_b64_tr_b16 a[98:99], v78 offset:4608
ds_read_b64_tr_b16 a[100:101], v78 offset:36864
ds_read_b64_tr_b16 a[102:103], v78 offset:41472
ds_read_b64_tr_b16 a[104:105], v80 offset:0
ds_read_b64_tr_b16 a[106:107], v80 offset:4608
ds_read_b64_tr_b16 a[108:109], v80 offset:36864
ds_read_b64_tr_b16 a[110:111], v80 offset:41472
ds_read_b64_tr_b16 a[112:113], v78 offset:8
ds_read_b64_tr_b16 a[114:115], v78 offset:4616
ds_read_b64_tr_b16 a[116:117], v78 offset:36872
ds_read_b64_tr_b16 a[118:119], v78 offset:41480
ds_read_b64_tr_b16 a[120:121], v80 offset:8
ds_read_b64_tr_b16 a[122:123], v80 offset:4616
ds_read_b64_tr_b16 a[124:125], v80 offset:36872
ds_read_b64_tr_b16 a[126:127], v80 offset:41480
ds_read_b64_tr_b16 a[128:129], v78 offset:16
ds_read_b64_tr_b16 a[130:131], v78 offset:4624
ds_read_b64_tr_b16 a[132:133], v78 offset:36880
ds_read_b64_tr_b16 a[134:135], v78 offset:41488
ds_read_b64_tr_b16 a[136:137], v80 offset:16
ds_read_b64_tr_b16 a[138:139], v80 offset:4624
ds_read_b64_tr_b16 a[140:141], v80 offset:36880
ds_read_b64_tr_b16 a[142:143], v80 offset:41488
ds_read_b64_tr_b16 a[144:145], v78 offset:24
ds_read_b64_tr_b16 a[146:147], v78 offset:4632
ds_read_b64_tr_b16 a[148:149], v78 offset:36888
ds_read_b64_tr_b16 a[150:151], v78 offset:41496
ds_read_b64_tr_b16 a[152:153], v80 offset:24
ds_read_b64_tr_b16 a[154:155], v80 offset:4632
ds_read_b64_tr_b16 a[156:157], v80 offset:36888
ds_read_b64_tr_b16 a[158:159], v80 offset:41496
ds_read_b64_tr_b16 a[160:161], v78 offset:128
ds_read_b64_tr_b16 a[162:163], v78 offset:4736
ds_read_b64_tr_b16 a[164:165], v78 offset:36992
ds_read_b64_tr_b16 a[166:167], v78 offset:41600
ds_read_b64_tr_b16 a[168:169], v80 offset:128
ds_read_b64_tr_b16 a[170:171], v80 offset:4736
ds_read_b64_tr_b16 a[172:173], v80 offset:36992
ds_read_b64_tr_b16 a[174:175], v80 offset:41600
ds_read_b64_tr_b16 a[176:177], v78 offset:136
ds_read_b64_tr_b16 a[178:179], v78 offset:4744
ds_read_b64_tr_b16 a[180:181], v78 offset:37000
ds_read_b64_tr_b16 a[182:183], v78 offset:41608
ds_read_b64_tr_b16 a[184:185], v80 offset:136
ds_read_b64_tr_b16 a[186:187], v80 offset:4744
ds_read_b64_tr_b16 a[188:189], v80 offset:37000
ds_read_b64_tr_b16 a[190:191], v80 offset:41608
ds_read_b64_tr_b16 a[192:193], v78 offset:144
ds_read_b64_tr_b16 a[194:195], v78 offset:4752
ds_read_b64_tr_b16 a[196:197], v78 offset:37008
ds_read_b64_tr_b16 a[198:199], v78 offset:41616
ds_read_b64_tr_b16 a[200:201], v80 offset:144
ds_read_b64_tr_b16 a[202:203], v80 offset:4752
ds_read_b64_tr_b16 a[204:205], v80 offset:37008
ds_read_b64_tr_b16 a[206:207], v80 offset:41616
ds_read_b64_tr_b16 a[208:209], v78 offset:152
ds_read_b64_tr_b16 a[210:211], v78 offset:4760
ds_read_b64_tr_b16 a[212:213], v78 offset:37016
ds_read_b64_tr_b16 a[214:215], v78 offset:41624
ds_read_b64_tr_b16 a[216:217], v80 offset:152
ds_read_b64_tr_b16 a[218:219], v80 offset:4760
ds_read_b64_tr_b16 a[220:221], v80 offset:37016
ds_read_b64_tr_b16 a[222:223], v80 offset:41624
ds_read_b64_tr_b16 a[224:225], v79 offset:0
ds_read_b64_tr_b16 a[226:227], v79 offset:4608
ds_read_b64_tr_b16 a[228:229], v79 offset:36864
ds_read_b64_tr_b16 a[230:231], v79 offset:41472
ds_read_b64_tr_b16 a[232:233], v81 offset:0
ds_read_b64_tr_b16 a[234:235], v81 offset:4608
ds_read_b64_tr_b16 a[236:237], v81 offset:36864
ds_read_b64_tr_b16 a[238:239], v81 offset:41472
s_branch A_loop_in
A_tail:
v_add_f32_dpp v71, v76, v76 row_ror:4 row_mask:0xf bank_mask:0xf
s_nop 1
v_add_f32_dpp v71, v71, v71 row_ror:8 row_mask:0xf bank_mask:0xf
v_mov_b32 v72, v71
s_nop 1
v_permlane16_swap_b32 v71, v72
v_add_f32 v71, v71, v72
v_mov_b32 v72, v71
s_nop 1
v_permlane32_swap_b32 v71, v72
v_add_f32 v71, v71, v72
v_mov_b32 v68, v73
v_mov_b32 v69, v71
v_cvt_pk_bf16_f32 v64, v56, v57
v_cvt_pk_bf16_f32 v65, v58, v59
s_lshl_b32 s6, s3, 3
s_add_u32 s6, s6, 152576
v_mov_b32 v5, s6
ds_write_b64 v90, v[64:65]
ds_write_b64 v5, v[68:69]
v_mov_b32 v5, 152576
s_waitcnt lgkmcnt(0)
s_barrier
ds_read_b128 v[40:43], v91 offset:0
ds_read_b128 v[44:47], v91 offset:64
ds_read_b128 v[48:51], v91 offset:128
ds_read_b128 v[52:55], v91 offset:192
ds_read_b128 v[20:23], v5
ds_read_b128 v[24:27], v5 offset:16
s_waitcnt lgkmcnt(2)
v_mfma_f32_16x16x32_bf16 v[188:191], v[40:43], a[96:99], 0
v_mfma_f32_16x16x32_bf16 v[188:191], v[44:47], a[100:103], v[188:191]
v_mfma_f32_16x16x32_bf16 v[188:191], v[48:51], a[104:107], v[188:191]
v_mfma_f32_16x16x32_bf16 v[188:191], v[52:55], a[108:111], v[188:191]
s_waitcnt lgkmcnt(0)
v_add_f32 v64, v20, v86
v_add_f32 v65, v22, v87
v_add_f32 v66, v24, v88
v_add_f32 v67, v26, v89
v_mfma_f32_16x16x32_bf16 v[192:195], v[40:43], a[112:115], 0
v_mfma_f32_16x16x32_bf16 v[192:195], v[44:47], a[116:119], v[192:195]
v_mfma_f32_16x16x32_bf16 v[192:195], v[48:51], a[120:123], v[192:195]
v_mfma_f32_16x16x32_bf16 v[192:195], v[52:55], a[124:127], v[192:195]
v_max_f32 v68, v64, v65
v_max3_f32 v68, v68, v66, v67
v_sub_f32 v64, v64, v68
v_sub_f32 v65, v65, v68
v_sub_f32 v66, v66, v68
v_sub_f32 v67, v67, v68
v_mfma_f32_16x16x32_bf16 v[196:199], v[40:43], a[128:131], 0
v_mfma_f32_16x16x32_bf16 v[196:199], v[44:47], a[132:135], v[196:199]
v_mfma_f32_16x16x32_bf16 v[196:199], v[48:51], a[136:139], v[196:199]
v_mfma_f32_16x16x32_bf16 v[196:199], v[52:55], a[140:143], v[196:199]
v_exp_f32 v64, v64
v_exp_f32 v65, v65
v_exp_f32 v66, v66
v_exp_f32 v67, v67
v_mfma_f32_16x16x32_bf16 v[200:203], v[40:43], a[144:147], 0
v_mfma_f32_16x16x32_bf16 v[200:203], v[44:47], a[148:151], v[200:203]
v_mfma_f32_16x16x32_bf16 v[200:203], v[48:51], a[152:155], v[200:203]
v_mfma_f32_16x16x32_bf16 v[200:203], v[52:55], a[156:159], v[200:203]
v_cmp_gt_u32 vcc, 32, v1
v_mul_f32 v69, v64, v21
v_fma_f32 v69, v65, v23, v69
v_fma_f32 v69, v66, v25, v69
v_fma_f32 v69, v67, v27, v69
v_cndmask_b32 v12, 0, v64, vcc
v_cndmask_b32 v13, 0, v65, vcc
v_cndmask_b32 v14, 0, v66, vcc
v_cndmask_b32 v15, 0, v67, vcc
v_mfma_f32_16x16x32_bf16 v[204:207], v[40:43], a[160:163], 0
v_mfma_f32_16x16x32_bf16 v[204:207], v[44:47], a[164:167], v[204:207]
v_mfma_f32_16x16x32_bf16 v[204:207], v[48:51], a[168:171], v[204:207]
v_mfma_f32_16x16x32_bf16 v[204:207], v[52:55], a[172:175], v[204:207]
v_cndmask_b32 v16, v64, 0, vcc
v_cndmask_b32 v17, v65, 0, vcc
v_cndmask_b32 v18, v66, 0, vcc
v_cndmask_b32 v19, v67, 0, vcc
v_min_u32 v68, -2, v68
v_min_u32 v69, -2, v69
v_mfma_f32_16x16x32_bf16 v[208:211], v[40:43], a[176:179], 0
v_mfma_f32_16x16x32_bf16 v[208:211], v[44:47], a[180:183], v[208:211]
v_mfma_f32_16x16x32_bf16 v[208:211], v[48:51], a[184:187], v[208:211]
v_mfma_f32_16x16x32_bf16 v[208:211], v[52:55], a[188:191], v[208:211]
v_mul_f32 v28, v12, v188
v_fma_f32 v28, v13, v189, v28
v_fma_f32 v28, v14, v190, v28
v_fma_f32 v28, v15, v191, v28
v_mul_f32 v29, v12, v192
v_fma_f32 v29, v13, v193, v29
v_fma_f32 v29, v14, v194, v29
v_fma_f32 v29, v15, v195, v29
v_mfma_f32_16x16x32_bf16 v[212:215], v[40:43], a[192:195], 0
v_mfma_f32_16x16x32_bf16 v[212:215], v[44:47], a[196:199], v[212:215]
v_mfma_f32_16x16x32_bf16 v[212:215], v[48:51], a[200:203], v[212:215]
v_mfma_f32_16x16x32_bf16 v[212:215], v[52:55], a[204:207], v[212:215]
v_mul_f32 v30, v12, v196
v_fma_f32 v30, v13, v197, v30
v_fma_f32 v30, v14, v198, v30
v_fma_f32 v30, v15, v199, v30
v_mul_f32 v31, v12, v200
v_fma_f32 v31, v13, v201, v31
v_fma_f32 v31, v14, v202, v31
v_fma_f32 v31, v15, v203, v31
v_mfma_f32_16x16x32_bf16 v[216:219], v[40:43], a[208:211], 0
v_mfma_f32_16x16x32_bf16 v[216:219], v[44:47], a[212:215], v[216:219]
v_mfma_f32_16x16x32_bf16 v[216:219], v[48:51], a[216:219], v[216:219]
v_mfma_f32_16x16x32_bf16 v[216:219], v[52:55], a[220:223], v[216:219]
v_fma_f32 v28, v16, v204, v28
v_fma_f32 v28, v17, v205, v28
v_fma_f32 v28, v18, v206, v28
v_fma_f32 v28, v19, v207, v28
v_fma_f32 v29, v16, v208, v29
v_fma_f32 v29, v17, v209, v29
v_fma_f32 v29, v18, v210, v29
v_fma_f32 v29, v19, v211, v29
v_mfma_f32_16x16x32_bf16 v[220:223], v[40:43], a[224:227], 0
v_mfma_f32_16x16x32_bf16 v[220:223], v[44:47], a[228:231], v[220:223]
v_mfma_f32_16x16x32_bf16 v[220:223], v[48:51], a[232:235], v[220:223]
v_mfma_f32_16x16x32_bf16 v[220:223], v[52:55], a[236:239], v[220:223]
v_fma_f32 v30, v16, v212, v30
v_fma_f32 v30, v17, v213, v30
v_fma_f32 v30, v18, v214, v30
v_fma_f32 v30, v19, v215, v30
s_cmp_lg_u32 s3, 0
s_cbranch_scc1 L_nost_12
s_mov_b64 exec, 0x10001
buffer_store_dwordx2 v[68:69], v84, s[64:67], 0 offen sc1
s_mov_b64 exec, -1
L_nost_12:
s_nop 3
v_fma_f32 v31, v16, v216, v31
v_fma_f32 v31, v17, v217, v31
v_fma_f32 v31, v18, v218, v31
v_fma_f32 v31, v19, v219, v31
v_min_u32 v28, -2, v28
v_min_u32 v29, -2, v29
v_min_u32 v30, -2, v30
v_min_u32 v31, -2, v31
buffer_store_dwordx4 v[28:31], v82, s[64:67], 0 offen sc1
v_mul_f32 v32, v64, v220
v_fma_f32 v32, v65, v221, v32
v_fma_f32 v32, v66, v222, v32
v_fma_f32 v32, v67, v223, v32
v_min_u32 v32, -2, v32
s_mov_b64 exec, 0xffffffff
buffer_store_dword v32, v83, s[64:67], 0 offen offset:512 sc1
s_mov_b64 exec, -1
s_endpgm
L_exit:
s_endpgm
B_role:
s_mov_b32 s8, s5
s_lshl_b32 s9, s4, 1
s_add_u32 s9, s9, s8
s_lshr_b32 s10, s9, 4
s_and_b32 s11, s9, 15
v_and_b32 v1, 63, v0
v_lshlrev_b32 v2, 4, v1
v_lshrrev_b32 v9, 4, v1
v_and_b32 v8, 15, v1
s_waitcnt lgkmcnt(0)
s_mul_i32 s6, s3, 288
s_sub_u32 s7, 4608, s6
s_add_u32 s44, s26, s6
s_addc_u32 s45, s27, 0
s_mov_b32 s46, s7
s_mov_b32 s47, 0x20000
s_mul_i32 s6, s3, 1179648
s_lshl_b32 s7, s4, 8
s_add_u32 s6, s6, s7
s_sub_u32 s7, 4718592, s6
s_add_u32 s48, s30, s6
s_addc_u32 s49, s31, 0
s_mov_b32 s50, s7
s_mov_b32 s51, 0x20000
s_lshl_b32 s6, s8, 2
s_add_u32 s6, s6, s3
s_lshl_b32 s6, s6, 19
s_lshl_b32 s7, s4, 8
s_add_u32 s6, s6, s7
s_sub_u32 s7, 4194304, s6
s_add_u32 s76, s32, s6
s_addc_u32 s77, s33, 0
s_mov_b32 s78, s7
s_mov_b32 s79, 0x20000
s_lshl_b32 s6, s9, 18
s_add_u32 s52, s28, s6
s_addc_u32 s53, s29, 0
s_mov_b32 s54, 262144
s_mov_b32 s55, 0x20000
v_mul_u32_u24 v3, 294912, v9
v_lshl_add_u32 v3, v8, 4, v3
v_mul_u32_u24 v4, 72, v9
v_lshrrev_b32 v6, 3, v8
v_mul_u32_u24 v6, 1152, v6
v_add_u32 v4, v4, v6
v_lshlrev_b32 v220, 17, v9
v_lshl_add_u32 v220, v8, 4, v220
buffer_load_dwordx4 v[22:25], v4, s[44:47], 0 offen offset:0
buffer_load_dwordx4 v[26:29], v4, s[44:47], 0 offen offset:16
buffer_load_dwordx4 v[30:33], v4, s[44:47], 0 offen offset:32
buffer_load_dwordx4 v[34:37], v4, s[44:47], 0 offen offset:48
buffer_load_dwordx2 v[38:39], v4, s[44:47], 0 offen offset:64
buffer_load_dwordx4 v[40:43], v4, s[44:47], 0 offen offset:2304
buffer_load_dwordx4 v[44:47], v4, s[44:47], 0 offen offset:2320
buffer_load_dwordx4 v[48:51], v4, s[44:47], 0 offen offset:2336
buffer_load_dwordx4 v[52:55], v4, s[44:47], 0 offen offset:2352
buffer_load_dwordx2 v[56:57], v4, s[44:47], 0 offen offset:2368
s_mov_b32 s6, 0
buffer_load_dwordx4 a[96:99], v3, s[48:51], s6 offen nt
s_mov_b32 s6, 8192
buffer_load_dwordx4 a[100:103], v3, s[48:51], s6 offen nt
s_mov_b32 s6, 16384
buffer_load_dwordx4 a[104:107], v3, s[48:51], s6 offen nt
s_mov_b32 s6, 24576
buffer_load_dwordx4 a[108:111], v3, s[48:51], s6 offen nt
s_mov_b32 s6, 32768
buffer_load_dwordx4 a[112:115], v3, s[48:51], s6 offen nt
s_mov_b32 s6, 40960
buffer_load_dwordx4 a[116:119], v3, s[48:51], s6 offen nt
s_mov_b32 s6, 49152
buffer_load_dwordx4 a[120:123], v3, s[48:51], s6 offen nt
s_mov_b32 s6, 57344
buffer_load_dwordx4 a[124:127], v3, s[48:51], s6 offen nt
s_mov_b32 s6, 65536
buffer_load_dwordx4 a[128:131], v3, s[48:51], s6 offen nt
s_mov_b32 s6, 73728
buffer_load_dwordx4 a[132:135], v3, s[48:51], s6 offen nt
s_mov_b32 s6, 81920
buffer_load_dwordx4 a[136:139], v3, s[48:51], s6 offen nt
s_mov_b32 s6, 90112
buffer_load_dwordx4 a[140:143], v3, s[48:51], s6 offen nt
s_mov_b32 s6, 98304
buffer_load_dwordx4 a[144:147], v3, s[48:51], s6 offen nt
s_mov_b32 s6, 106496
buffer_load_dwordx4 a[148:151], v3, s[48:51], s6 offen nt
s_mov_b32 s6, 114688
buffer_load_dwordx4 a[152:155], v3, s[48:51], s6 offen nt
s_mov_b32 s6, 122880
buffer_load_dwordx4 a[156:159], v3, s[48:51], s6 offen nt
s_mov_b32 s6, 131072
buffer_load_dwordx4 a[160:163], v3, s[48:51], s6 offen nt
s_mov_b32 s6, 139264
buffer_load_dwordx4 a[164:167], v3, s[48:51], s6 offen nt
s_mov_b32 s6, 147456
buffer_load_dwordx4 a[168:171], v3, s[48:51], s6 offen nt
s_mov_b32 s6, 155648
buffer_load_dwordx4 a[172:175], v3, s[48:51], s6 offen nt
s_mov_b32 s6, 163840
buffer_load_dwordx4 a[176:179], v3, s[48:51], s6 offen nt
s_mov_b32 s6, 172032
buffer_load_dwordx4 a[180:183], v3, s[48:51], s6 offen nt
s_mov_b32 s6, 180224
buffer_load_dwordx4 a[184:187], v3, s[48:51], s6 offen nt
s_mov_b32 s6, 188416
buffer_load_dwordx4 a[188:191], v3, s[48:51], s6 offen nt
s_mov_b32 s6, 196608
buffer_load_dwordx4 a[192:195], v3, s[48:51], s6 offen nt
s_mov_b32 s6, 204800
buffer_load_dwordx4 a[196:199], v3, s[48:51], s6 offen nt
s_mov_b32 s6, 212992
buffer_load_dwordx4 a[200:203], v3, s[48:51], s6 offen nt
s_mov_b32 s6, 221184
buffer_load_dwordx4 a[204:207], v3, s[48:51], s6 offen nt
s_mov_b32 s6, 229376
buffer_load_dwordx4 a[208:211], v3, s[48:51], s6 offen nt
s_mov_b32 s6, 237568
buffer_load_dwordx4 a[212:215], v3, s[48:51], s6 offen nt
s_mov_b32 s6, 245760
buffer_load_dwordx4 a[216:219], v3, s[48:51], s6 offen nt
s_mov_b32 s6, 253952
buffer_load_dwordx4 a[220:223], v3, s[48:51], s6 offen nt
s_mov_b32 s6, 262144
buffer_load_dwordx4 a[224:227], v3, s[48:51], s6 offen nt
s_mov_b32 s6, 270336
buffer_load_dwordx4 a[228:231], v3, s[48:51], s6 offen nt
s_mov_b32 s6, 278528
buffer_load_dwordx4 a[232:235], v3, s[48:51], s6 offen nt
s_mov_b32 s6, 286720
buffer_load_dwordx4 a[236:239], v3, s[48:51], s6 offen nt
s_mov_b32 s6, 0
buffer_load_dwordx4 v[84:87], v220, s[76:79], s6 offen nt
s_mov_b32 s6, 8192
buffer_load_dwordx4 v[88:91], v220, s[76:79], s6 offen nt
s_mov_b32 s6, 16384
buffer_load_dwordx4 v[92:95], v220, s[76:79], s6 offen nt
s_mov_b32 s6, 24576
buffer_load_dwordx4 v[96:99], v220, s[76:79], s6 offen nt
s_mov_b32 s6, 32768
buffer_load_dwordx4 v[100:103], v220, s[76:79], s6 offen nt
s_mov_b32 s6, 40960
buffer_load_dwordx4 v[104:107], v220, s[76:79], s6 offen nt
s_mov_b32 s6, 49152
buffer_load_dwordx4 v[108:111], v220, s[76:79], s6 offen nt
s_mov_b32 s6, 57344
buffer_load_dwordx4 v[112:115], v220, s[76:79], s6 offen nt
s_mov_b32 s6, 65536
buffer_load_dwordx4 v[116:119], v220, s[76:79], s6 offen nt
s_mov_b32 s6, 73728
buffer_load_dwordx4 v[120:123], v220, s[76:79], s6 offen nt
s_mov_b32 s6, 81920
buffer_load_dwordx4 v[124:127], v220, s[76:79], s6 offen nt
s_mov_b32 s6, 90112
buffer_load_dwordx4 v[128:131], v220, s[76:79], s6 offen nt
s_mov_b32 s6, 98304
buffer_load_dwordx4 v[132:135], v220, s[76:79], s6 offen nt
s_mov_b32 s6, 106496
buffer_load_dwordx4 v[136:139], v220, s[76:79], s6 offen nt
s_mov_b32 s6, 114688
buffer_load_dwordx4 v[140:143], v220, s[76:79], s6 offen nt
s_mov_b32 s6, 122880
buffer_load_dwordx4 v[144:147], v220, s[76:79], s6 offen nt
s_mov_b32 s64, s42
s_mov_b32 s65, s43
s_mov_b32 s66, 6291456
s_mov_b32 s67, 0x20000
s_mov_b32 s68, s40
s_mov_b32 s69, s41
s_mov_b32 s70, 256
s_mov_b32 s71, 0x20000
s_mov_b32 s72, s38
s_mov_b32 s73, s39
s_mov_b32 s74, 9216
s_mov_b32 s75, 0x20000
v_and_b32 v5, 1, v1
v_lshlrev_b32 v5, 4, v5
v_mov_b32 v6, 0xffff
v_lshlrev_b32 v5, v5, v6
v_bfe_u32 v6, v1, 1, 2
v_cmp_eq_u32 vcc, 0, v6
s_nop 1
v_cndmask_b32 v10, 0, v5, vcc
v_cmp_eq_u32 vcc, 1, v6
s_nop 1
v_cndmask_b32 v11, 0, v5, vcc
v_cmp_eq_u32 vcc, 2, v6
s_nop 1
v_cndmask_b32 v12, 0, v5, vcc
v_cmp_eq_u32 vcc, 3, v6
s_nop 1
v_cndmask_b32 v13, 0, v5, vcc
v_mov_b32 v5, 0x0c0c0c0c
s_mov_b32 s6, 0x01000100
s_mov_b32 s7, 0x03020302
v_bfi_b32 v14, v10, s6, v5
v_bfi_b32 v15, v11, s6, v5
v_bfi_b32 v16, v12, s6, v5
v_bfi_b32 v17, v13, s6, v5
v_bfi_b32 v18, v10, s7, v5
v_bfi_b32 v19, v11, s7, v5
v_bfi_b32 v20, v12, s7, v5
v_bfi_b32 v21, v13, s7, v5
s_mul_i32 s12, s3, 17408
s_lshl_b32 s13, s3, 14
s_waitcnt vmcnt(51)
v_perm_b32 v60, v22, v22, v14
v_perm_b32 v61, v22, v22, v15
v_perm_b32 v62, v22, v22, v16
v_perm_b32 v63, v22, v22, v17
s_nop 1
v_mfma_f32_16x16x32_bf16 v[76:79], v[60:63], a[96:99], 0
v_perm_b32 v64, v40, v40, v14
v_perm_b32 v65, v40, v40, v15
v_perm_b32 v66, v40, v40, v16
v_perm_b32 v67, v40, v40, v17
s_nop 1
v_mfma_f32_16x16x32_bf16 v[80:83], v[64:67], a[96:99], 0
s_add_u32 m0, s12, 0
s_add_u32 s6, s13, 0
buffer_load_dwordx4 v2, s[52:55], s6 offen nt lds
s_waitcnt vmcnt(51)
v_perm_b32 v68, v22, v22, v18
v_perm_b32 v69, v22, v22, v19
v_perm_b32 v70, v22, v22, v20
v_perm_b32 v71, v22, v22, v21
s_nop 1
v_mfma_f32_16x16x32_bf16 v[76:79], v[68:71], a[100:103], v[76:79]
v_perm_b32 v72, v40, v40, v18
v_perm_b32 v73, v40, v40, v19
v_perm_b32 v74, v40, v40, v20
v_perm_b32 v75, v40, v40, v21
s_nop 1
v_mfma_f32_16x16x32_bf16 v[80:83], v[72:75], a[100:103], v[80:83]
s_add_u32 m0, s12, 1088
s_add_u32 s6, s13, 1024
buffer_load_dwordx4 v2, s[52:55], s6 offen nt lds
s_waitcnt vmcnt(51)
v_perm_b32 v60, v23, v23, v14
v_perm_b32 v61, v23, v23, v15
v_perm_b32 v62, v23, v23, v16
v_perm_b32 v63, v23, v23, v17
s_nop 1
v_mfma_f32_16x16x32_bf16 v[76:79], v[60:63], a[104:107], v[76:79]
v_perm_b32 v64, v41, v41, v14
v_perm_b32 v65, v41, v41, v15
v_perm_b32 v66, v41, v41, v16
v_perm_b32 v67, v41, v41, v17
s_nop 1
v_mfma_f32_16x16x32_bf16 v[80:83], v[64:67], a[104:107], v[80:83]
s_add_u32 m0, s12, 2176
s_add_u32 s6, s13, 2048
buffer_load_dwordx4 v2, s[52:55], s6 offen nt lds
s_waitcnt vmcnt(51)
v_perm_b32 v68, v23, v23, v18
v_perm_b32 v69, v23, v23, v19
v_perm_b32 v70, v23, v23, v20
v_perm_b32 v71, v23, v23, v21
s_nop 1
v_mfma_f32_16x16x32_bf16 v[76:79], v[68:71], a[108:111], v[76:79]
v_perm_b32 v72, v41, v41, v18
v_perm_b32 v73, v41, v41, v19
v_perm_b32 v74, v41, v41, v20
v_perm_b32 v75, v41, v41, v21
s_nop 1
v_mfma_f32_16x16x32_bf16 v[80:83], v[72:75], a[108:111], v[80:83]
s_add_u32 m0, s12, 3264
s_add_u32 s6, s13, 3072
buffer_load_dwordx4 v2, s[52:55], s6 offen nt lds
s_waitcnt vmcnt(51)
v_perm_b32 v60, v24, v24, v14
v_perm_b32 v61, v24, v24, v15
v_perm_b32 v62, v24, v24, v16
v_perm_b32 v63, v24, v24, v17
s_nop 1
v_mfma_f32_16x16x32_bf16 v[76:79], v[60:63], a[112:115], v[76:79]
v_perm_b32 v64, v42, v42, v14
v_perm_b32 v65, v42, v42, v15
v_perm_b32 v66, v42, v42, v16
v_perm_b32 v67, v42, v42, v17
s_nop 1
v_mfma_f32_16x16x32_bf16 v[80:83], v[64:67], a[112:115], v[80:83]
s_add_u32 m0, s12, 4352
s_add_u32 s6, s13, 4096
buffer_load_dwordx4 v2, s[52:55], s6 offen nt lds
s_waitcnt vmcnt(51)
v_perm_b32 v68, v24, v24, v18
v_perm_b32 v69, v24, v24, v19
v_perm_b32 v70, v24, v24, v20
v_perm_b32 v71, v24, v24, v21
s_nop 1
v_mfma_f32_16x16x32_bf16 v[76:79], v[68:71], a[116:119], v[76:79]
v_perm_b32 v72, v42, v42, v18
v_perm_b32 v73, v42, v42, v19
v_perm_b32 v74, v42, v42, v20
v_perm_b32 v75, v42, v42, v21
s_nop 1
v_mfma_f32_16x16x32_bf16 v[80:83], v[72:75], a[116:119], v[80:83]
s_add_u32 m0, s12, 5440
s_add_u32 s6, s13, 5120
buffer_load_dwordx4 v2, s[52:55], s6 offen nt lds
s_waitcnt vmcnt(51)
v_perm_b32 v60, v25, v25, v14
v_perm_b32 v61, v25, v25, v15
v_perm_b32 v62, v25, v25, v16
v_perm_b32 v63, v25, v25, v17
s_nop 1
v_mfma_f32_16x16x32_bf16 v[76:79], v[60:63], a[120:123], v[76:79]
v_perm_b32 v64, v43, v43, v14
v_perm_b32 v65, v43, v43, v15
v_perm_b32 v66, v43, v43, v16
v_perm_b32 v67, v43, v43, v17
s_nop 1
v_mfma_f32_16x16x32_bf16 v[80:83], v[64:67], a[120:123], v[80:83]
s_add_u32 m0, s12, 6528
s_add_u32 s6, s13, 6144
buffer_load_dwordx4 v2, s[52:55], s6 offen nt lds
s_waitcnt vmcnt(51)
v_perm_b32 v68, v25, v25, v18
v_perm_b32 v69, v25, v25, v19
v_perm_b32 v70, v25, v25, v20
v_perm_b32 v71, v25, v25, v21
s_nop 1
v_mfma_f32_16x16x32_bf16 v[76:79], v[68:71], a[124:127], v[76:79]
v_perm_b32 v72, v43, v43, v18
v_perm_b32 v73, v43, v43, v19
v_perm_b32 v74, v43, v43, v20
v_perm_b32 v75, v43, v43, v21
s_nop 1
v_mfma_f32_16x16x32_bf16 v[80:83], v[72:75], a[124:127], v[80:83]
s_add_u32 m0, s12, 7616
s_add_u32 s6, s13, 7168
buffer_load_dwordx4 v2, s[52:55], s6 offen nt lds
s_waitcnt vmcnt(51)
v_perm_b32 v60, v26, v26, v14
v_perm_b32 v61, v26, v26, v15
v_perm_b32 v62, v26, v26, v16
v_perm_b32 v63, v26, v26, v17
s_nop 1
v_mfma_f32_16x16x32_bf16 v[76:79], v[60:63], a[128:131], v[76:79]
v_perm_b32 v64, v44, v44, v14
v_perm_b32 v65, v44, v44, v15
v_perm_b32 v66, v44, v44, v16
v_perm_b32 v67, v44, v44, v17
s_nop 1
v_mfma_f32_16x16x32_bf16 v[80:83], v[64:67], a[128:131], v[80:83]
s_add_u32 m0, s12, 8704
s_add_u32 s6, s13, 8192
buffer_load_dwordx4 v2, s[52:55], s6 offen nt lds
s_waitcnt vmcnt(51)
v_perm_b32 v68, v26, v26, v18
v_perm_b32 v69, v26, v26, v19
v_perm_b32 v70, v26, v26, v20
v_perm_b32 v71, v26, v26, v21
s_nop 1
v_mfma_f32_16x16x32_bf16 v[76:79], v[68:71], a[132:135], v[76:79]
v_perm_b32 v72, v44, v44, v18
v_perm_b32 v73, v44, v44, v19
v_perm_b32 v74, v44, v44, v20
v_perm_b32 v75, v44, v44, v21
s_nop 1
v_mfma_f32_16x16x32_bf16 v[80:83], v[72:75], a[132:135], v[80:83]
s_add_u32 m0, s12, 9792
s_add_u32 s6, s13, 9216
buffer_load_dwordx4 v2, s[52:55], s6 offen nt lds
s_waitcnt vmcnt(51)
v_perm_b32 v60, v27, v27, v14
v_perm_b32 v61, v27, v27, v15
v_perm_b32 v62, v27, v27, v16
v_perm_b32 v63, v27, v27, v17
s_nop 1
v_mfma_f32_16x16x32_bf16 v[76:79], v[60:63], a[136:139], v[76:79]
v_perm_b32 v64, v45, v45, v14
v_perm_b32 v65, v45, v45, v15
v_perm_b32 v66, v45, v45, v16
v_perm_b32 v67, v45, v45, v17
s_nop 1
v_mfma_f32_16x16x32_bf16 v[80:83], v[64:67], a[136:139], v[80:83]
s_add_u32 m0, s12, 10880
s_add_u32 s6, s13, 10240
buffer_load_dwordx4 v2, s[52:55], s6 offen nt lds
s_waitcnt vmcnt(51)
v_perm_b32 v68, v27, v27, v18
v_perm_b32 v69, v27, v27, v19
v_perm_b32 v70, v27, v27, v20
v_perm_b32 v71, v27, v27, v21
s_nop 1
v_mfma_f32_16x16x32_bf16 v[76:79], v[68:71], a[140:143], v[76:79]
v_perm_b32 v72, v45, v45, v18
v_perm_b32 v73, v45, v45, v19
v_perm_b32 v74, v45, v45, v20
v_perm_b32 v75, v45, v45, v21
s_nop 1
v_mfma_f32_16x16x32_bf16 v[80:83], v[72:75], a[140:143], v[80:83]
s_add_u32 m0, s12, 11968
s_add_u32 s6, s13, 11264
buffer_load_dwordx4 v2, s[52:55], s6 offen nt lds
s_waitcnt vmcnt(51)
v_perm_b32 v60, v28, v28, v14
v_perm_b32 v61, v28, v28, v15
v_perm_b32 v62, v28, v28, v16
v_perm_b32 v63, v28, v28, v17
s_nop 1
v_mfma_f32_16x16x32_bf16 v[76:79], v[60:63], a[144:147], v[76:79]
v_perm_b32 v64, v46, v46, v14
v_perm_b32 v65, v46, v46, v15
v_perm_b32 v66, v46, v46, v16
v_perm_b32 v67, v46, v46, v17
s_nop 1
v_mfma_f32_16x16x32_bf16 v[80:83], v[64:67], a[144:147], v[80:83]
s_add_u32 m0, s12, 13056
s_add_u32 s6, s13, 12288
buffer_load_dwordx4 v2, s[52:55], s6 offen nt lds
s_waitcnt vmcnt(51)
v_perm_b32 v68, v28, v28, v18
v_perm_b32 v69, v28, v28, v19
v_perm_b32 v70, v28, v28, v20
v_perm_b32 v71, v28, v28, v21
s_nop 1
v_mfma_f32_16x16x32_bf16 v[76:79], v[68:71], a[148:151], v[76:79]
v_perm_b32 v72, v46, v46, v18
v_perm_b32 v73, v46, v46, v19
v_perm_b32 v74, v46, v46, v20
v_perm_b32 v75, v46, v46, v21
s_nop 1
v_mfma_f32_16x16x32_bf16 v[80:83], v[72:75], a[148:151], v[80:83]
s_add_u32 m0, s12, 14144
s_add_u32 s6, s13, 13312
buffer_load_dwordx4 v2, s[52:55], s6 offen nt lds
s_waitcnt vmcnt(51)
v_perm_b32 v60, v29, v29, v14
v_perm_b32 v61, v29, v29, v15
v_perm_b32 v62, v29, v29, v16
v_perm_b32 v63, v29, v29, v17
s_nop 1
v_mfma_f32_16x16x32_bf16 v[76:79], v[60:63], a[152:155], v[76:79]
v_perm_b32 v64, v47, v47, v14
v_perm_b32 v65, v47, v47, v15
v_perm_b32 v66, v47, v47, v16
v_perm_b32 v67, v47, v47, v17
s_nop 1
v_mfma_f32_16x16x32_bf16 v[80:83], v[64:67], a[152:155], v[80:83]
s_add_u32 m0, s12, 15232
s_add_u32 s6, s13, 14336
buffer_load_dwordx4 v2, s[52:55], s6 offen nt lds
s_waitcnt vmcnt(51)
v_perm_b32 v68, v29, v29, v18
v_perm_b32 v69, v29, v29, v19
v_perm_b32 v70, v29, v29, v20
v_perm_b32 v71, v29, v29, v21
s_nop 1
v_mfma_f32_16x16x32_bf16 v[76:79], v[68:71], a[156:159], v[76:79]
v_perm_b32 v72, v47, v47, v18
v_perm_b32 v73, v47, v47, v19
v_perm_b32 v74, v47, v47, v20
v_perm_b32 v75, v47, v47, v21
s_nop 1
v_mfma_f32_16x16x32_bf16 v[80:83], v[72:75], a[156:159], v[80:83]
s_add_u32 m0, s12, 16320
s_add_u32 s6, s13, 15360
buffer_load_dwordx4 v2, s[52:55], s6 offen nt lds
s_waitcnt vmcnt(51)
v_perm_b32 v60, v30, v30, v14
v_perm_b32 v61, v30, v30, v15
v_perm_b32 v62, v30, v30, v16
v_perm_b32 v63, v30, v30, v17
s_nop 1
v_mfma_f32_16x16x32_bf16 v[76:79], v[60:63], a[160:163], v[76:79]
v_perm_b32 v64, v48, v48, v14
v_perm_b32 v65, v48, v48, v15
v_perm_b32 v66, v48, v48, v16
v_perm_b32 v67, v48, v48, v17
s_nop 1
v_mfma_f32_16x16x32_bf16 v[80:83], v[64:67], a[160:163], v[80:83]
s_add_u32 m0, s12, 69632
s_add_u32 s6, s13, 65536
buffer_load_dwordx4 v2, s[52:55], s6 offen nt lds
s_waitcnt vmcnt(51)
v_perm_b32 v68, v30, v30, v18
v_perm_b32 v69, v30, v30, v19
v_perm_b32 v70, v30, v30, v20
v_perm_b32 v71, v30, v30, v21
s_nop 1
v_mfma_f32_16x16x32_bf16 v[76:79], v[68:71], a[164:167], v[76:79]
v_perm_b32 v72, v48, v48, v18
v_perm_b32 v73, v48, v48, v19
v_perm_b32 v74, v48, v48, v20
v_perm_b32 v75, v48, v48, v21
s_nop 1
v_mfma_f32_16x16x32_bf16 v[80:83], v[72:75], a[164:167], v[80:83]
s_add_u32 m0, s12, 70720
s_add_u32 s6, s13, 66560
buffer_load_dwordx4 v2, s[52:55], s6 offen nt lds
s_waitcnt vmcnt(51)
v_perm_b32 v60, v31, v31, v14
v_perm_b32 v61, v31, v31, v15
v_perm_b32 v62, v31, v31, v16
v_perm_b32 v63, v31, v31, v17
s_nop 1
v_mfma_f32_16x16x32_bf16 v[76:79], v[60:63], a[168:171], v[76:79]
v_perm_b32 v64, v49, v49, v14
v_perm_b32 v65, v49, v49, v15
v_perm_b32 v66, v49, v49, v16
v_perm_b32 v67, v49, v49, v17
s_nop 1
v_mfma_f32_16x16x32_bf16 v[80:83], v[64:67], a[168:171], v[80:83]
s_add_u32 m0, s12, 71808
s_add_u32 s6, s13, 67584
buffer_load_dwordx4 v2, s[52:55], s6 offen nt lds
s_waitcnt vmcnt(51)
v_perm_b32 v68, v31, v31, v18
v_perm_b32 v69, v31, v31, v19
v_perm_b32 v70, v31, v31, v20
v_perm_b32 v71, v31, v31, v21
s_nop 1
v_mfma_f32_16x16x32_bf16 v[76:79], v[68:71], a[172:175], v[76:79]
v_perm_b32 v72, v49, v49, v18
v_perm_b32 v73, v49, v49, v19
v_perm_b32 v74, v49, v49, v20
v_perm_b32 v75, v49, v49, v21
s_nop 1
v_mfma_f32_16x16x32_bf16 v[80:83], v[72:75], a[172:175], v[80:83]
s_add_u32 m0, s12, 72896
s_add_u32 s6, s13, 68608
buffer_load_dwordx4 v2, s[52:55], s6 offen nt lds
s_waitcnt vmcnt(51)
v_perm_b32 v60, v32, v32, v14
v_perm_b32 v61, v32, v32, v15
v_perm_b32 v62, v32, v32, v16
v_perm_b32 v63, v32, v32, v17
s_nop 1
v_mfma_f32_16x16x32_bf16 v[76:79], v[60:63], a[176:179], v[76:79]
v_perm_b32 v64, v50, v50, v14
v_perm_b32 v65, v50, v50, v15
v_perm_b32 v66, v50, v50, v16
v_perm_b32 v67, v50, v50, v17
s_nop 1
v_mfma_f32_16x16x32_bf16 v[80:83], v[64:67], a[176:179], v[80:83]
s_add_u32 m0, s12, 73984
s_add_u32 s6, s13, 69632
buffer_load_dwordx4 v2, s[52:55], s6 offen nt lds
s_waitcnt vmcnt(51)
v_perm_b32 v68, v32, v32, v18
v_perm_b32 v69, v32, v32, v19
v_perm_b32 v70, v32, v32, v20
v_perm_b32 v71, v32, v32, v21
s_nop 1
v_mfma_f32_16x16x32_bf16 v[76:79], v[68:71], a[180:183], v[76:79]
v_perm_b32 v72, v50, v50, v18
v_perm_b32 v73, v50, v50, v19
v_perm_b32 v74, v50, v50, v20
v_perm_b32 v75, v50, v50, v21
s_nop 1
v_mfma_f32_16x16x32_bf16 v[80:83], v[72:75], a[180:183], v[80:83]
s_add_u32 m0, s12, 75072
s_add_u32 s6, s13, 70656
buffer_load_dwordx4 v2, s[52:55], s6 offen nt lds
s_waitcnt vmcnt(51)
v_perm_b32 v60, v33, v33, v14
v_perm_b32 v61, v33, v33, v15
v_perm_b32 v62, v33, v33, v16
v_perm_b32 v63, v33, v33, v17
s_nop 1
v_mfma_f32_16x16x32_bf16 v[76:79], v[60:63], a[184:187], v[76:79]
v_perm_b32 v64, v51, v51, v14
v_perm_b32 v65, v51, v51, v15
v_perm_b32 v66, v51, v51, v16
v_perm_b32 v67, v51, v51, v17
s_nop 1
v_mfma_f32_16x16x32_bf16 v[80:83], v[64:67], a[184:187], v[80:83]
s_add_u32 m0, s12, 76160
s_add_u32 s6, s13, 71680
buffer_load_dwordx4 v2, s[52:55], s6 offen nt lds
s_waitcnt vmcnt(51)
v_perm_b32 v68, v33, v33, v18
v_perm_b32 v69, v33, v33, v19
v_perm_b32 v70, v33, v33, v20
v_perm_b32 v71, v33, v33, v21
s_nop 1
v_mfma_f32_16x16x32_bf16 v[76:79], v[68:71], a[188:191], v[76:79]
v_perm_b32 v72, v51, v51, v18
v_perm_b32 v73, v51, v51, v19
v_perm_b32 v74, v51, v51, v20
v_perm_b32 v75, v51, v51, v21
s_nop 1
v_mfma_f32_16x16x32_bf16 v[80:83], v[72:75], a[188:191], v[80:83]
s_add_u32 m0, s12, 77248
s_add_u32 s6, s13, 72704
buffer_load_dwordx4 v2, s[52:55], s6 offen nt lds
s_waitcnt vmcnt(51)
v_perm_b32 v60, v34, v34, v14
v_perm_b32 v61, v34, v34, v15
v_perm_b32 v62, v34, v34, v16
v_perm_b32 v63, v34, v34, v17
s_nop 1
v_mfma_f32_16x16x32_bf16 v[76:79], v[60:63], a[192:195], v[76:79]
v_perm_b32 v64, v52, v52, v14
v_perm_b32 v65, v52, v52, v15
v_perm_b32 v66, v52, v52, v16
v_perm_b32 v67, v52, v52, v17
s_nop 1
v_mfma_f32_16x16x32_bf16 v[80:83], v[64:67], a[192:195], v[80:83]
s_add_u32 m0, s12, 78336
s_add_u32 s6, s13, 73728
buffer_load_dwordx4 v2, s[52:55], s6 offen nt lds
s_waitcnt vmcnt(51)
v_perm_b32 v68, v34, v34, v18
v_perm_b32 v69, v34, v34, v19
v_perm_b32 v70, v34, v34, v20
v_perm_b32 v71, v34, v34, v21
s_nop 1
v_mfma_f32_16x16x32_bf16 v[76:79], v[68:71], a[196:199], v[76:79]
v_perm_b32 v72, v52, v52, v18
v_perm_b32 v73, v52, v52, v19
v_perm_b32 v74, v52, v52, v20
v_perm_b32 v75, v52, v52, v21
s_nop 1
v_mfma_f32_16x16x32_bf16 v[80:83], v[72:75], a[196:199], v[80:83]
s_add_u32 m0, s12, 79424
s_add_u32 s6, s13, 74752
buffer_load_dwordx4 v2, s[52:55], s6 offen nt lds
s_waitcnt vmcnt(51)
v_perm_b32 v60, v35, v35, v14
v_perm_b32 v61, v35, v35, v15
v_perm_b32 v62, v35, v35, v16
v_perm_b32 v63, v35, v35, v17
s_nop 1
v_mfma_f32_16x16x32_bf16 v[76:79], v[60:63], a[200:203], v[76:79]
v_perm_b32 v64, v53, v53, v14
v_perm_b32 v65, v53, v53, v15
v_perm_b32 v66, v53, v53, v16
v_perm_b32 v67, v53, v53, v17
s_nop 1
v_mfma_f32_16x16x32_bf16 v[80:83], v[64:67], a[200:203], v[80:83]
s_add_u32 m0, s12, 80512
s_add_u32 s6, s13, 75776
buffer_load_dwordx4 v2, s[52:55], s6 offen nt lds
s_waitcnt vmcnt(51)
v_perm_b32 v68, v35, v35, v18
v_perm_b32 v69, v35, v35, v19
v_perm_b32 v70, v35, v35, v20
v_perm_b32 v71, v35, v35, v21
s_nop 1
v_mfma_f32_16x16x32_bf16 v[76:79], v[68:71], a[204:207], v[76:79]
v_perm_b32 v72, v53, v53, v18
v_perm_b32 v73, v53, v53, v19
v_perm_b32 v74, v53, v53, v20
v_perm_b32 v75, v53, v53, v21
s_nop 1
v_mfma_f32_16x16x32_bf16 v[80:83], v[72:75], a[204:207], v[80:83]
s_add_u32 m0, s12, 81600
s_add_u32 s6, s13, 76800
buffer_load_dwordx4 v2, s[52:55], s6 offen nt lds
s_waitcnt vmcnt(51)
v_perm_b32 v60, v36, v36, v14
v_perm_b32 v61, v36, v36, v15
v_perm_b32 v62, v36, v36, v16
v_perm_b32 v63, v36, v36, v17
s_nop 1
v_mfma_f32_16x16x32_bf16 v[76:79], v[60:63], a[208:211], v[76:79]
v_perm_b32 v64, v54, v54, v14
v_perm_b32 v65, v54, v54, v15
v_perm_b32 v66, v54, v54, v16
v_perm_b32 v67, v54, v54, v17
s_nop 1
v_mfma_f32_16x16x32_bf16 v[80:83], v[64:67], a[208:211], v[80:83]
s_add_u32 m0, s12, 82688
s_add_u32 s6, s13, 77824
buffer_load_dwordx4 v2, s[52:55], s6 offen nt lds
s_waitcnt vmcnt(51)
v_perm_b32 v68, v36, v36, v18
v_perm_b32 v69, v36, v36, v19
v_perm_b32 v70, v36, v36, v20
v_perm_b32 v71, v36, v36, v21
s_nop 1
v_mfma_f32_16x16x32_bf16 v[76:79], v[68:71], a[212:215], v[76:79]
v_perm_b32 v72, v54, v54, v18
v_perm_b32 v73, v54, v54, v19
v_perm_b32 v74, v54, v54, v20
v_perm_b32 v75, v54, v54, v21
s_nop 1
v_mfma_f32_16x16x32_bf16 v[80:83], v[72:75], a[212:215], v[80:83]
s_add_u32 m0, s12, 83776
s_add_u32 s6, s13, 78848
buffer_load_dwordx4 v2, s[52:55], s6 offen nt lds
s_waitcnt vmcnt(51)
v_perm_b32 v60, v37, v37, v14
v_perm_b32 v61, v37, v37, v15
v_perm_b32 v62, v37, v37, v16
v_perm_b32 v63, v37, v37, v17
s_nop 1
v_mfma_f32_16x16x32_bf16 v[76:79], v[60:63], a[216:219], v[76:79]
v_perm_b32 v64, v55, v55, v14
v_perm_b32 v65, v55, v55, v15
v_perm_b32 v66, v55, v55, v16
v_perm_b32 v67, v55, v55, v17
s_nop 1
v_mfma_f32_16x16x32_bf16 v[80:83], v[64:67], a[216:219], v[80:83]
s_add_u32 m0, s12, 84864
s_add_u32 s6, s13, 79872
buffer_load_dwordx4 v2, s[52:55], s6 offen nt lds
s_waitcnt vmcnt(51)
v_perm_b32 v68, v37, v37, v18
v_perm_b32 v69, v37, v37, v19
v_perm_b32 v70, v37, v37, v20
v_perm_b32 v71, v37, v37, v21
s_nop 1
v_mfma_f32_16x16x32_bf16 v[76:79], v[68:71], a[220:223], v[76:79]
v_perm_b32 v72, v55, v55, v18
v_perm_b32 v73, v55, v55, v19
v_perm_b32 v74, v55, v55, v20
v_perm_b32 v75, v55, v55, v21
s_nop 1
v_mfma_f32_16x16x32_bf16 v[80:83], v[72:75], a[220:223], v[80:83]
s_add_u32 m0, s12, 85952
s_add_u32 s6, s13, 80896
buffer_load_dwordx4 v2, s[52:55], s6 offen nt lds
s_waitcnt vmcnt(51)
v_perm_b32 v60, v38, v38, v14
v_perm_b32 v61, v38, v38, v15
v_perm_b32 v62, v38, v38, v16
v_perm_b32 v63, v38, v38, v17
s_nop 1
v_mfma_f32_16x16x32_bf16 v[76:79], v[60:63], a[224:227], v[76:79]
v_perm_b32 v64, v56, v56, v14
v_perm_b32 v65, v56, v56, v15
v_perm_b32 v66, v56, v56, v16
v_perm_b32 v67, v56, v56, v17
s_nop 1
v_mfma_f32_16x16x32_bf16 v[80:83], v[64:67], a[224:227], v[80:83]
s_waitcnt vmcnt(50)
v_perm_b32 v68, v38, v38, v18
v_perm_b32 v69, v38, v38, v19
v_perm_b32 v70, v38, v38, v20
v_perm_b32 v71, v38, v38, v21
s_nop 1
v_mfma_f32_16x16x32_bf16 v[76:79], v[68:71], a[228:231], v[76:79]
v_perm_b32 v72, v56, v56, v18
v_perm_b32 v73, v56, v56, v19
v_perm_b32 v74, v56, v56, v20
v_perm_b32 v75, v56, v56, v21
s_nop 1
v_mfma_f32_16x16x32_bf16 v[80:83], v[72:75], a[228:231], v[80:83]
s_waitcnt vmcnt(49)
v_perm_b32 v60, v39, v39, v14
v_perm_b32 v61, v39, v39, v15
v_perm_b32 v62, v39, v39, v16
v_perm_b32 v63, v39, v39, v17
s_nop 1
v_mfma_f32_16x16x32_bf16 v[76:79], v[60:63], a[232:235], v[76:79]
v_perm_b32 v64, v57, v57, v14
v_perm_b32 v65, v57, v57, v15
v_perm_b32 v66, v57, v57, v16
v_perm_b32 v67, v57, v57, v17
s_nop 1
v_mfma_f32_16x16x32_bf16 v[80:83], v[64:67], a[232:235], v[80:83]
s_waitcnt vmcnt(48)
v_perm_b32 v68, v39, v39, v18
v_perm_b32 v69, v39, v39, v19
v_perm_b32 v70, v39, v39, v20
v_perm_b32 v71, v39, v39, v21
s_nop 1
v_mfma_f32_16x16x32_bf16 v[76:79], v[68:71], a[236:239], v[76:79]
v_perm_b32 v72, v57, v57, v18
v_perm_b32 v73, v57, v57, v19
v_perm_b32 v74, v57, v57, v20
v_perm_b32 v75, v57, v57, v21
s_nop 1
v_mfma_f32_16x16x32_bf16 v[80:83], v[72:75], a[236:239], v[80:83]
v_lshlrev_b32 v5, 5, v8
v_and_b32 v6, 1, v9
v_lshl_add_u32 v6, v6, 4, v5
v_lshrrev_b32 v7, 5, v1
v_lshl_add_u32 v6, v7, 9, v6
s_lshl_b32 s6, s3, 11
s_add_u32 s6, s6, 144384
v_add_u32 v6, s6, v6
ds_write_b128 v6, v[76:79]
ds_write_b128 v6, v[80:83] offset:1024
v_add_u32 v5, 144384, v5
s_waitcnt lgkmcnt(0)
s_barrier
ds_read_b128 v[188:191], v5 offset:0
ds_read_b128 v[192:195], v5 offset:16
ds_read_b128 v[196:199], v5 offset:2048
ds_read_b128 v[200:203], v5 offset:2064
ds_read_b128 v[204:207], v5 offset:4096
ds_read_b128 v[208:211], v5 offset:4112
ds_read_b128 v[212:215], v5 offset:6144
ds_read_b128 v[216:219], v5 offset:6160
s_waitcnt lgkmcnt(0)
v_add_f32 v188, v188, v196
v_add_f32 v204, v204, v212
v_add_f32 v189, v189, v197
v_add_f32 v205, v205, v213
v_add_f32 v190, v190, v198
v_add_f32 v206, v206, v214
v_add_f32 v191, v191, v199
v_add_f32 v207, v207, v215
v_add_f32 v192, v192, v200
v_add_f32 v208, v208, v216
v_add_f32 v193, v193, v201
v_add_f32 v209, v209, v217
v_add_f32 v194, v194, v202
v_add_f32 v210, v210, v218
v_add_f32 v195, v195, v203
v_add_f32 v211, v211, v219
v_add_f32 v188, v188, v204
v_add_f32 v189, v189, v205
v_add_f32 v190, v190, v206
v_add_f32 v191, v191, v207
v_add_f32 v192, v192, v208
v_add_f32 v193, v193, v209
v_add_f32 v194, v194, v210
v_add_f32 v195, v195, v211
v_cvt_pk_bf16_f32 v148, v188, v189
v_cvt_pk_bf16_f32 v149, v190, v191
v_cvt_pk_bf16_f32 v150, v192, v193
v_cvt_pk_bf16_f32 v151, v194, v195
ds_read_b128 v[188:191], v5 offset:512
ds_read_b128 v[192:195], v5 offset:528
ds_read_b128 v[196:199], v5 offset:2560
ds_read_b128 v[200:203], v5 offset:2576
ds_read_b128 v[204:207], v5 offset:4608
ds_read_b128 v[208:211], v5 offset:4624
ds_read_b128 v[212:215], v5 offset:6656
ds_read_b128 v[216:219], v5 offset:6672
s_waitcnt lgkmcnt(0)
v_add_f32 v188, v188, v196
v_add_f32 v204, v204, v212
v_add_f32 v189, v189, v197
v_add_f32 v205, v205, v213
v_add_f32 v190, v190, v198
v_add_f32 v206, v206, v214
v_add_f32 v191, v191, v199
v_add_f32 v207, v207, v215
v_add_f32 v192, v192, v200
v_add_f32 v208, v208, v216
v_add_f32 v193, v193, v201
v_add_f32 v209, v209, v217
v_add_f32 v194, v194, v202
v_add_f32 v210, v210, v218
v_add_f32 v195, v195, v203
v_add_f32 v211, v211, v219
v_add_f32 v188, v188, v204
v_add_f32 v189, v189, v205
v_add_f32 v190, v190, v206
v_add_f32 v191, v191, v207
v_add_f32 v192, v192, v208
v_add_f32 v193, v193, v209
v_add_f32 v194, v194, v210
v_add_f32 v195, v195, v211
v_cvt_pk_bf16_f32 v152, v188, v189
v_cvt_pk_bf16_f32 v153, v190, v191
v_cvt_pk_bf16_f32 v154, v192, v193
v_cvt_pk_bf16_f32 v155, v194, v195
ds_read_b128 v[188:191], v5 offset:1024
ds_read_b128 v[192:195], v5 offset:1040
ds_read_b128 v[196:199], v5 offset:3072
ds_read_b128 v[200:203], v5 offset:3088
ds_read_b128 v[204:207], v5 offset:5120
ds_read_b128 v[208:211], v5 offset:5136
ds_read_b128 v[212:215], v5 offset:7168
ds_read_b128 v[216:219], v5 offset:7184
s_waitcnt lgkmcnt(0)
v_add_f32 v188, v188, v196
v_add_f32 v204, v204, v212
v_add_f32 v189, v189, v197
v_add_f32 v205, v205, v213
v_add_f32 v190, v190, v198
v_add_f32 v206, v206, v214
v_add_f32 v191, v191, v199
v_add_f32 v207, v207, v215
v_add_f32 v192, v192, v200
v_add_f32 v208, v208, v216
v_add_f32 v193, v193, v201
v_add_f32 v209, v209, v217
v_add_f32 v194, v194, v202
v_add_f32 v210, v210, v218
v_add_f32 v195, v195, v203
v_add_f32 v211, v211, v219
v_add_f32 v188, v188, v204
v_add_f32 v189, v189, v205
v_add_f32 v190, v190, v206
v_add_f32 v191, v191, v207
v_add_f32 v192, v192, v208
v_add_f32 v193, v193, v209
v_add_f32 v194, v194, v210
v_add_f32 v195, v195, v211
v_cvt_pk_bf16_f32 v156, v188, v189
v_cvt_pk_bf16_f32 v157, v190, v191
v_cvt_pk_bf16_f32 v158, v192, v193
v_cvt_pk_bf16_f32 v159, v194, v195
ds_read_b128 v[188:191], v5 offset:1536
ds_read_b128 v[192:195], v5 offset:1552
ds_read_b128 v[196:199], v5 offset:3584
ds_read_b128 v[200:203], v5 offset:3600
ds_read_b128 v[204:207], v5 offset:5632
ds_read_b128 v[208:211], v5 offset:5648
ds_read_b128 v[212:215], v5 offset:7680
ds_read_b128 v[216:219], v5 offset:7696
s_waitcnt lgkmcnt(0)
v_add_f32 v188, v188, v196
v_add_f32 v204, v204, v212
v_add_f32 v189, v189, v197
v_add_f32 v205, v205, v213
v_add_f32 v190, v190, v198
v_add_f32 v206, v206, v214
v_add_f32 v191, v191, v199
v_add_f32 v207, v207, v215
v_add_f32 v192, v192, v200
v_add_f32 v208, v208, v216
v_add_f32 v193, v193, v201
v_add_f32 v209, v209, v217
v_add_f32 v194, v194, v202
v_add_f32 v210, v210, v218
v_add_f32 v195, v195, v203
v_add_f32 v211, v211, v219
v_add_f32 v188, v188, v204
v_add_f32 v189, v189, v205
v_add_f32 v190, v190, v206
v_add_f32 v191, v191, v207
v_add_f32 v192, v192, v208
v_add_f32 v193, v193, v209
v_add_f32 v194, v194, v210
v_add_f32 v195, v195, v211
v_cvt_pk_bf16_f32 v160, v188, v189
v_cvt_pk_bf16_f32 v161, v190, v191
v_cvt_pk_bf16_f32 v162, v192, v193
v_cvt_pk_bf16_f32 v163, v194, v195
s_waitcnt vmcnt(32)
v_dot2_f32_bf16 v164, v84, v148, 0
v_dot2_f32_bf16 v165, v84, v152, 0
v_dot2_f32_bf16 v166, v84, v156, 0
v_dot2_f32_bf16 v167, v84, v160, 0
v_dot2_f32_bf16 v164, v85, v149, v164
v_dot2_f32_bf16 v165, v85, v153, v165
v_dot2_f32_bf16 v166, v85, v157, v166
v_dot2_f32_bf16 v167, v85, v161, v167
v_dot2_f32_bf16 v164, v86, v150, v164
v_dot2_f32_bf16 v165, v86, v154, v165
v_dot2_f32_bf16 v166, v86, v158, v166
v_dot2_f32_bf16 v167, v86, v162, v167
v_dot2_f32_bf16 v164, v87, v151, v164
v_dot2_f32_bf16 v165, v87, v155, v165
v_dot2_f32_bf16 v166, v87, v159, v166
v_dot2_f32_bf16 v167, v87, v163, v167
v_add_f32_dpp v168, v164, v164 row_ror:8 row_mask:0xf bank_mask:0x3
v_add_f32_dpp v169, v165, v165 row_ror:8 row_mask:0xf bank_mask:0x3
v_add_f32_dpp v168, v166, v166 row_ror:8 row_mask:0xf bank_mask:0xc
v_add_f32_dpp v169, v167, v167 row_ror:8 row_mask:0xf bank_mask:0xc
s_nop 0
v_add_f32_dpp v172, v168, v168 row_half_mirror row_mask:0xf bank_mask:0x5
v_add_f32_dpp v172, v169, v169 row_half_mirror row_mask:0xf bank_mask:0xa
s_nop 1
v_add_f32_dpp v172, v172, v172 quad_perm:[1,0,3,2] row_mask:0xf bank_mask:0xf
s_nop 1
v_add_f32_dpp v172, v172, v172 quad_perm:[2,3,0,1] row_mask:0xf bank_mask:0xf
v_dot2_f32_bf16 v164, v88, v148, 0
v_dot2_f32_bf16 v165, v88, v152, 0
v_dot2_f32_bf16 v166, v88, v156, 0
v_dot2_f32_bf16 v167, v88, v160, 0
v_dot2_f32_bf16 v164, v89, v149, v164
v_dot2_f32_bf16 v165, v89, v153, v165
v_dot2_f32_bf16 v166, v89, v157, v166
v_dot2_f32_bf16 v167, v89, v161, v167
v_dot2_f32_bf16 v164, v90, v150, v164
v_dot2_f32_bf16 v165, v90, v154, v165
v_dot2_f32_bf16 v166, v90, v158, v166
v_dot2_f32_bf16 v167, v90, v162, v167
v_dot2_f32_bf16 v164, v91, v151, v164
v_dot2_f32_bf16 v165, v91, v155, v165
v_dot2_f32_bf16 v166, v91, v159, v166
v_dot2_f32_bf16 v167, v91, v163, v167
v_add_f32_dpp v168, v164, v164 row_ror:8 row_mask:0xf bank_mask:0x3
v_add_f32_dpp v169, v165, v165 row_ror:8 row_mask:0xf bank_mask:0x3
v_add_f32_dpp v168, v166, v166 row_ror:8 row_mask:0xf bank_mask:0xc
v_add_f32_dpp v169, v167, v167 row_ror:8 row_mask:0xf bank_mask:0xc
s_nop 0
v_add_f32_dpp v173, v168, v168 row_half_mirror row_mask:0xf bank_mask:0x5
v_add_f32_dpp v173, v169, v169 row_half_mirror row_mask:0xf bank_mask:0xa
s_nop 1
v_add_f32_dpp v173, v173, v173 quad_perm:[1,0,3,2] row_mask:0xf bank_mask:0xf
s_nop 1
v_add_f32_dpp v173, v173, v173 quad_perm:[2,3,0,1] row_mask:0xf bank_mask:0xf
v_dot2_f32_bf16 v164, v92, v148, 0
v_dot2_f32_bf16 v165, v92, v152, 0
v_dot2_f32_bf16 v166, v92, v156, 0
v_dot2_f32_bf16 v167, v92, v160, 0
v_dot2_f32_bf16 v164, v93, v149, v164
v_dot2_f32_bf16 v165, v93, v153, v165
v_dot2_f32_bf16 v166, v93, v157, v166
v_dot2_f32_bf16 v167, v93, v161, v167
v_dot2_f32_bf16 v164, v94, v150, v164
v_dot2_f32_bf16 v165, v94, v154, v165
v_dot2_f32_bf16 v166, v94, v158, v166
v_dot2_f32_bf16 v167, v94, v162, v167
v_dot2_f32_bf16 v164, v95, v151, v164
v_dot2_f32_bf16 v165, v95, v155, v165
v_dot2_f32_bf16 v166, v95, v159, v166
v_dot2_f32_bf16 v167, v95, v163, v167
v_add_f32_dpp v168, v164, v164 row_ror:8 row_mask:0xf bank_mask:0x3
v_add_f32_dpp v169, v165, v165 row_ror:8 row_mask:0xf bank_mask:0x3
v_add_f32_dpp v168, v166, v166 row_ror:8 row_mask:0xf bank_mask:0xc
v_add_f32_dpp v169, v167, v167 row_ror:8 row_mask:0xf bank_mask:0xc
s_nop 0
v_add_f32_dpp v174, v168, v168 row_half_mirror row_mask:0xf bank_mask:0x5
v_add_f32_dpp v174, v169, v169 row_half_mirror row_mask:0xf bank_mask:0xa
s_nop 1
v_add_f32_dpp v174, v174, v174 quad_perm:[1,0,3,2] row_mask:0xf bank_mask:0xf
s_nop 1
v_add_f32_dpp v174, v174, v174 quad_perm:[2,3,0,1] row_mask:0xf bank_mask:0xf
v_dot2_f32_bf16 v164, v96, v148, 0
v_dot2_f32_bf16 v165, v96, v152, 0
v_dot2_f32_bf16 v166, v96, v156, 0
v_dot2_f32_bf16 v167, v96, v160, 0
v_dot2_f32_bf16 v164, v97, v149, v164
v_dot2_f32_bf16 v165, v97, v153, v165
v_dot2_f32_bf16 v166, v97, v157, v166
v_dot2_f32_bf16 v167, v97, v161, v167
v_dot2_f32_bf16 v164, v98, v150, v164
v_dot2_f32_bf16 v165, v98, v154, v165
v_dot2_f32_bf16 v166, v98, v158, v166
v_dot2_f32_bf16 v167, v98, v162, v167
v_dot2_f32_bf16 v164, v99, v151, v164
v_dot2_f32_bf16 v165, v99, v155, v165
v_dot2_f32_bf16 v166, v99, v159, v166
v_dot2_f32_bf16 v167, v99, v163, v167
v_add_f32_dpp v168, v164, v164 row_ror:8 row_mask:0xf bank_mask:0x3
v_add_f32_dpp v169, v165, v165 row_ror:8 row_mask:0xf bank_mask:0x3
v_add_f32_dpp v168, v166, v166 row_ror:8 row_mask:0xf bank_mask:0xc
v_add_f32_dpp v169, v167, v167 row_ror:8 row_mask:0xf bank_mask:0xc
s_nop 0
v_add_f32_dpp v175, v168, v168 row_half_mirror row_mask:0xf bank_mask:0x5
v_add_f32_dpp v175, v169, v169 row_half_mirror row_mask:0xf bank_mask:0xa
s_nop 1
v_add_f32_dpp v175, v175, v175 quad_perm:[1,0,3,2] row_mask:0xf bank_mask:0xf
s_nop 1
v_add_f32_dpp v175, v175, v175 quad_perm:[2,3,0,1] row_mask:0xf bank_mask:0xf
v_dot2_f32_bf16 v164, v100, v148, 0
v_dot2_f32_bf16 v165, v100, v152, 0
v_dot2_f32_bf16 v166, v100, v156, 0
v_dot2_f32_bf16 v167, v100, v160, 0
v_dot2_f32_bf16 v164, v101, v149, v164
v_dot2_f32_bf16 v165, v101, v153, v165
v_dot2_f32_bf16 v166, v101, v157, v166
v_dot2_f32_bf16 v167, v101, v161, v167
v_dot2_f32_bf16 v164, v102, v150, v164
v_dot2_f32_bf16 v165, v102, v154, v165
v_dot2_f32_bf16 v166, v102, v158, v166
v_dot2_f32_bf16 v167, v102, v162, v167
v_dot2_f32_bf16 v164, v103, v151, v164
v_dot2_f32_bf16 v165, v103, v155, v165
v_dot2_f32_bf16 v166, v103, v159, v166
v_dot2_f32_bf16 v167, v103, v163, v167
v_add_f32_dpp v168, v164, v164 row_ror:8 row_mask:0xf bank_mask:0x3
v_add_f32_dpp v169, v165, v165 row_ror:8 row_mask:0xf bank_mask:0x3
v_add_f32_dpp v168, v166, v166 row_ror:8 row_mask:0xf bank_mask:0xc
v_add_f32_dpp v169, v167, v167 row_ror:8 row_mask:0xf bank_mask:0xc
s_nop 0
v_add_f32_dpp v176, v168, v168 row_half_mirror row_mask:0xf bank_mask:0x5
v_add_f32_dpp v176, v169, v169 row_half_mirror row_mask:0xf bank_mask:0xa
s_nop 1
v_add_f32_dpp v176, v176, v176 quad_perm:[1,0,3,2] row_mask:0xf bank_mask:0xf
s_nop 1
v_add_f32_dpp v176, v176, v176 quad_perm:[2,3,0,1] row_mask:0xf bank_mask:0xf
v_dot2_f32_bf16 v164, v104, v148, 0
v_dot2_f32_bf16 v165, v104, v152, 0
v_dot2_f32_bf16 v166, v104, v156, 0
v_dot2_f32_bf16 v167, v104, v160, 0
v_dot2_f32_bf16 v164, v105, v149, v164
v_dot2_f32_bf16 v165, v105, v153, v165
v_dot2_f32_bf16 v166, v105, v157, v166
v_dot2_f32_bf16 v167, v105, v161, v167
v_dot2_f32_bf16 v164, v106, v150, v164
v_dot2_f32_bf16 v165, v106, v154, v165
v_dot2_f32_bf16 v166, v106, v158, v166
v_dot2_f32_bf16 v167, v106, v162, v167
v_dot2_f32_bf16 v164, v107, v151, v164
v_dot2_f32_bf16 v165, v107, v155, v165
v_dot2_f32_bf16 v166, v107, v159, v166
v_dot2_f32_bf16 v167, v107, v163, v167
v_add_f32_dpp v168, v164, v164 row_ror:8 row_mask:0xf bank_mask:0x3
v_add_f32_dpp v169, v165, v165 row_ror:8 row_mask:0xf bank_mask:0x3
v_add_f32_dpp v168, v166, v166 row_ror:8 row_mask:0xf bank_mask:0xc
v_add_f32_dpp v169, v167, v167 row_ror:8 row_mask:0xf bank_mask:0xc
s_nop 0
v_add_f32_dpp v177, v168, v168 row_half_mirror row_mask:0xf bank_mask:0x5
v_add_f32_dpp v177, v169, v169 row_half_mirror row_mask:0xf bank_mask:0xa
s_nop 1
v_add_f32_dpp v177, v177, v177 quad_perm:[1,0,3,2] row_mask:0xf bank_mask:0xf
s_nop 1
v_add_f32_dpp v177, v177, v177 quad_perm:[2,3,0,1] row_mask:0xf bank_mask:0xf
v_dot2_f32_bf16 v164, v108, v148, 0
v_dot2_f32_bf16 v165, v108, v152, 0
v_dot2_f32_bf16 v166, v108, v156, 0
v_dot2_f32_bf16 v167, v108, v160, 0
v_dot2_f32_bf16 v164, v109, v149, v164
v_dot2_f32_bf16 v165, v109, v153, v165
v_dot2_f32_bf16 v166, v109, v157, v166
v_dot2_f32_bf16 v167, v109, v161, v167
v_dot2_f32_bf16 v164, v110, v150, v164
v_dot2_f32_bf16 v165, v110, v154, v165
v_dot2_f32_bf16 v166, v110, v158, v166
v_dot2_f32_bf16 v167, v110, v162, v167
v_dot2_f32_bf16 v164, v111, v151, v164
v_dot2_f32_bf16 v165, v111, v155, v165
v_dot2_f32_bf16 v166, v111, v159, v166
v_dot2_f32_bf16 v167, v111, v163, v167
v_add_f32_dpp v168, v164, v164 row_ror:8 row_mask:0xf bank_mask:0x3
v_add_f32_dpp v169, v165, v165 row_ror:8 row_mask:0xf bank_mask:0x3
v_add_f32_dpp v168, v166, v166 row_ror:8 row_mask:0xf bank_mask:0xc
v_add_f32_dpp v169, v167, v167 row_ror:8 row_mask:0xf bank_mask:0xc
s_nop 0
v_add_f32_dpp v178, v168, v168 row_half_mirror row_mask:0xf bank_mask:0x5
v_add_f32_dpp v178, v169, v169 row_half_mirror row_mask:0xf bank_mask:0xa
s_nop 1
v_add_f32_dpp v178, v178, v178 quad_perm:[1,0,3,2] row_mask:0xf bank_mask:0xf
s_nop 1
v_add_f32_dpp v178, v178, v178 quad_perm:[2,3,0,1] row_mask:0xf bank_mask:0xf
v_dot2_f32_bf16 v164, v112, v148, 0
v_dot2_f32_bf16 v165, v112, v152, 0
v_dot2_f32_bf16 v166, v112, v156, 0
v_dot2_f32_bf16 v167, v112, v160, 0
v_dot2_f32_bf16 v164, v113, v149, v164
v_dot2_f32_bf16 v165, v113, v153, v165
v_dot2_f32_bf16 v166, v113, v157, v166
v_dot2_f32_bf16 v167, v113, v161, v167
v_dot2_f32_bf16 v164, v114, v150, v164
v_dot2_f32_bf16 v165, v114, v154, v165
v_dot2_f32_bf16 v166, v114, v158, v166
v_dot2_f32_bf16 v167, v114, v162, v167
v_dot2_f32_bf16 v164, v115, v151, v164
v_dot2_f32_bf16 v165, v115, v155, v165
v_dot2_f32_bf16 v166, v115, v159, v166
v_dot2_f32_bf16 v167, v115, v163, v167
v_add_f32_dpp v168, v164, v164 row_ror:8 row_mask:0xf bank_mask:0x3
v_add_f32_dpp v169, v165, v165 row_ror:8 row_mask:0xf bank_mask:0x3
v_add_f32_dpp v168, v166, v166 row_ror:8 row_mask:0xf bank_mask:0xc
v_add_f32_dpp v169, v167, v167 row_ror:8 row_mask:0xf bank_mask:0xc
s_nop 0
v_add_f32_dpp v179, v168, v168 row_half_mirror row_mask:0xf bank_mask:0x5
v_add_f32_dpp v179, v169, v169 row_half_mirror row_mask:0xf bank_mask:0xa
s_nop 1
v_add_f32_dpp v179, v179, v179 quad_perm:[1,0,3,2] row_mask:0xf bank_mask:0xf
s_nop 1
v_add_f32_dpp v179, v179, v179 quad_perm:[2,3,0,1] row_mask:0xf bank_mask:0xf
v_dot2_f32_bf16 v164, v116, v148, 0
v_dot2_f32_bf16 v165, v116, v152, 0
v_dot2_f32_bf16 v166, v116, v156, 0
v_dot2_f32_bf16 v167, v116, v160, 0
v_dot2_f32_bf16 v164, v117, v149, v164
v_dot2_f32_bf16 v165, v117, v153, v165
v_dot2_f32_bf16 v166, v117, v157, v166
v_dot2_f32_bf16 v167, v117, v161, v167
v_dot2_f32_bf16 v164, v118, v150, v164
v_dot2_f32_bf16 v165, v118, v154, v165
v_dot2_f32_bf16 v166, v118, v158, v166
v_dot2_f32_bf16 v167, v118, v162, v167
v_dot2_f32_bf16 v164, v119, v151, v164
v_dot2_f32_bf16 v165, v119, v155, v165
v_dot2_f32_bf16 v166, v119, v159, v166
v_dot2_f32_bf16 v167, v119, v163, v167
v_add_f32_dpp v168, v164, v164 row_ror:8 row_mask:0xf bank_mask:0x3
v_add_f32_dpp v169, v165, v165 row_ror:8 row_mask:0xf bank_mask:0x3
v_add_f32_dpp v168, v166, v166 row_ror:8 row_mask:0xf bank_mask:0xc
v_add_f32_dpp v169, v167, v167 row_ror:8 row_mask:0xf bank_mask:0xc
s_nop 0
v_add_f32_dpp v180, v168, v168 row_half_mirror row_mask:0xf bank_mask:0x5
v_add_f32_dpp v180, v169, v169 row_half_mirror row_mask:0xf bank_mask:0xa
s_nop 1
v_add_f32_dpp v180, v180, v180 quad_perm:[1,0,3,2] row_mask:0xf bank_mask:0xf
s_nop 1
v_add_f32_dpp v180, v180, v180 quad_perm:[2,3,0,1] row_mask:0xf bank_mask:0xf
v_dot2_f32_bf16 v164, v120, v148, 0
v_dot2_f32_bf16 v165, v120, v152, 0
v_dot2_f32_bf16 v166, v120, v156, 0
v_dot2_f32_bf16 v167, v120, v160, 0
v_dot2_f32_bf16 v164, v121, v149, v164
v_dot2_f32_bf16 v165, v121, v153, v165
v_dot2_f32_bf16 v166, v121, v157, v166
v_dot2_f32_bf16 v167, v121, v161, v167
v_dot2_f32_bf16 v164, v122, v150, v164
v_dot2_f32_bf16 v165, v122, v154, v165
v_dot2_f32_bf16 v166, v122, v158, v166
v_dot2_f32_bf16 v167, v122, v162, v167
v_dot2_f32_bf16 v164, v123, v151, v164
v_dot2_f32_bf16 v165, v123, v155, v165
v_dot2_f32_bf16 v166, v123, v159, v166
v_dot2_f32_bf16 v167, v123, v163, v167
v_add_f32_dpp v168, v164, v164 row_ror:8 row_mask:0xf bank_mask:0x3
v_add_f32_dpp v169, v165, v165 row_ror:8 row_mask:0xf bank_mask:0x3
v_add_f32_dpp v168, v166, v166 row_ror:8 row_mask:0xf bank_mask:0xc
v_add_f32_dpp v169, v167, v167 row_ror:8 row_mask:0xf bank_mask:0xc
s_nop 0
v_add_f32_dpp v181, v168, v168 row_half_mirror row_mask:0xf bank_mask:0x5
v_add_f32_dpp v181, v169, v169 row_half_mirror row_mask:0xf bank_mask:0xa
s_nop 1
v_add_f32_dpp v181, v181, v181 quad_perm:[1,0,3,2] row_mask:0xf bank_mask:0xf
s_nop 1
v_add_f32_dpp v181, v181, v181 quad_perm:[2,3,0,1] row_mask:0xf bank_mask:0xf
v_dot2_f32_bf16 v164, v124, v148, 0
v_dot2_f32_bf16 v165, v124, v152, 0
v_dot2_f32_bf16 v166, v124, v156, 0
v_dot2_f32_bf16 v167, v124, v160, 0
v_dot2_f32_bf16 v164, v125, v149, v164
v_dot2_f32_bf16 v165, v125, v153, v165
v_dot2_f32_bf16 v166, v125, v157, v166
v_dot2_f32_bf16 v167, v125, v161, v167
v_dot2_f32_bf16 v164, v126, v150, v164
v_dot2_f32_bf16 v165, v126, v154, v165
v_dot2_f32_bf16 v166, v126, v158, v166
v_dot2_f32_bf16 v167, v126, v162, v167
v_dot2_f32_bf16 v164, v127, v151, v164
v_dot2_f32_bf16 v165, v127, v155, v165
v_dot2_f32_bf16 v166, v127, v159, v166
v_dot2_f32_bf16 v167, v127, v163, v167
v_add_f32_dpp v168, v164, v164 row_ror:8 row_mask:0xf bank_mask:0x3
v_add_f32_dpp v169, v165, v165 row_ror:8 row_mask:0xf bank_mask:0x3
v_add_f32_dpp v168, v166, v166 row_ror:8 row_mask:0xf bank_mask:0xc
v_add_f32_dpp v169, v167, v167 row_ror:8 row_mask:0xf bank_mask:0xc
s_nop 0
v_add_f32_dpp v182, v168, v168 row_half_mirror row_mask:0xf bank_mask:0x5
v_add_f32_dpp v182, v169, v169 row_half_mirror row_mask:0xf bank_mask:0xa
s_nop 1
v_add_f32_dpp v182, v182, v182 quad_perm:[1,0,3,2] row_mask:0xf bank_mask:0xf
s_nop 1
v_add_f32_dpp v182, v182, v182 quad_perm:[2,3,0,1] row_mask:0xf bank_mask:0xf
v_dot2_f32_bf16 v164, v128, v148, 0
v_dot2_f32_bf16 v165, v128, v152, 0
v_dot2_f32_bf16 v166, v128, v156, 0
v_dot2_f32_bf16 v167, v128, v160, 0
v_dot2_f32_bf16 v164, v129, v149, v164
v_dot2_f32_bf16 v165, v129, v153, v165
v_dot2_f32_bf16 v166, v129, v157, v166
v_dot2_f32_bf16 v167, v129, v161, v167
v_dot2_f32_bf16 v164, v130, v150, v164
v_dot2_f32_bf16 v165, v130, v154, v165
v_dot2_f32_bf16 v166, v130, v158, v166
v_dot2_f32_bf16 v167, v130, v162, v167
v_dot2_f32_bf16 v164, v131, v151, v164
v_dot2_f32_bf16 v165, v131, v155, v165
v_dot2_f32_bf16 v166, v131, v159, v166
v_dot2_f32_bf16 v167, v131, v163, v167
v_add_f32_dpp v168, v164, v164 row_ror:8 row_mask:0xf bank_mask:0x3
v_add_f32_dpp v169, v165, v165 row_ror:8 row_mask:0xf bank_mask:0x3
v_add_f32_dpp v168, v166, v166 row_ror:8 row_mask:0xf bank_mask:0xc
v_add_f32_dpp v169, v167, v167 row_ror:8 row_mask:0xf bank_mask:0xc
s_nop 0
v_add_f32_dpp v183, v168, v168 row_half_mirror row_mask:0xf bank_mask:0x5
v_add_f32_dpp v183, v169, v169 row_half_mirror row_mask:0xf bank_mask:0xa
s_nop 1
v_add_f32_dpp v183, v183, v183 quad_perm:[1,0,3,2] row_mask:0xf bank_mask:0xf
s_nop 1
v_add_f32_dpp v183, v183, v183 quad_perm:[2,3,0,1] row_mask:0xf bank_mask:0xf
v_dot2_f32_bf16 v164, v132, v148, 0
v_dot2_f32_bf16 v165, v132, v152, 0
v_dot2_f32_bf16 v166, v132, v156, 0
v_dot2_f32_bf16 v167, v132, v160, 0
v_dot2_f32_bf16 v164, v133, v149, v164
v_dot2_f32_bf16 v165, v133, v153, v165
v_dot2_f32_bf16 v166, v133, v157, v166
v_dot2_f32_bf16 v167, v133, v161, v167
v_dot2_f32_bf16 v164, v134, v150, v164
v_dot2_f32_bf16 v165, v134, v154, v165
v_dot2_f32_bf16 v166, v134, v158, v166
v_dot2_f32_bf16 v167, v134, v162, v167
v_dot2_f32_bf16 v164, v135, v151, v164
v_dot2_f32_bf16 v165, v135, v155, v165
v_dot2_f32_bf16 v166, v135, v159, v166
v_dot2_f32_bf16 v167, v135, v163, v167
v_add_f32_dpp v168, v164, v164 row_ror:8 row_mask:0xf bank_mask:0x3
v_add_f32_dpp v169, v165, v165 row_ror:8 row_mask:0xf bank_mask:0x3
v_add_f32_dpp v168, v166, v166 row_ror:8 row_mask:0xf bank_mask:0xc
v_add_f32_dpp v169, v167, v167 row_ror:8 row_mask:0xf bank_mask:0xc
s_nop 0
v_add_f32_dpp v184, v168, v168 row_half_mirror row_mask:0xf bank_mask:0x5
v_add_f32_dpp v184, v169, v169 row_half_mirror row_mask:0xf bank_mask:0xa
s_nop 1
v_add_f32_dpp v184, v184, v184 quad_perm:[1,0,3,2] row_mask:0xf bank_mask:0xf
s_nop 1
v_add_f32_dpp v184, v184, v184 quad_perm:[2,3,0,1] row_mask:0xf bank_mask:0xf
v_dot2_f32_bf16 v164, v136, v148, 0
v_dot2_f32_bf16 v165, v136, v152, 0
v_dot2_f32_bf16 v166, v136, v156, 0
v_dot2_f32_bf16 v167, v136, v160, 0
v_dot2_f32_bf16 v164, v137, v149, v164
v_dot2_f32_bf16 v165, v137, v153, v165
v_dot2_f32_bf16 v166, v137, v157, v166
v_dot2_f32_bf16 v167, v137, v161, v167
v_dot2_f32_bf16 v164, v138, v150, v164
v_dot2_f32_bf16 v165, v138, v154, v165
v_dot2_f32_bf16 v166, v138, v158, v166
v_dot2_f32_bf16 v167, v138, v162, v167
v_dot2_f32_bf16 v164, v139, v151, v164
v_dot2_f32_bf16 v165, v139, v155, v165
v_dot2_f32_bf16 v166, v139, v159, v166
v_dot2_f32_bf16 v167, v139, v163, v167
v_add_f32_dpp v168, v164, v164 row_ror:8 row_mask:0xf bank_mask:0x3
v_add_f32_dpp v169, v165, v165 row_ror:8 row_mask:0xf bank_mask:0x3
v_add_f32_dpp v168, v166, v166 row_ror:8 row_mask:0xf bank_mask:0xc
v_add_f32_dpp v169, v167, v167 row_ror:8 row_mask:0xf bank_mask:0xc
s_nop 0
v_add_f32_dpp v185, v168, v168 row_half_mirror row_mask:0xf bank_mask:0x5
v_add_f32_dpp v185, v169, v169 row_half_mirror row_mask:0xf bank_mask:0xa
s_nop 1
v_add_f32_dpp v185, v185, v185 quad_perm:[1,0,3,2] row_mask:0xf bank_mask:0xf
s_nop 1
v_add_f32_dpp v185, v185, v185 quad_perm:[2,3,0,1] row_mask:0xf bank_mask:0xf
v_dot2_f32_bf16 v164, v140, v148, 0
v_dot2_f32_bf16 v165, v140, v152, 0
v_dot2_f32_bf16 v166, v140, v156, 0
v_dot2_f32_bf16 v167, v140, v160, 0
v_dot2_f32_bf16 v164, v141, v149, v164
v_dot2_f32_bf16 v165, v141, v153, v165
v_dot2_f32_bf16 v166, v141, v157, v166
v_dot2_f32_bf16 v167, v141, v161, v167
v_dot2_f32_bf16 v164, v142, v150, v164
v_dot2_f32_bf16 v165, v142, v154, v165
v_dot2_f32_bf16 v166, v142, v158, v166
v_dot2_f32_bf16 v167, v142, v162, v167
v_dot2_f32_bf16 v164, v143, v151, v164
v_dot2_f32_bf16 v165, v143, v155, v165
v_dot2_f32_bf16 v166, v143, v159, v166
v_dot2_f32_bf16 v167, v143, v163, v167
v_add_f32_dpp v168, v164, v164 row_ror:8 row_mask:0xf bank_mask:0x3
v_add_f32_dpp v169, v165, v165 row_ror:8 row_mask:0xf bank_mask:0x3
v_add_f32_dpp v168, v166, v166 row_ror:8 row_mask:0xf bank_mask:0xc
v_add_f32_dpp v169, v167, v167 row_ror:8 row_mask:0xf bank_mask:0xc
s_nop 0
v_add_f32_dpp v186, v168, v168 row_half_mirror row_mask:0xf bank_mask:0x5
v_add_f32_dpp v186, v169, v169 row_half_mirror row_mask:0xf bank_mask:0xa
s_nop 1
v_add_f32_dpp v186, v186, v186 quad_perm:[1,0,3,2] row_mask:0xf bank_mask:0xf
s_nop 1
v_add_f32_dpp v186, v186, v186 quad_perm:[2,3,0,1] row_mask:0xf bank_mask:0xf
v_dot2_f32_bf16 v164, v144, v148, 0
v_dot2_f32_bf16 v165, v144, v152, 0
v_dot2_f32_bf16 v166, v144, v156, 0
v_dot2_f32_bf16 v167, v144, v160, 0
v_dot2_f32_bf16 v164, v145, v149, v164
v_dot2_f32_bf16 v165, v145, v153, v165
v_dot2_f32_bf16 v166, v145, v157, v166
v_dot2_f32_bf16 v167, v145, v161, v167
v_dot2_f32_bf16 v164, v146, v150, v164
v_dot2_f32_bf16 v165, v146, v154, v165
v_dot2_f32_bf16 v166, v146, v158, v166
v_dot2_f32_bf16 v167, v146, v162, v167
v_dot2_f32_bf16 v164, v147, v151, v164
v_dot2_f32_bf16 v165, v147, v155, v165
v_dot2_f32_bf16 v166, v147, v159, v166
v_dot2_f32_bf16 v167, v147, v163, v167
v_add_f32_dpp v168, v164, v164 row_ror:8 row_mask:0xf bank_mask:0x3
v_add_f32_dpp v169, v165, v165 row_ror:8 row_mask:0xf bank_mask:0x3
v_add_f32_dpp v168, v166, v166 row_ror:8 row_mask:0xf bank_mask:0xc
v_add_f32_dpp v169, v167, v167 row_ror:8 row_mask:0xf bank_mask:0xc
s_nop 0
v_add_f32_dpp v187, v168, v168 row_half_mirror row_mask:0xf bank_mask:0x5
v_add_f32_dpp v187, v169, v169 row_half_mirror row_mask:0xf bank_mask:0xa
s_nop 1
v_add_f32_dpp v187, v187, v187 quad_perm:[1,0,3,2] row_mask:0xf bank_mask:0xf
s_nop 1
v_add_f32_dpp v187, v187, v187 quad_perm:[2,3,0,1] row_mask:0xf bank_mask:0xf
v_cvt_pk_bf16_f32 v188, v172, v173
v_cvt_pk_bf16_f32 v189, v174, v175
v_cvt_pk_bf16_f32 v190, v176, v177
v_cvt_pk_bf16_f32 v191, v178, v179
v_cvt_pk_bf16_f32 v192, v180, v181
v_cvt_pk_bf16_f32 v193, v182, v183
v_cvt_pk_bf16_f32 v194, v184, v185
v_cvt_pk_bf16_f32 v195, v186, v187
v_bfe_u32 v5, v1, 2, 2
v_lshlrev_b32 v5, 15, v5
v_lshl_add_u32 v5, v9, 5, v5
s_lshl_b32 s6, s4, 10
s_lshl_b32 s7, s8, 9
s_add_u32 s6, s6, s7
s_lshl_b32 s7, s3, 7
s_add_u32 s6, s6, s7
s_add_u32 s6, s6, 0
s_mov_b32 exec_lo, 0x11111111
s_mov_b32 exec_hi, 0x11111111
buffer_store_dwordx4 v[188:191], v5, s[64:67], s6 offen sc1
buffer_store_dwordx4 v[192:195], v5, s[64:67], s6 offen offset:16 sc1
s_mov_b64 exec, -1
s_waitcnt vmcnt(0) lgkmcnt(0)
s_barrier
s_cmp_lg_u32 s3, 0
s_cbranch_scc1 L_sig_13
v_mov_b32 v5, 1
s_mov_b64 exec, 1
buffer_atomic_add v5, off, s[68:71], 0 offset:0
s_mov_b64 exec, -1
L_sig_13:
s_lshl_b32 s6, s3, 4
v_add_u32 v5, s6, v8
v_mul_u32_u24 v5, 1088, v5
v_lshl_add_u32 v194, v9, 4, v5
v_add_u32 v195, 69632, v194
v_lshrrev_b32 v5, 5, v1
v_lshlrev_b32 v5, 3, v5
v_bfe_u32 v6, v1, 2, 2
v_add_u32 v5, v5, v6
v_mul_u32_u24 v5, 1088, v5
v_and_b32 v6, 1, v9
v_lshl_add_u32 v5, v6, 5, v5
v_and_b32 v6, 3, v1
v_lshl_add_u32 v5, v6, 3, v5
s_lshl_b32 s6, s3, 8
v_add_u32 v196, s6, v5
v_add_u32 v197, 69632, v196
v_lshlrev_b32 v199, 4, v8
v_add_u32 v199, 143360, v199
s_lshl_b32 s6, s3, 2
v_add_u32 v198, s6, v199
v_and_b32 v5, 31, v1
v_lshlrev_b32 v200, 4, v5
v_add_u32 v200, 143360, v200
v_lshlrev_b32 v202, 5, v5
v_lshrrev_b32 v6, 5, v1
v_lshl_add_u32 v202, v6, 4, v202
v_add_u32 v202, 139264, v202
v_lshlrev_b32 v201, 5, v8
v_lshl_add_u32 v201, v9, 3, v201
s_lshl_b32 s6, s3, 10
s_add_u32 s6, s6, 139264
v_add_u32 v201, s6, v201
v_lshlrev_b32 v203, 10, v8
v_lshl_add_u32 v203, v9, 4, v203
v_mov_b32 v185, 0x3e0293ee
v_mov_b32 v176, 0xff800000
v_mov_b32 v177, 0xff800000
v_mov_b32 v178, 0xff800000
v_mov_b32 v180, 0
v_mov_b32 v181, 0
s_cmp_lg_u32 s3, 0
s_cbranch_scc1 L_polld_15
s_mov_b32 s7, 20000
L_poll_14:
buffer_load_dword v5, off, s[68:71], 0 offset:0 sc1
s_waitcnt vmcnt(0)
v_readfirstlane_b32 s6, v5
s_cmp_ge_u32 s6, 64
s_cbranch_scc1 L_polld_15
s_sleep 8
s_sub_u32 s7, s7, 1
s_cmp_lg_u32 s7, 0
s_cbranch_scc1 L_poll_14
L_polld_15:
s_barrier
s_lshl_b32 s6, s10, 15
s_add_u32 s6, s6, 0
buffer_load_dwordx4 a[0:3], v203, s[64:67], s6 offen offset:0 sc1
buffer_load_dwordx4 a[4:7], v203, s[64:67], s6 offen offset:64 sc1
buffer_load_dwordx4 a[8:11], v203, s[64:67], s6 offen offset:128 sc1
buffer_load_dwordx4 a[12:15], v203, s[64:67], s6 offen offset:192 sc1
buffer_load_dwordx4 a[16:19], v203, s[64:67], s6 offen offset:256 sc1
buffer_load_dwordx4 a[20:23], v203, s[64:67], s6 offen offset:320 sc1
buffer_load_dwordx4 a[24:27], v203, s[64:67], s6 offen offset:384 sc1
buffer_load_dwordx4 a[28:31], v203, s[64:67], s6 offen offset:448 sc1
buffer_load_dwordx4 a[32:35], v203, s[64:67], s6 offen offset:512 sc1
buffer_load_dwordx4 a[36:39], v203, s[64:67], s6 offen offset:576 sc1
buffer_load_dwordx4 a[40:43], v203, s[64:67], s6 offen offset:640 sc1
buffer_load_dwordx4 a[44:47], v203, s[64:67], s6 offen offset:704 sc1
buffer_load_dwordx4 a[48:51], v203, s[64:67], s6 offen offset:768 sc1
buffer_load_dwordx4 a[52:55], v203, s[64:67], s6 offen offset:832 sc1
buffer_load_dwordx4 a[56:59], v203, s[64:67], s6 offen offset:896 sc1
buffer_load_dwordx4 a[60:63], v203, s[64:67], s6 offen offset:960 sc1
s_lshl_b32 s6, s10, 15
s_add_u32 s6, s6, 16384
buffer_load_dwordx4 a[64:67], v203, s[64:67], s6 offen offset:0 sc1
buffer_load_dwordx4 a[68:71], v203, s[64:67], s6 offen offset:64 sc1
buffer_load_dwordx4 a[72:75], v203, s[64:67], s6 offen offset:128 sc1
buffer_load_dwordx4 a[76:79], v203, s[64:67], s6 offen offset:192 sc1
buffer_load_dwordx4 a[80:83], v203, s[64:67], s6 offen offset:256 sc1
buffer_load_dwordx4 a[84:87], v203, s[64:67], s6 offen offset:320 sc1
buffer_load_dwordx4 a[88:91], v203, s[64:67], s6 offen offset:384 sc1
buffer_load_dwordx4 a[92:95], v203, s[64:67], s6 offen offset:448 sc1
buffer_load_dwordx4 a[96:99], v203, s[64:67], s6 offen offset:512 sc1
buffer_load_dwordx4 a[100:103], v203, s[64:67], s6 offen offset:576 sc1
buffer_load_dwordx4 a[104:107], v203, s[64:67], s6 offen offset:640 sc1
buffer_load_dwordx4 a[108:111], v203, s[64:67], s6 offen offset:704 sc1
buffer_load_dwordx4 a[112:115], v203, s[64:67], s6 offen offset:768 sc1
buffer_load_dwordx4 a[116:119], v203, s[64:67], s6 offen offset:832 sc1
buffer_load_dwordx4 a[120:123], v203, s[64:67], s6 offen offset:896 sc1
buffer_load_dwordx4 a[124:127], v203, s[64:67], s6 offen offset:960 sc1
s_waitcnt vmcnt(0)
ds_read_b128 v[84:87], v194 offset:0
ds_read_b128 v[88:91], v194 offset:64
ds_read_b128 v[92:95], v194 offset:128
ds_read_b128 v[96:99], v194 offset:192
ds_read_b128 v[100:103], v194 offset:256
ds_read_b128 v[104:107], v194 offset:320
ds_read_b128 v[108:111], v194 offset:384
ds_read_b128 v[112:115], v194 offset:448
ds_read_b128 v[116:119], v194 offset:512
ds_read_b128 v[120:123], v194 offset:576
ds_read_b128 v[124:127], v194 offset:640
ds_read_b128 v[128:131], v194 offset:704
ds_read_b128 v[132:135], v194 offset:768
ds_read_b128 v[136:139], v194 offset:832
ds_read_b128 v[140:143], v194 offset:896
ds_read_b128 v[144:147], v194 offset:960
s_waitcnt lgkmcnt(15)
v_mfma_f32_16x16x32_bf16 v[76:79], v[84:87], a[0:3], 0
v_mfma_f32_16x16x32_bf16 v[80:83], v[84:87], a[64:67], 0
s_waitcnt lgkmcnt(14)
v_mfma_f32_16x16x32_bf16 v[76:79], v[88:91], a[4:7], v[76:79]
v_mfma_f32_16x16x32_bf16 v[80:83], v[88:91], a[68:71], v[80:83]
s_waitcnt lgkmcnt(13)
v_mfma_f32_16x16x32_bf16 v[76:79], v[92:95], a[8:11], v[76:79]
v_mfma_f32_16x16x32_bf16 v[80:83], v[92:95], a[72:75], v[80:83]
s_waitcnt lgkmcnt(12)
v_mfma_f32_16x16x32_bf16 v[76:79], v[96:99], a[12:15], v[76:79]
v_mfma_f32_16x16x32_bf16 v[80:83], v[96:99], a[76:79], v[80:83]
s_waitcnt lgkmcnt(11)
v_mfma_f32_16x16x32_bf16 v[76:79], v[100:103], a[16:19], v[76:79]
v_mfma_f32_16x16x32_bf16 v[80:83], v[100:103], a[80:83], v[80:83]
s_waitcnt lgkmcnt(10)
v_mfma_f32_16x16x32_bf16 v[76:79], v[104:107], a[20:23], v[76:79]
v_mfma_f32_16x16x32_bf16 v[80:83], v[104:107], a[84:87], v[80:83]
s_waitcnt lgkmcnt(9)
v_mfma_f32_16x16x32_bf16 v[76:79], v[108:111], a[24:27], v[76:79]
v_mfma_f32_16x16x32_bf16 v[80:83], v[108:111], a[88:91], v[80:83]
s_waitcnt lgkmcnt(8)
v_mfma_f32_16x16x32_bf16 v[76:79], v[112:115], a[28:31], v[76:79]
v_mfma_f32_16x16x32_bf16 v[80:83], v[112:115], a[92:95], v[80:83]
s_waitcnt lgkmcnt(7)
v_mfma_f32_16x16x32_bf16 v[76:79], v[116:119], a[32:35], v[76:79]
v_mfma_f32_16x16x32_bf16 v[80:83], v[116:119], a[96:99], v[80:83]
s_waitcnt lgkmcnt(6)
v_mfma_f32_16x16x32_bf16 v[76:79], v[120:123], a[36:39], v[76:79]
v_mfma_f32_16x16x32_bf16 v[80:83], v[120:123], a[100:103], v[80:83]
s_waitcnt lgkmcnt(5)
v_mfma_f32_16x16x32_bf16 v[76:79], v[124:127], a[40:43], v[76:79]
v_mfma_f32_16x16x32_bf16 v[80:83], v[124:127], a[104:107], v[80:83]
s_waitcnt lgkmcnt(4)
v_mfma_f32_16x16x32_bf16 v[76:79], v[128:131], a[44:47], v[76:79]
v_mfma_f32_16x16x32_bf16 v[80:83], v[128:131], a[108:111], v[80:83]
s_waitcnt lgkmcnt(3)
v_mfma_f32_16x16x32_bf16 v[76:79], v[132:135], a[48:51], v[76:79]
v_mfma_f32_16x16x32_bf16 v[80:83], v[132:135], a[112:115], v[80:83]
s_waitcnt lgkmcnt(2)
v_mfma_f32_16x16x32_bf16 v[76:79], v[136:139], a[52:55], v[76:79]
v_mfma_f32_16x16x32_bf16 v[80:83], v[136:139], a[116:119], v[80:83]
s_waitcnt lgkmcnt(1)
v_mfma_f32_16x16x32_bf16 v[76:79], v[140:143], a[56:59], v[76:79]
v_mfma_f32_16x16x32_bf16 v[80:83], v[140:143], a[120:123], v[80:83]
s_waitcnt lgkmcnt(0)
v_mfma_f32_16x16x32_bf16 v[76:79], v[144:147], a[60:63], v[76:79]
v_mfma_f32_16x16x32_bf16 v[80:83], v[144:147], a[124:127], v[80:83]
s_nop 6
v_max_f32 v190, v76, v77
v_max3_f32 v190, v190, v78, v79
v_mov_b32 v192, v190
s_nop 1
v_permlane16_swap_b32 v190, v192
v_max_f32 v190, v190, v192
v_mov_b32 v192, v190
s_nop 1
v_permlane32_swap_b32 v190, v192
v_max_f32 v190, v190, v192
ds_write_b32 v198, v190 offset:0
v_max_f32 v191, v80, v81
v_max3_f32 v191, v191, v82, v83
v_mov_b32 v192, v191
s_nop 1
v_permlane16_swap_b32 v191, v192
v_max_f32 v191, v191, v192
v_mov_b32 v192, v191
s_nop 1
v_permlane32_swap_b32 v191, v192
v_max_f32 v191, v191, v192
ds_write_b32 v198, v191 offset:256
s_waitcnt lgkmcnt(0)
s_barrier
ds_read_b128 v[164:167], v199
ds_read_b128 v[168:171], v199 offset:256
ds_read_b128 v[172:175], v200
s_waitcnt lgkmcnt(0)
v_max_f32 v164, v164, v165
v_max3_f32 v164, v164, v166, v167
v_mul_f32 v164, v164, v185
v_max_f32 v164, v164, v176
v_sub_f32 v182, v176, v164
v_exp_f32 v182, v182
v_mov_b32 v176, v164
v_max_f32 v168, v168, v169
v_max3_f32 v168, v168, v170, v171
v_mul_f32 v168, v168, v185
v_max_f32 v168, v168, v177
v_sub_f32 v183, v177, v168
v_exp_f32 v183, v183
v_mov_b32 v177, v168
v_max_f32 v172, v172, v173
v_max3_f32 v172, v172, v174, v175
v_mul_f32 v172, v172, v185
v_max_f32 v172, v172, v178
v_sub_f32 v184, v178, v172
v_exp_f32 v184, v184
v_mov_b32 v178, v172
v_fma_f32 v76, v76, v185, -v176
v_fma_f32 v77, v77, v185, -v176
v_fma_f32 v78, v78, v185, -v176
v_fma_f32 v79, v79, v185, -v176
v_exp_f32 v76, v76
v_exp_f32 v77, v77
v_exp_f32 v78, v78
v_exp_f32 v79, v79
v_mul_f32 v180, v180, v182
v_cvt_pk_bf16_f32 v186, v76, v77
v_cvt_pk_bf16_f32 v187, v78, v79
ds_write_b64 v201, v[186:187] offset:0
v_add_f32 v180, v180, v76
v_add_f32 v180, v180, v77
v_add_f32 v180, v180, v78
v_add_f32 v180, v180, v79
v_fma_f32 v80, v80, v185, -v177
v_fma_f32 v81, v81, v185, -v177
v_fma_f32 v82, v82, v185, -v177
v_fma_f32 v83, v83, v185, -v177
v_exp_f32 v80, v80
v_exp_f32 v81, v81
v_exp_f32 v82, v82
v_exp_f32 v83, v83
v_mul_f32 v181, v181, v183
v_cvt_pk_bf16_f32 v188, v80, v81
v_cvt_pk_bf16_f32 v189, v82, v83
ds_write_b64 v201, v[188:189] offset:512
v_add_f32 v181, v181, v80
v_add_f32 v181, v181, v81
v_add_f32 v181, v181, v82
v_add_f32 v181, v181, v83
s_waitcnt lgkmcnt(0)
s_barrier
ds_read_b128 v[148:151], v202 offset:0
ds_read_b128 v[152:155], v202 offset:1024
ds_read_b128 v[156:159], v202 offset:2048
ds_read_b128 v[160:163], v202 offset:3072
ds_read_b64_tr_b16 v[84:85], v196 offset:0
ds_read_b64_tr_b16 v[86:87], v196 offset:4352
ds_read_b64_tr_b16 v[88:89], v196 offset:64
ds_read_b64_tr_b16 v[90:91], v196 offset:4416
ds_read_b64_tr_b16 v[92:93], v196 offset:128
ds_read_b64_tr_b16 v[94:95], v196 offset:4480
ds_read_b64_tr_b16 v[96:97], v196 offset:192
ds_read_b64_tr_b16 v[98:99], v196 offset:4544
ds_read_b64_tr_b16 v[100:101], v196 offset:17408
ds_read_b64_tr_b16 v[102:103], v196 offset:21760
ds_read_b64_tr_b16 v[104:105], v196 offset:17472
ds_read_b64_tr_b16 v[106:107], v196 offset:21824
ds_read_b64_tr_b16 v[108:109], v196 offset:17536
ds_read_b64_tr_b16 v[110:111], v196 offset:21888
ds_read_b64_tr_b16 v[112:113], v196 offset:17600
ds_read_b64_tr_b16 v[114:115], v196 offset:21952
ds_read_b64_tr_b16 v[116:117], v196 offset:34816
ds_read_b64_tr_b16 v[118:119], v196 offset:39168
ds_read_b64_tr_b16 v[120:121], v196 offset:34880
ds_read_b64_tr_b16 v[122:123], v196 offset:39232
ds_read_b64_tr_b16 v[124:125], v196 offset:34944
ds_read_b64_tr_b16 v[126:127], v196 offset:39296
ds_read_b64_tr_b16 v[128:129], v196 offset:35008
ds_read_b64_tr_b16 v[130:131], v196 offset:39360
ds_read_b64_tr_b16 v[132:133], v196 offset:52224
ds_read_b64_tr_b16 v[134:135], v196 offset:56576
ds_read_b64_tr_b16 v[136:137], v196 offset:52288
ds_read_b64_tr_b16 v[138:139], v196 offset:56640
ds_read_b64_tr_b16 v[140:141], v196 offset:52352
ds_read_b64_tr_b16 v[142:143], v196 offset:56704
ds_read_b64_tr_b16 v[144:145], v196 offset:52416
ds_read_b64_tr_b16 v[146:147], v196 offset:56768
s_waitcnt lgkmcnt(15)
v_mfma_f32_32x32x16_bf16 v[12:27], v[84:87], v[148:151], 0
v_mfma_f32_32x32x16_bf16 v[28:43], v[88:91], v[148:151], 0
v_mfma_f32_32x32x16_bf16 v[44:59], v[92:95], v[148:151], 0
v_mfma_f32_32x32x16_bf16 v[60:75], v[96:99], v[148:151], 0
s_waitcnt lgkmcnt(15)
v_mfma_f32_32x32x16_bf16 v[12:27], v[100:103], v[152:155], v[12:27]
v_mfma_f32_32x32x16_bf16 v[28:43], v[104:107], v[152:155], v[28:43]
v_mfma_f32_32x32x16_bf16 v[44:59], v[108:111], v[152:155], v[44:59]
v_mfma_f32_32x32x16_bf16 v[60:75], v[112:115], v[152:155], v[60:75]
s_waitcnt lgkmcnt(8)
v_mfma_f32_32x32x16_bf16 v[12:27], v[116:119], v[156:159], v[12:27]
v_mfma_f32_32x32x16_bf16 v[28:43], v[120:123], v[156:159], v[28:43]
v_mfma_f32_32x32x16_bf16 v[44:59], v[124:127], v[156:159], v[44:59]
v_mfma_f32_32x32x16_bf16 v[60:75], v[128:131], v[156:159], v[60:75]
s_waitcnt lgkmcnt(0)
v_mfma_f32_32x32x16_bf16 v[12:27], v[132:135], v[160:163], v[12:27]
v_mfma_f32_32x32x16_bf16 v[28:43], v[136:139], v[160:163], v[28:43]
v_mfma_f32_32x32x16_bf16 v[44:59], v[140:143], v[160:163], v[44:59]
v_mfma_f32_32x32x16_bf16 v[60:75], v[144:147], v[160:163], v[60:75]
ds_read_b128 v[84:87], v195 offset:0
ds_read_b128 v[88:91], v195 offset:64
ds_read_b128 v[92:95], v195 offset:128
ds_read_b128 v[96:99], v195 offset:192
ds_read_b128 v[100:103], v195 offset:256
ds_read_b128 v[104:107], v195 offset:320
ds_read_b128 v[108:111], v195 offset:384
ds_read_b128 v[112:115], v195 offset:448
ds_read_b128 v[116:119], v195 offset:512
ds_read_b128 v[120:123], v195 offset:576
ds_read_b128 v[124:127], v195 offset:640
ds_read_b128 v[128:131], v195 offset:704
ds_read_b128 v[132:135], v195 offset:768
ds_read_b128 v[136:139], v195 offset:832
ds_read_b128 v[140:143], v195 offset:896
ds_read_b128 v[144:147], v195 offset:960
s_waitcnt lgkmcnt(15)
v_mfma_f32_16x16x32_bf16 v[76:79], v[84:87], a[0:3], 0
v_mfma_f32_16x16x32_bf16 v[80:83], v[84:87], a[64:67], 0
s_waitcnt lgkmcnt(14)
v_mfma_f32_16x16x32_bf16 v[76:79], v[88:91], a[4:7], v[76:79]
v_mfma_f32_16x16x32_bf16 v[80:83], v[88:91], a[68:71], v[80:83]
s_waitcnt lgkmcnt(13)
v_mfma_f32_16x16x32_bf16 v[76:79], v[92:95], a[8:11], v[76:79]
v_mfma_f32_16x16x32_bf16 v[80:83], v[92:95], a[72:75], v[80:83]
s_waitcnt lgkmcnt(12)
v_mfma_f32_16x16x32_bf16 v[76:79], v[96:99], a[12:15], v[76:79]
v_mfma_f32_16x16x32_bf16 v[80:83], v[96:99], a[76:79], v[80:83]
s_waitcnt lgkmcnt(11)
v_mfma_f32_16x16x32_bf16 v[76:79], v[100:103], a[16:19], v[76:79]
v_mfma_f32_16x16x32_bf16 v[80:83], v[100:103], a[80:83], v[80:83]
s_waitcnt lgkmcnt(10)
v_mfma_f32_16x16x32_bf16 v[76:79], v[104:107], a[20:23], v[76:79]
v_mfma_f32_16x16x32_bf16 v[80:83], v[104:107], a[84:87], v[80:83]
s_waitcnt lgkmcnt(9)
v_mfma_f32_16x16x32_bf16 v[76:79], v[108:111], a[24:27], v[76:79]
v_mfma_f32_16x16x32_bf16 v[80:83], v[108:111], a[88:91], v[80:83]
s_waitcnt lgkmcnt(8)
v_mfma_f32_16x16x32_bf16 v[76:79], v[112:115], a[28:31], v[76:79]
v_mfma_f32_16x16x32_bf16 v[80:83], v[112:115], a[92:95], v[80:83]
s_waitcnt lgkmcnt(7)
v_mfma_f32_16x16x32_bf16 v[76:79], v[116:119], a[32:35], v[76:79]
v_mfma_f32_16x16x32_bf16 v[80:83], v[116:119], a[96:99], v[80:83]
s_waitcnt lgkmcnt(6)
v_mfma_f32_16x16x32_bf16 v[76:79], v[120:123], a[36:39], v[76:79]
v_mfma_f32_16x16x32_bf16 v[80:83], v[120:123], a[100:103], v[80:83]
s_waitcnt lgkmcnt(5)
v_mfma_f32_16x16x32_bf16 v[76:79], v[124:127], a[40:43], v[76:79]
v_mfma_f32_16x16x32_bf16 v[80:83], v[124:127], a[104:107], v[80:83]
s_waitcnt lgkmcnt(4)
v_mfma_f32_16x16x32_bf16 v[76:79], v[128:131], a[44:47], v[76:79]
v_mfma_f32_16x16x32_bf16 v[80:83], v[128:131], a[108:111], v[80:83]
s_waitcnt lgkmcnt(3)
v_mfma_f32_16x16x32_bf16 v[76:79], v[132:135], a[48:51], v[76:79]
v_mfma_f32_16x16x32_bf16 v[80:83], v[132:135], a[112:115], v[80:83]
s_waitcnt lgkmcnt(2)
v_mfma_f32_16x16x32_bf16 v[76:79], v[136:139], a[52:55], v[76:79]
v_mfma_f32_16x16x32_bf16 v[80:83], v[136:139], a[116:119], v[80:83]
s_waitcnt lgkmcnt(1)
v_mfma_f32_16x16x32_bf16 v[76:79], v[140:143], a[56:59], v[76:79]
v_mfma_f32_16x16x32_bf16 v[80:83], v[140:143], a[120:123], v[80:83]
s_waitcnt lgkmcnt(0)
v_mfma_f32_16x16x32_bf16 v[76:79], v[144:147], a[60:63], v[76:79]
v_mfma_f32_16x16x32_bf16 v[80:83], v[144:147], a[124:127], v[80:83]
s_nop 6
v_max_f32 v190, v76, v77
v_max3_f32 v190, v190, v78, v79
v_mov_b32 v192, v190
s_nop 1
v_permlane16_swap_b32 v190, v192
v_max_f32 v190, v190, v192
v_mov_b32 v192, v190
s_nop 1
v_permlane32_swap_b32 v190, v192
v_max_f32 v190, v190, v192
ds_write_b32 v198, v190 offset:0
v_max_f32 v191, v80, v81
v_max3_f32 v191, v191, v82, v83
v_mov_b32 v192, v191
s_nop 1
v_permlane16_swap_b32 v191, v192
v_max_f32 v191, v191, v192
v_mov_b32 v192, v191
s_nop 1
v_permlane32_swap_b32 v191, v192
v_max_f32 v191, v191, v192
ds_write_b32 v198, v191 offset:256
s_waitcnt lgkmcnt(0)
s_barrier
ds_read_b128 v[164:167], v199
ds_read_b128 v[168:171], v199 offset:256
ds_read_b128 v[172:175], v200
s_add_u32 m0, s12, 0
s_add_u32 s6, s13, 131072
buffer_load_dwordx4 v2, s[52:55], s6 offen nt lds
s_add_u32 m0, s12, 1088
s_add_u32 s6, s13, 132096
buffer_load_dwordx4 v2, s[52:55], s6 offen nt lds
s_add_u32 m0, s12, 2176
s_add_u32 s6, s13, 133120
buffer_load_dwordx4 v2, s[52:55], s6 offen nt lds
s_add_u32 m0, s12, 3264
s_add_u32 s6, s13, 134144
buffer_load_dwordx4 v2, s[52:55], s6 offen nt lds
s_add_u32 m0, s12, 4352
s_add_u32 s6, s13, 135168
buffer_load_dwordx4 v2, s[52:55], s6 offen nt lds
s_add_u32 m0, s12, 5440
s_add_u32 s6, s13, 136192
buffer_load_dwordx4 v2, s[52:55], s6 offen nt lds
s_add_u32 m0, s12, 6528
s_add_u32 s6, s13, 137216
buffer_load_dwordx4 v2, s[52:55], s6 offen nt lds
s_add_u32 m0, s12, 7616
s_add_u32 s6, s13, 138240
buffer_load_dwordx4 v2, s[52:55], s6 offen nt lds
s_add_u32 m0, s12, 8704
s_add_u32 s6, s13, 139264
buffer_load_dwordx4 v2, s[52:55], s6 offen nt lds
s_add_u32 m0, s12, 9792
s_add_u32 s6, s13, 140288
buffer_load_dwordx4 v2, s[52:55], s6 offen nt lds
s_add_u32 m0, s12, 10880
s_add_u32 s6, s13, 141312
buffer_load_dwordx4 v2, s[52:55], s6 offen nt lds
s_add_u32 m0, s12, 11968
s_add_u32 s6, s13, 142336
buffer_load_dwordx4 v2, s[52:55], s6 offen nt lds
s_add_u32 m0, s12, 13056
s_add_u32 s6, s13, 143360
buffer_load_dwordx4 v2, s[52:55], s6 offen nt lds
s_add_u32 m0, s12, 14144
s_add_u32 s6, s13, 144384
buffer_load_dwordx4 v2, s[52:55], s6 offen nt lds
s_add_u32 m0, s12, 15232
s_add_u32 s6, s13, 145408
buffer_load_dwordx4 v2, s[52:55], s6 offen nt lds
s_add_u32 m0, s12, 16320
s_add_u32 s6, s13, 146432
buffer_load_dwordx4 v2, s[52:55], s6 offen nt lds
s_waitcnt lgkmcnt(0)
v_max_f32 v164, v164, v165
v_max3_f32 v164, v164, v166, v167
v_mul_f32 v164, v164, v185
v_max_f32 v164, v164, v176
v_sub_f32 v182, v176, v164
v_exp_f32 v182, v182
v_mov_b32 v176, v164
v_max_f32 v168, v168, v169
v_max3_f32 v168, v168, v170, v171
v_mul_f32 v168, v168, v185
v_max_f32 v168, v168, v177
v_sub_f32 v183, v177, v168
v_exp_f32 v183, v183
v_mov_b32 v177, v168
v_max_f32 v172, v172, v173
v_max3_f32 v172, v172, v174, v175
v_mul_f32 v172, v172, v185
v_max_f32 v172, v172, v178
v_sub_f32 v184, v178, v172
v_exp_f32 v184, v184
v_mov_b32 v178, v172
v_fma_f32 v76, v76, v185, -v176
v_fma_f32 v77, v77, v185, -v176
v_fma_f32 v78, v78, v185, -v176
v_fma_f32 v79, v79, v185, -v176
v_exp_f32 v76, v76
v_exp_f32 v77, v77
v_exp_f32 v78, v78
v_exp_f32 v79, v79
v_mul_f32 v180, v180, v182
v_cvt_pk_bf16_f32 v186, v76, v77
v_cvt_pk_bf16_f32 v187, v78, v79
ds_write_b64 v201, v[186:187] offset:0
v_add_f32 v180, v180, v76
v_add_f32 v180, v180, v77
v_add_f32 v180, v180, v78
v_add_f32 v180, v180, v79
v_fma_f32 v80, v80, v185, -v177
v_fma_f32 v81, v81, v185, -v177
v_fma_f32 v82, v82, v185, -v177
v_fma_f32 v83, v83, v185, -v177
v_exp_f32 v80, v80
v_exp_f32 v81, v81
v_exp_f32 v82, v82
v_exp_f32 v83, v83
v_mul_f32 v181, v181, v183
v_cvt_pk_bf16_f32 v188, v80, v81
v_cvt_pk_bf16_f32 v189, v82, v83
ds_write_b64 v201, v[188:189] offset:512
v_add_f32 v181, v181, v80
v_add_f32 v181, v181, v81
v_add_f32 v181, v181, v82
v_add_f32 v181, v181, v83
v_mul_f32 v12, v12, v184
v_mul_f32 v13, v13, v184
v_mul_f32 v14, v14, v184
v_mul_f32 v15, v15, v184
v_mul_f32 v16, v16, v184
v_mul_f32 v17, v17, v184
v_mul_f32 v18, v18, v184
v_mul_f32 v19, v19, v184
v_mul_f32 v20, v20, v184
v_mul_f32 v21, v21, v184
v_mul_f32 v22, v22, v184
v_mul_f32 v23, v23, v184
v_mul_f32 v24, v24, v184
v_mul_f32 v25, v25, v184
v_mul_f32 v26, v26, v184
v_mul_f32 v27, v27, v184
v_mul_f32 v28, v28, v184
v_mul_f32 v29, v29, v184
v_mul_f32 v30, v30, v184
v_mul_f32 v31, v31, v184
v_mul_f32 v32, v32, v184
v_mul_f32 v33, v33, v184
v_mul_f32 v34, v34, v184
v_mul_f32 v35, v35, v184
v_mul_f32 v36, v36, v184
v_mul_f32 v37, v37, v184
v_mul_f32 v38, v38, v184
v_mul_f32 v39, v39, v184
v_mul_f32 v40, v40, v184
v_mul_f32 v41, v41, v184
v_mul_f32 v42, v42, v184
v_mul_f32 v43, v43, v184
v_mul_f32 v44, v44, v184
v_mul_f32 v45, v45, v184
v_mul_f32 v46, v46, v184
v_mul_f32 v47, v47, v184
v_mul_f32 v48, v48, v184
v_mul_f32 v49, v49, v184
v_mul_f32 v50, v50, v184
v_mul_f32 v51, v51, v184
v_mul_f32 v52, v52, v184
v_mul_f32 v53, v53, v184
v_mul_f32 v54, v54, v184
v_mul_f32 v55, v55, v184
v_mul_f32 v56, v56, v184
v_mul_f32 v57, v57, v184
v_mul_f32 v58, v58, v184
v_mul_f32 v59, v59, v184
v_mul_f32 v60, v60, v184
v_mul_f32 v61, v61, v184
v_mul_f32 v62, v62, v184
v_mul_f32 v63, v63, v184
v_mul_f32 v64, v64, v184
v_mul_f32 v65, v65, v184
v_mul_f32 v66, v66, v184
v_mul_f32 v67, v67, v184
v_mul_f32 v68, v68, v184
v_mul_f32 v69, v69, v184
v_mul_f32 v70, v70, v184
v_mul_f32 v71, v71, v184
v_mul_f32 v72, v72, v184
v_mul_f32 v73, v73, v184
v_mul_f32 v74, v74, v184
v_mul_f32 v75, v75, v184
s_waitcnt lgkmcnt(0)
s_barrier
ds_read_b128 v[148:151], v202 offset:0
ds_read_b128 v[152:155], v202 offset:1024
ds_read_b128 v[156:159], v202 offset:2048
ds_read_b128 v[160:163], v202 offset:3072
ds_read_b64_tr_b16 v[84:85], v197 offset:0
ds_read_b64_tr_b16 v[86:87], v197 offset:4352
ds_read_b64_tr_b16 v[88:89], v197 offset:64
ds_read_b64_tr_b16 v[90:91], v197 offset:4416
ds_read_b64_tr_b16 v[92:93], v197 offset:128
ds_read_b64_tr_b16 v[94:95], v197 offset:4480
ds_read_b64_tr_b16 v[96:97], v197 offset:192
ds_read_b64_tr_b16 v[98:99], v197 offset:4544
ds_read_b64_tr_b16 v[100:101], v197 offset:17408
ds_read_b64_tr_b16 v[102:103], v197 offset:21760
ds_read_b64_tr_b16 v[104:105], v197 offset:17472
ds_read_b64_tr_b16 v[106:107], v197 offset:21824
ds_read_b64_tr_b16 v[108:109], v197 offset:17536
ds_read_b64_tr_b16 v[110:111], v197 offset:21888
ds_read_b64_tr_b16 v[112:113], v197 offset:17600
ds_read_b64_tr_b16 v[114:115], v197 offset:21952
ds_read_b64_tr_b16 v[116:117], v197 offset:34816
ds_read_b64_tr_b16 v[118:119], v197 offset:39168
ds_read_b64_tr_b16 v[120:121], v197 offset:34880
ds_read_b64_tr_b16 v[122:123], v197 offset:39232
ds_read_b64_tr_b16 v[124:125], v197 offset:34944
ds_read_b64_tr_b16 v[126:127], v197 offset:39296
ds_read_b64_tr_b16 v[128:129], v197 offset:35008
ds_read_b64_tr_b16 v[130:131], v197 offset:39360
ds_read_b64_tr_b16 v[132:133], v197 offset:52224
ds_read_b64_tr_b16 v[134:135], v197 offset:56576
ds_read_b64_tr_b16 v[136:137], v197 offset:52288
ds_read_b64_tr_b16 v[138:139], v197 offset:56640
ds_read_b64_tr_b16 v[140:141], v197 offset:52352
ds_read_b64_tr_b16 v[142:143], v197 offset:56704
ds_read_b64_tr_b16 v[144:145], v197 offset:52416
ds_read_b64_tr_b16 v[146:147], v197 offset:56768
s_waitcnt lgkmcnt(15)
v_mfma_f32_32x32x16_bf16 v[12:27], v[84:87], v[148:151], v[12:27]
v_mfma_f32_32x32x16_bf16 v[28:43], v[88:91], v[148:151], v[28:43]
v_mfma_f32_32x32x16_bf16 v[44:59], v[92:95], v[148:151], v[44:59]
v_mfma_f32_32x32x16_bf16 v[60:75], v[96:99], v[148:151], v[60:75]
s_waitcnt lgkmcnt(15)
v_mfma_f32_32x32x16_bf16 v[12:27], v[100:103], v[152:155], v[12:27]
v_mfma_f32_32x32x16_bf16 v[28:43], v[104:107], v[152:155], v[28:43]
v_mfma_f32_32x32x16_bf16 v[44:59], v[108:111], v[152:155], v[44:59]
v_mfma_f32_32x32x16_bf16 v[60:75], v[112:115], v[152:155], v[60:75]
s_waitcnt lgkmcnt(8)
v_mfma_f32_32x32x16_bf16 v[12:27], v[116:119], v[156:159], v[12:27]
v_mfma_f32_32x32x16_bf16 v[28:43], v[120:123], v[156:159], v[28:43]
v_mfma_f32_32x32x16_bf16 v[44:59], v[124:127], v[156:159], v[44:59]
v_mfma_f32_32x32x16_bf16 v[60:75], v[128:131], v[156:159], v[60:75]
s_waitcnt lgkmcnt(0)
v_mfma_f32_32x32x16_bf16 v[12:27], v[132:135], v[160:163], v[12:27]
v_mfma_f32_32x32x16_bf16 v[28:43], v[136:139], v[160:163], v[28:43]
v_mfma_f32_32x32x16_bf16 v[44:59], v[140:143], v[160:163], v[44:59]
v_mfma_f32_32x32x16_bf16 v[60:75], v[144:147], v[160:163], v[60:75]
s_waitcnt vmcnt(0)
ds_read_b128 v[84:87], v194 offset:0
ds_read_b128 v[88:91], v194 offset:64
ds_read_b128 v[92:95], v194 offset:128
ds_read_b128 v[96:99], v194 offset:192
ds_read_b128 v[100:103], v194 offset:256
ds_read_b128 v[104:107], v194 offset:320
ds_read_b128 v[108:111], v194 offset:384
ds_read_b128 v[112:115], v194 offset:448
ds_read_b128 v[116:119], v194 offset:512
ds_read_b128 v[120:123], v194 offset:576
ds_read_b128 v[124:127], v194 offset:640
ds_read_b128 v[128:131], v194 offset:704
ds_read_b128 v[132:135], v194 offset:768
ds_read_b128 v[136:139], v194 offset:832
ds_read_b128 v[140:143], v194 offset:896
ds_read_b128 v[144:147], v194 offset:960
s_waitcnt lgkmcnt(15)
v_mfma_f32_16x16x32_bf16 v[76:79], v[84:87], a[0:3], 0
v_mfma_f32_16x16x32_bf16 v[80:83], v[84:87], a[64:67], 0
s_waitcnt lgkmcnt(14)
v_mfma_f32_16x16x32_bf16 v[76:79], v[88:91], a[4:7], v[76:79]
v_mfma_f32_16x16x32_bf16 v[80:83], v[88:91], a[68:71], v[80:83]
s_waitcnt lgkmcnt(13)
v_mfma_f32_16x16x32_bf16 v[76:79], v[92:95], a[8:11], v[76:79]
v_mfma_f32_16x16x32_bf16 v[80:83], v[92:95], a[72:75], v[80:83]
s_waitcnt lgkmcnt(12)
v_mfma_f32_16x16x32_bf16 v[76:79], v[96:99], a[12:15], v[76:79]
v_mfma_f32_16x16x32_bf16 v[80:83], v[96:99], a[76:79], v[80:83]
s_waitcnt lgkmcnt(11)
v_mfma_f32_16x16x32_bf16 v[76:79], v[100:103], a[16:19], v[76:79]
v_mfma_f32_16x16x32_bf16 v[80:83], v[100:103], a[80:83], v[80:83]
s_waitcnt lgkmcnt(10)
v_mfma_f32_16x16x32_bf16 v[76:79], v[104:107], a[20:23], v[76:79]
v_mfma_f32_16x16x32_bf16 v[80:83], v[104:107], a[84:87], v[80:83]
s_waitcnt lgkmcnt(9)
v_mfma_f32_16x16x32_bf16 v[76:79], v[108:111], a[24:27], v[76:79]
v_mfma_f32_16x16x32_bf16 v[80:83], v[108:111], a[88:91], v[80:83]
s_waitcnt lgkmcnt(8)
v_mfma_f32_16x16x32_bf16 v[76:79], v[112:115], a[28:31], v[76:79]
v_mfma_f32_16x16x32_bf16 v[80:83], v[112:115], a[92:95], v[80:83]
s_waitcnt lgkmcnt(7)
v_mfma_f32_16x16x32_bf16 v[76:79], v[116:119], a[32:35], v[76:79]
v_mfma_f32_16x16x32_bf16 v[80:83], v[116:119], a[96:99], v[80:83]
s_waitcnt lgkmcnt(6)
v_mfma_f32_16x16x32_bf16 v[76:79], v[120:123], a[36:39], v[76:79]
v_mfma_f32_16x16x32_bf16 v[80:83], v[120:123], a[100:103], v[80:83]
s_waitcnt lgkmcnt(5)
v_mfma_f32_16x16x32_bf16 v[76:79], v[124:127], a[40:43], v[76:79]
v_mfma_f32_16x16x32_bf16 v[80:83], v[124:127], a[104:107], v[80:83]
s_waitcnt lgkmcnt(4)
v_mfma_f32_16x16x32_bf16 v[76:79], v[128:131], a[44:47], v[76:79]
v_mfma_f32_16x16x32_bf16 v[80:83], v[128:131], a[108:111], v[80:83]
s_waitcnt lgkmcnt(3)
v_mfma_f32_16x16x32_bf16 v[76:79], v[132:135], a[48:51], v[76:79]
v_mfma_f32_16x16x32_bf16 v[80:83], v[132:135], a[112:115], v[80:83]
s_waitcnt lgkmcnt(2)
v_mfma_f32_16x16x32_bf16 v[76:79], v[136:139], a[52:55], v[76:79]
v_mfma_f32_16x16x32_bf16 v[80:83], v[136:139], a[116:119], v[80:83]
s_waitcnt lgkmcnt(1)
v_mfma_f32_16x16x32_bf16 v[76:79], v[140:143], a[56:59], v[76:79]
v_mfma_f32_16x16x32_bf16 v[80:83], v[140:143], a[120:123], v[80:83]
s_waitcnt lgkmcnt(0)
v_mfma_f32_16x16x32_bf16 v[76:79], v[144:147], a[60:63], v[76:79]
v_mfma_f32_16x16x32_bf16 v[80:83], v[144:147], a[124:127], v[80:83]
s_nop 6
v_max_f32 v190, v76, v77
v_max3_f32 v190, v190, v78, v79
v_mov_b32 v192, v190
s_nop 1
v_permlane16_swap_b32 v190, v192
v_max_f32 v190, v190, v192
v_mov_b32 v192, v190
s_nop 1
v_permlane32_swap_b32 v190, v192
v_max_f32 v190, v190, v192
ds_write_b32 v198, v190 offset:0
v_max_f32 v191, v80, v81
v_max3_f32 v191, v191, v82, v83
v_mov_b32 v192, v191
s_nop 1
v_permlane16_swap_b32 v191, v192
v_max_f32 v191, v191, v192
v_mov_b32 v192, v191
s_nop 1
v_permlane32_swap_b32 v191, v192
v_max_f32 v191, v191, v192
ds_write_b32 v198, v191 offset:256
s_waitcnt lgkmcnt(0)
s_barrier
ds_read_b128 v[164:167], v199
ds_read_b128 v[168:171], v199 offset:256
ds_read_b128 v[172:175], v200
s_add_u32 m0, s12, 69632
s_add_u32 s6, s13, 196608
buffer_load_dwordx4 v2, s[52:55], s6 offen nt lds
s_add_u32 m0, s12, 70720
s_add_u32 s6, s13, 197632
buffer_load_dwordx4 v2, s[52:55], s6 offen nt lds
s_add_u32 m0, s12, 71808
s_add_u32 s6, s13, 198656
buffer_load_dwordx4 v2, s[52:55], s6 offen nt lds
s_add_u32 m0, s12, 72896
s_add_u32 s6, s13, 199680
buffer_load_dwordx4 v2, s[52:55], s6 offen nt lds
s_add_u32 m0, s12, 73984
s_add_u32 s6, s13, 200704
buffer_load_dwordx4 v2, s[52:55], s6 offen nt lds
s_add_u32 m0, s12, 75072
s_add_u32 s6, s13, 201728
buffer_load_dwordx4 v2, s[52:55], s6 offen nt lds
s_add_u32 m0, s12, 76160
s_add_u32 s6, s13, 202752
buffer_load_dwordx4 v2, s[52:55], s6 offen nt lds
s_add_u32 m0, s12, 77248
s_add_u32 s6, s13, 203776
buffer_load_dwordx4 v2, s[52:55], s6 offen nt lds
s_add_u32 m0, s12, 78336
s_add_u32 s6, s13, 204800
buffer_load_dwordx4 v2, s[52:55], s6 offen nt lds
s_add_u32 m0, s12, 79424
s_add_u32 s6, s13, 205824
buffer_load_dwordx4 v2, s[52:55], s6 offen nt lds
s_add_u32 m0, s12, 80512
s_add_u32 s6, s13, 206848
buffer_load_dwordx4 v2, s[52:55], s6 offen nt lds
s_add_u32 m0, s12, 81600
s_add_u32 s6, s13, 207872
buffer_load_dwordx4 v2, s[52:55], s6 offen nt lds
s_add_u32 m0, s12, 82688
s_add_u32 s6, s13, 208896
buffer_load_dwordx4 v2, s[52:55], s6 offen nt lds
s_add_u32 m0, s12, 83776
s_add_u32 s6, s13, 209920
buffer_load_dwordx4 v2, s[52:55], s6 offen nt lds
s_add_u32 m0, s12, 84864
s_add_u32 s6, s13, 210944
buffer_load_dwordx4 v2, s[52:55], s6 offen nt lds
s_add_u32 m0, s12, 85952
s_add_u32 s6, s13, 211968
buffer_load_dwordx4 v2, s[52:55], s6 offen nt lds
s_waitcnt lgkmcnt(0)
v_max_f32 v164, v164, v165
v_max3_f32 v164, v164, v166, v167
v_mul_f32 v164, v164, v185
v_max_f32 v164, v164, v176
v_sub_f32 v182, v176, v164
v_exp_f32 v182, v182
v_mov_b32 v176, v164
v_max_f32 v168, v168, v169
v_max3_f32 v168, v168, v170, v171
v_mul_f32 v168, v168, v185
v_max_f32 v168, v168, v177
v_sub_f32 v183, v177, v168
v_exp_f32 v183, v183
v_mov_b32 v177, v168
v_max_f32 v172, v172, v173
v_max3_f32 v172, v172, v174, v175
v_mul_f32 v172, v172, v185
v_max_f32 v172, v172, v178
v_sub_f32 v184, v178, v172
v_exp_f32 v184, v184
v_mov_b32 v178, v172
v_fma_f32 v76, v76, v185, -v176
v_fma_f32 v77, v77, v185, -v176
v_fma_f32 v78, v78, v185, -v176
v_fma_f32 v79, v79, v185, -v176
v_exp_f32 v76, v76
v_exp_f32 v77, v77
v_exp_f32 v78, v78
v_exp_f32 v79, v79
v_mul_f32 v180, v180, v182
v_cvt_pk_bf16_f32 v186, v76, v77
v_cvt_pk_bf16_f32 v187, v78, v79
ds_write_b64 v201, v[186:187] offset:0
v_add_f32 v180, v180, v76
v_add_f32 v180, v180, v77
v_add_f32 v180, v180, v78
v_add_f32 v180, v180, v79
v_fma_f32 v80, v80, v185, -v177
v_fma_f32 v81, v81, v185, -v177
v_fma_f32 v82, v82, v185, -v177
v_fma_f32 v83, v83, v185, -v177
v_exp_f32 v80, v80
v_exp_f32 v81, v81
v_exp_f32 v82, v82
v_exp_f32 v83, v83
v_mul_f32 v181, v181, v183
v_cvt_pk_bf16_f32 v188, v80, v81
v_cvt_pk_bf16_f32 v189, v82, v83
ds_write_b64 v201, v[188:189] offset:512
v_add_f32 v181, v181, v80
v_add_f32 v181, v181, v81
v_add_f32 v181, v181, v82
v_add_f32 v181, v181, v83
v_mul_f32 v12, v12, v184
v_mul_f32 v13, v13, v184
v_mul_f32 v14, v14, v184
v_mul_f32 v15, v15, v184
v_mul_f32 v16, v16, v184
v_mul_f32 v17, v17, v184
v_mul_f32 v18, v18, v184
v_mul_f32 v19, v19, v184
v_mul_f32 v20, v20, v184
v_mul_f32 v21, v21, v184
v_mul_f32 v22, v22, v184
v_mul_f32 v23, v23, v184
v_mul_f32 v24, v24, v184
v_mul_f32 v25, v25, v184
v_mul_f32 v26, v26, v184
v_mul_f32 v27, v27, v184
v_mul_f32 v28, v28, v184
v_mul_f32 v29, v29, v184
v_mul_f32 v30, v30, v184
v_mul_f32 v31, v31, v184
v_mul_f32 v32, v32, v184
v_mul_f32 v33, v33, v184
v_mul_f32 v34, v34, v184
v_mul_f32 v35, v35, v184
v_mul_f32 v36, v36, v184
v_mul_f32 v37, v37, v184
v_mul_f32 v38, v38, v184
v_mul_f32 v39, v39, v184
v_mul_f32 v40, v40, v184
v_mul_f32 v41, v41, v184
v_mul_f32 v42, v42, v184
v_mul_f32 v43, v43, v184
v_mul_f32 v44, v44, v184
v_mul_f32 v45, v45, v184
v_mul_f32 v46, v46, v184
v_mul_f32 v47, v47, v184
v_mul_f32 v48, v48, v184
v_mul_f32 v49, v49, v184
v_mul_f32 v50, v50, v184
v_mul_f32 v51, v51, v184
v_mul_f32 v52, v52, v184
v_mul_f32 v53, v53, v184
v_mul_f32 v54, v54, v184
v_mul_f32 v55, v55, v184
v_mul_f32 v56, v56, v184
v_mul_f32 v57, v57, v184
v_mul_f32 v58, v58, v184
v_mul_f32 v59, v59, v184
v_mul_f32 v60, v60, v184
v_mul_f32 v61, v61, v184
v_mul_f32 v62, v62, v184
v_mul_f32 v63, v63, v184
v_mul_f32 v64, v64, v184
v_mul_f32 v65, v65, v184
v_mul_f32 v66, v66, v184
v_mul_f32 v67, v67, v184
v_mul_f32 v68, v68, v184
v_mul_f32 v69, v69, v184
v_mul_f32 v70, v70, v184
v_mul_f32 v71, v71, v184
v_mul_f32 v72, v72, v184
v_mul_f32 v73, v73, v184
v_mul_f32 v74, v74, v184
v_mul_f32 v75, v75, v184
s_waitcnt lgkmcnt(0)
s_barrier
ds_read_b128 v[148:151], v202 offset:0
ds_read_b128 v[152:155], v202 offset:1024
ds_read_b128 v[156:159], v202 offset:2048
ds_read_b128 v[160:163], v202 offset:3072
ds_read_b64_tr_b16 v[84:85], v196 offset:0
ds_read_b64_tr_b16 v[86:87], v196 offset:4352
ds_read_b64_tr_b16 v[88:89], v196 offset:64
ds_read_b64_tr_b16 v[90:91], v196 offset:4416
ds_read_b64_tr_b16 v[92:93], v196 offset:128
ds_read_b64_tr_b16 v[94:95], v196 offset:4480
ds_read_b64_tr_b16 v[96:97], v196 offset:192
ds_read_b64_tr_b16 v[98:99], v196 offset:4544
ds_read_b64_tr_b16 v[100:101], v196 offset:17408
ds_read_b64_tr_b16 v[102:103], v196 offset:21760
ds_read_b64_tr_b16 v[104:105], v196 offset:17472
ds_read_b64_tr_b16 v[106:107], v196 offset:21824
ds_read_b64_tr_b16 v[108:109], v196 offset:17536
ds_read_b64_tr_b16 v[110:111], v196 offset:21888
ds_read_b64_tr_b16 v[112:113], v196 offset:17600
ds_read_b64_tr_b16 v[114:115], v196 offset:21952
ds_read_b64_tr_b16 v[116:117], v196 offset:34816
ds_read_b64_tr_b16 v[118:119], v196 offset:39168
ds_read_b64_tr_b16 v[120:121], v196 offset:34880
ds_read_b64_tr_b16 v[122:123], v196 offset:39232
ds_read_b64_tr_b16 v[124:125], v196 offset:34944
ds_read_b64_tr_b16 v[126:127], v196 offset:39296
ds_read_b64_tr_b16 v[128:129], v196 offset:35008
ds_read_b64_tr_b16 v[130:131], v196 offset:39360
ds_read_b64_tr_b16 v[132:133], v196 offset:52224
ds_read_b64_tr_b16 v[134:135], v196 offset:56576
ds_read_b64_tr_b16 v[136:137], v196 offset:52288
ds_read_b64_tr_b16 v[138:139], v196 offset:56640
ds_read_b64_tr_b16 v[140:141], v196 offset:52352
ds_read_b64_tr_b16 v[142:143], v196 offset:56704
ds_read_b64_tr_b16 v[144:145], v196 offset:52416
ds_read_b64_tr_b16 v[146:147], v196 offset:56768
s_waitcnt lgkmcnt(15)
v_mfma_f32_32x32x16_bf16 v[12:27], v[84:87], v[148:151], v[12:27]
v_mfma_f32_32x32x16_bf16 v[28:43], v[88:91], v[148:151], v[28:43]
v_mfma_f32_32x32x16_bf16 v[44:59], v[92:95], v[148:151], v[44:59]
v_mfma_f32_32x32x16_bf16 v[60:75], v[96:99], v[148:151], v[60:75]
s_waitcnt lgkmcnt(15)
v_mfma_f32_32x32x16_bf16 v[12:27], v[100:103], v[152:155], v[12:27]
v_mfma_f32_32x32x16_bf16 v[28:43], v[104:107], v[152:155], v[28:43]
v_mfma_f32_32x32x16_bf16 v[44:59], v[108:111], v[152:155], v[44:59]
v_mfma_f32_32x32x16_bf16 v[60:75], v[112:115], v[152:155], v[60:75]
s_waitcnt lgkmcnt(8)
v_mfma_f32_32x32x16_bf16 v[12:27], v[116:119], v[156:159], v[12:27]
v_mfma_f32_32x32x16_bf16 v[28:43], v[120:123], v[156:159], v[28:43]
v_mfma_f32_32x32x16_bf16 v[44:59], v[124:127], v[156:159], v[44:59]
v_mfma_f32_32x32x16_bf16 v[60:75], v[128:131], v[156:159], v[60:75]
s_waitcnt lgkmcnt(0)
v_mfma_f32_32x32x16_bf16 v[12:27], v[132:135], v[160:163], v[12:27]
v_mfma_f32_32x32x16_bf16 v[28:43], v[136:139], v[160:163], v[28:43]
v_mfma_f32_32x32x16_bf16 v[44:59], v[140:143], v[160:163], v[44:59]
v_mfma_f32_32x32x16_bf16 v[60:75], v[144:147], v[160:163], v[60:75]
s_waitcnt vmcnt(0)
ds_read_b128 v[84:87], v195 offset:0
ds_read_b128 v[88:91], v195 offset:64
ds_read_b128 v[92:95], v195 offset:128
ds_read_b128 v[96:99], v195 offset:192
ds_read_b128 v[100:103], v195 offset:256
ds_read_b128 v[104:107], v195 offset:320
ds_read_b128 v[108:111], v195 offset:384
ds_read_b128 v[112:115], v195 offset:448
ds_read_b128 v[116:119], v195 offset:512
ds_read_b128 v[120:123], v195 offset:576
ds_read_b128 v[124:127], v195 offset:640
ds_read_b128 v[128:131], v195 offset:704
ds_read_b128 v[132:135], v195 offset:768
ds_read_b128 v[136:139], v195 offset:832
ds_read_b128 v[140:143], v195 offset:896
ds_read_b128 v[144:147], v195 offset:960
s_waitcnt lgkmcnt(15)
v_mfma_f32_16x16x32_bf16 v[76:79], v[84:87], a[0:3], 0
v_mfma_f32_16x16x32_bf16 v[80:83], v[84:87], a[64:67], 0
s_waitcnt lgkmcnt(14)
v_mfma_f32_16x16x32_bf16 v[76:79], v[88:91], a[4:7], v[76:79]
v_mfma_f32_16x16x32_bf16 v[80:83], v[88:91], a[68:71], v[80:83]
s_waitcnt lgkmcnt(13)
v_mfma_f32_16x16x32_bf16 v[76:79], v[92:95], a[8:11], v[76:79]
v_mfma_f32_16x16x32_bf16 v[80:83], v[92:95], a[72:75], v[80:83]
s_waitcnt lgkmcnt(12)
v_mfma_f32_16x16x32_bf16 v[76:79], v[96:99], a[12:15], v[76:79]
v_mfma_f32_16x16x32_bf16 v[80:83], v[96:99], a[76:79], v[80:83]
s_waitcnt lgkmcnt(11)
v_mfma_f32_16x16x32_bf16 v[76:79], v[100:103], a[16:19], v[76:79]
v_mfma_f32_16x16x32_bf16 v[80:83], v[100:103], a[80:83], v[80:83]
s_waitcnt lgkmcnt(10)
v_mfma_f32_16x16x32_bf16 v[76:79], v[104:107], a[20:23], v[76:79]
v_mfma_f32_16x16x32_bf16 v[80:83], v[104:107], a[84:87], v[80:83]
s_waitcnt lgkmcnt(9)
v_mfma_f32_16x16x32_bf16 v[76:79], v[108:111], a[24:27], v[76:79]
v_mfma_f32_16x16x32_bf16 v[80:83], v[108:111], a[88:91], v[80:83]
s_waitcnt lgkmcnt(8)
v_mfma_f32_16x16x32_bf16 v[76:79], v[112:115], a[28:31], v[76:79]
v_mfma_f32_16x16x32_bf16 v[80:83], v[112:115], a[92:95], v[80:83]
s_waitcnt lgkmcnt(7)
v_mfma_f32_16x16x32_bf16 v[76:79], v[116:119], a[32:35], v[76:79]
v_mfma_f32_16x16x32_bf16 v[80:83], v[116:119], a[96:99], v[80:83]
s_waitcnt lgkmcnt(6)
v_mfma_f32_16x16x32_bf16 v[76:79], v[120:123], a[36:39], v[76:79]
v_mfma_f32_16x16x32_bf16 v[80:83], v[120:123], a[100:103], v[80:83]
s_waitcnt lgkmcnt(5)
v_mfma_f32_16x16x32_bf16 v[76:79], v[124:127], a[40:43], v[76:79]
v_mfma_f32_16x16x32_bf16 v[80:83], v[124:127], a[104:107], v[80:83]
s_waitcnt lgkmcnt(4)
v_mfma_f32_16x16x32_bf16 v[76:79], v[128:131], a[44:47], v[76:79]
v_mfma_f32_16x16x32_bf16 v[80:83], v[128:131], a[108:111], v[80:83]
s_waitcnt lgkmcnt(3)
v_mfma_f32_16x16x32_bf16 v[76:79], v[132:135], a[48:51], v[76:79]
v_mfma_f32_16x16x32_bf16 v[80:83], v[132:135], a[112:115], v[80:83]
s_waitcnt lgkmcnt(2)
v_mfma_f32_16x16x32_bf16 v[76:79], v[136:139], a[52:55], v[76:79]
v_mfma_f32_16x16x32_bf16 v[80:83], v[136:139], a[116:119], v[80:83]
s_waitcnt lgkmcnt(1)
v_mfma_f32_16x16x32_bf16 v[76:79], v[140:143], a[56:59], v[76:79]
v_mfma_f32_16x16x32_bf16 v[80:83], v[140:143], a[120:123], v[80:83]
s_waitcnt lgkmcnt(0)
v_mfma_f32_16x16x32_bf16 v[76:79], v[144:147], a[60:63], v[76:79]
v_mfma_f32_16x16x32_bf16 v[80:83], v[144:147], a[124:127], v[80:83]
s_nop 6
v_max_f32 v190, v76, v77
v_max3_f32 v190, v190, v78, v79
v_mov_b32 v192, v190
s_nop 1
v_permlane16_swap_b32 v190, v192
v_max_f32 v190, v190, v192
v_mov_b32 v192, v190
s_nop 1
v_permlane32_swap_b32 v190, v192
v_max_f32 v190, v190, v192
ds_write_b32 v198, v190 offset:0
v_max_f32 v191, v80, v81
v_max3_f32 v191, v191, v82, v83
v_mov_b32 v192, v191
s_nop 1
v_permlane16_swap_b32 v191, v192
v_max_f32 v191, v191, v192
v_mov_b32 v192, v191
s_nop 1
v_permlane32_swap_b32 v191, v192
v_max_f32 v191, v191, v192
ds_write_b32 v198, v191 offset:256
s_waitcnt lgkmcnt(0)
s_barrier
ds_read_b128 v[164:167], v199
ds_read_b128 v[168:171], v199 offset:256
ds_read_b128 v[172:175], v200
s_waitcnt lgkmcnt(0)
v_max_f32 v164, v164, v165
v_max3_f32 v164, v164, v166, v167
v_mul_f32 v164, v164, v185
v_max_f32 v164, v164, v176
v_sub_f32 v182, v176, v164
v_exp_f32 v182, v182
v_mov_b32 v176, v164
v_max_f32 v168, v168, v169
v_max3_f32 v168, v168, v170, v171
v_mul_f32 v168, v168, v185
v_max_f32 v168, v168, v177
v_sub_f32 v183, v177, v168
v_exp_f32 v183, v183
v_mov_b32 v177, v168
v_max_f32 v172, v172, v173
v_max3_f32 v172, v172, v174, v175
v_mul_f32 v172, v172, v185
v_max_f32 v172, v172, v178
v_sub_f32 v184, v178, v172
v_exp_f32 v184, v184
v_mov_b32 v178, v172
v_fma_f32 v76, v76, v185, -v176
v_fma_f32 v77, v77, v185, -v176
v_fma_f32 v78, v78, v185, -v176
v_fma_f32 v79, v79, v185, -v176
v_exp_f32 v76, v76
v_exp_f32 v77, v77
v_exp_f32 v78, v78
v_exp_f32 v79, v79
v_mul_f32 v180, v180, v182
v_cvt_pk_bf16_f32 v186, v76, v77
v_cvt_pk_bf16_f32 v187, v78, v79
ds_write_b64 v201, v[186:187] offset:0
v_add_f32 v180, v180, v76
v_add_f32 v180, v180, v77
v_add_f32 v180, v180, v78
v_add_f32 v180, v180, v79
v_fma_f32 v80, v80, v185, -v177
v_fma_f32 v81, v81, v185, -v177
v_fma_f32 v82, v82, v185, -v177
v_fma_f32 v83, v83, v185, -v177
v_exp_f32 v80, v80
v_exp_f32 v81, v81
v_exp_f32 v82, v82
v_exp_f32 v83, v83
v_mul_f32 v181, v181, v183
v_cvt_pk_bf16_f32 v188, v80, v81
v_cvt_pk_bf16_f32 v189, v82, v83
ds_write_b64 v201, v[188:189] offset:512
v_add_f32 v181, v181, v80
v_add_f32 v181, v181, v81
v_add_f32 v181, v181, v82
v_add_f32 v181, v181, v83
v_mul_f32 v12, v12, v184
v_mul_f32 v13, v13, v184
v_mul_f32 v14, v14, v184
v_mul_f32 v15, v15, v184
v_mul_f32 v16, v16, v184
v_mul_f32 v17, v17, v184
v_mul_f32 v18, v18, v184
v_mul_f32 v19, v19, v184
v_mul_f32 v20, v20, v184
v_mul_f32 v21, v21, v184
v_mul_f32 v22, v22, v184
v_mul_f32 v23, v23, v184
v_mul_f32 v24, v24, v184
v_mul_f32 v25, v25, v184
v_mul_f32 v26, v26, v184
v_mul_f32 v27, v27, v184
v_mul_f32 v28, v28, v184
v_mul_f32 v29, v29, v184
v_mul_f32 v30, v30, v184
v_mul_f32 v31, v31, v184
v_mul_f32 v32, v32, v184
v_mul_f32 v33, v33, v184
v_mul_f32 v34, v34, v184
v_mul_f32 v35, v35, v184
v_mul_f32 v36, v36, v184
v_mul_f32 v37, v37, v184
v_mul_f32 v38, v38, v184
v_mul_f32 v39, v39, v184
v_mul_f32 v40, v40, v184
v_mul_f32 v41, v41, v184
v_mul_f32 v42, v42, v184
v_mul_f32 v43, v43, v184
v_mul_f32 v44, v44, v184
v_mul_f32 v45, v45, v184
v_mul_f32 v46, v46, v184
v_mul_f32 v47, v47, v184
v_mul_f32 v48, v48, v184
v_mul_f32 v49, v49, v184
v_mul_f32 v50, v50, v184
v_mul_f32 v51, v51, v184
v_mul_f32 v52, v52, v184
v_mul_f32 v53, v53, v184
v_mul_f32 v54, v54, v184
v_mul_f32 v55, v55, v184
v_mul_f32 v56, v56, v184
v_mul_f32 v57, v57, v184
v_mul_f32 v58, v58, v184
v_mul_f32 v59, v59, v184
v_mul_f32 v60, v60, v184
v_mul_f32 v61, v61, v184
v_mul_f32 v62, v62, v184
v_mul_f32 v63, v63, v184
v_mul_f32 v64, v64, v184
v_mul_f32 v65, v65, v184
v_mul_f32 v66, v66, v184
v_mul_f32 v67, v67, v184
v_mul_f32 v68, v68, v184
v_mul_f32 v69, v69, v184
v_mul_f32 v70, v70, v184
v_mul_f32 v71, v71, v184
v_mul_f32 v72, v72, v184
v_mul_f32 v73, v73, v184
v_mul_f32 v74, v74, v184
v_mul_f32 v75, v75, v184
s_waitcnt lgkmcnt(0)
s_barrier
ds_read_b128 v[148:151], v202 offset:0
ds_read_b128 v[152:155], v202 offset:1024
ds_read_b128 v[156:159], v202 offset:2048
ds_read_b128 v[160:163], v202 offset:3072
ds_read_b64_tr_b16 v[84:85], v197 offset:0
ds_read_b64_tr_b16 v[86:87], v197 offset:4352
ds_read_b64_tr_b16 v[88:89], v197 offset:64
ds_read_b64_tr_b16 v[90:91], v197 offset:4416
ds_read_b64_tr_b16 v[92:93], v197 offset:128
ds_read_b64_tr_b16 v[94:95], v197 offset:4480
ds_read_b64_tr_b16 v[96:97], v197 offset:192
ds_read_b64_tr_b16 v[98:99], v197 offset:4544
ds_read_b64_tr_b16 v[100:101], v197 offset:17408
ds_read_b64_tr_b16 v[102:103], v197 offset:21760
ds_read_b64_tr_b16 v[104:105], v197 offset:17472
ds_read_b64_tr_b16 v[106:107], v197 offset:21824
ds_read_b64_tr_b16 v[108:109], v197 offset:17536
ds_read_b64_tr_b16 v[110:111], v197 offset:21888
ds_read_b64_tr_b16 v[112:113], v197 offset:17600
ds_read_b64_tr_b16 v[114:115], v197 offset:21952
ds_read_b64_tr_b16 v[116:117], v197 offset:34816
ds_read_b64_tr_b16 v[118:119], v197 offset:39168
ds_read_b64_tr_b16 v[120:121], v197 offset:34880
ds_read_b64_tr_b16 v[122:123], v197 offset:39232
ds_read_b64_tr_b16 v[124:125], v197 offset:34944
ds_read_b64_tr_b16 v[126:127], v197 offset:39296
ds_read_b64_tr_b16 v[128:129], v197 offset:35008
ds_read_b64_tr_b16 v[130:131], v197 offset:39360
ds_read_b64_tr_b16 v[132:133], v197 offset:52224
ds_read_b64_tr_b16 v[134:135], v197 offset:56576
ds_read_b64_tr_b16 v[136:137], v197 offset:52288
ds_read_b64_tr_b16 v[138:139], v197 offset:56640
ds_read_b64_tr_b16 v[140:141], v197 offset:52352
ds_read_b64_tr_b16 v[142:143], v197 offset:56704
ds_read_b64_tr_b16 v[144:145], v197 offset:52416
ds_read_b64_tr_b16 v[146:147], v197 offset:56768
s_waitcnt lgkmcnt(15)
v_mfma_f32_32x32x16_bf16 v[12:27], v[84:87], v[148:151], v[12:27]
v_mfma_f32_32x32x16_bf16 v[28:43], v[88:91], v[148:151], v[28:43]
v_mfma_f32_32x32x16_bf16 v[44:59], v[92:95], v[148:151], v[44:59]
v_mfma_f32_32x32x16_bf16 v[60:75], v[96:99], v[148:151], v[60:75]
s_waitcnt lgkmcnt(15)
v_mfma_f32_32x32x16_bf16 v[12:27], v[100:103], v[152:155], v[12:27]
v_mfma_f32_32x32x16_bf16 v[28:43], v[104:107], v[152:155], v[28:43]
v_mfma_f32_32x32x16_bf16 v[44:59], v[108:111], v[152:155], v[44:59]
v_mfma_f32_32x32x16_bf16 v[60:75], v[112:115], v[152:155], v[60:75]
s_waitcnt lgkmcnt(8)
v_mfma_f32_32x32x16_bf16 v[12:27], v[116:119], v[156:159], v[12:27]
v_mfma_f32_32x32x16_bf16 v[28:43], v[120:123], v[156:159], v[28:43]
v_mfma_f32_32x32x16_bf16 v[44:59], v[124:127], v[156:159], v[44:59]
v_mfma_f32_32x32x16_bf16 v[60:75], v[128:131], v[156:159], v[60:75]
s_waitcnt lgkmcnt(0)
v_mfma_f32_32x32x16_bf16 v[12:27], v[132:135], v[160:163], v[12:27]
v_mfma_f32_32x32x16_bf16 v[28:43], v[136:139], v[160:163], v[28:43]
v_mfma_f32_32x32x16_bf16 v[44:59], v[140:143], v[160:163], v[44:59]
v_mfma_f32_32x32x16_bf16 v[60:75], v[144:147], v[160:163], v[60:75]
v_mov_b32 v192, v180
s_nop 1
v_permlane16_swap_b32 v180, v192
v_add_f32 v180, v180, v192
v_mov_b32 v192, v180
s_nop 1
v_permlane32_swap_b32 v180, v192
v_add_f32 v180, v180, v192
ds_write_b32 v198, v180 offset:512
v_mov_b32 v192, v181
s_nop 1
v_permlane16_swap_b32 v181, v192
v_add_f32 v181, v181, v192
v_mov_b32 v192, v181
s_nop 1
v_permlane32_swap_b32 v181, v192
v_add_f32 v181, v181, v192
ds_write_b32 v198, v181 offset:768
v_and_b32 v5, 31, v1
v_mul_u32_u24 v5, 1040, v5
v_lshrrev_b32 v6, 5, v1
v_lshl_add_u32 v5, v6, 3, v5
s_lshl_b32 s6, s3, 8
v_add_u32 v5, s6, v5
v_cvt_pk_bf16_f32 v84, v12, v13
v_cvt_pk_bf16_f32 v85, v14, v15
ds_write_b64 v5, v[84:85] offset:0
v_cvt_pk_bf16_f32 v86, v16, v17
v_cvt_pk_bf16_f32 v87, v18, v19
ds_write_b64 v5, v[86:87] offset:16
v_cvt_pk_bf16_f32 v88, v20, v21
v_cvt_pk_bf16_f32 v89, v22, v23
ds_write_b64 v5, v[88:89] offset:32
v_cvt_pk_bf16_f32 v90, v24, v25
v_cvt_pk_bf16_f32 v91, v26, v27
ds_write_b64 v5, v[90:91] offset:48
v_cvt_pk_bf16_f32 v92, v28, v29
v_cvt_pk_bf16_f32 v93, v30, v31
ds_write_b64 v5, v[92:93] offset:64
v_cvt_pk_bf16_f32 v94, v32, v33
v_cvt_pk_bf16_f32 v95, v34, v35
ds_write_b64 v5, v[94:95] offset:80
v_cvt_pk_bf16_f32 v96, v36, v37
v_cvt_pk_bf16_f32 v97, v38, v39
ds_write_b64 v5, v[96:97] offset:96
v_cvt_pk_bf16_f32 v98, v40, v41
v_cvt_pk_bf16_f32 v99, v42, v43
ds_write_b64 v5, v[98:99] offset:112
v_cvt_pk_bf16_f32 v100, v44, v45
v_cvt_pk_bf16_f32 v101, v46, v47
ds_write_b64 v5, v[100:101] offset:128
v_cvt_pk_bf16_f32 v102, v48, v49
v_cvt_pk_bf16_f32 v103, v50, v51
ds_write_b64 v5, v[102:103] offset:144
v_cvt_pk_bf16_f32 v104, v52, v53
v_cvt_pk_bf16_f32 v105, v54, v55
ds_write_b64 v5, v[104:105] offset:160
v_cvt_pk_bf16_f32 v106, v56, v57
v_cvt_pk_bf16_f32 v107, v58, v59
ds_write_b64 v5, v[106:107] offset:176
v_cvt_pk_bf16_f32 v108, v60, v61
v_cvt_pk_bf16_f32 v109, v62, v63
ds_write_b64 v5, v[108:109] offset:192
v_cvt_pk_bf16_f32 v110, v64, v65
v_cvt_pk_bf16_f32 v111, v66, v67
ds_write_b64 v5, v[110:111] offset:208
v_cvt_pk_bf16_f32 v112, v68, v69
v_cvt_pk_bf16_f32 v113, v70, v71
ds_write_b64 v5, v[112:113] offset:224
v_cvt_pk_bf16_f32 v114, v72, v73
v_cvt_pk_bf16_f32 v115, v74, v75
ds_write_b64 v5, v[114:115] offset:240
s_waitcnt lgkmcnt(0)
s_barrier
s_mul_i32 s6, s3, 8320
v_add_u32 v5, s6, v2
ds_read_b128 v[116:119], v5 offset:0
ds_read_b128 v[120:123], v5 offset:1040
ds_read_b128 v[124:127], v5 offset:2080
ds_read_b128 v[128:131], v5 offset:3120
ds_read_b128 v[132:135], v5 offset:4160
ds_read_b128 v[136:139], v5 offset:5200
ds_read_b128 v[140:143], v5 offset:6240
ds_read_b128 v[144:147], v5 offset:7280
ds_read_b128 v[164:167], v200 offset:512
s_lshl_b32 s7, s3, 19
s_lshl_b32 s6, s9, 10
s_add_u32 s7, s7, s6
s_add_u32 s7, s7, 1048576
s_waitcnt lgkmcnt(8)
s_add_u32 s6, s7, 0
buffer_store_dwordx4 v[116:119], v2, s[64:67], s6 offen sc1
s_waitcnt lgkmcnt(7)
s_add_u32 s6, s7, 65536
buffer_store_dwordx4 v[120:123], v2, s[64:67], s6 offen sc1
s_waitcnt lgkmcnt(6)
s_add_u32 s6, s7, 131072
buffer_store_dwordx4 v[124:127], v2, s[64:67], s6 offen sc1
s_waitcnt lgkmcnt(5)
s_add_u32 s6, s7, 196608
buffer_store_dwordx4 v[128:131], v2, s[64:67], s6 offen sc1
s_waitcnt lgkmcnt(4)
s_add_u32 s6, s7, 262144
buffer_store_dwordx4 v[132:135], v2, s[64:67], s6 offen sc1
s_waitcnt lgkmcnt(3)
s_add_u32 s6, s7, 327680
buffer_store_dwordx4 v[136:139], v2, s[64:67], s6 offen sc1
s_waitcnt lgkmcnt(2)
s_add_u32 s6, s7, 393216
buffer_store_dwordx4 v[140:143], v2, s[64:67], s6 offen sc1
s_waitcnt lgkmcnt(1)
s_add_u32 s6, s7, 458752
buffer_store_dwordx4 v[144:147], v2, s[64:67], s6 offen sc1
s_waitcnt lgkmcnt(0)
v_add_f32 v164, v164, v165
v_add_f32 v166, v166, v167
v_add_f32 v187, v164, v166
v_mov_b32 v186, v178
v_lshlrev_b32 v5, 9, v1
s_lshl_b32 s6, s9, 3
s_add_u32 s6, s6, 262144
s_cmp_lg_u32 s3, 0
s_cbranch_scc1 L_nops_16
s_mov_b64 exec, 0xffffffff
buffer_store_dwordx2 v[186:187], v5, s[64:67], s6 offen sc1
s_mov_b64 exec, -1
L_nops_16:
s_waitcnt vmcnt(0) lgkmcnt(0)
s_barrier
s_cmp_lg_u32 s3, 0
s_cbranch_scc1 L_sig_17
v_mov_b32 v5, 1
s_mov_b64 exec, 1
buffer_atomic_add v5, off, s[68:71], 0 offset:64
s_mov_b64 exec, -1
L_sig_17:
s_mul_i32 s6, s9, 73728
s_add_u32 s60, s36, s6
s_addc_u32 s61, s37, 0
s_mov_b32 s62, 73728
s_mov_b32 s63, 0x20000
s_lshl_b32 s6, s9, 7
s_sub_u32 s7, 4194304, s6
s_add_u32 s76, s34, s6
s_addc_u32 s77, s35, 0
s_mov_b32 s78, s7
s_mov_b32 s79, 0x20000
v_lshrrev_b32 v5, 3, v1
v_and_b32 v6, 7, v1
v_and_b32 v7, 2, v5
v_xor_b32 v6, v6, v7
v_lshlrev_b32 v5, 13, v5
v_lshl_add_u32 v152, v6, 4, v5
v_xor_b32 v6, 4, v6
v_lshl_add_u32 v153, v6, 4, v5
s_lshl_b32 s12, s3, 14
s_lshl_b32 s13, s3, 20
s_add_u32 m0, s12, 73728
s_add_u32 s6, s13, 0
buffer_load_dwordx4 v152, s[76:79], s6 offen nt lds
s_add_u32 m0, s12, 74752
s_add_u32 s6, s13, 65536
buffer_load_dwordx4 v153, s[76:79], s6 offen nt lds
s_add_u32 m0, s12, 75776
s_add_u32 s6, s13, 131072
buffer_load_dwordx4 v152, s[76:79], s6 offen nt lds
s_add_u32 m0, s12, 76800
s_add_u32 s6, s13, 196608
buffer_load_dwordx4 v153, s[76:79], s6 offen nt lds
s_add_u32 m0, s12, 77824
s_add_u32 s6, s13, 262144
buffer_load_dwordx4 v152, s[76:79], s6 offen nt lds
s_add_u32 m0, s12, 78848
s_add_u32 s6, s13, 327680
buffer_load_dwordx4 v153, s[76:79], s6 offen nt lds
s_add_u32 m0, s12, 79872
s_add_u32 s6, s13, 393216
buffer_load_dwordx4 v152, s[76:79], s6 offen nt lds
s_add_u32 m0, s12, 80896
s_add_u32 s6, s13, 458752
buffer_load_dwordx4 v153, s[76:79], s6 offen nt lds
s_add_u32 m0, s12, 81920
s_add_u32 s6, s13, 524288
buffer_load_dwordx4 v152, s[76:79], s6 offen nt lds
s_add_u32 m0, s12, 82944
s_add_u32 s6, s13, 589824
buffer_load_dwordx4 v153, s[76:79], s6 offen nt lds
s_add_u32 m0, s12, 83968
s_add_u32 s6, s13, 655360
buffer_load_dwordx4 v152, s[76:79], s6 offen nt lds
s_add_u32 m0, s12, 84992
s_add_u32 s6, s13, 720896
buffer_load_dwordx4 v153, s[76:79], s6 offen nt lds
s_add_u32 m0, s12, 86016
s_add_u32 s6, s13, 786432
buffer_load_dwordx4 v152, s[76:79], s6 offen nt lds
s_add_u32 m0, s12, 87040
s_add_u32 s6, s13, 851968
buffer_load_dwordx4 v153, s[76:79], s6 offen nt lds
s_add_u32 m0, s12, 88064
s_add_u32 s6, s13, 917504
buffer_load_dwordx4 v152, s[76:79], s6 offen nt lds
s_add_u32 m0, s12, 89088
s_add_u32 s6, s13, 983040
buffer_load_dwordx4 v153, s[76:79], s6 offen nt lds
s_mul_i32 s12, s3, 18432
s_add_u32 s6, s12, 0
s_mov_b32 m0, s6
s_nop 0
buffer_load_dwordx4 v2, s[60:63], s6 offen nt lds
s_add_u32 s6, s12, 1024
s_mov_b32 m0, s6
s_nop 0
buffer_load_dwordx4 v2, s[60:63], s6 offen nt lds
s_add_u32 s6, s12, 2048
s_mov_b32 m0, s6
s_nop 0
buffer_load_dwordx4 v2, s[60:63], s6 offen nt lds
s_add_u32 s6, s12, 3072
s_mov_b32 m0, s6
s_nop 0
buffer_load_dwordx4 v2, s[60:63], s6 offen nt lds
s_add_u32 s6, s12, 4096
s_mov_b32 m0, s6
s_nop 0
buffer_load_dwordx4 v2, s[60:63], s6 offen nt lds
s_add_u32 s6, s12, 5120
s_mov_b32 m0, s6
s_nop 0
buffer_load_dwordx4 v2, s[60:63], s6 offen nt lds
s_add_u32 s6, s12, 6144
s_mov_b32 m0, s6
s_nop 0
buffer_load_dwordx4 v2, s[60:63], s6 offen nt lds
s_add_u32 s6, s12, 7168
s_mov_b32 m0, s6
s_nop 0
buffer_load_dwordx4 v2, s[60:63], s6 offen nt lds
s_add_u32 s6, s12, 8192
s_mov_b32 m0, s6
s_nop 0
buffer_load_dwordx4 v2, s[60:63], s6 offen nt lds
s_add_u32 s6, s12, 9216
s_mov_b32 m0, s6
s_nop 0
buffer_load_dwordx4 v2, s[60:63], s6 offen nt lds
s_add_u32 s6, s12, 10240
s_mov_b32 m0, s6
s_nop 0
buffer_load_dwordx4 v2, s[60:63], s6 offen nt lds
s_add_u32 s6, s12, 11264
s_mov_b32 m0, s6
s_nop 0
buffer_load_dwordx4 v2, s[60:63], s6 offen nt lds
s_add_u32 s6, s12, 12288
s_mov_b32 m0, s6
s_nop 0
buffer_load_dwordx4 v2, s[60:63], s6 offen nt lds
s_add_u32 s6, s12, 13312
s_mov_b32 m0, s6
s_nop 0
buffer_load_dwordx4 v2, s[60:63], s6 offen nt lds
s_add_u32 s6, s12, 14336
s_mov_b32 m0, s6
s_nop 0
buffer_load_dwordx4 v2, s[60:63], s6 offen nt lds
s_add_u32 s6, s12, 15360
s_mov_b32 m0, s6
s_nop 0
buffer_load_dwordx4 v2, s[60:63], s6 offen nt lds
s_add_u32 s6, s12, 16384
s_mov_b32 m0, s6
s_nop 0
buffer_load_dwordx4 v2, s[60:63], s6 offen nt lds
s_add_u32 s6, s12, 17408
s_mov_b32 m0, s6
s_nop 0
buffer_load_dwordx4 v2, s[60:63], s6 offen nt lds
v_lshrrev_b32 v5, 4, v1
v_lshlrev_b32 v5, 3, v5
v_bfe_u32 v6, v1, 2, 2
v_add_u32 v5, v5, v6
v_mul_u32_u24 v5, 1152, v5
s_mul_i32 s6, s3, 288
v_add_u32 v5, s6, v5
v_and_b32 v6, 3, v1
v_lshl_add_u32 v158, v6, 5, v5
v_lshl_add_u32 v159, v6, 3, v5
v_add_u32 v159, 256, v159
v_bfe_u32 v5, v1, 2, 2
v_lshl_add_u32 v5, v9, 3, v5
v_lshlrev_b32 v5, 7, v5
v_and_b32 v6, 3, v1
v_lshl_add_u32 v5, v6, 3, v5
v_add_u32 v5, 73728, v5
v_bfe_u32 v6, v1, 3, 2
v_xor_b32 v7, 0, v6
v_lshl_add_u32 v154, v7, 5, v5
v_xor_b32 v7, 1, v6
v_lshl_add_u32 v155, v7, 5, v5
v_xor_b32 v7, 2, v6
v_lshl_add_u32 v156, v7, 5, v5
v_xor_b32 v7, 3, v6
v_lshl_add_u32 v157, v7, 5, v5
s_waitcnt vmcnt(0)
s_cmp_lg_u32 s3, 0
s_cbranch_scc1 L_polld_19
s_mov_b32 s7, 20000
L_poll_18:
buffer_load_dword v5, off, s[68:71], 0 offset:64 sc1
s_waitcnt vmcnt(0)
v_readfirstlane_b32 s6, v5
s_cmp_ge_u32 s6, 64
s_cbranch_scc1 L_polld_19
s_sleep 8
s_sub_u32 s7, s7, 1
s_cmp_lg_u32 s7, 0
s_cbranch_scc1 L_poll_18
L_polld_19:
s_barrier
v_lshlrev_b32 v5, 10, v8
v_lshl_add_u32 v5, v9, 4, v5
v_lshlrev_b32 v6, 3, v8
s_lshl_b32 s6, s4, 9
s_lshl_b32 s7, s3, 7
s_add_u32 s6, s6, s7
s_add_u32 s6, s6, 262144
buffer_load_dwordx2 v[148:149], v6, s[64:67], s6 offen sc1
s_lshl_b32 s6, s4, 16
s_lshl_b32 s7, s3, 14
s_add_u32 s6, s6, s7
s_add_u32 s6, s6, 1048576
buffer_load_dwordx4 v[12:15], v5, s[64:67], s6 offen offset:0 sc1
buffer_load_dwordx4 v[16:19], v5, s[64:67], s6 offen offset:64 sc1
buffer_load_dwordx4 v[20:23], v5, s[64:67], s6 offen offset:128 sc1
buffer_load_dwordx4 v[24:27], v5, s[64:67], s6 offen offset:192 sc1
buffer_load_dwordx4 v[28:31], v5, s[64:67], s6 offen offset:256 sc1
buffer_load_dwordx4 v[32:35], v5, s[64:67], s6 offen offset:320 sc1
buffer_load_dwordx4 v[36:39], v5, s[64:67], s6 offen offset:384 sc1
buffer_load_dwordx4 v[40:43], v5, s[64:67], s6 offen offset:448 sc1
buffer_load_dwordx4 v[44:47], v5, s[64:67], s6 offen offset:512 sc1
buffer_load_dwordx4 v[48:51], v5, s[64:67], s6 offen offset:576 sc1
buffer_load_dwordx4 v[52:55], v5, s[64:67], s6 offen offset:640 sc1
buffer_load_dwordx4 v[56:59], v5, s[64:67], s6 offen offset:704 sc1
buffer_load_dwordx4 v[60:63], v5, s[64:67], s6 offen offset:768 sc1
buffer_load_dwordx4 v[64:67], v5, s[64:67], s6 offen offset:832 sc1
buffer_load_dwordx4 v[68:71], v5, s[64:67], s6 offen offset:896 sc1
buffer_load_dwordx4 v[72:75], v5, s[64:67], s6 offen offset:960 sc1
ds_read_b64_tr_b16 a[96:97], v158 offset:0
ds_read_b64_tr_b16 a[98:99], v158 offset:4608
ds_read_b64_tr_b16 a[100:101], v158 offset:36864
ds_read_b64_tr_b16 a[102:103], v158 offset:41472
ds_read_b64_tr_b16 a[104:105], v158 offset:8
ds_read_b64_tr_b16 a[106:107], v158 offset:4616
ds_read_b64_tr_b16 a[108:109], v158 offset:36872
ds_read_b64_tr_b16 a[110:111], v158 offset:41480
ds_read_b64_tr_b16 a[112:113], v158 offset:16
ds_read_b64_tr_b16 a[114:115], v158 offset:4624
ds_read_b64_tr_b16 a[116:117], v158 offset:36880
ds_read_b64_tr_b16 a[118:119], v158 offset:41488
ds_read_b64_tr_b16 a[120:121], v158 offset:24
ds_read_b64_tr_b16 a[122:123], v158 offset:4632
ds_read_b64_tr_b16 a[124:125], v158 offset:36888
ds_read_b64_tr_b16 a[126:127], v158 offset:41496
ds_read_b64_tr_b16 a[128:129], v158 offset:128
ds_read_b64_tr_b16 a[130:131], v158 offset:4736
ds_read_b64_tr_b16 a[132:133], v158 offset:36992
ds_read_b64_tr_b16 a[134:135], v158 offset:41600
ds_read_b64_tr_b16 a[136:137], v158 offset:136
ds_read_b64_tr_b16 a[138:139], v158 offset:4744
ds_read_b64_tr_b16 a[140:141], v158 offset:37000
ds_read_b64_tr_b16 a[142:143], v158 offset:41608
ds_read_b64_tr_b16 a[144:145], v158 offset:144
ds_read_b64_tr_b16 a[146:147], v158 offset:4752
ds_read_b64_tr_b16 a[148:149], v158 offset:37008
ds_read_b64_tr_b16 a[150:151], v158 offset:41616
ds_read_b64_tr_b16 a[152:153], v158 offset:152
ds_read_b64_tr_b16 a[154:155], v158 offset:4760
ds_read_b64_tr_b16 a[156:157], v158 offset:37016
ds_read_b64_tr_b16 a[158:159], v158 offset:41624
ds_read_b64_tr_b16 a[160:161], v159 offset:0
ds_read_b64_tr_b16 a[162:163], v159 offset:4608
ds_read_b64_tr_b16 a[164:165], v159 offset:36864
ds_read_b64_tr_b16 a[166:167], v159 offset:41472
s_waitcnt vmcnt(16)
v_mov_b32 v150, v148
s_nop 1
v_max_f32_dpp v150, v150, v150 row_ror:8 row_mask:0xf bank_mask:0xf
s_nop 1
v_max_f32_dpp v150, v150, v150 row_ror:4 row_mask:0xf bank_mask:0xf
s_nop 1
v_max_f32_dpp v150, v150, v150 row_ror:2 row_mask:0xf bank_mask:0xf
s_nop 1
v_max_f32_dpp v150, v150, v150 row_ror:1 row_mask:0xf bank_mask:0xf
v_sub_f32 v148, v148, v150
v_exp_f32 v148, v148
s_nop 0
v_mul_f32 v151, v148, v149
s_nop 1
v_add_f32_dpp v151, v151, v151 row_ror:8 row_mask:0xf bank_mask:0xf
s_nop 1
v_add_f32_dpp v151, v151, v151 row_ror:4 row_mask:0xf bank_mask:0xf
s_nop 1
v_add_f32_dpp v151, v151, v151 row_ror:2 row_mask:0xf bank_mask:0xf
s_nop 1
v_add_f32_dpp v151, v151, v151 row_ror:1 row_mask:0xf bank_mask:0xf
v_rcp_f32 v151, v151
s_nop 0
v_mul_f32 v148, v148, v151
s_nop 1
v_mov_b32_dpp v144, v148 row_newbcast:0 row_mask:0x1 bank_mask:0xf
v_mov_b32_dpp v144, v148 row_newbcast:4 row_mask:0x2 bank_mask:0xf
v_mov_b32_dpp v144, v148 row_newbcast:8 row_mask:0x4 bank_mask:0xf
v_mov_b32_dpp v144, v148 row_newbcast:12 row_mask:0x8 bank_mask:0xf
v_mov_b32_dpp v145, v148 row_newbcast:1 row_mask:0x1 bank_mask:0xf
v_mov_b32_dpp v145, v148 row_newbcast:5 row_mask:0x2 bank_mask:0xf
v_mov_b32_dpp v145, v148 row_newbcast:9 row_mask:0x4 bank_mask:0xf
v_mov_b32_dpp v145, v148 row_newbcast:13 row_mask:0x8 bank_mask:0xf
v_mov_b32_dpp v146, v148 row_newbcast:2 row_mask:0x1 bank_mask:0xf
v_mov_b32_dpp v146, v148 row_newbcast:6 row_mask:0x2 bank_mask:0xf
v_mov_b32_dpp v146, v148 row_newbcast:10 row_mask:0x4 bank_mask:0xf
v_mov_b32_dpp v146, v148 row_newbcast:14 row_mask:0x8 bank_mask:0xf
v_mov_b32_dpp v147, v148 row_newbcast:3 row_mask:0x1 bank_mask:0xf
v_mov_b32_dpp v147, v148 row_newbcast:7 row_mask:0x2 bank_mask:0xf
v_mov_b32_dpp v147, v148 row_newbcast:11 row_mask:0x4 bank_mask:0xf
v_mov_b32_dpp v147, v148 row_newbcast:15 row_mask:0x8 bank_mask:0xf
s_waitcnt lgkmcnt(0)
ds_read_b64_tr_b16 v[76:77], v154 offset:0
ds_read_b64_tr_b16 v[78:79], v154 offset:512
ds_read_b64_tr_b16 v[80:81], v155 offset:0
ds_read_b64_tr_b16 v[82:83], v155 offset:512
ds_read_b64_tr_b16 v[84:85], v156 offset:0
ds_read_b64_tr_b16 v[86:87], v156 offset:512
ds_read_b64_tr_b16 v[88:89], v157 offset:0
ds_read_b64_tr_b16 v[90:91], v157 offset:512
ds_read_b64_tr_b16 v[92:93], v154 offset:4096
ds_read_b64_tr_b16 v[94:95], v154 offset:4608
ds_read_b64_tr_b16 v[96:97], v155 offset:4096
ds_read_b64_tr_b16 v[98:99], v155 offset:4608
ds_read_b64_tr_b16 v[100:101], v156 offset:4096
ds_read_b64_tr_b16 v[102:103], v156 offset:4608
ds_read_b64_tr_b16 v[104:105], v157 offset:4096
ds_read_b64_tr_b16 v[106:107], v157 offset:4608
s_waitcnt vmcnt(15)
s_waitcnt lgkmcnt(8)
v_mfma_f32_16x16x32_bf16 v[108:111], v[12:15], v[76:79], 0
v_mfma_f32_16x16x32_bf16 v[112:115], v[12:15], v[80:83], 0
v_mfma_f32_16x16x32_bf16 v[116:119], v[12:15], v[84:87], 0
v_mfma_f32_16x16x32_bf16 v[120:123], v[12:15], v[88:91], 0
ds_read_b64_tr_b16 v[76:77], v154 offset:8192
ds_read_b64_tr_b16 v[78:79], v154 offset:8704
ds_read_b64_tr_b16 v[80:81], v155 offset:8192
ds_read_b64_tr_b16 v[82:83], v155 offset:8704
ds_read_b64_tr_b16 v[84:85], v156 offset:8192
ds_read_b64_tr_b16 v[86:87], v156 offset:8704
ds_read_b64_tr_b16 v[88:89], v157 offset:8192
ds_read_b64_tr_b16 v[90:91], v157 offset:8704
s_waitcnt vmcnt(14)
s_waitcnt lgkmcnt(8)
v_mfma_f32_16x16x32_bf16 v[108:111], v[16:19], v[92:95], v[108:111]
v_mfma_f32_16x16x32_bf16 v[112:115], v[16:19], v[96:99], v[112:115]
v_mfma_f32_16x16x32_bf16 v[116:119], v[16:19], v[100:103], v[116:119]
v_mfma_f32_16x16x32_bf16 v[120:123], v[16:19], v[104:107], v[120:123]
ds_read_b64_tr_b16 v[92:93], v154 offset:12288
ds_read_b64_tr_b16 v[94:95], v154 offset:12800
ds_read_b64_tr_b16 v[96:97], v155 offset:12288
ds_read_b64_tr_b16 v[98:99], v155 offset:12800
ds_read_b64_tr_b16 v[100:101], v156 offset:12288
ds_read_b64_tr_b16 v[102:103], v156 offset:12800
ds_read_b64_tr_b16 v[104:105], v157 offset:12288
ds_read_b64_tr_b16 v[106:107], v157 offset:12800
s_waitcnt vmcnt(13)
s_waitcnt lgkmcnt(8)
v_mfma_f32_16x16x32_bf16 v[108:111], v[20:23], v[76:79], v[108:111]
v_mfma_f32_16x16x32_bf16 v[112:115], v[20:23], v[80:83], v[112:115]
v_mfma_f32_16x16x32_bf16 v[116:119], v[20:23], v[84:87], v[116:119]
v_mfma_f32_16x16x32_bf16 v[120:123], v[20:23], v[88:91], v[120:123]
ds_read_b64_tr_b16 v[76:77], v154 offset:16384
ds_read_b64_tr_b16 v[78:79], v154 offset:16896
ds_read_b64_tr_b16 v[80:81], v155 offset:16384
ds_read_b64_tr_b16 v[82:83], v155 offset:16896
ds_read_b64_tr_b16 v[84:85], v156 offset:16384
ds_read_b64_tr_b16 v[86:87], v156 offset:16896
ds_read_b64_tr_b16 v[88:89], v157 offset:16384
ds_read_b64_tr_b16 v[90:91], v157 offset:16896
s_waitcnt vmcnt(12)
s_waitcnt lgkmcnt(8)
v_mfma_f32_16x16x32_bf16 v[108:111], v[24:27], v[92:95], v[108:111]
v_mfma_f32_16x16x32_bf16 v[112:115], v[24:27], v[96:99], v[112:115]
v_mfma_f32_16x16x32_bf16 v[116:119], v[24:27], v[100:103], v[116:119]
v_mfma_f32_16x16x32_bf16 v[120:123], v[24:27], v[104:107], v[120:123]
ds_read_b64_tr_b16 v[92:93], v154 offset:20480
ds_read_b64_tr_b16 v[94:95], v154 offset:20992
ds_read_b64_tr_b16 v[96:97], v155 offset:20480
ds_read_b64_tr_b16 v[98:99], v155 offset:20992
ds_read_b64_tr_b16 v[100:101], v156 offset:20480
ds_read_b64_tr_b16 v[102:103], v156 offset:20992
ds_read_b64_tr_b16 v[104:105], v157 offset:20480
ds_read_b64_tr_b16 v[106:107], v157 offset:20992
s_waitcnt vmcnt(11)
s_waitcnt lgkmcnt(8)
v_mfma_f32_16x16x32_bf16 v[108:111], v[28:31], v[76:79], v[108:111]
v_mfma_f32_16x16x32_bf16 v[112:115], v[28:31], v[80:83], v[112:115]
v_mfma_f32_16x16x32_bf16 v[116:119], v[28:31], v[84:87], v[116:119]
v_mfma_f32_16x16x32_bf16 v[120:123], v[28:31], v[88:91], v[120:123]
ds_read_b64_tr_b16 v[76:77], v154 offset:24576
ds_read_b64_tr_b16 v[78:79], v154 offset:25088
ds_read_b64_tr_b16 v[80:81], v155 offset:24576
ds_read_b64_tr_b16 v[82:83], v155 offset:25088
ds_read_b64_tr_b16 v[84:85], v156 offset:24576
ds_read_b64_tr_b16 v[86:87], v156 offset:25088
ds_read_b64_tr_b16 v[88:89], v157 offset:24576
ds_read_b64_tr_b16 v[90:91], v157 offset:25088
s_waitcnt vmcnt(10)
s_waitcnt lgkmcnt(8)
v_mfma_f32_16x16x32_bf16 v[108:111], v[32:35], v[92:95], v[108:111]
v_mfma_f32_16x16x32_bf16 v[112:115], v[32:35], v[96:99], v[112:115]
v_mfma_f32_16x16x32_bf16 v[116:119], v[32:35], v[100:103], v[116:119]
v_mfma_f32_16x16x32_bf16 v[120:123], v[32:35], v[104:107], v[120:123]
ds_read_b64_tr_b16 v[92:93], v154 offset:28672
ds_read_b64_tr_b16 v[94:95], v154 offset:29184
ds_read_b64_tr_b16 v[96:97], v155 offset:28672
ds_read_b64_tr_b16 v[98:99], v155 offset:29184
ds_read_b64_tr_b16 v[100:101], v156 offset:28672
ds_read_b64_tr_b16 v[102:103], v156 offset:29184
ds_read_b64_tr_b16 v[104:105], v157 offset:28672
ds_read_b64_tr_b16 v[106:107], v157 offset:29184
s_waitcnt vmcnt(9)
s_waitcnt lgkmcnt(8)
v_mfma_f32_16x16x32_bf16 v[108:111], v[36:39], v[76:79], v[108:111]
v_mfma_f32_16x16x32_bf16 v[112:115], v[36:39], v[80:83], v[112:115]
v_mfma_f32_16x16x32_bf16 v[116:119], v[36:39], v[84:87], v[116:119]
v_mfma_f32_16x16x32_bf16 v[120:123], v[36:39], v[88:91], v[120:123]
ds_read_b64_tr_b16 v[76:77], v154 offset:32768
ds_read_b64_tr_b16 v[78:79], v154 offset:33280
ds_read_b64_tr_b16 v[80:81], v155 offset:32768
ds_read_b64_tr_b16 v[82:83], v155 offset:33280
ds_read_b64_tr_b16 v[84:85], v156 offset:32768
ds_read_b64_tr_b16 v[86:87], v156 offset:33280
ds_read_b64_tr_b16 v[88:89], v157 offset:32768
ds_read_b64_tr_b16 v[90:91], v157 offset:33280
s_waitcnt vmcnt(8)
s_waitcnt lgkmcnt(8)
v_mfma_f32_16x16x32_bf16 v[108:111], v[40:43], v[92:95], v[108:111]
v_mfma_f32_16x16x32_bf16 v[112:115], v[40:43], v[96:99], v[112:115]
v_mfma_f32_16x16x32_bf16 v[116:119], v[40:43], v[100:103], v[116:119]
v_mfma_f32_16x16x32_bf16 v[120:123], v[40:43], v[104:107], v[120:123]
ds_read_b64_tr_b16 v[92:93], v154 offset:36864
ds_read_b64_tr_b16 v[94:95], v154 offset:37376
ds_read_b64_tr_b16 v[96:97], v155 offset:36864
ds_read_b64_tr_b16 v[98:99], v155 offset:37376
ds_read_b64_tr_b16 v[100:101], v156 offset:36864
ds_read_b64_tr_b16 v[102:103], v156 offset:37376
ds_read_b64_tr_b16 v[104:105], v157 offset:36864
ds_read_b64_tr_b16 v[106:107], v157 offset:37376
s_waitcnt vmcnt(7)
s_waitcnt lgkmcnt(8)
v_mfma_f32_16x16x32_bf16 v[108:111], v[44:47], v[76:79], v[108:111]
v_mfma_f32_16x16x32_bf16 v[112:115], v[44:47], v[80:83], v[112:115]
v_mfma_f32_16x16x32_bf16 v[116:119], v[44:47], v[84:87], v[116:119]
v_mfma_f32_16x16x32_bf16 v[120:123], v[44:47], v[88:91], v[120:123]
ds_read_b64_tr_b16 v[76:77], v154 offset:40960
ds_read_b64_tr_b16 v[78:79], v154 offset:41472
ds_read_b64_tr_b16 v[80:81], v155 offset:40960
ds_read_b64_tr_b16 v[82:83], v155 offset:41472
ds_read_b64_tr_b16 v[84:85], v156 offset:40960
ds_read_b64_tr_b16 v[86:87], v156 offset:41472
ds_read_b64_tr_b16 v[88:89], v157 offset:40960
ds_read_b64_tr_b16 v[90:91], v157 offset:41472
s_waitcnt vmcnt(6)
s_waitcnt lgkmcnt(8)
v_mfma_f32_16x16x32_bf16 v[108:111], v[48:51], v[92:95], v[108:111]
v_mfma_f32_16x16x32_bf16 v[112:115], v[48:51], v[96:99], v[112:115]
v_mfma_f32_16x16x32_bf16 v[116:119], v[48:51], v[100:103], v[116:119]
v_mfma_f32_16x16x32_bf16 v[120:123], v[48:51], v[104:107], v[120:123]
ds_read_b64_tr_b16 v[92:93], v154 offset:45056
ds_read_b64_tr_b16 v[94:95], v154 offset:45568
ds_read_b64_tr_b16 v[96:97], v155 offset:45056
ds_read_b64_tr_b16 v[98:99], v155 offset:45568
ds_read_b64_tr_b16 v[100:101], v156 offset:45056
ds_read_b64_tr_b16 v[102:103], v156 offset:45568
ds_read_b64_tr_b16 v[104:105], v157 offset:45056
ds_read_b64_tr_b16 v[106:107], v157 offset:45568
s_waitcnt vmcnt(5)
s_waitcnt lgkmcnt(8)
v_mfma_f32_16x16x32_bf16 v[108:111], v[52:55], v[76:79], v[108:111]
v_mfma_f32_16x16x32_bf16 v[112:115], v[52:55], v[80:83], v[112:115]
v_mfma_f32_16x16x32_bf16 v[116:119], v[52:55], v[84:87], v[116:119]
v_mfma_f32_16x16x32_bf16 v[120:123], v[52:55], v[88:91], v[120:123]
ds_read_b64_tr_b16 v[76:77], v154 offset:49152
ds_read_b64_tr_b16 v[78:79], v154 offset:49664
ds_read_b64_tr_b16 v[80:81], v155 offset:49152
ds_read_b64_tr_b16 v[82:83], v155 offset:49664
ds_read_b64_tr_b16 v[84:85], v156 offset:49152
ds_read_b64_tr_b16 v[86:87], v156 offset:49664
ds_read_b64_tr_b16 v[88:89], v157 offset:49152
ds_read_b64_tr_b16 v[90:91], v157 offset:49664
s_waitcnt vmcnt(4)
s_waitcnt lgkmcnt(8)
v_mfma_f32_16x16x32_bf16 v[108:111], v[56:59], v[92:95], v[108:111]
v_mfma_f32_16x16x32_bf16 v[112:115], v[56:59], v[96:99], v[112:115]
v_mfma_f32_16x16x32_bf16 v[116:119], v[56:59], v[100:103], v[116:119]
v_mfma_f32_16x16x32_bf16 v[120:123], v[56:59], v[104:107], v[120:123]
ds_read_b64_tr_b16 v[92:93], v154 offset:53248
ds_read_b64_tr_b16 v[94:95], v154 offset:53760
ds_read_b64_tr_b16 v[96:97], v155 offset:53248
ds_read_b64_tr_b16 v[98:99], v155 offset:53760
ds_read_b64_tr_b16 v[100:101], v156 offset:53248
ds_read_b64_tr_b16 v[102:103], v156 offset:53760
ds_read_b64_tr_b16 v[104:105], v157 offset:53248
ds_read_b64_tr_b16 v[106:107], v157 offset:53760
s_waitcnt vmcnt(3)
s_waitcnt lgkmcnt(8)
v_mfma_f32_16x16x32_bf16 v[108:111], v[60:63], v[76:79], v[108:111]
v_mfma_f32_16x16x32_bf16 v[112:115], v[60:63], v[80:83], v[112:115]
v_mfma_f32_16x16x32_bf16 v[116:119], v[60:63], v[84:87], v[116:119]
v_mfma_f32_16x16x32_bf16 v[120:123], v[60:63], v[88:91], v[120:123]
ds_read_b64_tr_b16 v[76:77], v154 offset:57344
ds_read_b64_tr_b16 v[78:79], v154 offset:57856
ds_read_b64_tr_b16 v[80:81], v155 offset:57344
ds_read_b64_tr_b16 v[82:83], v155 offset:57856
ds_read_b64_tr_b16 v[84:85], v156 offset:57344
ds_read_b64_tr_b16 v[86:87], v156 offset:57856
ds_read_b64_tr_b16 v[88:89], v157 offset:57344
ds_read_b64_tr_b16 v[90:91], v157 offset:57856
s_waitcnt vmcnt(2)
s_waitcnt lgkmcnt(8)
v_mfma_f32_16x16x32_bf16 v[108:111], v[64:67], v[92:95], v[108:111]
v_mfma_f32_16x16x32_bf16 v[112:115], v[64:67], v[96:99], v[112:115]
v_mfma_f32_16x16x32_bf16 v[116:119], v[64:67], v[100:103], v[116:119]
v_mfma_f32_16x16x32_bf16 v[120:123], v[64:67], v[104:107], v[120:123]
ds_read_b64_tr_b16 v[92:93], v154 offset:61440
ds_read_b64_tr_b16 v[94:95], v154 offset:61952
ds_read_b64_tr_b16 v[96:97], v155 offset:61440
ds_read_b64_tr_b16 v[98:99], v155 offset:61952
ds_read_b64_tr_b16 v[100:101], v156 offset:61440
ds_read_b64_tr_b16 v[102:103], v156 offset:61952
ds_read_b64_tr_b16 v[104:105], v157 offset:61440
ds_read_b64_tr_b16 v[106:107], v157 offset:61952
s_waitcnt vmcnt(1)
s_waitcnt lgkmcnt(8)
v_mfma_f32_16x16x32_bf16 v[108:111], v[68:71], v[76:79], v[108:111]
v_mfma_f32_16x16x32_bf16 v[112:115], v[68:71], v[80:83], v[112:115]
v_mfma_f32_16x16x32_bf16 v[116:119], v[68:71], v[84:87], v[116:119]
v_mfma_f32_16x16x32_bf16 v[120:123], v[68:71], v[88:91], v[120:123]
s_waitcnt vmcnt(0)
s_waitcnt lgkmcnt(0)
v_mfma_f32_16x16x32_bf16 v[108:111], v[72:75], v[92:95], v[108:111]
v_mfma_f32_16x16x32_bf16 v[112:115], v[72:75], v[96:99], v[112:115]
v_mfma_f32_16x16x32_bf16 v[116:119], v[72:75], v[100:103], v[116:119]
v_mfma_f32_16x16x32_bf16 v[120:123], v[72:75], v[104:107], v[120:123]
v_lshlrev_b32 v5, 7, v9
v_lshl_add_u32 v5, v8, 1, v5
s_lshl_b32 s6, s3, 9
s_add_u32 s6, s6, 139264
v_add_u32 v5, s6, v5
v_mul_f32 v172, v144, v108
v_fma_f32 v172, v145, v109, v172
v_fma_f32 v172, v146, v110, v172
v_fma_f32 v172, v147, v111, v172
v_cvt_pk_bf16_f32 v172, v172, v172
ds_write_b16 v5, v172 offset:0
v_mul_f32 v173, v144, v112
v_fma_f32 v173, v145, v113, v173
v_fma_f32 v173, v146, v114, v173
v_fma_f32 v173, v147, v115, v173
v_cvt_pk_bf16_f32 v173, v173, v173
ds_write_b16 v5, v173 offset:32
v_mul_f32 v174, v144, v116
v_fma_f32 v174, v145, v117, v174
v_fma_f32 v174, v146, v118, v174
v_fma_f32 v174, v147, v119, v174
v_cvt_pk_bf16_f32 v174, v174, v174
ds_write_b16 v5, v174 offset:64
v_mul_f32 v175, v144, v120
v_fma_f32 v175, v145, v121, v175
v_fma_f32 v175, v146, v122, v175
v_fma_f32 v175, v147, v123, v175
v_cvt_pk_bf16_f32 v175, v175, v175
ds_write_b16 v5, v175 offset:96
v_lshlrev_b32 v6, 7, v8
v_lshl_add_u32 v6, v9, 4, v6
v_add_u32 v6, 139264, v6
s_waitcnt lgkmcnt(0)
s_barrier
ds_read_b128 v[164:167], v6 offset:0
ds_read_b128 v[168:171], v6 offset:64
v_mul_u32_u24 v5, 147456, v9
v_and_b32 v6, 3, v1
v_bfe_u32 v7, v1, 2, 2
v_lshl_add_u32 v6, v6, 2, v7
v_lshl_add_u32 v6, v6, 2, v5
v_lshl_add_u32 v5, v8, 4, v5
s_mul_i32 s6, s9, 2304
s_mul_i32 s7, s3, 576
s_add_u32 s6, s6, s7
s_add_u32 s6, s6, 5242880
s_waitcnt lgkmcnt(0)
v_mfma_f32_16x16x32_bf16 v[108:111], v[164:167], a[96:99], 0
v_mfma_f32_16x16x32_bf16 v[108:111], v[168:171], a[100:103], v[108:111]
v_mfma_f32_16x16x32_bf16 v[112:115], v[164:167], a[104:107], 0
v_mfma_f32_16x16x32_bf16 v[112:115], v[168:171], a[108:111], v[112:115]
v_mfma_f32_16x16x32_bf16 v[116:119], v[164:167], a[112:115], 0
v_mfma_f32_16x16x32_bf16 v[116:119], v[168:171], a[116:119], v[116:119]
v_mfma_f32_16x16x32_bf16 v[120:123], v[164:167], a[120:123], 0
v_mfma_f32_16x16x32_bf16 v[120:123], v[168:171], a[124:127], v[120:123]
v_mfma_f32_16x16x32_bf16 v[124:127], v[164:167], a[128:131], 0
v_mfma_f32_16x16x32_bf16 v[124:127], v[168:171], a[132:135], v[124:127]
v_mfma_f32_16x16x32_bf16 v[128:131], v[164:167], a[136:139], 0
v_mfma_f32_16x16x32_bf16 v[128:131], v[168:171], a[140:143], v[128:131]
v_mfma_f32_16x16x32_bf16 v[132:135], v[164:167], a[144:147], 0
v_mfma_f32_16x16x32_bf16 v[132:135], v[168:171], a[148:151], v[132:135]
v_mfma_f32_16x16x32_bf16 v[136:139], v[164:167], a[152:155], 0
v_mfma_f32_16x16x32_bf16 v[136:139], v[168:171], a[156:159], v[136:139]
v_mfma_f32_16x16x32_bf16 v[140:143], v[164:167], a[160:163], 0
v_mfma_f32_16x16x32_bf16 v[140:143], v[168:171], a[164:167], v[140:143]
v_add_f32 v108, v108, v109
v_add_f32 v110, v110, v111
v_add_f32 v172, v108, v110
v_add_f32 v112, v112, v113
v_add_f32 v114, v114, v115
v_add_f32 v173, v112, v114
v_add_f32 v116, v116, v117
v_add_f32 v118, v118, v119
v_add_f32 v174, v116, v118
v_add_f32 v120, v120, v121
v_add_f32 v122, v122, v123
v_add_f32 v175, v120, v122
v_add_f32 v124, v124, v125
v_add_f32 v126, v126, v127
v_add_f32 v176, v124, v126
v_add_f32 v128, v128, v129
v_add_f32 v130, v130, v131
v_add_f32 v177, v128, v130
v_add_f32 v132, v132, v133
v_add_f32 v134, v134, v135
v_add_f32 v178, v132, v134
v_add_f32 v136, v136, v137
v_add_f32 v138, v138, v139
v_add_f32 v179, v136, v138
v_add_f32 v140, v140, v141
v_add_f32 v142, v142, v143
v_add_f32 v180, v140, v142
buffer_store_dwordx4 v[172:175], v5, s[64:67], s6 offen sc1
buffer_store_dwordx4 v[176:179], v5, s[64:67], s6 offen offset:256 sc1
buffer_store_dword v180, v6, s[64:67], s6 offen offset:512 sc1
s_waitcnt vmcnt(0) lgkmcnt(0)
s_barrier
s_cmp_lg_u32 s3, 0
s_cbranch_scc1 L_sig_20
v_mov_b32 v5, 1
s_mov_b64 exec, 1
buffer_atomic_add v5, off, s[68:71], 0 offset:128
s_mov_b64 exec, -1
L_sig_20:
v_mul_u32_u24 v44, 2304, v9
v_lshl_add_u32 v44, v8, 4, v44
v_lshrrev_b32 v45, 5, v1
v_lshlrev_b32 v45, 4, v45
s_lshl_b32 s6, s3, 10
s_add_u32 s6, s6, 141312
v_add_u32 v46, s6, v2
v_lshlrev_b32 v47, 2, v1
v_add_u32 v47, 141312, v47
v_and_b32 v6, 3, v1
v_bfe_u32 v7, v1, 2, 2
v_lshl_add_u32 v6, v6, 2, v7
v_lshl_add_u32 v6, v9, 4, v6
v_lshlrev_b32 v48, 1, v6
s_cmp_lt_u32 s9, 28
s_cbranch_scc1 R_taskA
s_sub_u32 s14, s9, 28
s_mul_i32 s15, s14, 57
s_lshr_b32 s15, s15, 9
s_mul_i32 s6, s15, 9
s_sub_u32 s80, s14, s6
s_lshl_b32 s6, s15, 2
s_add_u32 s6, s6, s3
s_mul_i32 s81, s6, 36864
s_lshl_b32 s6, s80, 8
s_add_u32 s81, s81, s6
s_add_u32 s81, s81, 5242880
s_cmp_lg_u32 s3, 0
s_cbranch_scc1 L_polld_22
s_mov_b32 s7, 20000
L_poll_21:
buffer_load_dword v5, off, s[68:71], 0 offset:128 sc1
s_waitcnt vmcnt(0)
v_readfirstlane_b32 s6, v5
s_cmp_ge_u32 s6, 64
s_cbranch_scc1 L_polld_22
s_sleep 8
s_sub_u32 s7, s7, 1
s_cmp_lg_u32 s7, 0
s_cbranch_scc1 L_poll_21
L_polld_22:
s_barrier
s_add_u32 s6, s81, 0
buffer_load_dwordx4 v[12:15], v44, s[64:67], s6 offen sc1
s_add_u32 s6, s81, 9216
buffer_load_dwordx4 v[16:19], v44, s[64:67], s6 offen sc1
s_add_u32 s6, s81, 18432
buffer_load_dwordx4 v[20:23], v44, s[64:67], s6 offen sc1
s_add_u32 s6, s81, 27648
buffer_load_dwordx4 v[24:27], v44, s[64:67], s6 offen sc1
s_waitcnt vmcnt(0)
v_add_f32 v12, v12, v16
v_add_f32 v20, v20, v24
v_add_f32 v13, v13, v17
v_add_f32 v21, v21, v25
v_add_f32 v14, v14, v18
v_add_f32 v22, v22, v26
v_add_f32 v15, v15, v19
v_add_f32 v23, v23, v27
v_add_f32 v12, v12, v20
v_add_f32 v13, v13, v21
v_add_f32 v14, v14, v22
v_add_f32 v15, v15, v23
ds_write_b128 v46, v[12:15]
s_waitcnt lgkmcnt(0)
s_barrier
s_cmp_lg_u32 s3, 0
s_cbranch_scc1 L_fin_23
ds_read2st64_b32 v[50:51], v47 offset0:0 offset1:1
ds_read2st64_b32 v[52:53], v47 offset0:2 offset1:3
ds_read2st64_b32 v[54:55], v47 offset0:4 offset1:5
ds_read2st64_b32 v[56:57], v47 offset0:6 offset1:7
ds_read2st64_b32 v[58:59], v47 offset0:8 offset1:9
ds_read2st64_b32 v[60:61], v47 offset0:10 offset1:11
ds_read2st64_b32 v[62:63], v47 offset0:12 offset1:13
ds_read2st64_b32 v[64:65], v47 offset0:14 offset1:15
s_mul_i32 s6, s15, 2304
s_lshl_b32 s7, s80, 7
s_add_u32 s6, s6, s7
s_waitcnt lgkmcnt(0)
v_add_f32 v50, v50, v58
v_add_f32 v51, v51, v59
v_add_f32 v52, v52, v60
v_add_f32 v53, v53, v61
v_add_f32 v54, v54, v62
v_add_f32 v55, v55, v63
v_add_f32 v56, v56, v64
v_add_f32 v57, v57, v65
v_add_f32 v50, v50, v54
v_add_f32 v51, v51, v55
v_add_f32 v52, v52, v56
v_add_f32 v53, v53, v57
v_add_f32 v50, v50, v52
v_add_f32 v51, v51, v53
v_add_f32 v50, v50, v51
v_cvt_pk_bf16_f32 v50, v50, v50
buffer_store_short v50, v48, s[72:75], s6 offen offset:1152
L_fin_23:
s_cmp_ge_u32 s9, 36
s_cbranch_scc1 B_end
R_taskA:
s_mov_b32 s14, s9
s_mul_i32 s15, s14, 57
s_lshr_b32 s15, s15, 9
s_mul_i32 s6, s15, 9
s_sub_u32 s80, s14, s6
s_lshl_b32 s6, s15, 2
s_add_u32 s6, s6, s3
s_mul_i32 s81, s6, 36864
s_lshl_b32 s6, s80, 8
s_add_u32 s81, s81, s6
s_add_u32 s81, s81, 4194304
s_lshl_b32 s6, s15, 2
s_add_u32 s6, s6, s3
s_lshl_b32 s83, s6, 7
s_add_u32 s83, s83, 327680
v_and_b32 v7, 1, v9
s_cmp_lg_u32 s3, 0
s_cbranch_scc1 L_polld_25
s_mov_b32 s7, 20000
L_poll_24:
buffer_load_dword v5, off, s[68:71], 0 offset:192 sc1
s_waitcnt vmcnt(0)
v_readfirstlane_b32 s6, v5
s_cmp_ge_u32 s6, 192
s_cbranch_scc1 L_polld_25
s_sleep 8
s_sub_u32 s7, s7, 1
s_cmp_lg_u32 s7, 0
s_cbranch_scc1 L_poll_24
L_polld_25:
s_barrier
s_mov_b32 s82, 0
s_mov_b32 s7, 20000
R_pass:
s_bitcmp1_b32 s82, 0
s_cbranch_scc1 L_ld_26
s_add_u32 s6, s81, 0
buffer_load_dwordx4 v[12:15], v44, s[64:67], s6 offen sc1
buffer_load_dwordx4 v[28:31], v45, s[64:67], s83 offen offset:0 sc1
L_ld_26:
s_bitcmp1_b32 s82, 1
s_cbranch_scc1 L_ld_27
s_add_u32 s6, s81, 9216
buffer_load_dwordx4 v[16:19], v44, s[64:67], s6 offen sc1
buffer_load_dwordx4 v[32:35], v45, s[64:67], s83 offen offset:32 sc1
L_ld_27:
s_bitcmp1_b32 s82, 2
s_cbranch_scc1 L_ld_28
s_add_u32 s6, s81, 18432
buffer_load_dwordx4 v[20:23], v44, s[64:67], s6 offen sc1
buffer_load_dwordx4 v[36:39], v45, s[64:67], s83 offen offset:64 sc1
L_ld_28:
s_bitcmp1_b32 s82, 3
s_cbranch_scc1 L_ld_29
s_add_u32 s6, s81, 27648
buffer_load_dwordx4 v[24:27], v44, s[64:67], s6 offen sc1
buffer_load_dwordx4 v[40:43], v45, s[64:67], s83 offen offset:96 sc1
L_ld_29:
s_waitcnt vmcnt(0)
s_bitcmp1_b32 s82, 0
s_cbranch_scc1 L_ck_30
v_max3_u32 v66, v12, v13, v14
v_max3_u32 v67, v28, v29, v30
v_max3_u32 v66, v66, v15, v31
v_max_u32 v66, v66, v67
v_cmp_eq_u32 vcc, -1, v66
s_cbranch_vccnz L_ck_30
s_bitset1_b32 s82, 0
v_max_f32 v66, v28, v30
v_sub_f32 v28, v28, v66
v_sub_f32 v30, v30, v66
v_exp_f32 v28, v28
v_exp_f32 v30, v30
v_cmp_eq_u32 vcc, 1, v7
v_mul_f32 v66, v28, v29
v_fma_f32 v66, v30, v31, v66
v_rcp_f32 v66, v66
v_cndmask_b32 v28, v28, v30, vcc
v_mul_f32 v66, v66, v28
v_mul_f32 v12, v12, v66
v_mul_f32 v13, v13, v66
v_mul_f32 v14, v14, v66
v_mul_f32 v15, v15, v66
L_ck_30:
s_bitcmp1_b32 s82, 1
s_cbranch_scc1 L_ck_31
v_max3_u32 v66, v16, v17, v18
v_max3_u32 v67, v32, v33, v34
v_max3_u32 v66, v66, v19, v35
v_max_u32 v66, v66, v67
v_cmp_eq_u32 vcc, -1, v66
s_cbranch_vccnz L_ck_31
s_bitset1_b32 s82, 1
v_max_f32 v66, v32, v34
v_sub_f32 v32, v32, v66
v_sub_f32 v34, v34, v66
v_exp_f32 v32, v32
v_exp_f32 v34, v34
v_cmp_eq_u32 vcc, 1, v7
v_mul_f32 v66, v32, v33
v_fma_f32 v66, v34, v35, v66
v_rcp_f32 v66, v66
v_cndmask_b32 v32, v32, v34, vcc
v_mul_f32 v66, v66, v32
v_mul_f32 v16, v16, v66
v_mul_f32 v17, v17, v66
v_mul_f32 v18, v18, v66
v_mul_f32 v19, v19, v66
L_ck_31:
s_bitcmp1_b32 s82, 2
s_cbranch_scc1 L_ck_32
v_max3_u32 v66, v20, v21, v22
v_max3_u32 v67, v36, v37, v38
v_max3_u32 v66, v66, v23, v39
v_max_u32 v66, v66, v67
v_cmp_eq_u32 vcc, -1, v66
s_cbranch_vccnz L_ck_32
s_bitset1_b32 s82, 2
v_max_f32 v66, v36, v38
v_sub_f32 v36, v36, v66
v_sub_f32 v38, v38, v66
v_exp_f32 v36, v36
v_exp_f32 v38, v38
v_cmp_eq_u32 vcc, 1, v7
v_mul_f32 v66, v36, v37
v_fma_f32 v66, v38, v39, v66
v_rcp_f32 v66, v66
v_cndmask_b32 v36, v36, v38, vcc
v_mul_f32 v66, v66, v36
v_mul_f32 v20, v20, v66
v_mul_f32 v21, v21, v66
v_mul_f32 v22, v22, v66
v_mul_f32 v23, v23, v66
L_ck_32:
s_bitcmp1_b32 s82, 3
s_cbranch_scc1 L_ck_33
v_max3_u32 v66, v24, v25, v26
v_max3_u32 v67, v40, v41, v42
v_max3_u32 v66, v66, v27, v43
v_max_u32 v66, v66, v67
v_cmp_eq_u32 vcc, -1, v66
s_cbranch_vccnz L_ck_33
s_bitset1_b32 s82, 3
v_max_f32 v66, v40, v42
v_sub_f32 v40, v40, v66
v_sub_f32 v42, v42, v66
v_exp_f32 v40, v40
v_exp_f32 v42, v42
v_cmp_eq_u32 vcc, 1, v7
v_mul_f32 v66, v40, v41
v_fma_f32 v66, v42, v43, v66
v_rcp_f32 v66, v66
v_cndmask_b32 v40, v40, v42, vcc
v_mul_f32 v66, v66, v40
v_mul_f32 v24, v24, v66
v_mul_f32 v25, v25, v66
v_mul_f32 v26, v26, v66
v_mul_f32 v27, v27, v66
L_ck_33:
s_cmp_eq_u32 s82, 15
s_cbranch_scc1 R_done
s_sub_u32 s7, s7, 1
s_cmp_lg_u32 s7, 0
s_cbranch_scc1 R_pass
R_done:
v_add_f32 v12, v12, v16
v_add_f32 v20, v20, v24
v_add_f32 v13, v13, v17
v_add_f32 v21, v21, v25
v_add_f32 v14, v14, v18
v_add_f32 v22, v22, v26
v_add_f32 v15, v15, v19
v_add_f32 v23, v23, v27
v_add_f32 v12, v12, v20
v_add_f32 v13, v13, v21
v_add_f32 v14, v14, v22
v_add_f32 v15, v15, v23
ds_write_b128 v46, v[12:15]
s_waitcnt lgkmcnt(0)
s_barrier
s_cmp_lg_u32 s3, 0
s_cbranch_scc1 L_fin_34
ds_read2st64_b32 v[50:51], v47 offset0:0 offset1:1
ds_read2st64_b32 v[52:53], v47 offset0:2 offset1:3
ds_read2st64_b32 v[54:55], v47 offset0:4 offset1:5
ds_read2st64_b32 v[56:57], v47 offset0:6 offset1:7
ds_read2st64_b32 v[58:59], v47 offset0:8 offset1:9
ds_read2st64_b32 v[60:61], v47 offset0:10 offset1:11
ds_read2st64_b32 v[62:63], v47 offset0:12 offset1:13
ds_read2st64_b32 v[64:65], v47 offset0:14 offset1:15
s_mul_i32 s6, s15, 2304
s_lshl_b32 s7, s80, 7
s_add_u32 s6, s6, s7
s_waitcnt lgkmcnt(0)
v_add_f32 v50, v50, v58
v_add_f32 v51, v51, v59
v_add_f32 v52, v52, v60
v_add_f32 v53, v53, v61
v_add_f32 v54, v54, v62
v_add_f32 v55, v55, v63
v_add_f32 v56, v56, v64
v_add_f32 v57, v57, v65
v_add_f32 v50, v50, v54
v_add_f32 v51, v51, v55
v_add_f32 v52, v52, v56
v_add_f32 v53, v53, v57
v_add_f32 v50, v50, v52
v_add_f32 v51, v51, v53
v_add_f32 v50, v50, v51
v_cvt_pk_bf16_f32 v50, v50, v50
buffer_store_short v50, v48, s[72:75], s6 offen offset:0
L_fin_34:
B_end:
s_endpgm
.section .rodata,"a"
.p2align 6
.amdhsa_kernel concat_heads__mha_block_cached__compressed_kv_cla__decode_kernel
  .amdhsa_next_free_vgpr 512
  .amdhsa_next_free_sgpr 102
  .amdhsa_accum_offset 256
  .amdhsa_group_segment_fixed_size 0
  .amdhsa_kernarg_size 112
  .amdhsa_user_sgpr_count 2
  .amdhsa_user_sgpr_kernarg_segment_ptr 1
  .amdhsa_system_sgpr_workgroup_id_x 1
.end_amdhsa_kernel
```

```asm
; @launch grid=(256,1,1) block=(256,1,1) lds=163840
.amdgcn_target "amdgcn-amd-amdhsa--gfx950"
.text
.globl concat_heads__mha_block_cached__compressed_kv_cla__decode_kernel
.p2align 8
.type concat_heads__mha_block_cached__compressed_kv_cla__decode_kernel,@function
concat_heads__mha_block_cached__compressed_kv_cla__decode_kernel:
s_cmp_ge_u32 s2, 256
s_cbranch_scc1 L_exit
s_load_dwordx16 s[16:31], s[0:1], 0
s_load_dwordx8 s[32:39], s[0:1], 64
s_load_dwordx4 s[40:43], s[0:1], 96
v_lshrrev_b32 v1, 6, v0
s_nop 0
v_readfirstlane_b32 s3, v1
s_and_b32 s6, s2, 7
s_bfe_u32 s7, s2, 0x20003
s_lshl_b32 s4, s6, 2
s_add_u32 s4, s4, s7
s_lshr_b32 s5, s2, 5
s_cmp_lt_u32 s5, 2
s_cbranch_scc1 B_role
A_role:
s_sub_u32 s8, s5, 2
s_cmp_ge_u32 s8, 3
s_cselect_b32 s9, 1, 0
s_cselect_b32 s6, 3, 0
s_sub_u32 s8, s8, s6
s_lshl_b32 s11, s8, 2
s_add_u32 s11, s11, s3
s_cmp_ge_u32 s11, 6
s_cselect_b32 s83, 1, 0
s_cselect_b32 s6, -1, 1
s_add_u32 s11, s11, s6
s_cmp_ge_u32 s11, 6
s_cselect_b32 s6, 6, 0
s_sub_u32 s11, s11, s6
s_lshl_b32 s10, s9, 1
s_add_u32 s10, s10, s83
v_and_b32 v1, 63, v0
v_lshlrev_b32 v2, 4, v1
s_sub_u32 s14, s11, 8
s_lshl_b32 s14, s14, 12
s_mov_b32 s13, s14
s_add_u32 s13, s13, 24576
s_min_u32 s12, s13, 2146435072
s_lshl_b32 s82, s10, 5
s_add_u32 s82, s82, s4
s_lshl_b32 s6, s82, 20
s_waitcnt lgkmcnt(0)
s_add_u32 s52, s18, s6
s_addc_u32 s53, s19, 0
s_mov_b32 s54, 1048576
s_mov_b32 s55, 0x20000
s_add_u32 s56, s20, s6
s_addc_u32 s57, s21, 0
s_mov_b32 s58, 1048576
s_mov_b32 s59, 0x20000
s_mul_i32 s6, s9, 2304
s_mul_i32 s7, s3, 288
s_add_u32 s6, s6, s7
s_sub_u32 s7, 4608, s6
s_add_u32 s44, s16, s6
s_addc_u32 s45, s17, 0
s_mov_b32 s46, s7
s_mov_b32 s47, 0x20000
s_mul_i32 s6, s3, 1179648
s_lshl_b32 s7, s4, 8
s_add_u32 s6, s6, s7
s_sub_u32 s7, 4718592, s6
s_add_u32 s48, s22, s6
s_addc_u32 s49, s23, 0
s_mov_b32 s50, s7
s_mov_b32 s51, 0x20000
v_lshrrev_b32 v5, 4, v1
v_and_b32 v6, 15, v1
v_mul_u32_u24 v3, 294912, v5
v_lshl_add_u32 v3, v6, 4, v3
v_mul_u32_u24 v4, 72, v5
v_lshrrev_b32 v6, 3, v6
v_mul_u32_u24 v6, 1152, v6
v_add_u32 v4, v4, v6
buffer_load_dwordx4 v[40:43], v4, s[44:47], 0 offen offset:0
buffer_load_dwordx4 v[44:47], v4, s[44:47], 0 offen offset:16
buffer_load_dwordx4 v[48:51], v4, s[44:47], 0 offen offset:32
buffer_load_dwordx4 v[52:55], v4, s[44:47], 0 offen offset:48
buffer_load_dwordx2 v[56:57], v4, s[44:47], 0 offen offset:64
s_mov_b32 s6, 0
buffer_load_dwordx4 a[96:99], v3, s[48:51], s6 offen nt
s_mov_b32 s6, 8192
buffer_load_dwordx4 a[100:103], v3, s[48:51], s6 offen nt
s_mov_b32 s6, 16384
buffer_load_dwordx4 a[104:107], v3, s[48:51], s6 offen nt
buffer_load_dwordx4 v[132:135], v2, s[52:55], s12 offen offset:0 nt
buffer_load_dwordx4 v[136:139], v2, s[52:55], s12 offen offset:1024 nt
buffer_load_dwordx4 v[140:143], v2, s[52:55], s12 offen offset:2048 nt
buffer_load_dwordx4 v[144:147], v2, s[52:55], s12 offen offset:3072 nt
s_add_u32 s13, s13, 24576
s_min_u32 s12, s13, 2146435072
s_mov_b32 s6, 24576
buffer_load_dwordx4 a[108:111], v3, s[48:51], s6 offen nt
s_mov_b32 s6, 32768
buffer_load_dwordx4 a[112:115], v3, s[48:51], s6 offen nt
s_mov_b32 s6, 40960
buffer_load_dwordx4 a[116:119], v3, s[48:51], s6 offen nt
buffer_load_dwordx4 v[148:151], v2, s[52:55], s12 offen offset:0 nt
buffer_load_dwordx4 v[152:155], v2, s[52:55], s12 offen offset:1024 nt
buffer_load_dwordx4 v[156:159], v2, s[52:55], s12 offen offset:2048 nt
buffer_load_dwordx4 v[160:163], v2, s[52:55], s12 offen offset:3072 nt
s_add_u32 s13, s13, 24576
s_min_u32 s12, s13, 2146435072
s_mov_b32 s6, 49152
buffer_load_dwordx4 a[120:123], v3, s[48:51], s6 offen nt
s_mov_b32 s6, 57344
buffer_load_dwordx4 a[124:127], v3, s[48:51], s6 offen nt
s_mov_b32 s6, 65536
buffer_load_dwordx4 a[128:131], v3, s[48:51], s6 offen nt
buffer_load_dwordx4 v[164:167], v2, s[52:55], s12 offen offset:0 nt
buffer_load_dwordx4 v[168:171], v2, s[52:55], s12 offen offset:1024 nt
buffer_load_dwordx4 v[172:175], v2, s[52:55], s12 offen offset:2048 nt
buffer_load_dwordx4 v[176:179], v2, s[52:55], s12 offen offset:3072 nt
s_add_u32 s13, s13, 24576
s_min_u32 s12, s13, 2146435072
s_mov_b32 s6, 73728
buffer_load_dwordx4 a[132:135], v3, s[48:51], s6 offen nt
s_mov_b32 s6, 81920
buffer_load_dwordx4 a[136:139], v3, s[48:51], s6 offen nt
s_mov_b32 s6, 90112
buffer_load_dwordx4 a[140:143], v3, s[48:51], s6 offen nt
buffer_load_dwordx4 v[180:183], v2, s[52:55], s12 offen offset:0 nt
buffer_load_dwordx4 v[184:187], v2, s[52:55], s12 offen offset:1024 nt
buffer_load_dwordx4 v[188:191], v2, s[52:55], s12 offen offset:2048 nt
buffer_load_dwordx4 v[192:195], v2, s[52:55], s12 offen offset:3072 nt
s_add_u32 s13, s13, 24576
s_min_u32 s12, s13, 2146435072
s_mov_b32 s6, 98304
buffer_load_dwordx4 a[144:147], v3, s[48:51], s6 offen nt
s_mov_b32 s6, 106496
buffer_load_dwordx4 a[148:151], v3, s[48:51], s6 offen nt
s_mov_b32 s6, 114688
buffer_load_dwordx4 a[152:155], v3, s[48:51], s6 offen nt
buffer_load_dwordx4 v[196:199], v2, s[52:55], s12 offen offset:0 nt
buffer_load_dwordx4 v[200:203], v2, s[52:55], s12 offen offset:1024 nt
buffer_load_dwordx4 v[204:207], v2, s[52:55], s12 offen offset:2048 nt
buffer_load_dwordx4 v[208:211], v2, s[52:55], s12 offen offset:3072 nt
s_add_u32 s13, s13, 24576
s_min_u32 s12, s13, 2146435072
s_mov_b32 s6, 122880
buffer_load_dwordx4 a[156:159], v3, s[48:51], s6 offen nt
s_mov_b32 s6, 131072
buffer_load_dwordx4 a[160:163], v3, s[48:51], s6 offen nt
s_mov_b32 s6, 139264
buffer_load_dwordx4 a[164:167], v3, s[48:51], s6 offen nt
buffer_load_dwordx4 v[212:215], v2, s[52:55], s12 offen offset:0 nt
buffer_load_dwordx4 v[216:219], v2, s[52:55], s12 offen offset:1024 nt
buffer_load_dwordx4 v[220:223], v2, s[52:55], s12 offen offset:2048 nt
buffer_load_dwordx4 v[224:227], v2, s[52:55], s12 offen offset:3072 nt
s_add_u32 s13, s13, 24576
s_min_u32 s12, s13, 2146435072
s_mov_b32 s6, 147456
buffer_load_dwordx4 a[168:171], v3, s[48:51], s6 offen nt
s_mov_b32 s6, 155648
buffer_load_dwordx4 a[172:175], v3, s[48:51], s6 offen nt
s_mov_b32 s6, 163840
buffer_load_dwordx4 a[176:179], v3, s[48:51], s6 offen nt
buffer_load_dwordx4 v[228:231], v2, s[52:55], s12 offen offset:0 nt
buffer_load_dwordx4 v[232:235], v2, s[52:55], s12 offen offset:1024 nt
buffer_load_dwordx4 v[236:239], v2, s[52:55], s12 offen offset:2048 nt
buffer_load_dwordx4 v[240:243], v2, s[52:55], s12 offen offset:3072 nt
s_add_u32 s13, s13, 24576
s_min_u32 s12, s13, 2146435072
s_mov_b32 s6, 172032
buffer_load_dwordx4 a[180:183], v3, s[48:51], s6 offen nt
s_mov_b32 s6, 180224
buffer_load_dwordx4 a[184:187], v3, s[48:51], s6 offen nt
s_mov_b32 s6, 188416
buffer_load_dwordx4 a[188:191], v3, s[48:51], s6 offen nt
s_mov_b32 s6, 196608
buffer_load_dwordx4 a[192:195], v3, s[48:51], s6 offen nt
s_mov_b32 s6, 204800
buffer_load_dwordx4 a[196:199], v3, s[48:51], s6 offen nt
s_mov_b32 s6, 212992
buffer_load_dwordx4 a[200:203], v3, s[48:51], s6 offen nt
s_mov_b32 s6, 221184
buffer_load_dwordx4 a[204:207], v3, s[48:51], s6 offen nt
s_mov_b32 s64, s42
s_mov_b32 s65, s43
s_mov_b32 s66, 6291456
s_mov_b32 s67, 0x20000
s_mov_b32 s68, s40
s_mov_b32 s69, s41
s_mov_b32 s70, 256
s_mov_b32 s71, 0x20000
s_mul_i32 s6, s4, 147456
s_add_u32 s60, s24, s6
s_addc_u32 s61, s25, 0
s_mov_b32 s62, 147456
s_mov_b32 s63, 0x20000
v_and_b32 v5, 1, v1
v_lshlrev_b32 v5, 4, v5
v_mov_b32 v6, 0xffff
v_lshlrev_b32 v5, v5, v6
v_bfe_u32 v6, v1, 1, 2
v_cmp_eq_u32 vcc, 0, v6
s_nop 1
v_cndmask_b32 v8, 0, v5, vcc
v_cmp_eq_u32 vcc, 1, v6
s_nop 1
v_cndmask_b32 v9, 0, v5, vcc
v_cmp_eq_u32 vcc, 2, v6
s_nop 1
v_cndmask_b32 v10, 0, v5, vcc
v_cmp_eq_u32 vcc, 3, v6
s_nop 1
v_cndmask_b32 v11, 0, v5, vcc
v_mov_b32 v5, 0x0c0c0c0c
s_mov_b32 s6, 0x01000100
s_mov_b32 s7, 0x03020302
v_bfi_b32 v12, v8, s6, v5
v_bfi_b32 v13, v9, s6, v5
v_bfi_b32 v14, v10, s6, v5
v_bfi_b32 v15, v11, s6, v5
v_bfi_b32 v16, v8, s7, v5
v_bfi_b32 v17, v9, s7, v5
v_bfi_b32 v18, v10, s7, v5
v_bfi_b32 v19, v11, s7, v5
v_mov_b32 v7, 0x3e0293ee
v_mov_b32 v86, 0xff800000
v_lshrrev_b32 v5, 4, v1
v_lshlrev_b32 v5, 3, v5
v_bfe_u32 v6, v1, 2, 2
v_add_u32 v5, v5, v6
v_mul_u32_u24 v5, 1152, v5
s_mul_i32 s6, s3, 288
v_add_u32 v5, s6, v5
v_and_b32 v6, 3, v1
v_lshl_add_u32 v88, v6, 5, v5
v_lshl_add_u32 v89, v6, 3, v5
v_add_u32 v89, 256, v89
v_add_u32 v90, 73728, v88
v_add_u32 v91, 73728, v89
s_lshl_b32 s82, s82, 6
s_add_u32 s82, s82, 327680
s_mov_b64 s[72:73], 0
s_cmp_ge_u32 s11, 2
s_cselect_b32 s74, 0x22222222, 0
s_mov_b32 s75, s74
s_mov_b32 s76, 0x44444444
s_mov_b32 s77, s76
s_mov_b32 s78, 0x88888888
s_mov_b32 s79, s78
v_bfe_u32 v5, v1, 4, 1
s_lshl_b32 s6, s9, 7
s_lshl_b32 s7, s4, 1
s_add_u32 s6, s6, s7
s_add_u32 s6, s6, s8
v_mul_u32_u24 v6, 63, v5
v_add_u32 v6, s6, v6
v_mul_u32_u24 v92, 2304, v6
v_add_u32 v92, 4194304, v92
v_sub_u32 v6, s8, v5
v_cmp_lt_u32 vcc, 1, v6
v_mov_b32 v6, 2146435072
s_nop 0
v_cndmask_b32 v92, v92, v6, vcc
s_mul_i32 s6, s3, 576
v_add_u32 v92, s6, v92
v_and_b32 v35, 3, v1
v_bfe_u32 v36, v1, 2, 2
v_lshl_add_u32 v35, v35, 2, v36
v_lshl_add_u32 v93, v35, 2, v92
v_and_b32 v35, 15, v1
v_lshrrev_b32 v36, 5, v1
v_lshl_add_u32 v35, v36, 4, v35
v_lshl_add_u32 v92, v35, 4, v92
s_lshl_b32 s6, s8, 2
s_add_u32 s6, s6, 0
s_cmp_ge_u32 s6, 6
s_cselect_b32 s6, 1, 0
v_cmp_eq_u32 vcc, s6, v5
s_nop 1
v_cndmask_b32 v106, 0, 1.0, vcc
s_lshl_b32 s6, s8, 2
s_add_u32 s6, s6, 1
s_cmp_ge_u32 s6, 6
s_cselect_b32 s6, 1, 0
v_cmp_eq_u32 vcc, s6, v5
s_nop 1
v_cndmask_b32 v107, 0, 1.0, vcc
s_lshl_b32 s6, s8, 2
s_add_u32 s6, s6, 2
s_cmp_ge_u32 s6, 6
s_cselect_b32 s6, 1, 0
v_cmp_eq_u32 vcc, s6, v5
s_nop 1
v_cndmask_b32 v108, 0, 1.0, vcc
s_lshl_b32 s6, s8, 2
s_add_u32 s6, s6, 3
s_cmp_ge_u32 s6, 6
s_cselect_b32 s6, 1, 0
v_cmp_eq_u32 vcc, s6, v5
s_nop 1
v_cndmask_b32 v109, 0, 1.0, vcc
v_cmp_gt_u32 vcc, 32, v1
s_nop 1
v_cndmask_b32 v98, 0, v106, vcc
v_cndmask_b32 v102, v106, 0, vcc
v_cndmask_b32 v99, 0, v107, vcc
v_cndmask_b32 v103, v107, 0, vcc
v_cndmask_b32 v100, 0, v108, vcc
v_cndmask_b32 v104, v108, 0, vcc
v_cndmask_b32 v101, 0, v109, vcc
v_cndmask_b32 v105, v109, 0, vcc
v_and_b32 v35, 15, v1
v_lshlrev_b32 v35, 4, v35
v_lshl_add_u32 v94, v5, 3, v35
s_lshl_b32 s6, s3, 8
s_add_u32 s6, s6, 151552
v_add_u32 v94, s6, v94
v_and_b32 v35, 3, v1
v_lshlrev_b32 v35, 8, v35
v_lshrrev_b32 v36, 4, v1
v_lshl_add_u32 v95, v36, 4, v35
v_add_u32 v95, 151552, v95
s_mul_i32 s15, s3, 36864
s_mov_b32 s80, 0x0
s_mov_b32 s81, 0
v_and_b32 v35, 15, v1
v_lshlrev_b32 v35, 5, v35
v_lshl_add_u32 v36, v5, 4, v35
v_lshrrev_b32 v6, 5, v1
v_lshl_add_u32 v36, v6, 9, v36
s_lshl_b32 s6, s3, 10
s_add_u32 s6, s6, 147456
v_add_u32 v36, s6, v36
s_lshl_b32 s6, s83, 9
s_add_u32 s6, s6, 147456
v_add_u32 v35, s6, v35
s_waitcnt vmcnt(55)
v_perm_b32 v60, v40, v40, v12
v_perm_b32 v61, v40, v40, v13
v_perm_b32 v62, v40, v40, v14
v_perm_b32 v63, v40, v40, v15
s_nop 1
v_mfma_f32_16x16x32_bf16 v[20:23], v[60:63], a[96:99], 0
s_mov_b32 s6, 229376
buffer_load_dwordx4 a[208:211], v3, s[48:51], s6 offen nt
s_mov_b32 s6, 237568
buffer_load_dwordx4 a[212:215], v3, s[48:51], s6 offen nt
s_mov_b32 s6, 245760
buffer_load_dwordx4 a[216:219], v3, s[48:51], s6 offen nt
s_mov_b32 s6, 253952
buffer_load_dwordx4 a[220:223], v3, s[48:51], s6 offen nt
s_mov_b32 s6, 262144
buffer_load_dwordx4 a[224:227], v3, s[48:51], s6 offen nt
s_waitcnt vmcnt(59)
v_perm_b32 v64, v40, v40, v16
v_perm_b32 v65, v40, v40, v17
v_perm_b32 v66, v40, v40, v18
v_perm_b32 v67, v40, v40, v19
s_nop 1
v_mfma_f32_16x16x32_bf16 v[20:23], v[64:67], a[100:103], v[20:23]
s_mov_b32 s6, 270336
buffer_load_dwordx4 a[228:231], v3, s[48:51], s6 offen nt
s_waitcnt vmcnt(59)
v_perm_b32 v68, v41, v41, v12
v_perm_b32 v69, v41, v41, v13
v_perm_b32 v70, v41, v41, v14
v_perm_b32 v71, v41, v41, v15
s_nop 1
v_mfma_f32_16x16x32_bf16 v[20:23], v[68:71], a[104:107], v[20:23]
s_mov_b32 s6, 278528
buffer_load_dwordx4 a[232:235], v3, s[48:51], s6 offen nt
s_waitcnt vmcnt(55)
v_perm_b32 v72, v41, v41, v16
v_perm_b32 v73, v41, v41, v17
v_perm_b32 v74, v41, v41, v18
v_perm_b32 v75, v41, v41, v19
s_nop 1
v_mfma_f32_16x16x32_bf16 v[20:23], v[72:75], a[108:111], v[20:23]
s_mov_b32 s6, 286720
buffer_load_dwordx4 a[236:239], v3, s[48:51], s6 offen nt
s_waitcnt vmcnt(55)
v_perm_b32 v60, v42, v42, v12
v_perm_b32 v61, v42, v42, v13
v_perm_b32 v62, v42, v42, v14
v_perm_b32 v63, v42, v42, v15
s_nop 1
v_mfma_f32_16x16x32_bf16 v[20:23], v[60:63], a[112:115], v[20:23]
s_waitcnt vmcnt(54)
v_perm_b32 v64, v42, v42, v16
v_perm_b32 v65, v42, v42, v17
v_perm_b32 v66, v42, v42, v18
v_perm_b32 v67, v42, v42, v19
s_nop 1
v_mfma_f32_16x16x32_bf16 v[20:23], v[64:67], a[116:119], v[20:23]
s_waitcnt vmcnt(49)
v_perm_b32 v68, v43, v43, v12
v_perm_b32 v69, v43, v43, v13
v_perm_b32 v70, v43, v43, v14
v_perm_b32 v71, v43, v43, v15
s_nop 1
v_mfma_f32_16x16x32_bf16 v[20:23], v[68:71], a[120:123], v[20:23]
s_waitcnt vmcnt(48)
v_perm_b32 v72, v43, v43, v16
v_perm_b32 v73, v43, v43, v17
v_perm_b32 v74, v43, v43, v18
v_perm_b32 v75, v43, v43, v19
s_nop 1
v_mfma_f32_16x16x32_bf16 v[20:23], v[72:75], a[124:127], v[20:23]
s_waitcnt vmcnt(47)
v_perm_b32 v60, v44, v44, v12
v_perm_b32 v61, v44, v44, v13
v_perm_b32 v62, v44, v44, v14
v_perm_b32 v63, v44, v44, v15
s_nop 1
v_mfma_f32_16x16x32_bf16 v[20:23], v[60:63], a[128:131], v[20:23]
s_waitcnt vmcnt(42)
v_perm_b32 v64, v44, v44, v16
v_perm_b32 v65, v44, v44, v17
v_perm_b32 v66, v44, v44, v18
v_perm_b32 v67, v44, v44, v19
s_nop 1
v_mfma_f32_16x16x32_bf16 v[20:23], v[64:67], a[132:135], v[20:23]
s_waitcnt vmcnt(41)
v_perm_b32 v68, v45, v45, v12
v_perm_b32 v69, v45, v45, v13
v_perm_b32 v70, v45, v45, v14
v_perm_b32 v71, v45, v45, v15
s_nop 1
v_mfma_f32_16x16x32_bf16 v[20:23], v[68:71], a[136:139], v[20:23]
s_waitcnt vmcnt(40)
v_perm_b32 v72, v45, v45, v16
v_perm_b32 v73, v45, v45, v17
v_perm_b32 v74, v45, v45, v18
v_perm_b32 v75, v45, v45, v19
s_nop 1
v_mfma_f32_16x16x32_bf16 v[20:23], v[72:75], a[140:143], v[20:23]
s_waitcnt vmcnt(35)
v_perm_b32 v60, v46, v46, v12
v_perm_b32 v61, v46, v46, v13
v_perm_b32 v62, v46, v46, v14
v_perm_b32 v63, v46, v46, v15
s_nop 1
v_mfma_f32_16x16x32_bf16 v[20:23], v[60:63], a[144:147], v[20:23]
s_waitcnt vmcnt(34)
v_perm_b32 v64, v46, v46, v16
v_perm_b32 v65, v46, v46, v17
v_perm_b32 v66, v46, v46, v18
v_perm_b32 v67, v46, v46, v19
s_nop 1
v_mfma_f32_16x16x32_bf16 v[20:23], v[64:67], a[148:151], v[20:23]
s_waitcnt vmcnt(33)
v_perm_b32 v68, v47, v47, v12
v_perm_b32 v69, v47, v47, v13
v_perm_b32 v70, v47, v47, v14
v_perm_b32 v71, v47, v47, v15
s_nop 1
v_mfma_f32_16x16x32_bf16 v[20:23], v[68:71], a[152:155], v[20:23]
s_waitcnt vmcnt(28)
v_perm_b32 v72, v47, v47, v16
v_perm_b32 v73, v47, v47, v17
v_perm_b32 v74, v47, v47, v18
v_perm_b32 v75, v47, v47, v19
s_nop 1
v_mfma_f32_16x16x32_bf16 v[20:23], v[72:75], a[156:159], v[20:23]
s_waitcnt vmcnt(27)
v_perm_b32 v60, v48, v48, v12
v_perm_b32 v61, v48, v48, v13
v_perm_b32 v62, v48, v48, v14
v_perm_b32 v63, v48, v48, v15
s_nop 1
v_mfma_f32_16x16x32_bf16 v[20:23], v[60:63], a[160:163], v[20:23]
s_waitcnt vmcnt(26)
v_perm_b32 v64, v48, v48, v16
v_perm_b32 v65, v48, v48, v17
v_perm_b32 v66, v48, v48, v18
v_perm_b32 v67, v48, v48, v19
s_nop 1
v_mfma_f32_16x16x32_bf16 v[20:23], v[64:67], a[164:167], v[20:23]
s_waitcnt vmcnt(21)
v_perm_b32 v68, v49, v49, v12
v_perm_b32 v69, v49, v49, v13
v_perm_b32 v70, v49, v49, v14
v_perm_b32 v71, v49, v49, v15
s_nop 1
v_mfma_f32_16x16x32_bf16 v[20:23], v[68:71], a[168:171], v[20:23]
s_waitcnt vmcnt(20)
v_perm_b32 v72, v49, v49, v16
v_perm_b32 v73, v49, v49, v17
v_perm_b32 v74, v49, v49, v18
v_perm_b32 v75, v49, v49, v19
s_nop 1
v_mfma_f32_16x16x32_bf16 v[20:23], v[72:75], a[172:175], v[20:23]
s_waitcnt vmcnt(19)
v_perm_b32 v60, v50, v50, v12
v_perm_b32 v61, v50, v50, v13
v_perm_b32 v62, v50, v50, v14
v_perm_b32 v63, v50, v50, v15
s_nop 1
v_mfma_f32_16x16x32_bf16 v[20:23], v[60:63], a[176:179], v[20:23]
s_waitcnt vmcnt(14)
v_perm_b32 v64, v50, v50, v16
v_perm_b32 v65, v50, v50, v17
v_perm_b32 v66, v50, v50, v18
v_perm_b32 v67, v50, v50, v19
s_nop 1
v_mfma_f32_16x16x32_bf16 v[20:23], v[64:67], a[180:183], v[20:23]
s_waitcnt vmcnt(13)
v_perm_b32 v68, v51, v51, v12
v_perm_b32 v69, v51, v51, v13
v_perm_b32 v70, v51, v51, v14
v_perm_b32 v71, v51, v51, v15
s_nop 1
v_mfma_f32_16x16x32_bf16 v[20:23], v[68:71], a[184:187], v[20:23]
s_waitcnt vmcnt(12)
v_perm_b32 v72, v51, v51, v16
v_perm_b32 v73, v51, v51, v17
v_perm_b32 v74, v51, v51, v18
v_perm_b32 v75, v51, v51, v19
s_nop 1
v_mfma_f32_16x16x32_bf16 v[20:23], v[72:75], a[188:191], v[20:23]
s_waitcnt vmcnt(11)
v_perm_b32 v60, v52, v52, v12
v_perm_b32 v61, v52, v52, v13
v_perm_b32 v62, v52, v52, v14
v_perm_b32 v63, v52, v52, v15
s_nop 1
v_mfma_f32_16x16x32_bf16 v[20:23], v[60:63], a[192:195], v[20:23]
s_waitcnt vmcnt(10)
v_perm_b32 v64, v52, v52, v16
v_perm_b32 v65, v52, v52, v17
v_perm_b32 v66, v52, v52, v18
v_perm_b32 v67, v52, v52, v19
s_nop 1
v_mfma_f32_16x16x32_bf16 v[20:23], v[64:67], a[196:199], v[20:23]
s_waitcnt vmcnt(9)
v_perm_b32 v68, v53, v53, v12
v_perm_b32 v69, v53, v53, v13
v_perm_b32 v70, v53, v53, v14
v_perm_b32 v71, v53, v53, v15
s_nop 1
v_mfma_f32_16x16x32_bf16 v[20:23], v[68:71], a[200:203], v[20:23]
s_waitcnt vmcnt(8)
v_perm_b32 v72, v53, v53, v16
v_perm_b32 v73, v53, v53, v17
v_perm_b32 v74, v53, v53, v18
v_perm_b32 v75, v53, v53, v19
s_nop 1
v_mfma_f32_16x16x32_bf16 v[20:23], v[72:75], a[204:207], v[20:23]
s_waitcnt vmcnt(7)
v_perm_b32 v60, v54, v54, v12
v_perm_b32 v61, v54, v54, v13
v_perm_b32 v62, v54, v54, v14
v_perm_b32 v63, v54, v54, v15
s_nop 1
v_mfma_f32_16x16x32_bf16 v[20:23], v[60:63], a[208:211], v[20:23]
s_waitcnt vmcnt(6)
v_perm_b32 v64, v54, v54, v16
v_perm_b32 v65, v54, v54, v17
v_perm_b32 v66, v54, v54, v18
v_perm_b32 v67, v54, v54, v19
s_nop 1
v_mfma_f32_16x16x32_bf16 v[20:23], v[64:67], a[212:215], v[20:23]
s_waitcnt vmcnt(5)
v_perm_b32 v68, v55, v55, v12
v_perm_b32 v69, v55, v55, v13
v_perm_b32 v70, v55, v55, v14
v_perm_b32 v71, v55, v55, v15
s_nop 1
v_mfma_f32_16x16x32_bf16 v[20:23], v[68:71], a[216:219], v[20:23]
s_waitcnt vmcnt(4)
v_perm_b32 v72, v55, v55, v16
v_perm_b32 v73, v55, v55, v17
v_perm_b32 v74, v55, v55, v18
v_perm_b32 v75, v55, v55, v19
s_nop 1
v_mfma_f32_16x16x32_bf16 v[20:23], v[72:75], a[220:223], v[20:23]
s_waitcnt vmcnt(3)
v_perm_b32 v60, v56, v56, v12
v_perm_b32 v61, v56, v56, v13
v_perm_b32 v62, v56, v56, v14
v_perm_b32 v63, v56, v56, v15
s_nop 1
v_mfma_f32_16x16x32_bf16 v[20:23], v[60:63], a[224:227], v[20:23]
s_waitcnt vmcnt(2)
v_perm_b32 v64, v56, v56, v16
v_perm_b32 v65, v56, v56, v17
v_perm_b32 v66, v56, v56, v18
v_perm_b32 v67, v56, v56, v19
s_nop 1
v_mfma_f32_16x16x32_bf16 v[20:23], v[64:67], a[228:231], v[20:23]
s_waitcnt vmcnt(1)
v_perm_b32 v68, v57, v57, v12
v_perm_b32 v69, v57, v57, v13
v_perm_b32 v70, v57, v57, v14
v_perm_b32 v71, v57, v57, v15
s_nop 1
v_mfma_f32_16x16x32_bf16 v[20:23], v[68:71], a[232:235], v[20:23]
s_waitcnt vmcnt(0)
v_perm_b32 v72, v57, v57, v16
v_perm_b32 v73, v57, v57, v17
v_perm_b32 v74, v57, v57, v18
v_perm_b32 v75, v57, v57, v19
s_nop 1
v_mfma_f32_16x16x32_bf16 v[20:23], v[72:75], a[236:239], v[20:23]
s_nop 7
ds_write_b128 v36, v[20:23]
s_waitcnt lgkmcnt(0)
s_barrier
ds_read_b128 v[40:43], v35 offset:0
ds_read_b128 v[44:47], v35 offset:16
ds_read_b128 v[48:51], v35 offset:1024
ds_read_b128 v[52:55], v35 offset:1040
ds_read_b128 v[56:59], v35 offset:2048
ds_read_b128 v[60:63], v35 offset:2064
ds_read_b128 v[64:67], v35 offset:3072
ds_read_b128 v[68:71], v35 offset:3088
v_mov_b32 v20, 0
v_mov_b32 v21, 0
v_mov_b32 v22, 0
v_mov_b32 v23, 0
s_waitcnt lgkmcnt(0)
v_add_f32 v40, v40, v48
v_add_f32 v56, v56, v64
v_add_f32 v41, v41, v49
v_add_f32 v57, v57, v65
v_add_f32 v42, v42, v50
v_add_f32 v58, v58, v66
v_add_f32 v43, v43, v51
v_add_f32 v59, v59, v67
v_add_f32 v44, v44, v52
v_add_f32 v60, v60, v68
v_add_f32 v45, v45, v53
v_add_f32 v61, v61, v69
v_add_f32 v46, v46, v54
v_add_f32 v62, v62, v70
v_add_f32 v47, v47, v55
v_add_f32 v63, v63, v71
v_add_f32 v40, v40, v56
v_add_f32 v41, v41, v57
v_add_f32 v42, v42, v58
v_add_f32 v43, v43, v59
v_add_f32 v44, v44, v60
v_add_f32 v45, v45, v61
v_add_f32 v46, v46, v62
v_add_f32 v47, v47, v63
v_cvt_pk_bf16_f32 v24, v40, v41
v_cvt_pk_bf16_f32 v25, v42, v43
v_cvt_pk_bf16_f32 v26, v44, v45
v_cvt_pk_bf16_f32 v27, v46, v47
K_loop:
s_cmp_lg_u32 s81, 8
s_cbranch_scc1 L_c0_1
buffer_load_dword v96, off, s[68:71], 0 offset:0 sc1
L_c0_1:
s_waitcnt vmcnt(28)
v_dot2_f32_bf16 v28, v116, v24, 0
v_dot2_f32_bf16 v29, v120, v24, 0
v_dot2_f32_bf16 v30, v124, v24, 0
v_dot2_f32_bf16 v31, v128, v24, 0
v_dot2_f32_bf16 v28, v117, v25, v28
v_dot2_f32_bf16 v29, v121, v25, v29
v_dot2_f32_bf16 v30, v125, v25, v30
v_dot2_f32_bf16 v31, v129, v25, v31
v_dot2_f32_bf16 v28, v118, v26, v28
v_dot2_f32_bf16 v29, v122, v26, v29
v_dot2_f32_bf16 v30, v126, v26, v30
v_dot2_f32_bf16 v31, v130, v26, v31
v_dot2_f32_bf16 v28, v119, v27, v28
v_dot2_f32_bf16 v29, v123, v27, v29
v_dot2_f32_bf16 v30, v127, v27, v30
v_dot2_f32_bf16 v31, v131, v27, v31
buffer_load_dwordx4 v[116:119], v2, s[52:55], s12 offen offset:0 nt
buffer_load_dwordx4 v[120:123], v2, s[52:55], s12 offen offset:1024 nt
buffer_load_dwordx4 v[124:127], v2, s[52:55], s12 offen offset:2048 nt
buffer_load_dwordx4 v[128:131], v2, s[52:55], s12 offen offset:3072 nt
s_add_u32 s13, s13, 24576
s_min_u32 s12, s13, 2146435072
s_cmp_ge_u32 s80, 36
s_cbranch_scc1 L_nodma_2
s_mov_b32 m0, s15
s_nop 0
buffer_load_dwordx4 v2, s[60:63], s15 offen nt lds
s_add_u32 s15, s15, 1024
L_nodma_2:
s_add_u32 s80, s80, 1
v_add_f32_dpp v32, v28, v28 row_ror:8 row_mask:0xf bank_mask:0x3
v_add_f32_dpp v33, v29, v29 row_ror:8 row_mask:0xf bank_mask:0x3
v_add_f32_dpp v32, v30, v30 row_ror:8 row_mask:0xf bank_mask:0xc
v_add_f32_dpp v33, v31, v31 row_ror:8 row_mask:0xf bank_mask:0xc
s_nop 0
v_add_f32_dpp v34, v32, v32 row_half_mirror row_mask:0xf bank_mask:0x5
v_add_f32_dpp v34, v33, v33 row_half_mirror row_mask:0xf bank_mask:0xa
s_nop 1
v_add_f32_dpp v34, v34, v34 quad_perm:[1,0,3,2] row_mask:0xf bank_mask:0xf
s_nop 1
v_add_f32_dpp v34, v34, v34 quad_perm:[2,3,0,1] row_mask:0xf bank_mask:0xf
v_cndmask_b32 v86, v86, v34, s[72:73]
s_waitcnt vmcnt(28)
v_dot2_f32_bf16 v28, v132, v24, 0
v_dot2_f32_bf16 v29, v136, v24, 0
v_dot2_f32_bf16 v30, v140, v24, 0
v_dot2_f32_bf16 v31, v144, v24, 0
v_dot2_f32_bf16 v28, v133, v25, v28
v_dot2_f32_bf16 v29, v137, v25, v29
v_dot2_f32_bf16 v30, v141, v25, v30
v_dot2_f32_bf16 v31, v145, v25, v31
v_dot2_f32_bf16 v28, v134, v26, v28
v_dot2_f32_bf16 v29, v138, v26, v29
v_dot2_f32_bf16 v30, v142, v26, v30
v_dot2_f32_bf16 v31, v146, v26, v31
v_dot2_f32_bf16 v28, v135, v27, v28
v_dot2_f32_bf16 v29, v139, v27, v29
v_dot2_f32_bf16 v30, v143, v27, v30
v_dot2_f32_bf16 v31, v147, v27, v31
buffer_load_dwordx4 v[132:135], v2, s[52:55], s12 offen offset:0 nt
buffer_load_dwordx4 v[136:139], v2, s[52:55], s12 offen offset:1024 nt
buffer_load_dwordx4 v[140:143], v2, s[52:55], s12 offen offset:2048 nt
buffer_load_dwordx4 v[144:147], v2, s[52:55], s12 offen offset:3072 nt
s_add_u32 s13, s13, 24576
s_min_u32 s12, s13, 2146435072
v_add_f32_dpp v32, v28, v28 row_ror:8 row_mask:0xf bank_mask:0x3
v_add_f32_dpp v33, v29, v29 row_ror:8 row_mask:0xf bank_mask:0x3
v_add_f32_dpp v32, v30, v30 row_ror:8 row_mask:0xf bank_mask:0xc
v_add_f32_dpp v33, v31, v31 row_ror:8 row_mask:0xf bank_mask:0xc
s_nop 0
v_add_f32_dpp v34, v32, v32 row_half_mirror row_mask:0xf bank_mask:0x5
v_add_f32_dpp v34, v33, v33 row_half_mirror row_mask:0xf bank_mask:0xa
s_nop 1
v_add_f32_dpp v34, v34, v34 quad_perm:[1,0,3,2] row_mask:0xf bank_mask:0xf
s_nop 1
v_add_f32_dpp v34, v34, v34 quad_perm:[2,3,0,1] row_mask:0xf bank_mask:0xf
v_cndmask_b32 v86, v86, v34, s[74:75]
s_waitcnt vmcnt(28)
v_dot2_f32_bf16 v28, v148, v24, 0
v_dot2_f32_bf16 v29, v152, v24, 0
v_dot2_f32_bf16 v30, v156, v24, 0
v_dot2_f32_bf16 v31, v160, v24, 0
v_dot2_f32_bf16 v28, v149, v25, v28
v_dot2_f32_bf16 v29, v153, v25, v29
v_dot2_f32_bf16 v30, v157, v25, v30
v_dot2_f32_bf16 v31, v161, v25, v31
v_dot2_f32_bf16 v28, v150, v26, v28
v_dot2_f32_bf16 v29, v154, v26, v29
v_dot2_f32_bf16 v30, v158, v26, v30
v_dot2_f32_bf16 v31, v162, v26, v31
v_dot2_f32_bf16 v28, v151, v27, v28
v_dot2_f32_bf16 v29, v155, v27, v29
v_dot2_f32_bf16 v30, v159, v27, v30
v_dot2_f32_bf16 v31, v163, v27, v31
buffer_load_dwordx4 v[148:151], v2, s[52:55], s12 offen offset:0 nt
buffer_load_dwordx4 v[152:155], v2, s[52:55], s12 offen offset:1024 nt
buffer_load_dwordx4 v[156:159], v2, s[52:55], s12 offen offset:2048 nt
buffer_load_dwordx4 v[160:163], v2, s[52:55], s12 offen offset:3072 nt
s_add_u32 s13, s13, 24576
s_min_u32 s12, s13, 2146435072
s_cmp_ge_u32 s80, 36
s_cbranch_scc1 L_nodma_3
s_mov_b32 m0, s15
s_nop 0
buffer_load_dwordx4 v2, s[60:63], s15 offen nt lds
s_add_u32 s15, s15, 1024
L_nodma_3:
s_add_u32 s80, s80, 1
v_add_f32_dpp v32, v28, v28 row_ror:8 row_mask:0xf bank_mask:0x3
v_add_f32_dpp v33, v29, v29 row_ror:8 row_mask:0xf bank_mask:0x3
v_add_f32_dpp v32, v30, v30 row_ror:8 row_mask:0xf bank_mask:0xc
v_add_f32_dpp v33, v31, v31 row_ror:8 row_mask:0xf bank_mask:0xc
s_nop 0
v_add_f32_dpp v34, v32, v32 row_half_mirror row_mask:0xf bank_mask:0x5
v_add_f32_dpp v34, v33, v33 row_half_mirror row_mask:0xf bank_mask:0xa
s_nop 1
v_add_f32_dpp v34, v34, v34 quad_perm:[1,0,3,2] row_mask:0xf bank_mask:0xf
s_nop 1
v_add_f32_dpp v34, v34, v34 quad_perm:[2,3,0,1] row_mask:0xf bank_mask:0xf
v_cndmask_b32 v86, v86, v34, s[76:77]
s_waitcnt vmcnt(28)
v_dot2_f32_bf16 v28, v164, v24, 0
v_dot2_f32_bf16 v29, v168, v24, 0
v_dot2_f32_bf16 v30, v172, v24, 0
v_dot2_f32_bf16 v31, v176, v24, 0
v_dot2_f32_bf16 v28, v165, v25, v28
v_dot2_f32_bf16 v29, v169, v25, v29
v_dot2_f32_bf16 v30, v173, v25, v30
v_dot2_f32_bf16 v31, v177, v25, v31
v_dot2_f32_bf16 v28, v166, v26, v28
v_dot2_f32_bf16 v29, v170, v26, v29
v_dot2_f32_bf16 v30, v174, v26, v30
v_dot2_f32_bf16 v31, v178, v26, v31
v_dot2_f32_bf16 v28, v167, v27, v28
v_dot2_f32_bf16 v29, v171, v27, v29
v_dot2_f32_bf16 v30, v175, v27, v30
v_dot2_f32_bf16 v31, v179, v27, v31
buffer_load_dwordx4 v[164:167], v2, s[52:55], s12 offen offset:0 nt
buffer_load_dwordx4 v[168:171], v2, s[52:55], s12 offen offset:1024 nt
buffer_load_dwordx4 v[172:175], v2, s[52:55], s12 offen offset:2048 nt
buffer_load_dwordx4 v[176:179], v2, s[52:55], s12 offen offset:3072 nt
s_add_u32 s13, s13, 24576
s_min_u32 s12, s13, 2146435072
v_add_f32_dpp v32, v28, v28 row_ror:8 row_mask:0xf bank_mask:0x3
v_add_f32_dpp v33, v29, v29 row_ror:8 row_mask:0xf bank_mask:0x3
v_add_f32_dpp v32, v30, v30 row_ror:8 row_mask:0xf bank_mask:0xc
v_add_f32_dpp v33, v31, v31 row_ror:8 row_mask:0xf bank_mask:0xc
s_nop 0
v_add_f32_dpp v34, v32, v32 row_half_mirror row_mask:0xf bank_mask:0x5
v_add_f32_dpp v34, v33, v33 row_half_mirror row_mask:0xf bank_mask:0xa
s_nop 1
v_add_f32_dpp v34, v34, v34 quad_perm:[1,0,3,2] row_mask:0xf bank_mask:0xf
s_nop 1
v_add_f32_dpp v34, v34, v34 quad_perm:[2,3,0,1] row_mask:0xf bank_mask:0xf
v_cndmask_b32 v86, v86, v34, s[78:79]
s_add_u32 s81, s81, 1
s_cmp_eq_u32 s81, 11
s_cbranch_scc1 A_mid
v_mov_b32 v76, v77
v_mov_b32 v77, v78
v_mov_b32 v78, v79
v_mov_b32 v79, v80
v_mov_b32 v80, v81
v_mov_b32 v81, v82
v_mov_b32 v82, v83
v_mov_b32 v83, v84
v_mov_b32 v84, v85
v_mov_b32 v85, v86
s_lshr_b64 s[72:73], s[76:77], 2
s_lshr_b64 s[74:75], s[76:77], 1
s_cmp_eq_u32 s81, 9
s_cselect_b32 s52, s56, s52
s_cselect_b32 s53, s57, s53
s_cselect_b32 s13, s14, s13
s_min_u32 s12, s13, 2146435072
s_waitcnt vmcnt(28)
v_dot2_f32_bf16 v28, v180, v24, 0
v_dot2_f32_bf16 v29, v184, v24, 0
v_dot2_f32_bf16 v30, v188, v24, 0
v_dot2_f32_bf16 v31, v192, v24, 0
v_dot2_f32_bf16 v28, v181, v25, v28
v_dot2_f32_bf16 v29, v185, v25, v29
v_dot2_f32_bf16 v30, v189, v25, v30
v_dot2_f32_bf16 v31, v193, v25, v31
v_dot2_f32_bf16 v28, v182, v26, v28
v_dot2_f32_bf16 v29, v186, v26, v29
v_dot2_f32_bf16 v30, v190, v26, v30
v_dot2_f32_bf16 v31, v194, v26, v31
v_dot2_f32_bf16 v28, v183, v27, v28
v_dot2_f32_bf16 v29, v187, v27, v29
v_dot2_f32_bf16 v30, v191, v27, v30
v_dot2_f32_bf16 v31, v195, v27, v31
buffer_load_dwordx4 v[180:183], v2, s[52:55], s12 offen offset:0 nt
buffer_load_dwordx4 v[184:187], v2, s[52:55], s12 offen offset:1024 nt
buffer_load_dwordx4 v[188:191], v2, s[52:55], s12 offen offset:2048 nt
buffer_load_dwordx4 v[192:195], v2, s[52:55], s12 offen offset:3072 nt
s_add_u32 s13, s13, 24576
s_min_u32 s12, s13, 2146435072
s_cmp_ge_u32 s80, 36
s_cbranch_scc1 L_nodma_4
s_mov_b32 m0, s15
s_nop 0
buffer_load_dwordx4 v2, s[60:63], s15 offen nt lds
s_add_u32 s15, s15, 1024
L_nodma_4:
s_add_u32 s80, s80, 1
v_add_f32_dpp v32, v28, v28 row_ror:8 row_mask:0xf bank_mask:0x3
v_add_f32_dpp v33, v29, v29 row_ror:8 row_mask:0xf bank_mask:0x3
v_add_f32_dpp v32, v30, v30 row_ror:8 row_mask:0xf bank_mask:0xc
v_add_f32_dpp v33, v31, v31 row_ror:8 row_mask:0xf bank_mask:0xc
s_nop 0
v_add_f32_dpp v34, v32, v32 row_half_mirror row_mask:0xf bank_mask:0x5
v_add_f32_dpp v34, v33, v33 row_half_mirror row_mask:0xf bank_mask:0xa
s_nop 1
v_add_f32_dpp v34, v34, v34 quad_perm:[1,0,3,2] row_mask:0xf bank_mask:0xf
s_nop 1
v_add_f32_dpp v34, v34, v34 quad_perm:[2,3,0,1] row_mask:0xf bank_mask:0xf
v_cndmask_b32 v86, v86, v34, s[72:73]
s_waitcnt vmcnt(28)
v_dot2_f32_bf16 v28, v196, v24, 0
v_dot2_f32_bf16 v29, v200, v24, 0
v_dot2_f32_bf16 v30, v204, v24, 0
v_dot2_f32_bf16 v31, v208, v24, 0
v_dot2_f32_bf16 v28, v197, v25, v28
v_dot2_f32_bf16 v29, v201, v25, v29
v_dot2_f32_bf16 v30, v205, v25, v30
v_dot2_f32_bf16 v31, v209, v25, v31
v_dot2_f32_bf16 v28, v198, v26, v28
v_dot2_f32_bf16 v29, v202, v26, v29
v_dot2_f32_bf16 v30, v206, v26, v30
v_dot2_f32_bf16 v31, v210, v26, v31
v_dot2_f32_bf16 v28, v199, v27, v28
v_dot2_f32_bf16 v29, v203, v27, v29
v_dot2_f32_bf16 v30, v207, v27, v30
v_dot2_f32_bf16 v31, v211, v27, v31
buffer_load_dwordx4 v[196:199], v2, s[52:55], s12 offen offset:0 nt
buffer_load_dwordx4 v[200:203], v2, s[52:55], s12 offen offset:1024 nt
buffer_load_dwordx4 v[204:207], v2, s[52:55], s12 offen offset:2048 nt
buffer_load_dwordx4 v[208:211], v2, s[52:55], s12 offen offset:3072 nt
s_add_u32 s13, s13, 24576
s_min_u32 s12, s13, 2146435072
v_add_f32_dpp v32, v28, v28 row_ror:8 row_mask:0xf bank_mask:0x3
v_add_f32_dpp v33, v29, v29 row_ror:8 row_mask:0xf bank_mask:0x3
v_add_f32_dpp v32, v30, v30 row_ror:8 row_mask:0xf bank_mask:0xc
v_add_f32_dpp v33, v31, v31 row_ror:8 row_mask:0xf bank_mask:0xc
s_nop 0
v_add_f32_dpp v34, v32, v32 row_half_mirror row_mask:0xf bank_mask:0x5
v_add_f32_dpp v34, v33, v33 row_half_mirror row_mask:0xf bank_mask:0xa
s_nop 1
v_add_f32_dpp v34, v34, v34 quad_perm:[1,0,3,2] row_mask:0xf bank_mask:0xf
s_nop 1
v_add_f32_dpp v34, v34, v34 quad_perm:[2,3,0,1] row_mask:0xf bank_mask:0xf
v_cndmask_b32 v86, v86, v34, s[74:75]
s_waitcnt vmcnt(28)
v_dot2_f32_bf16 v28, v212, v24, 0
v_dot2_f32_bf16 v29, v216, v24, 0
v_dot2_f32_bf16 v30, v220, v24, 0
v_dot2_f32_bf16 v31, v224, v24, 0
v_dot2_f32_bf16 v28, v213, v25, v28
v_dot2_f32_bf16 v29, v217, v25, v29
v_dot2_f32_bf16 v30, v221, v25, v30
v_dot2_f32_bf16 v31, v225, v25, v31
v_dot2_f32_bf16 v28, v214, v26, v28
v_dot2_f32_bf16 v29, v218, v26, v29
v_dot2_f32_bf16 v30, v222, v26, v30
v_dot2_f32_bf16 v31, v226, v26, v31
v_dot2_f32_bf16 v28, v215, v27, v28
v_dot2_f32_bf16 v29, v219, v27, v29
v_dot2_f32_bf16 v30, v223, v27, v30
v_dot2_f32_bf16 v31, v227, v27, v31
buffer_load_dwordx4 v[212:215], v2, s[52:55], s12 offen offset:0 nt
buffer_load_dwordx4 v[216:219], v2, s[52:55], s12 offen offset:1024 nt
buffer_load_dwordx4 v[220:223], v2, s[52:55], s12 offen offset:2048 nt
buffer_load_dwordx4 v[224:227], v2, s[52:55], s12 offen offset:3072 nt
s_add_u32 s13, s13, 24576
s_min_u32 s12, s13, 2146435072
s_cmp_ge_u32 s80, 36
s_cbranch_scc1 L_nodma_5
s_mov_b32 m0, s15
s_nop 0
buffer_load_dwordx4 v2, s[60:63], s15 offen nt lds
s_add_u32 s15, s15, 1024
L_nodma_5:
s_add_u32 s80, s80, 1
v_add_f32_dpp v32, v28, v28 row_ror:8 row_mask:0xf bank_mask:0x3
v_add_f32_dpp v33, v29, v29 row_ror:8 row_mask:0xf bank_mask:0x3
v_add_f32_dpp v32, v30, v30 row_ror:8 row_mask:0xf bank_mask:0xc
v_add_f32_dpp v33, v31, v31 row_ror:8 row_mask:0xf bank_mask:0xc
s_nop 0
v_add_f32_dpp v34, v32, v32 row_half_mirror row_mask:0xf bank_mask:0x5
v_add_f32_dpp v34, v33, v33 row_half_mirror row_mask:0xf bank_mask:0xa
s_nop 1
v_add_f32_dpp v34, v34, v34 quad_perm:[1,0,3,2] row_mask:0xf bank_mask:0xf
s_nop 1
v_add_f32_dpp v34, v34, v34 quad_perm:[2,3,0,1] row_mask:0xf bank_mask:0xf
v_cndmask_b32 v86, v86, v34, s[76:77]
s_waitcnt vmcnt(28)
v_dot2_f32_bf16 v28, v228, v24, 0
v_dot2_f32_bf16 v29, v232, v24, 0
v_dot2_f32_bf16 v30, v236, v24, 0
v_dot2_f32_bf16 v31, v240, v24, 0
v_dot2_f32_bf16 v28, v229, v25, v28
v_dot2_f32_bf16 v29, v233, v25, v29
v_dot2_f32_bf16 v30, v237, v25, v30
v_dot2_f32_bf16 v31, v241, v25, v31
v_dot2_f32_bf16 v28, v230, v26, v28
v_dot2_f32_bf16 v29, v234, v26, v29
v_dot2_f32_bf16 v30, v238, v26, v30
v_dot2_f32_bf16 v31, v242, v26, v31
v_dot2_f32_bf16 v28, v231, v27, v28
v_dot2_f32_bf16 v29, v235, v27, v29
v_dot2_f32_bf16 v30, v239, v27, v30
v_dot2_f32_bf16 v31, v243, v27, v31
buffer_load_dwordx4 v[228:231], v2, s[52:55], s12 offen offset:0 nt
buffer_load_dwordx4 v[232:235], v2, s[52:55], s12 offen offset:1024 nt
buffer_load_dwordx4 v[236:239], v2, s[52:55], s12 offen offset:2048 nt
buffer_load_dwordx4 v[240:243], v2, s[52:55], s12 offen offset:3072 nt
s_add_u32 s13, s13, 24576
s_min_u32 s12, s13, 2146435072
v_add_f32_dpp v32, v28, v28 row_ror:8 row_mask:0xf bank_mask:0x3
v_add_f32_dpp v33, v29, v29 row_ror:8 row_mask:0xf bank_mask:0x3
v_add_f32_dpp v32, v30, v30 row_ror:8 row_mask:0xf bank_mask:0xc
v_add_f32_dpp v33, v31, v31 row_ror:8 row_mask:0xf bank_mask:0xc
s_nop 0
v_add_f32_dpp v34, v32, v32 row_half_mirror row_mask:0xf bank_mask:0x5
v_add_f32_dpp v34, v33, v33 row_half_mirror row_mask:0xf bank_mask:0xa
s_nop 1
v_add_f32_dpp v34, v34, v34 quad_perm:[1,0,3,2] row_mask:0xf bank_mask:0xf
s_nop 1
v_add_f32_dpp v34, v34, v34 quad_perm:[2,3,0,1] row_mask:0xf bank_mask:0xf
v_cndmask_b32 v86, v86, v34, s[78:79]
s_add_u32 s81, s81, 1
v_mov_b32 v76, v77
v_mov_b32 v77, v78
v_mov_b32 v78, v79
v_mov_b32 v79, v80
v_mov_b32 v80, v81
v_mov_b32 v81, v82
v_mov_b32 v82, v83
v_mov_b32 v83, v84
v_mov_b32 v84, v85
v_mov_b32 v85, v86
s_branch K_loop
A_mid:
v_max3_f32 v35, v76, v77, v78
v_max3_f32 v35, v35, v79, v80
v_max3_f32 v35, v35, v81, v82
v_max3_f32 v35, v35, v83, v84
v_max3_f32 v35, v35, v85, v86
s_nop 1
v_max_f32_dpp v35, v35, v35 row_ror:8 row_mask:0xf bank_mask:0xf
s_nop 1
v_max_f32_dpp v35, v35, v35 row_ror:4 row_mask:0xf bank_mask:0xf
s_nop 1
v_max_f32_dpp v35, v35, v35 row_ror:2 row_mask:0xf bank_mask:0xf
s_nop 1
v_max_f32_dpp v35, v35, v35 row_ror:1 row_mask:0xf bank_mask:0xf
v_mov_b32 v36, v35
s_nop 1
v_permlane16_swap_b32 v35, v36
v_max_f32 v35, v35, v36
v_mov_b32 v36, v35
s_nop 1
v_permlane32_swap_b32 v35, v36
v_max_f32 v35, v35, v36
v_mul_f32 v32, v35, v7
v_fma_f32 v76, v76, v7, -v32
v_fma_f32 v77, v77, v7, -v32
v_fma_f32 v78, v78, v7, -v32
v_fma_f32 v79, v79, v7, -v32
v_fma_f32 v80, v80, v7, -v32
v_fma_f32 v81, v81, v7, -v32
v_fma_f32 v82, v82, v7, -v32
v_fma_f32 v83, v83, v7, -v32
v_fma_f32 v84, v84, v7, -v32
v_fma_f32 v85, v85, v7, -v32
v_fma_f32 v86, v86, v7, -v32
v_exp_f32 v76, v76
v_exp_f32 v77, v77
v_exp_f32 v78, v78
v_exp_f32 v79, v79
v_exp_f32 v80, v80
v_exp_f32 v81, v81
v_exp_f32 v82, v82
v_exp_f32 v83, v83
v_exp_f32 v84, v84
v_exp_f32 v85, v85
v_exp_f32 v86, v86
v_add_f32 v35, v76, v77
v_add_f32 v35, v35, v78
v_add_f32 v35, v35, v79
v_add_f32 v35, v35, v80
v_add_f32 v35, v35, v81
v_add_f32 v35, v35, v82
v_add_f32 v35, v35, v83
v_add_f32 v35, v35, v84
v_add_f32 v35, v35, v85
v_add_f32 v35, v35, v86
v_cvt_pk_bf16_f32 v76, v76, v76
v_cvt_pk_bf16_f32 v77, v77, v77
v_cvt_pk_bf16_f32 v78, v78, v78
v_cvt_pk_bf16_f32 v79, v79, v79
v_cvt_pk_bf16_f32 v80, v80, v80
v_cvt_pk_bf16_f32 v81, v81, v81
v_cvt_pk_bf16_f32 v82, v82, v82
v_cvt_pk_bf16_f32 v83, v83, v83
v_cvt_pk_bf16_f32 v84, v84, v84
v_cvt_pk_bf16_f32 v85, v85, v85
v_cvt_pk_bf16_f32 v86, v86, v86
v_add_f32_dpp v35, v35, v35 row_ror:8 row_mask:0xf bank_mask:0xf
s_nop 1
v_add_f32_dpp v35, v35, v35 row_ror:4 row_mask:0xf bank_mask:0xf
s_nop 1
v_add_f32_dpp v35, v35, v35 row_ror:2 row_mask:0xf bank_mask:0xf
s_nop 1
v_add_f32_dpp v35, v35, v35 row_ror:1 row_mask:0xf bank_mask:0xf
v_mov_b32 v36, v35
s_nop 1
v_permlane16_swap_b32 v35, v36
v_add_f32 v35, v35, v36
v_mov_b32 v36, v35
s_nop 1
v_permlane32_swap_b32 v35, v36
v_add_f32 v35, v35, v36
v_min_u32 v32, -2, v32
v_min_u32 v33, -2, v35
s_mov_b32 s7, 400000
L_ens_6:
v_readfirstlane_b32 s6, v96
s_cmp_ge_u32 s6, 64
s_cbranch_scc1 L_ensd_7
s_sleep 16
buffer_load_dword v96, off, s[68:71], 0 offset:0 sc1
s_waitcnt vmcnt(0)
s_sub_u32 s7, s7, 1
s_cmp_lg_u32 s7, 0
s_cbranch_scc1 L_ens_6
L_ensd_7:
s_lshl_b32 s6, s11, 3
s_add_u32 s6, s6, s82
s_mov_b64 exec, 1
buffer_store_dwordx2 v[32:33], off, s[64:67], s6 sc1
s_mov_b64 exec, -1
s_branch V_entry
V_loop:
s_cmp_eq_u32 s81, 20
s_cbranch_scc1 A_ev1
A_ev1_ret:
s_nop 1
v_and_b32_dpp v60, v76, v8 row_newbcast:0 row_mask:0xf bank_mask:0xf
v_and_b32_dpp v61, v76, v9 row_newbcast:0 row_mask:0xf bank_mask:0xf
v_and_b32_dpp v62, v76, v10 row_newbcast:0 row_mask:0xf bank_mask:0xf
v_and_b32_dpp v63, v76, v11 row_newbcast:0 row_mask:0xf bank_mask:0xf
v_and_b32_dpp v64, v76, v8 row_newbcast:4 row_mask:0xf bank_mask:0xf
v_and_b32_dpp v65, v76, v9 row_newbcast:4 row_mask:0xf bank_mask:0xf
v_and_b32_dpp v66, v76, v10 row_newbcast:4 row_mask:0xf bank_mask:0xf
v_and_b32_dpp v67, v76, v11 row_newbcast:4 row_mask:0xf bank_mask:0xf
v_and_b32_dpp v68, v76, v8 row_newbcast:8 row_mask:0xf bank_mask:0xf
v_and_b32_dpp v69, v76, v9 row_newbcast:8 row_mask:0xf bank_mask:0xf
v_and_b32_dpp v70, v76, v10 row_newbcast:8 row_mask:0xf bank_mask:0xf
v_and_b32_dpp v71, v76, v11 row_newbcast:8 row_mask:0xf bank_mask:0xf
v_and_b32_dpp v72, v76, v8 row_newbcast:12 row_mask:0xf bank_mask:0xf
v_and_b32_dpp v73, v76, v9 row_newbcast:12 row_mask:0xf bank_mask:0xf
v_and_b32_dpp v74, v76, v10 row_newbcast:12 row_mask:0xf bank_mask:0xf
v_and_b32_dpp v75, v76, v11 row_newbcast:12 row_mask:0xf bank_mask:0xf
s_waitcnt vmcnt(28)
v_mfma_f32_16x16x32_bf16 v[20:23], v[60:63], v[116:119], v[20:23]
v_mfma_f32_16x16x32_bf16 v[20:23], v[64:67], v[120:123], v[20:23]
v_mfma_f32_16x16x32_bf16 v[20:23], v[68:71], v[124:127], v[20:23]
v_mfma_f32_16x16x32_bf16 v[20:23], v[72:75], v[128:131], v[20:23]
buffer_load_dwordx4 v[116:119], v2, s[52:55], s12 offen offset:0 nt
buffer_load_dwordx4 v[120:123], v2, s[52:55], s12 offen offset:1024 nt
buffer_load_dwordx4 v[124:127], v2, s[52:55], s12 offen offset:2048 nt
buffer_load_dwordx4 v[128:131], v2, s[52:55], s12 offen offset:3072 nt
s_add_u32 s13, s13, 24576
s_min_u32 s12, s13, 2146435072
s_cmp_ge_u32 s80, 36
s_cbranch_scc1 L_nodma_8
s_mov_b32 m0, s15
s_nop 0
buffer_load_dwordx4 v2, s[60:63], s15 offen nt lds
s_add_u32 s15, s15, 1024
L_nodma_8:
s_add_u32 s80, s80, 1
v_and_b32_dpp v60, v76, v8 row_newbcast:1 row_mask:0xf bank_mask:0xf
v_and_b32_dpp v61, v76, v9 row_newbcast:1 row_mask:0xf bank_mask:0xf
v_and_b32_dpp v62, v76, v10 row_newbcast:1 row_mask:0xf bank_mask:0xf
v_and_b32_dpp v63, v76, v11 row_newbcast:1 row_mask:0xf bank_mask:0xf
v_and_b32_dpp v64, v76, v8 row_newbcast:5 row_mask:0xf bank_mask:0xf
v_and_b32_dpp v65, v76, v9 row_newbcast:5 row_mask:0xf bank_mask:0xf
v_and_b32_dpp v66, v76, v10 row_newbcast:5 row_mask:0xf bank_mask:0xf
v_and_b32_dpp v67, v76, v11 row_newbcast:5 row_mask:0xf bank_mask:0xf
v_and_b32_dpp v68, v76, v8 row_newbcast:9 row_mask:0xf bank_mask:0xf
v_and_b32_dpp v69, v76, v9 row_newbcast:9 row_mask:0xf bank_mask:0xf
v_and_b32_dpp v70, v76, v10 row_newbcast:9 row_mask:0xf bank_mask:0xf
v_and_b32_dpp v71, v76, v11 row_newbcast:9 row_mask:0xf bank_mask:0xf
v_and_b32_dpp v72, v76, v8 row_newbcast:13 row_mask:0xf bank_mask:0xf
v_and_b32_dpp v73, v76, v9 row_newbcast:13 row_mask:0xf bank_mask:0xf
v_and_b32_dpp v74, v76, v10 row_newbcast:13 row_mask:0xf bank_mask:0xf
v_and_b32_dpp v75, v76, v11 row_newbcast:13 row_mask:0xf bank_mask:0xf
s_waitcnt vmcnt(28)
v_mfma_f32_16x16x32_bf16 v[20:23], v[60:63], v[132:135], v[20:23]
v_mfma_f32_16x16x32_bf16 v[20:23], v[64:67], v[136:139], v[20:23]
v_mfma_f32_16x16x32_bf16 v[20:23], v[68:71], v[140:143], v[20:23]
v_mfma_f32_16x16x32_bf16 v[20:23], v[72:75], v[144:147], v[20:23]
buffer_load_dwordx4 v[132:135], v2, s[52:55], s12 offen offset:0 nt
buffer_load_dwordx4 v[136:139], v2, s[52:55], s12 offen offset:1024 nt
buffer_load_dwordx4 v[140:143], v2, s[52:55], s12 offen offset:2048 nt
buffer_load_dwordx4 v[144:147], v2, s[52:55], s12 offen offset:3072 nt
s_add_u32 s13, s13, 24576
s_min_u32 s12, s13, 2146435072
v_and_b32_dpp v60, v76, v8 row_newbcast:2 row_mask:0xf bank_mask:0xf
v_and_b32_dpp v61, v76, v9 row_newbcast:2 row_mask:0xf bank_mask:0xf
v_and_b32_dpp v62, v76, v10 row_newbcast:2 row_mask:0xf bank_mask:0xf
v_and_b32_dpp v63, v76, v11 row_newbcast:2 row_mask:0xf bank_mask:0xf
v_and_b32_dpp v64, v76, v8 row_newbcast:6 row_mask:0xf bank_mask:0xf
v_and_b32_dpp v65, v76, v9 row_newbcast:6 row_mask:0xf bank_mask:0xf
v_and_b32_dpp v66, v76, v10 row_newbcast:6 row_mask:0xf bank_mask:0xf
v_and_b32_dpp v67, v76, v11 row_newbcast:6 row_mask:0xf bank_mask:0xf
v_and_b32_dpp v68, v76, v8 row_newbcast:10 row_mask:0xf bank_mask:0xf
v_and_b32_dpp v69, v76, v9 row_newbcast:10 row_mask:0xf bank_mask:0xf
v_and_b32_dpp v70, v76, v10 row_newbcast:10 row_mask:0xf bank_mask:0xf
v_and_b32_dpp v71, v76, v11 row_newbcast:10 row_mask:0xf bank_mask:0xf
v_and_b32_dpp v72, v76, v8 row_newbcast:14 row_mask:0xf bank_mask:0xf
v_and_b32_dpp v73, v76, v9 row_newbcast:14 row_mask:0xf bank_mask:0xf
v_and_b32_dpp v74, v76, v10 row_newbcast:14 row_mask:0xf bank_mask:0xf
v_and_b32_dpp v75, v76, v11 row_newbcast:14 row_mask:0xf bank_mask:0xf
s_waitcnt vmcnt(28)
v_mfma_f32_16x16x32_bf16 v[20:23], v[60:63], v[148:151], v[20:23]
v_mfma_f32_16x16x32_bf16 v[20:23], v[64:67], v[152:155], v[20:23]
v_mfma_f32_16x16x32_bf16 v[20:23], v[68:71], v[156:159], v[20:23]
v_mfma_f32_16x16x32_bf16 v[20:23], v[72:75], v[160:163], v[20:23]
buffer_load_dwordx4 v[148:151], v2, s[52:55], s12 offen offset:0 nt
buffer_load_dwordx4 v[152:155], v2, s[52:55], s12 offen offset:1024 nt
buffer_load_dwordx4 v[156:159], v2, s[52:55], s12 offen offset:2048 nt
buffer_load_dwordx4 v[160:163], v2, s[52:55], s12 offen offset:3072 nt
s_add_u32 s13, s13, 24576
s_min_u32 s12, s13, 2146435072
s_cmp_ge_u32 s80, 36
s_cbranch_scc1 L_nodma_9
s_mov_b32 m0, s15
s_nop 0
buffer_load_dwordx4 v2, s[60:63], s15 offen nt lds
s_add_u32 s15, s15, 1024
L_nodma_9:
s_add_u32 s80, s80, 1
v_and_b32_dpp v60, v76, v8 row_newbcast:3 row_mask:0xf bank_mask:0xf
v_and_b32_dpp v61, v76, v9 row_newbcast:3 row_mask:0xf bank_mask:0xf
v_and_b32_dpp v62, v76, v10 row_newbcast:3 row_mask:0xf bank_mask:0xf
v_and_b32_dpp v63, v76, v11 row_newbcast:3 row_mask:0xf bank_mask:0xf
v_and_b32_dpp v64, v76, v8 row_newbcast:7 row_mask:0xf bank_mask:0xf
v_and_b32_dpp v65, v76, v9 row_newbcast:7 row_mask:0xf bank_mask:0xf
v_and_b32_dpp v66, v76, v10 row_newbcast:7 row_mask:0xf bank_mask:0xf
v_and_b32_dpp v67, v76, v11 row_newbcast:7 row_mask:0xf bank_mask:0xf
v_and_b32_dpp v68, v76, v8 row_newbcast:11 row_mask:0xf bank_mask:0xf
v_and_b32_dpp v69, v76, v9 row_newbcast:11 row_mask:0xf bank_mask:0xf
v_and_b32_dpp v70, v76, v10 row_newbcast:11 row_mask:0xf bank_mask:0xf
v_and_b32_dpp v71, v76, v11 row_newbcast:11 row_mask:0xf bank_mask:0xf
v_and_b32_dpp v72, v76, v8 row_newbcast:15 row_mask:0xf bank_mask:0xf
v_and_b32_dpp v73, v76, v9 row_newbcast:15 row_mask:0xf bank_mask:0xf
v_and_b32_dpp v74, v76, v10 row_newbcast:15 row_mask:0xf bank_mask:0xf
v_and_b32_dpp v75, v76, v11 row_newbcast:15 row_mask:0xf bank_mask:0xf
s_waitcnt vmcnt(28)
v_mfma_f32_16x16x32_bf16 v[20:23], v[60:63], v[164:167], v[20:23]
v_mfma_f32_16x16x32_bf16 v[20:23], v[64:67], v[168:171], v[20:23]
v_mfma_f32_16x16x32_bf16 v[20:23], v[68:71], v[172:175], v[20:23]
v_mfma_f32_16x16x32_bf16 v[20:23], v[72:75], v[176:179], v[20:23]
s_add_u32 s81, s81, 1
buffer_load_dwordx4 v[164:167], v2, s[52:55], s12 offen offset:0 nt
buffer_load_dwordx4 v[168:171], v2, s[52:55], s12 offen offset:1024 nt
buffer_load_dwordx4 v[172:175], v2, s[52:55], s12 offen offset:2048 nt
buffer_load_dwordx4 v[176:179], v2, s[52:55], s12 offen offset:3072 nt
s_add_u32 s13, s13, 24576
s_min_u32 s12, s13, 2146435072
v_mov_b32 v76, v77
v_mov_b32 v77, v78
v_mov_b32 v78, v79
v_mov_b32 v79, v80
v_mov_b32 v80, v81
v_mov_b32 v81, v82
v_mov_b32 v82, v83
v_mov_b32 v83, v84
v_mov_b32 v84, v85
v_mov_b32 v85, v86
V_entry:
s_cmp_lg_u32 s81, 19
s_cbranch_scc1 L_nost_10
buffer_load_dwordx4 v[40:43], off, s[64:67], s82 offset:0 sc1
buffer_load_dwordx4 v[44:47], off, s[64:67], s82 offset:16 sc1
buffer_load_dwordx4 v[48:51], off, s[64:67], s82 offset:32 sc1
L_nost_10:
s_cmp_eq_u32 s81, 21
s_cbranch_scc1 A_ev2
A_ev2_ret:
s_nop 1
v_and_b32_dpp v60, v76, v8 row_newbcast:0 row_mask:0xf bank_mask:0xf
v_and_b32_dpp v61, v76, v9 row_newbcast:0 row_mask:0xf bank_mask:0xf
v_and_b32_dpp v62, v76, v10 row_newbcast:0 row_mask:0xf bank_mask:0xf
v_and_b32_dpp v63, v76, v11 row_newbcast:0 row_mask:0xf bank_mask:0xf
v_and_b32_dpp v64, v76, v8 row_newbcast:4 row_mask:0xf bank_mask:0xf
v_and_b32_dpp v65, v76, v9 row_newbcast:4 row_mask:0xf bank_mask:0xf
v_and_b32_dpp v66, v76, v10 row_newbcast:4 row_mask:0xf bank_mask:0xf
v_and_b32_dpp v67, v76, v11 row_newbcast:4 row_mask:0xf bank_mask:0xf
v_and_b32_dpp v68, v76, v8 row_newbcast:8 row_mask:0xf bank_mask:0xf
v_and_b32_dpp v69, v76, v9 row_newbcast:8 row_mask:0xf bank_mask:0xf
v_and_b32_dpp v70, v76, v10 row_newbcast:8 row_mask:0xf bank_mask:0xf
v_and_b32_dpp v71, v76, v11 row_newbcast:8 row_mask:0xf bank_mask:0xf
v_and_b32_dpp v72, v76, v8 row_newbcast:12 row_mask:0xf bank_mask:0xf
v_and_b32_dpp v73, v76, v9 row_newbcast:12 row_mask:0xf bank_mask:0xf
v_and_b32_dpp v74, v76, v10 row_newbcast:12 row_mask:0xf bank_mask:0xf
v_and_b32_dpp v75, v76, v11 row_newbcast:12 row_mask:0xf bank_mask:0xf
s_waitcnt vmcnt(28)
v_mfma_f32_16x16x32_bf16 v[20:23], v[60:63], v[180:183], v[20:23]
v_mfma_f32_16x16x32_bf16 v[20:23], v[64:67], v[184:187], v[20:23]
v_mfma_f32_16x16x32_bf16 v[20:23], v[68:71], v[188:191], v[20:23]
v_mfma_f32_16x16x32_bf16 v[20:23], v[72:75], v[192:195], v[20:23]
buffer_load_dwordx4 v[180:183], v2, s[52:55], s12 offen offset:0 nt
buffer_load_dwordx4 v[184:187], v2, s[52:55], s12 offen offset:1024 nt
buffer_load_dwordx4 v[188:191], v2, s[52:55], s12 offen offset:2048 nt
buffer_load_dwordx4 v[192:195], v2, s[52:55], s12 offen offset:3072 nt
s_add_u32 s13, s13, 24576
s_min_u32 s12, s13, 2146435072
s_cmp_ge_u32 s80, 36
s_cbranch_scc1 L_nodma_11
s_mov_b32 m0, s15
s_nop 0
buffer_load_dwordx4 v2, s[60:63], s15 offen nt lds
s_add_u32 s15, s15, 1024
L_nodma_11:
s_add_u32 s80, s80, 1
v_and_b32_dpp v60, v76, v8 row_newbcast:1 row_mask:0xf bank_mask:0xf
v_and_b32_dpp v61, v76, v9 row_newbcast:1 row_mask:0xf bank_mask:0xf
v_and_b32_dpp v62, v76, v10 row_newbcast:1 row_mask:0xf bank_mask:0xf
v_and_b32_dpp v63, v76, v11 row_newbcast:1 row_mask:0xf bank_mask:0xf
v_and_b32_dpp v64, v76, v8 row_newbcast:5 row_mask:0xf bank_mask:0xf
v_and_b32_dpp v65, v76, v9 row_newbcast:5 row_mask:0xf bank_mask:0xf
v_and_b32_dpp v66, v76, v10 row_newbcast:5 row_mask:0xf bank_mask:0xf
v_and_b32_dpp v67, v76, v11 row_newbcast:5 row_mask:0xf bank_mask:0xf
v_and_b32_dpp v68, v76, v8 row_newbcast:9 row_mask:0xf bank_mask:0xf
v_and_b32_dpp v69, v76, v9 row_newbcast:9 row_mask:0xf bank_mask:0xf
v_and_b32_dpp v70, v76, v10 row_newbcast:9 row_mask:0xf bank_mask:0xf
v_and_b32_dpp v71, v76, v11 row_newbcast:9 row_mask:0xf bank_mask:0xf
v_and_b32_dpp v72, v76, v8 row_newbcast:13 row_mask:0xf bank_mask:0xf
v_and_b32_dpp v73, v76, v9 row_newbcast:13 row_mask:0xf bank_mask:0xf
v_and_b32_dpp v74, v76, v10 row_newbcast:13 row_mask:0xf bank_mask:0xf
v_and_b32_dpp v75, v76, v11 row_newbcast:13 row_mask:0xf bank_mask:0xf
s_waitcnt vmcnt(28)
v_mfma_f32_16x16x32_bf16 v[20:23], v[60:63], v[196:199], v[20:23]
v_mfma_f32_16x16x32_bf16 v[20:23], v[64:67], v[200:203], v[20:23]
v_mfma_f32_16x16x32_bf16 v[20:23], v[68:71], v[204:207], v[20:23]
v_mfma_f32_16x16x32_bf16 v[20:23], v[72:75], v[208:211], v[20:23]
buffer_load_dwordx4 v[196:199], v2, s[52:55], s12 offen offset:0 nt
buffer_load_dwordx4 v[200:203], v2, s[52:55], s12 offen offset:1024 nt
buffer_load_dwordx4 v[204:207], v2, s[52:55], s12 offen offset:2048 nt
buffer_load_dwordx4 v[208:211], v2, s[52:55], s12 offen offset:3072 nt
s_add_u32 s13, s13, 24576
s_min_u32 s12, s13, 2146435072
v_and_b32_dpp v60, v76, v8 row_newbcast:2 row_mask:0xf bank_mask:0xf
v_and_b32_dpp v61, v76, v9 row_newbcast:2 row_mask:0xf bank_mask:0xf
v_and_b32_dpp v62, v76, v10 row_newbcast:2 row_mask:0xf bank_mask:0xf
v_and_b32_dpp v63, v76, v11 row_newbcast:2 row_mask:0xf bank_mask:0xf
v_and_b32_dpp v64, v76, v8 row_newbcast:6 row_mask:0xf bank_mask:0xf
v_and_b32_dpp v65, v76, v9 row_newbcast:6 row_mask:0xf bank_mask:0xf
v_and_b32_dpp v66, v76, v10 row_newbcast:6 row_mask:0xf bank_mask:0xf
v_and_b32_dpp v67, v76, v11 row_newbcast:6 row_mask:0xf bank_mask:0xf
v_and_b32_dpp v68, v76, v8 row_newbcast:10 row_mask:0xf bank_mask:0xf
v_and_b32_dpp v69, v76, v9 row_newbcast:10 row_mask:0xf bank_mask:0xf
v_and_b32_dpp v70, v76, v10 row_newbcast:10 row_mask:0xf bank_mask:0xf
v_and_b32_dpp v71, v76, v11 row_newbcast:10 row_mask:0xf bank_mask:0xf
v_and_b32_dpp v72, v76, v8 row_newbcast:14 row_mask:0xf bank_mask:0xf
v_and_b32_dpp v73, v76, v9 row_newbcast:14 row_mask:0xf bank_mask:0xf
v_and_b32_dpp v74, v76, v10 row_newbcast:14 row_mask:0xf bank_mask:0xf
v_and_b32_dpp v75, v76, v11 row_newbcast:14 row_mask:0xf bank_mask:0xf
s_waitcnt vmcnt(28)
v_mfma_f32_16x16x32_bf16 v[20:23], v[60:63], v[212:215], v[20:23]
v_mfma_f32_16x16x32_bf16 v[20:23], v[64:67], v[216:219], v[20:23]
v_mfma_f32_16x16x32_bf16 v[20:23], v[68:71], v[220:223], v[20:23]
v_mfma_f32_16x16x32_bf16 v[20:23], v[72:75], v[224:227], v[20:23]
buffer_load_dwordx4 v[212:215], v2, s[52:55], s12 offen offset:0 nt
buffer_load_dwordx4 v[216:219], v2, s[52:55], s12 offen offset:1024 nt
buffer_load_dwordx4 v[220:223], v2, s[52:55], s12 offen offset:2048 nt
buffer_load_dwordx4 v[224:227], v2, s[52:55], s12 offen offset:3072 nt
s_add_u32 s13, s13, 24576
s_min_u32 s12, s13, 2146435072
s_cmp_ge_u32 s80, 36
s_cbranch_scc1 L_nodma_12
s_mov_b32 m0, s15
s_nop 0
buffer_load_dwordx4 v2, s[60:63], s15 offen nt lds
s_add_u32 s15, s15, 1024
L_nodma_12:
s_add_u32 s80, s80, 1
v_and_b32_dpp v60, v76, v8 row_newbcast:3 row_mask:0xf bank_mask:0xf
v_and_b32_dpp v61, v76, v9 row_newbcast:3 row_mask:0xf bank_mask:0xf
v_and_b32_dpp v62, v76, v10 row_newbcast:3 row_mask:0xf bank_mask:0xf
v_and_b32_dpp v63, v76, v11 row_newbcast:3 row_mask:0xf bank_mask:0xf
v_and_b32_dpp v64, v76, v8 row_newbcast:7 row_mask:0xf bank_mask:0xf
v_and_b32_dpp v65, v76, v9 row_newbcast:7 row_mask:0xf bank_mask:0xf
v_and_b32_dpp v66, v76, v10 row_newbcast:7 row_mask:0xf bank_mask:0xf
v_and_b32_dpp v67, v76, v11 row_newbcast:7 row_mask:0xf bank_mask:0xf
v_and_b32_dpp v68, v76, v8 row_newbcast:11 row_mask:0xf bank_mask:0xf
v_and_b32_dpp v69, v76, v9 row_newbcast:11 row_mask:0xf bank_mask:0xf
v_and_b32_dpp v70, v76, v10 row_newbcast:11 row_mask:0xf bank_mask:0xf
v_and_b32_dpp v71, v76, v11 row_newbcast:11 row_mask:0xf bank_mask:0xf
v_and_b32_dpp v72, v76, v8 row_newbcast:15 row_mask:0xf bank_mask:0xf
v_and_b32_dpp v73, v76, v9 row_newbcast:15 row_mask:0xf bank_mask:0xf
v_and_b32_dpp v74, v76, v10 row_newbcast:15 row_mask:0xf bank_mask:0xf
v_and_b32_dpp v75, v76, v11 row_newbcast:15 row_mask:0xf bank_mask:0xf
s_waitcnt vmcnt(28)
v_mfma_f32_16x16x32_bf16 v[20:23], v[60:63], v[228:231], v[20:23]
v_mfma_f32_16x16x32_bf16 v[20:23], v[64:67], v[232:235], v[20:23]
v_mfma_f32_16x16x32_bf16 v[20:23], v[68:71], v[236:239], v[20:23]
v_mfma_f32_16x16x32_bf16 v[20:23], v[72:75], v[240:243], v[20:23]
s_add_u32 s81, s81, 1
s_cmp_eq_u32 s81, 22
s_cbranch_scc1 A_tail
buffer_load_dwordx4 v[228:231], v2, s[52:55], s12 offen offset:0 nt
buffer_load_dwordx4 v[232:235], v2, s[52:55], s12 offen offset:1024 nt
buffer_load_dwordx4 v[236:239], v2, s[52:55], s12 offen offset:2048 nt
buffer_load_dwordx4 v[240:243], v2, s[52:55], s12 offen offset:3072 nt
s_add_u32 s13, s13, 24576
s_min_u32 s12, s13, 2146435072
v_mov_b32 v76, v77
v_mov_b32 v77, v78
v_mov_b32 v78, v79
v_mov_b32 v79, v80
v_mov_b32 v80, v81
v_mov_b32 v81, v82
v_mov_b32 v82, v83
v_mov_b32 v83, v84
v_mov_b32 v84, v85
v_mov_b32 v85, v86
s_branch V_loop
A_ev1:
s_barrier
ds_read_b64_tr_b16 a[96:97], v88 offset:0
ds_read_b64_tr_b16 a[98:99], v88 offset:4608
ds_read_b64_tr_b16 a[100:101], v88 offset:36864
ds_read_b64_tr_b16 a[102:103], v88 offset:41472
ds_read_b64_tr_b16 a[104:105], v90 offset:0
ds_read_b64_tr_b16 a[106:107], v90 offset:4608
ds_read_b64_tr_b16 a[108:109], v90 offset:36864
ds_read_b64_tr_b16 a[110:111], v90 offset:41472
ds_read_b64_tr_b16 a[112:113], v88 offset:8
ds_read_b64_tr_b16 a[114:115], v88 offset:4616
ds_read_b64_tr_b16 a[116:117], v88 offset:36872
ds_read_b64_tr_b16 a[118:119], v88 offset:41480
ds_read_b64_tr_b16 a[120:121], v90 offset:8
ds_read_b64_tr_b16 a[122:123], v90 offset:4616
ds_read_b64_tr_b16 a[124:125], v90 offset:36872
ds_read_b64_tr_b16 a[126:127], v90 offset:41480
ds_read_b64_tr_b16 a[128:129], v88 offset:16
ds_read_b64_tr_b16 a[130:131], v88 offset:4624
ds_read_b64_tr_b16 a[132:133], v88 offset:36880
ds_read_b64_tr_b16 a[134:135], v88 offset:41488
ds_read_b64_tr_b16 a[136:137], v90 offset:16
ds_read_b64_tr_b16 a[138:139], v90 offset:4624
ds_read_b64_tr_b16 a[140:141], v90 offset:36880
ds_read_b64_tr_b16 a[142:143], v90 offset:41488
ds_read_b64_tr_b16 a[144:145], v88 offset:24
ds_read_b64_tr_b16 a[146:147], v88 offset:4632
ds_read_b64_tr_b16 a[148:149], v88 offset:36888
ds_read_b64_tr_b16 a[150:151], v88 offset:41496
ds_read_b64_tr_b16 a[152:153], v90 offset:24
ds_read_b64_tr_b16 a[154:155], v90 offset:4632
ds_read_b64_tr_b16 a[156:157], v90 offset:36888
ds_read_b64_tr_b16 a[158:159], v90 offset:41496
ds_read_b64_tr_b16 a[160:161], v88 offset:128
ds_read_b64_tr_b16 a[162:163], v88 offset:4736
ds_read_b64_tr_b16 a[164:165], v88 offset:36992
ds_read_b64_tr_b16 a[166:167], v88 offset:41600
ds_read_b64_tr_b16 a[168:169], v90 offset:128
ds_read_b64_tr_b16 a[170:171], v90 offset:4736
ds_read_b64_tr_b16 a[172:173], v90 offset:36992
ds_read_b64_tr_b16 a[174:175], v90 offset:41600
ds_read_b64_tr_b16 a[176:177], v88 offset:136
ds_read_b64_tr_b16 a[178:179], v88 offset:4744
ds_read_b64_tr_b16 a[180:181], v88 offset:37000
ds_read_b64_tr_b16 a[182:183], v88 offset:41608
ds_read_b64_tr_b16 a[184:185], v90 offset:136
ds_read_b64_tr_b16 a[186:187], v90 offset:4744
ds_read_b64_tr_b16 a[188:189], v90 offset:37000
ds_read_b64_tr_b16 a[190:191], v90 offset:41608
ds_read_b64_tr_b16 a[192:193], v88 offset:144
ds_read_b64_tr_b16 a[194:195], v88 offset:4752
ds_read_b64_tr_b16 a[196:197], v88 offset:37008
ds_read_b64_tr_b16 a[198:199], v88 offset:41616
ds_read_b64_tr_b16 a[200:201], v90 offset:144
ds_read_b64_tr_b16 a[202:203], v90 offset:4752
ds_read_b64_tr_b16 a[204:205], v90 offset:37008
ds_read_b64_tr_b16 a[206:207], v90 offset:41616
ds_read_b64_tr_b16 a[208:209], v88 offset:152
ds_read_b64_tr_b16 a[210:211], v88 offset:4760
ds_read_b64_tr_b16 a[212:213], v88 offset:37016
ds_read_b64_tr_b16 a[214:215], v88 offset:41624
ds_read_b64_tr_b16 a[216:217], v90 offset:152
ds_read_b64_tr_b16 a[218:219], v90 offset:4760
ds_read_b64_tr_b16 a[220:221], v90 offset:37016
ds_read_b64_tr_b16 a[222:223], v90 offset:41624
ds_read_b64_tr_b16 a[224:225], v89 offset:0
ds_read_b64_tr_b16 a[226:227], v89 offset:4608
ds_read_b64_tr_b16 a[228:229], v89 offset:36864
ds_read_b64_tr_b16 a[230:231], v89 offset:41472
ds_read_b64_tr_b16 a[232:233], v91 offset:0
ds_read_b64_tr_b16 a[234:235], v91 offset:4608
ds_read_b64_tr_b16 a[236:237], v91 offset:36864
ds_read_b64_tr_b16 a[238:239], v91 offset:41472
s_branch A_ev1_ret
A_ev2:
s_mov_b32 s7, 400000
A_ev2_chk:
v_max3_u32 v35, v40, v41, v42
v_max3_u32 v35, v35, v43, v44
v_max3_u32 v35, v35, v45, v46
v_max3_u32 v35, v35, v47, v48
v_max3_u32 v35, v35, v49, v50
v_max_u32 v35, v35, v51
v_cmp_eq_u32 vcc, -1, v35
s_cbranch_vccz A_ev2_ok
buffer_load_dwordx4 v[40:43], off, s[64:67], s82 offset:0 sc1
buffer_load_dwordx4 v[44:47], off, s[64:67], s82 offset:16 sc1
buffer_load_dwordx4 v[48:51], off, s[64:67], s82 offset:32 sc1
s_waitcnt vmcnt(0)
s_sub_u32 s7, s7, 1
s_cmp_lg_u32 s7, 0
s_cbranch_scc1 A_ev2_chk
A_ev2_ok:
v_max3_f32 v35, v40, v42, v44
v_max3_f32 v36, v46, v48, v50
v_max_f32 v35, v35, v36
v_sub_f32 v40, v40, v35
v_sub_f32 v42, v42, v35
v_sub_f32 v44, v44, v35
v_sub_f32 v46, v46, v35
v_sub_f32 v48, v48, v35
v_sub_f32 v50, v50, v35
v_sub_f32 v37, v32, v35
v_exp_f32 v40, v40
v_exp_f32 v42, v42
v_exp_f32 v44, v44
v_exp_f32 v46, v46
v_exp_f32 v48, v48
v_exp_f32 v50, v50
v_exp_f32 v37, v37
v_mul_f32 v35, v40, v41
v_fma_f32 v35, v42, v43, v35
v_fma_f32 v35, v44, v45, v35
v_fma_f32 v35, v46, v47, v35
v_fma_f32 v35, v48, v49, v35
v_fma_f32 v35, v50, v51, v35
v_rcp_f32 v35, v35
s_nop 0
v_mul_f32 v37, v37, v35
s_branch A_ev2_ret
A_tail:
s_nop 4
v_mul_f32 v20, v20, v37
v_mul_f32 v21, v21, v37
v_mul_f32 v22, v22, v37
v_mul_f32 v23, v23, v37
v_cvt_pk_bf16_f32 v28, v20, v21
v_cvt_pk_bf16_f32 v29, v22, v23
ds_write_b64 v94, v[28:29]
s_waitcnt lgkmcnt(0)
s_barrier
ds_read_b128 a[0:3], v95 offset:0
ds_read_b128 a[4:7], v95 offset:64
ds_read_b128 a[8:11], v95 offset:128
ds_read_b128 a[12:15], v95 offset:192
s_waitcnt lgkmcnt(0)
v_mfma_f32_16x16x32_bf16 v[72:75], a[0:3], a[224:227], 0
v_mfma_f32_16x16x32_bf16 v[72:75], a[4:7], a[228:231], v[72:75]
v_mfma_f32_16x16x32_bf16 v[72:75], a[8:11], a[232:235], v[72:75]
v_mfma_f32_16x16x32_bf16 v[72:75], a[12:15], a[236:239], v[72:75]
v_mfma_f32_16x16x32_bf16 v[40:43], a[0:3], a[96:99], 0
v_mfma_f32_16x16x32_bf16 v[40:43], a[4:7], a[100:103], v[40:43]
v_mfma_f32_16x16x32_bf16 v[40:43], a[8:11], a[104:107], v[40:43]
v_mfma_f32_16x16x32_bf16 v[40:43], a[12:15], a[108:111], v[40:43]
v_mfma_f32_16x16x32_bf16 v[44:47], a[0:3], a[112:115], 0
v_mfma_f32_16x16x32_bf16 v[44:47], a[4:7], a[116:119], v[44:47]
v_mfma_f32_16x16x32_bf16 v[44:47], a[8:11], a[120:123], v[44:47]
v_mfma_f32_16x16x32_bf16 v[44:47], a[12:15], a[124:127], v[44:47]
v_mul_f32 v114, v106, v72
v_fma_f32 v114, v107, v73, v114
v_fma_f32 v114, v108, v74, v114
v_fma_f32 v114, v109, v75, v114
v_mfma_f32_16x16x32_bf16 v[48:51], a[0:3], a[128:131], 0
v_mfma_f32_16x16x32_bf16 v[48:51], a[4:7], a[132:135], v[48:51]
v_mfma_f32_16x16x32_bf16 v[48:51], a[8:11], a[136:139], v[48:51]
v_mfma_f32_16x16x32_bf16 v[48:51], a[12:15], a[140:143], v[48:51]
v_min_u32 v114, -2, v114
s_mov_b64 exec, 0xffffffff
buffer_store_dword v114, v93, s[64:67], 0 offen offset:512 sc1
s_mov_b64 exec, -1
v_mul_f32 v110, v98, v40
v_fma_f32 v110, v99, v41, v110
v_fma_f32 v110, v100, v42, v110
v_fma_f32 v110, v101, v43, v110
v_mfma_f32_16x16x32_bf16 v[52:55], a[0:3], a[144:147], 0
v_mfma_f32_16x16x32_bf16 v[52:55], a[4:7], a[148:151], v[52:55]
v_mfma_f32_16x16x32_bf16 v[52:55], a[8:11], a[152:155], v[52:55]
v_mfma_f32_16x16x32_bf16 v[52:55], a[12:15], a[156:159], v[52:55]
v_mul_f32 v111, v98, v44
v_fma_f32 v111, v99, v45, v111
v_fma_f32 v111, v100, v46, v111
v_fma_f32 v111, v101, v47, v111
v_mfma_f32_16x16x32_bf16 v[56:59], a[0:3], a[160:163], 0
v_mfma_f32_16x16x32_bf16 v[56:59], a[4:7], a[164:167], v[56:59]
v_mfma_f32_16x16x32_bf16 v[56:59], a[8:11], a[168:171], v[56:59]
v_mfma_f32_16x16x32_bf16 v[56:59], a[12:15], a[172:175], v[56:59]
v_mul_f32 v112, v98, v48
v_fma_f32 v112, v99, v49, v112
v_fma_f32 v112, v100, v50, v112
v_fma_f32 v112, v101, v51, v112
v_mfma_f32_16x16x32_bf16 v[60:63], a[0:3], a[176:179], 0
v_mfma_f32_16x16x32_bf16 v[60:63], a[4:7], a[180:183], v[60:63]
v_mfma_f32_16x16x32_bf16 v[60:63], a[8:11], a[184:187], v[60:63]
v_mfma_f32_16x16x32_bf16 v[60:63], a[12:15], a[188:191], v[60:63]
v_mul_f32 v113, v98, v52
v_fma_f32 v113, v99, v53, v113
v_fma_f32 v113, v100, v54, v113
v_fma_f32 v113, v101, v55, v113
v_mfma_f32_16x16x32_bf16 v[64:67], a[0:3], a[192:195], 0
v_mfma_f32_16x16x32_bf16 v[64:67], a[4:7], a[196:199], v[64:67]
v_mfma_f32_16x16x32_bf16 v[64:67], a[8:11], a[200:203], v[64:67]
v_mfma_f32_16x16x32_bf16 v[64:67], a[12:15], a[204:207], v[64:67]
v_fma_f32 v110, v102, v56, v110
v_fma_f32 v110, v103, v57, v110
v_fma_f32 v110, v104, v58, v110
v_fma_f32 v110, v105, v59, v110
v_mfma_f32_16x16x32_bf16 v[68:71], a[0:3], a[208:211], 0
v_mfma_f32_16x16x32_bf16 v[68:71], a[4:7], a[212:215], v[68:71]
v_mfma_f32_16x16x32_bf16 v[68:71], a[8:11], a[216:219], v[68:71]
v_mfma_f32_16x16x32_bf16 v[68:71], a[12:15], a[220:223], v[68:71]
v_fma_f32 v111, v102, v60, v111
v_fma_f32 v111, v103, v61, v111
v_fma_f32 v111, v104, v62, v111
v_fma_f32 v111, v105, v63, v111
v_fma_f32 v112, v102, v64, v112
v_fma_f32 v112, v103, v65, v112
v_fma_f32 v112, v104, v66, v112
v_fma_f32 v112, v105, v67, v112
v_min_u32 v110, -2, v110
v_min_u32 v111, -2, v111
v_min_u32 v112, -2, v112
v_fma_f32 v113, v102, v68, v113
v_fma_f32 v113, v103, v69, v113
v_fma_f32 v113, v104, v70, v113
v_fma_f32 v113, v105, v71, v113
v_min_u32 v113, -2, v113
buffer_store_dwordx4 v[110:113], v92, s[64:67], 0 offen sc1
s_endpgm
L_exit:
s_endpgm
B_role:
s_mov_b32 s8, s5
s_lshl_b32 s9, s4, 1
s_add_u32 s9, s9, s8
s_lshr_b32 s10, s9, 4
s_and_b32 s11, s9, 15
v_and_b32 v1, 63, v0
v_lshlrev_b32 v2, 4, v1
v_lshrrev_b32 v9, 4, v1
v_and_b32 v8, 15, v1
s_waitcnt lgkmcnt(0)
s_mul_i32 s6, s3, 288
s_sub_u32 s7, 4608, s6
s_add_u32 s44, s26, s6
s_addc_u32 s45, s27, 0
s_mov_b32 s46, s7
s_mov_b32 s47, 0x20000
s_mul_i32 s6, s3, 1179648
s_lshl_b32 s7, s4, 8
s_add_u32 s6, s6, s7
s_sub_u32 s7, 4718592, s6
s_add_u32 s48, s30, s6
s_addc_u32 s49, s31, 0
s_mov_b32 s50, s7
s_mov_b32 s51, 0x20000
s_lshl_b32 s6, s8, 2
s_add_u32 s6, s6, s3
s_lshl_b32 s6, s6, 19
s_lshl_b32 s7, s4, 8
s_add_u32 s6, s6, s7
s_sub_u32 s7, 4194304, s6
s_add_u32 s76, s32, s6
s_addc_u32 s77, s33, 0
s_mov_b32 s78, s7
s_mov_b32 s79, 0x20000
s_lshl_b32 s6, s9, 18
s_add_u32 s52, s28, s6
s_addc_u32 s53, s29, 0
s_mov_b32 s54, 262144
s_mov_b32 s55, 0x20000
v_mul_u32_u24 v3, 294912, v9
v_lshl_add_u32 v3, v8, 4, v3
v_mul_u32_u24 v4, 72, v9
v_lshrrev_b32 v6, 3, v8
v_mul_u32_u24 v6, 1152, v6
v_add_u32 v4, v4, v6
v_lshlrev_b32 v220, 17, v9
v_lshl_add_u32 v220, v8, 4, v220
v_xor_b32 v10, 32, v2
s_mov_b32 s64, s42
s_mov_b32 s65, s43
s_mov_b32 s66, 6291456
s_mov_b32 s67, 0x20000
buffer_load_dwordx4 v[24:27], v4, s[44:47], 0 offen offset:0
buffer_load_dwordx4 v[28:31], v4, s[44:47], 0 offen offset:16
buffer_load_dwordx4 v[32:35], v4, s[44:47], 0 offen offset:32
buffer_load_dwordx4 v[36:39], v4, s[44:47], 0 offen offset:48
buffer_load_dwordx2 v[40:41], v4, s[44:47], 0 offen offset:64
buffer_load_dwordx4 v[42:45], v4, s[44:47], 0 offen offset:2304
buffer_load_dwordx4 v[46:49], v4, s[44:47], 0 offen offset:2320
buffer_load_dwordx4 v[50:53], v4, s[44:47], 0 offen offset:2336
buffer_load_dwordx4 v[54:57], v4, s[44:47], 0 offen offset:2352
buffer_load_dwordx2 v[58:59], v4, s[44:47], 0 offen offset:2368
s_cmp_lg_u32 s3, 0
s_cbranch_scc1 L_noclr_13
v_mov_b32 v188, -1
v_mov_b32 v189, -1
v_mov_b32 v190, -1
v_mov_b32 v191, -1
v_lshrrev_b32 v5, 5, v1
v_lshlrev_b32 v5, 15, v5
v_and_b32 v6, 31, v1
v_lshl_add_u32 v5, v6, 4, v5
v_lshlrev_b32 v6, 9, v6
s_lshl_b32 s6, s9, 9
s_add_u32 s7, s6, 65536
s_add_u32 s6, s6, 0
buffer_store_dwordx4 v[188:191], v5, s[64:67], s6 offen sc1
buffer_store_dwordx4 v[188:191], v5, s[64:67], s7 offen sc1
s_lshl_b32 s6, s9, 3
s_add_u32 s6, s6, 262144
s_mov_b64 exec, 0xffffffff
buffer_store_dwordx2 v[188:189], v6, s[64:67], s6 offen sc1
s_lshl_b32 s6, s9, 7
s_add_u32 s6, s6, 327680
s_mov_b64 exec, 0xff
buffer_store_dwordx4 v[188:191], v2, s[64:67], s6 offen sc1
s_mov_b64 exec, -1
s_mul_i32 s6, s9, 9216
s_add_u32 s6, s6, 4194304
buffer_store_dwordx4 v[188:191], v2, s[64:67], s6 offen offset:0 sc1
buffer_store_dwordx4 v[188:191], v2, s[64:67], s6 offen offset:1024 sc1
buffer_store_dwordx4 v[188:191], v2, s[64:67], s6 offen offset:2048 sc1
buffer_store_dwordx4 v[188:191], v2, s[64:67], s6 offen offset:3072 sc1
s_add_u32 s6, s6, 4096
buffer_store_dwordx4 v[188:191], v2, s[64:67], s6 offen offset:0 sc1
buffer_store_dwordx4 v[188:191], v2, s[64:67], s6 offen offset:1024 sc1
buffer_store_dwordx4 v[188:191], v2, s[64:67], s6 offen offset:2048 sc1
buffer_store_dwordx4 v[188:191], v2, s[64:67], s6 offen offset:3072 sc1
s_add_u32 s6, s6, 4096
buffer_store_dwordx4 v[188:191], v2, s[64:67], s6 offen offset:0 sc1
L_noclr_13:
s_mov_b32 s6, 0
buffer_load_dwordx4 a[96:99], v3, s[48:51], s6 offen nt
s_mov_b32 s6, 8192
buffer_load_dwordx4 a[100:103], v3, s[48:51], s6 offen nt
s_mov_b32 s6, 16384
buffer_load_dwordx4 a[104:107], v3, s[48:51], s6 offen nt
s_mov_b32 s6, 24576
buffer_load_dwordx4 a[108:111], v3, s[48:51], s6 offen nt
s_mov_b32 s6, 32768
buffer_load_dwordx4 a[112:115], v3, s[48:51], s6 offen nt
s_mov_b32 s6, 40960
buffer_load_dwordx4 a[116:119], v3, s[48:51], s6 offen nt
s_mov_b32 s6, 49152
buffer_load_dwordx4 a[120:123], v3, s[48:51], s6 offen nt
s_mov_b32 s6, 57344
buffer_load_dwordx4 a[124:127], v3, s[48:51], s6 offen nt
s_mov_b32 s6, 65536
buffer_load_dwordx4 a[128:131], v3, s[48:51], s6 offen nt
s_mov_b32 s6, 73728
buffer_load_dwordx4 a[132:135], v3, s[48:51], s6 offen nt
s_mov_b32 s6, 81920
buffer_load_dwordx4 a[136:139], v3, s[48:51], s6 offen nt
s_mov_b32 s6, 90112
buffer_load_dwordx4 a[140:143], v3, s[48:51], s6 offen nt
s_mov_b32 s6, 98304
buffer_load_dwordx4 a[144:147], v3, s[48:51], s6 offen nt
s_mov_b32 s6, 106496
buffer_load_dwordx4 a[148:151], v3, s[48:51], s6 offen nt
s_mov_b32 s6, 114688
buffer_load_dwordx4 a[152:155], v3, s[48:51], s6 offen nt
s_mov_b32 s6, 122880
buffer_load_dwordx4 a[156:159], v3, s[48:51], s6 offen nt
s_mov_b32 s6, 131072
buffer_load_dwordx4 a[160:163], v3, s[48:51], s6 offen nt
s_mov_b32 s6, 139264
buffer_load_dwordx4 a[164:167], v3, s[48:51], s6 offen nt
s_mov_b32 s6, 147456
buffer_load_dwordx4 a[168:171], v3, s[48:51], s6 offen nt
s_mov_b32 s6, 155648
buffer_load_dwordx4 a[172:175], v3, s[48:51], s6 offen nt
s_mov_b32 s6, 163840
buffer_load_dwordx4 a[176:179], v3, s[48:51], s6 offen nt
s_mov_b32 s6, 172032
buffer_load_dwordx4 a[180:183], v3, s[48:51], s6 offen nt
s_mov_b32 s6, 180224
buffer_load_dwordx4 a[184:187], v3, s[48:51], s6 offen nt
s_mov_b32 s6, 188416
buffer_load_dwordx4 a[188:191], v3, s[48:51], s6 offen nt
s_mov_b32 s6, 196608
buffer_load_dwordx4 a[192:195], v3, s[48:51], s6 offen nt
s_mov_b32 s6, 204800
buffer_load_dwordx4 a[196:199], v3, s[48:51], s6 offen nt
s_mov_b32 s6, 212992
buffer_load_dwordx4 a[200:203], v3, s[48:51], s6 offen nt
s_mov_b32 s6, 221184
buffer_load_dwordx4 a[204:207], v3, s[48:51], s6 offen nt
s_mov_b32 s6, 229376
buffer_load_dwordx4 a[208:211], v3, s[48:51], s6 offen nt
s_mov_b32 s6, 237568
buffer_load_dwordx4 a[212:215], v3, s[48:51], s6 offen nt
s_mov_b32 s6, 245760
buffer_load_dwordx4 a[216:219], v3, s[48:51], s6 offen nt
s_mov_b32 s6, 253952
buffer_load_dwordx4 a[220:223], v3, s[48:51], s6 offen nt
s_mov_b32 s6, 262144
buffer_load_dwordx4 a[224:227], v3, s[48:51], s6 offen nt
s_mov_b32 s6, 270336
buffer_load_dwordx4 a[228:231], v3, s[48:51], s6 offen nt
s_mov_b32 s6, 278528
buffer_load_dwordx4 a[232:235], v3, s[48:51], s6 offen nt
s_mov_b32 s6, 286720
buffer_load_dwordx4 a[236:239], v3, s[48:51], s6 offen nt
s_mov_b32 s6, 0
buffer_load_dwordx4 v[84:87], v220, s[76:79], s6 offen nt
s_mov_b32 s6, 8192
buffer_load_dwordx4 v[88:91], v220, s[76:79], s6 offen nt
s_mov_b32 s6, 16384
buffer_load_dwordx4 v[92:95], v220, s[76:79], s6 offen nt
s_mov_b32 s68, s40
s_mov_b32 s69, s41
s_mov_b32 s70, 256
s_mov_b32 s71, 0x20000
s_mov_b32 s72, s38
s_mov_b32 s73, s39
s_mov_b32 s74, 9216
s_mov_b32 s75, 0x20000
v_and_b32 v5, 1, v1
v_lshlrev_b32 v5, 4, v5
v_mov_b32 v6, 0xffff
v_lshlrev_b32 v5, v5, v6
v_bfe_u32 v6, v1, 1, 2
v_cmp_eq_u32 vcc, 0, v6
s_nop 1
v_cndmask_b32 v12, 0, v5, vcc
v_cmp_eq_u32 vcc, 1, v6
s_nop 1
v_cndmask_b32 v13, 0, v5, vcc
v_cmp_eq_u32 vcc, 2, v6
s_nop 1
v_cndmask_b32 v14, 0, v5, vcc
v_cmp_eq_u32 vcc, 3, v6
s_nop 1
v_cndmask_b32 v15, 0, v5, vcc
v_mov_b32 v5, 0x0c0c0c0c
s_mov_b32 s6, 0x01000100
s_mov_b32 s7, 0x03020302
v_bfi_b32 v16, v12, s6, v5
v_bfi_b32 v17, v13, s6, v5
v_bfi_b32 v18, v14, s6, v5
v_bfi_b32 v19, v15, s6, v5
v_bfi_b32 v20, v12, s7, v5
v_bfi_b32 v21, v13, s7, v5
v_bfi_b32 v22, v14, s7, v5
v_bfi_b32 v23, v15, s7, v5
s_mul_i32 s12, s3, 17408
s_lshl_b32 s13, s3, 14
s_waitcnt vmcnt(38)
s_cmp_lg_u32 s3, 0
s_cbranch_scc1 L_sig0_14
v_mov_b32 v7, 1
s_mov_b64 exec, 1
buffer_atomic_add v7, off, s[68:71], 0 offset:0
s_mov_b64 exec, -1
L_sig0_14:
s_mov_b32 s6, 24576
buffer_load_dwordx4 v[96:99], v220, s[76:79], s6 offen nt
s_mov_b32 s6, 32768
buffer_load_dwordx4 v[100:103], v220, s[76:79], s6 offen nt
s_mov_b32 s6, 40960
buffer_load_dwordx4 v[104:107], v220, s[76:79], s6 offen nt
s_mov_b32 s6, 49152
buffer_load_dwordx4 v[108:111], v220, s[76:79], s6 offen nt
s_mov_b32 s6, 57344
buffer_load_dwordx4 v[112:115], v220, s[76:79], s6 offen nt
s_mov_b32 s6, 65536
buffer_load_dwordx4 v[116:119], v220, s[76:79], s6 offen nt
s_mov_b32 s6, 73728
buffer_load_dwordx4 v[120:123], v220, s[76:79], s6 offen nt
s_mov_b32 s6, 81920
buffer_load_dwordx4 v[124:127], v220, s[76:79], s6 offen nt
s_mov_b32 s6, 90112
buffer_load_dwordx4 v[128:131], v220, s[76:79], s6 offen nt
s_mov_b32 s6, 98304
buffer_load_dwordx4 v[132:135], v220, s[76:79], s6 offen nt
s_mov_b32 s6, 106496
buffer_load_dwordx4 v[136:139], v220, s[76:79], s6 offen nt
s_mov_b32 s6, 114688
buffer_load_dwordx4 v[140:143], v220, s[76:79], s6 offen nt
s_mov_b32 s6, 122880
buffer_load_dwordx4 v[144:147], v220, s[76:79], s6 offen nt
v_perm_b32 v60, v24, v24, v16
v_perm_b32 v61, v24, v24, v17
v_perm_b32 v62, v24, v24, v18
v_perm_b32 v63, v24, v24, v19
s_nop 1
v_mfma_f32_16x16x32_bf16 v[76:79], v[60:63], a[96:99], 0
v_perm_b32 v64, v42, v42, v16
v_perm_b32 v65, v42, v42, v17
v_perm_b32 v66, v42, v42, v18
v_perm_b32 v67, v42, v42, v19
s_nop 1
v_mfma_f32_16x16x32_bf16 v[80:83], v[64:67], a[96:99], 0
s_add_u32 m0, s12, 0
s_add_u32 s6, s13, 0
buffer_load_dwordx4 v2, s[52:55], s6 offen nt lds
s_waitcnt vmcnt(51)
v_perm_b32 v68, v24, v24, v20
v_perm_b32 v69, v24, v24, v21
v_perm_b32 v70, v24, v24, v22
v_perm_b32 v71, v24, v24, v23
s_nop 1
v_mfma_f32_16x16x32_bf16 v[76:79], v[68:71], a[100:103], v[76:79]
v_perm_b32 v72, v42, v42, v20
v_perm_b32 v73, v42, v42, v21
v_perm_b32 v74, v42, v42, v22
v_perm_b32 v75, v42, v42, v23
s_nop 1
v_mfma_f32_16x16x32_bf16 v[80:83], v[72:75], a[100:103], v[80:83]
s_add_u32 m0, s12, 1088
s_add_u32 s6, s13, 1024
buffer_load_dwordx4 v2, s[52:55], s6 offen nt lds
s_waitcnt vmcnt(51)
v_perm_b32 v60, v25, v25, v16
v_perm_b32 v61, v25, v25, v17
v_perm_b32 v62, v25, v25, v18
v_perm_b32 v63, v25, v25, v19
s_nop 1
v_mfma_f32_16x16x32_bf16 v[76:79], v[60:63], a[104:107], v[76:79]
v_perm_b32 v64, v43, v43, v16
v_perm_b32 v65, v43, v43, v17
v_perm_b32 v66, v43, v43, v18
v_perm_b32 v67, v43, v43, v19
s_nop 1
v_mfma_f32_16x16x32_bf16 v[80:83], v[64:67], a[104:107], v[80:83]
s_add_u32 m0, s12, 2176
s_add_u32 s6, s13, 2048
buffer_load_dwordx4 v2, s[52:55], s6 offen nt lds
s_waitcnt vmcnt(51)
v_perm_b32 v68, v25, v25, v20
v_perm_b32 v69, v25, v25, v21
v_perm_b32 v70, v25, v25, v22
v_perm_b32 v71, v25, v25, v23
s_nop 1
v_mfma_f32_16x16x32_bf16 v[76:79], v[68:71], a[108:111], v[76:79]
v_perm_b32 v72, v43, v43, v20
v_perm_b32 v73, v43, v43, v21
v_perm_b32 v74, v43, v43, v22
v_perm_b32 v75, v43, v43, v23
s_nop 1
v_mfma_f32_16x16x32_bf16 v[80:83], v[72:75], a[108:111], v[80:83]
s_add_u32 m0, s12, 3264
s_add_u32 s6, s13, 3072
buffer_load_dwordx4 v2, s[52:55], s6 offen nt lds
s_waitcnt vmcnt(51)
v_perm_b32 v60, v26, v26, v16
v_perm_b32 v61, v26, v26, v17
v_perm_b32 v62, v26, v26, v18
v_perm_b32 v63, v26, v26, v19
s_nop 1
v_mfma_f32_16x16x32_bf16 v[76:79], v[60:63], a[112:115], v[76:79]
v_perm_b32 v64, v44, v44, v16
v_perm_b32 v65, v44, v44, v17
v_perm_b32 v66, v44, v44, v18
v_perm_b32 v67, v44, v44, v19
s_nop 1
v_mfma_f32_16x16x32_bf16 v[80:83], v[64:67], a[112:115], v[80:83]
s_add_u32 m0, s12, 4352
s_add_u32 s6, s13, 4096
buffer_load_dwordx4 v2, s[52:55], s6 offen nt lds
s_waitcnt vmcnt(51)
v_perm_b32 v68, v26, v26, v20
v_perm_b32 v69, v26, v26, v21
v_perm_b32 v70, v26, v26, v22
v_perm_b32 v71, v26, v26, v23
s_nop 1
v_mfma_f32_16x16x32_bf16 v[76:79], v[68:71], a[116:119], v[76:79]
v_perm_b32 v72, v44, v44, v20
v_perm_b32 v73, v44, v44, v21
v_perm_b32 v74, v44, v44, v22
v_perm_b32 v75, v44, v44, v23
s_nop 1
v_mfma_f32_16x16x32_bf16 v[80:83], v[72:75], a[116:119], v[80:83]
s_add_u32 m0, s12, 5440
s_add_u32 s6, s13, 5120
buffer_load_dwordx4 v2, s[52:55], s6 offen nt lds
s_waitcnt vmcnt(51)
v_perm_b32 v60, v27, v27, v16
v_perm_b32 v61, v27, v27, v17
v_perm_b32 v62, v27, v27, v18
v_perm_b32 v63, v27, v27, v19
s_nop 1
v_mfma_f32_16x16x32_bf16 v[76:79], v[60:63], a[120:123], v[76:79]
v_perm_b32 v64, v45, v45, v16
v_perm_b32 v65, v45, v45, v17
v_perm_b32 v66, v45, v45, v18
v_perm_b32 v67, v45, v45, v19
s_nop 1
v_mfma_f32_16x16x32_bf16 v[80:83], v[64:67], a[120:123], v[80:83]
s_add_u32 m0, s12, 6528
s_add_u32 s6, s13, 6144
buffer_load_dwordx4 v2, s[52:55], s6 offen nt lds
s_waitcnt vmcnt(51)
v_perm_b32 v68, v27, v27, v20
v_perm_b32 v69, v27, v27, v21
v_perm_b32 v70, v27, v27, v22
v_perm_b32 v71, v27, v27, v23
s_nop 1
v_mfma_f32_16x16x32_bf16 v[76:79], v[68:71], a[124:127], v[76:79]
v_perm_b32 v72, v45, v45, v20
v_perm_b32 v73, v45, v45, v21
v_perm_b32 v74, v45, v45, v22
v_perm_b32 v75, v45, v45, v23
s_nop 1
v_mfma_f32_16x16x32_bf16 v[80:83], v[72:75], a[124:127], v[80:83]
s_add_u32 m0, s12, 7616
s_add_u32 s6, s13, 7168
buffer_load_dwordx4 v2, s[52:55], s6 offen nt lds
s_waitcnt vmcnt(51)
v_perm_b32 v60, v28, v28, v16
v_perm_b32 v61, v28, v28, v17
v_perm_b32 v62, v28, v28, v18
v_perm_b32 v63, v28, v28, v19
s_nop 1
v_mfma_f32_16x16x32_bf16 v[76:79], v[60:63], a[128:131], v[76:79]
v_perm_b32 v64, v46, v46, v16
v_perm_b32 v65, v46, v46, v17
v_perm_b32 v66, v46, v46, v18
v_perm_b32 v67, v46, v46, v19
s_nop 1
v_mfma_f32_16x16x32_bf16 v[80:83], v[64:67], a[128:131], v[80:83]
s_add_u32 m0, s12, 8704
s_add_u32 s6, s13, 8192
buffer_load_dwordx4 v10, s[52:55], s6 offen nt lds
s_waitcnt vmcnt(51)
v_perm_b32 v68, v28, v28, v20
v_perm_b32 v69, v28, v28, v21
v_perm_b32 v70, v28, v28, v22
v_perm_b32 v71, v28, v28, v23
s_nop 1
v_mfma_f32_16x16x32_bf16 v[76:79], v[68:71], a[132:135], v[76:79]
v_perm_b32 v72, v46, v46, v20
v_perm_b32 v73, v46, v46, v21
v_perm_b32 v74, v46, v46, v22
v_perm_b32 v75, v46, v46, v23
s_nop 1
v_mfma_f32_16x16x32_bf16 v[80:83], v[72:75], a[132:135], v[80:83]
s_add_u32 m0, s12, 9792
s_add_u32 s6, s13, 9216
buffer_load_dwordx4 v10, s[52:55], s6 offen nt lds
s_waitcnt vmcnt(51)
v_perm_b32 v60, v29, v29, v16
v_perm_b32 v61, v29, v29, v17
v_perm_b32 v62, v29, v29, v18
v_perm_b32 v63, v29, v29, v19
s_nop 1
v_mfma_f32_16x16x32_bf16 v[76:79], v[60:63], a[136:139], v[76:79]
v_perm_b32 v64, v47, v47, v16
v_perm_b32 v65, v47, v47, v17
v_perm_b32 v66, v47, v47, v18
v_perm_b32 v67, v47, v47, v19
s_nop 1
v_mfma_f32_16x16x32_bf16 v[80:83], v[64:67], a[136:139], v[80:83]
s_add_u32 m0, s12, 10880
s_add_u32 s6, s13, 10240
buffer_load_dwordx4 v10, s[52:55], s6 offen nt lds
s_waitcnt vmcnt(51)
v_perm_b32 v68, v29, v29, v20
v_perm_b32 v69, v29, v29, v21
v_perm_b32 v70, v29, v29, v22
v_perm_b32 v71, v29, v29, v23
s_nop 1
v_mfma_f32_16x16x32_bf16 v[76:79], v[68:71], a[140:143], v[76:79]
v_perm_b32 v72, v47, v47, v20
v_perm_b32 v73, v47, v47, v21
v_perm_b32 v74, v47, v47, v22
v_perm_b32 v75, v47, v47, v23
s_nop 1
v_mfma_f32_16x16x32_bf16 v[80:83], v[72:75], a[140:143], v[80:83]
s_add_u32 m0, s12, 11968
s_add_u32 s6, s13, 11264
buffer_load_dwordx4 v10, s[52:55], s6 offen nt lds
s_waitcnt vmcnt(51)
v_perm_b32 v60, v30, v30, v16
v_perm_b32 v61, v30, v30, v17
v_perm_b32 v62, v30, v30, v18
v_perm_b32 v63, v30, v30, v19
s_nop 1
v_mfma_f32_16x16x32_bf16 v[76:79], v[60:63], a[144:147], v[76:79]
v_perm_b32 v64, v48, v48, v16
v_perm_b32 v65, v48, v48, v17
v_perm_b32 v66, v48, v48, v18
v_perm_b32 v67, v48, v48, v19
s_nop 1
v_mfma_f32_16x16x32_bf16 v[80:83], v[64:67], a[144:147], v[80:83]
s_add_u32 m0, s12, 13056
s_add_u32 s6, s13, 12288
buffer_load_dwordx4 v10, s[52:55], s6 offen nt lds
s_waitcnt vmcnt(51)
v_perm_b32 v68, v30, v30, v20
v_perm_b32 v69, v30, v30, v21
v_perm_b32 v70, v30, v30, v22
v_perm_b32 v71, v30, v30, v23
s_nop 1
v_mfma_f32_16x16x32_bf16 v[76:79], v[68:71], a[148:151], v[76:79]
v_perm_b32 v72, v48, v48, v20
v_perm_b32 v73, v48, v48, v21
v_perm_b32 v74, v48, v48, v22
v_perm_b32 v75, v48, v48, v23
s_nop 1
v_mfma_f32_16x16x32_bf16 v[80:83], v[72:75], a[148:151], v[80:83]
s_add_u32 m0, s12, 14144
s_add_u32 s6, s13, 13312
buffer_load_dwordx4 v10, s[52:55], s6 offen nt lds
s_waitcnt vmcnt(51)
v_perm_b32 v60, v31, v31, v16
v_perm_b32 v61, v31, v31, v17
v_perm_b32 v62, v31, v31, v18
v_perm_b32 v63, v31, v31, v19
s_nop 1
v_mfma_f32_16x16x32_bf16 v[76:79], v[60:63], a[152:155], v[76:79]
v_perm_b32 v64, v49, v49, v16
v_perm_b32 v65, v49, v49, v17
v_perm_b32 v66, v49, v49, v18
v_perm_b32 v67, v49, v49, v19
s_nop 1
v_mfma_f32_16x16x32_bf16 v[80:83], v[64:67], a[152:155], v[80:83]
s_add_u32 m0, s12, 15232
s_add_u32 s6, s13, 14336
buffer_load_dwordx4 v10, s[52:55], s6 offen nt lds
s_waitcnt vmcnt(51)
v_perm_b32 v68, v31, v31, v20
v_perm_b32 v69, v31, v31, v21
v_perm_b32 v70, v31, v31, v22
v_perm_b32 v71, v31, v31, v23
s_nop 1
v_mfma_f32_16x16x32_bf16 v[76:79], v[68:71], a[156:159], v[76:79]
v_perm_b32 v72, v49, v49, v20
v_perm_b32 v73, v49, v49, v21
v_perm_b32 v74, v49, v49, v22
v_perm_b32 v75, v49, v49, v23
s_nop 1
v_mfma_f32_16x16x32_bf16 v[80:83], v[72:75], a[156:159], v[80:83]
s_add_u32 m0, s12, 16320
s_add_u32 s6, s13, 15360
buffer_load_dwordx4 v10, s[52:55], s6 offen nt lds
s_waitcnt vmcnt(51)
v_perm_b32 v60, v32, v32, v16
v_perm_b32 v61, v32, v32, v17
v_perm_b32 v62, v32, v32, v18
v_perm_b32 v63, v32, v32, v19
s_nop 1
v_mfma_f32_16x16x32_bf16 v[76:79], v[60:63], a[160:163], v[76:79]
v_perm_b32 v64, v50, v50, v16
v_perm_b32 v65, v50, v50, v17
v_perm_b32 v66, v50, v50, v18
v_perm_b32 v67, v50, v50, v19
s_nop 1
v_mfma_f32_16x16x32_bf16 v[80:83], v[64:67], a[160:163], v[80:83]
s_add_u32 m0, s12, 69632
s_add_u32 s6, s13, 65536
buffer_load_dwordx4 v2, s[52:55], s6 offen nt lds
s_waitcnt vmcnt(51)
v_perm_b32 v68, v32, v32, v20
v_perm_b32 v69, v32, v32, v21
v_perm_b32 v70, v32, v32, v22
v_perm_b32 v71, v32, v32, v23
s_nop 1
v_mfma_f32_16x16x32_bf16 v[76:79], v[68:71], a[164:167], v[76:79]
v_perm_b32 v72, v50, v50, v20
v_perm_b32 v73, v50, v50, v21
v_perm_b32 v74, v50, v50, v22
v_perm_b32 v75, v50, v50, v23
s_nop 1
v_mfma_f32_16x16x32_bf16 v[80:83], v[72:75], a[164:167], v[80:83]
s_add_u32 m0, s12, 70720
s_add_u32 s6, s13, 66560
buffer_load_dwordx4 v2, s[52:55], s6 offen nt lds
s_waitcnt vmcnt(51)
v_perm_b32 v60, v33, v33, v16
v_perm_b32 v61, v33, v33, v17
v_perm_b32 v62, v33, v33, v18
v_perm_b32 v63, v33, v33, v19
s_nop 1
v_mfma_f32_16x16x32_bf16 v[76:79], v[60:63], a[168:171], v[76:79]
v_perm_b32 v64, v51, v51, v16
v_perm_b32 v65, v51, v51, v17
v_perm_b32 v66, v51, v51, v18
v_perm_b32 v67, v51, v51, v19
s_nop 1
v_mfma_f32_16x16x32_bf16 v[80:83], v[64:67], a[168:171], v[80:83]
s_add_u32 m0, s12, 71808
s_add_u32 s6, s13, 67584
buffer_load_dwordx4 v2, s[52:55], s6 offen nt lds
s_waitcnt vmcnt(51)
v_perm_b32 v68, v33, v33, v20
v_perm_b32 v69, v33, v33, v21
v_perm_b32 v70, v33, v33, v22
v_perm_b32 v71, v33, v33, v23
s_nop 1
v_mfma_f32_16x16x32_bf16 v[76:79], v[68:71], a[172:175], v[76:79]
v_perm_b32 v72, v51, v51, v20
v_perm_b32 v73, v51, v51, v21
v_perm_b32 v74, v51, v51, v22
v_perm_b32 v75, v51, v51, v23
s_nop 1
v_mfma_f32_16x16x32_bf16 v[80:83], v[72:75], a[172:175], v[80:83]
s_add_u32 m0, s12, 72896
s_add_u32 s6, s13, 68608
buffer_load_dwordx4 v2, s[52:55], s6 offen nt lds
s_waitcnt vmcnt(51)
v_perm_b32 v60, v34, v34, v16
v_perm_b32 v61, v34, v34, v17
v_perm_b32 v62, v34, v34, v18
v_perm_b32 v63, v34, v34, v19
s_nop 1
v_mfma_f32_16x16x32_bf16 v[76:79], v[60:63], a[176:179], v[76:79]
v_perm_b32 v64, v52, v52, v16
v_perm_b32 v65, v52, v52, v17
v_perm_b32 v66, v52, v52, v18
v_perm_b32 v67, v52, v52, v19
s_nop 1
v_mfma_f32_16x16x32_bf16 v[80:83], v[64:67], a[176:179], v[80:83]
s_add_u32 m0, s12, 73984
s_add_u32 s6, s13, 69632
buffer_load_dwordx4 v2, s[52:55], s6 offen nt lds
s_waitcnt vmcnt(51)
v_perm_b32 v68, v34, v34, v20
v_perm_b32 v69, v34, v34, v21
v_perm_b32 v70, v34, v34, v22
v_perm_b32 v71, v34, v34, v23
s_nop 1
v_mfma_f32_16x16x32_bf16 v[76:79], v[68:71], a[180:183], v[76:79]
v_perm_b32 v72, v52, v52, v20
v_perm_b32 v73, v52, v52, v21
v_perm_b32 v74, v52, v52, v22
v_perm_b32 v75, v52, v52, v23
s_nop 1
v_mfma_f32_16x16x32_bf16 v[80:83], v[72:75], a[180:183], v[80:83]
s_add_u32 m0, s12, 75072
s_add_u32 s6, s13, 70656
buffer_load_dwordx4 v2, s[52:55], s6 offen nt lds
s_waitcnt vmcnt(51)
v_perm_b32 v60, v35, v35, v16
v_perm_b32 v61, v35, v35, v17
v_perm_b32 v62, v35, v35, v18
v_perm_b32 v63, v35, v35, v19
s_nop 1
v_mfma_f32_16x16x32_bf16 v[76:79], v[60:63], a[184:187], v[76:79]
v_perm_b32 v64, v53, v53, v16
v_perm_b32 v65, v53, v53, v17
v_perm_b32 v66, v53, v53, v18
v_perm_b32 v67, v53, v53, v19
s_nop 1
v_mfma_f32_16x16x32_bf16 v[80:83], v[64:67], a[184:187], v[80:83]
s_add_u32 m0, s12, 76160
s_add_u32 s6, s13, 71680
buffer_load_dwordx4 v2, s[52:55], s6 offen nt lds
s_waitcnt vmcnt(51)
v_perm_b32 v68, v35, v35, v20
v_perm_b32 v69, v35, v35, v21
v_perm_b32 v70, v35, v35, v22
v_perm_b32 v71, v35, v35, v23
s_nop 1
v_mfma_f32_16x16x32_bf16 v[76:79], v[68:71], a[188:191], v[76:79]
v_perm_b32 v72, v53, v53, v20
v_perm_b32 v73, v53, v53, v21
v_perm_b32 v74, v53, v53, v22
v_perm_b32 v75, v53, v53, v23
s_nop 1
v_mfma_f32_16x16x32_bf16 v[80:83], v[72:75], a[188:191], v[80:83]
s_add_u32 m0, s12, 77248
s_add_u32 s6, s13, 72704
buffer_load_dwordx4 v2, s[52:55], s6 offen nt lds
s_waitcnt vmcnt(51)
v_perm_b32 v60, v36, v36, v16
v_perm_b32 v61, v36, v36, v17
v_perm_b32 v62, v36, v36, v18
v_perm_b32 v63, v36, v36, v19
s_nop 1
v_mfma_f32_16x16x32_bf16 v[76:79], v[60:63], a[192:195], v[76:79]
v_perm_b32 v64, v54, v54, v16
v_perm_b32 v65, v54, v54, v17
v_perm_b32 v66, v54, v54, v18
v_perm_b32 v67, v54, v54, v19
s_nop 1
v_mfma_f32_16x16x32_bf16 v[80:83], v[64:67], a[192:195], v[80:83]
s_add_u32 m0, s12, 78336
s_add_u32 s6, s13, 73728
buffer_load_dwordx4 v10, s[52:55], s6 offen nt lds
s_waitcnt vmcnt(51)
v_perm_b32 v68, v36, v36, v20
v_perm_b32 v69, v36, v36, v21
v_perm_b32 v70, v36, v36, v22
v_perm_b32 v71, v36, v36, v23
s_nop 1
v_mfma_f32_16x16x32_bf16 v[76:79], v[68:71], a[196:199], v[76:79]
v_perm_b32 v72, v54, v54, v20
v_perm_b32 v73, v54, v54, v21
v_perm_b32 v74, v54, v54, v22
v_perm_b32 v75, v54, v54, v23
s_nop 1
v_mfma_f32_16x16x32_bf16 v[80:83], v[72:75], a[196:199], v[80:83]
s_add_u32 m0, s12, 79424
s_add_u32 s6, s13, 74752
buffer_load_dwordx4 v10, s[52:55], s6 offen nt lds
s_waitcnt vmcnt(51)
v_perm_b32 v60, v37, v37, v16
v_perm_b32 v61, v37, v37, v17
v_perm_b32 v62, v37, v37, v18
v_perm_b32 v63, v37, v37, v19
s_nop 1
v_mfma_f32_16x16x32_bf16 v[76:79], v[60:63], a[200:203], v[76:79]
v_perm_b32 v64, v55, v55, v16
v_perm_b32 v65, v55, v55, v17
v_perm_b32 v66, v55, v55, v18
v_perm_b32 v67, v55, v55, v19
s_nop 1
v_mfma_f32_16x16x32_bf16 v[80:83], v[64:67], a[200:203], v[80:83]
s_add_u32 m0, s12, 80512
s_add_u32 s6, s13, 75776
buffer_load_dwordx4 v10, s[52:55], s6 offen nt lds
s_waitcnt vmcnt(51)
v_perm_b32 v68, v37, v37, v20
v_perm_b32 v69, v37, v37, v21
v_perm_b32 v70, v37, v37, v22
v_perm_b32 v71, v37, v37, v23
s_nop 1
v_mfma_f32_16x16x32_bf16 v[76:79], v[68:71], a[204:207], v[76:79]
v_perm_b32 v72, v55, v55, v20
v_perm_b32 v73, v55, v55, v21
v_perm_b32 v74, v55, v55, v22
v_perm_b32 v75, v55, v55, v23
s_nop 1
v_mfma_f32_16x16x32_bf16 v[80:83], v[72:75], a[204:207], v[80:83]
s_add_u32 m0, s12, 81600
s_add_u32 s6, s13, 76800
buffer_load_dwordx4 v10, s[52:55], s6 offen nt lds
s_waitcnt vmcnt(51)
v_perm_b32 v60, v38, v38, v16
v_perm_b32 v61, v38, v38, v17
v_perm_b32 v62, v38, v38, v18
v_perm_b32 v63, v38, v38, v19
s_nop 1
v_mfma_f32_16x16x32_bf16 v[76:79], v[60:63], a[208:211], v[76:79]
v_perm_b32 v64, v56, v56, v16
v_perm_b32 v65, v56, v56, v17
v_perm_b32 v66, v56, v56, v18
v_perm_b32 v67, v56, v56, v19
s_nop 1
v_mfma_f32_16x16x32_bf16 v[80:83], v[64:67], a[208:211], v[80:83]
buffer_load_dword v11, off, s[68:71], 0 offset:0 sc1
s_add_u32 m0, s12, 82688
s_add_u32 s6, s13, 77824
buffer_load_dwordx4 v10, s[52:55], s6 offen nt lds
s_waitcnt vmcnt(52)
v_perm_b32 v68, v38, v38, v20
v_perm_b32 v69, v38, v38, v21
v_perm_b32 v70, v38, v38, v22
v_perm_b32 v71, v38, v38, v23
s_nop 1
v_mfma_f32_16x16x32_bf16 v[76:79], v[68:71], a[212:215], v[76:79]
v_perm_b32 v72, v56, v56, v20
v_perm_b32 v73, v56, v56, v21
v_perm_b32 v74, v56, v56, v22
v_perm_b32 v75, v56, v56, v23
s_nop 1
v_mfma_f32_16x16x32_bf16 v[80:83], v[72:75], a[212:215], v[80:83]
s_add_u32 m0, s12, 83776
s_add_u32 s6, s13, 78848
buffer_load_dwordx4 v10, s[52:55], s6 offen nt lds
s_waitcnt vmcnt(52)
v_perm_b32 v60, v39, v39, v16
v_perm_b32 v61, v39, v39, v17
v_perm_b32 v62, v39, v39, v18
v_perm_b32 v63, v39, v39, v19
s_nop 1
v_mfma_f32_16x16x32_bf16 v[76:79], v[60:63], a[216:219], v[76:79]
v_perm_b32 v64, v57, v57, v16
v_perm_b32 v65, v57, v57, v17
v_perm_b32 v66, v57, v57, v18
v_perm_b32 v67, v57, v57, v19
s_nop 1
v_mfma_f32_16x16x32_bf16 v[80:83], v[64:67], a[216:219], v[80:83]
s_add_u32 m0, s12, 84864
s_add_u32 s6, s13, 79872
buffer_load_dwordx4 v10, s[52:55], s6 offen nt lds
s_waitcnt vmcnt(52)
v_perm_b32 v68, v39, v39, v20
v_perm_b32 v69, v39, v39, v21
v_perm_b32 v70, v39, v39, v22
v_perm_b32 v71, v39, v39, v23
s_nop 1
v_mfma_f32_16x16x32_bf16 v[76:79], v[68:71], a[220:223], v[76:79]
v_perm_b32 v72, v57, v57, v20
v_perm_b32 v73, v57, v57, v21
v_perm_b32 v74, v57, v57, v22
v_perm_b32 v75, v57, v57, v23
s_nop 1
v_mfma_f32_16x16x32_bf16 v[80:83], v[72:75], a[220:223], v[80:83]
s_add_u32 m0, s12, 85952
s_add_u32 s6, s13, 80896
buffer_load_dwordx4 v10, s[52:55], s6 offen nt lds
s_waitcnt vmcnt(52)
v_perm_b32 v60, v40, v40, v16
v_perm_b32 v61, v40, v40, v17
v_perm_b32 v62, v40, v40, v18
v_perm_b32 v63, v40, v40, v19
s_nop 1
v_mfma_f32_16x16x32_bf16 v[76:79], v[60:63], a[224:227], v[76:79]
v_perm_b32 v64, v58, v58, v16
v_perm_b32 v65, v58, v58, v17
v_perm_b32 v66, v58, v58, v18
v_perm_b32 v67, v58, v58, v19
s_nop 1
v_mfma_f32_16x16x32_bf16 v[80:83], v[64:67], a[224:227], v[80:83]
s_waitcnt vmcnt(51)
v_perm_b32 v68, v40, v40, v20
v_perm_b32 v69, v40, v40, v21
v_perm_b32 v70, v40, v40, v22
v_perm_b32 v71, v40, v40, v23
s_nop 1
v_mfma_f32_16x16x32_bf16 v[76:79], v[68:71], a[228:231], v[76:79]
v_perm_b32 v72, v58, v58, v20
v_perm_b32 v73, v58, v58, v21
v_perm_b32 v74, v58, v58, v22
v_perm_b32 v75, v58, v58, v23
s_nop 1
v_mfma_f32_16x16x32_bf16 v[80:83], v[72:75], a[228:231], v[80:83]
s_waitcnt vmcnt(50)
v_perm_b32 v60, v41, v41, v16
v_perm_b32 v61, v41, v41, v17
v_perm_b32 v62, v41, v41, v18
v_perm_b32 v63, v41, v41, v19
s_nop 1
v_mfma_f32_16x16x32_bf16 v[76:79], v[60:63], a[232:235], v[76:79]
v_perm_b32 v64, v59, v59, v16
v_perm_b32 v65, v59, v59, v17
v_perm_b32 v66, v59, v59, v18
v_perm_b32 v67, v59, v59, v19
s_nop 1
v_mfma_f32_16x16x32_bf16 v[80:83], v[64:67], a[232:235], v[80:83]
s_waitcnt vmcnt(49)
v_perm_b32 v68, v41, v41, v20
v_perm_b32 v69, v41, v41, v21
v_perm_b32 v70, v41, v41, v22
v_perm_b32 v71, v41, v41, v23
s_nop 1
v_mfma_f32_16x16x32_bf16 v[76:79], v[68:71], a[236:239], v[76:79]
v_perm_b32 v72, v59, v59, v20
v_perm_b32 v73, v59, v59, v21
v_perm_b32 v74, v59, v59, v22
v_perm_b32 v75, v59, v59, v23
s_nop 1
v_mfma_f32_16x16x32_bf16 v[80:83], v[72:75], a[236:239], v[80:83]
v_lshlrev_b32 v5, 5, v8
v_and_b32 v6, 1, v9
v_lshl_add_u32 v6, v6, 4, v5
v_lshrrev_b32 v7, 5, v1
v_lshl_add_u32 v6, v7, 9, v6
s_lshl_b32 s6, s3, 11
s_add_u32 s6, s6, 139264
v_add_u32 v6, s6, v6
ds_write_b128 v6, v[76:79]
ds_write_b128 v6, v[80:83] offset:1024
v_add_u32 v5, 139264, v5
s_waitcnt lgkmcnt(0)
s_barrier
ds_read_b128 v[188:191], v5 offset:0
ds_read_b128 v[192:195], v5 offset:16
ds_read_b128 v[196:199], v5 offset:2048
ds_read_b128 v[200:203], v5 offset:2064
ds_read_b128 v[204:207], v5 offset:4096
ds_read_b128 v[208:211], v5 offset:4112
ds_read_b128 v[212:215], v5 offset:6144
ds_read_b128 v[216:219], v5 offset:6160
s_waitcnt lgkmcnt(0)
v_add_f32 v188, v188, v196
v_add_f32 v204, v204, v212
v_add_f32 v189, v189, v197
v_add_f32 v205, v205, v213
v_add_f32 v190, v190, v198
v_add_f32 v206, v206, v214
v_add_f32 v191, v191, v199
v_add_f32 v207, v207, v215
v_add_f32 v192, v192, v200
v_add_f32 v208, v208, v216
v_add_f32 v193, v193, v201
v_add_f32 v209, v209, v217
v_add_f32 v194, v194, v202
v_add_f32 v210, v210, v218
v_add_f32 v195, v195, v203
v_add_f32 v211, v211, v219
v_add_f32 v188, v188, v204
v_add_f32 v189, v189, v205
v_add_f32 v190, v190, v206
v_add_f32 v191, v191, v207
v_add_f32 v192, v192, v208
v_add_f32 v193, v193, v209
v_add_f32 v194, v194, v210
v_add_f32 v195, v195, v211
v_cvt_pk_bf16_f32 v148, v188, v189
v_cvt_pk_bf16_f32 v149, v190, v191
v_cvt_pk_bf16_f32 v150, v192, v193
v_cvt_pk_bf16_f32 v151, v194, v195
ds_read_b128 v[188:191], v5 offset:512
ds_read_b128 v[192:195], v5 offset:528
ds_read_b128 v[196:199], v5 offset:2560
ds_read_b128 v[200:203], v5 offset:2576
ds_read_b128 v[204:207], v5 offset:4608
ds_read_b128 v[208:211], v5 offset:4624
ds_read_b128 v[212:215], v5 offset:6656
ds_read_b128 v[216:219], v5 offset:6672
s_waitcnt lgkmcnt(0)
v_add_f32 v188, v188, v196
v_add_f32 v204, v204, v212
v_add_f32 v189, v189, v197
v_add_f32 v205, v205, v213
v_add_f32 v190, v190, v198
v_add_f32 v206, v206, v214
v_add_f32 v191, v191, v199
v_add_f32 v207, v207, v215
v_add_f32 v192, v192, v200
v_add_f32 v208, v208, v216
v_add_f32 v193, v193, v201
v_add_f32 v209, v209, v217
v_add_f32 v194, v194, v202
v_add_f32 v210, v210, v218
v_add_f32 v195, v195, v203
v_add_f32 v211, v211, v219
v_add_f32 v188, v188, v204
v_add_f32 v189, v189, v205
v_add_f32 v190, v190, v206
v_add_f32 v191, v191, v207
v_add_f32 v192, v192, v208
v_add_f32 v193, v193, v209
v_add_f32 v194, v194, v210
v_add_f32 v195, v195, v211
v_cvt_pk_bf16_f32 v152, v188, v189
v_cvt_pk_bf16_f32 v153, v190, v191
v_cvt_pk_bf16_f32 v154, v192, v193
v_cvt_pk_bf16_f32 v155, v194, v195
ds_read_b128 v[188:191], v5 offset:1024
ds_read_b128 v[192:195], v5 offset:1040
ds_read_b128 v[196:199], v5 offset:3072
ds_read_b128 v[200:203], v5 offset:3088
ds_read_b128 v[204:207], v5 offset:5120
ds_read_b128 v[208:211], v5 offset:5136
ds_read_b128 v[212:215], v5 offset:7168
ds_read_b128 v[216:219], v5 offset:7184
s_waitcnt lgkmcnt(0)
v_add_f32 v188, v188, v196
v_add_f32 v204, v204, v212
v_add_f32 v189, v189, v197
v_add_f32 v205, v205, v213
v_add_f32 v190, v190, v198
v_add_f32 v206, v206, v214
v_add_f32 v191, v191, v199
v_add_f32 v207, v207, v215
v_add_f32 v192, v192, v200
v_add_f32 v208, v208, v216
v_add_f32 v193, v193, v201
v_add_f32 v209, v209, v217
v_add_f32 v194, v194, v202
v_add_f32 v210, v210, v218
v_add_f32 v195, v195, v203
v_add_f32 v211, v211, v219
v_add_f32 v188, v188, v204
v_add_f32 v189, v189, v205
v_add_f32 v190, v190, v206
v_add_f32 v191, v191, v207
v_add_f32 v192, v192, v208
v_add_f32 v193, v193, v209
v_add_f32 v194, v194, v210
v_add_f32 v195, v195, v211
v_cvt_pk_bf16_f32 v156, v188, v189
v_cvt_pk_bf16_f32 v157, v190, v191
v_cvt_pk_bf16_f32 v158, v192, v193
v_cvt_pk_bf16_f32 v159, v194, v195
ds_read_b128 v[188:191], v5 offset:1536
ds_read_b128 v[192:195], v5 offset:1552
ds_read_b128 v[196:199], v5 offset:3584
ds_read_b128 v[200:203], v5 offset:3600
ds_read_b128 v[204:207], v5 offset:5632
ds_read_b128 v[208:211], v5 offset:5648
ds_read_b128 v[212:215], v5 offset:7680
ds_read_b128 v[216:219], v5 offset:7696
s_waitcnt lgkmcnt(0)
v_add_f32 v188, v188, v196
v_add_f32 v204, v204, v212
v_add_f32 v189, v189, v197
v_add_f32 v205, v205, v213
v_add_f32 v190, v190, v198
v_add_f32 v206, v206, v214
v_add_f32 v191, v191, v199
v_add_f32 v207, v207, v215
v_add_f32 v192, v192, v200
v_add_f32 v208, v208, v216
v_add_f32 v193, v193, v201
v_add_f32 v209, v209, v217
v_add_f32 v194, v194, v202
v_add_f32 v210, v210, v218
v_add_f32 v195, v195, v203
v_add_f32 v211, v211, v219
v_add_f32 v188, v188, v204
v_add_f32 v189, v189, v205
v_add_f32 v190, v190, v206
v_add_f32 v191, v191, v207
v_add_f32 v192, v192, v208
v_add_f32 v193, v193, v209
v_add_f32 v194, v194, v210
v_add_f32 v195, v195, v211
v_cvt_pk_bf16_f32 v160, v188, v189
v_cvt_pk_bf16_f32 v161, v190, v191
v_cvt_pk_bf16_f32 v162, v192, v193
v_cvt_pk_bf16_f32 v163, v194, v195
s_waitcnt vmcnt(33)
v_dot2_f32_bf16 v164, v84, v148, 0
v_dot2_f32_bf16 v165, v84, v152, 0
v_dot2_f32_bf16 v166, v84, v156, 0
v_dot2_f32_bf16 v167, v84, v160, 0
v_dot2_f32_bf16 v164, v85, v149, v164
v_dot2_f32_bf16 v165, v85, v153, v165
v_dot2_f32_bf16 v166, v85, v157, v166
v_dot2_f32_bf16 v167, v85, v161, v167
v_dot2_f32_bf16 v164, v86, v150, v164
v_dot2_f32_bf16 v165, v86, v154, v165
v_dot2_f32_bf16 v166, v86, v158, v166
v_dot2_f32_bf16 v167, v86, v162, v167
v_dot2_f32_bf16 v164, v87, v151, v164
v_dot2_f32_bf16 v165, v87, v155, v165
v_dot2_f32_bf16 v166, v87, v159, v166
v_dot2_f32_bf16 v167, v87, v163, v167
v_add_f32_dpp v168, v164, v164 row_ror:8 row_mask:0xf bank_mask:0x3
v_add_f32_dpp v169, v165, v165 row_ror:8 row_mask:0xf bank_mask:0x3
v_add_f32_dpp v168, v166, v166 row_ror:8 row_mask:0xf bank_mask:0xc
v_add_f32_dpp v169, v167, v167 row_ror:8 row_mask:0xf bank_mask:0xc
s_nop 0
v_add_f32_dpp v172, v168, v168 row_half_mirror row_mask:0xf bank_mask:0x5
v_add_f32_dpp v172, v169, v169 row_half_mirror row_mask:0xf bank_mask:0xa
s_nop 1
v_add_f32_dpp v172, v172, v172 quad_perm:[1,0,3,2] row_mask:0xf bank_mask:0xf
s_nop 1
v_add_f32_dpp v172, v172, v172 quad_perm:[2,3,0,1] row_mask:0xf bank_mask:0xf
v_dot2_f32_bf16 v164, v88, v148, 0
v_dot2_f32_bf16 v165, v88, v152, 0
v_dot2_f32_bf16 v166, v88, v156, 0
v_dot2_f32_bf16 v167, v88, v160, 0
v_dot2_f32_bf16 v164, v89, v149, v164
v_dot2_f32_bf16 v165, v89, v153, v165
v_dot2_f32_bf16 v166, v89, v157, v166
v_dot2_f32_bf16 v167, v89, v161, v167
v_dot2_f32_bf16 v164, v90, v150, v164
v_dot2_f32_bf16 v165, v90, v154, v165
v_dot2_f32_bf16 v166, v90, v158, v166
v_dot2_f32_bf16 v167, v90, v162, v167
v_dot2_f32_bf16 v164, v91, v151, v164
v_dot2_f32_bf16 v165, v91, v155, v165
v_dot2_f32_bf16 v166, v91, v159, v166
v_dot2_f32_bf16 v167, v91, v163, v167
v_add_f32_dpp v168, v164, v164 row_ror:8 row_mask:0xf bank_mask:0x3
v_add_f32_dpp v169, v165, v165 row_ror:8 row_mask:0xf bank_mask:0x3
v_add_f32_dpp v168, v166, v166 row_ror:8 row_mask:0xf bank_mask:0xc
v_add_f32_dpp v169, v167, v167 row_ror:8 row_mask:0xf bank_mask:0xc
s_nop 0
v_add_f32_dpp v173, v168, v168 row_half_mirror row_mask:0xf bank_mask:0x5
v_add_f32_dpp v173, v169, v169 row_half_mirror row_mask:0xf bank_mask:0xa
s_nop 1
v_add_f32_dpp v173, v173, v173 quad_perm:[1,0,3,2] row_mask:0xf bank_mask:0xf
s_nop 1
v_add_f32_dpp v173, v173, v173 quad_perm:[2,3,0,1] row_mask:0xf bank_mask:0xf
v_dot2_f32_bf16 v164, v92, v148, 0
v_dot2_f32_bf16 v165, v92, v152, 0
v_dot2_f32_bf16 v166, v92, v156, 0
v_dot2_f32_bf16 v167, v92, v160, 0
v_dot2_f32_bf16 v164, v93, v149, v164
v_dot2_f32_bf16 v165, v93, v153, v165
v_dot2_f32_bf16 v166, v93, v157, v166
v_dot2_f32_bf16 v167, v93, v161, v167
v_dot2_f32_bf16 v164, v94, v150, v164
v_dot2_f32_bf16 v165, v94, v154, v165
v_dot2_f32_bf16 v166, v94, v158, v166
v_dot2_f32_bf16 v167, v94, v162, v167
v_dot2_f32_bf16 v164, v95, v151, v164
v_dot2_f32_bf16 v165, v95, v155, v165
v_dot2_f32_bf16 v166, v95, v159, v166
v_dot2_f32_bf16 v167, v95, v163, v167
v_add_f32_dpp v168, v164, v164 row_ror:8 row_mask:0xf bank_mask:0x3
v_add_f32_dpp v169, v165, v165 row_ror:8 row_mask:0xf bank_mask:0x3
v_add_f32_dpp v168, v166, v166 row_ror:8 row_mask:0xf bank_mask:0xc
v_add_f32_dpp v169, v167, v167 row_ror:8 row_mask:0xf bank_mask:0xc
s_nop 0
v_add_f32_dpp v174, v168, v168 row_half_mirror row_mask:0xf bank_mask:0x5
v_add_f32_dpp v174, v169, v169 row_half_mirror row_mask:0xf bank_mask:0xa
s_nop 1
v_add_f32_dpp v174, v174, v174 quad_perm:[1,0,3,2] row_mask:0xf bank_mask:0xf
s_nop 1
v_add_f32_dpp v174, v174, v174 quad_perm:[2,3,0,1] row_mask:0xf bank_mask:0xf
v_dot2_f32_bf16 v164, v96, v148, 0
v_dot2_f32_bf16 v165, v96, v152, 0
v_dot2_f32_bf16 v166, v96, v156, 0
v_dot2_f32_bf16 v167, v96, v160, 0
v_dot2_f32_bf16 v164, v97, v149, v164
v_dot2_f32_bf16 v165, v97, v153, v165
v_dot2_f32_bf16 v166, v97, v157, v166
v_dot2_f32_bf16 v167, v97, v161, v167
v_dot2_f32_bf16 v164, v98, v150, v164
v_dot2_f32_bf16 v165, v98, v154, v165
v_dot2_f32_bf16 v166, v98, v158, v166
v_dot2_f32_bf16 v167, v98, v162, v167
v_dot2_f32_bf16 v164, v99, v151, v164
v_dot2_f32_bf16 v165, v99, v155, v165
v_dot2_f32_bf16 v166, v99, v159, v166
v_dot2_f32_bf16 v167, v99, v163, v167
v_add_f32_dpp v168, v164, v164 row_ror:8 row_mask:0xf bank_mask:0x3
v_add_f32_dpp v169, v165, v165 row_ror:8 row_mask:0xf bank_mask:0x3
v_add_f32_dpp v168, v166, v166 row_ror:8 row_mask:0xf bank_mask:0xc
v_add_f32_dpp v169, v167, v167 row_ror:8 row_mask:0xf bank_mask:0xc
s_nop 0
v_add_f32_dpp v175, v168, v168 row_half_mirror row_mask:0xf bank_mask:0x5
v_add_f32_dpp v175, v169, v169 row_half_mirror row_mask:0xf bank_mask:0xa
s_nop 1
v_add_f32_dpp v175, v175, v175 quad_perm:[1,0,3,2] row_mask:0xf bank_mask:0xf
s_nop 1
v_add_f32_dpp v175, v175, v175 quad_perm:[2,3,0,1] row_mask:0xf bank_mask:0xf
v_dot2_f32_bf16 v164, v100, v148, 0
v_dot2_f32_bf16 v165, v100, v152, 0
v_dot2_f32_bf16 v166, v100, v156, 0
v_dot2_f32_bf16 v167, v100, v160, 0
v_dot2_f32_bf16 v164, v101, v149, v164
v_dot2_f32_bf16 v165, v101, v153, v165
v_dot2_f32_bf16 v166, v101, v157, v166
v_dot2_f32_bf16 v167, v101, v161, v167
v_dot2_f32_bf16 v164, v102, v150, v164
v_dot2_f32_bf16 v165, v102, v154, v165
v_dot2_f32_bf16 v166, v102, v158, v166
v_dot2_f32_bf16 v167, v102, v162, v167
v_dot2_f32_bf16 v164, v103, v151, v164
v_dot2_f32_bf16 v165, v103, v155, v165
v_dot2_f32_bf16 v166, v103, v159, v166
v_dot2_f32_bf16 v167, v103, v163, v167
v_add_f32_dpp v168, v164, v164 row_ror:8 row_mask:0xf bank_mask:0x3
v_add_f32_dpp v169, v165, v165 row_ror:8 row_mask:0xf bank_mask:0x3
v_add_f32_dpp v168, v166, v166 row_ror:8 row_mask:0xf bank_mask:0xc
v_add_f32_dpp v169, v167, v167 row_ror:8 row_mask:0xf bank_mask:0xc
s_nop 0
v_add_f32_dpp v176, v168, v168 row_half_mirror row_mask:0xf bank_mask:0x5
v_add_f32_dpp v176, v169, v169 row_half_mirror row_mask:0xf bank_mask:0xa
s_nop 1
v_add_f32_dpp v176, v176, v176 quad_perm:[1,0,3,2] row_mask:0xf bank_mask:0xf
s_nop 1
v_add_f32_dpp v176, v176, v176 quad_perm:[2,3,0,1] row_mask:0xf bank_mask:0xf
v_dot2_f32_bf16 v164, v104, v148, 0
v_dot2_f32_bf16 v165, v104, v152, 0
v_dot2_f32_bf16 v166, v104, v156, 0
v_dot2_f32_bf16 v167, v104, v160, 0
v_dot2_f32_bf16 v164, v105, v149, v164
v_dot2_f32_bf16 v165, v105, v153, v165
v_dot2_f32_bf16 v166, v105, v157, v166
v_dot2_f32_bf16 v167, v105, v161, v167
v_dot2_f32_bf16 v164, v106, v150, v164
v_dot2_f32_bf16 v165, v106, v154, v165
v_dot2_f32_bf16 v166, v106, v158, v166
v_dot2_f32_bf16 v167, v106, v162, v167
v_dot2_f32_bf16 v164, v107, v151, v164
v_dot2_f32_bf16 v165, v107, v155, v165
v_dot2_f32_bf16 v166, v107, v159, v166
v_dot2_f32_bf16 v167, v107, v163, v167
v_add_f32_dpp v168, v164, v164 row_ror:8 row_mask:0xf bank_mask:0x3
v_add_f32_dpp v169, v165, v165 row_ror:8 row_mask:0xf bank_mask:0x3
v_add_f32_dpp v168, v166, v166 row_ror:8 row_mask:0xf bank_mask:0xc
v_add_f32_dpp v169, v167, v167 row_ror:8 row_mask:0xf bank_mask:0xc
s_nop 0
v_add_f32_dpp v177, v168, v168 row_half_mirror row_mask:0xf bank_mask:0x5
v_add_f32_dpp v177, v169, v169 row_half_mirror row_mask:0xf bank_mask:0xa
s_nop 1
v_add_f32_dpp v177, v177, v177 quad_perm:[1,0,3,2] row_mask:0xf bank_mask:0xf
s_nop 1
v_add_f32_dpp v177, v177, v177 quad_perm:[2,3,0,1] row_mask:0xf bank_mask:0xf
v_dot2_f32_bf16 v164, v108, v148, 0
v_dot2_f32_bf16 v165, v108, v152, 0
v_dot2_f32_bf16 v166, v108, v156, 0
v_dot2_f32_bf16 v167, v108, v160, 0
v_dot2_f32_bf16 v164, v109, v149, v164
v_dot2_f32_bf16 v165, v109, v153, v165
v_dot2_f32_bf16 v166, v109, v157, v166
v_dot2_f32_bf16 v167, v109, v161, v167
v_dot2_f32_bf16 v164, v110, v150, v164
v_dot2_f32_bf16 v165, v110, v154, v165
v_dot2_f32_bf16 v166, v110, v158, v166
v_dot2_f32_bf16 v167, v110, v162, v167
v_dot2_f32_bf16 v164, v111, v151, v164
v_dot2_f32_bf16 v165, v111, v155, v165
v_dot2_f32_bf16 v166, v111, v159, v166
v_dot2_f32_bf16 v167, v111, v163, v167
v_add_f32_dpp v168, v164, v164 row_ror:8 row_mask:0xf bank_mask:0x3
v_add_f32_dpp v169, v165, v165 row_ror:8 row_mask:0xf bank_mask:0x3
v_add_f32_dpp v168, v166, v166 row_ror:8 row_mask:0xf bank_mask:0xc
v_add_f32_dpp v169, v167, v167 row_ror:8 row_mask:0xf bank_mask:0xc
s_nop 0
v_add_f32_dpp v178, v168, v168 row_half_mirror row_mask:0xf bank_mask:0x5
v_add_f32_dpp v178, v169, v169 row_half_mirror row_mask:0xf bank_mask:0xa
s_nop 1
v_add_f32_dpp v178, v178, v178 quad_perm:[1,0,3,2] row_mask:0xf bank_mask:0xf
s_nop 1
v_add_f32_dpp v178, v178, v178 quad_perm:[2,3,0,1] row_mask:0xf bank_mask:0xf
v_dot2_f32_bf16 v164, v112, v148, 0
v_dot2_f32_bf16 v165, v112, v152, 0
v_dot2_f32_bf16 v166, v112, v156, 0
v_dot2_f32_bf16 v167, v112, v160, 0
v_dot2_f32_bf16 v164, v113, v149, v164
v_dot2_f32_bf16 v165, v113, v153, v165
v_dot2_f32_bf16 v166, v113, v157, v166
v_dot2_f32_bf16 v167, v113, v161, v167
v_dot2_f32_bf16 v164, v114, v150, v164
v_dot2_f32_bf16 v165, v114, v154, v165
v_dot2_f32_bf16 v166, v114, v158, v166
v_dot2_f32_bf16 v167, v114, v162, v167
v_dot2_f32_bf16 v164, v115, v151, v164
v_dot2_f32_bf16 v165, v115, v155, v165
v_dot2_f32_bf16 v166, v115, v159, v166
v_dot2_f32_bf16 v167, v115, v163, v167
v_add_f32_dpp v168, v164, v164 row_ror:8 row_mask:0xf bank_mask:0x3
v_add_f32_dpp v169, v165, v165 row_ror:8 row_mask:0xf bank_mask:0x3
v_add_f32_dpp v168, v166, v166 row_ror:8 row_mask:0xf bank_mask:0xc
v_add_f32_dpp v169, v167, v167 row_ror:8 row_mask:0xf bank_mask:0xc
s_nop 0
v_add_f32_dpp v179, v168, v168 row_half_mirror row_mask:0xf bank_mask:0x5
v_add_f32_dpp v179, v169, v169 row_half_mirror row_mask:0xf bank_mask:0xa
s_nop 1
v_add_f32_dpp v179, v179, v179 quad_perm:[1,0,3,2] row_mask:0xf bank_mask:0xf
s_nop 1
v_add_f32_dpp v179, v179, v179 quad_perm:[2,3,0,1] row_mask:0xf bank_mask:0xf
v_dot2_f32_bf16 v164, v116, v148, 0
v_dot2_f32_bf16 v165, v116, v152, 0
v_dot2_f32_bf16 v166, v116, v156, 0
v_dot2_f32_bf16 v167, v116, v160, 0
v_dot2_f32_bf16 v164, v117, v149, v164
v_dot2_f32_bf16 v165, v117, v153, v165
v_dot2_f32_bf16 v166, v117, v157, v166
v_dot2_f32_bf16 v167, v117, v161, v167
v_dot2_f32_bf16 v164, v118, v150, v164
v_dot2_f32_bf16 v165, v118, v154, v165
v_dot2_f32_bf16 v166, v118, v158, v166
v_dot2_f32_bf16 v167, v118, v162, v167
v_dot2_f32_bf16 v164, v119, v151, v164
v_dot2_f32_bf16 v165, v119, v155, v165
v_dot2_f32_bf16 v166, v119, v159, v166
v_dot2_f32_bf16 v167, v119, v163, v167
v_add_f32_dpp v168, v164, v164 row_ror:8 row_mask:0xf bank_mask:0x3
v_add_f32_dpp v169, v165, v165 row_ror:8 row_mask:0xf bank_mask:0x3
v_add_f32_dpp v168, v166, v166 row_ror:8 row_mask:0xf bank_mask:0xc
v_add_f32_dpp v169, v167, v167 row_ror:8 row_mask:0xf bank_mask:0xc
s_nop 0
v_add_f32_dpp v180, v168, v168 row_half_mirror row_mask:0xf bank_mask:0x5
v_add_f32_dpp v180, v169, v169 row_half_mirror row_mask:0xf bank_mask:0xa
s_nop 1
v_add_f32_dpp v180, v180, v180 quad_perm:[1,0,3,2] row_mask:0xf bank_mask:0xf
s_nop 1
v_add_f32_dpp v180, v180, v180 quad_perm:[2,3,0,1] row_mask:0xf bank_mask:0xf
v_dot2_f32_bf16 v164, v120, v148, 0
v_dot2_f32_bf16 v165, v120, v152, 0
v_dot2_f32_bf16 v166, v120, v156, 0
v_dot2_f32_bf16 v167, v120, v160, 0
v_dot2_f32_bf16 v164, v121, v149, v164
v_dot2_f32_bf16 v165, v121, v153, v165
v_dot2_f32_bf16 v166, v121, v157, v166
v_dot2_f32_bf16 v167, v121, v161, v167
v_dot2_f32_bf16 v164, v122, v150, v164
v_dot2_f32_bf16 v165, v122, v154, v165
v_dot2_f32_bf16 v166, v122, v158, v166
v_dot2_f32_bf16 v167, v122, v162, v167
v_dot2_f32_bf16 v164, v123, v151, v164
v_dot2_f32_bf16 v165, v123, v155, v165
v_dot2_f32_bf16 v166, v123, v159, v166
v_dot2_f32_bf16 v167, v123, v163, v167
v_add_f32_dpp v168, v164, v164 row_ror:8 row_mask:0xf bank_mask:0x3
v_add_f32_dpp v169, v165, v165 row_ror:8 row_mask:0xf bank_mask:0x3
v_add_f32_dpp v168, v166, v166 row_ror:8 row_mask:0xf bank_mask:0xc
v_add_f32_dpp v169, v167, v167 row_ror:8 row_mask:0xf bank_mask:0xc
s_nop 0
v_add_f32_dpp v181, v168, v168 row_half_mirror row_mask:0xf bank_mask:0x5
v_add_f32_dpp v181, v169, v169 row_half_mirror row_mask:0xf bank_mask:0xa
s_nop 1
v_add_f32_dpp v181, v181, v181 quad_perm:[1,0,3,2] row_mask:0xf bank_mask:0xf
s_nop 1
v_add_f32_dpp v181, v181, v181 quad_perm:[2,3,0,1] row_mask:0xf bank_mask:0xf
v_dot2_f32_bf16 v164, v124, v148, 0
v_dot2_f32_bf16 v165, v124, v152, 0
v_dot2_f32_bf16 v166, v124, v156, 0
v_dot2_f32_bf16 v167, v124, v160, 0
v_dot2_f32_bf16 v164, v125, v149, v164
v_dot2_f32_bf16 v165, v125, v153, v165
v_dot2_f32_bf16 v166, v125, v157, v166
v_dot2_f32_bf16 v167, v125, v161, v167
v_dot2_f32_bf16 v164, v126, v150, v164
v_dot2_f32_bf16 v165, v126, v154, v165
v_dot2_f32_bf16 v166, v126, v158, v166
v_dot2_f32_bf16 v167, v126, v162, v167
v_dot2_f32_bf16 v164, v127, v151, v164
v_dot2_f32_bf16 v165, v127, v155, v165
v_dot2_f32_bf16 v166, v127, v159, v166
v_dot2_f32_bf16 v167, v127, v163, v167
v_add_f32_dpp v168, v164, v164 row_ror:8 row_mask:0xf bank_mask:0x3
v_add_f32_dpp v169, v165, v165 row_ror:8 row_mask:0xf bank_mask:0x3
v_add_f32_dpp v168, v166, v166 row_ror:8 row_mask:0xf bank_mask:0xc
v_add_f32_dpp v169, v167, v167 row_ror:8 row_mask:0xf bank_mask:0xc
s_nop 0
v_add_f32_dpp v182, v168, v168 row_half_mirror row_mask:0xf bank_mask:0x5
v_add_f32_dpp v182, v169, v169 row_half_mirror row_mask:0xf bank_mask:0xa
s_nop 1
v_add_f32_dpp v182, v182, v182 quad_perm:[1,0,3,2] row_mask:0xf bank_mask:0xf
s_nop 1
v_add_f32_dpp v182, v182, v182 quad_perm:[2,3,0,1] row_mask:0xf bank_mask:0xf
v_dot2_f32_bf16 v164, v128, v148, 0
v_dot2_f32_bf16 v165, v128, v152, 0
v_dot2_f32_bf16 v166, v128, v156, 0
v_dot2_f32_bf16 v167, v128, v160, 0
v_dot2_f32_bf16 v164, v129, v149, v164
v_dot2_f32_bf16 v165, v129, v153, v165
v_dot2_f32_bf16 v166, v129, v157, v166
v_dot2_f32_bf16 v167, v129, v161, v167
v_dot2_f32_bf16 v164, v130, v150, v164
v_dot2_f32_bf16 v165, v130, v154, v165
v_dot2_f32_bf16 v166, v130, v158, v166
v_dot2_f32_bf16 v167, v130, v162, v167
v_dot2_f32_bf16 v164, v131, v151, v164
v_dot2_f32_bf16 v165, v131, v155, v165
v_dot2_f32_bf16 v166, v131, v159, v166
v_dot2_f32_bf16 v167, v131, v163, v167
v_add_f32_dpp v168, v164, v164 row_ror:8 row_mask:0xf bank_mask:0x3
v_add_f32_dpp v169, v165, v165 row_ror:8 row_mask:0xf bank_mask:0x3
v_add_f32_dpp v168, v166, v166 row_ror:8 row_mask:0xf bank_mask:0xc
v_add_f32_dpp v169, v167, v167 row_ror:8 row_mask:0xf bank_mask:0xc
s_nop 0
v_add_f32_dpp v183, v168, v168 row_half_mirror row_mask:0xf bank_mask:0x5
v_add_f32_dpp v183, v169, v169 row_half_mirror row_mask:0xf bank_mask:0xa
s_nop 1
v_add_f32_dpp v183, v183, v183 quad_perm:[1,0,3,2] row_mask:0xf bank_mask:0xf
s_nop 1
v_add_f32_dpp v183, v183, v183 quad_perm:[2,3,0,1] row_mask:0xf bank_mask:0xf
v_dot2_f32_bf16 v164, v132, v148, 0
v_dot2_f32_bf16 v165, v132, v152, 0
v_dot2_f32_bf16 v166, v132, v156, 0
v_dot2_f32_bf16 v167, v132, v160, 0
v_dot2_f32_bf16 v164, v133, v149, v164
v_dot2_f32_bf16 v165, v133, v153, v165
v_dot2_f32_bf16 v166, v133, v157, v166
v_dot2_f32_bf16 v167, v133, v161, v167
v_dot2_f32_bf16 v164, v134, v150, v164
v_dot2_f32_bf16 v165, v134, v154, v165
v_dot2_f32_bf16 v166, v134, v158, v166
v_dot2_f32_bf16 v167, v134, v162, v167
v_dot2_f32_bf16 v164, v135, v151, v164
v_dot2_f32_bf16 v165, v135, v155, v165
v_dot2_f32_bf16 v166, v135, v159, v166
v_dot2_f32_bf16 v167, v135, v163, v167
v_add_f32_dpp v168, v164, v164 row_ror:8 row_mask:0xf bank_mask:0x3
v_add_f32_dpp v169, v165, v165 row_ror:8 row_mask:0xf bank_mask:0x3
v_add_f32_dpp v168, v166, v166 row_ror:8 row_mask:0xf bank_mask:0xc
v_add_f32_dpp v169, v167, v167 row_ror:8 row_mask:0xf bank_mask:0xc
s_nop 0
v_add_f32_dpp v184, v168, v168 row_half_mirror row_mask:0xf bank_mask:0x5
v_add_f32_dpp v184, v169, v169 row_half_mirror row_mask:0xf bank_mask:0xa
s_nop 1
v_add_f32_dpp v184, v184, v184 quad_perm:[1,0,3,2] row_mask:0xf bank_mask:0xf
s_nop 1
v_add_f32_dpp v184, v184, v184 quad_perm:[2,3,0,1] row_mask:0xf bank_mask:0xf
v_dot2_f32_bf16 v164, v136, v148, 0
v_dot2_f32_bf16 v165, v136, v152, 0
v_dot2_f32_bf16 v166, v136, v156, 0
v_dot2_f32_bf16 v167, v136, v160, 0
v_dot2_f32_bf16 v164, v137, v149, v164
v_dot2_f32_bf16 v165, v137, v153, v165
v_dot2_f32_bf16 v166, v137, v157, v166
v_dot2_f32_bf16 v167, v137, v161, v167
v_dot2_f32_bf16 v164, v138, v150, v164
v_dot2_f32_bf16 v165, v138, v154, v165
v_dot2_f32_bf16 v166, v138, v158, v166
v_dot2_f32_bf16 v167, v138, v162, v167
v_dot2_f32_bf16 v164, v139, v151, v164
v_dot2_f32_bf16 v165, v139, v155, v165
v_dot2_f32_bf16 v166, v139, v159, v166
v_dot2_f32_bf16 v167, v139, v163, v167
v_add_f32_dpp v168, v164, v164 row_ror:8 row_mask:0xf bank_mask:0x3
v_add_f32_dpp v169, v165, v165 row_ror:8 row_mask:0xf bank_mask:0x3
v_add_f32_dpp v168, v166, v166 row_ror:8 row_mask:0xf bank_mask:0xc
v_add_f32_dpp v169, v167, v167 row_ror:8 row_mask:0xf bank_mask:0xc
s_nop 0
v_add_f32_dpp v185, v168, v168 row_half_mirror row_mask:0xf bank_mask:0x5
v_add_f32_dpp v185, v169, v169 row_half_mirror row_mask:0xf bank_mask:0xa
s_nop 1
v_add_f32_dpp v185, v185, v185 quad_perm:[1,0,3,2] row_mask:0xf bank_mask:0xf
s_nop 1
v_add_f32_dpp v185, v185, v185 quad_perm:[2,3,0,1] row_mask:0xf bank_mask:0xf
v_dot2_f32_bf16 v164, v140, v148, 0
v_dot2_f32_bf16 v165, v140, v152, 0
v_dot2_f32_bf16 v166, v140, v156, 0
v_dot2_f32_bf16 v167, v140, v160, 0
v_dot2_f32_bf16 v164, v141, v149, v164
v_dot2_f32_bf16 v165, v141, v153, v165
v_dot2_f32_bf16 v166, v141, v157, v166
v_dot2_f32_bf16 v167, v141, v161, v167
v_dot2_f32_bf16 v164, v142, v150, v164
v_dot2_f32_bf16 v165, v142, v154, v165
v_dot2_f32_bf16 v166, v142, v158, v166
v_dot2_f32_bf16 v167, v142, v162, v167
v_dot2_f32_bf16 v164, v143, v151, v164
v_dot2_f32_bf16 v165, v143, v155, v165
v_dot2_f32_bf16 v166, v143, v159, v166
v_dot2_f32_bf16 v167, v143, v163, v167
v_add_f32_dpp v168, v164, v164 row_ror:8 row_mask:0xf bank_mask:0x3
v_add_f32_dpp v169, v165, v165 row_ror:8 row_mask:0xf bank_mask:0x3
v_add_f32_dpp v168, v166, v166 row_ror:8 row_mask:0xf bank_mask:0xc
v_add_f32_dpp v169, v167, v167 row_ror:8 row_mask:0xf bank_mask:0xc
s_nop 0
v_add_f32_dpp v186, v168, v168 row_half_mirror row_mask:0xf bank_mask:0x5
v_add_f32_dpp v186, v169, v169 row_half_mirror row_mask:0xf bank_mask:0xa
s_nop 1
v_add_f32_dpp v186, v186, v186 quad_perm:[1,0,3,2] row_mask:0xf bank_mask:0xf
s_nop 1
v_add_f32_dpp v186, v186, v186 quad_perm:[2,3,0,1] row_mask:0xf bank_mask:0xf
v_dot2_f32_bf16 v164, v144, v148, 0
v_dot2_f32_bf16 v165, v144, v152, 0
v_dot2_f32_bf16 v166, v144, v156, 0
v_dot2_f32_bf16 v167, v144, v160, 0
v_dot2_f32_bf16 v164, v145, v149, v164
v_dot2_f32_bf16 v165, v145, v153, v165
v_dot2_f32_bf16 v166, v145, v157, v166
v_dot2_f32_bf16 v167, v145, v161, v167
v_dot2_f32_bf16 v164, v146, v150, v164
v_dot2_f32_bf16 v165, v146, v154, v165
v_dot2_f32_bf16 v166, v146, v158, v166
v_dot2_f32_bf16 v167, v146, v162, v167
v_dot2_f32_bf16 v164, v147, v151, v164
v_dot2_f32_bf16 v165, v147, v155, v165
v_dot2_f32_bf16 v166, v147, v159, v166
v_dot2_f32_bf16 v167, v147, v163, v167
v_add_f32_dpp v168, v164, v164 row_ror:8 row_mask:0xf bank_mask:0x3
v_add_f32_dpp v169, v165, v165 row_ror:8 row_mask:0xf bank_mask:0x3
v_add_f32_dpp v168, v166, v166 row_ror:8 row_mask:0xf bank_mask:0xc
v_add_f32_dpp v169, v167, v167 row_ror:8 row_mask:0xf bank_mask:0xc
s_nop 0
v_add_f32_dpp v187, v168, v168 row_half_mirror row_mask:0xf bank_mask:0x5
v_add_f32_dpp v187, v169, v169 row_half_mirror row_mask:0xf bank_mask:0xa
s_nop 1
v_add_f32_dpp v187, v187, v187 quad_perm:[1,0,3,2] row_mask:0xf bank_mask:0xf
s_nop 1
v_add_f32_dpp v187, v187, v187 quad_perm:[2,3,0,1] row_mask:0xf bank_mask:0xf
v_cvt_pk_bf16_f32 v188, v172, v173
v_cvt_pk_bf16_f32 v189, v174, v175
v_cvt_pk_bf16_f32 v190, v176, v177
v_cvt_pk_bf16_f32 v191, v178, v179
v_cvt_pk_bf16_f32 v192, v180, v181
v_cvt_pk_bf16_f32 v193, v182, v183
v_cvt_pk_bf16_f32 v194, v184, v185
v_cvt_pk_bf16_f32 v195, v186, v187
v_min_u32 v188, -2, v188
v_min_u32 v189, -2, v189
v_min_u32 v190, -2, v190
v_min_u32 v191, -2, v191
v_min_u32 v192, -2, v192
v_min_u32 v193, -2, v193
v_min_u32 v194, -2, v194
v_min_u32 v195, -2, v195
v_bfe_u32 v5, v1, 2, 2
v_lshlrev_b32 v5, 15, v5
v_lshl_add_u32 v5, v9, 5, v5
s_lshl_b32 s6, s4, 10
s_lshl_b32 s7, s8, 9
s_add_u32 s6, s6, s7
s_lshl_b32 s7, s3, 7
s_add_u32 s6, s6, s7
s_add_u32 s6, s6, 0
s_mov_b32 exec_lo, 0x11111111
s_mov_b32 exec_hi, 0x11111111
buffer_store_dwordx4 v[188:191], v5, s[64:67], s6 offen sc1
buffer_store_dwordx4 v[192:195], v5, s[64:67], s6 offen offset:16 sc1
s_mov_b64 exec, -1
s_waitcnt vmcnt(6)
s_mov_b32 s7, 400000
L_ens_15:
v_readfirstlane_b32 s6, v11
s_cmp_ge_u32 s6, 64
s_cbranch_scc1 L_ensd_16
s_sleep 16
buffer_load_dword v11, off, s[68:71], 0 offset:0 sc1
s_waitcnt vmcnt(0)
s_sub_u32 s7, s7, 1
s_cmp_lg_u32 s7, 0
s_cbranch_scc1 L_ens_15
L_ensd_16:
s_lshl_b32 s14, s10, 15
s_lshl_b32 s6, s3, 12
s_add_u32 s14, s14, s6
s_add_u32 s14, s14, 0
s_add_u32 s15, s14, 16384
s_nop 1
buffer_load_dwordx4 v[84:87], v2, s[64:67], s14 offen offset:0 sc1
buffer_load_dwordx4 v[88:91], v2, s[64:67], s14 offen offset:1024 sc1
buffer_load_dwordx4 v[92:95], v2, s[64:67], s14 offen offset:2048 sc1
buffer_load_dwordx4 v[96:99], v2, s[64:67], s14 offen offset:3072 sc1
buffer_load_dwordx4 v[100:103], v2, s[64:67], s15 offen offset:0 sc1
buffer_load_dwordx4 v[104:107], v2, s[64:67], s15 offen offset:1024 sc1
buffer_load_dwordx4 v[108:111], v2, s[64:67], s15 offen offset:2048 sc1
buffer_load_dwordx4 v[112:115], v2, s[64:67], s15 offen offset:3072 sc1
s_add_u32 s6, s13, 131072
buffer_load_dwordx4 a[128:131], v2, s[52:55], s6 offen nt
s_add_u32 s6, s13, 132096
buffer_load_dwordx4 a[132:135], v2, s[52:55], s6 offen nt
s_add_u32 s6, s13, 133120
buffer_load_dwordx4 a[136:139], v2, s[52:55], s6 offen nt
s_add_u32 s6, s13, 134144
buffer_load_dwordx4 a[140:143], v2, s[52:55], s6 offen nt
s_add_u32 s6, s13, 135168
buffer_load_dwordx4 a[144:147], v2, s[52:55], s6 offen nt
s_add_u32 s6, s13, 136192
buffer_load_dwordx4 a[148:151], v2, s[52:55], s6 offen nt
s_add_u32 s6, s13, 137216
buffer_load_dwordx4 a[152:155], v2, s[52:55], s6 offen nt
s_add_u32 s6, s13, 138240
buffer_load_dwordx4 a[156:159], v2, s[52:55], s6 offen nt
s_add_u32 s6, s13, 139264
buffer_load_dwordx4 a[160:163], v10, s[52:55], s6 offen nt
s_add_u32 s6, s13, 140288
buffer_load_dwordx4 a[164:167], v10, s[52:55], s6 offen nt
s_add_u32 s6, s13, 141312
buffer_load_dwordx4 a[168:171], v10, s[52:55], s6 offen nt
s_add_u32 s6, s13, 142336
buffer_load_dwordx4 a[172:175], v10, s[52:55], s6 offen nt
s_add_u32 s6, s13, 143360
buffer_load_dwordx4 a[176:179], v10, s[52:55], s6 offen nt
s_add_u32 s6, s13, 144384
buffer_load_dwordx4 a[180:183], v10, s[52:55], s6 offen nt
s_add_u32 s6, s13, 145408
buffer_load_dwordx4 a[184:187], v10, s[52:55], s6 offen nt
s_add_u32 s6, s13, 146432
buffer_load_dwordx4 a[188:191], v10, s[52:55], s6 offen nt
s_add_u32 s6, s13, 196608
buffer_load_dwordx4 a[192:195], v2, s[52:55], s6 offen nt
s_add_u32 s6, s13, 197632
buffer_load_dwordx4 a[196:199], v2, s[52:55], s6 offen nt
s_add_u32 s6, s13, 198656
buffer_load_dwordx4 a[200:203], v2, s[52:55], s6 offen nt
s_add_u32 s6, s13, 199680
buffer_load_dwordx4 a[204:207], v2, s[52:55], s6 offen nt
s_add_u32 s6, s13, 200704
buffer_load_dwordx4 a[208:211], v2, s[52:55], s6 offen nt
s_add_u32 s6, s13, 201728
buffer_load_dwordx4 a[212:215], v2, s[52:55], s6 offen nt
s_add_u32 s6, s13, 202752
buffer_load_dwordx4 a[216:219], v2, s[52:55], s6 offen nt
s_add_u32 s6, s13, 203776
buffer_load_dwordx4 a[220:223], v2, s[52:55], s6 offen nt
s_add_u32 s6, s13, 204800
buffer_load_dwordx4 a[224:227], v10, s[52:55], s6 offen nt
s_add_u32 s6, s13, 205824
buffer_load_dwordx4 a[228:231], v10, s[52:55], s6 offen nt
s_add_u32 s6, s13, 206848
buffer_load_dwordx4 a[232:235], v10, s[52:55], s6 offen nt
s_add_u32 s6, s13, 207872
buffer_load_dwordx4 a[236:239], v10, s[52:55], s6 offen nt
s_add_u32 s6, s13, 208896
buffer_load_dwordx4 a[240:243], v10, s[52:55], s6 offen nt
s_add_u32 s6, s13, 209920
buffer_load_dwordx4 a[244:247], v10, s[52:55], s6 offen nt
s_add_u32 s6, s13, 210944
buffer_load_dwordx4 a[248:251], v10, s[52:55], s6 offen nt
s_add_u32 s6, s13, 211968
buffer_load_dwordx4 a[252:255], v10, s[52:55], s6 offen nt
s_lshl_b32 s6, s3, 4
v_add_u32 v5, s6, v8
v_mul_u32_u24 v5, 1088, v5
v_lshrrev_b32 v6, 3, v8
v_lshlrev_b32 v6, 1, v6
v_xor_b32 v6, v6, v9
v_lshl_add_u32 v194, v6, 4, v5
v_add_u32 v195, 69632, v194
v_lshrrev_b32 v5, 5, v1
v_lshlrev_b32 v5, 3, v5
v_bfe_u32 v6, v1, 2, 2
v_add_u32 v5, v5, v6
v_mul_u32_u24 v5, 1088, v5
v_lshrrev_b32 v6, 1, v9
v_xor_b32 v6, v6, v9
v_and_b32 v6, 1, v6
v_lshl_add_u32 v5, v6, 5, v5
v_and_b32 v6, 3, v1
v_lshl_add_u32 v5, v6, 3, v5
s_lshl_b32 s6, s3, 8
v_add_u32 v196, s6, v5
v_add_u32 v197, 69632, v196
v_lshlrev_b32 v199, 4, v8
v_add_u32 v199, 160256, v199
s_lshl_b32 s6, s3, 2
v_add_u32 v198, s6, v199
v_and_b32 v5, 31, v1
v_lshlrev_b32 v200, 4, v5
v_add_u32 v200, 160256, v200
v_lshlrev_b32 v202, 5, v5
v_lshrrev_b32 v6, 5, v1
v_lshl_add_u32 v202, v6, 4, v202
v_add_u32 v202, 156160, v202
v_lshlrev_b32 v201, 5, v8
v_lshl_add_u32 v201, v9, 3, v201
s_lshl_b32 s6, s3, 10
s_add_u32 s6, s6, 156160
v_add_u32 v201, s6, v201
v_mul_u32_u24 v203, 1056, v8
v_lshl_add_u32 v203, v9, 4, v203
v_add_u32 v203, 139264, v203
s_mul_i32 s6, s3, 4224
s_add_u32 s6, s6, 139264
v_add_u32 v204, s6, v2
v_add_u32 v206, s12, v2
v_add_u32 v207, 69632, v206
v_mov_b32 v185, 0x3e0293ee
v_mov_b32 v176, 0xff800000
v_mov_b32 v177, 0xff800000
v_mov_b32 v178, 0xff800000
v_mov_b32 v180, 0
v_mov_b32 v181, 0
s_waitcnt vmcnt(32)
s_mov_b32 s7, 400000
Q_chk:
v_max3_u32 v192, v84, v85, v86
v_max3_u32 v192, v192, v87, v88
v_max3_u32 v192, v192, v89, v90
v_max3_u32 v192, v192, v91, v92
v_max3_u32 v192, v192, v93, v94
v_max3_u32 v192, v192, v95, v96
v_max3_u32 v192, v192, v97, v98
v_max3_u32 v192, v192, v99, v100
v_max3_u32 v192, v192, v101, v102
v_max3_u32 v192, v192, v103, v104
v_max3_u32 v192, v192, v105, v106
v_max3_u32 v192, v192, v107, v108
v_max3_u32 v192, v192, v109, v110
v_max3_u32 v192, v192, v111, v112
v_max3_u32 v192, v192, v113, v114
v_max_u32 v192, v192, v115
v_cmp_eq_u32 vcc, -1, v192
s_cbranch_vccz Q_ok
s_sleep 16
buffer_load_dwordx4 v[84:87], v2, s[64:67], s14 offen offset:0 sc1
buffer_load_dwordx4 v[88:91], v2, s[64:67], s14 offen offset:1024 sc1
buffer_load_dwordx4 v[92:95], v2, s[64:67], s14 offen offset:2048 sc1
buffer_load_dwordx4 v[96:99], v2, s[64:67], s14 offen offset:3072 sc1
buffer_load_dwordx4 v[100:103], v2, s[64:67], s15 offen offset:0 sc1
buffer_load_dwordx4 v[104:107], v2, s[64:67], s15 offen offset:1024 sc1
buffer_load_dwordx4 v[108:111], v2, s[64:67], s15 offen offset:2048 sc1
buffer_load_dwordx4 v[112:115], v2, s[64:67], s15 offen offset:3072 sc1
s_waitcnt vmcnt(0)
s_sub_u32 s7, s7, 1
s_cmp_lg_u32 s7, 0
s_cbranch_scc1 Q_chk
Q_ok:
s_barrier
ds_write_b128 v204, v[84:87] offset:0
ds_write_b128 v204, v[88:91] offset:1056
ds_write_b128 v204, v[92:95] offset:2112
ds_write_b128 v204, v[96:99] offset:3168
s_waitcnt lgkmcnt(0)
s_barrier
ds_read_b128 a[0:3], v203 offset:0
ds_read_b128 a[4:7], v203 offset:64
ds_read_b128 a[8:11], v203 offset:128
ds_read_b128 a[12:15], v203 offset:192
ds_read_b128 a[16:19], v203 offset:256
ds_read_b128 a[20:23], v203 offset:320
ds_read_b128 a[24:27], v203 offset:384
ds_read_b128 a[28:31], v203 offset:448
ds_read_b128 a[32:35], v203 offset:512
ds_read_b128 a[36:39], v203 offset:576
ds_read_b128 a[40:43], v203 offset:640
ds_read_b128 a[44:47], v203 offset:704
ds_read_b128 a[48:51], v203 offset:768
ds_read_b128 a[52:55], v203 offset:832
ds_read_b128 a[56:59], v203 offset:896
ds_read_b128 a[60:63], v203 offset:960
s_waitcnt lgkmcnt(0)
s_barrier
ds_write_b128 v204, v[100:103] offset:0
ds_write_b128 v204, v[104:107] offset:1056
ds_write_b128 v204, v[108:111] offset:2112
ds_write_b128 v204, v[112:115] offset:3168
s_waitcnt lgkmcnt(0)
s_barrier
ds_read_b128 a[64:67], v203 offset:0
ds_read_b128 a[68:71], v203 offset:64
ds_read_b128 a[72:75], v203 offset:128
ds_read_b128 a[76:79], v203 offset:192
ds_read_b128 a[80:83], v203 offset:256
ds_read_b128 a[84:87], v203 offset:320
ds_read_b128 a[88:91], v203 offset:384
ds_read_b128 a[92:95], v203 offset:448
ds_read_b128 a[96:99], v203 offset:512
ds_read_b128 a[100:103], v203 offset:576
ds_read_b128 a[104:107], v203 offset:640
ds_read_b128 a[108:111], v203 offset:704
ds_read_b128 a[112:115], v203 offset:768
ds_read_b128 a[116:119], v203 offset:832
ds_read_b128 a[120:123], v203 offset:896
ds_read_b128 a[124:127], v203 offset:960
s_waitcnt lgkmcnt(0)
ds_read_b128 v[84:87], v194 offset:0
ds_read_b128 v[88:91], v194 offset:64
ds_read_b128 v[92:95], v194 offset:128
ds_read_b128 v[96:99], v194 offset:192
ds_read_b128 v[100:103], v194 offset:256
ds_read_b128 v[104:107], v194 offset:320
ds_read_b128 v[108:111], v194 offset:384
ds_read_b128 v[112:115], v194 offset:448
ds_read_b128 v[116:119], v194 offset:512
ds_read_b128 v[120:123], v194 offset:576
ds_read_b128 v[124:127], v194 offset:640
ds_read_b128 v[128:131], v194 offset:704
ds_read_b128 v[132:135], v194 offset:768
ds_read_b128 v[136:139], v194 offset:832
ds_read_b128 v[140:143], v194 offset:896
ds_read_b128 v[144:147], v194 offset:960
s_waitcnt lgkmcnt(15)
v_mfma_f32_16x16x32_bf16 v[76:79], v[84:87], a[0:3], 0
v_mfma_f32_16x16x32_bf16 v[80:83], v[84:87], a[64:67], 0
s_waitcnt lgkmcnt(14)
v_mfma_f32_16x16x32_bf16 v[76:79], v[88:91], a[4:7], v[76:79]
v_mfma_f32_16x16x32_bf16 v[80:83], v[88:91], a[68:71], v[80:83]
s_waitcnt lgkmcnt(13)
v_mfma_f32_16x16x32_bf16 v[76:79], v[92:95], a[8:11], v[76:79]
v_mfma_f32_16x16x32_bf16 v[80:83], v[92:95], a[72:75], v[80:83]
s_waitcnt lgkmcnt(12)
v_mfma_f32_16x16x32_bf16 v[76:79], v[96:99], a[12:15], v[76:79]
v_mfma_f32_16x16x32_bf16 v[80:83], v[96:99], a[76:79], v[80:83]
s_waitcnt lgkmcnt(11)
v_mfma_f32_16x16x32_bf16 v[76:79], v[100:103], a[16:19], v[76:79]
v_mfma_f32_16x16x32_bf16 v[80:83], v[100:103], a[80:83], v[80:83]
s_waitcnt lgkmcnt(10)
v_mfma_f32_16x16x32_bf16 v[76:79], v[104:107], a[20:23], v[76:79]
v_mfma_f32_16x16x32_bf16 v[80:83], v[104:107], a[84:87], v[80:83]
s_waitcnt lgkmcnt(9)
v_mfma_f32_16x16x32_bf16 v[76:79], v[108:111], a[24:27], v[76:79]
v_mfma_f32_16x16x32_bf16 v[80:83], v[108:111], a[88:91], v[80:83]
s_waitcnt lgkmcnt(8)
v_mfma_f32_16x16x32_bf16 v[76:79], v[112:115], a[28:31], v[76:79]
v_mfma_f32_16x16x32_bf16 v[80:83], v[112:115], a[92:95], v[80:83]
s_waitcnt lgkmcnt(7)
v_mfma_f32_16x16x32_bf16 v[76:79], v[116:119], a[32:35], v[76:79]
v_mfma_f32_16x16x32_bf16 v[80:83], v[116:119], a[96:99], v[80:83]
s_waitcnt lgkmcnt(6)
v_mfma_f32_16x16x32_bf16 v[76:79], v[120:123], a[36:39], v[76:79]
v_mfma_f32_16x16x32_bf16 v[80:83], v[120:123], a[100:103], v[80:83]
s_waitcnt lgkmcnt(5)
v_mfma_f32_16x16x32_bf16 v[76:79], v[124:127], a[40:43], v[76:79]
v_mfma_f32_16x16x32_bf16 v[80:83], v[124:127], a[104:107], v[80:83]
s_waitcnt lgkmcnt(4)
v_mfma_f32_16x16x32_bf16 v[76:79], v[128:131], a[44:47], v[76:79]
v_mfma_f32_16x16x32_bf16 v[80:83], v[128:131], a[108:111], v[80:83]
s_waitcnt lgkmcnt(3)
v_mfma_f32_16x16x32_bf16 v[76:79], v[132:135], a[48:51], v[76:79]
v_mfma_f32_16x16x32_bf16 v[80:83], v[132:135], a[112:115], v[80:83]
s_waitcnt lgkmcnt(2)
v_mfma_f32_16x16x32_bf16 v[76:79], v[136:139], a[52:55], v[76:79]
v_mfma_f32_16x16x32_bf16 v[80:83], v[136:139], a[116:119], v[80:83]
s_waitcnt lgkmcnt(1)
v_mfma_f32_16x16x32_bf16 v[76:79], v[140:143], a[56:59], v[76:79]
v_mfma_f32_16x16x32_bf16 v[80:83], v[140:143], a[120:123], v[80:83]
s_waitcnt lgkmcnt(0)
v_mfma_f32_16x16x32_bf16 v[76:79], v[144:147], a[60:63], v[76:79]
v_mfma_f32_16x16x32_bf16 v[80:83], v[144:147], a[124:127], v[80:83]
s_nop 6
v_max_f32 v190, v76, v77
v_max3_f32 v190, v190, v78, v79
v_mov_b32 v192, v190
s_nop 1
v_permlane16_swap_b32 v190, v192
v_max_f32 v190, v190, v192
v_mov_b32 v192, v190
s_nop 1
v_permlane32_swap_b32 v190, v192
v_max_f32 v190, v190, v192
ds_write_b32 v198, v190 offset:0
v_max_f32 v191, v80, v81
v_max3_f32 v191, v191, v82, v83
v_mov_b32 v192, v191
s_nop 1
v_permlane16_swap_b32 v191, v192
v_max_f32 v191, v191, v192
v_mov_b32 v192, v191
s_nop 1
v_permlane32_swap_b32 v191, v192
v_max_f32 v191, v191, v192
ds_write_b32 v198, v191 offset:256
s_waitcnt lgkmcnt(0)
s_barrier
ds_read_b128 v[164:167], v199
ds_read_b128 v[168:171], v199 offset:256
ds_read_b128 v[172:175], v200
s_waitcnt lgkmcnt(0)
v_max_f32 v164, v164, v165
v_max3_f32 v164, v164, v166, v167
v_mul_f32 v164, v164, v185
v_max_f32 v164, v164, v176
v_sub_f32 v182, v176, v164
v_exp_f32 v182, v182
v_mov_b32 v176, v164
v_max_f32 v168, v168, v169
v_max3_f32 v168, v168, v170, v171
v_mul_f32 v168, v168, v185
v_max_f32 v168, v168, v177
v_sub_f32 v183, v177, v168
v_exp_f32 v183, v183
v_mov_b32 v177, v168
v_max_f32 v172, v172, v173
v_max3_f32 v172, v172, v174, v175
v_mul_f32 v172, v172, v185
v_max_f32 v172, v172, v178
v_sub_f32 v184, v178, v172
v_exp_f32 v184, v184
v_mov_b32 v178, v172
v_fma_f32 v76, v76, v185, -v176
v_fma_f32 v77, v77, v185, -v176
v_fma_f32 v78, v78, v185, -v176
v_fma_f32 v79, v79, v185, -v176
v_exp_f32 v76, v76
v_exp_f32 v77, v77
v_exp_f32 v78, v78
v_exp_f32 v79, v79
v_mul_f32 v180, v180, v182
v_cvt_pk_bf16_f32 v186, v76, v77
v_cvt_pk_bf16_f32 v187, v78, v79
ds_write_b64 v201, v[186:187] offset:0
v_add_f32 v180, v180, v76
v_add_f32 v180, v180, v77
v_add_f32 v180, v180, v78
v_add_f32 v180, v180, v79
v_fma_f32 v80, v80, v185, -v177
v_fma_f32 v81, v81, v185, -v177
v_fma_f32 v82, v82, v185, -v177
v_fma_f32 v83, v83, v185, -v177
v_exp_f32 v80, v80
v_exp_f32 v81, v81
v_exp_f32 v82, v82
v_exp_f32 v83, v83
v_mul_f32 v181, v181, v183
v_cvt_pk_bf16_f32 v188, v80, v81
v_cvt_pk_bf16_f32 v189, v82, v83
ds_write_b64 v201, v[188:189] offset:512
v_add_f32 v181, v181, v80
v_add_f32 v181, v181, v81
v_add_f32 v181, v181, v82
v_add_f32 v181, v181, v83
s_waitcnt lgkmcnt(0)
s_barrier
ds_read_b128 v[148:151], v202 offset:0
ds_read_b128 v[152:155], v202 offset:1024
ds_read_b128 v[156:159], v202 offset:2048
ds_read_b128 v[160:163], v202 offset:3072
ds_read_b64_tr_b16 v[84:85], v196 offset:0
ds_read_b64_tr_b16 v[86:87], v196 offset:4352
ds_read_b64_tr_b16 v[88:89], v196 offset:64
ds_read_b64_tr_b16 v[90:91], v196 offset:4416
ds_read_b64_tr_b16 v[92:93], v196 offset:128
ds_read_b64_tr_b16 v[94:95], v196 offset:4480
ds_read_b64_tr_b16 v[96:97], v196 offset:192
ds_read_b64_tr_b16 v[98:99], v196 offset:4544
ds_read_b64_tr_b16 v[100:101], v196 offset:17408
ds_read_b64_tr_b16 v[102:103], v196 offset:21760
ds_read_b64_tr_b16 v[104:105], v196 offset:17472
ds_read_b64_tr_b16 v[106:107], v196 offset:21824
ds_read_b64_tr_b16 v[108:109], v196 offset:17536
ds_read_b64_tr_b16 v[110:111], v196 offset:21888
ds_read_b64_tr_b16 v[112:113], v196 offset:17600
ds_read_b64_tr_b16 v[114:115], v196 offset:21952
ds_read_b64_tr_b16 v[116:117], v196 offset:34816
ds_read_b64_tr_b16 v[118:119], v196 offset:39168
ds_read_b64_tr_b16 v[120:121], v196 offset:34880
ds_read_b64_tr_b16 v[122:123], v196 offset:39232
ds_read_b64_tr_b16 v[124:125], v196 offset:34944
ds_read_b64_tr_b16 v[126:127], v196 offset:39296
ds_read_b64_tr_b16 v[128:129], v196 offset:35008
ds_read_b64_tr_b16 v[130:131], v196 offset:39360
ds_read_b64_tr_b16 v[132:133], v196 offset:52224
ds_read_b64_tr_b16 v[134:135], v196 offset:56576
ds_read_b64_tr_b16 v[136:137], v196 offset:52288
ds_read_b64_tr_b16 v[138:139], v196 offset:56640
ds_read_b64_tr_b16 v[140:141], v196 offset:52352
ds_read_b64_tr_b16 v[142:143], v196 offset:56704
ds_read_b64_tr_b16 v[144:145], v196 offset:52416
ds_read_b64_tr_b16 v[146:147], v196 offset:56768
s_waitcnt lgkmcnt(15)
v_mfma_f32_32x32x16_bf16 v[12:27], v[84:87], v[148:151], 0
v_mfma_f32_32x32x16_bf16 v[28:43], v[88:91], v[148:151], 0
v_mfma_f32_32x32x16_bf16 v[44:59], v[92:95], v[148:151], 0
v_mfma_f32_32x32x16_bf16 v[60:75], v[96:99], v[148:151], 0
s_waitcnt lgkmcnt(15)
v_mfma_f32_32x32x16_bf16 v[12:27], v[100:103], v[152:155], v[12:27]
v_mfma_f32_32x32x16_bf16 v[28:43], v[104:107], v[152:155], v[28:43]
v_mfma_f32_32x32x16_bf16 v[44:59], v[108:111], v[152:155], v[44:59]
v_mfma_f32_32x32x16_bf16 v[60:75], v[112:115], v[152:155], v[60:75]
s_waitcnt lgkmcnt(8)
v_mfma_f32_32x32x16_bf16 v[12:27], v[116:119], v[156:159], v[12:27]
v_mfma_f32_32x32x16_bf16 v[28:43], v[120:123], v[156:159], v[28:43]
v_mfma_f32_32x32x16_bf16 v[44:59], v[124:127], v[156:159], v[44:59]
v_mfma_f32_32x32x16_bf16 v[60:75], v[128:131], v[156:159], v[60:75]
s_waitcnt lgkmcnt(0)
v_mfma_f32_32x32x16_bf16 v[12:27], v[132:135], v[160:163], v[12:27]
v_mfma_f32_32x32x16_bf16 v[28:43], v[136:139], v[160:163], v[28:43]
v_mfma_f32_32x32x16_bf16 v[44:59], v[140:143], v[160:163], v[44:59]
v_mfma_f32_32x32x16_bf16 v[60:75], v[144:147], v[160:163], v[60:75]
ds_read_b128 v[84:87], v195 offset:0
ds_read_b128 v[88:91], v195 offset:64
ds_read_b128 v[92:95], v195 offset:128
ds_read_b128 v[96:99], v195 offset:192
ds_read_b128 v[100:103], v195 offset:256
ds_read_b128 v[104:107], v195 offset:320
ds_read_b128 v[108:111], v195 offset:384
ds_read_b128 v[112:115], v195 offset:448
ds_read_b128 v[116:119], v195 offset:512
ds_read_b128 v[120:123], v195 offset:576
ds_read_b128 v[124:127], v195 offset:640
ds_read_b128 v[128:131], v195 offset:704
ds_read_b128 v[132:135], v195 offset:768
ds_read_b128 v[136:139], v195 offset:832
ds_read_b128 v[140:143], v195 offset:896
ds_read_b128 v[144:147], v195 offset:960
s_waitcnt lgkmcnt(15)
v_mfma_f32_16x16x32_bf16 v[76:79], v[84:87], a[0:3], 0
v_mfma_f32_16x16x32_bf16 v[80:83], v[84:87], a[64:67], 0
s_waitcnt lgkmcnt(14)
v_mfma_f32_16x16x32_bf16 v[76:79], v[88:91], a[4:7], v[76:79]
v_mfma_f32_16x16x32_bf16 v[80:83], v[88:91], a[68:71], v[80:83]
s_waitcnt lgkmcnt(13)
v_mfma_f32_16x16x32_bf16 v[76:79], v[92:95], a[8:11], v[76:79]
v_mfma_f32_16x16x32_bf16 v[80:83], v[92:95], a[72:75], v[80:83]
s_waitcnt lgkmcnt(12)
v_mfma_f32_16x16x32_bf16 v[76:79], v[96:99], a[12:15], v[76:79]
v_mfma_f32_16x16x32_bf16 v[80:83], v[96:99], a[76:79], v[80:83]
s_waitcnt lgkmcnt(11)
v_mfma_f32_16x16x32_bf16 v[76:79], v[100:103], a[16:19], v[76:79]
v_mfma_f32_16x16x32_bf16 v[80:83], v[100:103], a[80:83], v[80:83]
s_waitcnt lgkmcnt(10)
v_mfma_f32_16x16x32_bf16 v[76:79], v[104:107], a[20:23], v[76:79]
v_mfma_f32_16x16x32_bf16 v[80:83], v[104:107], a[84:87], v[80:83]
s_waitcnt lgkmcnt(9)
v_mfma_f32_16x16x32_bf16 v[76:79], v[108:111], a[24:27], v[76:79]
v_mfma_f32_16x16x32_bf16 v[80:83], v[108:111], a[88:91], v[80:83]
s_waitcnt lgkmcnt(8)
v_mfma_f32_16x16x32_bf16 v[76:79], v[112:115], a[28:31], v[76:79]
v_mfma_f32_16x16x32_bf16 v[80:83], v[112:115], a[92:95], v[80:83]
s_waitcnt lgkmcnt(7)
v_mfma_f32_16x16x32_bf16 v[76:79], v[116:119], a[32:35], v[76:79]
v_mfma_f32_16x16x32_bf16 v[80:83], v[116:119], a[96:99], v[80:83]
s_waitcnt lgkmcnt(6)
v_mfma_f32_16x16x32_bf16 v[76:79], v[120:123], a[36:39], v[76:79]
v_mfma_f32_16x16x32_bf16 v[80:83], v[120:123], a[100:103], v[80:83]
s_waitcnt lgkmcnt(5)
v_mfma_f32_16x16x32_bf16 v[76:79], v[124:127], a[40:43], v[76:79]
v_mfma_f32_16x16x32_bf16 v[80:83], v[124:127], a[104:107], v[80:83]
s_waitcnt lgkmcnt(4)
v_mfma_f32_16x16x32_bf16 v[76:79], v[128:131], a[44:47], v[76:79]
v_mfma_f32_16x16x32_bf16 v[80:83], v[128:131], a[108:111], v[80:83]
s_waitcnt lgkmcnt(3)
v_mfma_f32_16x16x32_bf16 v[76:79], v[132:135], a[48:51], v[76:79]
v_mfma_f32_16x16x32_bf16 v[80:83], v[132:135], a[112:115], v[80:83]
s_waitcnt lgkmcnt(2)
v_mfma_f32_16x16x32_bf16 v[76:79], v[136:139], a[52:55], v[76:79]
v_mfma_f32_16x16x32_bf16 v[80:83], v[136:139], a[116:119], v[80:83]
s_waitcnt lgkmcnt(1)
v_mfma_f32_16x16x32_bf16 v[76:79], v[140:143], a[56:59], v[76:79]
v_mfma_f32_16x16x32_bf16 v[80:83], v[140:143], a[120:123], v[80:83]
s_waitcnt lgkmcnt(0)
v_mfma_f32_16x16x32_bf16 v[76:79], v[144:147], a[60:63], v[76:79]
v_mfma_f32_16x16x32_bf16 v[80:83], v[144:147], a[124:127], v[80:83]
s_nop 6
v_max_f32 v190, v76, v77
v_max3_f32 v190, v190, v78, v79
v_mov_b32 v192, v190
s_nop 1
v_permlane16_swap_b32 v190, v192
v_max_f32 v190, v190, v192
v_mov_b32 v192, v190
s_nop 1
v_permlane32_swap_b32 v190, v192
v_max_f32 v190, v190, v192
ds_write_b32 v198, v190 offset:0
v_max_f32 v191, v80, v81
v_max3_f32 v191, v191, v82, v83
v_mov_b32 v192, v191
s_nop 1
v_permlane16_swap_b32 v191, v192
v_max_f32 v191, v191, v192
v_mov_b32 v192, v191
s_nop 1
v_permlane32_swap_b32 v191, v192
v_max_f32 v191, v191, v192
ds_write_b32 v198, v191 offset:256
s_waitcnt lgkmcnt(0)
s_barrier
ds_read_b128 v[164:167], v199
ds_read_b128 v[168:171], v199 offset:256
ds_read_b128 v[172:175], v200
s_waitcnt vmcnt(16)
ds_write_b128 v206, a[128:131] offset:0
ds_write_b128 v206, a[132:135] offset:1088
ds_write_b128 v206, a[136:139] offset:2176
ds_write_b128 v206, a[140:143] offset:3264
ds_write_b128 v206, a[144:147] offset:4352
ds_write_b128 v206, a[148:151] offset:5440
ds_write_b128 v206, a[152:155] offset:6528
ds_write_b128 v206, a[156:159] offset:7616
ds_write_b128 v206, a[160:163] offset:8704
ds_write_b128 v206, a[164:167] offset:9792
ds_write_b128 v206, a[168:171] offset:10880
ds_write_b128 v206, a[172:175] offset:11968
ds_write_b128 v206, a[176:179] offset:13056
ds_write_b128 v206, a[180:183] offset:14144
ds_write_b128 v206, a[184:187] offset:15232
ds_write_b128 v206, a[188:191] offset:16320
s_waitcnt lgkmcnt(15)
v_max_f32 v164, v164, v165
v_max3_f32 v164, v164, v166, v167
v_mul_f32 v164, v164, v185
v_max_f32 v164, v164, v176
v_sub_f32 v182, v176, v164
v_exp_f32 v182, v182
v_mov_b32 v176, v164
v_max_f32 v168, v168, v169
v_max3_f32 v168, v168, v170, v171
v_mul_f32 v168, v168, v185
v_max_f32 v168, v168, v177
v_sub_f32 v183, v177, v168
v_exp_f32 v183, v183
v_mov_b32 v177, v168
v_max_f32 v172, v172, v173
v_max3_f32 v172, v172, v174, v175
v_mul_f32 v172, v172, v185
v_max_f32 v172, v172, v178
v_sub_f32 v184, v178, v172
v_exp_f32 v184, v184
v_mov_b32 v178, v172
v_fma_f32 v76, v76, v185, -v176
v_fma_f32 v77, v77, v185, -v176
v_fma_f32 v78, v78, v185, -v176
v_fma_f32 v79, v79, v185, -v176
v_exp_f32 v76, v76
v_exp_f32 v77, v77
v_exp_f32 v78, v78
v_exp_f32 v79, v79
v_mul_f32 v180, v180, v182
v_cvt_pk_bf16_f32 v186, v76, v77
v_cvt_pk_bf16_f32 v187, v78, v79
ds_write_b64 v201, v[186:187] offset:0
v_add_f32 v180, v180, v76
v_add_f32 v180, v180, v77
v_add_f32 v180, v180, v78
v_add_f32 v180, v180, v79
v_fma_f32 v80, v80, v185, -v177
v_fma_f32 v81, v81, v185, -v177
v_fma_f32 v82, v82, v185, -v177
v_fma_f32 v83, v83, v185, -v177
v_exp_f32 v80, v80
v_exp_f32 v81, v81
v_exp_f32 v82, v82
v_exp_f32 v83, v83
v_mul_f32 v181, v181, v183
v_cvt_pk_bf16_f32 v188, v80, v81
v_cvt_pk_bf16_f32 v189, v82, v83
ds_write_b64 v201, v[188:189] offset:512
v_add_f32 v181, v181, v80
v_add_f32 v181, v181, v81
v_add_f32 v181, v181, v82
v_add_f32 v181, v181, v83
v_mul_f32 v12, v12, v184
v_mul_f32 v13, v13, v184
v_mul_f32 v14, v14, v184
v_mul_f32 v15, v15, v184
v_mul_f32 v16, v16, v184
v_mul_f32 v17, v17, v184
v_mul_f32 v18, v18, v184
v_mul_f32 v19, v19, v184
v_mul_f32 v20, v20, v184
v_mul_f32 v21, v21, v184
v_mul_f32 v22, v22, v184
v_mul_f32 v23, v23, v184
v_mul_f32 v24, v24, v184
v_mul_f32 v25, v25, v184
v_mul_f32 v26, v26, v184
v_mul_f32 v27, v27, v184
v_mul_f32 v28, v28, v184
v_mul_f32 v29, v29, v184
v_mul_f32 v30, v30, v184
v_mul_f32 v31, v31, v184
v_mul_f32 v32, v32, v184
v_mul_f32 v33, v33, v184
v_mul_f32 v34, v34, v184
v_mul_f32 v35, v35, v184
v_mul_f32 v36, v36, v184
v_mul_f32 v37, v37, v184
v_mul_f32 v38, v38, v184
v_mul_f32 v39, v39, v184
v_mul_f32 v40, v40, v184
v_mul_f32 v41, v41, v184
v_mul_f32 v42, v42, v184
v_mul_f32 v43, v43, v184
v_mul_f32 v44, v44, v184
v_mul_f32 v45, v45, v184
v_mul_f32 v46, v46, v184
v_mul_f32 v47, v47, v184
v_mul_f32 v48, v48, v184
v_mul_f32 v49, v49, v184
v_mul_f32 v50, v50, v184
v_mul_f32 v51, v51, v184
v_mul_f32 v52, v52, v184
v_mul_f32 v53, v53, v184
v_mul_f32 v54, v54, v184
v_mul_f32 v55, v55, v184
v_mul_f32 v56, v56, v184
v_mul_f32 v57, v57, v184
v_mul_f32 v58, v58, v184
v_mul_f32 v59, v59, v184
v_mul_f32 v60, v60, v184
v_mul_f32 v61, v61, v184
v_mul_f32 v62, v62, v184
v_mul_f32 v63, v63, v184
v_mul_f32 v64, v64, v184
v_mul_f32 v65, v65, v184
v_mul_f32 v66, v66, v184
v_mul_f32 v67, v67, v184
v_mul_f32 v68, v68, v184
v_mul_f32 v69, v69, v184
v_mul_f32 v70, v70, v184
v_mul_f32 v71, v71, v184
v_mul_f32 v72, v72, v184
v_mul_f32 v73, v73, v184
v_mul_f32 v74, v74, v184
v_mul_f32 v75, v75, v184
s_waitcnt lgkmcnt(0)
s_barrier
ds_read_b128 v[148:151], v202 offset:0
ds_read_b128 v[152:155], v202 offset:1024
ds_read_b128 v[156:159], v202 offset:2048
ds_read_b128 v[160:163], v202 offset:3072
ds_read_b64_tr_b16 v[84:85], v197 offset:0
ds_read_b64_tr_b16 v[86:87], v197 offset:4352
ds_read_b64_tr_b16 v[88:89], v197 offset:64
ds_read_b64_tr_b16 v[90:91], v197 offset:4416
ds_read_b64_tr_b16 v[92:93], v197 offset:128
ds_read_b64_tr_b16 v[94:95], v197 offset:4480
ds_read_b64_tr_b16 v[96:97], v197 offset:192
ds_read_b64_tr_b16 v[98:99], v197 offset:4544
ds_read_b64_tr_b16 v[100:101], v197 offset:17408
ds_read_b64_tr_b16 v[102:103], v197 offset:21760
ds_read_b64_tr_b16 v[104:105], v197 offset:17472
ds_read_b64_tr_b16 v[106:107], v197 offset:21824
ds_read_b64_tr_b16 v[108:109], v197 offset:17536
ds_read_b64_tr_b16 v[110:111], v197 offset:21888
ds_read_b64_tr_b16 v[112:113], v197 offset:17600
ds_read_b64_tr_b16 v[114:115], v197 offset:21952
ds_read_b64_tr_b16 v[116:117], v197 offset:34816
ds_read_b64_tr_b16 v[118:119], v197 offset:39168
ds_read_b64_tr_b16 v[120:121], v197 offset:34880
ds_read_b64_tr_b16 v[122:123], v197 offset:39232
ds_read_b64_tr_b16 v[124:125], v197 offset:34944
ds_read_b64_tr_b16 v[126:127], v197 offset:39296
ds_read_b64_tr_b16 v[128:129], v197 offset:35008
ds_read_b64_tr_b16 v[130:131], v197 offset:39360
ds_read_b64_tr_b16 v[132:133], v197 offset:52224
ds_read_b64_tr_b16 v[134:135], v197 offset:56576
ds_read_b64_tr_b16 v[136:137], v197 offset:52288
ds_read_b64_tr_b16 v[138:139], v197 offset:56640
ds_read_b64_tr_b16 v[140:141], v197 offset:52352
ds_read_b64_tr_b16 v[142:143], v197 offset:56704
ds_read_b64_tr_b16 v[144:145], v197 offset:52416
ds_read_b64_tr_b16 v[146:147], v197 offset:56768
s_waitcnt lgkmcnt(15)
v_mfma_f32_32x32x16_bf16 v[12:27], v[84:87], v[148:151], v[12:27]
v_mfma_f32_32x32x16_bf16 v[28:43], v[88:91], v[148:151], v[28:43]
v_mfma_f32_32x32x16_bf16 v[44:59], v[92:95], v[148:151], v[44:59]
v_mfma_f32_32x32x16_bf16 v[60:75], v[96:99], v[148:151], v[60:75]
s_waitcnt lgkmcnt(15)
v_mfma_f32_32x32x16_bf16 v[12:27], v[100:103], v[152:155], v[12:27]
v_mfma_f32_32x32x16_bf16 v[28:43], v[104:107], v[152:155], v[28:43]
v_mfma_f32_32x32x16_bf16 v[44:59], v[108:111], v[152:155], v[44:59]
v_mfma_f32_32x32x16_bf16 v[60:75], v[112:115], v[152:155], v[60:75]
s_waitcnt lgkmcnt(8)
v_mfma_f32_32x32x16_bf16 v[12:27], v[116:119], v[156:159], v[12:27]
v_mfma_f32_32x32x16_bf16 v[28:43], v[120:123], v[156:159], v[28:43]
v_mfma_f32_32x32x16_bf16 v[44:59], v[124:127], v[156:159], v[44:59]
v_mfma_f32_32x32x16_bf16 v[60:75], v[128:131], v[156:159], v[60:75]
s_waitcnt lgkmcnt(0)
v_mfma_f32_32x32x16_bf16 v[12:27], v[132:135], v[160:163], v[12:27]
v_mfma_f32_32x32x16_bf16 v[28:43], v[136:139], v[160:163], v[28:43]
v_mfma_f32_32x32x16_bf16 v[44:59], v[140:143], v[160:163], v[44:59]
v_mfma_f32_32x32x16_bf16 v[60:75], v[144:147], v[160:163], v[60:75]
ds_read_b128 v[84:87], v194 offset:0
ds_read_b128 v[88:91], v194 offset:64
ds_read_b128 v[92:95], v194 offset:128
ds_read_b128 v[96:99], v194 offset:192
ds_read_b128 v[100:103], v194 offset:256
ds_read_b128 v[104:107], v194 offset:320
ds_read_b128 v[108:111], v194 offset:384
ds_read_b128 v[112:115], v194 offset:448
ds_read_b128 v[116:119], v194 offset:512
ds_read_b128 v[120:123], v194 offset:576
ds_read_b128 v[124:127], v194 offset:640
ds_read_b128 v[128:131], v194 offset:704
ds_read_b128 v[132:135], v194 offset:768
ds_read_b128 v[136:139], v194 offset:832
ds_read_b128 v[140:143], v194 offset:896
ds_read_b128 v[144:147], v194 offset:960
s_waitcnt lgkmcnt(15)
v_mfma_f32_16x16x32_bf16 v[76:79], v[84:87], a[0:3], 0
v_mfma_f32_16x16x32_bf16 v[80:83], v[84:87], a[64:67], 0
s_waitcnt lgkmcnt(14)
v_mfma_f32_16x16x32_bf16 v[76:79], v[88:91], a[4:7], v[76:79]
v_mfma_f32_16x16x32_bf16 v[80:83], v[88:91], a[68:71], v[80:83]
s_waitcnt lgkmcnt(13)
v_mfma_f32_16x16x32_bf16 v[76:79], v[92:95], a[8:11], v[76:79]
v_mfma_f32_16x16x32_bf16 v[80:83], v[92:95], a[72:75], v[80:83]
s_waitcnt lgkmcnt(12)
v_mfma_f32_16x16x32_bf16 v[76:79], v[96:99], a[12:15], v[76:79]
v_mfma_f32_16x16x32_bf16 v[80:83], v[96:99], a[76:79], v[80:83]
s_waitcnt lgkmcnt(11)
v_mfma_f32_16x16x32_bf16 v[76:79], v[100:103], a[16:19], v[76:79]
v_mfma_f32_16x16x32_bf16 v[80:83], v[100:103], a[80:83], v[80:83]
s_waitcnt lgkmcnt(10)
v_mfma_f32_16x16x32_bf16 v[76:79], v[104:107], a[20:23], v[76:79]
v_mfma_f32_16x16x32_bf16 v[80:83], v[104:107], a[84:87], v[80:83]
s_waitcnt lgkmcnt(9)
v_mfma_f32_16x16x32_bf16 v[76:79], v[108:111], a[24:27], v[76:79]
v_mfma_f32_16x16x32_bf16 v[80:83], v[108:111], a[88:91], v[80:83]
s_waitcnt lgkmcnt(8)
v_mfma_f32_16x16x32_bf16 v[76:79], v[112:115], a[28:31], v[76:79]
v_mfma_f32_16x16x32_bf16 v[80:83], v[112:115], a[92:95], v[80:83]
s_waitcnt lgkmcnt(7)
v_mfma_f32_16x16x32_bf16 v[76:79], v[116:119], a[32:35], v[76:79]
v_mfma_f32_16x16x32_bf16 v[80:83], v[116:119], a[96:99], v[80:83]
s_waitcnt lgkmcnt(6)
v_mfma_f32_16x16x32_bf16 v[76:79], v[120:123], a[36:39], v[76:79]
v_mfma_f32_16x16x32_bf16 v[80:83], v[120:123], a[100:103], v[80:83]
s_waitcnt lgkmcnt(5)
v_mfma_f32_16x16x32_bf16 v[76:79], v[124:127], a[40:43], v[76:79]
v_mfma_f32_16x16x32_bf16 v[80:83], v[124:127], a[104:107], v[80:83]
s_waitcnt lgkmcnt(4)
v_mfma_f32_16x16x32_bf16 v[76:79], v[128:131], a[44:47], v[76:79]
v_mfma_f32_16x16x32_bf16 v[80:83], v[128:131], a[108:111], v[80:83]
s_waitcnt lgkmcnt(3)
v_mfma_f32_16x16x32_bf16 v[76:79], v[132:135], a[48:51], v[76:79]
v_mfma_f32_16x16x32_bf16 v[80:83], v[132:135], a[112:115], v[80:83]
s_waitcnt lgkmcnt(2)
v_mfma_f32_16x16x32_bf16 v[76:79], v[136:139], a[52:55], v[76:79]
v_mfma_f32_16x16x32_bf16 v[80:83], v[136:139], a[116:119], v[80:83]
s_waitcnt lgkmcnt(1)
v_mfma_f32_16x16x32_bf16 v[76:79], v[140:143], a[56:59], v[76:79]
v_mfma_f32_16x16x32_bf16 v[80:83], v[140:143], a[120:123], v[80:83]
s_waitcnt lgkmcnt(0)
v_mfma_f32_16x16x32_bf16 v[76:79], v[144:147], a[60:63], v[76:79]
v_mfma_f32_16x16x32_bf16 v[80:83], v[144:147], a[124:127], v[80:83]
s_nop 6
v_max_f32 v190, v76, v77
v_max3_f32 v190, v190, v78, v79
v_mov_b32 v192, v190
s_nop 1
v_permlane16_swap_b32 v190, v192
v_max_f32 v190, v190, v192
v_mov_b32 v192, v190
s_nop 1
v_permlane32_swap_b32 v190, v192
v_max_f32 v190, v190, v192
ds_write_b32 v198, v190 offset:0
v_max_f32 v191, v80, v81
v_max3_f32 v191, v191, v82, v83
v_mov_b32 v192, v191
s_nop 1
v_permlane16_swap_b32 v191, v192
v_max_f32 v191, v191, v192
v_mov_b32 v192, v191
s_nop 1
v_permlane32_swap_b32 v191, v192
v_max_f32 v191, v191, v192
ds_write_b32 v198, v191 offset:256
s_waitcnt lgkmcnt(0)
s_barrier
ds_read_b128 v[164:167], v199
ds_read_b128 v[168:171], v199 offset:256
ds_read_b128 v[172:175], v200
s_waitcnt vmcnt(0)
ds_write_b128 v207, a[192:195] offset:0
ds_write_b128 v207, a[196:199] offset:1088
ds_write_b128 v207, a[200:203] offset:2176
ds_write_b128 v207, a[204:207] offset:3264
ds_write_b128 v207, a[208:211] offset:4352
ds_write_b128 v207, a[212:215] offset:5440
ds_write_b128 v207, a[216:219] offset:6528
ds_write_b128 v207, a[220:223] offset:7616
ds_write_b128 v207, a[224:227] offset:8704
ds_write_b128 v207, a[228:231] offset:9792
ds_write_b128 v207, a[232:235] offset:10880
ds_write_b128 v207, a[236:239] offset:11968
ds_write_b128 v207, a[240:243] offset:13056
ds_write_b128 v207, a[244:247] offset:14144
ds_write_b128 v207, a[248:251] offset:15232
ds_write_b128 v207, a[252:255] offset:16320
s_waitcnt lgkmcnt(15)
v_max_f32 v164, v164, v165
v_max3_f32 v164, v164, v166, v167
v_mul_f32 v164, v164, v185
v_max_f32 v164, v164, v176
v_sub_f32 v182, v176, v164
v_exp_f32 v182, v182
v_mov_b32 v176, v164
v_max_f32 v168, v168, v169
v_max3_f32 v168, v168, v170, v171
v_mul_f32 v168, v168, v185
v_max_f32 v168, v168, v177
v_sub_f32 v183, v177, v168
v_exp_f32 v183, v183
v_mov_b32 v177, v168
v_max_f32 v172, v172, v173
v_max3_f32 v172, v172, v174, v175
v_mul_f32 v172, v172, v185
v_max_f32 v172, v172, v178
v_sub_f32 v184, v178, v172
v_exp_f32 v184, v184
v_mov_b32 v178, v172
v_fma_f32 v76, v76, v185, -v176
v_fma_f32 v77, v77, v185, -v176
v_fma_f32 v78, v78, v185, -v176
v_fma_f32 v79, v79, v185, -v176
v_exp_f32 v76, v76
v_exp_f32 v77, v77
v_exp_f32 v78, v78
v_exp_f32 v79, v79
v_mul_f32 v180, v180, v182
v_cvt_pk_bf16_f32 v186, v76, v77
v_cvt_pk_bf16_f32 v187, v78, v79
ds_write_b64 v201, v[186:187] offset:0
v_add_f32 v180, v180, v76
v_add_f32 v180, v180, v77
v_add_f32 v180, v180, v78
v_add_f32 v180, v180, v79
v_fma_f32 v80, v80, v185, -v177
v_fma_f32 v81, v81, v185, -v177
v_fma_f32 v82, v82, v185, -v177
v_fma_f32 v83, v83, v185, -v177
v_exp_f32 v80, v80
v_exp_f32 v81, v81
v_exp_f32 v82, v82
v_exp_f32 v83, v83
v_mul_f32 v181, v181, v183
v_cvt_pk_bf16_f32 v188, v80, v81
v_cvt_pk_bf16_f32 v189, v82, v83
ds_write_b64 v201, v[188:189] offset:512
v_add_f32 v181, v181, v80
v_add_f32 v181, v181, v81
v_add_f32 v181, v181, v82
v_add_f32 v181, v181, v83
v_mul_f32 v12, v12, v184
v_mul_f32 v13, v13, v184
v_mul_f32 v14, v14, v184
v_mul_f32 v15, v15, v184
v_mul_f32 v16, v16, v184
v_mul_f32 v17, v17, v184
v_mul_f32 v18, v18, v184
v_mul_f32 v19, v19, v184
v_mul_f32 v20, v20, v184
v_mul_f32 v21, v21, v184
v_mul_f32 v22, v22, v184
v_mul_f32 v23, v23, v184
v_mul_f32 v24, v24, v184
v_mul_f32 v25, v25, v184
v_mul_f32 v26, v26, v184
v_mul_f32 v27, v27, v184
v_mul_f32 v28, v28, v184
v_mul_f32 v29, v29, v184
v_mul_f32 v30, v30, v184
v_mul_f32 v31, v31, v184
v_mul_f32 v32, v32, v184
v_mul_f32 v33, v33, v184
v_mul_f32 v34, v34, v184
v_mul_f32 v35, v35, v184
v_mul_f32 v36, v36, v184
v_mul_f32 v37, v37, v184
v_mul_f32 v38, v38, v184
v_mul_f32 v39, v39, v184
v_mul_f32 v40, v40, v184
v_mul_f32 v41, v41, v184
v_mul_f32 v42, v42, v184
v_mul_f32 v43, v43, v184
v_mul_f32 v44, v44, v184
v_mul_f32 v45, v45, v184
v_mul_f32 v46, v46, v184
v_mul_f32 v47, v47, v184
v_mul_f32 v48, v48, v184
v_mul_f32 v49, v49, v184
v_mul_f32 v50, v50, v184
v_mul_f32 v51, v51, v184
v_mul_f32 v52, v52, v184
v_mul_f32 v53, v53, v184
v_mul_f32 v54, v54, v184
v_mul_f32 v55, v55, v184
v_mul_f32 v56, v56, v184
v_mul_f32 v57, v57, v184
v_mul_f32 v58, v58, v184
v_mul_f32 v59, v59, v184
v_mul_f32 v60, v60, v184
v_mul_f32 v61, v61, v184
v_mul_f32 v62, v62, v184
v_mul_f32 v63, v63, v184
v_mul_f32 v64, v64, v184
v_mul_f32 v65, v65, v184
v_mul_f32 v66, v66, v184
v_mul_f32 v67, v67, v184
v_mul_f32 v68, v68, v184
v_mul_f32 v69, v69, v184
v_mul_f32 v70, v70, v184
v_mul_f32 v71, v71, v184
v_mul_f32 v72, v72, v184
v_mul_f32 v73, v73, v184
v_mul_f32 v74, v74, v184
v_mul_f32 v75, v75, v184
s_waitcnt lgkmcnt(0)
s_barrier
ds_read_b128 v[148:151], v202 offset:0
ds_read_b128 v[152:155], v202 offset:1024
ds_read_b128 v[156:159], v202 offset:2048
ds_read_b128 v[160:163], v202 offset:3072
ds_read_b64_tr_b16 v[84:85], v196 offset:0
ds_read_b64_tr_b16 v[86:87], v196 offset:4352
ds_read_b64_tr_b16 v[88:89], v196 offset:64
ds_read_b64_tr_b16 v[90:91], v196 offset:4416
ds_read_b64_tr_b16 v[92:93], v196 offset:128
ds_read_b64_tr_b16 v[94:95], v196 offset:4480
ds_read_b64_tr_b16 v[96:97], v196 offset:192
ds_read_b64_tr_b16 v[98:99], v196 offset:4544
ds_read_b64_tr_b16 v[100:101], v196 offset:17408
ds_read_b64_tr_b16 v[102:103], v196 offset:21760
ds_read_b64_tr_b16 v[104:105], v196 offset:17472
ds_read_b64_tr_b16 v[106:107], v196 offset:21824
ds_read_b64_tr_b16 v[108:109], v196 offset:17536
ds_read_b64_tr_b16 v[110:111], v196 offset:21888
ds_read_b64_tr_b16 v[112:113], v196 offset:17600
ds_read_b64_tr_b16 v[114:115], v196 offset:21952
ds_read_b64_tr_b16 v[116:117], v196 offset:34816
ds_read_b64_tr_b16 v[118:119], v196 offset:39168
ds_read_b64_tr_b16 v[120:121], v196 offset:34880
ds_read_b64_tr_b16 v[122:123], v196 offset:39232
ds_read_b64_tr_b16 v[124:125], v196 offset:34944
ds_read_b64_tr_b16 v[126:127], v196 offset:39296
ds_read_b64_tr_b16 v[128:129], v196 offset:35008
ds_read_b64_tr_b16 v[130:131], v196 offset:39360
ds_read_b64_tr_b16 v[132:133], v196 offset:52224
ds_read_b64_tr_b16 v[134:135], v196 offset:56576
ds_read_b64_tr_b16 v[136:137], v196 offset:52288
ds_read_b64_tr_b16 v[138:139], v196 offset:56640
ds_read_b64_tr_b16 v[140:141], v196 offset:52352
ds_read_b64_tr_b16 v[142:143], v196 offset:56704
ds_read_b64_tr_b16 v[144:145], v196 offset:52416
ds_read_b64_tr_b16 v[146:147], v196 offset:56768
s_waitcnt lgkmcnt(15)
v_mfma_f32_32x32x16_bf16 v[12:27], v[84:87], v[148:151], v[12:27]
v_mfma_f32_32x32x16_bf16 v[28:43], v[88:91], v[148:151], v[28:43]
v_mfma_f32_32x32x16_bf16 v[44:59], v[92:95], v[148:151], v[44:59]
v_mfma_f32_32x32x16_bf16 v[60:75], v[96:99], v[148:151], v[60:75]
s_waitcnt lgkmcnt(15)
v_mfma_f32_32x32x16_bf16 v[12:27], v[100:103], v[152:155], v[12:27]
v_mfma_f32_32x32x16_bf16 v[28:43], v[104:107], v[152:155], v[28:43]
v_mfma_f32_32x32x16_bf16 v[44:59], v[108:111], v[152:155], v[44:59]
v_mfma_f32_32x32x16_bf16 v[60:75], v[112:115], v[152:155], v[60:75]
s_waitcnt lgkmcnt(8)
v_mfma_f32_32x32x16_bf16 v[12:27], v[116:119], v[156:159], v[12:27]
v_mfma_f32_32x32x16_bf16 v[28:43], v[120:123], v[156:159], v[28:43]
v_mfma_f32_32x32x16_bf16 v[44:59], v[124:127], v[156:159], v[44:59]
v_mfma_f32_32x32x16_bf16 v[60:75], v[128:131], v[156:159], v[60:75]
s_waitcnt lgkmcnt(0)
v_mfma_f32_32x32x16_bf16 v[12:27], v[132:135], v[160:163], v[12:27]
v_mfma_f32_32x32x16_bf16 v[28:43], v[136:139], v[160:163], v[28:43]
v_mfma_f32_32x32x16_bf16 v[44:59], v[140:143], v[160:163], v[44:59]
v_mfma_f32_32x32x16_bf16 v[60:75], v[144:147], v[160:163], v[60:75]
ds_read_b128 v[84:87], v195 offset:0
ds_read_b128 v[88:91], v195 offset:64
ds_read_b128 v[92:95], v195 offset:128
ds_read_b128 v[96:99], v195 offset:192
ds_read_b128 v[100:103], v195 offset:256
ds_read_b128 v[104:107], v195 offset:320
ds_read_b128 v[108:111], v195 offset:384
ds_read_b128 v[112:115], v195 offset:448
ds_read_b128 v[116:119], v195 offset:512
ds_read_b128 v[120:123], v195 offset:576
ds_read_b128 v[124:127], v195 offset:640
ds_read_b128 v[128:131], v195 offset:704
ds_read_b128 v[132:135], v195 offset:768
ds_read_b128 v[136:139], v195 offset:832
ds_read_b128 v[140:143], v195 offset:896
ds_read_b128 v[144:147], v195 offset:960
s_waitcnt lgkmcnt(15)
v_mfma_f32_16x16x32_bf16 v[76:79], v[84:87], a[0:3], 0
v_mfma_f32_16x16x32_bf16 v[80:83], v[84:87], a[64:67], 0
s_waitcnt lgkmcnt(14)
v_mfma_f32_16x16x32_bf16 v[76:79], v[88:91], a[4:7], v[76:79]
v_mfma_f32_16x16x32_bf16 v[80:83], v[88:91], a[68:71], v[80:83]
s_waitcnt lgkmcnt(13)
v_mfma_f32_16x16x32_bf16 v[76:79], v[92:95], a[8:11], v[76:79]
v_mfma_f32_16x16x32_bf16 v[80:83], v[92:95], a[72:75], v[80:83]
s_waitcnt lgkmcnt(12)
v_mfma_f32_16x16x32_bf16 v[76:79], v[96:99], a[12:15], v[76:79]
v_mfma_f32_16x16x32_bf16 v[80:83], v[96:99], a[76:79], v[80:83]
s_waitcnt lgkmcnt(11)
v_mfma_f32_16x16x32_bf16 v[76:79], v[100:103], a[16:19], v[76:79]
v_mfma_f32_16x16x32_bf16 v[80:83], v[100:103], a[80:83], v[80:83]
s_waitcnt lgkmcnt(10)
v_mfma_f32_16x16x32_bf16 v[76:79], v[104:107], a[20:23], v[76:79]
v_mfma_f32_16x16x32_bf16 v[80:83], v[104:107], a[84:87], v[80:83]
s_waitcnt lgkmcnt(9)
v_mfma_f32_16x16x32_bf16 v[76:79], v[108:111], a[24:27], v[76:79]
v_mfma_f32_16x16x32_bf16 v[80:83], v[108:111], a[88:91], v[80:83]
s_waitcnt lgkmcnt(8)
v_mfma_f32_16x16x32_bf16 v[76:79], v[112:115], a[28:31], v[76:79]
v_mfma_f32_16x16x32_bf16 v[80:83], v[112:115], a[92:95], v[80:83]
s_waitcnt lgkmcnt(7)
v_mfma_f32_16x16x32_bf16 v[76:79], v[116:119], a[32:35], v[76:79]
v_mfma_f32_16x16x32_bf16 v[80:83], v[116:119], a[96:99], v[80:83]
s_waitcnt lgkmcnt(6)
v_mfma_f32_16x16x32_bf16 v[76:79], v[120:123], a[36:39], v[76:79]
v_mfma_f32_16x16x32_bf16 v[80:83], v[120:123], a[100:103], v[80:83]
s_waitcnt lgkmcnt(5)
v_mfma_f32_16x16x32_bf16 v[76:79], v[124:127], a[40:43], v[76:79]
v_mfma_f32_16x16x32_bf16 v[80:83], v[124:127], a[104:107], v[80:83]
s_waitcnt lgkmcnt(4)
v_mfma_f32_16x16x32_bf16 v[76:79], v[128:131], a[44:47], v[76:79]
v_mfma_f32_16x16x32_bf16 v[80:83], v[128:131], a[108:111], v[80:83]
s_waitcnt lgkmcnt(3)
v_mfma_f32_16x16x32_bf16 v[76:79], v[132:135], a[48:51], v[76:79]
v_mfma_f32_16x16x32_bf16 v[80:83], v[132:135], a[112:115], v[80:83]
s_waitcnt lgkmcnt(2)
v_mfma_f32_16x16x32_bf16 v[76:79], v[136:139], a[52:55], v[76:79]
v_mfma_f32_16x16x32_bf16 v[80:83], v[136:139], a[116:119], v[80:83]
s_waitcnt lgkmcnt(1)
v_mfma_f32_16x16x32_bf16 v[76:79], v[140:143], a[56:59], v[76:79]
v_mfma_f32_16x16x32_bf16 v[80:83], v[140:143], a[120:123], v[80:83]
s_waitcnt lgkmcnt(0)
v_mfma_f32_16x16x32_bf16 v[76:79], v[144:147], a[60:63], v[76:79]
v_mfma_f32_16x16x32_bf16 v[80:83], v[144:147], a[124:127], v[80:83]
s_nop 6
v_max_f32 v190, v76, v77
v_max3_f32 v190, v190, v78, v79
v_mov_b32 v192, v190
s_nop 1
v_permlane16_swap_b32 v190, v192
v_max_f32 v190, v190, v192
v_mov_b32 v192, v190
s_nop 1
v_permlane32_swap_b32 v190, v192
v_max_f32 v190, v190, v192
ds_write_b32 v198, v190 offset:0
v_max_f32 v191, v80, v81
v_max3_f32 v191, v191, v82, v83
v_mov_b32 v192, v191
s_nop 1
v_permlane16_swap_b32 v191, v192
v_max_f32 v191, v191, v192
v_mov_b32 v192, v191
s_nop 1
v_permlane32_swap_b32 v191, v192
v_max_f32 v191, v191, v192
ds_write_b32 v198, v191 offset:256
s_waitcnt lgkmcnt(0)
s_barrier
ds_read_b128 v[164:167], v199
ds_read_b128 v[168:171], v199 offset:256
ds_read_b128 v[172:175], v200
s_waitcnt lgkmcnt(0)
v_max_f32 v164, v164, v165
v_max3_f32 v164, v164, v166, v167
v_mul_f32 v164, v164, v185
v_max_f32 v164, v164, v176
v_sub_f32 v182, v176, v164
v_exp_f32 v182, v182
v_mov_b32 v176, v164
v_max_f32 v168, v168, v169
v_max3_f32 v168, v168, v170, v171
v_mul_f32 v168, v168, v185
v_max_f32 v168, v168, v177
v_sub_f32 v183, v177, v168
v_exp_f32 v183, v183
v_mov_b32 v177, v168
v_max_f32 v172, v172, v173
v_max3_f32 v172, v172, v174, v175
v_mul_f32 v172, v172, v185
v_max_f32 v172, v172, v178
v_sub_f32 v184, v178, v172
v_exp_f32 v184, v184
v_mov_b32 v178, v172
v_fma_f32 v76, v76, v185, -v176
v_fma_f32 v77, v77, v185, -v176
v_fma_f32 v78, v78, v185, -v176
v_fma_f32 v79, v79, v185, -v176
v_exp_f32 v76, v76
v_exp_f32 v77, v77
v_exp_f32 v78, v78
v_exp_f32 v79, v79
v_mul_f32 v180, v180, v182
v_cvt_pk_bf16_f32 v186, v76, v77
v_cvt_pk_bf16_f32 v187, v78, v79
ds_write_b64 v201, v[186:187] offset:0
v_add_f32 v180, v180, v76
v_add_f32 v180, v180, v77
v_add_f32 v180, v180, v78
v_add_f32 v180, v180, v79
v_fma_f32 v80, v80, v185, -v177
v_fma_f32 v81, v81, v185, -v177
v_fma_f32 v82, v82, v185, -v177
v_fma_f32 v83, v83, v185, -v177
v_exp_f32 v80, v80
v_exp_f32 v81, v81
v_exp_f32 v82, v82
v_exp_f32 v83, v83
v_mul_f32 v181, v181, v183
v_cvt_pk_bf16_f32 v188, v80, v81
v_cvt_pk_bf16_f32 v189, v82, v83
ds_write_b64 v201, v[188:189] offset:512
v_add_f32 v181, v181, v80
v_add_f32 v181, v181, v81
v_add_f32 v181, v181, v82
v_add_f32 v181, v181, v83
v_mul_f32 v12, v12, v184
v_mul_f32 v13, v13, v184
v_mul_f32 v14, v14, v184
v_mul_f32 v15, v15, v184
v_mul_f32 v16, v16, v184
v_mul_f32 v17, v17, v184
v_mul_f32 v18, v18, v184
v_mul_f32 v19, v19, v184
v_mul_f32 v20, v20, v184
v_mul_f32 v21, v21, v184
v_mul_f32 v22, v22, v184
v_mul_f32 v23, v23, v184
v_mul_f32 v24, v24, v184
v_mul_f32 v25, v25, v184
v_mul_f32 v26, v26, v184
v_mul_f32 v27, v27, v184
v_mul_f32 v28, v28, v184
v_mul_f32 v29, v29, v184
v_mul_f32 v30, v30, v184
v_mul_f32 v31, v31, v184
v_mul_f32 v32, v32, v184
v_mul_f32 v33, v33, v184
v_mul_f32 v34, v34, v184
v_mul_f32 v35, v35, v184
v_mul_f32 v36, v36, v184
v_mul_f32 v37, v37, v184
v_mul_f32 v38, v38, v184
v_mul_f32 v39, v39, v184
v_mul_f32 v40, v40, v184
v_mul_f32 v41, v41, v184
v_mul_f32 v42, v42, v184
v_mul_f32 v43, v43, v184
v_mul_f32 v44, v44, v184
v_mul_f32 v45, v45, v184
v_mul_f32 v46, v46, v184
v_mul_f32 v47, v47, v184
v_mul_f32 v48, v48, v184
v_mul_f32 v49, v49, v184
v_mul_f32 v50, v50, v184
v_mul_f32 v51, v51, v184
v_mul_f32 v52, v52, v184
v_mul_f32 v53, v53, v184
v_mul_f32 v54, v54, v184
v_mul_f32 v55, v55, v184
v_mul_f32 v56, v56, v184
v_mul_f32 v57, v57, v184
v_mul_f32 v58, v58, v184
v_mul_f32 v59, v59, v184
v_mul_f32 v60, v60, v184
v_mul_f32 v61, v61, v184
v_mul_f32 v62, v62, v184
v_mul_f32 v63, v63, v184
v_mul_f32 v64, v64, v184
v_mul_f32 v65, v65, v184
v_mul_f32 v66, v66, v184
v_mul_f32 v67, v67, v184
v_mul_f32 v68, v68, v184
v_mul_f32 v69, v69, v184
v_mul_f32 v70, v70, v184
v_mul_f32 v71, v71, v184
v_mul_f32 v72, v72, v184
v_mul_f32 v73, v73, v184
v_mul_f32 v74, v74, v184
v_mul_f32 v75, v75, v184
s_waitcnt lgkmcnt(0)
s_barrier
ds_read_b128 v[148:151], v202 offset:0
ds_read_b128 v[152:155], v202 offset:1024
ds_read_b128 v[156:159], v202 offset:2048
ds_read_b128 v[160:163], v202 offset:3072
ds_read_b64_tr_b16 v[84:85], v197 offset:0
ds_read_b64_tr_b16 v[86:87], v197 offset:4352
ds_read_b64_tr_b16 v[88:89], v197 offset:64
ds_read_b64_tr_b16 v[90:91], v197 offset:4416
ds_read_b64_tr_b16 v[92:93], v197 offset:128
ds_read_b64_tr_b16 v[94:95], v197 offset:4480
ds_read_b64_tr_b16 v[96:97], v197 offset:192
ds_read_b64_tr_b16 v[98:99], v197 offset:4544
ds_read_b64_tr_b16 v[100:101], v197 offset:17408
ds_read_b64_tr_b16 v[102:103], v197 offset:21760
ds_read_b64_tr_b16 v[104:105], v197 offset:17472
ds_read_b64_tr_b16 v[106:107], v197 offset:21824
ds_read_b64_tr_b16 v[108:109], v197 offset:17536
ds_read_b64_tr_b16 v[110:111], v197 offset:21888
ds_read_b64_tr_b16 v[112:113], v197 offset:17600
ds_read_b64_tr_b16 v[114:115], v197 offset:21952
ds_read_b64_tr_b16 v[116:117], v197 offset:34816
ds_read_b64_tr_b16 v[118:119], v197 offset:39168
ds_read_b64_tr_b16 v[120:121], v197 offset:34880
ds_read_b64_tr_b16 v[122:123], v197 offset:39232
ds_read_b64_tr_b16 v[124:125], v197 offset:34944
ds_read_b64_tr_b16 v[126:127], v197 offset:39296
ds_read_b64_tr_b16 v[128:129], v197 offset:35008
ds_read_b64_tr_b16 v[130:131], v197 offset:39360
ds_read_b64_tr_b16 v[132:133], v197 offset:52224
ds_read_b64_tr_b16 v[134:135], v197 offset:56576
ds_read_b64_tr_b16 v[136:137], v197 offset:52288
ds_read_b64_tr_b16 v[138:139], v197 offset:56640
ds_read_b64_tr_b16 v[140:141], v197 offset:52352
ds_read_b64_tr_b16 v[142:143], v197 offset:56704
ds_read_b64_tr_b16 v[144:145], v197 offset:52416
ds_read_b64_tr_b16 v[146:147], v197 offset:56768
s_waitcnt lgkmcnt(15)
v_mfma_f32_32x32x16_bf16 v[12:27], v[84:87], v[148:151], v[12:27]
v_mfma_f32_32x32x16_bf16 v[28:43], v[88:91], v[148:151], v[28:43]
v_mfma_f32_32x32x16_bf16 v[44:59], v[92:95], v[148:151], v[44:59]
v_mfma_f32_32x32x16_bf16 v[60:75], v[96:99], v[148:151], v[60:75]
s_waitcnt lgkmcnt(15)
v_mfma_f32_32x32x16_bf16 v[12:27], v[100:103], v[152:155], v[12:27]
v_mfma_f32_32x32x16_bf16 v[28:43], v[104:107], v[152:155], v[28:43]
v_mfma_f32_32x32x16_bf16 v[44:59], v[108:111], v[152:155], v[44:59]
v_mfma_f32_32x32x16_bf16 v[60:75], v[112:115], v[152:155], v[60:75]
s_waitcnt lgkmcnt(8)
v_mfma_f32_32x32x16_bf16 v[12:27], v[116:119], v[156:159], v[12:27]
v_mfma_f32_32x32x16_bf16 v[28:43], v[120:123], v[156:159], v[28:43]
v_mfma_f32_32x32x16_bf16 v[44:59], v[124:127], v[156:159], v[44:59]
v_mfma_f32_32x32x16_bf16 v[60:75], v[128:131], v[156:159], v[60:75]
s_waitcnt lgkmcnt(0)
v_mfma_f32_32x32x16_bf16 v[12:27], v[132:135], v[160:163], v[12:27]
v_mfma_f32_32x32x16_bf16 v[28:43], v[136:139], v[160:163], v[28:43]
v_mfma_f32_32x32x16_bf16 v[44:59], v[140:143], v[160:163], v[44:59]
v_mfma_f32_32x32x16_bf16 v[60:75], v[144:147], v[160:163], v[60:75]
v_mov_b32 v192, v180
s_nop 1
v_permlane16_swap_b32 v180, v192
v_add_f32 v180, v180, v192
v_mov_b32 v192, v180
s_nop 1
v_permlane32_swap_b32 v180, v192
v_add_f32 v180, v180, v192
ds_write_b32 v198, v180 offset:512
v_mov_b32 v192, v181
s_nop 1
v_permlane16_swap_b32 v181, v192
v_add_f32 v181, v181, v192
v_mov_b32 v192, v181
s_nop 1
v_permlane32_swap_b32 v181, v192
v_add_f32 v181, v181, v192
ds_write_b32 v198, v181 offset:768
v_and_b32 v5, 31, v1
v_mul_u32_u24 v5, 1040, v5
v_lshrrev_b32 v6, 5, v1
v_lshl_add_u32 v5, v6, 3, v5
s_lshl_b32 s6, s3, 8
v_add_u32 v5, s6, v5
v_cvt_pk_bf16_f32 v84, v12, v13
v_cvt_pk_bf16_f32 v85, v14, v15
ds_write_b64 v5, v[84:85] offset:0
v_cvt_pk_bf16_f32 v86, v16, v17
v_cvt_pk_bf16_f32 v87, v18, v19
ds_write_b64 v5, v[86:87] offset:16
v_cvt_pk_bf16_f32 v88, v20, v21
v_cvt_pk_bf16_f32 v89, v22, v23
ds_write_b64 v5, v[88:89] offset:32
v_cvt_pk_bf16_f32 v90, v24, v25
v_cvt_pk_bf16_f32 v91, v26, v27
ds_write_b64 v5, v[90:91] offset:48
v_cvt_pk_bf16_f32 v92, v28, v29
v_cvt_pk_bf16_f32 v93, v30, v31
ds_write_b64 v5, v[92:93] offset:64
v_cvt_pk_bf16_f32 v94, v32, v33
v_cvt_pk_bf16_f32 v95, v34, v35
ds_write_b64 v5, v[94:95] offset:80
v_cvt_pk_bf16_f32 v96, v36, v37
v_cvt_pk_bf16_f32 v97, v38, v39
ds_write_b64 v5, v[96:97] offset:96
v_cvt_pk_bf16_f32 v98, v40, v41
v_cvt_pk_bf16_f32 v99, v42, v43
ds_write_b64 v5, v[98:99] offset:112
v_cvt_pk_bf16_f32 v100, v44, v45
v_cvt_pk_bf16_f32 v101, v46, v47
ds_write_b64 v5, v[100:101] offset:128
v_cvt_pk_bf16_f32 v102, v48, v49
v_cvt_pk_bf16_f32 v103, v50, v51
ds_write_b64 v5, v[102:103] offset:144
v_cvt_pk_bf16_f32 v104, v52, v53
v_cvt_pk_bf16_f32 v105, v54, v55
ds_write_b64 v5, v[104:105] offset:160
v_cvt_pk_bf16_f32 v106, v56, v57
v_cvt_pk_bf16_f32 v107, v58, v59
ds_write_b64 v5, v[106:107] offset:176
v_cvt_pk_bf16_f32 v108, v60, v61
v_cvt_pk_bf16_f32 v109, v62, v63
ds_write_b64 v5, v[108:109] offset:192
v_cvt_pk_bf16_f32 v110, v64, v65
v_cvt_pk_bf16_f32 v111, v66, v67
ds_write_b64 v5, v[110:111] offset:208
v_cvt_pk_bf16_f32 v112, v68, v69
v_cvt_pk_bf16_f32 v113, v70, v71
ds_write_b64 v5, v[112:113] offset:224
v_cvt_pk_bf16_f32 v114, v72, v73
v_cvt_pk_bf16_f32 v115, v74, v75
ds_write_b64 v5, v[114:115] offset:240
s_waitcnt lgkmcnt(0)
s_barrier
s_mul_i32 s6, s3, 8320
v_add_u32 v5, s6, v2
ds_read_b128 v[116:119], v5 offset:0
ds_read_b128 v[120:123], v5 offset:1040
ds_read_b128 v[124:127], v5 offset:2080
ds_read_b128 v[128:131], v5 offset:3120
ds_read_b128 v[132:135], v5 offset:4160
ds_read_b128 v[136:139], v5 offset:5200
ds_read_b128 v[140:143], v5 offset:6240
ds_read_b128 v[144:147], v5 offset:7280
ds_read_b128 v[164:167], v200 offset:512
s_lshl_b32 s7, s3, 19
s_lshl_b32 s6, s9, 10
s_add_u32 s7, s7, s6
s_add_u32 s7, s7, 1048576
s_waitcnt lgkmcnt(8)
s_add_u32 s6, s7, 0
buffer_store_dwordx4 v[116:119], v2, s[64:67], s6 offen sc1
s_waitcnt lgkmcnt(7)
s_add_u32 s6, s7, 65536
buffer_store_dwordx4 v[120:123], v2, s[64:67], s6 offen sc1
s_waitcnt lgkmcnt(6)
s_add_u32 s6, s7, 131072
buffer_store_dwordx4 v[124:127], v2, s[64:67], s6 offen sc1
s_waitcnt lgkmcnt(5)
s_add_u32 s6, s7, 196608
buffer_store_dwordx4 v[128:131], v2, s[64:67], s6 offen sc1
s_waitcnt lgkmcnt(4)
s_add_u32 s6, s7, 262144
buffer_store_dwordx4 v[132:135], v2, s[64:67], s6 offen sc1
s_waitcnt lgkmcnt(3)
s_add_u32 s6, s7, 327680
buffer_store_dwordx4 v[136:139], v2, s[64:67], s6 offen sc1
s_waitcnt lgkmcnt(2)
s_add_u32 s6, s7, 393216
buffer_store_dwordx4 v[140:143], v2, s[64:67], s6 offen sc1
s_waitcnt lgkmcnt(1)
s_add_u32 s6, s7, 458752
buffer_store_dwordx4 v[144:147], v2, s[64:67], s6 offen sc1
s_waitcnt lgkmcnt(0)
v_add_f32 v164, v164, v165
v_add_f32 v166, v166, v167
v_add_f32 v187, v164, v166
v_mov_b32 v186, v178
v_lshlrev_b32 v5, 9, v1
s_lshl_b32 s6, s9, 3
s_add_u32 s6, s6, 262144
v_min_u32 v186, -2, v186
v_min_u32 v187, -2, v187
s_waitcnt vmcnt(0)
s_barrier
s_cmp_lg_u32 s3, 0
s_cbranch_scc1 L_nops_17
s_mov_b64 exec, 0xffffffff
buffer_store_dwordx2 v[186:187], v5, s[64:67], s6 offen sc1
s_mov_b64 exec, -1
L_nops_17:
s_mul_i32 s6, s9, 73728
s_add_u32 s60, s36, s6
s_addc_u32 s61, s37, 0
s_mov_b32 s62, 73728
s_mov_b32 s63, 0x20000
s_lshl_b32 s6, s9, 7
s_sub_u32 s7, 4194304, s6
s_add_u32 s76, s34, s6
s_addc_u32 s77, s35, 0
s_mov_b32 s78, s7
s_mov_b32 s79, 0x20000
v_lshrrev_b32 v5, 3, v1
v_and_b32 v6, 7, v1
v_and_b32 v7, 2, v5
v_xor_b32 v6, v6, v7
v_lshlrev_b32 v5, 13, v5
v_lshl_add_u32 v152, v6, 4, v5
v_xor_b32 v6, 4, v6
v_lshl_add_u32 v153, v6, 4, v5
s_lshl_b32 s12, s3, 14
s_lshl_b32 s13, s3, 20
s_add_u32 m0, s12, 73728
s_add_u32 s6, s13, 0
buffer_load_dwordx4 v152, s[76:79], s6 offen nt lds
s_add_u32 m0, s12, 74752
s_add_u32 s6, s13, 65536
buffer_load_dwordx4 v153, s[76:79], s6 offen nt lds
s_add_u32 m0, s12, 75776
s_add_u32 s6, s13, 131072
buffer_load_dwordx4 v152, s[76:79], s6 offen nt lds
s_add_u32 m0, s12, 76800
s_add_u32 s6, s13, 196608
buffer_load_dwordx4 v153, s[76:79], s6 offen nt lds
s_add_u32 m0, s12, 77824
s_add_u32 s6, s13, 262144
buffer_load_dwordx4 v152, s[76:79], s6 offen nt lds
s_add_u32 m0, s12, 78848
s_add_u32 s6, s13, 327680
buffer_load_dwordx4 v153, s[76:79], s6 offen nt lds
s_add_u32 m0, s12, 79872
s_add_u32 s6, s13, 393216
buffer_load_dwordx4 v152, s[76:79], s6 offen nt lds
s_add_u32 m0, s12, 80896
s_add_u32 s6, s13, 458752
buffer_load_dwordx4 v153, s[76:79], s6 offen nt lds
s_add_u32 m0, s12, 81920
s_add_u32 s6, s13, 524288
buffer_load_dwordx4 v152, s[76:79], s6 offen nt lds
s_add_u32 m0, s12, 82944
s_add_u32 s6, s13, 589824
buffer_load_dwordx4 v153, s[76:79], s6 offen nt lds
s_add_u32 m0, s12, 83968
s_add_u32 s6, s13, 655360
buffer_load_dwordx4 v152, s[76:79], s6 offen nt lds
s_add_u32 m0, s12, 84992
s_add_u32 s6, s13, 720896
buffer_load_dwordx4 v153, s[76:79], s6 offen nt lds
s_add_u32 m0, s12, 86016
s_add_u32 s6, s13, 786432
buffer_load_dwordx4 v152, s[76:79], s6 offen nt lds
s_add_u32 m0, s12, 87040
s_add_u32 s6, s13, 851968
buffer_load_dwordx4 v153, s[76:79], s6 offen nt lds
s_add_u32 m0, s12, 88064
s_add_u32 s6, s13, 917504
buffer_load_dwordx4 v152, s[76:79], s6 offen nt lds
s_add_u32 m0, s12, 89088
s_add_u32 s6, s13, 983040
buffer_load_dwordx4 v153, s[76:79], s6 offen nt lds
s_mul_i32 s12, s3, 18432
s_add_u32 s6, s12, 0
s_mov_b32 m0, s6
s_nop 0
buffer_load_dwordx4 v2, s[60:63], s6 offen nt lds
s_add_u32 s6, s12, 1024
s_mov_b32 m0, s6
s_nop 0
buffer_load_dwordx4 v2, s[60:63], s6 offen nt lds
s_add_u32 s6, s12, 2048
s_mov_b32 m0, s6
s_nop 0
buffer_load_dwordx4 v2, s[60:63], s6 offen nt lds
s_add_u32 s6, s12, 3072
s_mov_b32 m0, s6
s_nop 0
buffer_load_dwordx4 v2, s[60:63], s6 offen nt lds
s_add_u32 s6, s12, 4096
s_mov_b32 m0, s6
s_nop 0
buffer_load_dwordx4 v2, s[60:63], s6 offen nt lds
s_add_u32 s6, s12, 5120
s_mov_b32 m0, s6
s_nop 0
buffer_load_dwordx4 v2, s[60:63], s6 offen nt lds
s_add_u32 s6, s12, 6144
s_mov_b32 m0, s6
s_nop 0
buffer_load_dwordx4 v2, s[60:63], s6 offen nt lds
s_add_u32 s6, s12, 7168
s_mov_b32 m0, s6
s_nop 0
buffer_load_dwordx4 v2, s[60:63], s6 offen nt lds
s_add_u32 s6, s12, 8192
s_mov_b32 m0, s6
s_nop 0
buffer_load_dwordx4 v2, s[60:63], s6 offen nt lds
s_add_u32 s6, s12, 9216
s_mov_b32 m0, s6
s_nop 0
buffer_load_dwordx4 v2, s[60:63], s6 offen nt lds
s_add_u32 s6, s12, 10240
s_mov_b32 m0, s6
s_nop 0
buffer_load_dwordx4 v2, s[60:63], s6 offen nt lds
s_add_u32 s6, s12, 11264
s_mov_b32 m0, s6
s_nop 0
buffer_load_dwordx4 v2, s[60:63], s6 offen nt lds
s_add_u32 s6, s12, 12288
s_mov_b32 m0, s6
s_nop 0
buffer_load_dwordx4 v2, s[60:63], s6 offen nt lds
s_add_u32 s6, s12, 13312
s_mov_b32 m0, s6
s_nop 0
buffer_load_dwordx4 v2, s[60:63], s6 offen nt lds
s_add_u32 s6, s12, 14336
s_mov_b32 m0, s6
s_nop 0
buffer_load_dwordx4 v2, s[60:63], s6 offen nt lds
s_add_u32 s6, s12, 15360
s_mov_b32 m0, s6
s_nop 0
buffer_load_dwordx4 v2, s[60:63], s6 offen nt lds
s_add_u32 s6, s12, 16384
s_mov_b32 m0, s6
s_nop 0
buffer_load_dwordx4 v2, s[60:63], s6 offen nt lds
s_add_u32 s6, s12, 17408
s_mov_b32 m0, s6
s_nop 0
buffer_load_dwordx4 v2, s[60:63], s6 offen nt lds
v_lshrrev_b32 v5, 4, v1
v_lshlrev_b32 v5, 3, v5
v_bfe_u32 v6, v1, 2, 2
v_add_u32 v5, v5, v6
v_mul_u32_u24 v5, 1152, v5
s_mul_i32 s6, s3, 288
v_add_u32 v5, s6, v5
v_and_b32 v6, 3, v1
v_lshl_add_u32 v158, v6, 5, v5
v_lshl_add_u32 v159, v6, 3, v5
v_add_u32 v159, 256, v159
v_bfe_u32 v5, v1, 2, 2
v_lshl_add_u32 v5, v9, 3, v5
v_lshlrev_b32 v5, 7, v5
v_and_b32 v6, 3, v1
v_lshl_add_u32 v5, v6, 3, v5
v_add_u32 v5, 73728, v5
v_bfe_u32 v6, v1, 3, 2
v_xor_b32 v7, 0, v6
v_lshl_add_u32 v154, v7, 5, v5
v_xor_b32 v7, 1, v6
v_lshl_add_u32 v155, v7, 5, v5
v_xor_b32 v7, 2, v6
v_lshl_add_u32 v156, v7, 5, v5
v_xor_b32 v7, 3, v6
v_lshl_add_u32 v157, v7, 5, v5
v_lshlrev_b32 v5, 10, v8
v_lshl_add_u32 v5, v9, 4, v5
v_lshlrev_b32 v6, 3, v8
s_lshl_b32 s6, s4, 9
s_lshl_b32 s7, s3, 7
s_add_u32 s6, s6, s7
s_add_u32 s6, s6, 262144
s_mov_b32 s7, 400000
P_poll:
buffer_load_dwordx2 v[148:149], v6, s[64:67], s6 offen sc1
s_waitcnt vmcnt(0)
v_max_u32 v150, v148, v149
v_cmp_eq_u32 vcc, -1, v150
s_cbranch_vccz P_ok
s_sleep 16
s_sub_u32 s7, s7, 1
s_cmp_lg_u32 s7, 0
s_cbranch_scc1 P_poll
P_ok:
s_lshl_b32 s6, s4, 16
s_lshl_b32 s7, s3, 14
s_add_u32 s6, s6, s7
s_add_u32 s6, s6, 1048576
buffer_load_dwordx4 v[12:15], v5, s[64:67], s6 offen offset:0 sc1
buffer_load_dwordx4 v[16:19], v5, s[64:67], s6 offen offset:64 sc1
buffer_load_dwordx4 v[20:23], v5, s[64:67], s6 offen offset:128 sc1
buffer_load_dwordx4 v[24:27], v5, s[64:67], s6 offen offset:192 sc1
buffer_load_dwordx4 v[28:31], v5, s[64:67], s6 offen offset:256 sc1
buffer_load_dwordx4 v[32:35], v5, s[64:67], s6 offen offset:320 sc1
buffer_load_dwordx4 v[36:39], v5, s[64:67], s6 offen offset:384 sc1
buffer_load_dwordx4 v[40:43], v5, s[64:67], s6 offen offset:448 sc1
buffer_load_dwordx4 v[44:47], v5, s[64:67], s6 offen offset:512 sc1
buffer_load_dwordx4 v[48:51], v5, s[64:67], s6 offen offset:576 sc1
buffer_load_dwordx4 v[52:55], v5, s[64:67], s6 offen offset:640 sc1
buffer_load_dwordx4 v[56:59], v5, s[64:67], s6 offen offset:704 sc1
buffer_load_dwordx4 v[60:63], v5, s[64:67], s6 offen offset:768 sc1
buffer_load_dwordx4 v[64:67], v5, s[64:67], s6 offen offset:832 sc1
buffer_load_dwordx4 v[68:71], v5, s[64:67], s6 offen offset:896 sc1
buffer_load_dwordx4 v[72:75], v5, s[64:67], s6 offen offset:960 sc1
s_barrier
ds_read_b64_tr_b16 a[96:97], v158 offset:0
ds_read_b64_tr_b16 a[98:99], v158 offset:4608
ds_read_b64_tr_b16 a[100:101], v158 offset:36864
ds_read_b64_tr_b16 a[102:103], v158 offset:41472
ds_read_b64_tr_b16 a[104:105], v158 offset:8
ds_read_b64_tr_b16 a[106:107], v158 offset:4616
ds_read_b64_tr_b16 a[108:109], v158 offset:36872
ds_read_b64_tr_b16 a[110:111], v158 offset:41480
ds_read_b64_tr_b16 a[112:113], v158 offset:16
ds_read_b64_tr_b16 a[114:115], v158 offset:4624
ds_read_b64_tr_b16 a[116:117], v158 offset:36880
ds_read_b64_tr_b16 a[118:119], v158 offset:41488
ds_read_b64_tr_b16 a[120:121], v158 offset:24
ds_read_b64_tr_b16 a[122:123], v158 offset:4632
ds_read_b64_tr_b16 a[124:125], v158 offset:36888
ds_read_b64_tr_b16 a[126:127], v158 offset:41496
ds_read_b64_tr_b16 a[128:129], v158 offset:128
ds_read_b64_tr_b16 a[130:131], v158 offset:4736
ds_read_b64_tr_b16 a[132:133], v158 offset:36992
ds_read_b64_tr_b16 a[134:135], v158 offset:41600
ds_read_b64_tr_b16 a[136:137], v158 offset:136
ds_read_b64_tr_b16 a[138:139], v158 offset:4744
ds_read_b64_tr_b16 a[140:141], v158 offset:37000
ds_read_b64_tr_b16 a[142:143], v158 offset:41608
ds_read_b64_tr_b16 a[144:145], v158 offset:144
ds_read_b64_tr_b16 a[146:147], v158 offset:4752
ds_read_b64_tr_b16 a[148:149], v158 offset:37008
ds_read_b64_tr_b16 a[150:151], v158 offset:41616
ds_read_b64_tr_b16 a[152:153], v158 offset:152
ds_read_b64_tr_b16 a[154:155], v158 offset:4760
ds_read_b64_tr_b16 a[156:157], v158 offset:37016
ds_read_b64_tr_b16 a[158:159], v158 offset:41624
ds_read_b64_tr_b16 a[160:161], v159 offset:0
ds_read_b64_tr_b16 a[162:163], v159 offset:4608
ds_read_b64_tr_b16 a[164:165], v159 offset:36864
ds_read_b64_tr_b16 a[166:167], v159 offset:41472
v_mov_b32 v150, v148
s_nop 1
v_max_f32_dpp v150, v150, v150 row_ror:8 row_mask:0xf bank_mask:0xf
s_nop 1
v_max_f32_dpp v150, v150, v150 row_ror:4 row_mask:0xf bank_mask:0xf
s_nop 1
v_max_f32_dpp v150, v150, v150 row_ror:2 row_mask:0xf bank_mask:0xf
s_nop 1
v_max_f32_dpp v150, v150, v150 row_ror:1 row_mask:0xf bank_mask:0xf
v_sub_f32 v148, v148, v150
v_exp_f32 v148, v148
s_nop 0
v_mul_f32 v151, v148, v149
s_nop 1
v_add_f32_dpp v151, v151, v151 row_ror:8 row_mask:0xf bank_mask:0xf
s_nop 1
v_add_f32_dpp v151, v151, v151 row_ror:4 row_mask:0xf bank_mask:0xf
s_nop 1
v_add_f32_dpp v151, v151, v151 row_ror:2 row_mask:0xf bank_mask:0xf
s_nop 1
v_add_f32_dpp v151, v151, v151 row_ror:1 row_mask:0xf bank_mask:0xf
v_rcp_f32 v151, v151
s_nop 0
v_mul_f32 v148, v148, v151
s_nop 1
v_mov_b32_dpp v144, v148 row_newbcast:0 row_mask:0x1 bank_mask:0xf
v_mov_b32_dpp v144, v148 row_newbcast:4 row_mask:0x2 bank_mask:0xf
v_mov_b32_dpp v144, v148 row_newbcast:8 row_mask:0x4 bank_mask:0xf
v_mov_b32_dpp v144, v148 row_newbcast:12 row_mask:0x8 bank_mask:0xf
v_mov_b32_dpp v145, v148 row_newbcast:1 row_mask:0x1 bank_mask:0xf
v_mov_b32_dpp v145, v148 row_newbcast:5 row_mask:0x2 bank_mask:0xf
v_mov_b32_dpp v145, v148 row_newbcast:9 row_mask:0x4 bank_mask:0xf
v_mov_b32_dpp v145, v148 row_newbcast:13 row_mask:0x8 bank_mask:0xf
v_mov_b32_dpp v146, v148 row_newbcast:2 row_mask:0x1 bank_mask:0xf
v_mov_b32_dpp v146, v148 row_newbcast:6 row_mask:0x2 bank_mask:0xf
v_mov_b32_dpp v146, v148 row_newbcast:10 row_mask:0x4 bank_mask:0xf
v_mov_b32_dpp v146, v148 row_newbcast:14 row_mask:0x8 bank_mask:0xf
v_mov_b32_dpp v147, v148 row_newbcast:3 row_mask:0x1 bank_mask:0xf
v_mov_b32_dpp v147, v148 row_newbcast:7 row_mask:0x2 bank_mask:0xf
v_mov_b32_dpp v147, v148 row_newbcast:11 row_mask:0x4 bank_mask:0xf
v_mov_b32_dpp v147, v148 row_newbcast:15 row_mask:0x8 bank_mask:0xf
s_waitcnt lgkmcnt(0)
ds_read_b64_tr_b16 v[76:77], v154 offset:0
ds_read_b64_tr_b16 v[78:79], v154 offset:512
ds_read_b64_tr_b16 v[80:81], v155 offset:0
ds_read_b64_tr_b16 v[82:83], v155 offset:512
ds_read_b64_tr_b16 v[84:85], v156 offset:0
ds_read_b64_tr_b16 v[86:87], v156 offset:512
ds_read_b64_tr_b16 v[88:89], v157 offset:0
ds_read_b64_tr_b16 v[90:91], v157 offset:512
ds_read_b64_tr_b16 v[92:93], v154 offset:4096
ds_read_b64_tr_b16 v[94:95], v154 offset:4608
ds_read_b64_tr_b16 v[96:97], v155 offset:4096
ds_read_b64_tr_b16 v[98:99], v155 offset:4608
ds_read_b64_tr_b16 v[100:101], v156 offset:4096
ds_read_b64_tr_b16 v[102:103], v156 offset:4608
ds_read_b64_tr_b16 v[104:105], v157 offset:4096
ds_read_b64_tr_b16 v[106:107], v157 offset:4608
s_waitcnt vmcnt(15)
s_waitcnt lgkmcnt(8)
v_mfma_f32_16x16x32_bf16 v[108:111], v[12:15], v[76:79], 0
v_mfma_f32_16x16x32_bf16 v[112:115], v[12:15], v[80:83], 0
v_mfma_f32_16x16x32_bf16 v[116:119], v[12:15], v[84:87], 0
v_mfma_f32_16x16x32_bf16 v[120:123], v[12:15], v[88:91], 0
ds_read_b64_tr_b16 v[76:77], v154 offset:8192
ds_read_b64_tr_b16 v[78:79], v154 offset:8704
ds_read_b64_tr_b16 v[80:81], v155 offset:8192
ds_read_b64_tr_b16 v[82:83], v155 offset:8704
ds_read_b64_tr_b16 v[84:85], v156 offset:8192
ds_read_b64_tr_b16 v[86:87], v156 offset:8704
ds_read_b64_tr_b16 v[88:89], v157 offset:8192
ds_read_b64_tr_b16 v[90:91], v157 offset:8704
s_waitcnt vmcnt(14)
s_waitcnt lgkmcnt(8)
v_mfma_f32_16x16x32_bf16 v[108:111], v[16:19], v[92:95], v[108:111]
v_mfma_f32_16x16x32_bf16 v[112:115], v[16:19], v[96:99], v[112:115]
v_mfma_f32_16x16x32_bf16 v[116:119], v[16:19], v[100:103], v[116:119]
v_mfma_f32_16x16x32_bf16 v[120:123], v[16:19], v[104:107], v[120:123]
ds_read_b64_tr_b16 v[92:93], v154 offset:12288
ds_read_b64_tr_b16 v[94:95], v154 offset:12800
ds_read_b64_tr_b16 v[96:97], v155 offset:12288
ds_read_b64_tr_b16 v[98:99], v155 offset:12800
ds_read_b64_tr_b16 v[100:101], v156 offset:12288
ds_read_b64_tr_b16 v[102:103], v156 offset:12800
ds_read_b64_tr_b16 v[104:105], v157 offset:12288
ds_read_b64_tr_b16 v[106:107], v157 offset:12800
s_waitcnt vmcnt(13)
s_waitcnt lgkmcnt(8)
v_mfma_f32_16x16x32_bf16 v[108:111], v[20:23], v[76:79], v[108:111]
v_mfma_f32_16x16x32_bf16 v[112:115], v[20:23], v[80:83], v[112:115]
v_mfma_f32_16x16x32_bf16 v[116:119], v[20:23], v[84:87], v[116:119]
v_mfma_f32_16x16x32_bf16 v[120:123], v[20:23], v[88:91], v[120:123]
ds_read_b64_tr_b16 v[76:77], v154 offset:16384
ds_read_b64_tr_b16 v[78:79], v154 offset:16896
ds_read_b64_tr_b16 v[80:81], v155 offset:16384
ds_read_b64_tr_b16 v[82:83], v155 offset:16896
ds_read_b64_tr_b16 v[84:85], v156 offset:16384
ds_read_b64_tr_b16 v[86:87], v156 offset:16896
ds_read_b64_tr_b16 v[88:89], v157 offset:16384
ds_read_b64_tr_b16 v[90:91], v157 offset:16896
s_waitcnt vmcnt(12)
s_waitcnt lgkmcnt(8)
v_mfma_f32_16x16x32_bf16 v[108:111], v[24:27], v[92:95], v[108:111]
v_mfma_f32_16x16x32_bf16 v[112:115], v[24:27], v[96:99], v[112:115]
v_mfma_f32_16x16x32_bf16 v[116:119], v[24:27], v[100:103], v[116:119]
v_mfma_f32_16x16x32_bf16 v[120:123], v[24:27], v[104:107], v[120:123]
ds_read_b64_tr_b16 v[92:93], v154 offset:20480
ds_read_b64_tr_b16 v[94:95], v154 offset:20992
ds_read_b64_tr_b16 v[96:97], v155 offset:20480
ds_read_b64_tr_b16 v[98:99], v155 offset:20992
ds_read_b64_tr_b16 v[100:101], v156 offset:20480
ds_read_b64_tr_b16 v[102:103], v156 offset:20992
ds_read_b64_tr_b16 v[104:105], v157 offset:20480
ds_read_b64_tr_b16 v[106:107], v157 offset:20992
s_waitcnt vmcnt(11)
s_waitcnt lgkmcnt(8)
v_mfma_f32_16x16x32_bf16 v[108:111], v[28:31], v[76:79], v[108:111]
v_mfma_f32_16x16x32_bf16 v[112:115], v[28:31], v[80:83], v[112:115]
v_mfma_f32_16x16x32_bf16 v[116:119], v[28:31], v[84:87], v[116:119]
v_mfma_f32_16x16x32_bf16 v[120:123], v[28:31], v[88:91], v[120:123]
ds_read_b64_tr_b16 v[76:77], v154 offset:24576
ds_read_b64_tr_b16 v[78:79], v154 offset:25088
ds_read_b64_tr_b16 v[80:81], v155 offset:24576
ds_read_b64_tr_b16 v[82:83], v155 offset:25088
ds_read_b64_tr_b16 v[84:85], v156 offset:24576
ds_read_b64_tr_b16 v[86:87], v156 offset:25088
ds_read_b64_tr_b16 v[88:89], v157 offset:24576
ds_read_b64_tr_b16 v[90:91], v157 offset:25088
s_waitcnt vmcnt(10)
s_waitcnt lgkmcnt(8)
v_mfma_f32_16x16x32_bf16 v[108:111], v[32:35], v[92:95], v[108:111]
v_mfma_f32_16x16x32_bf16 v[112:115], v[32:35], v[96:99], v[112:115]
v_mfma_f32_16x16x32_bf16 v[116:119], v[32:35], v[100:103], v[116:119]
v_mfma_f32_16x16x32_bf16 v[120:123], v[32:35], v[104:107], v[120:123]
ds_read_b64_tr_b16 v[92:93], v154 offset:28672
ds_read_b64_tr_b16 v[94:95], v154 offset:29184
ds_read_b64_tr_b16 v[96:97], v155 offset:28672
ds_read_b64_tr_b16 v[98:99], v155 offset:29184
ds_read_b64_tr_b16 v[100:101], v156 offset:28672
ds_read_b64_tr_b16 v[102:103], v156 offset:29184
ds_read_b64_tr_b16 v[104:105], v157 offset:28672
ds_read_b64_tr_b16 v[106:107], v157 offset:29184
s_waitcnt vmcnt(9)
s_waitcnt lgkmcnt(8)
v_mfma_f32_16x16x32_bf16 v[108:111], v[36:39], v[76:79], v[108:111]
v_mfma_f32_16x16x32_bf16 v[112:115], v[36:39], v[80:83], v[112:115]
v_mfma_f32_16x16x32_bf16 v[116:119], v[36:39], v[84:87], v[116:119]
v_mfma_f32_16x16x32_bf16 v[120:123], v[36:39], v[88:91], v[120:123]
ds_read_b64_tr_b16 v[76:77], v154 offset:32768
ds_read_b64_tr_b16 v[78:79], v154 offset:33280
ds_read_b64_tr_b16 v[80:81], v155 offset:32768
ds_read_b64_tr_b16 v[82:83], v155 offset:33280
ds_read_b64_tr_b16 v[84:85], v156 offset:32768
ds_read_b64_tr_b16 v[86:87], v156 offset:33280
ds_read_b64_tr_b16 v[88:89], v157 offset:32768
ds_read_b64_tr_b16 v[90:91], v157 offset:33280
s_waitcnt vmcnt(8)
s_waitcnt lgkmcnt(8)
v_mfma_f32_16x16x32_bf16 v[108:111], v[40:43], v[92:95], v[108:111]
v_mfma_f32_16x16x32_bf16 v[112:115], v[40:43], v[96:99], v[112:115]
v_mfma_f32_16x16x32_bf16 v[116:119], v[40:43], v[100:103], v[116:119]
v_mfma_f32_16x16x32_bf16 v[120:123], v[40:43], v[104:107], v[120:123]
ds_read_b64_tr_b16 v[92:93], v154 offset:36864
ds_read_b64_tr_b16 v[94:95], v154 offset:37376
ds_read_b64_tr_b16 v[96:97], v155 offset:36864
ds_read_b64_tr_b16 v[98:99], v155 offset:37376
ds_read_b64_tr_b16 v[100:101], v156 offset:36864
ds_read_b64_tr_b16 v[102:103], v156 offset:37376
ds_read_b64_tr_b16 v[104:105], v157 offset:36864
ds_read_b64_tr_b16 v[106:107], v157 offset:37376
s_waitcnt vmcnt(7)
s_waitcnt lgkmcnt(8)
v_mfma_f32_16x16x32_bf16 v[108:111], v[44:47], v[76:79], v[108:111]
v_mfma_f32_16x16x32_bf16 v[112:115], v[44:47], v[80:83], v[112:115]
v_mfma_f32_16x16x32_bf16 v[116:119], v[44:47], v[84:87], v[116:119]
v_mfma_f32_16x16x32_bf16 v[120:123], v[44:47], v[88:91], v[120:123]
ds_read_b64_tr_b16 v[76:77], v154 offset:40960
ds_read_b64_tr_b16 v[78:79], v154 offset:41472
ds_read_b64_tr_b16 v[80:81], v155 offset:40960
ds_read_b64_tr_b16 v[82:83], v155 offset:41472
ds_read_b64_tr_b16 v[84:85], v156 offset:40960
ds_read_b64_tr_b16 v[86:87], v156 offset:41472
ds_read_b64_tr_b16 v[88:89], v157 offset:40960
ds_read_b64_tr_b16 v[90:91], v157 offset:41472
s_waitcnt vmcnt(6)
s_waitcnt lgkmcnt(8)
v_mfma_f32_16x16x32_bf16 v[108:111], v[48:51], v[92:95], v[108:111]
v_mfma_f32_16x16x32_bf16 v[112:115], v[48:51], v[96:99], v[112:115]
v_mfma_f32_16x16x32_bf16 v[116:119], v[48:51], v[100:103], v[116:119]
v_mfma_f32_16x16x32_bf16 v[120:123], v[48:51], v[104:107], v[120:123]
ds_read_b64_tr_b16 v[92:93], v154 offset:45056
ds_read_b64_tr_b16 v[94:95], v154 offset:45568
ds_read_b64_tr_b16 v[96:97], v155 offset:45056
ds_read_b64_tr_b16 v[98:99], v155 offset:45568
ds_read_b64_tr_b16 v[100:101], v156 offset:45056
ds_read_b64_tr_b16 v[102:103], v156 offset:45568
ds_read_b64_tr_b16 v[104:105], v157 offset:45056
ds_read_b64_tr_b16 v[106:107], v157 offset:45568
s_waitcnt vmcnt(5)
s_waitcnt lgkmcnt(8)
v_mfma_f32_16x16x32_bf16 v[108:111], v[52:55], v[76:79], v[108:111]
v_mfma_f32_16x16x32_bf16 v[112:115], v[52:55], v[80:83], v[112:115]
v_mfma_f32_16x16x32_bf16 v[116:119], v[52:55], v[84:87], v[116:119]
v_mfma_f32_16x16x32_bf16 v[120:123], v[52:55], v[88:91], v[120:123]
ds_read_b64_tr_b16 v[76:77], v154 offset:49152
ds_read_b64_tr_b16 v[78:79], v154 offset:49664
ds_read_b64_tr_b16 v[80:81], v155 offset:49152
ds_read_b64_tr_b16 v[82:83], v155 offset:49664
ds_read_b64_tr_b16 v[84:85], v156 offset:49152
ds_read_b64_tr_b16 v[86:87], v156 offset:49664
ds_read_b64_tr_b16 v[88:89], v157 offset:49152
ds_read_b64_tr_b16 v[90:91], v157 offset:49664
s_waitcnt vmcnt(4)
s_waitcnt lgkmcnt(8)
v_mfma_f32_16x16x32_bf16 v[108:111], v[56:59], v[92:95], v[108:111]
v_mfma_f32_16x16x32_bf16 v[112:115], v[56:59], v[96:99], v[112:115]
v_mfma_f32_16x16x32_bf16 v[116:119], v[56:59], v[100:103], v[116:119]
v_mfma_f32_16x16x32_bf16 v[120:123], v[56:59], v[104:107], v[120:123]
ds_read_b64_tr_b16 v[92:93], v154 offset:53248
ds_read_b64_tr_b16 v[94:95], v154 offset:53760
ds_read_b64_tr_b16 v[96:97], v155 offset:53248
ds_read_b64_tr_b16 v[98:99], v155 offset:53760
ds_read_b64_tr_b16 v[100:101], v156 offset:53248
ds_read_b64_tr_b16 v[102:103], v156 offset:53760
ds_read_b64_tr_b16 v[104:105], v157 offset:53248
ds_read_b64_tr_b16 v[106:107], v157 offset:53760
s_waitcnt vmcnt(3)
s_waitcnt lgkmcnt(8)
v_mfma_f32_16x16x32_bf16 v[108:111], v[60:63], v[76:79], v[108:111]
v_mfma_f32_16x16x32_bf16 v[112:115], v[60:63], v[80:83], v[112:115]
v_mfma_f32_16x16x32_bf16 v[116:119], v[60:63], v[84:87], v[116:119]
v_mfma_f32_16x16x32_bf16 v[120:123], v[60:63], v[88:91], v[120:123]
ds_read_b64_tr_b16 v[76:77], v154 offset:57344
ds_read_b64_tr_b16 v[78:79], v154 offset:57856
ds_read_b64_tr_b16 v[80:81], v155 offset:57344
ds_read_b64_tr_b16 v[82:83], v155 offset:57856
ds_read_b64_tr_b16 v[84:85], v156 offset:57344
ds_read_b64_tr_b16 v[86:87], v156 offset:57856
ds_read_b64_tr_b16 v[88:89], v157 offset:57344
ds_read_b64_tr_b16 v[90:91], v157 offset:57856
s_waitcnt vmcnt(2)
s_waitcnt lgkmcnt(8)
v_mfma_f32_16x16x32_bf16 v[108:111], v[64:67], v[92:95], v[108:111]
v_mfma_f32_16x16x32_bf16 v[112:115], v[64:67], v[96:99], v[112:115]
v_mfma_f32_16x16x32_bf16 v[116:119], v[64:67], v[100:103], v[116:119]
v_mfma_f32_16x16x32_bf16 v[120:123], v[64:67], v[104:107], v[120:123]
ds_read_b64_tr_b16 v[92:93], v154 offset:61440
ds_read_b64_tr_b16 v[94:95], v154 offset:61952
ds_read_b64_tr_b16 v[96:97], v155 offset:61440
ds_read_b64_tr_b16 v[98:99], v155 offset:61952
ds_read_b64_tr_b16 v[100:101], v156 offset:61440
ds_read_b64_tr_b16 v[102:103], v156 offset:61952
ds_read_b64_tr_b16 v[104:105], v157 offset:61440
ds_read_b64_tr_b16 v[106:107], v157 offset:61952
s_waitcnt vmcnt(1)
s_waitcnt lgkmcnt(8)
v_mfma_f32_16x16x32_bf16 v[108:111], v[68:71], v[76:79], v[108:111]
v_mfma_f32_16x16x32_bf16 v[112:115], v[68:71], v[80:83], v[112:115]
v_mfma_f32_16x16x32_bf16 v[116:119], v[68:71], v[84:87], v[116:119]
v_mfma_f32_16x16x32_bf16 v[120:123], v[68:71], v[88:91], v[120:123]
s_waitcnt vmcnt(0)
s_waitcnt lgkmcnt(0)
v_mfma_f32_16x16x32_bf16 v[108:111], v[72:75], v[92:95], v[108:111]
v_mfma_f32_16x16x32_bf16 v[112:115], v[72:75], v[96:99], v[112:115]
v_mfma_f32_16x16x32_bf16 v[116:119], v[72:75], v[100:103], v[116:119]
v_mfma_f32_16x16x32_bf16 v[120:123], v[72:75], v[104:107], v[120:123]
v_lshlrev_b32 v5, 7, v9
v_lshl_add_u32 v5, v8, 1, v5
s_lshl_b32 s6, s3, 9
s_add_u32 s6, s6, 139264
v_add_u32 v5, s6, v5
v_mul_f32 v172, v144, v108
v_fma_f32 v172, v145, v109, v172
v_fma_f32 v172, v146, v110, v172
v_fma_f32 v172, v147, v111, v172
v_cvt_pk_bf16_f32 v172, v172, v172
ds_write_b16 v5, v172 offset:0
v_mul_f32 v173, v144, v112
v_fma_f32 v173, v145, v113, v173
v_fma_f32 v173, v146, v114, v173
v_fma_f32 v173, v147, v115, v173
v_cvt_pk_bf16_f32 v173, v173, v173
ds_write_b16 v5, v173 offset:32
v_mul_f32 v174, v144, v116
v_fma_f32 v174, v145, v117, v174
v_fma_f32 v174, v146, v118, v174
v_fma_f32 v174, v147, v119, v174
v_cvt_pk_bf16_f32 v174, v174, v174
ds_write_b16 v5, v174 offset:64
v_mul_f32 v175, v144, v120
v_fma_f32 v175, v145, v121, v175
v_fma_f32 v175, v146, v122, v175
v_fma_f32 v175, v147, v123, v175
v_cvt_pk_bf16_f32 v175, v175, v175
ds_write_b16 v5, v175 offset:96
v_lshlrev_b32 v6, 7, v8
v_lshl_add_u32 v6, v9, 4, v6
v_add_u32 v6, 139264, v6
s_waitcnt lgkmcnt(0)
s_barrier
ds_read_b128 v[164:167], v6 offset:0
ds_read_b128 v[168:171], v6 offset:64
v_mul_u32_u24 v5, 147456, v9
v_and_b32 v6, 3, v1
v_bfe_u32 v7, v1, 2, 2
v_lshl_add_u32 v6, v6, 2, v7
v_lshl_add_u32 v6, v6, 2, v5
v_lshl_add_u32 v5, v8, 4, v5
s_mul_i32 s6, s9, 2304
s_mul_i32 s7, s3, 576
s_add_u32 s6, s6, s7
s_add_u32 s6, s6, 5242880
s_waitcnt lgkmcnt(0)
v_mfma_f32_16x16x32_bf16 v[108:111], v[164:167], a[96:99], 0
v_mfma_f32_16x16x32_bf16 v[108:111], v[168:171], a[100:103], v[108:111]
v_mfma_f32_16x16x32_bf16 v[112:115], v[164:167], a[104:107], 0
v_mfma_f32_16x16x32_bf16 v[112:115], v[168:171], a[108:111], v[112:115]
v_mfma_f32_16x16x32_bf16 v[116:119], v[164:167], a[112:115], 0
v_mfma_f32_16x16x32_bf16 v[116:119], v[168:171], a[116:119], v[116:119]
v_mfma_f32_16x16x32_bf16 v[120:123], v[164:167], a[120:123], 0
v_mfma_f32_16x16x32_bf16 v[120:123], v[168:171], a[124:127], v[120:123]
v_mfma_f32_16x16x32_bf16 v[124:127], v[164:167], a[128:131], 0
v_mfma_f32_16x16x32_bf16 v[124:127], v[168:171], a[132:135], v[124:127]
v_mfma_f32_16x16x32_bf16 v[128:131], v[164:167], a[136:139], 0
v_mfma_f32_16x16x32_bf16 v[128:131], v[168:171], a[140:143], v[128:131]
v_mfma_f32_16x16x32_bf16 v[132:135], v[164:167], a[144:147], 0
v_mfma_f32_16x16x32_bf16 v[132:135], v[168:171], a[148:151], v[132:135]
v_mfma_f32_16x16x32_bf16 v[136:139], v[164:167], a[152:155], 0
v_mfma_f32_16x16x32_bf16 v[136:139], v[168:171], a[156:159], v[136:139]
v_mfma_f32_16x16x32_bf16 v[140:143], v[164:167], a[160:163], 0
v_mfma_f32_16x16x32_bf16 v[140:143], v[168:171], a[164:167], v[140:143]
v_add_f32 v108, v108, v109
v_add_f32 v110, v110, v111
v_add_f32 v172, v108, v110
v_add_f32 v112, v112, v113
v_add_f32 v114, v114, v115
v_add_f32 v173, v112, v114
v_add_f32 v116, v116, v117
v_add_f32 v118, v118, v119
v_add_f32 v174, v116, v118
v_add_f32 v120, v120, v121
v_add_f32 v122, v122, v123
v_add_f32 v175, v120, v122
v_add_f32 v124, v124, v125
v_add_f32 v126, v126, v127
v_add_f32 v176, v124, v126
v_add_f32 v128, v128, v129
v_add_f32 v130, v130, v131
v_add_f32 v177, v128, v130
v_add_f32 v132, v132, v133
v_add_f32 v134, v134, v135
v_add_f32 v178, v132, v134
v_add_f32 v136, v136, v137
v_add_f32 v138, v138, v139
v_add_f32 v179, v136, v138
v_add_f32 v140, v140, v141
v_add_f32 v142, v142, v143
v_add_f32 v180, v140, v142
buffer_store_dwordx4 v[172:175], v5, s[64:67], s6 offen sc1
buffer_store_dwordx4 v[176:179], v5, s[64:67], s6 offen offset:256 sc1
buffer_store_dword v180, v6, s[64:67], s6 offen offset:512 sc1
s_waitcnt vmcnt(0)
s_barrier
s_cmp_lg_u32 s3, 0
s_cbranch_scc1 L_nofb_18
v_mov_b32 v5, 1
s_mov_b64 exec, 1
buffer_store_byte v5, off, s[68:71], s9 offset:128 sc1
s_mov_b64 exec, -1
L_nofb_18:
v_mul_u32_u24 v44, 2304, v9
v_lshl_add_u32 v44, v8, 4, v44
s_lshl_b32 s6, s3, 10
s_add_u32 s6, s6, 141312
v_add_u32 v46, s6, v2
v_lshlrev_b32 v47, 2, v1
v_add_u32 v47, 141312, v47
v_and_b32 v6, 3, v1
v_bfe_u32 v7, v1, 2, 2
v_lshl_add_u32 v6, v6, 2, v7
v_lshl_add_u32 v6, v9, 4, v6
v_lshlrev_b32 v48, 1, v6
s_cmp_lt_u32 s9, 28
s_cbranch_scc1 R_taskA
s_sub_u32 s14, s9, 28
s_mul_i32 s15, s14, 57
s_lshr_b32 s15, s15, 9
s_mul_i32 s6, s15, 9
s_sub_u32 s80, s14, s6
s_lshl_b32 s6, s15, 2
s_add_u32 s6, s6, s3
s_mul_i32 s81, s6, 36864
s_lshl_b32 s6, s80, 8
s_add_u32 s81, s81, s6
s_add_u32 s81, s81, 5242880
s_mov_b32 s7, 400000
s_lshl_b32 s83, s3, 4
F_poll:
buffer_load_dwordx4 v[28:31], off, s[68:71], s83 offset:128 sc1
s_waitcnt vmcnt(0)
v_and_b32 v28, v28, v29
v_and_b32 v30, v30, v31
v_and_b32 v28, v28, v30
s_nop 0
v_readfirstlane_b32 s6, v28
s_cmp_eq_u32 s6, 0x01010101
s_cbranch_scc1 F_ok
s_sleep 16
s_sub_u32 s7, s7, 1
s_cmp_lg_u32 s7, 0
s_cbranch_scc1 F_poll
F_ok:
s_add_u32 s6, s81, 0
buffer_load_dwordx4 v[12:15], v44, s[64:67], s6 offen sc1
s_add_u32 s6, s81, 9216
buffer_load_dwordx4 v[16:19], v44, s[64:67], s6 offen sc1
s_add_u32 s6, s81, 18432
buffer_load_dwordx4 v[20:23], v44, s[64:67], s6 offen sc1
s_add_u32 s6, s81, 27648
buffer_load_dwordx4 v[24:27], v44, s[64:67], s6 offen sc1
s_waitcnt vmcnt(0)
v_add_f32 v12, v12, v16
v_add_f32 v20, v20, v24
v_add_f32 v13, v13, v17
v_add_f32 v21, v21, v25
v_add_f32 v14, v14, v18
v_add_f32 v22, v22, v26
v_add_f32 v15, v15, v19
v_add_f32 v23, v23, v27
v_add_f32 v12, v12, v20
v_add_f32 v13, v13, v21
v_add_f32 v14, v14, v22
v_add_f32 v15, v15, v23
ds_write_b128 v46, v[12:15]
s_waitcnt lgkmcnt(0)
s_barrier
s_cmp_lg_u32 s3, 0
s_cbranch_scc1 L_fin_19
ds_read2st64_b32 v[50:51], v47 offset0:0 offset1:1
ds_read2st64_b32 v[52:53], v47 offset0:2 offset1:3
ds_read2st64_b32 v[54:55], v47 offset0:4 offset1:5
ds_read2st64_b32 v[56:57], v47 offset0:6 offset1:7
ds_read2st64_b32 v[58:59], v47 offset0:8 offset1:9
ds_read2st64_b32 v[60:61], v47 offset0:10 offset1:11
ds_read2st64_b32 v[62:63], v47 offset0:12 offset1:13
ds_read2st64_b32 v[64:65], v47 offset0:14 offset1:15
s_mul_i32 s6, s15, 2304
s_lshl_b32 s7, s80, 7
s_add_u32 s6, s6, s7
s_waitcnt lgkmcnt(0)
v_add_f32 v50, v50, v58
v_add_f32 v51, v51, v59
v_add_f32 v52, v52, v60
v_add_f32 v53, v53, v61
v_add_f32 v54, v54, v62
v_add_f32 v55, v55, v63
v_add_f32 v56, v56, v64
v_add_f32 v57, v57, v65
v_add_f32 v50, v50, v54
v_add_f32 v51, v51, v55
v_add_f32 v52, v52, v56
v_add_f32 v53, v53, v57
v_add_f32 v50, v50, v52
v_add_f32 v51, v51, v53
v_add_f32 v50, v50, v51
v_cvt_pk_bf16_f32 v50, v50, v50
buffer_store_short v50, v48, s[72:75], s6 offen offset:1152
L_fin_19:
s_cmp_ge_u32 s9, 36
s_cbranch_scc1 B_end
R_taskA:
s_mov_b32 s14, s9
s_mul_i32 s15, s14, 57
s_lshr_b32 s15, s15, 9
s_mul_i32 s6, s15, 9
s_sub_u32 s80, s14, s6
s_lshl_b32 s6, s15, 2
s_add_u32 s6, s6, s3
s_mul_i32 s81, s6, 36864
s_lshl_b32 s6, s80, 8
s_add_u32 s81, s81, s6
s_add_u32 s81, s81, 4194304
s_barrier
s_mov_b32 s82, 0
s_mov_b32 s7, 400000
R_pass:
s_bitcmp1_b32 s82, 0
s_cbranch_scc1 L_ld_20
s_add_u32 s6, s81, 0
buffer_load_dwordx4 v[12:15], v44, s[64:67], s6 offen sc1
L_ld_20:
s_bitcmp1_b32 s82, 1
s_cbranch_scc1 L_ld_21
s_add_u32 s6, s81, 9216
buffer_load_dwordx4 v[16:19], v44, s[64:67], s6 offen sc1
L_ld_21:
s_bitcmp1_b32 s82, 2
s_cbranch_scc1 L_ld_22
s_add_u32 s6, s81, 18432
buffer_load_dwordx4 v[20:23], v44, s[64:67], s6 offen sc1
L_ld_22:
s_bitcmp1_b32 s82, 3
s_cbranch_scc1 L_ld_23
s_add_u32 s6, s81, 27648
buffer_load_dwordx4 v[24:27], v44, s[64:67], s6 offen sc1
L_ld_23:
s_waitcnt vmcnt(0)
v_max3_u32 v66, v12, v13, v14
v_max_u32 v66, v66, v15
v_max3_u32 v67, v16, v17, v18
v_max_u32 v67, v67, v19
v_max3_u32 v68, v20, v21, v22
v_max_u32 v68, v68, v23
v_max3_u32 v69, v24, v25, v26
v_max_u32 v69, v69, v27
v_cmp_eq_u32 vcc, -1, v66
s_cmp_eq_u64 vcc, 0
s_cselect_b32 s6, 1, 0
s_or_b32 s82, s82, s6
v_cmp_eq_u32 vcc, -1, v67
s_cmp_eq_u64 vcc, 0
s_cselect_b32 s6, 2, 0
s_or_b32 s82, s82, s6
v_cmp_eq_u32 vcc, -1, v68
s_cmp_eq_u64 vcc, 0
s_cselect_b32 s6, 4, 0
s_or_b32 s82, s82, s6
v_cmp_eq_u32 vcc, -1, v69
s_cmp_eq_u64 vcc, 0
s_cselect_b32 s6, 8, 0
s_or_b32 s82, s82, s6
s_cmp_eq_u32 s82, 15
s_cbranch_scc1 R_done
s_sleep 4
s_sub_u32 s7, s7, 1
s_cmp_lg_u32 s7, 0
s_cbranch_scc1 R_pass
R_done:
v_add_f32 v12, v12, v16
v_add_f32 v20, v20, v24
v_add_f32 v13, v13, v17
v_add_f32 v21, v21, v25
v_add_f32 v14, v14, v18
v_add_f32 v22, v22, v26
v_add_f32 v15, v15, v19
v_add_f32 v23, v23, v27
v_add_f32 v12, v12, v20
v_add_f32 v13, v13, v21
v_add_f32 v14, v14, v22
v_add_f32 v15, v15, v23
ds_write_b128 v46, v[12:15]
s_waitcnt lgkmcnt(0)
s_barrier
s_cmp_lg_u32 s3, 0
s_cbranch_scc1 L_fin_24
ds_read2st64_b32 v[50:51], v47 offset0:0 offset1:1
ds_read2st64_b32 v[52:53], v47 offset0:2 offset1:3
ds_read2st64_b32 v[54:55], v47 offset0:4 offset1:5
ds_read2st64_b32 v[56:57], v47 offset0:6 offset1:7
ds_read2st64_b32 v[58:59], v47 offset0:8 offset1:9
ds_read2st64_b32 v[60:61], v47 offset0:10 offset1:11
ds_read2st64_b32 v[62:63], v47 offset0:12 offset1:13
ds_read2st64_b32 v[64:65], v47 offset0:14 offset1:15
s_mul_i32 s6, s15, 2304
s_lshl_b32 s7, s80, 7
s_add_u32 s6, s6, s7
s_waitcnt lgkmcnt(0)
v_add_f32 v50, v50, v58
v_add_f32 v51, v51, v59
v_add_f32 v52, v52, v60
v_add_f32 v53, v53, v61
v_add_f32 v54, v54, v62
v_add_f32 v55, v55, v63
v_add_f32 v56, v56, v64
v_add_f32 v57, v57, v65
v_add_f32 v50, v50, v54
v_add_f32 v51, v51, v55
v_add_f32 v52, v52, v56
v_add_f32 v53, v53, v57
v_add_f32 v50, v50, v52
v_add_f32 v51, v51, v53
v_add_f32 v50, v50, v51
v_cvt_pk_bf16_f32 v50, v50, v50
buffer_store_short v50, v48, s[72:75], s6 offen offset:0
L_fin_24:
B_end:
s_endpgm
.section .rodata,"a"
.p2align 6
.amdhsa_kernel concat_heads__mha_block_cached__compressed_kv_cla__decode_kernel
  .amdhsa_next_free_vgpr 512
  .amdhsa_next_free_sgpr 102
  .amdhsa_accum_offset 256
  .amdhsa_group_segment_fixed_size 0
  .amdhsa_kernarg_size 112
  .amdhsa_user_sgpr_count 2
  .amdhsa_user_sgpr_kernarg_segment_ptr 1
  .amdhsa_system_sgpr_workgroup_id_x 1
.end_amdhsa_kernel
```

```asm
; @launch grid=(256,1,1) block=(256,1,1) lds=163840
.amdgcn_target "amdgcn-amd-amdhsa--gfx950"
.text
.globl concat_heads__mha_block_cached__compressed_kv_cla__decode_kernel
.p2align 8
.type concat_heads__mha_block_cached__compressed_kv_cla__decode_kernel,@function
concat_heads__mha_block_cached__compressed_kv_cla__decode_kernel:
s_cmp_ge_u32 s2, 256
s_cbranch_scc1 L_exit
s_load_dwordx16 s[16:31], s[0:1], 0
s_load_dwordx8 s[32:39], s[0:1], 64
s_load_dwordx4 s[40:43], s[0:1], 96
v_lshrrev_b32 v1, 6, v0
s_nop 0
v_readfirstlane_b32 s3, v1
s_and_b32 s6, s2, 7
s_bfe_u32 s7, s2, 0x20003
s_lshl_b32 s4, s6, 2
s_add_u32 s4, s4, s7
s_lshr_b32 s5, s2, 5
s_cmp_lt_u32 s5, 2
s_cbranch_scc1 B_role
A_role:
s_sub_u32 s8, s5, 2
s_cmp_ge_u32 s8, 3
s_cselect_b32 s9, 1, 0
s_cselect_b32 s6, 3, 0
s_sub_u32 s8, s8, s6
s_lshl_b32 s11, s8, 2
s_add_u32 s11, s11, s3
s_cmp_ge_u32 s11, 6
s_cselect_b32 s83, 1, 0
s_cselect_b32 s6, -1, 1
s_add_u32 s11, s11, s6
s_cmp_ge_u32 s11, 6
s_cselect_b32 s6, 6, 0
s_sub_u32 s11, s11, s6
s_lshl_b32 s10, s9, 1
s_add_u32 s10, s10, s83
v_and_b32 v1, 63, v0
v_lshlrev_b32 v2, 4, v1
s_sub_u32 s14, s11, 8
s_lshl_b32 s14, s14, 12
s_mov_b32 s13, s14
s_add_u32 s13, s13, 24576
s_min_u32 s12, s13, 2146435072
s_lshl_b32 s82, s10, 5
s_add_u32 s82, s82, s4
s_lshl_b32 s6, s82, 20
s_waitcnt lgkmcnt(0)
s_add_u32 s52, s18, s6
s_addc_u32 s53, s19, 0
s_mov_b32 s54, 1048576
s_mov_b32 s55, 0x20000
s_add_u32 s56, s20, s6
s_addc_u32 s57, s21, 0
s_mov_b32 s58, 1048576
s_mov_b32 s59, 0x20000
s_mul_i32 s6, s9, 2304
s_mul_i32 s7, s3, 288
s_add_u32 s6, s6, s7
s_sub_u32 s7, 4608, s6
s_add_u32 s44, s16, s6
s_addc_u32 s45, s17, 0
s_mov_b32 s46, s7
s_mov_b32 s47, 0x20000
s_mul_i32 s6, s3, 1179648
s_lshl_b32 s7, s4, 8
s_add_u32 s6, s6, s7
s_sub_u32 s7, 4718592, s6
s_add_u32 s48, s22, s6
s_addc_u32 s49, s23, 0
s_mov_b32 s50, s7
s_mov_b32 s51, 0x20000
v_lshrrev_b32 v5, 4, v1
v_and_b32 v6, 15, v1
v_mul_u32_u24 v3, 294912, v5
v_lshl_add_u32 v3, v6, 4, v3
v_mul_u32_u24 v4, 72, v5
v_lshrrev_b32 v6, 3, v6
v_mul_u32_u24 v6, 1152, v6
v_add_u32 v4, v4, v6
buffer_load_dwordx4 v[40:43], v4, s[44:47], 0 offen offset:0
buffer_load_dwordx4 v[44:47], v4, s[44:47], 0 offen offset:16
buffer_load_dwordx4 v[48:51], v4, s[44:47], 0 offen offset:32
buffer_load_dwordx4 v[52:55], v4, s[44:47], 0 offen offset:48
buffer_load_dwordx2 v[56:57], v4, s[44:47], 0 offen offset:64
s_mov_b32 s6, 0
buffer_load_dwordx4 a[96:99], v3, s[48:51], s6 offen
s_mov_b32 s6, 8192
buffer_load_dwordx4 a[100:103], v3, s[48:51], s6 offen
s_mov_b32 s6, 16384
buffer_load_dwordx4 a[104:107], v3, s[48:51], s6 offen
buffer_load_dwordx4 v[136:139], v2, s[52:55], s12 offen offset:0 nt
buffer_load_dwordx4 v[140:143], v2, s[52:55], s12 offen offset:1024 nt
buffer_load_dwordx4 v[144:147], v2, s[52:55], s12 offen offset:2048 nt
buffer_load_dwordx4 v[148:151], v2, s[52:55], s12 offen offset:3072 nt
s_add_u32 s13, s13, 24576
s_min_u32 s12, s13, 2146435072
s_mov_b32 s6, 24576
buffer_load_dwordx4 a[108:111], v3, s[48:51], s6 offen
s_mov_b32 s6, 32768
buffer_load_dwordx4 a[112:115], v3, s[48:51], s6 offen
s_mov_b32 s6, 40960
buffer_load_dwordx4 a[116:119], v3, s[48:51], s6 offen
buffer_load_dwordx4 v[152:155], v2, s[52:55], s12 offen offset:0 nt
buffer_load_dwordx4 v[156:159], v2, s[52:55], s12 offen offset:1024 nt
buffer_load_dwordx4 v[160:163], v2, s[52:55], s12 offen offset:2048 nt
buffer_load_dwordx4 v[164:167], v2, s[52:55], s12 offen offset:3072 nt
s_add_u32 s13, s13, 24576
s_min_u32 s12, s13, 2146435072
s_mov_b32 s6, 49152
buffer_load_dwordx4 a[120:123], v3, s[48:51], s6 offen
s_mov_b32 s6, 57344
buffer_load_dwordx4 a[124:127], v3, s[48:51], s6 offen
s_mov_b32 s6, 65536
buffer_load_dwordx4 a[128:131], v3, s[48:51], s6 offen
buffer_load_dwordx4 v[168:171], v2, s[52:55], s12 offen offset:0 nt
buffer_load_dwordx4 v[172:175], v2, s[52:55], s12 offen offset:1024 nt
buffer_load_dwordx4 v[176:179], v2, s[52:55], s12 offen offset:2048 nt
buffer_load_dwordx4 v[180:183], v2, s[52:55], s12 offen offset:3072 nt
s_add_u32 s13, s13, 24576
s_min_u32 s12, s13, 2146435072
s_mov_b32 s6, 73728
buffer_load_dwordx4 a[132:135], v3, s[48:51], s6 offen
s_mov_b32 s6, 81920
buffer_load_dwordx4 a[136:139], v3, s[48:51], s6 offen
s_mov_b32 s6, 90112
buffer_load_dwordx4 a[140:143], v3, s[48:51], s6 offen
buffer_load_dwordx4 v[184:187], v2, s[52:55], s12 offen offset:0 nt
buffer_load_dwordx4 v[188:191], v2, s[52:55], s12 offen offset:1024 nt
buffer_load_dwordx4 v[192:195], v2, s[52:55], s12 offen offset:2048 nt
buffer_load_dwordx4 v[196:199], v2, s[52:55], s12 offen offset:3072 nt
s_add_u32 s13, s13, 24576
s_min_u32 s12, s13, 2146435072
s_mov_b32 s6, 98304
buffer_load_dwordx4 a[144:147], v3, s[48:51], s6 offen
s_mov_b32 s6, 106496
buffer_load_dwordx4 a[148:151], v3, s[48:51], s6 offen
s_mov_b32 s6, 114688
buffer_load_dwordx4 a[152:155], v3, s[48:51], s6 offen
buffer_load_dwordx4 v[200:203], v2, s[52:55], s12 offen offset:0 nt
buffer_load_dwordx4 v[204:207], v2, s[52:55], s12 offen offset:1024 nt
buffer_load_dwordx4 v[208:211], v2, s[52:55], s12 offen offset:2048 nt
buffer_load_dwordx4 v[212:215], v2, s[52:55], s12 offen offset:3072 nt
s_add_u32 s13, s13, 24576
s_min_u32 s12, s13, 2146435072
s_mov_b32 s6, 122880
buffer_load_dwordx4 a[156:159], v3, s[48:51], s6 offen
s_mov_b32 s6, 131072
buffer_load_dwordx4 a[160:163], v3, s[48:51], s6 offen
s_mov_b32 s6, 139264
buffer_load_dwordx4 a[164:167], v3, s[48:51], s6 offen
buffer_load_dwordx4 v[216:219], v2, s[52:55], s12 offen offset:0 nt
buffer_load_dwordx4 v[220:223], v2, s[52:55], s12 offen offset:1024 nt
buffer_load_dwordx4 v[224:227], v2, s[52:55], s12 offen offset:2048 nt
buffer_load_dwordx4 v[228:231], v2, s[52:55], s12 offen offset:3072 nt
s_add_u32 s13, s13, 24576
s_min_u32 s12, s13, 2146435072
s_mov_b32 s6, 147456
buffer_load_dwordx4 a[168:171], v3, s[48:51], s6 offen
s_mov_b32 s6, 155648
buffer_load_dwordx4 a[172:175], v3, s[48:51], s6 offen
s_mov_b32 s6, 163840
buffer_load_dwordx4 a[176:179], v3, s[48:51], s6 offen
buffer_load_dwordx4 v[232:235], v2, s[52:55], s12 offen offset:0 nt
buffer_load_dwordx4 v[236:239], v2, s[52:55], s12 offen offset:1024 nt
buffer_load_dwordx4 v[240:243], v2, s[52:55], s12 offen offset:2048 nt
buffer_load_dwordx4 v[244:247], v2, s[52:55], s12 offen offset:3072 nt
s_add_u32 s13, s13, 24576
s_min_u32 s12, s13, 2146435072
s_mov_b32 s6, 172032
buffer_load_dwordx4 a[180:183], v3, s[48:51], s6 offen
s_mov_b32 s6, 180224
buffer_load_dwordx4 a[184:187], v3, s[48:51], s6 offen
s_mov_b32 s6, 188416
buffer_load_dwordx4 a[188:191], v3, s[48:51], s6 offen
s_mov_b32 s6, 196608
buffer_load_dwordx4 a[192:195], v3, s[48:51], s6 offen
s_mov_b32 s6, 204800
buffer_load_dwordx4 a[196:199], v3, s[48:51], s6 offen
s_mov_b32 s6, 212992
buffer_load_dwordx4 a[200:203], v3, s[48:51], s6 offen
s_mov_b32 s6, 221184
buffer_load_dwordx4 a[204:207], v3, s[48:51], s6 offen
s_mov_b32 s64, s42
s_mov_b32 s65, s43
s_mov_b32 s66, 6291456
s_mov_b32 s67, 0x20000
s_mov_b32 s68, s40
s_mov_b32 s69, s41
s_mov_b32 s70, 256
s_mov_b32 s71, 0x20000
s_mul_i32 s6, s4, 147456
s_add_u32 s60, s24, s6
s_addc_u32 s61, s25, 0
s_mov_b32 s62, 147456
s_mov_b32 s63, 0x20000
v_and_b32 v5, 1, v1
v_lshlrev_b32 v5, 4, v5
v_mov_b32 v6, 0xffff
v_lshlrev_b32 v5, v5, v6
v_bfe_u32 v6, v1, 1, 2
v_cmp_eq_u32 vcc, 0, v6
s_nop 1
v_cndmask_b32 v8, 0, v5, vcc
v_cmp_eq_u32 vcc, 1, v6
s_nop 1
v_cndmask_b32 v9, 0, v5, vcc
v_cmp_eq_u32 vcc, 2, v6
s_nop 1
v_cndmask_b32 v10, 0, v5, vcc
v_cmp_eq_u32 vcc, 3, v6
s_nop 1
v_cndmask_b32 v11, 0, v5, vcc
v_mov_b32 v5, 0x0c0c0c0c
s_mov_b32 s6, 0x01000100
s_mov_b32 s7, 0x03020302
v_bfi_b32 v12, v8, s6, v5
v_bfi_b32 v13, v9, s6, v5
v_bfi_b32 v14, v10, s6, v5
v_bfi_b32 v15, v11, s6, v5
v_bfi_b32 v16, v8, s7, v5
v_bfi_b32 v17, v9, s7, v5
v_bfi_b32 v18, v10, s7, v5
v_bfi_b32 v19, v11, s7, v5
v_mov_b32 v7, 0x3e0293ee
v_mov_b32 v86, 0xff800000
v_lshrrev_b32 v5, 4, v1
v_lshlrev_b32 v5, 3, v5
v_bfe_u32 v6, v1, 2, 2
v_add_u32 v5, v5, v6
v_mul_u32_u24 v5, 1152, v5
s_mul_i32 s6, s3, 288
v_add_u32 v5, s6, v5
v_and_b32 v6, 3, v1
v_lshl_add_u32 v88, v6, 5, v5
v_lshl_add_u32 v89, v6, 3, v5
v_add_u32 v89, 256, v89
v_add_u32 v90, 73728, v88
v_add_u32 v91, 73728, v89
s_lshl_b32 s82, s82, 6
s_add_u32 s82, s82, 327680
s_mov_b64 s[72:73], 0
s_cmp_ge_u32 s11, 2
s_cselect_b32 s74, 0x22222222, 0
s_mov_b32 s75, s74
s_mov_b32 s76, 0x44444444
s_mov_b32 s77, s76
s_mov_b32 s78, 0x88888888
s_mov_b32 s79, s78
v_bfe_u32 v5, v1, 4, 1
s_lshl_b32 s6, s9, 7
s_lshl_b32 s7, s4, 1
s_add_u32 s6, s6, s7
s_add_u32 s6, s6, s8
v_mul_u32_u24 v6, 63, v5
v_add_u32 v6, s6, v6
v_mul_u32_u24 v92, 2304, v6
v_add_u32 v92, 4194304, v92
v_sub_u32 v6, s8, v5
v_cmp_lt_u32 vcc, 1, v6
v_mov_b32 v6, 2146435072
s_nop 0
v_cndmask_b32 v92, v92, v6, vcc
s_mul_i32 s6, s3, 576
v_add_u32 v92, s6, v92
v_and_b32 v35, 3, v1
v_bfe_u32 v36, v1, 2, 2
v_lshl_add_u32 v35, v35, 2, v36
v_lshl_add_u32 v93, v35, 2, v92
v_and_b32 v35, 15, v1
v_lshrrev_b32 v36, 5, v1
v_lshl_add_u32 v35, v36, 4, v35
v_lshl_add_u32 v92, v35, 4, v92
s_lshl_b32 s6, s8, 2
s_add_u32 s6, s6, 0
s_cmp_ge_u32 s6, 6
s_cselect_b32 s6, 1, 0
v_cmp_eq_u32 vcc, s6, v5
s_nop 1
v_cndmask_b32 v106, 0, 1.0, vcc
s_lshl_b32 s6, s8, 2
s_add_u32 s6, s6, 1
s_cmp_ge_u32 s6, 6
s_cselect_b32 s6, 1, 0
v_cmp_eq_u32 vcc, s6, v5
s_nop 1
v_cndmask_b32 v107, 0, 1.0, vcc
s_lshl_b32 s6, s8, 2
s_add_u32 s6, s6, 2
s_cmp_ge_u32 s6, 6
s_cselect_b32 s6, 1, 0
v_cmp_eq_u32 vcc, s6, v5
s_nop 1
v_cndmask_b32 v108, 0, 1.0, vcc
s_lshl_b32 s6, s8, 2
s_add_u32 s6, s6, 3
s_cmp_ge_u32 s6, 6
s_cselect_b32 s6, 1, 0
v_cmp_eq_u32 vcc, s6, v5
s_nop 1
v_cndmask_b32 v109, 0, 1.0, vcc
v_cmp_gt_u32 vcc, 32, v1
s_nop 1
v_cndmask_b32 v98, 0, v106, vcc
v_cndmask_b32 v102, v106, 0, vcc
v_cndmask_b32 v99, 0, v107, vcc
v_cndmask_b32 v103, v107, 0, vcc
v_cndmask_b32 v100, 0, v108, vcc
v_cndmask_b32 v104, v108, 0, vcc
v_cndmask_b32 v101, 0, v109, vcc
v_cndmask_b32 v105, v109, 0, vcc
v_and_b32 v35, 15, v1
v_lshlrev_b32 v35, 4, v35
v_lshl_add_u32 v94, v5, 3, v35
s_lshl_b32 s6, s3, 8
s_add_u32 s6, s6, 151552
v_add_u32 v94, s6, v94
v_and_b32 v35, 3, v1
v_lshlrev_b32 v35, 8, v35
v_lshrrev_b32 v36, 4, v1
v_lshl_add_u32 v95, v36, 4, v35
v_add_u32 v95, 151552, v95
s_mul_i32 s15, s3, 36864
s_mov_b32 s80, 0x0
s_mov_b32 s81, 0
v_and_b32 v35, 15, v1
v_lshlrev_b32 v35, 5, v35
v_lshl_add_u32 v36, v5, 4, v35
v_lshrrev_b32 v6, 5, v1
v_lshl_add_u32 v36, v6, 9, v36
s_lshl_b32 s6, s3, 10
s_add_u32 s6, s6, 147456
v_add_u32 v36, s6, v36
s_lshl_b32 s6, s83, 9
s_add_u32 s6, s6, 147456
v_add_u32 v35, s6, v35
s_waitcnt vmcnt(55)
v_perm_b32 v60, v40, v40, v12
v_perm_b32 v61, v40, v40, v13
v_perm_b32 v62, v40, v40, v14
v_perm_b32 v63, v40, v40, v15
s_nop 1
v_mfma_f32_16x16x32_bf16 v[20:23], v[60:63], a[96:99], 0
s_mov_b32 s6, 229376
buffer_load_dwordx4 a[208:211], v3, s[48:51], s6 offen
s_mov_b32 s6, 237568
buffer_load_dwordx4 a[212:215], v3, s[48:51], s6 offen
s_mov_b32 s6, 245760
buffer_load_dwordx4 a[216:219], v3, s[48:51], s6 offen
s_mov_b32 s6, 253952
buffer_load_dwordx4 a[220:223], v3, s[48:51], s6 offen
s_mov_b32 s6, 262144
buffer_load_dwordx4 a[224:227], v3, s[48:51], s6 offen
s_waitcnt vmcnt(59)
v_perm_b32 v64, v40, v40, v16
v_perm_b32 v65, v40, v40, v17
v_perm_b32 v66, v40, v40, v18
v_perm_b32 v67, v40, v40, v19
s_nop 1
v_mfma_f32_16x16x32_bf16 v[20:23], v[64:67], a[100:103], v[20:23]
s_mov_b32 s6, 270336
buffer_load_dwordx4 a[228:231], v3, s[48:51], s6 offen
s_waitcnt vmcnt(59)
v_perm_b32 v68, v41, v41, v12
v_perm_b32 v69, v41, v41, v13
v_perm_b32 v70, v41, v41, v14
v_perm_b32 v71, v41, v41, v15
s_nop 1
v_mfma_f32_16x16x32_bf16 v[20:23], v[68:71], a[104:107], v[20:23]
s_mov_b32 s6, 278528
buffer_load_dwordx4 a[232:235], v3, s[48:51], s6 offen
s_waitcnt vmcnt(55)
v_perm_b32 v72, v41, v41, v16
v_perm_b32 v73, v41, v41, v17
v_perm_b32 v74, v41, v41, v18
v_perm_b32 v75, v41, v41, v19
s_nop 1
v_mfma_f32_16x16x32_bf16 v[20:23], v[72:75], a[108:111], v[20:23]
s_mov_b32 s6, 286720
buffer_load_dwordx4 a[236:239], v3, s[48:51], s6 offen
s_waitcnt vmcnt(55)
v_perm_b32 v60, v42, v42, v12
v_perm_b32 v61, v42, v42, v13
v_perm_b32 v62, v42, v42, v14
v_perm_b32 v63, v42, v42, v15
s_nop 1
v_mfma_f32_16x16x32_bf16 v[20:23], v[60:63], a[112:115], v[20:23]
s_waitcnt vmcnt(54)
v_perm_b32 v64, v42, v42, v16
v_perm_b32 v65, v42, v42, v17
v_perm_b32 v66, v42, v42, v18
v_perm_b32 v67, v42, v42, v19
s_nop 1
v_mfma_f32_16x16x32_bf16 v[20:23], v[64:67], a[116:119], v[20:23]
s_waitcnt vmcnt(49)
v_perm_b32 v68, v43, v43, v12
v_perm_b32 v69, v43, v43, v13
v_perm_b32 v70, v43, v43, v14
v_perm_b32 v71, v43, v43, v15
s_nop 1
v_mfma_f32_16x16x32_bf16 v[20:23], v[68:71], a[120:123], v[20:23]
s_waitcnt vmcnt(48)
v_perm_b32 v72, v43, v43, v16
v_perm_b32 v73, v43, v43, v17
v_perm_b32 v74, v43, v43, v18
v_perm_b32 v75, v43, v43, v19
s_nop 1
v_mfma_f32_16x16x32_bf16 v[20:23], v[72:75], a[124:127], v[20:23]
s_waitcnt vmcnt(47)
v_perm_b32 v60, v44, v44, v12
v_perm_b32 v61, v44, v44, v13
v_perm_b32 v62, v44, v44, v14
v_perm_b32 v63, v44, v44, v15
s_nop 1
v_mfma_f32_16x16x32_bf16 v[20:23], v[60:63], a[128:131], v[20:23]
s_waitcnt vmcnt(42)
v_perm_b32 v64, v44, v44, v16
v_perm_b32 v65, v44, v44, v17
v_perm_b32 v66, v44, v44, v18
v_perm_b32 v67, v44, v44, v19
s_nop 1
v_mfma_f32_16x16x32_bf16 v[20:23], v[64:67], a[132:135], v[20:23]
s_waitcnt vmcnt(41)
v_perm_b32 v68, v45, v45, v12
v_perm_b32 v69, v45, v45, v13
v_perm_b32 v70, v45, v45, v14
v_perm_b32 v71, v45, v45, v15
s_nop 1
v_mfma_f32_16x16x32_bf16 v[20:23], v[68:71], a[136:139], v[20:23]
s_waitcnt vmcnt(40)
v_perm_b32 v72, v45, v45, v16
v_perm_b32 v73, v45, v45, v17
v_perm_b32 v74, v45, v45, v18
v_perm_b32 v75, v45, v45, v19
s_nop 1
v_mfma_f32_16x16x32_bf16 v[20:23], v[72:75], a[140:143], v[20:23]
s_waitcnt vmcnt(35)
v_perm_b32 v60, v46, v46, v12
v_perm_b32 v61, v46, v46, v13
v_perm_b32 v62, v46, v46, v14
v_perm_b32 v63, v46, v46, v15
s_nop 1
v_mfma_f32_16x16x32_bf16 v[20:23], v[60:63], a[144:147], v[20:23]
s_waitcnt vmcnt(34)
v_perm_b32 v64, v46, v46, v16
v_perm_b32 v65, v46, v46, v17
v_perm_b32 v66, v46, v46, v18
v_perm_b32 v67, v46, v46, v19
s_nop 1
v_mfma_f32_16x16x32_bf16 v[20:23], v[64:67], a[148:151], v[20:23]
s_waitcnt vmcnt(33)
v_perm_b32 v68, v47, v47, v12
v_perm_b32 v69, v47, v47, v13
v_perm_b32 v70, v47, v47, v14
v_perm_b32 v71, v47, v47, v15
s_nop 1
v_mfma_f32_16x16x32_bf16 v[20:23], v[68:71], a[152:155], v[20:23]
s_waitcnt vmcnt(28)
v_perm_b32 v72, v47, v47, v16
v_perm_b32 v73, v47, v47, v17
v_perm_b32 v74, v47, v47, v18
v_perm_b32 v75, v47, v47, v19
s_nop 1
v_mfma_f32_16x16x32_bf16 v[20:23], v[72:75], a[156:159], v[20:23]
s_waitcnt vmcnt(27)
v_perm_b32 v60, v48, v48, v12
v_perm_b32 v61, v48, v48, v13
v_perm_b32 v62, v48, v48, v14
v_perm_b32 v63, v48, v48, v15
s_nop 1
v_mfma_f32_16x16x32_bf16 v[20:23], v[60:63], a[160:163], v[20:23]
s_waitcnt vmcnt(26)
v_perm_b32 v64, v48, v48, v16
v_perm_b32 v65, v48, v48, v17
v_perm_b32 v66, v48, v48, v18
v_perm_b32 v67, v48, v48, v19
s_nop 1
v_mfma_f32_16x16x32_bf16 v[20:23], v[64:67], a[164:167], v[20:23]
s_waitcnt vmcnt(21)
v_perm_b32 v68, v49, v49, v12
v_perm_b32 v69, v49, v49, v13
v_perm_b32 v70, v49, v49, v14
v_perm_b32 v71, v49, v49, v15
s_nop 1
v_mfma_f32_16x16x32_bf16 v[20:23], v[68:71], a[168:171], v[20:23]
s_waitcnt vmcnt(20)
v_perm_b32 v72, v49, v49, v16
v_perm_b32 v73, v49, v49, v17
v_perm_b32 v74, v49, v49, v18
v_perm_b32 v75, v49, v49, v19
s_nop 1
v_mfma_f32_16x16x32_bf16 v[20:23], v[72:75], a[172:175], v[20:23]
s_waitcnt vmcnt(19)
v_perm_b32 v60, v50, v50, v12
v_perm_b32 v61, v50, v50, v13
v_perm_b32 v62, v50, v50, v14
v_perm_b32 v63, v50, v50, v15
s_nop 1
v_mfma_f32_16x16x32_bf16 v[20:23], v[60:63], a[176:179], v[20:23]
s_waitcnt vmcnt(14)
v_perm_b32 v64, v50, v50, v16
v_perm_b32 v65, v50, v50, v17
v_perm_b32 v66, v50, v50, v18
v_perm_b32 v67, v50, v50, v19
s_nop 1
v_mfma_f32_16x16x32_bf16 v[20:23], v[64:67], a[180:183], v[20:23]
s_waitcnt vmcnt(13)
v_perm_b32 v68, v51, v51, v12
v_perm_b32 v69, v51, v51, v13
v_perm_b32 v70, v51, v51, v14
v_perm_b32 v71, v51, v51, v15
s_nop 1
v_mfma_f32_16x16x32_bf16 v[20:23], v[68:71], a[184:187], v[20:23]
s_waitcnt vmcnt(12)
v_perm_b32 v72, v51, v51, v16
v_perm_b32 v73, v51, v51, v17
v_perm_b32 v74, v51, v51, v18
v_perm_b32 v75, v51, v51, v19
s_nop 1
v_mfma_f32_16x16x32_bf16 v[20:23], v[72:75], a[188:191], v[20:23]
s_waitcnt vmcnt(11)
v_perm_b32 v60, v52, v52, v12
v_perm_b32 v61, v52, v52, v13
v_perm_b32 v62, v52, v52, v14
v_perm_b32 v63, v52, v52, v15
s_nop 1
v_mfma_f32_16x16x32_bf16 v[20:23], v[60:63], a[192:195], v[20:23]
s_waitcnt vmcnt(10)
v_perm_b32 v64, v52, v52, v16
v_perm_b32 v65, v52, v52, v17
v_perm_b32 v66, v52, v52, v18
v_perm_b32 v67, v52, v52, v19
s_nop 1
v_mfma_f32_16x16x32_bf16 v[20:23], v[64:67], a[196:199], v[20:23]
s_waitcnt vmcnt(9)
v_perm_b32 v68, v53, v53, v12
v_perm_b32 v69, v53, v53, v13
v_perm_b32 v70, v53, v53, v14
v_perm_b32 v71, v53, v53, v15
s_nop 1
v_mfma_f32_16x16x32_bf16 v[20:23], v[68:71], a[200:203], v[20:23]
s_waitcnt vmcnt(8)
v_perm_b32 v72, v53, v53, v16
v_perm_b32 v73, v53, v53, v17
v_perm_b32 v74, v53, v53, v18
v_perm_b32 v75, v53, v53, v19
s_nop 1
v_mfma_f32_16x16x32_bf16 v[20:23], v[72:75], a[204:207], v[20:23]
s_waitcnt vmcnt(7)
v_perm_b32 v60, v54, v54, v12
v_perm_b32 v61, v54, v54, v13
v_perm_b32 v62, v54, v54, v14
v_perm_b32 v63, v54, v54, v15
s_nop 1
v_mfma_f32_16x16x32_bf16 v[20:23], v[60:63], a[208:211], v[20:23]
s_waitcnt vmcnt(6)
v_perm_b32 v64, v54, v54, v16
v_perm_b32 v65, v54, v54, v17
v_perm_b32 v66, v54, v54, v18
v_perm_b32 v67, v54, v54, v19
s_nop 1
v_mfma_f32_16x16x32_bf16 v[20:23], v[64:67], a[212:215], v[20:23]
s_waitcnt vmcnt(5)
v_perm_b32 v68, v55, v55, v12
v_perm_b32 v69, v55, v55, v13
v_perm_b32 v70, v55, v55, v14
v_perm_b32 v71, v55, v55, v15
s_nop 1
v_mfma_f32_16x16x32_bf16 v[20:23], v[68:71], a[216:219], v[20:23]
s_waitcnt vmcnt(4)
v_perm_b32 v72, v55, v55, v16
v_perm_b32 v73, v55, v55, v17
v_perm_b32 v74, v55, v55, v18
v_perm_b32 v75, v55, v55, v19
s_nop 1
v_mfma_f32_16x16x32_bf16 v[20:23], v[72:75], a[220:223], v[20:23]
s_waitcnt vmcnt(3)
v_perm_b32 v60, v56, v56, v12
v_perm_b32 v61, v56, v56, v13
v_perm_b32 v62, v56, v56, v14
v_perm_b32 v63, v56, v56, v15
s_nop 1
v_mfma_f32_16x16x32_bf16 v[20:23], v[60:63], a[224:227], v[20:23]
s_waitcnt vmcnt(2)
v_perm_b32 v64, v56, v56, v16
v_perm_b32 v65, v56, v56, v17
v_perm_b32 v66, v56, v56, v18
v_perm_b32 v67, v56, v56, v19
s_nop 1
v_mfma_f32_16x16x32_bf16 v[20:23], v[64:67], a[228:231], v[20:23]
s_waitcnt vmcnt(1)
v_perm_b32 v68, v57, v57, v12
v_perm_b32 v69, v57, v57, v13
v_perm_b32 v70, v57, v57, v14
v_perm_b32 v71, v57, v57, v15
s_nop 1
v_mfma_f32_16x16x32_bf16 v[20:23], v[68:71], a[232:235], v[20:23]
s_waitcnt vmcnt(0)
v_perm_b32 v72, v57, v57, v16
v_perm_b32 v73, v57, v57, v17
v_perm_b32 v74, v57, v57, v18
v_perm_b32 v75, v57, v57, v19
s_nop 1
v_mfma_f32_16x16x32_bf16 v[20:23], v[72:75], a[236:239], v[20:23]
s_nop 7
ds_write_b128 v36, v[20:23]
s_waitcnt lgkmcnt(0)
s_barrier
ds_read_b128 v[40:43], v35 offset:0
ds_read_b128 v[44:47], v35 offset:16
ds_read_b128 v[48:51], v35 offset:1024
ds_read_b128 v[52:55], v35 offset:1040
ds_read_b128 v[56:59], v35 offset:2048
ds_read_b128 v[60:63], v35 offset:2064
ds_read_b128 v[64:67], v35 offset:3072
ds_read_b128 v[68:71], v35 offset:3088
v_mov_b32 v20, 0
v_mov_b32 v21, 0
v_mov_b32 v22, 0
v_mov_b32 v23, 0
s_waitcnt lgkmcnt(0)
v_add_f32 v40, v40, v48
v_add_f32 v56, v56, v64
v_add_f32 v41, v41, v49
v_add_f32 v57, v57, v65
v_add_f32 v42, v42, v50
v_add_f32 v58, v58, v66
v_add_f32 v43, v43, v51
v_add_f32 v59, v59, v67
v_add_f32 v44, v44, v52
v_add_f32 v60, v60, v68
v_add_f32 v45, v45, v53
v_add_f32 v61, v61, v69
v_add_f32 v46, v46, v54
v_add_f32 v62, v62, v70
v_add_f32 v47, v47, v55
v_add_f32 v63, v63, v71
v_add_f32 v40, v40, v56
v_add_f32 v41, v41, v57
v_add_f32 v42, v42, v58
v_add_f32 v43, v43, v59
v_add_f32 v44, v44, v60
v_add_f32 v45, v45, v61
v_add_f32 v46, v46, v62
v_add_f32 v47, v47, v63
v_cvt_pk_bf16_f32 v24, v40, v41
v_cvt_pk_bf16_f32 v25, v42, v43
v_cvt_pk_bf16_f32 v26, v44, v45
v_cvt_pk_bf16_f32 v27, v46, v47
K_loop:
s_cmp_lg_u32 s81, 8
s_cbranch_scc1 L_c0_1
buffer_load_dword v96, off, s[68:71], 0 offset:0 sc1
L_c0_1:
s_waitcnt vmcnt(28)
v_dot2_f32_bf16 v28, v120, v24, 0
v_dot2_f32_bf16 v29, v124, v24, 0
v_dot2_f32_bf16 v30, v128, v24, 0
v_dot2_f32_bf16 v31, v132, v24, 0
v_dot2_f32_bf16 v28, v121, v25, v28
v_dot2_f32_bf16 v29, v125, v25, v29
v_dot2_f32_bf16 v30, v129, v25, v30
v_dot2_f32_bf16 v31, v133, v25, v31
v_dot2_f32_bf16 v28, v122, v26, v28
v_dot2_f32_bf16 v29, v126, v26, v29
v_dot2_f32_bf16 v30, v130, v26, v30
v_dot2_f32_bf16 v31, v134, v26, v31
v_dot2_f32_bf16 v28, v123, v27, v28
v_dot2_f32_bf16 v29, v127, v27, v29
v_dot2_f32_bf16 v30, v131, v27, v30
v_dot2_f32_bf16 v31, v135, v27, v31
buffer_load_dwordx4 v[120:123], v2, s[52:55], s12 offen offset:0 nt
buffer_load_dwordx4 v[124:127], v2, s[52:55], s12 offen offset:1024 nt
buffer_load_dwordx4 v[128:131], v2, s[52:55], s12 offen offset:2048 nt
buffer_load_dwordx4 v[132:135], v2, s[52:55], s12 offen offset:3072 nt
s_add_u32 s13, s13, 24576
s_min_u32 s12, s13, 2146435072
s_cmp_ge_u32 s80, 36
s_cbranch_scc1 L_nodma_2
s_mov_b32 m0, s15
s_nop 0
buffer_load_dwordx4 v2, s[60:63], s15 offen  lds
s_add_u32 s15, s15, 1024
L_nodma_2:
s_add_u32 s80, s80, 1
v_add_f32_dpp v32, v28, v28 row_ror:8 row_mask:0xf bank_mask:0x3
v_add_f32_dpp v33, v29, v29 row_ror:8 row_mask:0xf bank_mask:0x3
v_add_f32_dpp v32, v30, v30 row_ror:8 row_mask:0xf bank_mask:0xc
v_add_f32_dpp v33, v31, v31 row_ror:8 row_mask:0xf bank_mask:0xc
s_nop 0
v_add_f32_dpp v34, v32, v32 row_half_mirror row_mask:0xf bank_mask:0x5
v_add_f32_dpp v34, v33, v33 row_half_mirror row_mask:0xf bank_mask:0xa
s_nop 1
v_add_f32_dpp v34, v34, v34 quad_perm:[1,0,3,2] row_mask:0xf bank_mask:0xf
s_nop 1
v_add_f32_dpp v34, v34, v34 quad_perm:[2,3,0,1] row_mask:0xf bank_mask:0xf
v_cndmask_b32 v86, v86, v34, s[72:73]
s_waitcnt vmcnt(28)
v_dot2_f32_bf16 v28, v136, v24, 0
v_dot2_f32_bf16 v29, v140, v24, 0
v_dot2_f32_bf16 v30, v144, v24, 0
v_dot2_f32_bf16 v31, v148, v24, 0
v_dot2_f32_bf16 v28, v137, v25, v28
v_dot2_f32_bf16 v29, v141, v25, v29
v_dot2_f32_bf16 v30, v145, v25, v30
v_dot2_f32_bf16 v31, v149, v25, v31
v_dot2_f32_bf16 v28, v138, v26, v28
v_dot2_f32_bf16 v29, v142, v26, v29
v_dot2_f32_bf16 v30, v146, v26, v30
v_dot2_f32_bf16 v31, v150, v26, v31
v_dot2_f32_bf16 v28, v139, v27, v28
v_dot2_f32_bf16 v29, v143, v27, v29
v_dot2_f32_bf16 v30, v147, v27, v30
v_dot2_f32_bf16 v31, v151, v27, v31
buffer_load_dwordx4 v[136:139], v2, s[52:55], s12 offen offset:0 nt
buffer_load_dwordx4 v[140:143], v2, s[52:55], s12 offen offset:1024 nt
buffer_load_dwordx4 v[144:147], v2, s[52:55], s12 offen offset:2048 nt
buffer_load_dwordx4 v[148:151], v2, s[52:55], s12 offen offset:3072 nt
s_add_u32 s13, s13, 24576
s_min_u32 s12, s13, 2146435072
s_cmp_ge_u32 s80, 36
s_cbranch_scc1 L_nodma_3
s_mov_b32 m0, s15
s_nop 0
buffer_load_dwordx4 v2, s[60:63], s15 offen  lds
s_add_u32 s15, s15, 1024
L_nodma_3:
s_add_u32 s80, s80, 1
v_add_f32_dpp v32, v28, v28 row_ror:8 row_mask:0xf bank_mask:0x3
v_add_f32_dpp v33, v29, v29 row_ror:8 row_mask:0xf bank_mask:0x3
v_add_f32_dpp v32, v30, v30 row_ror:8 row_mask:0xf bank_mask:0xc
v_add_f32_dpp v33, v31, v31 row_ror:8 row_mask:0xf bank_mask:0xc
s_nop 0
v_add_f32_dpp v34, v32, v32 row_half_mirror row_mask:0xf bank_mask:0x5
v_add_f32_dpp v34, v33, v33 row_half_mirror row_mask:0xf bank_mask:0xa
s_nop 1
v_add_f32_dpp v34, v34, v34 quad_perm:[1,0,3,2] row_mask:0xf bank_mask:0xf
s_nop 1
v_add_f32_dpp v34, v34, v34 quad_perm:[2,3,0,1] row_mask:0xf bank_mask:0xf
v_cndmask_b32 v86, v86, v34, s[74:75]
s_waitcnt vmcnt(28)
v_dot2_f32_bf16 v28, v152, v24, 0
v_dot2_f32_bf16 v29, v156, v24, 0
v_dot2_f32_bf16 v30, v160, v24, 0
v_dot2_f32_bf16 v31, v164, v24, 0
v_dot2_f32_bf16 v28, v153, v25, v28
v_dot2_f32_bf16 v29, v157, v25, v29
v_dot2_f32_bf16 v30, v161, v25, v30
v_dot2_f32_bf16 v31, v165, v25, v31
v_dot2_f32_bf16 v28, v154, v26, v28
v_dot2_f32_bf16 v29, v158, v26, v29
v_dot2_f32_bf16 v30, v162, v26, v30
v_dot2_f32_bf16 v31, v166, v26, v31
v_dot2_f32_bf16 v28, v155, v27, v28
v_dot2_f32_bf16 v29, v159, v27, v29
v_dot2_f32_bf16 v30, v163, v27, v30
v_dot2_f32_bf16 v31, v167, v27, v31
buffer_load_dwordx4 v[152:155], v2, s[52:55], s12 offen offset:0 nt
buffer_load_dwordx4 v[156:159], v2, s[52:55], s12 offen offset:1024 nt
buffer_load_dwordx4 v[160:163], v2, s[52:55], s12 offen offset:2048 nt
buffer_load_dwordx4 v[164:167], v2, s[52:55], s12 offen offset:3072 nt
s_add_u32 s13, s13, 24576
s_min_u32 s12, s13, 2146435072
s_cmp_ge_u32 s80, 36
s_cbranch_scc1 L_nodma_4
s_mov_b32 m0, s15
s_nop 0
buffer_load_dwordx4 v2, s[60:63], s15 offen  lds
s_add_u32 s15, s15, 1024
L_nodma_4:
s_add_u32 s80, s80, 1
v_add_f32_dpp v32, v28, v28 row_ror:8 row_mask:0xf bank_mask:0x3
v_add_f32_dpp v33, v29, v29 row_ror:8 row_mask:0xf bank_mask:0x3
v_add_f32_dpp v32, v30, v30 row_ror:8 row_mask:0xf bank_mask:0xc
v_add_f32_dpp v33, v31, v31 row_ror:8 row_mask:0xf bank_mask:0xc
s_nop 0
v_add_f32_dpp v34, v32, v32 row_half_mirror row_mask:0xf bank_mask:0x5
v_add_f32_dpp v34, v33, v33 row_half_mirror row_mask:0xf bank_mask:0xa
s_nop 1
v_add_f32_dpp v34, v34, v34 quad_perm:[1,0,3,2] row_mask:0xf bank_mask:0xf
s_nop 1
v_add_f32_dpp v34, v34, v34 quad_perm:[2,3,0,1] row_mask:0xf bank_mask:0xf
v_cndmask_b32 v86, v86, v34, s[76:77]
s_waitcnt vmcnt(28)
v_dot2_f32_bf16 v28, v168, v24, 0
v_dot2_f32_bf16 v29, v172, v24, 0
v_dot2_f32_bf16 v30, v176, v24, 0
v_dot2_f32_bf16 v31, v180, v24, 0
v_dot2_f32_bf16 v28, v169, v25, v28
v_dot2_f32_bf16 v29, v173, v25, v29
v_dot2_f32_bf16 v30, v177, v25, v30
v_dot2_f32_bf16 v31, v181, v25, v31
v_dot2_f32_bf16 v28, v170, v26, v28
v_dot2_f32_bf16 v29, v174, v26, v29
v_dot2_f32_bf16 v30, v178, v26, v30
v_dot2_f32_bf16 v31, v182, v26, v31
v_dot2_f32_bf16 v28, v171, v27, v28
v_dot2_f32_bf16 v29, v175, v27, v29
v_dot2_f32_bf16 v30, v179, v27, v30
v_dot2_f32_bf16 v31, v183, v27, v31
buffer_load_dwordx4 v[168:171], v2, s[52:55], s12 offen offset:0 nt
buffer_load_dwordx4 v[172:175], v2, s[52:55], s12 offen offset:1024 nt
buffer_load_dwordx4 v[176:179], v2, s[52:55], s12 offen offset:2048 nt
buffer_load_dwordx4 v[180:183], v2, s[52:55], s12 offen offset:3072 nt
s_add_u32 s13, s13, 24576
s_min_u32 s12, s13, 2146435072
v_add_f32_dpp v32, v28, v28 row_ror:8 row_mask:0xf bank_mask:0x3
v_add_f32_dpp v33, v29, v29 row_ror:8 row_mask:0xf bank_mask:0x3
v_add_f32_dpp v32, v30, v30 row_ror:8 row_mask:0xf bank_mask:0xc
v_add_f32_dpp v33, v31, v31 row_ror:8 row_mask:0xf bank_mask:0xc
s_nop 0
v_add_f32_dpp v34, v32, v32 row_half_mirror row_mask:0xf bank_mask:0x5
v_add_f32_dpp v34, v33, v33 row_half_mirror row_mask:0xf bank_mask:0xa
s_nop 1
v_add_f32_dpp v34, v34, v34 quad_perm:[1,0,3,2] row_mask:0xf bank_mask:0xf
s_nop 1
v_add_f32_dpp v34, v34, v34 quad_perm:[2,3,0,1] row_mask:0xf bank_mask:0xf
v_cndmask_b32 v86, v86, v34, s[78:79]
s_add_u32 s81, s81, 1
s_cmp_eq_u32 s81, 11
s_cbranch_scc1 A_mid
v_mov_b32 v76, v77
v_mov_b32 v77, v78
v_mov_b32 v78, v79
v_mov_b32 v79, v80
v_mov_b32 v80, v81
v_mov_b32 v81, v82
v_mov_b32 v82, v83
v_mov_b32 v83, v84
v_mov_b32 v84, v85
v_mov_b32 v85, v86
s_lshr_b64 s[72:73], s[76:77], 2
s_lshr_b64 s[74:75], s[76:77], 1
s_cmp_eq_u32 s81, 9
s_cselect_b32 s52, s56, s52
s_cselect_b32 s53, s57, s53
s_cselect_b32 s13, s14, s13
s_min_u32 s12, s13, 2146435072
s_waitcnt vmcnt(28)
v_dot2_f32_bf16 v28, v184, v24, 0
v_dot2_f32_bf16 v29, v188, v24, 0
v_dot2_f32_bf16 v30, v192, v24, 0
v_dot2_f32_bf16 v31, v196, v24, 0
v_dot2_f32_bf16 v28, v185, v25, v28
v_dot2_f32_bf16 v29, v189, v25, v29
v_dot2_f32_bf16 v30, v193, v25, v30
v_dot2_f32_bf16 v31, v197, v25, v31
v_dot2_f32_bf16 v28, v186, v26, v28
v_dot2_f32_bf16 v29, v190, v26, v29
v_dot2_f32_bf16 v30, v194, v26, v30
v_dot2_f32_bf16 v31, v198, v26, v31
v_dot2_f32_bf16 v28, v187, v27, v28
v_dot2_f32_bf16 v29, v191, v27, v29
v_dot2_f32_bf16 v30, v195, v27, v30
v_dot2_f32_bf16 v31, v199, v27, v31
buffer_load_dwordx4 v[184:187], v2, s[52:55], s12 offen offset:0 nt
buffer_load_dwordx4 v[188:191], v2, s[52:55], s12 offen offset:1024 nt
buffer_load_dwordx4 v[192:195], v2, s[52:55], s12 offen offset:2048 nt
buffer_load_dwordx4 v[196:199], v2, s[52:55], s12 offen offset:3072 nt
s_add_u32 s13, s13, 24576
s_min_u32 s12, s13, 2146435072
s_cmp_ge_u32 s80, 36
s_cbranch_scc1 L_nodma_5
s_mov_b32 m0, s15
s_nop 0
buffer_load_dwordx4 v2, s[60:63], s15 offen  lds
s_add_u32 s15, s15, 1024
L_nodma_5:
s_add_u32 s80, s80, 1
v_add_f32_dpp v32, v28, v28 row_ror:8 row_mask:0xf bank_mask:0x3
v_add_f32_dpp v33, v29, v29 row_ror:8 row_mask:0xf bank_mask:0x3
v_add_f32_dpp v32, v30, v30 row_ror:8 row_mask:0xf bank_mask:0xc
v_add_f32_dpp v33, v31, v31 row_ror:8 row_mask:0xf bank_mask:0xc
s_nop 0
v_add_f32_dpp v34, v32, v32 row_half_mirror row_mask:0xf bank_mask:0x5
v_add_f32_dpp v34, v33, v33 row_half_mirror row_mask:0xf bank_mask:0xa
s_nop 1
v_add_f32_dpp v34, v34, v34 quad_perm:[1,0,3,2] row_mask:0xf bank_mask:0xf
s_nop 1
v_add_f32_dpp v34, v34, v34 quad_perm:[2,3,0,1] row_mask:0xf bank_mask:0xf
v_cndmask_b32 v86, v86, v34, s[72:73]
s_waitcnt vmcnt(28)
v_dot2_f32_bf16 v28, v200, v24, 0
v_dot2_f32_bf16 v29, v204, v24, 0
v_dot2_f32_bf16 v30, v208, v24, 0
v_dot2_f32_bf16 v31, v212, v24, 0
v_dot2_f32_bf16 v28, v201, v25, v28
v_dot2_f32_bf16 v29, v205, v25, v29
v_dot2_f32_bf16 v30, v209, v25, v30
v_dot2_f32_bf16 v31, v213, v25, v31
v_dot2_f32_bf16 v28, v202, v26, v28
v_dot2_f32_bf16 v29, v206, v26, v29
v_dot2_f32_bf16 v30, v210, v26, v30
v_dot2_f32_bf16 v31, v214, v26, v31
v_dot2_f32_bf16 v28, v203, v27, v28
v_dot2_f32_bf16 v29, v207, v27, v29
v_dot2_f32_bf16 v30, v211, v27, v30
v_dot2_f32_bf16 v31, v215, v27, v31
buffer_load_dwordx4 v[200:203], v2, s[52:55], s12 offen offset:0 nt
buffer_load_dwordx4 v[204:207], v2, s[52:55], s12 offen offset:1024 nt
buffer_load_dwordx4 v[208:211], v2, s[52:55], s12 offen offset:2048 nt
buffer_load_dwordx4 v[212:215], v2, s[52:55], s12 offen offset:3072 nt
s_add_u32 s13, s13, 24576
s_min_u32 s12, s13, 2146435072
s_cmp_ge_u32 s80, 36
s_cbranch_scc1 L_nodma_6
s_mov_b32 m0, s15
s_nop 0
buffer_load_dwordx4 v2, s[60:63], s15 offen  lds
s_add_u32 s15, s15, 1024
L_nodma_6:
s_add_u32 s80, s80, 1
v_add_f32_dpp v32, v28, v28 row_ror:8 row_mask:0xf bank_mask:0x3
v_add_f32_dpp v33, v29, v29 row_ror:8 row_mask:0xf bank_mask:0x3
v_add_f32_dpp v32, v30, v30 row_ror:8 row_mask:0xf bank_mask:0xc
v_add_f32_dpp v33, v31, v31 row_ror:8 row_mask:0xf bank_mask:0xc
s_nop 0
v_add_f32_dpp v34, v32, v32 row_half_mirror row_mask:0xf bank_mask:0x5
v_add_f32_dpp v34, v33, v33 row_half_mirror row_mask:0xf bank_mask:0xa
s_nop 1
v_add_f32_dpp v34, v34, v34 quad_perm:[1,0,3,2] row_mask:0xf bank_mask:0xf
s_nop 1
v_add_f32_dpp v34, v34, v34 quad_perm:[2,3,0,1] row_mask:0xf bank_mask:0xf
v_cndmask_b32 v86, v86, v34, s[74:75]
s_waitcnt vmcnt(28)
v_dot2_f32_bf16 v28, v216, v24, 0
v_dot2_f32_bf16 v29, v220, v24, 0
v_dot2_f32_bf16 v30, v224, v24, 0
v_dot2_f32_bf16 v31, v228, v24, 0
v_dot2_f32_bf16 v28, v217, v25, v28
v_dot2_f32_bf16 v29, v221, v25, v29
v_dot2_f32_bf16 v30, v225, v25, v30
v_dot2_f32_bf16 v31, v229, v25, v31
v_dot2_f32_bf16 v28, v218, v26, v28
v_dot2_f32_bf16 v29, v222, v26, v29
v_dot2_f32_bf16 v30, v226, v26, v30
v_dot2_f32_bf16 v31, v230, v26, v31
v_dot2_f32_bf16 v28, v219, v27, v28
v_dot2_f32_bf16 v29, v223, v27, v29
v_dot2_f32_bf16 v30, v227, v27, v30
v_dot2_f32_bf16 v31, v231, v27, v31
buffer_load_dwordx4 v[216:219], v2, s[52:55], s12 offen offset:0 nt
buffer_load_dwordx4 v[220:223], v2, s[52:55], s12 offen offset:1024 nt
buffer_load_dwordx4 v[224:227], v2, s[52:55], s12 offen offset:2048 nt
buffer_load_dwordx4 v[228:231], v2, s[52:55], s12 offen offset:3072 nt
s_add_u32 s13, s13, 24576
s_min_u32 s12, s13, 2146435072
s_cmp_ge_u32 s80, 36
s_cbranch_scc1 L_nodma_7
s_mov_b32 m0, s15
s_nop 0
buffer_load_dwordx4 v2, s[60:63], s15 offen  lds
s_add_u32 s15, s15, 1024
L_nodma_7:
s_add_u32 s80, s80, 1
v_add_f32_dpp v32, v28, v28 row_ror:8 row_mask:0xf bank_mask:0x3
v_add_f32_dpp v33, v29, v29 row_ror:8 row_mask:0xf bank_mask:0x3
v_add_f32_dpp v32, v30, v30 row_ror:8 row_mask:0xf bank_mask:0xc
v_add_f32_dpp v33, v31, v31 row_ror:8 row_mask:0xf bank_mask:0xc
s_nop 0
v_add_f32_dpp v34, v32, v32 row_half_mirror row_mask:0xf bank_mask:0x5
v_add_f32_dpp v34, v33, v33 row_half_mirror row_mask:0xf bank_mask:0xa
s_nop 1
v_add_f32_dpp v34, v34, v34 quad_perm:[1,0,3,2] row_mask:0xf bank_mask:0xf
s_nop 1
v_add_f32_dpp v34, v34, v34 quad_perm:[2,3,0,1] row_mask:0xf bank_mask:0xf
v_cndmask_b32 v86, v86, v34, s[76:77]
s_waitcnt vmcnt(28)
v_dot2_f32_bf16 v28, v232, v24, 0
v_dot2_f32_bf16 v29, v236, v24, 0
v_dot2_f32_bf16 v30, v240, v24, 0
v_dot2_f32_bf16 v31, v244, v24, 0
v_dot2_f32_bf16 v28, v233, v25, v28
v_dot2_f32_bf16 v29, v237, v25, v29
v_dot2_f32_bf16 v30, v241, v25, v30
v_dot2_f32_bf16 v31, v245, v25, v31
v_dot2_f32_bf16 v28, v234, v26, v28
v_dot2_f32_bf16 v29, v238, v26, v29
v_dot2_f32_bf16 v30, v242, v26, v30
v_dot2_f32_bf16 v31, v246, v26, v31
v_dot2_f32_bf16 v28, v235, v27, v28
v_dot2_f32_bf16 v29, v239, v27, v29
v_dot2_f32_bf16 v30, v243, v27, v30
v_dot2_f32_bf16 v31, v247, v27, v31
buffer_load_dwordx4 v[232:235], v2, s[52:55], s12 offen offset:0 nt
buffer_load_dwordx4 v[236:239], v2, s[52:55], s12 offen offset:1024 nt
buffer_load_dwordx4 v[240:243], v2, s[52:55], s12 offen offset:2048 nt
buffer_load_dwordx4 v[244:247], v2, s[52:55], s12 offen offset:3072 nt
s_add_u32 s13, s13, 24576
s_min_u32 s12, s13, 2146435072
v_add_f32_dpp v32, v28, v28 row_ror:8 row_mask:0xf bank_mask:0x3
v_add_f32_dpp v33, v29, v29 row_ror:8 row_mask:0xf bank_mask:0x3
v_add_f32_dpp v32, v30, v30 row_ror:8 row_mask:0xf bank_mask:0xc
v_add_f32_dpp v33, v31, v31 row_ror:8 row_mask:0xf bank_mask:0xc
s_nop 0
v_add_f32_dpp v34, v32, v32 row_half_mirror row_mask:0xf bank_mask:0x5
v_add_f32_dpp v34, v33, v33 row_half_mirror row_mask:0xf bank_mask:0xa
s_nop 1
v_add_f32_dpp v34, v34, v34 quad_perm:[1,0,3,2] row_mask:0xf bank_mask:0xf
s_nop 1
v_add_f32_dpp v34, v34, v34 quad_perm:[2,3,0,1] row_mask:0xf bank_mask:0xf
v_cndmask_b32 v86, v86, v34, s[78:79]
s_add_u32 s81, s81, 1
v_mov_b32 v76, v77
v_mov_b32 v77, v78
v_mov_b32 v78, v79
v_mov_b32 v79, v80
v_mov_b32 v80, v81
v_mov_b32 v81, v82
v_mov_b32 v82, v83
v_mov_b32 v83, v84
v_mov_b32 v84, v85
v_mov_b32 v85, v86
s_branch K_loop
A_mid:
v_max3_f32 v35, v76, v77, v78
v_max3_f32 v35, v35, v79, v80
v_max3_f32 v35, v35, v81, v82
v_max3_f32 v35, v35, v83, v84
v_max3_f32 v35, v35, v85, v86
s_nop 1
v_max_f32_dpp v35, v35, v35 row_ror:8 row_mask:0xf bank_mask:0xf
s_nop 1
v_max_f32_dpp v35, v35, v35 row_ror:4 row_mask:0xf bank_mask:0xf
s_nop 1
v_max_f32_dpp v35, v35, v35 row_ror:2 row_mask:0xf bank_mask:0xf
s_nop 1
v_max_f32_dpp v35, v35, v35 row_ror:1 row_mask:0xf bank_mask:0xf
v_mov_b32 v36, v35
s_nop 1
v_permlane16_swap_b32 v35, v36
v_max_f32 v35, v35, v36
v_mov_b32 v36, v35
s_nop 1
v_permlane32_swap_b32 v35, v36
v_max_f32 v35, v35, v36
v_mul_f32 v32, v35, v7
v_fma_f32 v76, v76, v7, -v32
v_fma_f32 v77, v77, v7, -v32
v_fma_f32 v78, v78, v7, -v32
v_fma_f32 v79, v79, v7, -v32
v_fma_f32 v80, v80, v7, -v32
v_fma_f32 v81, v81, v7, -v32
v_fma_f32 v82, v82, v7, -v32
v_fma_f32 v83, v83, v7, -v32
v_fma_f32 v84, v84, v7, -v32
v_fma_f32 v85, v85, v7, -v32
v_fma_f32 v86, v86, v7, -v32
v_exp_f32 v76, v76
v_exp_f32 v77, v77
v_exp_f32 v78, v78
v_exp_f32 v79, v79
v_exp_f32 v80, v80
v_exp_f32 v81, v81
v_exp_f32 v82, v82
v_exp_f32 v83, v83
v_exp_f32 v84, v84
v_exp_f32 v85, v85
v_exp_f32 v86, v86
v_add_f32 v35, v76, v77
v_add_f32 v35, v35, v78
v_add_f32 v35, v35, v79
v_add_f32 v35, v35, v80
v_add_f32 v35, v35, v81
v_add_f32 v35, v35, v82
v_add_f32 v35, v35, v83
v_add_f32 v35, v35, v84
v_add_f32 v35, v35, v85
v_add_f32 v35, v35, v86
v_cvt_pk_bf16_f32 v76, v76, v76
v_cvt_pk_bf16_f32 v77, v77, v77
v_cvt_pk_bf16_f32 v78, v78, v78
v_cvt_pk_bf16_f32 v79, v79, v79
v_cvt_pk_bf16_f32 v80, v80, v80
v_cvt_pk_bf16_f32 v81, v81, v81
v_cvt_pk_bf16_f32 v82, v82, v82
v_cvt_pk_bf16_f32 v83, v83, v83
v_cvt_pk_bf16_f32 v84, v84, v84
v_cvt_pk_bf16_f32 v85, v85, v85
v_cvt_pk_bf16_f32 v86, v86, v86
v_add_f32_dpp v35, v35, v35 row_ror:8 row_mask:0xf bank_mask:0xf
s_nop 1
v_add_f32_dpp v35, v35, v35 row_ror:4 row_mask:0xf bank_mask:0xf
s_nop 1
v_add_f32_dpp v35, v35, v35 row_ror:2 row_mask:0xf bank_mask:0xf
s_nop 1
v_add_f32_dpp v35, v35, v35 row_ror:1 row_mask:0xf bank_mask:0xf
v_mov_b32 v36, v35
s_nop 1
v_permlane16_swap_b32 v35, v36
v_add_f32 v35, v35, v36
v_mov_b32 v36, v35
s_nop 1
v_permlane32_swap_b32 v35, v36
v_add_f32 v35, v35, v36
v_min_u32 v32, -2, v32
v_min_u32 v33, -2, v35
s_mov_b32 s7, 400000
L_ens_8:
v_readfirstlane_b32 s6, v96
s_cmp_ge_u32 s6, 128
s_cbranch_scc1 L_ensd_9
s_sleep 16
buffer_load_dword v96, off, s[68:71], 0 offset:0 sc1
s_waitcnt vmcnt(0)
s_sub_u32 s7, s7, 1
s_cmp_lg_u32 s7, 0
s_cbranch_scc1 L_ens_8
L_ensd_9:
s_lshl_b32 s6, s11, 3
s_add_u32 s6, s6, s82
s_mov_b64 exec, 1
buffer_store_dwordx2 v[32:33], off, s[64:67], s6 sc1
s_mov_b64 exec, -1
s_branch V_entry
V_loop:
s_cmp_eq_u32 s81, 16
s_cbranch_scc1 A_ev1
A_ev1_ret:
s_nop 1
v_and_b32_dpp v60, v76, v8 row_newbcast:0 row_mask:0xf bank_mask:0xf
v_and_b32_dpp v61, v76, v9 row_newbcast:0 row_mask:0xf bank_mask:0xf
v_and_b32_dpp v62, v76, v10 row_newbcast:0 row_mask:0xf bank_mask:0xf
v_and_b32_dpp v63, v76, v11 row_newbcast:0 row_mask:0xf bank_mask:0xf
v_and_b32_dpp v64, v76, v8 row_newbcast:4 row_mask:0xf bank_mask:0xf
v_and_b32_dpp v65, v76, v9 row_newbcast:4 row_mask:0xf bank_mask:0xf
v_and_b32_dpp v66, v76, v10 row_newbcast:4 row_mask:0xf bank_mask:0xf
v_and_b32_dpp v67, v76, v11 row_newbcast:4 row_mask:0xf bank_mask:0xf
v_and_b32_dpp v68, v76, v8 row_newbcast:8 row_mask:0xf bank_mask:0xf
v_and_b32_dpp v69, v76, v9 row_newbcast:8 row_mask:0xf bank_mask:0xf
v_and_b32_dpp v70, v76, v10 row_newbcast:8 row_mask:0xf bank_mask:0xf
v_and_b32_dpp v71, v76, v11 row_newbcast:8 row_mask:0xf bank_mask:0xf
v_and_b32_dpp v72, v76, v8 row_newbcast:12 row_mask:0xf bank_mask:0xf
v_and_b32_dpp v73, v76, v9 row_newbcast:12 row_mask:0xf bank_mask:0xf
v_and_b32_dpp v74, v76, v10 row_newbcast:12 row_mask:0xf bank_mask:0xf
v_and_b32_dpp v75, v76, v11 row_newbcast:12 row_mask:0xf bank_mask:0xf
s_waitcnt vmcnt(28)
v_mfma_f32_16x16x32_bf16 v[20:23], v[60:63], v[120:123], v[20:23]
v_mfma_f32_16x16x32_bf16 v[20:23], v[64:67], v[124:127], v[20:23]
v_mfma_f32_16x16x32_bf16 v[20:23], v[68:71], v[128:131], v[20:23]
v_mfma_f32_16x16x32_bf16 v[20:23], v[72:75], v[132:135], v[20:23]
buffer_load_dwordx4 v[120:123], v2, s[52:55], s12 offen offset:0 nt
buffer_load_dwordx4 v[124:127], v2, s[52:55], s12 offen offset:1024 nt
buffer_load_dwordx4 v[128:131], v2, s[52:55], s12 offen offset:2048 nt
buffer_load_dwordx4 v[132:135], v2, s[52:55], s12 offen offset:3072 nt
s_add_u32 s13, s13, 24576
s_min_u32 s12, s13, 2146435072
s_cmp_ge_u32 s80, 36
s_cbranch_scc1 L_nodma_10
s_mov_b32 m0, s15
s_nop 0
buffer_load_dwordx4 v2, s[60:63], s15 offen  lds
s_add_u32 s15, s15, 1024
L_nodma_10:
s_add_u32 s80, s80, 1
v_and_b32_dpp v60, v76, v8 row_newbcast:1 row_mask:0xf bank_mask:0xf
v_and_b32_dpp v61, v76, v9 row_newbcast:1 row_mask:0xf bank_mask:0xf
v_and_b32_dpp v62, v76, v10 row_newbcast:1 row_mask:0xf bank_mask:0xf
v_and_b32_dpp v63, v76, v11 row_newbcast:1 row_mask:0xf bank_mask:0xf
v_and_b32_dpp v64, v76, v8 row_newbcast:5 row_mask:0xf bank_mask:0xf
v_and_b32_dpp v65, v76, v9 row_newbcast:5 row_mask:0xf bank_mask:0xf
v_and_b32_dpp v66, v76, v10 row_newbcast:5 row_mask:0xf bank_mask:0xf
v_and_b32_dpp v67, v76, v11 row_newbcast:5 row_mask:0xf bank_mask:0xf
v_and_b32_dpp v68, v76, v8 row_newbcast:9 row_mask:0xf bank_mask:0xf
v_and_b32_dpp v69, v76, v9 row_newbcast:9 row_mask:0xf bank_mask:0xf
v_and_b32_dpp v70, v76, v10 row_newbcast:9 row_mask:0xf bank_mask:0xf
v_and_b32_dpp v71, v76, v11 row_newbcast:9 row_mask:0xf bank_mask:0xf
v_and_b32_dpp v72, v76, v8 row_newbcast:13 row_mask:0xf bank_mask:0xf
v_and_b32_dpp v73, v76, v9 row_newbcast:13 row_mask:0xf bank_mask:0xf
v_and_b32_dpp v74, v76, v10 row_newbcast:13 row_mask:0xf bank_mask:0xf
v_and_b32_dpp v75, v76, v11 row_newbcast:13 row_mask:0xf bank_mask:0xf
s_waitcnt vmcnt(28)
v_mfma_f32_16x16x32_bf16 v[20:23], v[60:63], v[136:139], v[20:23]
v_mfma_f32_16x16x32_bf16 v[20:23], v[64:67], v[140:143], v[20:23]
v_mfma_f32_16x16x32_bf16 v[20:23], v[68:71], v[144:147], v[20:23]
v_mfma_f32_16x16x32_bf16 v[20:23], v[72:75], v[148:151], v[20:23]
buffer_load_dwordx4 v[136:139], v2, s[52:55], s12 offen offset:0 nt
buffer_load_dwordx4 v[140:143], v2, s[52:55], s12 offen offset:1024 nt
buffer_load_dwordx4 v[144:147], v2, s[52:55], s12 offen offset:2048 nt
buffer_load_dwordx4 v[148:151], v2, s[52:55], s12 offen offset:3072 nt
s_add_u32 s13, s13, 24576
s_min_u32 s12, s13, 2146435072
s_cmp_ge_u32 s80, 36
s_cbranch_scc1 L_nodma_11
s_mov_b32 m0, s15
s_nop 0
buffer_load_dwordx4 v2, s[60:63], s15 offen  lds
s_add_u32 s15, s15, 1024
L_nodma_11:
s_add_u32 s80, s80, 1
v_and_b32_dpp v60, v76, v8 row_newbcast:2 row_mask:0xf bank_mask:0xf
v_and_b32_dpp v61, v76, v9 row_newbcast:2 row_mask:0xf bank_mask:0xf
v_and_b32_dpp v62, v76, v10 row_newbcast:2 row_mask:0xf bank_mask:0xf
v_and_b32_dpp v63, v76, v11 row_newbcast:2 row_mask:0xf bank_mask:0xf
v_and_b32_dpp v64, v76, v8 row_newbcast:6 row_mask:0xf bank_mask:0xf
v_and_b32_dpp v65, v76, v9 row_newbcast:6 row_mask:0xf bank_mask:0xf
v_and_b32_dpp v66, v76, v10 row_newbcast:6 row_mask:0xf bank_mask:0xf
v_and_b32_dpp v67, v76, v11 row_newbcast:6 row_mask:0xf bank_mask:0xf
v_and_b32_dpp v68, v76, v8 row_newbcast:10 row_mask:0xf bank_mask:0xf
v_and_b32_dpp v69, v76, v9 row_newbcast:10 row_mask:0xf bank_mask:0xf
v_and_b32_dpp v70, v76, v10 row_newbcast:10 row_mask:0xf bank_mask:0xf
v_and_b32_dpp v71, v76, v11 row_newbcast:10 row_mask:0xf bank_mask:0xf
v_and_b32_dpp v72, v76, v8 row_newbcast:14 row_mask:0xf bank_mask:0xf
v_and_b32_dpp v73, v76, v9 row_newbcast:14 row_mask:0xf bank_mask:0xf
v_and_b32_dpp v74, v76, v10 row_newbcast:14 row_mask:0xf bank_mask:0xf
v_and_b32_dpp v75, v76, v11 row_newbcast:14 row_mask:0xf bank_mask:0xf
s_waitcnt vmcnt(28)
v_mfma_f32_16x16x32_bf16 v[20:23], v[60:63], v[152:155], v[20:23]
v_mfma_f32_16x16x32_bf16 v[20:23], v[64:67], v[156:159], v[20:23]
v_mfma_f32_16x16x32_bf16 v[20:23], v[68:71], v[160:163], v[20:23]
v_mfma_f32_16x16x32_bf16 v[20:23], v[72:75], v[164:167], v[20:23]
buffer_load_dwordx4 v[152:155], v2, s[52:55], s12 offen offset:0 nt
buffer_load_dwordx4 v[156:159], v2, s[52:55], s12 offen offset:1024 nt
buffer_load_dwordx4 v[160:163], v2, s[52:55], s12 offen offset:2048 nt
buffer_load_dwordx4 v[164:167], v2, s[52:55], s12 offen offset:3072 nt
s_add_u32 s13, s13, 24576
s_min_u32 s12, s13, 2146435072
s_cmp_ge_u32 s80, 36
s_cbranch_scc1 L_nodma_12
s_mov_b32 m0, s15
s_nop 0
buffer_load_dwordx4 v2, s[60:63], s15 offen  lds
s_add_u32 s15, s15, 1024
L_nodma_12:
s_add_u32 s80, s80, 1
v_and_b32_dpp v60, v76, v8 row_newbcast:3 row_mask:0xf bank_mask:0xf
v_and_b32_dpp v61, v76, v9 row_newbcast:3 row_mask:0xf bank_mask:0xf
v_and_b32_dpp v62, v76, v10 row_newbcast:3 row_mask:0xf bank_mask:0xf
v_and_b32_dpp v63, v76, v11 row_newbcast:3 row_mask:0xf bank_mask:0xf
v_and_b32_dpp v64, v76, v8 row_newbcast:7 row_mask:0xf bank_mask:0xf
v_and_b32_dpp v65, v76, v9 row_newbcast:7 row_mask:0xf bank_mask:0xf
v_and_b32_dpp v66, v76, v10 row_newbcast:7 row_mask:0xf bank_mask:0xf
v_and_b32_dpp v67, v76, v11 row_newbcast:7 row_mask:0xf bank_mask:0xf
v_and_b32_dpp v68, v76, v8 row_newbcast:11 row_mask:0xf bank_mask:0xf
v_and_b32_dpp v69, v76, v9 row_newbcast:11 row_mask:0xf bank_mask:0xf
v_and_b32_dpp v70, v76, v10 row_newbcast:11 row_mask:0xf bank_mask:0xf
v_and_b32_dpp v71, v76, v11 row_newbcast:11 row_mask:0xf bank_mask:0xf
v_and_b32_dpp v72, v76, v8 row_newbcast:15 row_mask:0xf bank_mask:0xf
v_and_b32_dpp v73, v76, v9 row_newbcast:15 row_mask:0xf bank_mask:0xf
v_and_b32_dpp v74, v76, v10 row_newbcast:15 row_mask:0xf bank_mask:0xf
v_and_b32_dpp v75, v76, v11 row_newbcast:15 row_mask:0xf bank_mask:0xf
s_waitcnt vmcnt(28)
v_mfma_f32_16x16x32_bf16 v[20:23], v[60:63], v[168:171], v[20:23]
v_mfma_f32_16x16x32_bf16 v[20:23], v[64:67], v[172:175], v[20:23]
v_mfma_f32_16x16x32_bf16 v[20:23], v[68:71], v[176:179], v[20:23]
v_mfma_f32_16x16x32_bf16 v[20:23], v[72:75], v[180:183], v[20:23]
s_add_u32 s81, s81, 1
buffer_load_dwordx4 v[168:171], v2, s[52:55], s12 offen offset:0 nt
buffer_load_dwordx4 v[172:175], v2, s[52:55], s12 offen offset:1024 nt
buffer_load_dwordx4 v[176:179], v2, s[52:55], s12 offen offset:2048 nt
buffer_load_dwordx4 v[180:183], v2, s[52:55], s12 offen offset:3072 nt
s_add_u32 s13, s13, 24576
s_min_u32 s12, s13, 2146435072
v_mov_b32 v76, v77
v_mov_b32 v77, v78
v_mov_b32 v78, v79
v_mov_b32 v79, v80
v_mov_b32 v80, v81
v_mov_b32 v81, v82
v_mov_b32 v82, v83
v_mov_b32 v83, v84
v_mov_b32 v84, v85
v_mov_b32 v85, v86
V_entry:
s_cmp_lg_u32 s81, 19
s_cbranch_scc1 L_nost_13
buffer_load_dwordx4 v[40:43], off, s[64:67], s82 offset:0 sc1
buffer_load_dwordx4 v[44:47], off, s[64:67], s82 offset:16 sc1
buffer_load_dwordx4 v[48:51], off, s[64:67], s82 offset:32 sc1
L_nost_13:
s_cmp_eq_u32 s81, 21
s_cbranch_scc1 A_ev2
A_ev2_ret:
s_nop 1
v_and_b32_dpp v60, v76, v8 row_newbcast:0 row_mask:0xf bank_mask:0xf
v_and_b32_dpp v61, v76, v9 row_newbcast:0 row_mask:0xf bank_mask:0xf
v_and_b32_dpp v62, v76, v10 row_newbcast:0 row_mask:0xf bank_mask:0xf
v_and_b32_dpp v63, v76, v11 row_newbcast:0 row_mask:0xf bank_mask:0xf
v_and_b32_dpp v64, v76, v8 row_newbcast:4 row_mask:0xf bank_mask:0xf
v_and_b32_dpp v65, v76, v9 row_newbcast:4 row_mask:0xf bank_mask:0xf
v_and_b32_dpp v66, v76, v10 row_newbcast:4 row_mask:0xf bank_mask:0xf
v_and_b32_dpp v67, v76, v11 row_newbcast:4 row_mask:0xf bank_mask:0xf
v_and_b32_dpp v68, v76, v8 row_newbcast:8 row_mask:0xf bank_mask:0xf
v_and_b32_dpp v69, v76, v9 row_newbcast:8 row_mask:0xf bank_mask:0xf
v_and_b32_dpp v70, v76, v10 row_newbcast:8 row_mask:0xf bank_mask:0xf
v_and_b32_dpp v71, v76, v11 row_newbcast:8 row_mask:0xf bank_mask:0xf
v_and_b32_dpp v72, v76, v8 row_newbcast:12 row_mask:0xf bank_mask:0xf
v_and_b32_dpp v73, v76, v9 row_newbcast:12 row_mask:0xf bank_mask:0xf
v_and_b32_dpp v74, v76, v10 row_newbcast:12 row_mask:0xf bank_mask:0xf
v_and_b32_dpp v75, v76, v11 row_newbcast:12 row_mask:0xf bank_mask:0xf
s_waitcnt vmcnt(28)
v_mfma_f32_16x16x32_bf16 v[20:23], v[60:63], v[184:187], v[20:23]
v_mfma_f32_16x16x32_bf16 v[20:23], v[64:67], v[188:191], v[20:23]
v_mfma_f32_16x16x32_bf16 v[20:23], v[68:71], v[192:195], v[20:23]
v_mfma_f32_16x16x32_bf16 v[20:23], v[72:75], v[196:199], v[20:23]
buffer_load_dwordx4 v[184:187], v2, s[52:55], s12 offen offset:0 nt
buffer_load_dwordx4 v[188:191], v2, s[52:55], s12 offen offset:1024 nt
buffer_load_dwordx4 v[192:195], v2, s[52:55], s12 offen offset:2048 nt
buffer_load_dwordx4 v[196:199], v2, s[52:55], s12 offen offset:3072 nt
s_add_u32 s13, s13, 24576
s_min_u32 s12, s13, 2146435072
s_cmp_ge_u32 s80, 36
s_cbranch_scc1 L_nodma_14
s_mov_b32 m0, s15
s_nop 0
buffer_load_dwordx4 v2, s[60:63], s15 offen  lds
s_add_u32 s15, s15, 1024
L_nodma_14:
s_add_u32 s80, s80, 1
v_and_b32_dpp v60, v76, v8 row_newbcast:1 row_mask:0xf bank_mask:0xf
v_and_b32_dpp v61, v76, v9 row_newbcast:1 row_mask:0xf bank_mask:0xf
v_and_b32_dpp v62, v76, v10 row_newbcast:1 row_mask:0xf bank_mask:0xf
v_and_b32_dpp v63, v76, v11 row_newbcast:1 row_mask:0xf bank_mask:0xf
v_and_b32_dpp v64, v76, v8 row_newbcast:5 row_mask:0xf bank_mask:0xf
v_and_b32_dpp v65, v76, v9 row_newbcast:5 row_mask:0xf bank_mask:0xf
v_and_b32_dpp v66, v76, v10 row_newbcast:5 row_mask:0xf bank_mask:0xf
v_and_b32_dpp v67, v76, v11 row_newbcast:5 row_mask:0xf bank_mask:0xf
v_and_b32_dpp v68, v76, v8 row_newbcast:9 row_mask:0xf bank_mask:0xf
v_and_b32_dpp v69, v76, v9 row_newbcast:9 row_mask:0xf bank_mask:0xf
v_and_b32_dpp v70, v76, v10 row_newbcast:9 row_mask:0xf bank_mask:0xf
v_and_b32_dpp v71, v76, v11 row_newbcast:9 row_mask:0xf bank_mask:0xf
v_and_b32_dpp v72, v76, v8 row_newbcast:13 row_mask:0xf bank_mask:0xf
v_and_b32_dpp v73, v76, v9 row_newbcast:13 row_mask:0xf bank_mask:0xf
v_and_b32_dpp v74, v76, v10 row_newbcast:13 row_mask:0xf bank_mask:0xf
v_and_b32_dpp v75, v76, v11 row_newbcast:13 row_mask:0xf bank_mask:0xf
s_waitcnt vmcnt(28)
v_mfma_f32_16x16x32_bf16 v[20:23], v[60:63], v[200:203], v[20:23]
v_mfma_f32_16x16x32_bf16 v[20:23], v[64:67], v[204:207], v[20:23]
v_mfma_f32_16x16x32_bf16 v[20:23], v[68:71], v[208:211], v[20:23]
v_mfma_f32_16x16x32_bf16 v[20:23], v[72:75], v[212:215], v[20:23]
buffer_load_dwordx4 v[200:203], v2, s[52:55], s12 offen offset:0 nt
buffer_load_dwordx4 v[204:207], v2, s[52:55], s12 offen offset:1024 nt
buffer_load_dwordx4 v[208:211], v2, s[52:55], s12 offen offset:2048 nt
buffer_load_dwordx4 v[212:215], v2, s[52:55], s12 offen offset:3072 nt
s_add_u32 s13, s13, 24576
s_min_u32 s12, s13, 2146435072
s_cmp_ge_u32 s80, 36
s_cbranch_scc1 L_nodma_15
s_mov_b32 m0, s15
s_nop 0
buffer_load_dwordx4 v2, s[60:63], s15 offen  lds
s_add_u32 s15, s15, 1024
L_nodma_15:
s_add_u32 s80, s80, 1
v_and_b32_dpp v60, v76, v8 row_newbcast:2 row_mask:0xf bank_mask:0xf
v_and_b32_dpp v61, v76, v9 row_newbcast:2 row_mask:0xf bank_mask:0xf
v_and_b32_dpp v62, v76, v10 row_newbcast:2 row_mask:0xf bank_mask:0xf
v_and_b32_dpp v63, v76, v11 row_newbcast:2 row_mask:0xf bank_mask:0xf
v_and_b32_dpp v64, v76, v8 row_newbcast:6 row_mask:0xf bank_mask:0xf
v_and_b32_dpp v65, v76, v9 row_newbcast:6 row_mask:0xf bank_mask:0xf
v_and_b32_dpp v66, v76, v10 row_newbcast:6 row_mask:0xf bank_mask:0xf
v_and_b32_dpp v67, v76, v11 row_newbcast:6 row_mask:0xf bank_mask:0xf
v_and_b32_dpp v68, v76, v8 row_newbcast:10 row_mask:0xf bank_mask:0xf
v_and_b32_dpp v69, v76, v9 row_newbcast:10 row_mask:0xf bank_mask:0xf
v_and_b32_dpp v70, v76, v10 row_newbcast:10 row_mask:0xf bank_mask:0xf
v_and_b32_dpp v71, v76, v11 row_newbcast:10 row_mask:0xf bank_mask:0xf
v_and_b32_dpp v72, v76, v8 row_newbcast:14 row_mask:0xf bank_mask:0xf
v_and_b32_dpp v73, v76, v9 row_newbcast:14 row_mask:0xf bank_mask:0xf
v_and_b32_dpp v74, v76, v10 row_newbcast:14 row_mask:0xf bank_mask:0xf
v_and_b32_dpp v75, v76, v11 row_newbcast:14 row_mask:0xf bank_mask:0xf
s_waitcnt vmcnt(28)
v_mfma_f32_16x16x32_bf16 v[20:23], v[60:63], v[216:219], v[20:23]
v_mfma_f32_16x16x32_bf16 v[20:23], v[64:67], v[220:223], v[20:23]
v_mfma_f32_16x16x32_bf16 v[20:23], v[68:71], v[224:227], v[20:23]
v_mfma_f32_16x16x32_bf16 v[20:23], v[72:75], v[228:231], v[20:23]
buffer_load_dwordx4 v[216:219], v2, s[52:55], s12 offen offset:0 nt
buffer_load_dwordx4 v[220:223], v2, s[52:55], s12 offen offset:1024 nt
buffer_load_dwordx4 v[224:227], v2, s[52:55], s12 offen offset:2048 nt
buffer_load_dwordx4 v[228:231], v2, s[52:55], s12 offen offset:3072 nt
s_add_u32 s13, s13, 24576
s_min_u32 s12, s13, 2146435072
s_cmp_ge_u32 s80, 36
s_cbranch_scc1 L_nodma_16
s_mov_b32 m0, s15
s_nop 0
buffer_load_dwordx4 v2, s[60:63], s15 offen  lds
s_add_u32 s15, s15, 1024
L_nodma_16:
s_add_u32 s80, s80, 1
v_and_b32_dpp v60, v76, v8 row_newbcast:3 row_mask:0xf bank_mask:0xf
v_and_b32_dpp v61, v76, v9 row_newbcast:3 row_mask:0xf bank_mask:0xf
v_and_b32_dpp v62, v76, v10 row_newbcast:3 row_mask:0xf bank_mask:0xf
v_and_b32_dpp v63, v76, v11 row_newbcast:3 row_mask:0xf bank_mask:0xf
v_and_b32_dpp v64, v76, v8 row_newbcast:7 row_mask:0xf bank_mask:0xf
v_and_b32_dpp v65, v76, v9 row_newbcast:7 row_mask:0xf bank_mask:0xf
v_and_b32_dpp v66, v76, v10 row_newbcast:7 row_mask:0xf bank_mask:0xf
v_and_b32_dpp v67, v76, v11 row_newbcast:7 row_mask:0xf bank_mask:0xf
v_and_b32_dpp v68, v76, v8 row_newbcast:11 row_mask:0xf bank_mask:0xf
v_and_b32_dpp v69, v76, v9 row_newbcast:11 row_mask:0xf bank_mask:0xf
v_and_b32_dpp v70, v76, v10 row_newbcast:11 row_mask:0xf bank_mask:0xf
v_and_b32_dpp v71, v76, v11 row_newbcast:11 row_mask:0xf bank_mask:0xf
v_and_b32_dpp v72, v76, v8 row_newbcast:15 row_mask:0xf bank_mask:0xf
v_and_b32_dpp v73, v76, v9 row_newbcast:15 row_mask:0xf bank_mask:0xf
v_and_b32_dpp v74, v76, v10 row_newbcast:15 row_mask:0xf bank_mask:0xf
v_and_b32_dpp v75, v76, v11 row_newbcast:15 row_mask:0xf bank_mask:0xf
s_waitcnt vmcnt(28)
v_mfma_f32_16x16x32_bf16 v[20:23], v[60:63], v[232:235], v[20:23]
v_mfma_f32_16x16x32_bf16 v[20:23], v[64:67], v[236:239], v[20:23]
v_mfma_f32_16x16x32_bf16 v[20:23], v[68:71], v[240:243], v[20:23]
v_mfma_f32_16x16x32_bf16 v[20:23], v[72:75], v[244:247], v[20:23]
s_add_u32 s81, s81, 1
s_cmp_eq_u32 s81, 22
s_cbranch_scc1 A_tail
buffer_load_dwordx4 v[232:235], v2, s[52:55], s12 offen offset:0 nt
buffer_load_dwordx4 v[236:239], v2, s[52:55], s12 offen offset:1024 nt
buffer_load_dwordx4 v[240:243], v2, s[52:55], s12 offen offset:2048 nt
buffer_load_dwordx4 v[244:247], v2, s[52:55], s12 offen offset:3072 nt
s_add_u32 s13, s13, 24576
s_min_u32 s12, s13, 2146435072
v_mov_b32 v76, v77
v_mov_b32 v77, v78
v_mov_b32 v78, v79
v_mov_b32 v79, v80
v_mov_b32 v80, v81
v_mov_b32 v81, v82
v_mov_b32 v82, v83
v_mov_b32 v83, v84
v_mov_b32 v84, v85
v_mov_b32 v85, v86
s_branch V_loop
A_ev1:
s_barrier
ds_read_b64_tr_b16 a[96:97], v88 offset:0
ds_read_b64_tr_b16 a[98:99], v88 offset:4608
ds_read_b64_tr_b16 a[100:101], v88 offset:36864
ds_read_b64_tr_b16 a[102:103], v88 offset:41472
ds_read_b64_tr_b16 a[104:105], v90 offset:0
ds_read_b64_tr_b16 a[106:107], v90 offset:4608
ds_read_b64_tr_b16 a[108:109], v90 offset:36864
ds_read_b64_tr_b16 a[110:111], v90 offset:41472
ds_read_b64_tr_b16 a[112:113], v88 offset:8
ds_read_b64_tr_b16 a[114:115], v88 offset:4616
ds_read_b64_tr_b16 a[116:117], v88 offset:36872
ds_read_b64_tr_b16 a[118:119], v88 offset:41480
ds_read_b64_tr_b16 a[120:121], v90 offset:8
ds_read_b64_tr_b16 a[122:123], v90 offset:4616
ds_read_b64_tr_b16 a[124:125], v90 offset:36872
ds_read_b64_tr_b16 a[126:127], v90 offset:41480
ds_read_b64_tr_b16 a[128:129], v88 offset:16
ds_read_b64_tr_b16 a[130:131], v88 offset:4624
ds_read_b64_tr_b16 a[132:133], v88 offset:36880
ds_read_b64_tr_b16 a[134:135], v88 offset:41488
ds_read_b64_tr_b16 a[136:137], v90 offset:16
ds_read_b64_tr_b16 a[138:139], v90 offset:4624
ds_read_b64_tr_b16 a[140:141], v90 offset:36880
ds_read_b64_tr_b16 a[142:143], v90 offset:41488
ds_read_b64_tr_b16 a[144:145], v88 offset:24
ds_read_b64_tr_b16 a[146:147], v88 offset:4632
ds_read_b64_tr_b16 a[148:149], v88 offset:36888
ds_read_b64_tr_b16 a[150:151], v88 offset:41496
ds_read_b64_tr_b16 a[152:153], v90 offset:24
ds_read_b64_tr_b16 a[154:155], v90 offset:4632
ds_read_b64_tr_b16 a[156:157], v90 offset:36888
ds_read_b64_tr_b16 a[158:159], v90 offset:41496
ds_read_b64_tr_b16 a[160:161], v88 offset:128
ds_read_b64_tr_b16 a[162:163], v88 offset:4736
ds_read_b64_tr_b16 a[164:165], v88 offset:36992
ds_read_b64_tr_b16 a[166:167], v88 offset:41600
ds_read_b64_tr_b16 a[168:169], v90 offset:128
ds_read_b64_tr_b16 a[170:171], v90 offset:4736
ds_read_b64_tr_b16 a[172:173], v90 offset:36992
ds_read_b64_tr_b16 a[174:175], v90 offset:41600
ds_read_b64_tr_b16 a[176:177], v88 offset:136
ds_read_b64_tr_b16 a[178:179], v88 offset:4744
ds_read_b64_tr_b16 a[180:181], v88 offset:37000
ds_read_b64_tr_b16 a[182:183], v88 offset:41608
ds_read_b64_tr_b16 a[184:185], v90 offset:136
ds_read_b64_tr_b16 a[186:187], v90 offset:4744
ds_read_b64_tr_b16 a[188:189], v90 offset:37000
ds_read_b64_tr_b16 a[190:191], v90 offset:41608
ds_read_b64_tr_b16 a[192:193], v88 offset:144
ds_read_b64_tr_b16 a[194:195], v88 offset:4752
ds_read_b64_tr_b16 a[196:197], v88 offset:37008
ds_read_b64_tr_b16 a[198:199], v88 offset:41616
ds_read_b64_tr_b16 a[200:201], v90 offset:144
ds_read_b64_tr_b16 a[202:203], v90 offset:4752
ds_read_b64_tr_b16 a[204:205], v90 offset:37008
ds_read_b64_tr_b16 a[206:207], v90 offset:41616
ds_read_b64_tr_b16 a[208:209], v88 offset:152
ds_read_b64_tr_b16 a[210:211], v88 offset:4760
ds_read_b64_tr_b16 a[212:213], v88 offset:37016
ds_read_b64_tr_b16 a[214:215], v88 offset:41624
ds_read_b64_tr_b16 a[216:217], v90 offset:152
ds_read_b64_tr_b16 a[218:219], v90 offset:4760
ds_read_b64_tr_b16 a[220:221], v90 offset:37016
ds_read_b64_tr_b16 a[222:223], v90 offset:41624
ds_read_b64_tr_b16 a[224:225], v89 offset:0
ds_read_b64_tr_b16 a[226:227], v89 offset:4608
ds_read_b64_tr_b16 a[228:229], v89 offset:36864
ds_read_b64_tr_b16 a[230:231], v89 offset:41472
ds_read_b64_tr_b16 a[232:233], v91 offset:0
ds_read_b64_tr_b16 a[234:235], v91 offset:4608
ds_read_b64_tr_b16 a[236:237], v91 offset:36864
ds_read_b64_tr_b16 a[238:239], v91 offset:41472
s_branch A_ev1_ret
A_ev2:
s_mov_b32 s7, 400000
A_ev2_chk:
v_max3_u32 v35, v40, v41, v42
v_max3_u32 v35, v35, v43, v44
v_max3_u32 v35, v35, v45, v46
v_max3_u32 v35, v35, v47, v48
v_max3_u32 v35, v35, v49, v50
v_max_u32 v35, v35, v51
v_cmp_eq_u32 vcc, -1, v35
s_cbranch_vccz A_ev2_ok
buffer_load_dwordx4 v[40:43], off, s[64:67], s82 offset:0 sc1
buffer_load_dwordx4 v[44:47], off, s[64:67], s82 offset:16 sc1
buffer_load_dwordx4 v[48:51], off, s[64:67], s82 offset:32 sc1
s_waitcnt vmcnt(0)
s_sub_u32 s7, s7, 1
s_cmp_lg_u32 s7, 0
s_cbranch_scc1 A_ev2_chk
A_ev2_ok:
v_max3_f32 v35, v40, v42, v44
v_max3_f32 v36, v46, v48, v50
v_max_f32 v35, v35, v36
v_sub_f32 v40, v40, v35
v_sub_f32 v42, v42, v35
v_sub_f32 v44, v44, v35
v_sub_f32 v46, v46, v35
v_sub_f32 v48, v48, v35
v_sub_f32 v50, v50, v35
v_sub_f32 v37, v32, v35
v_exp_f32 v40, v40
v_exp_f32 v42, v42
v_exp_f32 v44, v44
v_exp_f32 v46, v46
v_exp_f32 v48, v48
v_exp_f32 v50, v50
v_exp_f32 v37, v37
v_mul_f32 v35, v40, v41
v_fma_f32 v35, v42, v43, v35
v_fma_f32 v35, v44, v45, v35
v_fma_f32 v35, v46, v47, v35
v_fma_f32 v35, v48, v49, v35
v_fma_f32 v35, v50, v51, v35
v_rcp_f32 v35, v35
s_nop 0
v_mul_f32 v37, v37, v35
s_branch A_ev2_ret
A_tail:
s_nop 4
v_mul_f32 v20, v20, v37
v_mul_f32 v21, v21, v37
v_mul_f32 v22, v22, v37
v_mul_f32 v23, v23, v37
v_cvt_pk_bf16_f32 v28, v20, v21
v_cvt_pk_bf16_f32 v29, v22, v23
ds_write_b64 v94, v[28:29]
s_waitcnt lgkmcnt(0)
s_barrier
ds_read_b128 a[0:3], v95 offset:0
ds_read_b128 a[4:7], v95 offset:64
ds_read_b128 a[8:11], v95 offset:128
ds_read_b128 a[12:15], v95 offset:192
s_waitcnt lgkmcnt(0)
v_mfma_f32_16x16x32_bf16 v[72:75], a[0:3], a[224:227], 0
v_mfma_f32_16x16x32_bf16 v[72:75], a[4:7], a[228:231], v[72:75]
v_mfma_f32_16x16x32_bf16 v[72:75], a[8:11], a[232:235], v[72:75]
v_mfma_f32_16x16x32_bf16 v[72:75], a[12:15], a[236:239], v[72:75]
v_mfma_f32_16x16x32_bf16 v[40:43], a[0:3], a[96:99], 0
v_mfma_f32_16x16x32_bf16 v[40:43], a[4:7], a[100:103], v[40:43]
v_mfma_f32_16x16x32_bf16 v[40:43], a[8:11], a[104:107], v[40:43]
v_mfma_f32_16x16x32_bf16 v[40:43], a[12:15], a[108:111], v[40:43]
v_mfma_f32_16x16x32_bf16 v[44:47], a[0:3], a[112:115], 0
v_mfma_f32_16x16x32_bf16 v[44:47], a[4:7], a[116:119], v[44:47]
v_mfma_f32_16x16x32_bf16 v[44:47], a[8:11], a[120:123], v[44:47]
v_mfma_f32_16x16x32_bf16 v[44:47], a[12:15], a[124:127], v[44:47]
v_mul_f32 v114, v106, v72
v_fma_f32 v114, v107, v73, v114
v_fma_f32 v114, v108, v74, v114
v_fma_f32 v114, v109, v75, v114
v_mfma_f32_16x16x32_bf16 v[48:51], a[0:3], a[128:131], 0
v_mfma_f32_16x16x32_bf16 v[48:51], a[4:7], a[132:135], v[48:51]
v_mfma_f32_16x16x32_bf16 v[48:51], a[8:11], a[136:139], v[48:51]
v_mfma_f32_16x16x32_bf16 v[48:51], a[12:15], a[140:143], v[48:51]
v_min_u32 v114, -2, v114
s_mov_b64 exec, 0xffffffff
buffer_store_dword v114, v93, s[64:67], 0 offen offset:512 sc1
s_mov_b64 exec, -1
v_mul_f32 v110, v98, v40
v_fma_f32 v110, v99, v41, v110
v_fma_f32 v110, v100, v42, v110
v_fma_f32 v110, v101, v43, v110
v_mfma_f32_16x16x32_bf16 v[52:55], a[0:3], a[144:147], 0
v_mfma_f32_16x16x32_bf16 v[52:55], a[4:7], a[148:151], v[52:55]
v_mfma_f32_16x16x32_bf16 v[52:55], a[8:11], a[152:155], v[52:55]
v_mfma_f32_16x16x32_bf16 v[52:55], a[12:15], a[156:159], v[52:55]
v_mul_f32 v111, v98, v44
v_fma_f32 v111, v99, v45, v111
v_fma_f32 v111, v100, v46, v111
v_fma_f32 v111, v101, v47, v111
v_mfma_f32_16x16x32_bf16 v[56:59], a[0:3], a[160:163], 0
v_mfma_f32_16x16x32_bf16 v[56:59], a[4:7], a[164:167], v[56:59]
v_mfma_f32_16x16x32_bf16 v[56:59], a[8:11], a[168:171], v[56:59]
v_mfma_f32_16x16x32_bf16 v[56:59], a[12:15], a[172:175], v[56:59]
v_mul_f32 v112, v98, v48
v_fma_f32 v112, v99, v49, v112
v_fma_f32 v112, v100, v50, v112
v_fma_f32 v112, v101, v51, v112
v_mfma_f32_16x16x32_bf16 v[60:63], a[0:3], a[176:179], 0
v_mfma_f32_16x16x32_bf16 v[60:63], a[4:7], a[180:183], v[60:63]
v_mfma_f32_16x16x32_bf16 v[60:63], a[8:11], a[184:187], v[60:63]
v_mfma_f32_16x16x32_bf16 v[60:63], a[12:15], a[188:191], v[60:63]
v_mul_f32 v113, v98, v52
v_fma_f32 v113, v99, v53, v113
v_fma_f32 v113, v100, v54, v113
v_fma_f32 v113, v101, v55, v113
v_mfma_f32_16x16x32_bf16 v[64:67], a[0:3], a[192:195], 0
v_mfma_f32_16x16x32_bf16 v[64:67], a[4:7], a[196:199], v[64:67]
v_mfma_f32_16x16x32_bf16 v[64:67], a[8:11], a[200:203], v[64:67]
v_mfma_f32_16x16x32_bf16 v[64:67], a[12:15], a[204:207], v[64:67]
v_fma_f32 v110, v102, v56, v110
v_fma_f32 v110, v103, v57, v110
v_fma_f32 v110, v104, v58, v110
v_fma_f32 v110, v105, v59, v110
v_mfma_f32_16x16x32_bf16 v[68:71], a[0:3], a[208:211], 0
v_mfma_f32_16x16x32_bf16 v[68:71], a[4:7], a[212:215], v[68:71]
v_mfma_f32_16x16x32_bf16 v[68:71], a[8:11], a[216:219], v[68:71]
v_mfma_f32_16x16x32_bf16 v[68:71], a[12:15], a[220:223], v[68:71]
v_fma_f32 v111, v102, v60, v111
v_fma_f32 v111, v103, v61, v111
v_fma_f32 v111, v104, v62, v111
v_fma_f32 v111, v105, v63, v111
v_fma_f32 v112, v102, v64, v112
v_fma_f32 v112, v103, v65, v112
v_fma_f32 v112, v104, v66, v112
v_fma_f32 v112, v105, v67, v112
v_min_u32 v110, -2, v110
v_min_u32 v111, -2, v111
v_min_u32 v112, -2, v112
v_fma_f32 v113, v102, v68, v113
v_fma_f32 v113, v103, v69, v113
v_fma_f32 v113, v104, v70, v113
v_fma_f32 v113, v105, v71, v113
v_min_u32 v113, -2, v113
buffer_store_dwordx4 v[110:113], v92, s[64:67], 0 offen sc1
s_endpgm
L_exit:
s_endpgm
B_role:
s_mov_b32 s8, s5
s_lshl_b32 s9, s4, 1
s_add_u32 s9, s9, s8
s_lshr_b32 s10, s9, 4
s_and_b32 s11, s9, 15
v_and_b32 v1, 63, v0
v_lshlrev_b32 v2, 4, v1
v_lshrrev_b32 v9, 4, v1
v_and_b32 v8, 15, v1
s_waitcnt lgkmcnt(0)
s_mul_i32 s6, s3, 288
s_sub_u32 s7, 4608, s6
s_add_u32 s44, s26, s6
s_addc_u32 s45, s27, 0
s_mov_b32 s46, s7
s_mov_b32 s47, 0x20000
s_mul_i32 s6, s3, 1179648
s_lshl_b32 s7, s4, 8
s_add_u32 s6, s6, s7
s_sub_u32 s7, 4718592, s6
s_add_u32 s48, s30, s6
s_addc_u32 s49, s31, 0
s_mov_b32 s50, s7
s_mov_b32 s51, 0x20000
s_lshl_b32 s6, s8, 2
s_add_u32 s6, s6, s3
s_lshl_b32 s6, s6, 19
s_lshl_b32 s7, s4, 8
s_add_u32 s6, s6, s7
s_sub_u32 s7, 4194304, s6
s_add_u32 s76, s32, s6
s_addc_u32 s77, s33, 0
s_mov_b32 s78, s7
s_mov_b32 s79, 0x20000
s_lshl_b32 s6, s9, 18
s_add_u32 s52, s28, s6
s_addc_u32 s53, s29, 0
s_mov_b32 s54, 262144
s_mov_b32 s55, 0x20000
v_mul_u32_u24 v3, 294912, v9
v_lshl_add_u32 v3, v8, 4, v3
v_mul_u32_u24 v4, 72, v9
v_lshrrev_b32 v6, 3, v8
v_mul_u32_u24 v6, 1152, v6
v_add_u32 v4, v4, v6
v_lshlrev_b32 v220, 17, v9
v_lshl_add_u32 v220, v8, 4, v220
v_xor_b32 v10, 32, v2
s_mov_b32 s64, s42
s_mov_b32 s65, s43
s_mov_b32 s66, 6291456
s_mov_b32 s67, 0x20000
buffer_load_dwordx4 v[24:27], v4, s[44:47], 0 offen offset:0
buffer_load_dwordx4 v[28:31], v4, s[44:47], 0 offen offset:16
buffer_load_dwordx4 v[32:35], v4, s[44:47], 0 offen offset:32
buffer_load_dwordx4 v[36:39], v4, s[44:47], 0 offen offset:48
buffer_load_dwordx2 v[40:41], v4, s[44:47], 0 offen offset:64
buffer_load_dwordx4 v[42:45], v4, s[44:47], 0 offen offset:2304
buffer_load_dwordx4 v[46:49], v4, s[44:47], 0 offen offset:2320
buffer_load_dwordx4 v[50:53], v4, s[44:47], 0 offen offset:2336
buffer_load_dwordx4 v[54:57], v4, s[44:47], 0 offen offset:2352
buffer_load_dwordx2 v[58:59], v4, s[44:47], 0 offen offset:2368
s_cmp_ge_u32 s3, 2
s_cbranch_scc1 L_noclr_17
v_mov_b32 v188, -1
v_mov_b32 v189, -1
v_mov_b32 v190, -1
v_mov_b32 v191, -1
s_cmp_eq_u32 s3, 1
s_cbranch_scc1 L_clr1_18
v_lshrrev_b32 v5, 5, v1
v_lshlrev_b32 v5, 15, v5
v_and_b32 v6, 31, v1
v_lshl_add_u32 v5, v6, 4, v5
s_lshl_b32 s6, s9, 9
s_add_u32 s7, s6, 65536
s_add_u32 s6, s6, 0
buffer_store_dwordx4 v[188:191], v5, s[64:67], s6 offen sc1
buffer_store_dwordx4 v[188:191], v5, s[64:67], s7 offen sc1
s_add_u32 s6, s6, 262144
s_mov_b64 exec, 0xffffffff
buffer_store_dwordx4 v[188:191], v2, s[64:67], s6 offen sc1
s_lshl_b32 s6, s9, 7
s_add_u32 s6, s6, 327680
s_mov_b64 exec, 0xff
buffer_store_dwordx4 v[188:191], v2, s[64:67], s6 offen sc1
s_mov_b64 exec, -1
L_clr1_18:
s_mul_i32 s6, s9, 9216
s_mul_i32 s7, s3, 1048576
s_add_u32 s6, s6, s7
s_add_u32 s6, s6, 4194304
buffer_store_dwordx4 v[188:191], v2, s[64:67], s6 offen offset:0 sc1
buffer_store_dwordx4 v[188:191], v2, s[64:67], s6 offen offset:1024 sc1
buffer_store_dwordx4 v[188:191], v2, s[64:67], s6 offen offset:2048 sc1
buffer_store_dwordx4 v[188:191], v2, s[64:67], s6 offen offset:3072 sc1
s_add_u32 s6, s6, 4096
buffer_store_dwordx4 v[188:191], v2, s[64:67], s6 offen offset:0 sc1
buffer_store_dwordx4 v[188:191], v2, s[64:67], s6 offen offset:1024 sc1
buffer_store_dwordx4 v[188:191], v2, s[64:67], s6 offen offset:2048 sc1
buffer_store_dwordx4 v[188:191], v2, s[64:67], s6 offen offset:3072 sc1
s_add_u32 s6, s6, 4096
buffer_store_dwordx4 v[188:191], v2, s[64:67], s6 offen offset:0 sc1
L_noclr_17:
s_mov_b32 s6, 0
buffer_load_dwordx4 a[96:99], v3, s[48:51], s6 offen
s_mov_b32 s6, 8192
buffer_load_dwordx4 a[100:103], v3, s[48:51], s6 offen
s_mov_b32 s6, 16384
buffer_load_dwordx4 a[104:107], v3, s[48:51], s6 offen
s_mov_b32 s6, 24576
buffer_load_dwordx4 a[108:111], v3, s[48:51], s6 offen
s_mov_b32 s6, 32768
buffer_load_dwordx4 a[112:115], v3, s[48:51], s6 offen
s_mov_b32 s6, 40960
buffer_load_dwordx4 a[116:119], v3, s[48:51], s6 offen
s_mov_b32 s6, 49152
buffer_load_dwordx4 a[120:123], v3, s[48:51], s6 offen
s_mov_b32 s6, 57344
buffer_load_dwordx4 a[124:127], v3, s[48:51], s6 offen
s_mov_b32 s6, 65536
buffer_load_dwordx4 a[128:131], v3, s[48:51], s6 offen
s_mov_b32 s6, 73728
buffer_load_dwordx4 a[132:135], v3, s[48:51], s6 offen
s_mov_b32 s6, 81920
buffer_load_dwordx4 a[136:139], v3, s[48:51], s6 offen
s_mov_b32 s6, 90112
buffer_load_dwordx4 a[140:143], v3, s[48:51], s6 offen
s_mov_b32 s6, 98304
buffer_load_dwordx4 a[144:147], v3, s[48:51], s6 offen
s_mov_b32 s6, 106496
buffer_load_dwordx4 a[148:151], v3, s[48:51], s6 offen
s_mov_b32 s6, 114688
buffer_load_dwordx4 a[152:155], v3, s[48:51], s6 offen
s_mov_b32 s6, 122880
buffer_load_dwordx4 a[156:159], v3, s[48:51], s6 offen
s_mov_b32 s6, 131072
buffer_load_dwordx4 a[160:163], v3, s[48:51], s6 offen
s_mov_b32 s6, 139264
buffer_load_dwordx4 a[164:167], v3, s[48:51], s6 offen
s_mov_b32 s6, 147456
buffer_load_dwordx4 a[168:171], v3, s[48:51], s6 offen
s_mov_b32 s6, 155648
buffer_load_dwordx4 a[172:175], v3, s[48:51], s6 offen
s_mov_b32 s6, 163840
buffer_load_dwordx4 a[176:179], v3, s[48:51], s6 offen
s_mov_b32 s6, 172032
buffer_load_dwordx4 a[180:183], v3, s[48:51], s6 offen
s_mov_b32 s6, 180224
buffer_load_dwordx4 a[184:187], v3, s[48:51], s6 offen
s_mov_b32 s6, 188416
buffer_load_dwordx4 a[188:191], v3, s[48:51], s6 offen
s_mov_b32 s6, 196608
buffer_load_dwordx4 a[192:195], v3, s[48:51], s6 offen
s_mov_b32 s6, 204800
buffer_load_dwordx4 a[196:199], v3, s[48:51], s6 offen
s_mov_b32 s6, 212992
buffer_load_dwordx4 a[200:203], v3, s[48:51], s6 offen
s_mov_b32 s6, 221184
buffer_load_dwordx4 a[204:207], v3, s[48:51], s6 offen
s_mov_b32 s6, 229376
buffer_load_dwordx4 a[208:211], v3, s[48:51], s6 offen
s_mov_b32 s6, 237568
buffer_load_dwordx4 a[212:215], v3, s[48:51], s6 offen
s_mov_b32 s6, 245760
buffer_load_dwordx4 a[216:219], v3, s[48:51], s6 offen
s_mov_b32 s6, 253952
buffer_load_dwordx4 a[220:223], v3, s[48:51], s6 offen
s_mov_b32 s6, 262144
buffer_load_dwordx4 a[224:227], v3, s[48:51], s6 offen
s_mov_b32 s6, 270336
buffer_load_dwordx4 a[228:231], v3, s[48:51], s6 offen
s_mov_b32 s6, 278528
buffer_load_dwordx4 a[232:235], v3, s[48:51], s6 offen
s_mov_b32 s6, 286720
buffer_load_dwordx4 a[236:239], v3, s[48:51], s6 offen
s_mov_b32 s6, 0
buffer_load_dwordx4 v[84:87], v220, s[76:79], s6 offen
s_mov_b32 s6, 8192
buffer_load_dwordx4 v[88:91], v220, s[76:79], s6 offen
s_mov_b32 s6, 16384
buffer_load_dwordx4 v[92:95], v220, s[76:79], s6 offen
s_mov_b32 s68, s40
s_mov_b32 s69, s41
s_mov_b32 s70, 256
s_mov_b32 s71, 0x20000
s_mov_b32 s72, s38
s_mov_b32 s73, s39
s_mov_b32 s74, 9216
s_mov_b32 s75, 0x20000
v_and_b32 v5, 1, v1
v_lshlrev_b32 v5, 4, v5
v_mov_b32 v6, 0xffff
v_lshlrev_b32 v5, v5, v6
v_bfe_u32 v6, v1, 1, 2
v_cmp_eq_u32 vcc, 0, v6
s_nop 1
v_cndmask_b32 v12, 0, v5, vcc
v_cmp_eq_u32 vcc, 1, v6
s_nop 1
v_cndmask_b32 v13, 0, v5, vcc
v_cmp_eq_u32 vcc, 2, v6
s_nop 1
v_cndmask_b32 v14, 0, v5, vcc
v_cmp_eq_u32 vcc, 3, v6
s_nop 1
v_cndmask_b32 v15, 0, v5, vcc
v_mov_b32 v5, 0x0c0c0c0c
s_mov_b32 s6, 0x01000100
s_mov_b32 s7, 0x03020302
v_bfi_b32 v16, v12, s6, v5
v_bfi_b32 v17, v13, s6, v5
v_bfi_b32 v18, v14, s6, v5
v_bfi_b32 v19, v15, s6, v5
v_bfi_b32 v20, v12, s7, v5
v_bfi_b32 v21, v13, s7, v5
v_bfi_b32 v22, v14, s7, v5
v_bfi_b32 v23, v15, s7, v5
s_mul_i32 s12, s3, 17408
s_lshl_b32 s13, s3, 14
s_waitcnt vmcnt(38)
s_cmp_ge_u32 s3, 2
s_cbranch_scc1 L_sig0_19
v_mov_b32 v7, 1
s_mov_b64 exec, 1
buffer_atomic_add v7, off, s[68:71], 0 offset:0
s_mov_b64 exec, -1
L_sig0_19:
s_mov_b32 s6, 24576
buffer_load_dwordx4 v[96:99], v220, s[76:79], s6 offen
s_mov_b32 s6, 32768
buffer_load_dwordx4 v[100:103], v220, s[76:79], s6 offen
s_mov_b32 s6, 40960
buffer_load_dwordx4 v[104:107], v220, s[76:79], s6 offen
s_mov_b32 s6, 49152
buffer_load_dwordx4 v[108:111], v220, s[76:79], s6 offen
s_mov_b32 s6, 57344
buffer_load_dwordx4 v[112:115], v220, s[76:79], s6 offen
s_mov_b32 s6, 65536
buffer_load_dwordx4 v[116:119], v220, s[76:79], s6 offen
s_mov_b32 s6, 73728
buffer_load_dwordx4 v[120:123], v220, s[76:79], s6 offen
s_mov_b32 s6, 81920
buffer_load_dwordx4 v[124:127], v220, s[76:79], s6 offen
s_mov_b32 s6, 90112
buffer_load_dwordx4 v[128:131], v220, s[76:79], s6 offen
s_mov_b32 s6, 98304
buffer_load_dwordx4 v[132:135], v220, s[76:79], s6 offen
s_mov_b32 s6, 106496
buffer_load_dwordx4 v[136:139], v220, s[76:79], s6 offen
s_mov_b32 s6, 114688
buffer_load_dwordx4 v[140:143], v220, s[76:79], s6 offen
s_mov_b32 s6, 122880
buffer_load_dwordx4 v[144:147], v220, s[76:79], s6 offen
v_perm_b32 v60, v24, v24, v16
v_perm_b32 v61, v24, v24, v17
v_perm_b32 v62, v24, v24, v18
v_perm_b32 v63, v24, v24, v19
s_nop 1
v_mfma_f32_16x16x32_bf16 v[76:79], v[60:63], a[96:99], 0
v_perm_b32 v64, v42, v42, v16
v_perm_b32 v65, v42, v42, v17
v_perm_b32 v66, v42, v42, v18
v_perm_b32 v67, v42, v42, v19
s_nop 1
v_mfma_f32_16x16x32_bf16 v[80:83], v[64:67], a[96:99], 0
s_add_u32 m0, s12, 0
s_add_u32 s6, s13, 0
buffer_load_dwordx4 v2, s[52:55], s6 offen  lds
s_waitcnt vmcnt(51)
v_perm_b32 v68, v24, v24, v20
v_perm_b32 v69, v24, v24, v21
v_perm_b32 v70, v24, v24, v22
v_perm_b32 v71, v24, v24, v23
s_nop 1
v_mfma_f32_16x16x32_bf16 v[76:79], v[68:71], a[100:103], v[76:79]
v_perm_b32 v72, v42, v42, v20
v_perm_b32 v73, v42, v42, v21
v_perm_b32 v74, v42, v42, v22
v_perm_b32 v75, v42, v42, v23
s_nop 1
v_mfma_f32_16x16x32_bf16 v[80:83], v[72:75], a[100:103], v[80:83]
s_add_u32 m0, s12, 1088
s_add_u32 s6, s13, 1024
buffer_load_dwordx4 v2, s[52:55], s6 offen  lds
s_waitcnt vmcnt(51)
v_perm_b32 v60, v25, v25, v16
v_perm_b32 v61, v25, v25, v17
v_perm_b32 v62, v25, v25, v18
v_perm_b32 v63, v25, v25, v19
s_nop 1
v_mfma_f32_16x16x32_bf16 v[76:79], v[60:63], a[104:107], v[76:79]
v_perm_b32 v64, v43, v43, v16
v_perm_b32 v65, v43, v43, v17
v_perm_b32 v66, v43, v43, v18
v_perm_b32 v67, v43, v43, v19
s_nop 1
v_mfma_f32_16x16x32_bf16 v[80:83], v[64:67], a[104:107], v[80:83]
s_add_u32 m0, s12, 2176
s_add_u32 s6, s13, 2048
buffer_load_dwordx4 v2, s[52:55], s6 offen  lds
s_waitcnt vmcnt(51)
v_perm_b32 v68, v25, v25, v20
v_perm_b32 v69, v25, v25, v21
v_perm_b32 v70, v25, v25, v22
v_perm_b32 v71, v25, v25, v23
s_nop 1
v_mfma_f32_16x16x32_bf16 v[76:79], v[68:71], a[108:111], v[76:79]
v_perm_b32 v72, v43, v43, v20
v_perm_b32 v73, v43, v43, v21
v_perm_b32 v74, v43, v43, v22
v_perm_b32 v75, v43, v43, v23
s_nop 1
v_mfma_f32_16x16x32_bf16 v[80:83], v[72:75], a[108:111], v[80:83]
s_add_u32 m0, s12, 3264
s_add_u32 s6, s13, 3072
buffer_load_dwordx4 v2, s[52:55], s6 offen  lds
s_waitcnt vmcnt(51)
v_perm_b32 v60, v26, v26, v16
v_perm_b32 v61, v26, v26, v17
v_perm_b32 v62, v26, v26, v18
v_perm_b32 v63, v26, v26, v19
s_nop 1
v_mfma_f32_16x16x32_bf16 v[76:79], v[60:63], a[112:115], v[76:79]
v_perm_b32 v64, v44, v44, v16
v_perm_b32 v65, v44, v44, v17
v_perm_b32 v66, v44, v44, v18
v_perm_b32 v67, v44, v44, v19
s_nop 1
v_mfma_f32_16x16x32_bf16 v[80:83], v[64:67], a[112:115], v[80:83]
s_add_u32 m0, s12, 4352
s_add_u32 s6, s13, 4096
buffer_load_dwordx4 v2, s[52:55], s6 offen  lds
s_waitcnt vmcnt(51)
v_perm_b32 v68, v26, v26, v20
v_perm_b32 v69, v26, v26, v21
v_perm_b32 v70, v26, v26, v22
v_perm_b32 v71, v26, v26, v23
s_nop 1
v_mfma_f32_16x16x32_bf16 v[76:79], v[68:71], a[116:119], v[76:79]
v_perm_b32 v72, v44, v44, v20
v_perm_b32 v73, v44, v44, v21
v_perm_b32 v74, v44, v44, v22
v_perm_b32 v75, v44, v44, v23
s_nop 1
v_mfma_f32_16x16x32_bf16 v[80:83], v[72:75], a[116:119], v[80:83]
s_add_u32 m0, s12, 5440
s_add_u32 s6, s13, 5120
buffer_load_dwordx4 v2, s[52:55], s6 offen  lds
s_waitcnt vmcnt(51)
v_perm_b32 v60, v27, v27, v16
v_perm_b32 v61, v27, v27, v17
v_perm_b32 v62, v27, v27, v18
v_perm_b32 v63, v27, v27, v19
s_nop 1
v_mfma_f32_16x16x32_bf16 v[76:79], v[60:63], a[120:123], v[76:79]
v_perm_b32 v64, v45, v45, v16
v_perm_b32 v65, v45, v45, v17
v_perm_b32 v66, v45, v45, v18
v_perm_b32 v67, v45, v45, v19
s_nop 1
v_mfma_f32_16x16x32_bf16 v[80:83], v[64:67], a[120:123], v[80:83]
s_add_u32 m0, s12, 6528
s_add_u32 s6, s13, 6144
buffer_load_dwordx4 v2, s[52:55], s6 offen  lds
s_waitcnt vmcnt(51)
v_perm_b32 v68, v27, v27, v20
v_perm_b32 v69, v27, v27, v21
v_perm_b32 v70, v27, v27, v22
v_perm_b32 v71, v27, v27, v23
s_nop 1
v_mfma_f32_16x16x32_bf16 v[76:79], v[68:71], a[124:127], v[76:79]
v_perm_b32 v72, v45, v45, v20
v_perm_b32 v73, v45, v45, v21
v_perm_b32 v74, v45, v45, v22
v_perm_b32 v75, v45, v45, v23
s_nop 1
v_mfma_f32_16x16x32_bf16 v[80:83], v[72:75], a[124:127], v[80:83]
s_add_u32 m0, s12, 7616
s_add_u32 s6, s13, 7168
buffer_load_dwordx4 v2, s[52:55], s6 offen  lds
s_waitcnt vmcnt(51)
v_perm_b32 v60, v28, v28, v16
v_perm_b32 v61, v28, v28, v17
v_perm_b32 v62, v28, v28, v18
v_perm_b32 v63, v28, v28, v19
s_nop 1
v_mfma_f32_16x16x32_bf16 v[76:79], v[60:63], a[128:131], v[76:79]
v_perm_b32 v64, v46, v46, v16
v_perm_b32 v65, v46, v46, v17
v_perm_b32 v66, v46, v46, v18
v_perm_b32 v67, v46, v46, v19
s_nop 1
v_mfma_f32_16x16x32_bf16 v[80:83], v[64:67], a[128:131], v[80:83]
s_add_u32 m0, s12, 8704
s_add_u32 s6, s13, 8192
buffer_load_dwordx4 v10, s[52:55], s6 offen  lds
s_waitcnt vmcnt(51)
v_perm_b32 v68, v28, v28, v20
v_perm_b32 v69, v28, v28, v21
v_perm_b32 v70, v28, v28, v22
v_perm_b32 v71, v28, v28, v23
s_nop 1
v_mfma_f32_16x16x32_bf16 v[76:79], v[68:71], a[132:135], v[76:79]
v_perm_b32 v72, v46, v46, v20
v_perm_b32 v73, v46, v46, v21
v_perm_b32 v74, v46, v46, v22
v_perm_b32 v75, v46, v46, v23
s_nop 1
v_mfma_f32_16x16x32_bf16 v[80:83], v[72:75], a[132:135], v[80:83]
s_add_u32 m0, s12, 9792
s_add_u32 s6, s13, 9216
buffer_load_dwordx4 v10, s[52:55], s6 offen  lds
s_waitcnt vmcnt(51)
v_perm_b32 v60, v29, v29, v16
v_perm_b32 v61, v29, v29, v17
v_perm_b32 v62, v29, v29, v18
v_perm_b32 v63, v29, v29, v19
s_nop 1
v_mfma_f32_16x16x32_bf16 v[76:79], v[60:63], a[136:139], v[76:79]
v_perm_b32 v64, v47, v47, v16
v_perm_b32 v65, v47, v47, v17
v_perm_b32 v66, v47, v47, v18
v_perm_b32 v67, v47, v47, v19
s_nop 1
v_mfma_f32_16x16x32_bf16 v[80:83], v[64:67], a[136:139], v[80:83]
s_add_u32 m0, s12, 10880
s_add_u32 s6, s13, 10240
buffer_load_dwordx4 v10, s[52:55], s6 offen  lds
s_waitcnt vmcnt(51)
v_perm_b32 v68, v29, v29, v20
v_perm_b32 v69, v29, v29, v21
v_perm_b32 v70, v29, v29, v22
v_perm_b32 v71, v29, v29, v23
s_nop 1
v_mfma_f32_16x16x32_bf16 v[76:79], v[68:71], a[140:143], v[76:79]
v_perm_b32 v72, v47, v47, v20
v_perm_b32 v73, v47, v47, v21
v_perm_b32 v74, v47, v47, v22
v_perm_b32 v75, v47, v47, v23
s_nop 1
v_mfma_f32_16x16x32_bf16 v[80:83], v[72:75], a[140:143], v[80:83]
s_add_u32 m0, s12, 11968
s_add_u32 s6, s13, 11264
buffer_load_dwordx4 v10, s[52:55], s6 offen  lds
s_waitcnt vmcnt(51)
v_perm_b32 v60, v30, v30, v16
v_perm_b32 v61, v30, v30, v17
v_perm_b32 v62, v30, v30, v18
v_perm_b32 v63, v30, v30, v19
s_nop 1
v_mfma_f32_16x16x32_bf16 v[76:79], v[60:63], a[144:147], v[76:79]
v_perm_b32 v64, v48, v48, v16
v_perm_b32 v65, v48, v48, v17
v_perm_b32 v66, v48, v48, v18
v_perm_b32 v67, v48, v48, v19
s_nop 1
v_mfma_f32_16x16x32_bf16 v[80:83], v[64:67], a[144:147], v[80:83]
s_add_u32 m0, s12, 13056
s_add_u32 s6, s13, 12288
buffer_load_dwordx4 v10, s[52:55], s6 offen  lds
s_waitcnt vmcnt(51)
v_perm_b32 v68, v30, v30, v20
v_perm_b32 v69, v30, v30, v21
v_perm_b32 v70, v30, v30, v22
v_perm_b32 v71, v30, v30, v23
s_nop 1
v_mfma_f32_16x16x32_bf16 v[76:79], v[68:71], a[148:151], v[76:79]
v_perm_b32 v72, v48, v48, v20
v_perm_b32 v73, v48, v48, v21
v_perm_b32 v74, v48, v48, v22
v_perm_b32 v75, v48, v48, v23
s_nop 1
v_mfma_f32_16x16x32_bf16 v[80:83], v[72:75], a[148:151], v[80:83]
s_add_u32 m0, s12, 14144
s_add_u32 s6, s13, 13312
buffer_load_dwordx4 v10, s[52:55], s6 offen  lds
s_waitcnt vmcnt(51)
v_perm_b32 v60, v31, v31, v16
v_perm_b32 v61, v31, v31, v17
v_perm_b32 v62, v31, v31, v18
v_perm_b32 v63, v31, v31, v19
s_nop 1
v_mfma_f32_16x16x32_bf16 v[76:79], v[60:63], a[152:155], v[76:79]
v_perm_b32 v64, v49, v49, v16
v_perm_b32 v65, v49, v49, v17
v_perm_b32 v66, v49, v49, v18
v_perm_b32 v67, v49, v49, v19
s_nop 1
v_mfma_f32_16x16x32_bf16 v[80:83], v[64:67], a[152:155], v[80:83]
s_add_u32 m0, s12, 15232
s_add_u32 s6, s13, 14336
buffer_load_dwordx4 v10, s[52:55], s6 offen  lds
s_waitcnt vmcnt(51)
v_perm_b32 v68, v31, v31, v20
v_perm_b32 v69, v31, v31, v21
v_perm_b32 v70, v31, v31, v22
v_perm_b32 v71, v31, v31, v23
s_nop 1
v_mfma_f32_16x16x32_bf16 v[76:79], v[68:71], a[156:159], v[76:79]
v_perm_b32 v72, v49, v49, v20
v_perm_b32 v73, v49, v49, v21
v_perm_b32 v74, v49, v49, v22
v_perm_b32 v75, v49, v49, v23
s_nop 1
v_mfma_f32_16x16x32_bf16 v[80:83], v[72:75], a[156:159], v[80:83]
s_add_u32 m0, s12, 16320
s_add_u32 s6, s13, 15360
buffer_load_dwordx4 v10, s[52:55], s6 offen  lds
s_waitcnt vmcnt(51)
v_perm_b32 v60, v32, v32, v16
v_perm_b32 v61, v32, v32, v17
v_perm_b32 v62, v32, v32, v18
v_perm_b32 v63, v32, v32, v19
s_nop 1
v_mfma_f32_16x16x32_bf16 v[76:79], v[60:63], a[160:163], v[76:79]
v_perm_b32 v64, v50, v50, v16
v_perm_b32 v65, v50, v50, v17
v_perm_b32 v66, v50, v50, v18
v_perm_b32 v67, v50, v50, v19
s_nop 1
v_mfma_f32_16x16x32_bf16 v[80:83], v[64:67], a[160:163], v[80:83]
s_add_u32 m0, s12, 69632
s_add_u32 s6, s13, 65536
buffer_load_dwordx4 v2, s[52:55], s6 offen  lds
s_waitcnt vmcnt(51)
v_perm_b32 v68, v32, v32, v20
v_perm_b32 v69, v32, v32, v21
v_perm_b32 v70, v32, v32, v22
v_perm_b32 v71, v32, v32, v23
s_nop 1
v_mfma_f32_16x16x32_bf16 v[76:79], v[68:71], a[164:167], v[76:79]
v_perm_b32 v72, v50, v50, v20
v_perm_b32 v73, v50, v50, v21
v_perm_b32 v74, v50, v50, v22
v_perm_b32 v75, v50, v50, v23
s_nop 1
v_mfma_f32_16x16x32_bf16 v[80:83], v[72:75], a[164:167], v[80:83]
s_add_u32 m0, s12, 70720
s_add_u32 s6, s13, 66560
buffer_load_dwordx4 v2, s[52:55], s6 offen  lds
s_waitcnt vmcnt(51)
v_perm_b32 v60, v33, v33, v16
v_perm_b32 v61, v33, v33, v17
v_perm_b32 v62, v33, v33, v18
v_perm_b32 v63, v33, v33, v19
s_nop 1
v_mfma_f32_16x16x32_bf16 v[76:79], v[60:63], a[168:171], v[76:79]
v_perm_b32 v64, v51, v51, v16
v_perm_b32 v65, v51, v51, v17
v_perm_b32 v66, v51, v51, v18
v_perm_b32 v67, v51, v51, v19
s_nop 1
v_mfma_f32_16x16x32_bf16 v[80:83], v[64:67], a[168:171], v[80:83]
s_add_u32 m0, s12, 71808
s_add_u32 s6, s13, 67584
buffer_load_dwordx4 v2, s[52:55], s6 offen  lds
s_waitcnt vmcnt(51)
v_perm_b32 v68, v33, v33, v20
v_perm_b32 v69, v33, v33, v21
v_perm_b32 v70, v33, v33, v22
v_perm_b32 v71, v33, v33, v23
s_nop 1
v_mfma_f32_16x16x32_bf16 v[76:79], v[68:71], a[172:175], v[76:79]
v_perm_b32 v72, v51, v51, v20
v_perm_b32 v73, v51, v51, v21
v_perm_b32 v74, v51, v51, v22
v_perm_b32 v75, v51, v51, v23
s_nop 1
v_mfma_f32_16x16x32_bf16 v[80:83], v[72:75], a[172:175], v[80:83]
s_add_u32 m0, s12, 72896
s_add_u32 s6, s13, 68608
buffer_load_dwordx4 v2, s[52:55], s6 offen  lds
s_waitcnt vmcnt(51)
v_perm_b32 v60, v34, v34, v16
v_perm_b32 v61, v34, v34, v17
v_perm_b32 v62, v34, v34, v18
v_perm_b32 v63, v34, v34, v19
s_nop 1
v_mfma_f32_16x16x32_bf16 v[76:79], v[60:63], a[176:179], v[76:79]
v_perm_b32 v64, v52, v52, v16
v_perm_b32 v65, v52, v52, v17
v_perm_b32 v66, v52, v52, v18
v_perm_b32 v67, v52, v52, v19
s_nop 1
v_mfma_f32_16x16x32_bf16 v[80:83], v[64:67], a[176:179], v[80:83]
s_add_u32 m0, s12, 73984
s_add_u32 s6, s13, 69632
buffer_load_dwordx4 v2, s[52:55], s6 offen  lds
s_waitcnt vmcnt(51)
v_perm_b32 v68, v34, v34, v20
v_perm_b32 v69, v34, v34, v21
v_perm_b32 v70, v34, v34, v22
v_perm_b32 v71, v34, v34, v23
s_nop 1
v_mfma_f32_16x16x32_bf16 v[76:79], v[68:71], a[180:183], v[76:79]
v_perm_b32 v72, v52, v52, v20
v_perm_b32 v73, v52, v52, v21
v_perm_b32 v74, v52, v52, v22
v_perm_b32 v75, v52, v52, v23
s_nop 1
v_mfma_f32_16x16x32_bf16 v[80:83], v[72:75], a[180:183], v[80:83]
s_add_u32 m0, s12, 75072
s_add_u32 s6, s13, 70656
buffer_load_dwordx4 v2, s[52:55], s6 offen  lds
s_waitcnt vmcnt(51)
v_perm_b32 v60, v35, v35, v16
v_perm_b32 v61, v35, v35, v17
v_perm_b32 v62, v35, v35, v18
v_perm_b32 v63, v35, v35, v19
s_nop 1
v_mfma_f32_16x16x32_bf16 v[76:79], v[60:63], a[184:187], v[76:79]
v_perm_b32 v64, v53, v53, v16
v_perm_b32 v65, v53, v53, v17
v_perm_b32 v66, v53, v53, v18
v_perm_b32 v67, v53, v53, v19
s_nop 1
v_mfma_f32_16x16x32_bf16 v[80:83], v[64:67], a[184:187], v[80:83]
s_add_u32 m0, s12, 76160
s_add_u32 s6, s13, 71680
buffer_load_dwordx4 v2, s[52:55], s6 offen  lds
s_waitcnt vmcnt(51)
v_perm_b32 v68, v35, v35, v20
v_perm_b32 v69, v35, v35, v21
v_perm_b32 v70, v35, v35, v22
v_perm_b32 v71, v35, v35, v23
s_nop 1
v_mfma_f32_16x16x32_bf16 v[76:79], v[68:71], a[188:191], v[76:79]
v_perm_b32 v72, v53, v53, v20
v_perm_b32 v73, v53, v53, v21
v_perm_b32 v74, v53, v53, v22
v_perm_b32 v75, v53, v53, v23
s_nop 1
v_mfma_f32_16x16x32_bf16 v[80:83], v[72:75], a[188:191], v[80:83]
s_add_u32 m0, s12, 77248
s_add_u32 s6, s13, 72704
buffer_load_dwordx4 v2, s[52:55], s6 offen  lds
s_waitcnt vmcnt(51)
v_perm_b32 v60, v36, v36, v16
v_perm_b32 v61, v36, v36, v17
v_perm_b32 v62, v36, v36, v18
v_perm_b32 v63, v36, v36, v19
s_nop 1
v_mfma_f32_16x16x32_bf16 v[76:79], v[60:63], a[192:195], v[76:79]
v_perm_b32 v64, v54, v54, v16
v_perm_b32 v65, v54, v54, v17
v_perm_b32 v66, v54, v54, v18
v_perm_b32 v67, v54, v54, v19
s_nop 1
v_mfma_f32_16x16x32_bf16 v[80:83], v[64:67], a[192:195], v[80:83]
s_add_u32 m0, s12, 78336
s_add_u32 s6, s13, 73728
buffer_load_dwordx4 v10, s[52:55], s6 offen  lds
s_waitcnt vmcnt(51)
v_perm_b32 v68, v36, v36, v20
v_perm_b32 v69, v36, v36, v21
v_perm_b32 v70, v36, v36, v22
v_perm_b32 v71, v36, v36, v23
s_nop 1
v_mfma_f32_16x16x32_bf16 v[76:79], v[68:71], a[196:199], v[76:79]
v_perm_b32 v72, v54, v54, v20
v_perm_b32 v73, v54, v54, v21
v_perm_b32 v74, v54, v54, v22
v_perm_b32 v75, v54, v54, v23
s_nop 1
v_mfma_f32_16x16x32_bf16 v[80:83], v[72:75], a[196:199], v[80:83]
s_add_u32 m0, s12, 79424
s_add_u32 s6, s13, 74752
buffer_load_dwordx4 v10, s[52:55], s6 offen  lds
s_waitcnt vmcnt(51)
v_perm_b32 v60, v37, v37, v16
v_perm_b32 v61, v37, v37, v17
v_perm_b32 v62, v37, v37, v18
v_perm_b32 v63, v37, v37, v19
s_nop 1
v_mfma_f32_16x16x32_bf16 v[76:79], v[60:63], a[200:203], v[76:79]
v_perm_b32 v64, v55, v55, v16
v_perm_b32 v65, v55, v55, v17
v_perm_b32 v66, v55, v55, v18
v_perm_b32 v67, v55, v55, v19
s_nop 1
v_mfma_f32_16x16x32_bf16 v[80:83], v[64:67], a[200:203], v[80:83]
s_add_u32 m0, s12, 80512
s_add_u32 s6, s13, 75776
buffer_load_dwordx4 v10, s[52:55], s6 offen  lds
s_waitcnt vmcnt(51)
v_perm_b32 v68, v37, v37, v20
v_perm_b32 v69, v37, v37, v21
v_perm_b32 v70, v37, v37, v22
v_perm_b32 v71, v37, v37, v23
s_nop 1
v_mfma_f32_16x16x32_bf16 v[76:79], v[68:71], a[204:207], v[76:79]
v_perm_b32 v72, v55, v55, v20
v_perm_b32 v73, v55, v55, v21
v_perm_b32 v74, v55, v55, v22
v_perm_b32 v75, v55, v55, v23
s_nop 1
v_mfma_f32_16x16x32_bf16 v[80:83], v[72:75], a[204:207], v[80:83]
s_add_u32 m0, s12, 81600
s_add_u32 s6, s13, 76800
buffer_load_dwordx4 v10, s[52:55], s6 offen  lds
s_waitcnt vmcnt(51)
v_perm_b32 v60, v38, v38, v16
v_perm_b32 v61, v38, v38, v17
v_perm_b32 v62, v38, v38, v18
v_perm_b32 v63, v38, v38, v19
s_nop 1
v_mfma_f32_16x16x32_bf16 v[76:79], v[60:63], a[208:211], v[76:79]
v_perm_b32 v64, v56, v56, v16
v_perm_b32 v65, v56, v56, v17
v_perm_b32 v66, v56, v56, v18
v_perm_b32 v67, v56, v56, v19
s_nop 1
v_mfma_f32_16x16x32_bf16 v[80:83], v[64:67], a[208:211], v[80:83]
buffer_load_dword v11, off, s[68:71], 0 offset:0 sc1
s_add_u32 m0, s12, 82688
s_add_u32 s6, s13, 77824
buffer_load_dwordx4 v10, s[52:55], s6 offen  lds
s_waitcnt vmcnt(52)
v_perm_b32 v68, v38, v38, v20
v_perm_b32 v69, v38, v38, v21
v_perm_b32 v70, v38, v38, v22
v_perm_b32 v71, v38, v38, v23
s_nop 1
v_mfma_f32_16x16x32_bf16 v[76:79], v[68:71], a[212:215], v[76:79]
v_perm_b32 v72, v56, v56, v20
v_perm_b32 v73, v56, v56, v21
v_perm_b32 v74, v56, v56, v22
v_perm_b32 v75, v56, v56, v23
s_nop 1
v_mfma_f32_16x16x32_bf16 v[80:83], v[72:75], a[212:215], v[80:83]
s_add_u32 m0, s12, 83776
s_add_u32 s6, s13, 78848
buffer_load_dwordx4 v10, s[52:55], s6 offen  lds
s_waitcnt vmcnt(52)
v_perm_b32 v60, v39, v39, v16
v_perm_b32 v61, v39, v39, v17
v_perm_b32 v62, v39, v39, v18
v_perm_b32 v63, v39, v39, v19
s_nop 1
v_mfma_f32_16x16x32_bf16 v[76:79], v[60:63], a[216:219], v[76:79]
v_perm_b32 v64, v57, v57, v16
v_perm_b32 v65, v57, v57, v17
v_perm_b32 v66, v57, v57, v18
v_perm_b32 v67, v57, v57, v19
s_nop 1
v_mfma_f32_16x16x32_bf16 v[80:83], v[64:67], a[216:219], v[80:83]
s_add_u32 m0, s12, 84864
s_add_u32 s6, s13, 79872
buffer_load_dwordx4 v10, s[52:55], s6 offen  lds
s_waitcnt vmcnt(52)
v_perm_b32 v68, v39, v39, v20
v_perm_b32 v69, v39, v39, v21
v_perm_b32 v70, v39, v39, v22
v_perm_b32 v71, v39, v39, v23
s_nop 1
v_mfma_f32_16x16x32_bf16 v[76:79], v[68:71], a[220:223], v[76:79]
v_perm_b32 v72, v57, v57, v20
v_perm_b32 v73, v57, v57, v21
v_perm_b32 v74, v57, v57, v22
v_perm_b32 v75, v57, v57, v23
s_nop 1
v_mfma_f32_16x16x32_bf16 v[80:83], v[72:75], a[220:223], v[80:83]
s_add_u32 m0, s12, 85952
s_add_u32 s6, s13, 80896
buffer_load_dwordx4 v10, s[52:55], s6 offen  lds
s_waitcnt vmcnt(52)
v_perm_b32 v60, v40, v40, v16
v_perm_b32 v61, v40, v40, v17
v_perm_b32 v62, v40, v40, v18
v_perm_b32 v63, v40, v40, v19
s_nop 1
v_mfma_f32_16x16x32_bf16 v[76:79], v[60:63], a[224:227], v[76:79]
v_perm_b32 v64, v58, v58, v16
v_perm_b32 v65, v58, v58, v17
v_perm_b32 v66, v58, v58, v18
v_perm_b32 v67, v58, v58, v19
s_nop 1
v_mfma_f32_16x16x32_bf16 v[80:83], v[64:67], a[224:227], v[80:83]
s_waitcnt vmcnt(51)
v_perm_b32 v68, v40, v40, v20
v_perm_b32 v69, v40, v40, v21
v_perm_b32 v70, v40, v40, v22
v_perm_b32 v71, v40, v40, v23
s_nop 1
v_mfma_f32_16x16x32_bf16 v[76:79], v[68:71], a[228:231], v[76:79]
v_perm_b32 v72, v58, v58, v20
v_perm_b32 v73, v58, v58, v21
v_perm_b32 v74, v58, v58, v22
v_perm_b32 v75, v58, v58, v23
s_nop 1
v_mfma_f32_16x16x32_bf16 v[80:83], v[72:75], a[228:231], v[80:83]
s_waitcnt vmcnt(50)
v_perm_b32 v60, v41, v41, v16
v_perm_b32 v61, v41, v41, v17
v_perm_b32 v62, v41, v41, v18
v_perm_b32 v63, v41, v41, v19
s_nop 1
v_mfma_f32_16x16x32_bf16 v[76:79], v[60:63], a[232:235], v[76:79]
v_perm_b32 v64, v59, v59, v16
v_perm_b32 v65, v59, v59, v17
v_perm_b32 v66, v59, v59, v18
v_perm_b32 v67, v59, v59, v19
s_nop 1
v_mfma_f32_16x16x32_bf16 v[80:83], v[64:67], a[232:235], v[80:83]
s_waitcnt vmcnt(49)
v_perm_b32 v68, v41, v41, v20
v_perm_b32 v69, v41, v41, v21
v_perm_b32 v70, v41, v41, v22
v_perm_b32 v71, v41, v41, v23
s_nop 1
v_mfma_f32_16x16x32_bf16 v[76:79], v[68:71], a[236:239], v[76:79]
v_perm_b32 v72, v59, v59, v20
v_perm_b32 v73, v59, v59, v21
v_perm_b32 v74, v59, v59, v22
v_perm_b32 v75, v59, v59, v23
s_nop 1
v_mfma_f32_16x16x32_bf16 v[80:83], v[72:75], a[236:239], v[80:83]
v_lshlrev_b32 v5, 5, v8
v_and_b32 v6, 1, v9
v_lshl_add_u32 v6, v6, 4, v5
v_lshrrev_b32 v7, 5, v1
v_lshl_add_u32 v6, v7, 9, v6
s_lshl_b32 s6, s3, 11
s_add_u32 s6, s6, 139264
v_add_u32 v6, s6, v6
ds_write_b128 v6, v[76:79]
ds_write_b128 v6, v[80:83] offset:1024
v_add_u32 v5, 139264, v5
s_waitcnt lgkmcnt(0)
s_barrier
ds_read_b128 v[188:191], v5 offset:0
ds_read_b128 v[192:195], v5 offset:16
ds_read_b128 v[196:199], v5 offset:2048
ds_read_b128 v[200:203], v5 offset:2064
ds_read_b128 v[204:207], v5 offset:4096
ds_read_b128 v[208:211], v5 offset:4112
ds_read_b128 v[212:215], v5 offset:6144
ds_read_b128 v[216:219], v5 offset:6160
s_waitcnt lgkmcnt(0)
v_add_f32 v188, v188, v196
v_add_f32 v204, v204, v212
v_add_f32 v189, v189, v197
v_add_f32 v205, v205, v213
v_add_f32 v190, v190, v198
v_add_f32 v206, v206, v214
v_add_f32 v191, v191, v199
v_add_f32 v207, v207, v215
v_add_f32 v192, v192, v200
v_add_f32 v208, v208, v216
v_add_f32 v193, v193, v201
v_add_f32 v209, v209, v217
v_add_f32 v194, v194, v202
v_add_f32 v210, v210, v218
v_add_f32 v195, v195, v203
v_add_f32 v211, v211, v219
v_add_f32 v188, v188, v204
v_add_f32 v189, v189, v205
v_add_f32 v190, v190, v206
v_add_f32 v191, v191, v207
v_add_f32 v192, v192, v208
v_add_f32 v193, v193, v209
v_add_f32 v194, v194, v210
v_add_f32 v195, v195, v211
v_cvt_pk_bf16_f32 v148, v188, v189
v_cvt_pk_bf16_f32 v149, v190, v191
v_cvt_pk_bf16_f32 v150, v192, v193
v_cvt_pk_bf16_f32 v151, v194, v195
ds_read_b128 v[188:191], v5 offset:512
ds_read_b128 v[192:195], v5 offset:528
ds_read_b128 v[196:199], v5 offset:2560
ds_read_b128 v[200:203], v5 offset:2576
ds_read_b128 v[204:207], v5 offset:4608
ds_read_b128 v[208:211], v5 offset:4624
ds_read_b128 v[212:215], v5 offset:6656
ds_read_b128 v[216:219], v5 offset:6672
s_waitcnt lgkmcnt(0)
v_add_f32 v188, v188, v196
v_add_f32 v204, v204, v212
v_add_f32 v189, v189, v197
v_add_f32 v205, v205, v213
v_add_f32 v190, v190, v198
v_add_f32 v206, v206, v214
v_add_f32 v191, v191, v199
v_add_f32 v207, v207, v215
v_add_f32 v192, v192, v200
v_add_f32 v208, v208, v216
v_add_f32 v193, v193, v201
v_add_f32 v209, v209, v217
v_add_f32 v194, v194, v202
v_add_f32 v210, v210, v218
v_add_f32 v195, v195, v203
v_add_f32 v211, v211, v219
v_add_f32 v188, v188, v204
v_add_f32 v189, v189, v205
v_add_f32 v190, v190, v206
v_add_f32 v191, v191, v207
v_add_f32 v192, v192, v208
v_add_f32 v193, v193, v209
v_add_f32 v194, v194, v210
v_add_f32 v195, v195, v211
v_cvt_pk_bf16_f32 v152, v188, v189
v_cvt_pk_bf16_f32 v153, v190, v191
v_cvt_pk_bf16_f32 v154, v192, v193
v_cvt_pk_bf16_f32 v155, v194, v195
ds_read_b128 v[188:191], v5 offset:1024
ds_read_b128 v[192:195], v5 offset:1040
ds_read_b128 v[196:199], v5 offset:3072
ds_read_b128 v[200:203], v5 offset:3088
ds_read_b128 v[204:207], v5 offset:5120
ds_read_b128 v[208:211], v5 offset:5136
ds_read_b128 v[212:215], v5 offset:7168
ds_read_b128 v[216:219], v5 offset:7184
s_waitcnt lgkmcnt(0)
v_add_f32 v188, v188, v196
v_add_f32 v204, v204, v212
v_add_f32 v189, v189, v197
v_add_f32 v205, v205, v213
v_add_f32 v190, v190, v198
v_add_f32 v206, v206, v214
v_add_f32 v191, v191, v199
v_add_f32 v207, v207, v215
v_add_f32 v192, v192, v200
v_add_f32 v208, v208, v216
v_add_f32 v193, v193, v201
v_add_f32 v209, v209, v217
v_add_f32 v194, v194, v202
v_add_f32 v210, v210, v218
v_add_f32 v195, v195, v203
v_add_f32 v211, v211, v219
v_add_f32 v188, v188, v204
v_add_f32 v189, v189, v205
v_add_f32 v190, v190, v206
v_add_f32 v191, v191, v207
v_add_f32 v192, v192, v208
v_add_f32 v193, v193, v209
v_add_f32 v194, v194, v210
v_add_f32 v195, v195, v211
v_cvt_pk_bf16_f32 v156, v188, v189
v_cvt_pk_bf16_f32 v157, v190, v191
v_cvt_pk_bf16_f32 v158, v192, v193
v_cvt_pk_bf16_f32 v159, v194, v195
ds_read_b128 v[188:191], v5 offset:1536
ds_read_b128 v[192:195], v5 offset:1552
ds_read_b128 v[196:199], v5 offset:3584
ds_read_b128 v[200:203], v5 offset:3600
ds_read_b128 v[204:207], v5 offset:5632
ds_read_b128 v[208:211], v5 offset:5648
ds_read_b128 v[212:215], v5 offset:7680
ds_read_b128 v[216:219], v5 offset:7696
s_waitcnt lgkmcnt(0)
v_add_f32 v188, v188, v196
v_add_f32 v204, v204, v212
v_add_f32 v189, v189, v197
v_add_f32 v205, v205, v213
v_add_f32 v190, v190, v198
v_add_f32 v206, v206, v214
v_add_f32 v191, v191, v199
v_add_f32 v207, v207, v215
v_add_f32 v192, v192, v200
v_add_f32 v208, v208, v216
v_add_f32 v193, v193, v201
v_add_f32 v209, v209, v217
v_add_f32 v194, v194, v202
v_add_f32 v210, v210, v218
v_add_f32 v195, v195, v203
v_add_f32 v211, v211, v219
v_add_f32 v188, v188, v204
v_add_f32 v189, v189, v205
v_add_f32 v190, v190, v206
v_add_f32 v191, v191, v207
v_add_f32 v192, v192, v208
v_add_f32 v193, v193, v209
v_add_f32 v194, v194, v210
v_add_f32 v195, v195, v211
v_cvt_pk_bf16_f32 v160, v188, v189
v_cvt_pk_bf16_f32 v161, v190, v191
v_cvt_pk_bf16_f32 v162, v192, v193
v_cvt_pk_bf16_f32 v163, v194, v195
s_waitcnt vmcnt(33)
v_dot2_f32_bf16 v164, v84, v148, 0
v_dot2_f32_bf16 v165, v84, v152, 0
v_dot2_f32_bf16 v166, v84, v156, 0
v_dot2_f32_bf16 v167, v84, v160, 0
v_dot2_f32_bf16 v164, v85, v149, v164
v_dot2_f32_bf16 v165, v85, v153, v165
v_dot2_f32_bf16 v166, v85, v157, v166
v_dot2_f32_bf16 v167, v85, v161, v167
v_dot2_f32_bf16 v164, v86, v150, v164
v_dot2_f32_bf16 v165, v86, v154, v165
v_dot2_f32_bf16 v166, v86, v158, v166
v_dot2_f32_bf16 v167, v86, v162, v167
v_dot2_f32_bf16 v164, v87, v151, v164
v_dot2_f32_bf16 v165, v87, v155, v165
v_dot2_f32_bf16 v166, v87, v159, v166
v_dot2_f32_bf16 v167, v87, v163, v167
v_add_f32_dpp v168, v164, v164 row_ror:8 row_mask:0xf bank_mask:0x3
v_add_f32_dpp v169, v165, v165 row_ror:8 row_mask:0xf bank_mask:0x3
v_add_f32_dpp v168, v166, v166 row_ror:8 row_mask:0xf bank_mask:0xc
v_add_f32_dpp v169, v167, v167 row_ror:8 row_mask:0xf bank_mask:0xc
s_nop 0
v_add_f32_dpp v172, v168, v168 row_half_mirror row_mask:0xf bank_mask:0x5
v_add_f32_dpp v172, v169, v169 row_half_mirror row_mask:0xf bank_mask:0xa
s_nop 1
v_add_f32_dpp v172, v172, v172 quad_perm:[1,0,3,2] row_mask:0xf bank_mask:0xf
s_nop 1
v_add_f32_dpp v172, v172, v172 quad_perm:[2,3,0,1] row_mask:0xf bank_mask:0xf
v_dot2_f32_bf16 v164, v88, v148, 0
v_dot2_f32_bf16 v165, v88, v152, 0
v_dot2_f32_bf16 v166, v88, v156, 0
v_dot2_f32_bf16 v167, v88, v160, 0
v_dot2_f32_bf16 v164, v89, v149, v164
v_dot2_f32_bf16 v165, v89, v153, v165
v_dot2_f32_bf16 v166, v89, v157, v166
v_dot2_f32_bf16 v167, v89, v161, v167
v_dot2_f32_bf16 v164, v90, v150, v164
v_dot2_f32_bf16 v165, v90, v154, v165
v_dot2_f32_bf16 v166, v90, v158, v166
v_dot2_f32_bf16 v167, v90, v162, v167
v_dot2_f32_bf16 v164, v91, v151, v164
v_dot2_f32_bf16 v165, v91, v155, v165
v_dot2_f32_bf16 v166, v91, v159, v166
v_dot2_f32_bf16 v167, v91, v163, v167
v_add_f32_dpp v168, v164, v164 row_ror:8 row_mask:0xf bank_mask:0x3
v_add_f32_dpp v169, v165, v165 row_ror:8 row_mask:0xf bank_mask:0x3
v_add_f32_dpp v168, v166, v166 row_ror:8 row_mask:0xf bank_mask:0xc
v_add_f32_dpp v169, v167, v167 row_ror:8 row_mask:0xf bank_mask:0xc
s_nop 0
v_add_f32_dpp v173, v168, v168 row_half_mirror row_mask:0xf bank_mask:0x5
v_add_f32_dpp v173, v169, v169 row_half_mirror row_mask:0xf bank_mask:0xa
s_nop 1
v_add_f32_dpp v173, v173, v173 quad_perm:[1,0,3,2] row_mask:0xf bank_mask:0xf
s_nop 1
v_add_f32_dpp v173, v173, v173 quad_perm:[2,3,0,1] row_mask:0xf bank_mask:0xf
v_dot2_f32_bf16 v164, v92, v148, 0
v_dot2_f32_bf16 v165, v92, v152, 0
v_dot2_f32_bf16 v166, v92, v156, 0
v_dot2_f32_bf16 v167, v92, v160, 0
v_dot2_f32_bf16 v164, v93, v149, v164
v_dot2_f32_bf16 v165, v93, v153, v165
v_dot2_f32_bf16 v166, v93, v157, v166
v_dot2_f32_bf16 v167, v93, v161, v167
v_dot2_f32_bf16 v164, v94, v150, v164
v_dot2_f32_bf16 v165, v94, v154, v165
v_dot2_f32_bf16 v166, v94, v158, v166
v_dot2_f32_bf16 v167, v94, v162, v167
v_dot2_f32_bf16 v164, v95, v151, v164
v_dot2_f32_bf16 v165, v95, v155, v165
v_dot2_f32_bf16 v166, v95, v159, v166
v_dot2_f32_bf16 v167, v95, v163, v167
v_add_f32_dpp v168, v164, v164 row_ror:8 row_mask:0xf bank_mask:0x3
v_add_f32_dpp v169, v165, v165 row_ror:8 row_mask:0xf bank_mask:0x3
v_add_f32_dpp v168, v166, v166 row_ror:8 row_mask:0xf bank_mask:0xc
v_add_f32_dpp v169, v167, v167 row_ror:8 row_mask:0xf bank_mask:0xc
s_nop 0
v_add_f32_dpp v174, v168, v168 row_half_mirror row_mask:0xf bank_mask:0x5
v_add_f32_dpp v174, v169, v169 row_half_mirror row_mask:0xf bank_mask:0xa
s_nop 1
v_add_f32_dpp v174, v174, v174 quad_perm:[1,0,3,2] row_mask:0xf bank_mask:0xf
s_nop 1
v_add_f32_dpp v174, v174, v174 quad_perm:[2,3,0,1] row_mask:0xf bank_mask:0xf
v_dot2_f32_bf16 v164, v96, v148, 0
v_dot2_f32_bf16 v165, v96, v152, 0
v_dot2_f32_bf16 v166, v96, v156, 0
v_dot2_f32_bf16 v167, v96, v160, 0
v_dot2_f32_bf16 v164, v97, v149, v164
v_dot2_f32_bf16 v165, v97, v153, v165
v_dot2_f32_bf16 v166, v97, v157, v166
v_dot2_f32_bf16 v167, v97, v161, v167
v_dot2_f32_bf16 v164, v98, v150, v164
v_dot2_f32_bf16 v165, v98, v154, v165
v_dot2_f32_bf16 v166, v98, v158, v166
v_dot2_f32_bf16 v167, v98, v162, v167
v_dot2_f32_bf16 v164, v99, v151, v164
v_dot2_f32_bf16 v165, v99, v155, v165
v_dot2_f32_bf16 v166, v99, v159, v166
v_dot2_f32_bf16 v167, v99, v163, v167
v_add_f32_dpp v168, v164, v164 row_ror:8 row_mask:0xf bank_mask:0x3
v_add_f32_dpp v169, v165, v165 row_ror:8 row_mask:0xf bank_mask:0x3
v_add_f32_dpp v168, v166, v166 row_ror:8 row_mask:0xf bank_mask:0xc
v_add_f32_dpp v169, v167, v167 row_ror:8 row_mask:0xf bank_mask:0xc
s_nop 0
v_add_f32_dpp v175, v168, v168 row_half_mirror row_mask:0xf bank_mask:0x5
v_add_f32_dpp v175, v169, v169 row_half_mirror row_mask:0xf bank_mask:0xa
s_nop 1
v_add_f32_dpp v175, v175, v175 quad_perm:[1,0,3,2] row_mask:0xf bank_mask:0xf
s_nop 1
v_add_f32_dpp v175, v175, v175 quad_perm:[2,3,0,1] row_mask:0xf bank_mask:0xf
v_dot2_f32_bf16 v164, v100, v148, 0
v_dot2_f32_bf16 v165, v100, v152, 0
v_dot2_f32_bf16 v166, v100, v156, 0
v_dot2_f32_bf16 v167, v100, v160, 0
v_dot2_f32_bf16 v164, v101, v149, v164
v_dot2_f32_bf16 v165, v101, v153, v165
v_dot2_f32_bf16 v166, v101, v157, v166
v_dot2_f32_bf16 v167, v101, v161, v167
v_dot2_f32_bf16 v164, v102, v150, v164
v_dot2_f32_bf16 v165, v102, v154, v165
v_dot2_f32_bf16 v166, v102, v158, v166
v_dot2_f32_bf16 v167, v102, v162, v167
v_dot2_f32_bf16 v164, v103, v151, v164
v_dot2_f32_bf16 v165, v103, v155, v165
v_dot2_f32_bf16 v166, v103, v159, v166
v_dot2_f32_bf16 v167, v103, v163, v167
v_add_f32_dpp v168, v164, v164 row_ror:8 row_mask:0xf bank_mask:0x3
v_add_f32_dpp v169, v165, v165 row_ror:8 row_mask:0xf bank_mask:0x3
v_add_f32_dpp v168, v166, v166 row_ror:8 row_mask:0xf bank_mask:0xc
v_add_f32_dpp v169, v167, v167 row_ror:8 row_mask:0xf bank_mask:0xc
s_nop 0
v_add_f32_dpp v176, v168, v168 row_half_mirror row_mask:0xf bank_mask:0x5
v_add_f32_dpp v176, v169, v169 row_half_mirror row_mask:0xf bank_mask:0xa
s_nop 1
v_add_f32_dpp v176, v176, v176 quad_perm:[1,0,3,2] row_mask:0xf bank_mask:0xf
s_nop 1
v_add_f32_dpp v176, v176, v176 quad_perm:[2,3,0,1] row_mask:0xf bank_mask:0xf
v_dot2_f32_bf16 v164, v104, v148, 0
v_dot2_f32_bf16 v165, v104, v152, 0
v_dot2_f32_bf16 v166, v104, v156, 0
v_dot2_f32_bf16 v167, v104, v160, 0
v_dot2_f32_bf16 v164, v105, v149, v164
v_dot2_f32_bf16 v165, v105, v153, v165
v_dot2_f32_bf16 v166, v105, v157, v166
v_dot2_f32_bf16 v167, v105, v161, v167
v_dot2_f32_bf16 v164, v106, v150, v164
v_dot2_f32_bf16 v165, v106, v154, v165
v_dot2_f32_bf16 v166, v106, v158, v166
v_dot2_f32_bf16 v167, v106, v162, v167
v_dot2_f32_bf16 v164, v107, v151, v164
v_dot2_f32_bf16 v165, v107, v155, v165
v_dot2_f32_bf16 v166, v107, v159, v166
v_dot2_f32_bf16 v167, v107, v163, v167
v_add_f32_dpp v168, v164, v164 row_ror:8 row_mask:0xf bank_mask:0x3
v_add_f32_dpp v169, v165, v165 row_ror:8 row_mask:0xf bank_mask:0x3
v_add_f32_dpp v168, v166, v166 row_ror:8 row_mask:0xf bank_mask:0xc
v_add_f32_dpp v169, v167, v167 row_ror:8 row_mask:0xf bank_mask:0xc
s_nop 0
v_add_f32_dpp v177, v168, v168 row_half_mirror row_mask:0xf bank_mask:0x5
v_add_f32_dpp v177, v169, v169 row_half_mirror row_mask:0xf bank_mask:0xa
s_nop 1
v_add_f32_dpp v177, v177, v177 quad_perm:[1,0,3,2] row_mask:0xf bank_mask:0xf
s_nop 1
v_add_f32_dpp v177, v177, v177 quad_perm:[2,3,0,1] row_mask:0xf bank_mask:0xf
v_dot2_f32_bf16 v164, v108, v148, 0
v_dot2_f32_bf16 v165, v108, v152, 0
v_dot2_f32_bf16 v166, v108, v156, 0
v_dot2_f32_bf16 v167, v108, v160, 0
v_dot2_f32_bf16 v164, v109, v149, v164
v_dot2_f32_bf16 v165, v109, v153, v165
v_dot2_f32_bf16 v166, v109, v157, v166
v_dot2_f32_bf16 v167, v109, v161, v167
v_dot2_f32_bf16 v164, v110, v150, v164
v_dot2_f32_bf16 v165, v110, v154, v165
v_dot2_f32_bf16 v166, v110, v158, v166
v_dot2_f32_bf16 v167, v110, v162, v167
v_dot2_f32_bf16 v164, v111, v151, v164
v_dot2_f32_bf16 v165, v111, v155, v165
v_dot2_f32_bf16 v166, v111, v159, v166
v_dot2_f32_bf16 v167, v111, v163, v167
v_add_f32_dpp v168, v164, v164 row_ror:8 row_mask:0xf bank_mask:0x3
v_add_f32_dpp v169, v165, v165 row_ror:8 row_mask:0xf bank_mask:0x3
v_add_f32_dpp v168, v166, v166 row_ror:8 row_mask:0xf bank_mask:0xc
v_add_f32_dpp v169, v167, v167 row_ror:8 row_mask:0xf bank_mask:0xc
s_nop 0
v_add_f32_dpp v178, v168, v168 row_half_mirror row_mask:0xf bank_mask:0x5
v_add_f32_dpp v178, v169, v169 row_half_mirror row_mask:0xf bank_mask:0xa
s_nop 1
v_add_f32_dpp v178, v178, v178 quad_perm:[1,0,3,2] row_mask:0xf bank_mask:0xf
s_nop 1
v_add_f32_dpp v178, v178, v178 quad_perm:[2,3,0,1] row_mask:0xf bank_mask:0xf
v_dot2_f32_bf16 v164, v112, v148, 0
v_dot2_f32_bf16 v165, v112, v152, 0
v_dot2_f32_bf16 v166, v112, v156, 0
v_dot2_f32_bf16 v167, v112, v160, 0
v_dot2_f32_bf16 v164, v113, v149, v164
v_dot2_f32_bf16 v165, v113, v153, v165
v_dot2_f32_bf16 v166, v113, v157, v166
v_dot2_f32_bf16 v167, v113, v161, v167
v_dot2_f32_bf16 v164, v114, v150, v164
v_dot2_f32_bf16 v165, v114, v154, v165
v_dot2_f32_bf16 v166, v114, v158, v166
v_dot2_f32_bf16 v167, v114, v162, v167
v_dot2_f32_bf16 v164, v115, v151, v164
v_dot2_f32_bf16 v165, v115, v155, v165
v_dot2_f32_bf16 v166, v115, v159, v166
v_dot2_f32_bf16 v167, v115, v163, v167
v_add_f32_dpp v168, v164, v164 row_ror:8 row_mask:0xf bank_mask:0x3
v_add_f32_dpp v169, v165, v165 row_ror:8 row_mask:0xf bank_mask:0x3
v_add_f32_dpp v168, v166, v166 row_ror:8 row_mask:0xf bank_mask:0xc
v_add_f32_dpp v169, v167, v167 row_ror:8 row_mask:0xf bank_mask:0xc
s_nop 0
v_add_f32_dpp v179, v168, v168 row_half_mirror row_mask:0xf bank_mask:0x5
v_add_f32_dpp v179, v169, v169 row_half_mirror row_mask:0xf bank_mask:0xa
s_nop 1
v_add_f32_dpp v179, v179, v179 quad_perm:[1,0,3,2] row_mask:0xf bank_mask:0xf
s_nop 1
v_add_f32_dpp v179, v179, v179 quad_perm:[2,3,0,1] row_mask:0xf bank_mask:0xf
v_dot2_f32_bf16 v164, v116, v148, 0
v_dot2_f32_bf16 v165, v116, v152, 0
v_dot2_f32_bf16 v166, v116, v156, 0
v_dot2_f32_bf16 v167, v116, v160, 0
v_dot2_f32_bf16 v164, v117, v149, v164
v_dot2_f32_bf16 v165, v117, v153, v165
v_dot2_f32_bf16 v166, v117, v157, v166
v_dot2_f32_bf16 v167, v117, v161, v167
v_dot2_f32_bf16 v164, v118, v150, v164
v_dot2_f32_bf16 v165, v118, v154, v165
v_dot2_f32_bf16 v166, v118, v158, v166
v_dot2_f32_bf16 v167, v118, v162, v167
v_dot2_f32_bf16 v164, v119, v151, v164
v_dot2_f32_bf16 v165, v119, v155, v165
v_dot2_f32_bf16 v166, v119, v159, v166
v_dot2_f32_bf16 v167, v119, v163, v167
v_add_f32_dpp v168, v164, v164 row_ror:8 row_mask:0xf bank_mask:0x3
v_add_f32_dpp v169, v165, v165 row_ror:8 row_mask:0xf bank_mask:0x3
v_add_f32_dpp v168, v166, v166 row_ror:8 row_mask:0xf bank_mask:0xc
v_add_f32_dpp v169, v167, v167 row_ror:8 row_mask:0xf bank_mask:0xc
s_nop 0
v_add_f32_dpp v180, v168, v168 row_half_mirror row_mask:0xf bank_mask:0x5
v_add_f32_dpp v180, v169, v169 row_half_mirror row_mask:0xf bank_mask:0xa
s_nop 1
v_add_f32_dpp v180, v180, v180 quad_perm:[1,0,3,2] row_mask:0xf bank_mask:0xf
s_nop 1
v_add_f32_dpp v180, v180, v180 quad_perm:[2,3,0,1] row_mask:0xf bank_mask:0xf
v_dot2_f32_bf16 v164, v120, v148, 0
v_dot2_f32_bf16 v165, v120, v152, 0
v_dot2_f32_bf16 v166, v120, v156, 0
v_dot2_f32_bf16 v167, v120, v160, 0
v_dot2_f32_bf16 v164, v121, v149, v164
v_dot2_f32_bf16 v165, v121, v153, v165
v_dot2_f32_bf16 v166, v121, v157, v166
v_dot2_f32_bf16 v167, v121, v161, v167
v_dot2_f32_bf16 v164, v122, v150, v164
v_dot2_f32_bf16 v165, v122, v154, v165
v_dot2_f32_bf16 v166, v122, v158, v166
v_dot2_f32_bf16 v167, v122, v162, v167
v_dot2_f32_bf16 v164, v123, v151, v164
v_dot2_f32_bf16 v165, v123, v155, v165
v_dot2_f32_bf16 v166, v123, v159, v166
v_dot2_f32_bf16 v167, v123, v163, v167
v_add_f32_dpp v168, v164, v164 row_ror:8 row_mask:0xf bank_mask:0x3
v_add_f32_dpp v169, v165, v165 row_ror:8 row_mask:0xf bank_mask:0x3
v_add_f32_dpp v168, v166, v166 row_ror:8 row_mask:0xf bank_mask:0xc
v_add_f32_dpp v169, v167, v167 row_ror:8 row_mask:0xf bank_mask:0xc
s_nop 0
v_add_f32_dpp v181, v168, v168 row_half_mirror row_mask:0xf bank_mask:0x5
v_add_f32_dpp v181, v169, v169 row_half_mirror row_mask:0xf bank_mask:0xa
s_nop 1
v_add_f32_dpp v181, v181, v181 quad_perm:[1,0,3,2] row_mask:0xf bank_mask:0xf
s_nop 1
v_add_f32_dpp v181, v181, v181 quad_perm:[2,3,0,1] row_mask:0xf bank_mask:0xf
v_dot2_f32_bf16 v164, v124, v148, 0
v_dot2_f32_bf16 v165, v124, v152, 0
v_dot2_f32_bf16 v166, v124, v156, 0
v_dot2_f32_bf16 v167, v124, v160, 0
v_dot2_f32_bf16 v164, v125, v149, v164
v_dot2_f32_bf16 v165, v125, v153, v165
v_dot2_f32_bf16 v166, v125, v157, v166
v_dot2_f32_bf16 v167, v125, v161, v167
v_dot2_f32_bf16 v164, v126, v150, v164
v_dot2_f32_bf16 v165, v126, v154, v165
v_dot2_f32_bf16 v166, v126, v158, v166
v_dot2_f32_bf16 v167, v126, v162, v167
v_dot2_f32_bf16 v164, v127, v151, v164
v_dot2_f32_bf16 v165, v127, v155, v165
v_dot2_f32_bf16 v166, v127, v159, v166
v_dot2_f32_bf16 v167, v127, v163, v167
v_add_f32_dpp v168, v164, v164 row_ror:8 row_mask:0xf bank_mask:0x3
v_add_f32_dpp v169, v165, v165 row_ror:8 row_mask:0xf bank_mask:0x3
v_add_f32_dpp v168, v166, v166 row_ror:8 row_mask:0xf bank_mask:0xc
v_add_f32_dpp v169, v167, v167 row_ror:8 row_mask:0xf bank_mask:0xc
s_nop 0
v_add_f32_dpp v182, v168, v168 row_half_mirror row_mask:0xf bank_mask:0x5
v_add_f32_dpp v182, v169, v169 row_half_mirror row_mask:0xf bank_mask:0xa
s_nop 1
v_add_f32_dpp v182, v182, v182 quad_perm:[1,0,3,2] row_mask:0xf bank_mask:0xf
s_nop 1
v_add_f32_dpp v182, v182, v182 quad_perm:[2,3,0,1] row_mask:0xf bank_mask:0xf
v_dot2_f32_bf16 v164, v128, v148, 0
v_dot2_f32_bf16 v165, v128, v152, 0
v_dot2_f32_bf16 v166, v128, v156, 0
v_dot2_f32_bf16 v167, v128, v160, 0
v_dot2_f32_bf16 v164, v129, v149, v164
v_dot2_f32_bf16 v165, v129, v153, v165
v_dot2_f32_bf16 v166, v129, v157, v166
v_dot2_f32_bf16 v167, v129, v161, v167
v_dot2_f32_bf16 v164, v130, v150, v164
v_dot2_f32_bf16 v165, v130, v154, v165
v_dot2_f32_bf16 v166, v130, v158, v166
v_dot2_f32_bf16 v167, v130, v162, v167
v_dot2_f32_bf16 v164, v131, v151, v164
v_dot2_f32_bf16 v165, v131, v155, v165
v_dot2_f32_bf16 v166, v131, v159, v166
v_dot2_f32_bf16 v167, v131, v163, v167
v_add_f32_dpp v168, v164, v164 row_ror:8 row_mask:0xf bank_mask:0x3
v_add_f32_dpp v169, v165, v165 row_ror:8 row_mask:0xf bank_mask:0x3
v_add_f32_dpp v168, v166, v166 row_ror:8 row_mask:0xf bank_mask:0xc
v_add_f32_dpp v169, v167, v167 row_ror:8 row_mask:0xf bank_mask:0xc
s_nop 0
v_add_f32_dpp v183, v168, v168 row_half_mirror row_mask:0xf bank_mask:0x5
v_add_f32_dpp v183, v169, v169 row_half_mirror row_mask:0xf bank_mask:0xa
s_nop 1
v_add_f32_dpp v183, v183, v183 quad_perm:[1,0,3,2] row_mask:0xf bank_mask:0xf
s_nop 1
v_add_f32_dpp v183, v183, v183 quad_perm:[2,3,0,1] row_mask:0xf bank_mask:0xf
v_dot2_f32_bf16 v164, v132, v148, 0
v_dot2_f32_bf16 v165, v132, v152, 0
v_dot2_f32_bf16 v166, v132, v156, 0
v_dot2_f32_bf16 v167, v132, v160, 0
v_dot2_f32_bf16 v164, v133, v149, v164
v_dot2_f32_bf16 v165, v133, v153, v165
v_dot2_f32_bf16 v166, v133, v157, v166
v_dot2_f32_bf16 v167, v133, v161, v167
v_dot2_f32_bf16 v164, v134, v150, v164
v_dot2_f32_bf16 v165, v134, v154, v165
v_dot2_f32_bf16 v166, v134, v158, v166
v_dot2_f32_bf16 v167, v134, v162, v167
v_dot2_f32_bf16 v164, v135, v151, v164
v_dot2_f32_bf16 v165, v135, v155, v165
v_dot2_f32_bf16 v166, v135, v159, v166
v_dot2_f32_bf16 v167, v135, v163, v167
v_add_f32_dpp v168, v164, v164 row_ror:8 row_mask:0xf bank_mask:0x3
v_add_f32_dpp v169, v165, v165 row_ror:8 row_mask:0xf bank_mask:0x3
v_add_f32_dpp v168, v166, v166 row_ror:8 row_mask:0xf bank_mask:0xc
v_add_f32_dpp v169, v167, v167 row_ror:8 row_mask:0xf bank_mask:0xc
s_nop 0
v_add_f32_dpp v184, v168, v168 row_half_mirror row_mask:0xf bank_mask:0x5
v_add_f32_dpp v184, v169, v169 row_half_mirror row_mask:0xf bank_mask:0xa
s_nop 1
v_add_f32_dpp v184, v184, v184 quad_perm:[1,0,3,2] row_mask:0xf bank_mask:0xf
s_nop 1
v_add_f32_dpp v184, v184, v184 quad_perm:[2,3,0,1] row_mask:0xf bank_mask:0xf
v_dot2_f32_bf16 v164, v136, v148, 0
v_dot2_f32_bf16 v165, v136, v152, 0
v_dot2_f32_bf16 v166, v136, v156, 0
v_dot2_f32_bf16 v167, v136, v160, 0
v_dot2_f32_bf16 v164, v137, v149, v164
v_dot2_f32_bf16 v165, v137, v153, v165
v_dot2_f32_bf16 v166, v137, v157, v166
v_dot2_f32_bf16 v167, v137, v161, v167
v_dot2_f32_bf16 v164, v138, v150, v164
v_dot2_f32_bf16 v165, v138, v154, v165
v_dot2_f32_bf16 v166, v138, v158, v166
v_dot2_f32_bf16 v167, v138, v162, v167
v_dot2_f32_bf16 v164, v139, v151, v164
v_dot2_f32_bf16 v165, v139, v155, v165
v_dot2_f32_bf16 v166, v139, v159, v166
v_dot2_f32_bf16 v167, v139, v163, v167
v_add_f32_dpp v168, v164, v164 row_ror:8 row_mask:0xf bank_mask:0x3
v_add_f32_dpp v169, v165, v165 row_ror:8 row_mask:0xf bank_mask:0x3
v_add_f32_dpp v168, v166, v166 row_ror:8 row_mask:0xf bank_mask:0xc
v_add_f32_dpp v169, v167, v167 row_ror:8 row_mask:0xf bank_mask:0xc
s_nop 0
v_add_f32_dpp v185, v168, v168 row_half_mirror row_mask:0xf bank_mask:0x5
v_add_f32_dpp v185, v169, v169 row_half_mirror row_mask:0xf bank_mask:0xa
s_nop 1
v_add_f32_dpp v185, v185, v185 quad_perm:[1,0,3,2] row_mask:0xf bank_mask:0xf
s_nop 1
v_add_f32_dpp v185, v185, v185 quad_perm:[2,3,0,1] row_mask:0xf bank_mask:0xf
v_dot2_f32_bf16 v164, v140, v148, 0
v_dot2_f32_bf16 v165, v140, v152, 0
v_dot2_f32_bf16 v166, v140, v156, 0
v_dot2_f32_bf16 v167, v140, v160, 0
v_dot2_f32_bf16 v164, v141, v149, v164
v_dot2_f32_bf16 v165, v141, v153, v165
v_dot2_f32_bf16 v166, v141, v157, v166
v_dot2_f32_bf16 v167, v141, v161, v167
v_dot2_f32_bf16 v164, v142, v150, v164
v_dot2_f32_bf16 v165, v142, v154, v165
v_dot2_f32_bf16 v166, v142, v158, v166
v_dot2_f32_bf16 v167, v142, v162, v167
v_dot2_f32_bf16 v164, v143, v151, v164
v_dot2_f32_bf16 v165, v143, v155, v165
v_dot2_f32_bf16 v166, v143, v159, v166
v_dot2_f32_bf16 v167, v143, v163, v167
v_add_f32_dpp v168, v164, v164 row_ror:8 row_mask:0xf bank_mask:0x3
v_add_f32_dpp v169, v165, v165 row_ror:8 row_mask:0xf bank_mask:0x3
v_add_f32_dpp v168, v166, v166 row_ror:8 row_mask:0xf bank_mask:0xc
v_add_f32_dpp v169, v167, v167 row_ror:8 row_mask:0xf bank_mask:0xc
s_nop 0
v_add_f32_dpp v186, v168, v168 row_half_mirror row_mask:0xf bank_mask:0x5
v_add_f32_dpp v186, v169, v169 row_half_mirror row_mask:0xf bank_mask:0xa
s_nop 1
v_add_f32_dpp v186, v186, v186 quad_perm:[1,0,3,2] row_mask:0xf bank_mask:0xf
s_nop 1
v_add_f32_dpp v186, v186, v186 quad_perm:[2,3,0,1] row_mask:0xf bank_mask:0xf
v_dot2_f32_bf16 v164, v144, v148, 0
v_dot2_f32_bf16 v165, v144, v152, 0
v_dot2_f32_bf16 v166, v144, v156, 0
v_dot2_f32_bf16 v167, v144, v160, 0
v_dot2_f32_bf16 v164, v145, v149, v164
v_dot2_f32_bf16 v165, v145, v153, v165
v_dot2_f32_bf16 v166, v145, v157, v166
v_dot2_f32_bf16 v167, v145, v161, v167
v_dot2_f32_bf16 v164, v146, v150, v164
v_dot2_f32_bf16 v165, v146, v154, v165
v_dot2_f32_bf16 v166, v146, v158, v166
v_dot2_f32_bf16 v167, v146, v162, v167
v_dot2_f32_bf16 v164, v147, v151, v164
v_dot2_f32_bf16 v165, v147, v155, v165
v_dot2_f32_bf16 v166, v147, v159, v166
v_dot2_f32_bf16 v167, v147, v163, v167
v_add_f32_dpp v168, v164, v164 row_ror:8 row_mask:0xf bank_mask:0x3
v_add_f32_dpp v169, v165, v165 row_ror:8 row_mask:0xf bank_mask:0x3
v_add_f32_dpp v168, v166, v166 row_ror:8 row_mask:0xf bank_mask:0xc
v_add_f32_dpp v169, v167, v167 row_ror:8 row_mask:0xf bank_mask:0xc
s_nop 0
v_add_f32_dpp v187, v168, v168 row_half_mirror row_mask:0xf bank_mask:0x5
v_add_f32_dpp v187, v169, v169 row_half_mirror row_mask:0xf bank_mask:0xa
s_nop 1
v_add_f32_dpp v187, v187, v187 quad_perm:[1,0,3,2] row_mask:0xf bank_mask:0xf
s_nop 1
v_add_f32_dpp v187, v187, v187 quad_perm:[2,3,0,1] row_mask:0xf bank_mask:0xf
v_cvt_pk_bf16_f32 v188, v172, v173
v_cvt_pk_bf16_f32 v189, v174, v175
v_cvt_pk_bf16_f32 v190, v176, v177
v_cvt_pk_bf16_f32 v191, v178, v179
v_cvt_pk_bf16_f32 v192, v180, v181
v_cvt_pk_bf16_f32 v193, v182, v183
v_cvt_pk_bf16_f32 v194, v184, v185
v_cvt_pk_bf16_f32 v195, v186, v187
v_min_u32 v188, -2, v188
v_min_u32 v189, -2, v189
v_min_u32 v190, -2, v190
v_min_u32 v191, -2, v191
v_min_u32 v192, -2, v192
v_min_u32 v193, -2, v193
v_min_u32 v194, -2, v194
v_min_u32 v195, -2, v195
v_bfe_u32 v5, v1, 2, 2
v_lshlrev_b32 v5, 15, v5
v_lshl_add_u32 v5, v9, 5, v5
s_lshl_b32 s6, s4, 10
s_lshl_b32 s7, s8, 9
s_add_u32 s6, s6, s7
s_lshl_b32 s7, s3, 7
s_add_u32 s6, s6, s7
s_add_u32 s6, s6, 0
s_mov_b32 exec_lo, 0x11111111
s_mov_b32 exec_hi, 0x11111111
buffer_store_dwordx4 v[188:191], v5, s[64:67], s6 offen sc1
buffer_store_dwordx4 v[192:195], v5, s[64:67], s6 offen offset:16 sc1
s_mov_b64 exec, -1
s_waitcnt vmcnt(6)
s_mov_b32 s7, 400000
L_ens_20:
v_readfirstlane_b32 s6, v11
s_cmp_ge_u32 s6, 128
s_cbranch_scc1 L_ensd_21
s_sleep 16
buffer_load_dword v11, off, s[68:71], 0 offset:0 sc1
s_waitcnt vmcnt(0)
s_sub_u32 s7, s7, 1
s_cmp_lg_u32 s7, 0
s_cbranch_scc1 L_ens_20
L_ensd_21:
s_lshl_b32 s14, s10, 15
s_lshl_b32 s6, s3, 12
s_add_u32 s14, s14, s6
s_add_u32 s14, s14, 0
s_add_u32 s15, s14, 16384
s_nop 1
buffer_load_dwordx4 v[84:87], v2, s[64:67], s14 offen offset:0 sc1
buffer_load_dwordx4 v[88:91], v2, s[64:67], s14 offen offset:1024 sc1
buffer_load_dwordx4 v[92:95], v2, s[64:67], s14 offen offset:2048 sc1
buffer_load_dwordx4 v[96:99], v2, s[64:67], s14 offen offset:3072 sc1
buffer_load_dwordx4 v[100:103], v2, s[64:67], s15 offen offset:0 sc1
buffer_load_dwordx4 v[104:107], v2, s[64:67], s15 offen offset:1024 sc1
buffer_load_dwordx4 v[108:111], v2, s[64:67], s15 offen offset:2048 sc1
buffer_load_dwordx4 v[112:115], v2, s[64:67], s15 offen offset:3072 sc1
s_add_u32 s6, s13, 131072
buffer_load_dwordx4 a[128:131], v2, s[52:55], s6 offen
s_add_u32 s6, s13, 132096
buffer_load_dwordx4 a[132:135], v2, s[52:55], s6 offen
s_add_u32 s6, s13, 133120
buffer_load_dwordx4 a[136:139], v2, s[52:55], s6 offen
s_add_u32 s6, s13, 134144
buffer_load_dwordx4 a[140:143], v2, s[52:55], s6 offen
s_add_u32 s6, s13, 135168
buffer_load_dwordx4 a[144:147], v2, s[52:55], s6 offen
s_add_u32 s6, s13, 136192
buffer_load_dwordx4 a[148:151], v2, s[52:55], s6 offen
s_add_u32 s6, s13, 137216
buffer_load_dwordx4 a[152:155], v2, s[52:55], s6 offen
s_add_u32 s6, s13, 138240
buffer_load_dwordx4 a[156:159], v2, s[52:55], s6 offen
s_add_u32 s6, s13, 139264
buffer_load_dwordx4 a[160:163], v10, s[52:55], s6 offen
s_add_u32 s6, s13, 140288
buffer_load_dwordx4 a[164:167], v10, s[52:55], s6 offen
s_add_u32 s6, s13, 141312
buffer_load_dwordx4 a[168:171], v10, s[52:55], s6 offen
s_add_u32 s6, s13, 142336
buffer_load_dwordx4 a[172:175], v10, s[52:55], s6 offen
s_add_u32 s6, s13, 143360
buffer_load_dwordx4 a[176:179], v10, s[52:55], s6 offen
s_add_u32 s6, s13, 144384
buffer_load_dwordx4 a[180:183], v10, s[52:55], s6 offen
s_add_u32 s6, s13, 145408
buffer_load_dwordx4 a[184:187], v10, s[52:55], s6 offen
s_add_u32 s6, s13, 146432
buffer_load_dwordx4 a[188:191], v10, s[52:55], s6 offen
s_add_u32 s6, s13, 196608
buffer_load_dwordx4 a[192:195], v2, s[52:55], s6 offen
s_add_u32 s6, s13, 197632
buffer_load_dwordx4 a[196:199], v2, s[52:55], s6 offen
s_add_u32 s6, s13, 198656
buffer_load_dwordx4 a[200:203], v2, s[52:55], s6 offen
s_add_u32 s6, s13, 199680
buffer_load_dwordx4 a[204:207], v2, s[52:55], s6 offen
s_add_u32 s6, s13, 200704
buffer_load_dwordx4 a[208:211], v2, s[52:55], s6 offen
s_add_u32 s6, s13, 201728
buffer_load_dwordx4 a[212:215], v2, s[52:55], s6 offen
s_add_u32 s6, s13, 202752
buffer_load_dwordx4 a[216:219], v2, s[52:55], s6 offen
s_add_u32 s6, s13, 203776
buffer_load_dwordx4 a[220:223], v2, s[52:55], s6 offen
s_add_u32 s6, s13, 204800
buffer_load_dwordx4 a[224:227], v10, s[52:55], s6 offen
s_add_u32 s6, s13, 205824
buffer_load_dwordx4 a[228:231], v10, s[52:55], s6 offen
s_add_u32 s6, s13, 206848
buffer_load_dwordx4 a[232:235], v10, s[52:55], s6 offen
s_add_u32 s6, s13, 207872
buffer_load_dwordx4 a[236:239], v10, s[52:55], s6 offen
s_add_u32 s6, s13, 208896
buffer_load_dwordx4 a[240:243], v10, s[52:55], s6 offen
s_add_u32 s6, s13, 209920
buffer_load_dwordx4 a[244:247], v10, s[52:55], s6 offen
s_add_u32 s6, s13, 210944
buffer_load_dwordx4 a[248:251], v10, s[52:55], s6 offen
s_add_u32 s6, s13, 211968
buffer_load_dwordx4 a[252:255], v10, s[52:55], s6 offen
s_lshl_b32 s6, s3, 4
v_add_u32 v5, s6, v8
v_mul_u32_u24 v5, 1088, v5
v_lshrrev_b32 v6, 3, v8
v_lshlrev_b32 v6, 1, v6
v_xor_b32 v6, v6, v9
v_lshl_add_u32 v194, v6, 4, v5
v_add_u32 v195, 69632, v194
v_lshrrev_b32 v5, 5, v1
v_lshlrev_b32 v5, 3, v5
v_bfe_u32 v6, v1, 2, 2
v_add_u32 v5, v5, v6
v_mul_u32_u24 v5, 1088, v5
v_lshrrev_b32 v6, 1, v9
v_xor_b32 v6, v6, v9
v_and_b32 v6, 1, v6
v_lshl_add_u32 v5, v6, 5, v5
v_and_b32 v6, 3, v1
v_lshl_add_u32 v5, v6, 3, v5
s_lshl_b32 s6, s3, 8
v_add_u32 v196, s6, v5
v_add_u32 v197, 69632, v196
v_lshlrev_b32 v199, 4, v8
v_add_u32 v199, 160256, v199
s_lshl_b32 s6, s3, 2
v_add_u32 v198, s6, v199
v_and_b32 v5, 31, v1
v_lshlrev_b32 v200, 4, v5
v_add_u32 v200, 160256, v200
v_lshlrev_b32 v202, 5, v5
v_lshrrev_b32 v6, 5, v1
v_lshl_add_u32 v202, v6, 4, v202
v_add_u32 v202, 156160, v202
v_lshlrev_b32 v201, 5, v8
v_lshl_add_u32 v201, v9, 3, v201
s_lshl_b32 s6, s3, 10
s_add_u32 s6, s6, 156160
v_add_u32 v201, s6, v201
v_mul_u32_u24 v203, 1056, v8
v_lshl_add_u32 v203, v9, 4, v203
v_add_u32 v203, 139264, v203
s_mul_i32 s6, s3, 4224
s_add_u32 s6, s6, 139264
v_add_u32 v204, s6, v2
v_add_u32 v206, s12, v2
v_add_u32 v207, 69632, v206
v_mov_b32 v185, 0x3e0293ee
v_mov_b32 v176, 0xff800000
v_mov_b32 v177, 0xff800000
v_mov_b32 v178, 0xff800000
v_mov_b32 v180, 0
v_mov_b32 v181, 0
s_waitcnt vmcnt(32)
s_mov_b32 s7, 400000
Q_chk:
v_max3_u32 v192, v84, v85, v86
v_max3_u32 v192, v192, v87, v88
v_max3_u32 v192, v192, v89, v90
v_max3_u32 v192, v192, v91, v92
v_max3_u32 v192, v192, v93, v94
v_max3_u32 v192, v192, v95, v96
v_max3_u32 v192, v192, v97, v98
v_max3_u32 v192, v192, v99, v100
v_max3_u32 v192, v192, v101, v102
v_max3_u32 v192, v192, v103, v104
v_max3_u32 v192, v192, v105, v106
v_max3_u32 v192, v192, v107, v108
v_max3_u32 v192, v192, v109, v110
v_max3_u32 v192, v192, v111, v112
v_max3_u32 v192, v192, v113, v114
v_max_u32 v192, v192, v115
v_cmp_eq_u32 vcc, -1, v192
s_cbranch_vccz Q_ok
s_sleep 16
buffer_load_dwordx4 v[84:87], v2, s[64:67], s14 offen offset:0 sc1
buffer_load_dwordx4 v[88:91], v2, s[64:67], s14 offen offset:1024 sc1
buffer_load_dwordx4 v[92:95], v2, s[64:67], s14 offen offset:2048 sc1
buffer_load_dwordx4 v[96:99], v2, s[64:67], s14 offen offset:3072 sc1
buffer_load_dwordx4 v[100:103], v2, s[64:67], s15 offen offset:0 sc1
buffer_load_dwordx4 v[104:107], v2, s[64:67], s15 offen offset:1024 sc1
buffer_load_dwordx4 v[108:111], v2, s[64:67], s15 offen offset:2048 sc1
buffer_load_dwordx4 v[112:115], v2, s[64:67], s15 offen offset:3072 sc1
s_waitcnt vmcnt(0)
s_sub_u32 s7, s7, 1
s_cmp_lg_u32 s7, 0
s_cbranch_scc1 Q_chk
Q_ok:
s_barrier
ds_write_b128 v204, v[84:87] offset:0
ds_write_b128 v204, v[88:91] offset:1056
ds_write_b128 v204, v[92:95] offset:2112
ds_write_b128 v204, v[96:99] offset:3168
s_waitcnt lgkmcnt(0)
s_barrier
ds_read_b128 a[0:3], v203 offset:0
ds_read_b128 a[4:7], v203 offset:64
ds_read_b128 a[8:11], v203 offset:128
ds_read_b128 a[12:15], v203 offset:192
ds_read_b128 a[16:19], v203 offset:256
ds_read_b128 a[20:23], v203 offset:320
ds_read_b128 a[24:27], v203 offset:384
ds_read_b128 a[28:31], v203 offset:448
ds_read_b128 a[32:35], v203 offset:512
ds_read_b128 a[36:39], v203 offset:576
ds_read_b128 a[40:43], v203 offset:640
ds_read_b128 a[44:47], v203 offset:704
ds_read_b128 a[48:51], v203 offset:768
ds_read_b128 a[52:55], v203 offset:832
ds_read_b128 a[56:59], v203 offset:896
ds_read_b128 a[60:63], v203 offset:960
s_waitcnt lgkmcnt(0)
s_barrier
ds_write_b128 v204, v[100:103] offset:0
ds_write_b128 v204, v[104:107] offset:1056
ds_write_b128 v204, v[108:111] offset:2112
ds_write_b128 v204, v[112:115] offset:3168
s_waitcnt lgkmcnt(0)
s_barrier
ds_read_b128 a[64:67], v203 offset:0
ds_read_b128 a[68:71], v203 offset:64
ds_read_b128 a[72:75], v203 offset:128
ds_read_b128 a[76:79], v203 offset:192
ds_read_b128 a[80:83], v203 offset:256
ds_read_b128 a[84:87], v203 offset:320
ds_read_b128 a[88:91], v203 offset:384
ds_read_b128 a[92:95], v203 offset:448
ds_read_b128 a[96:99], v203 offset:512
ds_read_b128 a[100:103], v203 offset:576
ds_read_b128 a[104:107], v203 offset:640
ds_read_b128 a[108:111], v203 offset:704
ds_read_b128 a[112:115], v203 offset:768
ds_read_b128 a[116:119], v203 offset:832
ds_read_b128 a[120:123], v203 offset:896
ds_read_b128 a[124:127], v203 offset:960
s_waitcnt lgkmcnt(0)
ds_read_b128 v[84:87], v194 offset:0
ds_read_b128 v[88:91], v194 offset:64
ds_read_b128 v[92:95], v194 offset:128
ds_read_b128 v[96:99], v194 offset:192
ds_read_b128 v[100:103], v194 offset:256
ds_read_b128 v[104:107], v194 offset:320
ds_read_b128 v[108:111], v194 offset:384
ds_read_b128 v[112:115], v194 offset:448
ds_read_b128 v[116:119], v194 offset:512
ds_read_b128 v[120:123], v194 offset:576
ds_read_b128 v[124:127], v194 offset:640
ds_read_b128 v[128:131], v194 offset:704
ds_read_b128 v[132:135], v194 offset:768
ds_read_b128 v[136:139], v194 offset:832
ds_read_b128 v[140:143], v194 offset:896
ds_read_b128 v[144:147], v194 offset:960
s_waitcnt lgkmcnt(15)
v_mfma_f32_16x16x32_bf16 v[76:79], v[84:87], a[0:3], 0
v_mfma_f32_16x16x32_bf16 v[80:83], v[84:87], a[64:67], 0
s_waitcnt lgkmcnt(14)
v_mfma_f32_16x16x32_bf16 v[76:79], v[88:91], a[4:7], v[76:79]
v_mfma_f32_16x16x32_bf16 v[80:83], v[88:91], a[68:71], v[80:83]
s_waitcnt lgkmcnt(13)
v_mfma_f32_16x16x32_bf16 v[76:79], v[92:95], a[8:11], v[76:79]
v_mfma_f32_16x16x32_bf16 v[80:83], v[92:95], a[72:75], v[80:83]
s_waitcnt lgkmcnt(12)
v_mfma_f32_16x16x32_bf16 v[76:79], v[96:99], a[12:15], v[76:79]
v_mfma_f32_16x16x32_bf16 v[80:83], v[96:99], a[76:79], v[80:83]
s_waitcnt lgkmcnt(11)
v_mfma_f32_16x16x32_bf16 v[76:79], v[100:103], a[16:19], v[76:79]
v_mfma_f32_16x16x32_bf16 v[80:83], v[100:103], a[80:83], v[80:83]
s_waitcnt lgkmcnt(10)
v_mfma_f32_16x16x32_bf16 v[76:79], v[104:107], a[20:23], v[76:79]
v_mfma_f32_16x16x32_bf16 v[80:83], v[104:107], a[84:87], v[80:83]
s_waitcnt lgkmcnt(9)
v_mfma_f32_16x16x32_bf16 v[76:79], v[108:111], a[24:27], v[76:79]
v_mfma_f32_16x16x32_bf16 v[80:83], v[108:111], a[88:91], v[80:83]
s_waitcnt lgkmcnt(8)
v_mfma_f32_16x16x32_bf16 v[76:79], v[112:115], a[28:31], v[76:79]
v_mfma_f32_16x16x32_bf16 v[80:83], v[112:115], a[92:95], v[80:83]
s_waitcnt lgkmcnt(7)
v_mfma_f32_16x16x32_bf16 v[76:79], v[116:119], a[32:35], v[76:79]
v_mfma_f32_16x16x32_bf16 v[80:83], v[116:119], a[96:99], v[80:83]
s_waitcnt lgkmcnt(6)
v_mfma_f32_16x16x32_bf16 v[76:79], v[120:123], a[36:39], v[76:79]
v_mfma_f32_16x16x32_bf16 v[80:83], v[120:123], a[100:103], v[80:83]
s_waitcnt lgkmcnt(5)
v_mfma_f32_16x16x32_bf16 v[76:79], v[124:127], a[40:43], v[76:79]
v_mfma_f32_16x16x32_bf16 v[80:83], v[124:127], a[104:107], v[80:83]
s_waitcnt lgkmcnt(4)
v_mfma_f32_16x16x32_bf16 v[76:79], v[128:131], a[44:47], v[76:79]
v_mfma_f32_16x16x32_bf16 v[80:83], v[128:131], a[108:111], v[80:83]
s_waitcnt lgkmcnt(3)
v_mfma_f32_16x16x32_bf16 v[76:79], v[132:135], a[48:51], v[76:79]
v_mfma_f32_16x16x32_bf16 v[80:83], v[132:135], a[112:115], v[80:83]
s_waitcnt lgkmcnt(2)
v_mfma_f32_16x16x32_bf16 v[76:79], v[136:139], a[52:55], v[76:79]
v_mfma_f32_16x16x32_bf16 v[80:83], v[136:139], a[116:119], v[80:83]
s_waitcnt lgkmcnt(1)
v_mfma_f32_16x16x32_bf16 v[76:79], v[140:143], a[56:59], v[76:79]
v_mfma_f32_16x16x32_bf16 v[80:83], v[140:143], a[120:123], v[80:83]
s_waitcnt lgkmcnt(0)
v_mfma_f32_16x16x32_bf16 v[76:79], v[144:147], a[60:63], v[76:79]
v_mfma_f32_16x16x32_bf16 v[80:83], v[144:147], a[124:127], v[80:83]
s_nop 6
v_max_f32 v190, v76, v77
v_max3_f32 v190, v190, v78, v79
v_mov_b32 v192, v190
s_nop 1
v_permlane16_swap_b32 v190, v192
v_max_f32 v190, v190, v192
v_mov_b32 v192, v190
s_nop 1
v_permlane32_swap_b32 v190, v192
v_max_f32 v190, v190, v192
ds_write_b32 v198, v190 offset:0
v_max_f32 v191, v80, v81
v_max3_f32 v191, v191, v82, v83
v_mov_b32 v192, v191
s_nop 1
v_permlane16_swap_b32 v191, v192
v_max_f32 v191, v191, v192
v_mov_b32 v192, v191
s_nop 1
v_permlane32_swap_b32 v191, v192
v_max_f32 v191, v191, v192
ds_write_b32 v198, v191 offset:256
s_waitcnt lgkmcnt(0)
s_barrier
ds_read_b128 v[164:167], v199
ds_read_b128 v[168:171], v199 offset:256
ds_read_b128 v[172:175], v200
s_waitcnt lgkmcnt(0)
v_max_f32 v164, v164, v165
v_max3_f32 v164, v164, v166, v167
v_mul_f32 v164, v164, v185
v_max_f32 v164, v164, v176
v_sub_f32 v182, v176, v164
v_exp_f32 v182, v182
v_mov_b32 v176, v164
v_max_f32 v168, v168, v169
v_max3_f32 v168, v168, v170, v171
v_mul_f32 v168, v168, v185
v_max_f32 v168, v168, v177
v_sub_f32 v183, v177, v168
v_exp_f32 v183, v183
v_mov_b32 v177, v168
v_max_f32 v172, v172, v173
v_max3_f32 v172, v172, v174, v175
v_mul_f32 v172, v172, v185
v_max_f32 v172, v172, v178
v_sub_f32 v184, v178, v172
v_exp_f32 v184, v184
v_mov_b32 v178, v172
v_fma_f32 v76, v76, v185, -v176
v_fma_f32 v77, v77, v185, -v176
v_fma_f32 v78, v78, v185, -v176
v_fma_f32 v79, v79, v185, -v176
v_exp_f32 v76, v76
v_exp_f32 v77, v77
v_exp_f32 v78, v78
v_exp_f32 v79, v79
v_mul_f32 v180, v180, v182
v_cvt_pk_bf16_f32 v186, v76, v77
v_cvt_pk_bf16_f32 v187, v78, v79
ds_write_b64 v201, v[186:187] offset:0
v_add_f32 v180, v180, v76
v_add_f32 v180, v180, v77
v_add_f32 v180, v180, v78
v_add_f32 v180, v180, v79
v_fma_f32 v80, v80, v185, -v177
v_fma_f32 v81, v81, v185, -v177
v_fma_f32 v82, v82, v185, -v177
v_fma_f32 v83, v83, v185, -v177
v_exp_f32 v80, v80
v_exp_f32 v81, v81
v_exp_f32 v82, v82
v_exp_f32 v83, v83
v_mul_f32 v181, v181, v183
v_cvt_pk_bf16_f32 v188, v80, v81
v_cvt_pk_bf16_f32 v189, v82, v83
ds_write_b64 v201, v[188:189] offset:512
v_add_f32 v181, v181, v80
v_add_f32 v181, v181, v81
v_add_f32 v181, v181, v82
v_add_f32 v181, v181, v83
s_waitcnt lgkmcnt(0)
s_barrier
ds_read_b128 v[148:151], v202 offset:0
ds_read_b128 v[152:155], v202 offset:1024
ds_read_b128 v[156:159], v202 offset:2048
ds_read_b128 v[160:163], v202 offset:3072
ds_read_b64_tr_b16 v[84:85], v196 offset:0
ds_read_b64_tr_b16 v[86:87], v196 offset:4352
ds_read_b64_tr_b16 v[88:89], v196 offset:64
ds_read_b64_tr_b16 v[90:91], v196 offset:4416
ds_read_b64_tr_b16 v[92:93], v196 offset:128
ds_read_b64_tr_b16 v[94:95], v196 offset:4480
ds_read_b64_tr_b16 v[96:97], v196 offset:192
ds_read_b64_tr_b16 v[98:99], v196 offset:4544
ds_read_b64_tr_b16 v[100:101], v196 offset:17408
ds_read_b64_tr_b16 v[102:103], v196 offset:21760
ds_read_b64_tr_b16 v[104:105], v196 offset:17472
ds_read_b64_tr_b16 v[106:107], v196 offset:21824
ds_read_b64_tr_b16 v[108:109], v196 offset:17536
ds_read_b64_tr_b16 v[110:111], v196 offset:21888
ds_read_b64_tr_b16 v[112:113], v196 offset:17600
ds_read_b64_tr_b16 v[114:115], v196 offset:21952
ds_read_b64_tr_b16 v[116:117], v196 offset:34816
ds_read_b64_tr_b16 v[118:119], v196 offset:39168
ds_read_b64_tr_b16 v[120:121], v196 offset:34880
ds_read_b64_tr_b16 v[122:123], v196 offset:39232
ds_read_b64_tr_b16 v[124:125], v196 offset:34944
ds_read_b64_tr_b16 v[126:127], v196 offset:39296
ds_read_b64_tr_b16 v[128:129], v196 offset:35008
ds_read_b64_tr_b16 v[130:131], v196 offset:39360
ds_read_b64_tr_b16 v[132:133], v196 offset:52224
ds_read_b64_tr_b16 v[134:135], v196 offset:56576
ds_read_b64_tr_b16 v[136:137], v196 offset:52288
ds_read_b64_tr_b16 v[138:139], v196 offset:56640
ds_read_b64_tr_b16 v[140:141], v196 offset:52352
ds_read_b64_tr_b16 v[142:143], v196 offset:56704
ds_read_b64_tr_b16 v[144:145], v196 offset:52416
ds_read_b64_tr_b16 v[146:147], v196 offset:56768
s_waitcnt lgkmcnt(15)
v_mfma_f32_32x32x16_bf16 v[12:27], v[84:87], v[148:151], 0
v_mfma_f32_32x32x16_bf16 v[28:43], v[88:91], v[148:151], 0
v_mfma_f32_32x32x16_bf16 v[44:59], v[92:95], v[148:151], 0
v_mfma_f32_32x32x16_bf16 v[60:75], v[96:99], v[148:151], 0
s_waitcnt lgkmcnt(15)
v_mfma_f32_32x32x16_bf16 v[12:27], v[100:103], v[152:155], v[12:27]
v_mfma_f32_32x32x16_bf16 v[28:43], v[104:107], v[152:155], v[28:43]
v_mfma_f32_32x32x16_bf16 v[44:59], v[108:111], v[152:155], v[44:59]
v_mfma_f32_32x32x16_bf16 v[60:75], v[112:115], v[152:155], v[60:75]
s_waitcnt lgkmcnt(8)
v_mfma_f32_32x32x16_bf16 v[12:27], v[116:119], v[156:159], v[12:27]
v_mfma_f32_32x32x16_bf16 v[28:43], v[120:123], v[156:159], v[28:43]
v_mfma_f32_32x32x16_bf16 v[44:59], v[124:127], v[156:159], v[44:59]
v_mfma_f32_32x32x16_bf16 v[60:75], v[128:131], v[156:159], v[60:75]
s_waitcnt lgkmcnt(0)
v_mfma_f32_32x32x16_bf16 v[12:27], v[132:135], v[160:163], v[12:27]
v_mfma_f32_32x32x16_bf16 v[28:43], v[136:139], v[160:163], v[28:43]
v_mfma_f32_32x32x16_bf16 v[44:59], v[140:143], v[160:163], v[44:59]
v_mfma_f32_32x32x16_bf16 v[60:75], v[144:147], v[160:163], v[60:75]
ds_read_b128 v[84:87], v195 offset:0
ds_read_b128 v[88:91], v195 offset:64
ds_read_b128 v[92:95], v195 offset:128
ds_read_b128 v[96:99], v195 offset:192
ds_read_b128 v[100:103], v195 offset:256
ds_read_b128 v[104:107], v195 offset:320
ds_read_b128 v[108:111], v195 offset:384
ds_read_b128 v[112:115], v195 offset:448
ds_read_b128 v[116:119], v195 offset:512
ds_read_b128 v[120:123], v195 offset:576
ds_read_b128 v[124:127], v195 offset:640
ds_read_b128 v[128:131], v195 offset:704
ds_read_b128 v[132:135], v195 offset:768
ds_read_b128 v[136:139], v195 offset:832
ds_read_b128 v[140:143], v195 offset:896
ds_read_b128 v[144:147], v195 offset:960
s_waitcnt lgkmcnt(15)
v_mfma_f32_16x16x32_bf16 v[76:79], v[84:87], a[0:3], 0
v_mfma_f32_16x16x32_bf16 v[80:83], v[84:87], a[64:67], 0
s_waitcnt lgkmcnt(14)
v_mfma_f32_16x16x32_bf16 v[76:79], v[88:91], a[4:7], v[76:79]
v_mfma_f32_16x16x32_bf16 v[80:83], v[88:91], a[68:71], v[80:83]
s_waitcnt lgkmcnt(13)
v_mfma_f32_16x16x32_bf16 v[76:79], v[92:95], a[8:11], v[76:79]
v_mfma_f32_16x16x32_bf16 v[80:83], v[92:95], a[72:75], v[80:83]
s_waitcnt lgkmcnt(12)
v_mfma_f32_16x16x32_bf16 v[76:79], v[96:99], a[12:15], v[76:79]
v_mfma_f32_16x16x32_bf16 v[80:83], v[96:99], a[76:79], v[80:83]
s_waitcnt lgkmcnt(11)
v_mfma_f32_16x16x32_bf16 v[76:79], v[100:103], a[16:19], v[76:79]
v_mfma_f32_16x16x32_bf16 v[80:83], v[100:103], a[80:83], v[80:83]
s_waitcnt lgkmcnt(10)
v_mfma_f32_16x16x32_bf16 v[76:79], v[104:107], a[20:23], v[76:79]
v_mfma_f32_16x16x32_bf16 v[80:83], v[104:107], a[84:87], v[80:83]
s_waitcnt lgkmcnt(9)
v_mfma_f32_16x16x32_bf16 v[76:79], v[108:111], a[24:27], v[76:79]
v_mfma_f32_16x16x32_bf16 v[80:83], v[108:111], a[88:91], v[80:83]
s_waitcnt lgkmcnt(8)
v_mfma_f32_16x16x32_bf16 v[76:79], v[112:115], a[28:31], v[76:79]
v_mfma_f32_16x16x32_bf16 v[80:83], v[112:115], a[92:95], v[80:83]
s_waitcnt lgkmcnt(7)
v_mfma_f32_16x16x32_bf16 v[76:79], v[116:119], a[32:35], v[76:79]
v_mfma_f32_16x16x32_bf16 v[80:83], v[116:119], a[96:99], v[80:83]
s_waitcnt lgkmcnt(6)
v_mfma_f32_16x16x32_bf16 v[76:79], v[120:123], a[36:39], v[76:79]
v_mfma_f32_16x16x32_bf16 v[80:83], v[120:123], a[100:103], v[80:83]
s_waitcnt lgkmcnt(5)
v_mfma_f32_16x16x32_bf16 v[76:79], v[124:127], a[40:43], v[76:79]
v_mfma_f32_16x16x32_bf16 v[80:83], v[124:127], a[104:107], v[80:83]
s_waitcnt lgkmcnt(4)
v_mfma_f32_16x16x32_bf16 v[76:79], v[128:131], a[44:47], v[76:79]
v_mfma_f32_16x16x32_bf16 v[80:83], v[128:131], a[108:111], v[80:83]
s_waitcnt lgkmcnt(3)
v_mfma_f32_16x16x32_bf16 v[76:79], v[132:135], a[48:51], v[76:79]
v_mfma_f32_16x16x32_bf16 v[80:83], v[132:135], a[112:115], v[80:83]
s_waitcnt lgkmcnt(2)
v_mfma_f32_16x16x32_bf16 v[76:79], v[136:139], a[52:55], v[76:79]
v_mfma_f32_16x16x32_bf16 v[80:83], v[136:139], a[116:119], v[80:83]
s_waitcnt lgkmcnt(1)
v_mfma_f32_16x16x32_bf16 v[76:79], v[140:143], a[56:59], v[76:79]
v_mfma_f32_16x16x32_bf16 v[80:83], v[140:143], a[120:123], v[80:83]
s_waitcnt lgkmcnt(0)
v_mfma_f32_16x16x32_bf16 v[76:79], v[144:147], a[60:63], v[76:79]
v_mfma_f32_16x16x32_bf16 v[80:83], v[144:147], a[124:127], v[80:83]
s_nop 6
v_max_f32 v190, v76, v77
v_max3_f32 v190, v190, v78, v79
v_mov_b32 v192, v190
s_nop 1
v_permlane16_swap_b32 v190, v192
v_max_f32 v190, v190, v192
v_mov_b32 v192, v190
s_nop 1
v_permlane32_swap_b32 v190, v192
v_max_f32 v190, v190, v192
ds_write_b32 v198, v190 offset:0
v_max_f32 v191, v80, v81
v_max3_f32 v191, v191, v82, v83
v_mov_b32 v192, v191
s_nop 1
v_permlane16_swap_b32 v191, v192
v_max_f32 v191, v191, v192
v_mov_b32 v192, v191
s_nop 1
v_permlane32_swap_b32 v191, v192
v_max_f32 v191, v191, v192
ds_write_b32 v198, v191 offset:256
s_waitcnt lgkmcnt(0)
s_barrier
ds_read_b128 v[164:167], v199
ds_read_b128 v[168:171], v199 offset:256
ds_read_b128 v[172:175], v200
s_waitcnt vmcnt(16)
ds_write_b128 v206, a[128:131] offset:0
ds_write_b128 v206, a[132:135] offset:1088
ds_write_b128 v206, a[136:139] offset:2176
ds_write_b128 v206, a[140:143] offset:3264
ds_write_b128 v206, a[144:147] offset:4352
ds_write_b128 v206, a[148:151] offset:5440
ds_write_b128 v206, a[152:155] offset:6528
ds_write_b128 v206, a[156:159] offset:7616
ds_write_b128 v206, a[160:163] offset:8704
ds_write_b128 v206, a[164:167] offset:9792
ds_write_b128 v206, a[168:171] offset:10880
ds_write_b128 v206, a[172:175] offset:11968
ds_write_b128 v206, a[176:179] offset:13056
ds_write_b128 v206, a[180:183] offset:14144
ds_write_b128 v206, a[184:187] offset:15232
ds_write_b128 v206, a[188:191] offset:16320
s_waitcnt lgkmcnt(15)
v_max_f32 v164, v164, v165
v_max3_f32 v164, v164, v166, v167
v_mul_f32 v164, v164, v185
v_max_f32 v164, v164, v176
v_sub_f32 v182, v176, v164
v_exp_f32 v182, v182
v_mov_b32 v176, v164
v_max_f32 v168, v168, v169
v_max3_f32 v168, v168, v170, v171
v_mul_f32 v168, v168, v185
v_max_f32 v168, v168, v177
v_sub_f32 v183, v177, v168
v_exp_f32 v183, v183
v_mov_b32 v177, v168
v_max_f32 v172, v172, v173
v_max3_f32 v172, v172, v174, v175
v_mul_f32 v172, v172, v185
v_max_f32 v172, v172, v178
v_sub_f32 v184, v178, v172
v_exp_f32 v184, v184
v_mov_b32 v178, v172
v_fma_f32 v76, v76, v185, -v176
v_fma_f32 v77, v77, v185, -v176
v_fma_f32 v78, v78, v185, -v176
v_fma_f32 v79, v79, v185, -v176
v_exp_f32 v76, v76
v_exp_f32 v77, v77
v_exp_f32 v78, v78
v_exp_f32 v79, v79
v_mul_f32 v180, v180, v182
v_cvt_pk_bf16_f32 v186, v76, v77
v_cvt_pk_bf16_f32 v187, v78, v79
ds_write_b64 v201, v[186:187] offset:0
v_add_f32 v180, v180, v76
v_add_f32 v180, v180, v77
v_add_f32 v180, v180, v78
v_add_f32 v180, v180, v79
v_fma_f32 v80, v80, v185, -v177
v_fma_f32 v81, v81, v185, -v177
v_fma_f32 v82, v82, v185, -v177
v_fma_f32 v83, v83, v185, -v177
v_exp_f32 v80, v80
v_exp_f32 v81, v81
v_exp_f32 v82, v82
v_exp_f32 v83, v83
v_mul_f32 v181, v181, v183
v_cvt_pk_bf16_f32 v188, v80, v81
v_cvt_pk_bf16_f32 v189, v82, v83
ds_write_b64 v201, v[188:189] offset:512
v_add_f32 v181, v181, v80
v_add_f32 v181, v181, v81
v_add_f32 v181, v181, v82
v_add_f32 v181, v181, v83
v_mul_f32 v12, v12, v184
v_mul_f32 v13, v13, v184
v_mul_f32 v14, v14, v184
v_mul_f32 v15, v15, v184
v_mul_f32 v16, v16, v184
v_mul_f32 v17, v17, v184
v_mul_f32 v18, v18, v184
v_mul_f32 v19, v19, v184
v_mul_f32 v20, v20, v184
v_mul_f32 v21, v21, v184
v_mul_f32 v22, v22, v184
v_mul_f32 v23, v23, v184
v_mul_f32 v24, v24, v184
v_mul_f32 v25, v25, v184
v_mul_f32 v26, v26, v184
v_mul_f32 v27, v27, v184
v_mul_f32 v28, v28, v184
v_mul_f32 v29, v29, v184
v_mul_f32 v30, v30, v184
v_mul_f32 v31, v31, v184
v_mul_f32 v32, v32, v184
v_mul_f32 v33, v33, v184
v_mul_f32 v34, v34, v184
v_mul_f32 v35, v35, v184
v_mul_f32 v36, v36, v184
v_mul_f32 v37, v37, v184
v_mul_f32 v38, v38, v184
v_mul_f32 v39, v39, v184
v_mul_f32 v40, v40, v184
v_mul_f32 v41, v41, v184
v_mul_f32 v42, v42, v184
v_mul_f32 v43, v43, v184
v_mul_f32 v44, v44, v184
v_mul_f32 v45, v45, v184
v_mul_f32 v46, v46, v184
v_mul_f32 v47, v47, v184
v_mul_f32 v48, v48, v184
v_mul_f32 v49, v49, v184
v_mul_f32 v50, v50, v184
v_mul_f32 v51, v51, v184
v_mul_f32 v52, v52, v184
v_mul_f32 v53, v53, v184
v_mul_f32 v54, v54, v184
v_mul_f32 v55, v55, v184
v_mul_f32 v56, v56, v184
v_mul_f32 v57, v57, v184
v_mul_f32 v58, v58, v184
v_mul_f32 v59, v59, v184
v_mul_f32 v60, v60, v184
v_mul_f32 v61, v61, v184
v_mul_f32 v62, v62, v184
v_mul_f32 v63, v63, v184
v_mul_f32 v64, v64, v184
v_mul_f32 v65, v65, v184
v_mul_f32 v66, v66, v184
v_mul_f32 v67, v67, v184
v_mul_f32 v68, v68, v184
v_mul_f32 v69, v69, v184
v_mul_f32 v70, v70, v184
v_mul_f32 v71, v71, v184
v_mul_f32 v72, v72, v184
v_mul_f32 v73, v73, v184
v_mul_f32 v74, v74, v184
v_mul_f32 v75, v75, v184
s_waitcnt lgkmcnt(0)
s_barrier
ds_read_b128 v[148:151], v202 offset:0
ds_read_b128 v[152:155], v202 offset:1024
ds_read_b128 v[156:159], v202 offset:2048
ds_read_b128 v[160:163], v202 offset:3072
ds_read_b64_tr_b16 v[84:85], v197 offset:0
ds_read_b64_tr_b16 v[86:87], v197 offset:4352
ds_read_b64_tr_b16 v[88:89], v197 offset:64
ds_read_b64_tr_b16 v[90:91], v197 offset:4416
ds_read_b64_tr_b16 v[92:93], v197 offset:128
ds_read_b64_tr_b16 v[94:95], v197 offset:4480
ds_read_b64_tr_b16 v[96:97], v197 offset:192
ds_read_b64_tr_b16 v[98:99], v197 offset:4544
ds_read_b64_tr_b16 v[100:101], v197 offset:17408
ds_read_b64_tr_b16 v[102:103], v197 offset:21760
ds_read_b64_tr_b16 v[104:105], v197 offset:17472
ds_read_b64_tr_b16 v[106:107], v197 offset:21824
ds_read_b64_tr_b16 v[108:109], v197 offset:17536
ds_read_b64_tr_b16 v[110:111], v197 offset:21888
ds_read_b64_tr_b16 v[112:113], v197 offset:17600
ds_read_b64_tr_b16 v[114:115], v197 offset:21952
ds_read_b64_tr_b16 v[116:117], v197 offset:34816
ds_read_b64_tr_b16 v[118:119], v197 offset:39168
ds_read_b64_tr_b16 v[120:121], v197 offset:34880
ds_read_b64_tr_b16 v[122:123], v197 offset:39232
ds_read_b64_tr_b16 v[124:125], v197 offset:34944
ds_read_b64_tr_b16 v[126:127], v197 offset:39296
ds_read_b64_tr_b16 v[128:129], v197 offset:35008
ds_read_b64_tr_b16 v[130:131], v197 offset:39360
ds_read_b64_tr_b16 v[132:133], v197 offset:52224
ds_read_b64_tr_b16 v[134:135], v197 offset:56576
ds_read_b64_tr_b16 v[136:137], v197 offset:52288
ds_read_b64_tr_b16 v[138:139], v197 offset:56640
ds_read_b64_tr_b16 v[140:141], v197 offset:52352
ds_read_b64_tr_b16 v[142:143], v197 offset:56704
ds_read_b64_tr_b16 v[144:145], v197 offset:52416
ds_read_b64_tr_b16 v[146:147], v197 offset:56768
s_waitcnt lgkmcnt(15)
v_mfma_f32_32x32x16_bf16 v[12:27], v[84:87], v[148:151], v[12:27]
v_mfma_f32_32x32x16_bf16 v[28:43], v[88:91], v[148:151], v[28:43]
v_mfma_f32_32x32x16_bf16 v[44:59], v[92:95], v[148:151], v[44:59]
v_mfma_f32_32x32x16_bf16 v[60:75], v[96:99], v[148:151], v[60:75]
s_waitcnt lgkmcnt(15)
v_mfma_f32_32x32x16_bf16 v[12:27], v[100:103], v[152:155], v[12:27]
v_mfma_f32_32x32x16_bf16 v[28:43], v[104:107], v[152:155], v[28:43]
v_mfma_f32_32x32x16_bf16 v[44:59], v[108:111], v[152:155], v[44:59]
v_mfma_f32_32x32x16_bf16 v[60:75], v[112:115], v[152:155], v[60:75]
s_waitcnt lgkmcnt(8)
v_mfma_f32_32x32x16_bf16 v[12:27], v[116:119], v[156:159], v[12:27]
v_mfma_f32_32x32x16_bf16 v[28:43], v[120:123], v[156:159], v[28:43]
v_mfma_f32_32x32x16_bf16 v[44:59], v[124:127], v[156:159], v[44:59]
v_mfma_f32_32x32x16_bf16 v[60:75], v[128:131], v[156:159], v[60:75]
s_waitcnt lgkmcnt(0)
v_mfma_f32_32x32x16_bf16 v[12:27], v[132:135], v[160:163], v[12:27]
v_mfma_f32_32x32x16_bf16 v[28:43], v[136:139], v[160:163], v[28:43]
v_mfma_f32_32x32x16_bf16 v[44:59], v[140:143], v[160:163], v[44:59]
v_mfma_f32_32x32x16_bf16 v[60:75], v[144:147], v[160:163], v[60:75]
ds_read_b128 v[84:87], v194 offset:0
ds_read_b128 v[88:91], v194 offset:64
ds_read_b128 v[92:95], v194 offset:128
ds_read_b128 v[96:99], v194 offset:192
ds_read_b128 v[100:103], v194 offset:256
ds_read_b128 v[104:107], v194 offset:320
ds_read_b128 v[108:111], v194 offset:384
ds_read_b128 v[112:115], v194 offset:448
ds_read_b128 v[116:119], v194 offset:512
ds_read_b128 v[120:123], v194 offset:576
ds_read_b128 v[124:127], v194 offset:640
ds_read_b128 v[128:131], v194 offset:704
ds_read_b128 v[132:135], v194 offset:768
ds_read_b128 v[136:139], v194 offset:832
ds_read_b128 v[140:143], v194 offset:896
ds_read_b128 v[144:147], v194 offset:960
s_waitcnt lgkmcnt(15)
v_mfma_f32_16x16x32_bf16 v[76:79], v[84:87], a[0:3], 0
v_mfma_f32_16x16x32_bf16 v[80:83], v[84:87], a[64:67], 0
s_waitcnt lgkmcnt(14)
v_mfma_f32_16x16x32_bf16 v[76:79], v[88:91], a[4:7], v[76:79]
v_mfma_f32_16x16x32_bf16 v[80:83], v[88:91], a[68:71], v[80:83]
s_waitcnt lgkmcnt(13)
v_mfma_f32_16x16x32_bf16 v[76:79], v[92:95], a[8:11], v[76:79]
v_mfma_f32_16x16x32_bf16 v[80:83], v[92:95], a[72:75], v[80:83]
s_waitcnt lgkmcnt(12)
v_mfma_f32_16x16x32_bf16 v[76:79], v[96:99], a[12:15], v[76:79]
v_mfma_f32_16x16x32_bf16 v[80:83], v[96:99], a[76:79], v[80:83]
s_waitcnt lgkmcnt(11)
v_mfma_f32_16x16x32_bf16 v[76:79], v[100:103], a[16:19], v[76:79]
v_mfma_f32_16x16x32_bf16 v[80:83], v[100:103], a[80:83], v[80:83]
s_waitcnt lgkmcnt(10)
v_mfma_f32_16x16x32_bf16 v[76:79], v[104:107], a[20:23], v[76:79]
v_mfma_f32_16x16x32_bf16 v[80:83], v[104:107], a[84:87], v[80:83]
s_waitcnt lgkmcnt(9)
v_mfma_f32_16x16x32_bf16 v[76:79], v[108:111], a[24:27], v[76:79]
v_mfma_f32_16x16x32_bf16 v[80:83], v[108:111], a[88:91], v[80:83]
s_waitcnt lgkmcnt(8)
v_mfma_f32_16x16x32_bf16 v[76:79], v[112:115], a[28:31], v[76:79]
v_mfma_f32_16x16x32_bf16 v[80:83], v[112:115], a[92:95], v[80:83]
s_waitcnt lgkmcnt(7)
v_mfma_f32_16x16x32_bf16 v[76:79], v[116:119], a[32:35], v[76:79]
v_mfma_f32_16x16x32_bf16 v[80:83], v[116:119], a[96:99], v[80:83]
s_waitcnt lgkmcnt(6)
v_mfma_f32_16x16x32_bf16 v[76:79], v[120:123], a[36:39], v[76:79]
v_mfma_f32_16x16x32_bf16 v[80:83], v[120:123], a[100:103], v[80:83]
s_waitcnt lgkmcnt(5)
v_mfma_f32_16x16x32_bf16 v[76:79], v[124:127], a[40:43], v[76:79]
v_mfma_f32_16x16x32_bf16 v[80:83], v[124:127], a[104:107], v[80:83]
s_waitcnt lgkmcnt(4)
v_mfma_f32_16x16x32_bf16 v[76:79], v[128:131], a[44:47], v[76:79]
v_mfma_f32_16x16x32_bf16 v[80:83], v[128:131], a[108:111], v[80:83]
s_waitcnt lgkmcnt(3)
v_mfma_f32_16x16x32_bf16 v[76:79], v[132:135], a[48:51], v[76:79]
v_mfma_f32_16x16x32_bf16 v[80:83], v[132:135], a[112:115], v[80:83]
s_waitcnt lgkmcnt(2)
v_mfma_f32_16x16x32_bf16 v[76:79], v[136:139], a[52:55], v[76:79]
v_mfma_f32_16x16x32_bf16 v[80:83], v[136:139], a[116:119], v[80:83]
s_waitcnt lgkmcnt(1)
v_mfma_f32_16x16x32_bf16 v[76:79], v[140:143], a[56:59], v[76:79]
v_mfma_f32_16x16x32_bf16 v[80:83], v[140:143], a[120:123], v[80:83]
s_waitcnt lgkmcnt(0)
v_mfma_f32_16x16x32_bf16 v[76:79], v[144:147], a[60:63], v[76:79]
v_mfma_f32_16x16x32_bf16 v[80:83], v[144:147], a[124:127], v[80:83]
s_nop 6
v_max_f32 v190, v76, v77
v_max3_f32 v190, v190, v78, v79
v_mov_b32 v192, v190
s_nop 1
v_permlane16_swap_b32 v190, v192
v_max_f32 v190, v190, v192
v_mov_b32 v192, v190
s_nop 1
v_permlane32_swap_b32 v190, v192
v_max_f32 v190, v190, v192
ds_write_b32 v198, v190 offset:0
v_max_f32 v191, v80, v81
v_max3_f32 v191, v191, v82, v83
v_mov_b32 v192, v191
s_nop 1
v_permlane16_swap_b32 v191, v192
v_max_f32 v191, v191, v192
v_mov_b32 v192, v191
s_nop 1
v_permlane32_swap_b32 v191, v192
v_max_f32 v191, v191, v192
ds_write_b32 v198, v191 offset:256
s_waitcnt lgkmcnt(0)
s_barrier
ds_read_b128 v[164:167], v199
ds_read_b128 v[168:171], v199 offset:256
ds_read_b128 v[172:175], v200
s_waitcnt vmcnt(0)
ds_write_b128 v207, a[192:195] offset:0
ds_write_b128 v207, a[196:199] offset:1088
ds_write_b128 v207, a[200:203] offset:2176
ds_write_b128 v207, a[204:207] offset:3264
ds_write_b128 v207, a[208:211] offset:4352
ds_write_b128 v207, a[212:215] offset:5440
ds_write_b128 v207, a[216:219] offset:6528
ds_write_b128 v207, a[220:223] offset:7616
ds_write_b128 v207, a[224:227] offset:8704
ds_write_b128 v207, a[228:231] offset:9792
ds_write_b128 v207, a[232:235] offset:10880
ds_write_b128 v207, a[236:239] offset:11968
ds_write_b128 v207, a[240:243] offset:13056
ds_write_b128 v207, a[244:247] offset:14144
ds_write_b128 v207, a[248:251] offset:15232
ds_write_b128 v207, a[252:255] offset:16320
s_waitcnt lgkmcnt(15)
v_max_f32 v164, v164, v165
v_max3_f32 v164, v164, v166, v167
v_mul_f32 v164, v164, v185
v_max_f32 v164, v164, v176
v_sub_f32 v182, v176, v164
v_exp_f32 v182, v182
v_mov_b32 v176, v164
v_max_f32 v168, v168, v169
v_max3_f32 v168, v168, v170, v171
v_mul_f32 v168, v168, v185
v_max_f32 v168, v168, v177
v_sub_f32 v183, v177, v168
v_exp_f32 v183, v183
v_mov_b32 v177, v168
v_max_f32 v172, v172, v173
v_max3_f32 v172, v172, v174, v175
v_mul_f32 v172, v172, v185
v_max_f32 v172, v172, v178
v_sub_f32 v184, v178, v172
v_exp_f32 v184, v184
v_mov_b32 v178, v172
v_fma_f32 v76, v76, v185, -v176
v_fma_f32 v77, v77, v185, -v176
v_fma_f32 v78, v78, v185, -v176
v_fma_f32 v79, v79, v185, -v176
v_exp_f32 v76, v76
v_exp_f32 v77, v77
v_exp_f32 v78, v78
v_exp_f32 v79, v79
v_mul_f32 v180, v180, v182
v_cvt_pk_bf16_f32 v186, v76, v77
v_cvt_pk_bf16_f32 v187, v78, v79
ds_write_b64 v201, v[186:187] offset:0
v_add_f32 v180, v180, v76
v_add_f32 v180, v180, v77
v_add_f32 v180, v180, v78
v_add_f32 v180, v180, v79
v_fma_f32 v80, v80, v185, -v177
v_fma_f32 v81, v81, v185, -v177
v_fma_f32 v82, v82, v185, -v177
v_fma_f32 v83, v83, v185, -v177
v_exp_f32 v80, v80
v_exp_f32 v81, v81
v_exp_f32 v82, v82
v_exp_f32 v83, v83
v_mul_f32 v181, v181, v183
v_cvt_pk_bf16_f32 v188, v80, v81
v_cvt_pk_bf16_f32 v189, v82, v83
ds_write_b64 v201, v[188:189] offset:512
v_add_f32 v181, v181, v80
v_add_f32 v181, v181, v81
v_add_f32 v181, v181, v82
v_add_f32 v181, v181, v83
v_mul_f32 v12, v12, v184
v_mul_f32 v13, v13, v184
v_mul_f32 v14, v14, v184
v_mul_f32 v15, v15, v184
v_mul_f32 v16, v16, v184
v_mul_f32 v17, v17, v184
v_mul_f32 v18, v18, v184
v_mul_f32 v19, v19, v184
v_mul_f32 v20, v20, v184
v_mul_f32 v21, v21, v184
v_mul_f32 v22, v22, v184
v_mul_f32 v23, v23, v184
v_mul_f32 v24, v24, v184
v_mul_f32 v25, v25, v184
v_mul_f32 v26, v26, v184
v_mul_f32 v27, v27, v184
v_mul_f32 v28, v28, v184
v_mul_f32 v29, v29, v184
v_mul_f32 v30, v30, v184
v_mul_f32 v31, v31, v184
v_mul_f32 v32, v32, v184
v_mul_f32 v33, v33, v184
v_mul_f32 v34, v34, v184
v_mul_f32 v35, v35, v184
v_mul_f32 v36, v36, v184
v_mul_f32 v37, v37, v184
v_mul_f32 v38, v38, v184
v_mul_f32 v39, v39, v184
v_mul_f32 v40, v40, v184
v_mul_f32 v41, v41, v184
v_mul_f32 v42, v42, v184
v_mul_f32 v43, v43, v184
v_mul_f32 v44, v44, v184
v_mul_f32 v45, v45, v184
v_mul_f32 v46, v46, v184
v_mul_f32 v47, v47, v184
v_mul_f32 v48, v48, v184
v_mul_f32 v49, v49, v184
v_mul_f32 v50, v50, v184
v_mul_f32 v51, v51, v184
v_mul_f32 v52, v52, v184
v_mul_f32 v53, v53, v184
v_mul_f32 v54, v54, v184
v_mul_f32 v55, v55, v184
v_mul_f32 v56, v56, v184
v_mul_f32 v57, v57, v184
v_mul_f32 v58, v58, v184
v_mul_f32 v59, v59, v184
v_mul_f32 v60, v60, v184
v_mul_f32 v61, v61, v184
v_mul_f32 v62, v62, v184
v_mul_f32 v63, v63, v184
v_mul_f32 v64, v64, v184
v_mul_f32 v65, v65, v184
v_mul_f32 v66, v66, v184
v_mul_f32 v67, v67, v184
v_mul_f32 v68, v68, v184
v_mul_f32 v69, v69, v184
v_mul_f32 v70, v70, v184
v_mul_f32 v71, v71, v184
v_mul_f32 v72, v72, v184
v_mul_f32 v73, v73, v184
v_mul_f32 v74, v74, v184
v_mul_f32 v75, v75, v184
s_waitcnt lgkmcnt(0)
s_barrier
ds_read_b128 v[148:151], v202 offset:0
ds_read_b128 v[152:155], v202 offset:1024
ds_read_b128 v[156:159], v202 offset:2048
ds_read_b128 v[160:163], v202 offset:3072
ds_read_b64_tr_b16 v[84:85], v196 offset:0
ds_read_b64_tr_b16 v[86:87], v196 offset:4352
ds_read_b64_tr_b16 v[88:89], v196 offset:64
ds_read_b64_tr_b16 v[90:91], v196 offset:4416
ds_read_b64_tr_b16 v[92:93], v196 offset:128
ds_read_b64_tr_b16 v[94:95], v196 offset:4480
ds_read_b64_tr_b16 v[96:97], v196 offset:192
ds_read_b64_tr_b16 v[98:99], v196 offset:4544
ds_read_b64_tr_b16 v[100:101], v196 offset:17408
ds_read_b64_tr_b16 v[102:103], v196 offset:21760
ds_read_b64_tr_b16 v[104:105], v196 offset:17472
ds_read_b64_tr_b16 v[106:107], v196 offset:21824
ds_read_b64_tr_b16 v[108:109], v196 offset:17536
ds_read_b64_tr_b16 v[110:111], v196 offset:21888
ds_read_b64_tr_b16 v[112:113], v196 offset:17600
ds_read_b64_tr_b16 v[114:115], v196 offset:21952
ds_read_b64_tr_b16 v[116:117], v196 offset:34816
ds_read_b64_tr_b16 v[118:119], v196 offset:39168
ds_read_b64_tr_b16 v[120:121], v196 offset:34880
ds_read_b64_tr_b16 v[122:123], v196 offset:39232
ds_read_b64_tr_b16 v[124:125], v196 offset:34944
ds_read_b64_tr_b16 v[126:127], v196 offset:39296
ds_read_b64_tr_b16 v[128:129], v196 offset:35008
ds_read_b64_tr_b16 v[130:131], v196 offset:39360
ds_read_b64_tr_b16 v[132:133], v196 offset:52224
ds_read_b64_tr_b16 v[134:135], v196 offset:56576
ds_read_b64_tr_b16 v[136:137], v196 offset:52288
ds_read_b64_tr_b16 v[138:139], v196 offset:56640
ds_read_b64_tr_b16 v[140:141], v196 offset:52352
ds_read_b64_tr_b16 v[142:143], v196 offset:56704
ds_read_b64_tr_b16 v[144:145], v196 offset:52416
ds_read_b64_tr_b16 v[146:147], v196 offset:56768
s_waitcnt lgkmcnt(15)
v_mfma_f32_32x32x16_bf16 v[12:27], v[84:87], v[148:151], v[12:27]
v_mfma_f32_32x32x16_bf16 v[28:43], v[88:91], v[148:151], v[28:43]
v_mfma_f32_32x32x16_bf16 v[44:59], v[92:95], v[148:151], v[44:59]
v_mfma_f32_32x32x16_bf16 v[60:75], v[96:99], v[148:151], v[60:75]
s_waitcnt lgkmcnt(15)
v_mfma_f32_32x32x16_bf16 v[12:27], v[100:103], v[152:155], v[12:27]
v_mfma_f32_32x32x16_bf16 v[28:43], v[104:107], v[152:155], v[28:43]
v_mfma_f32_32x32x16_bf16 v[44:59], v[108:111], v[152:155], v[44:59]
v_mfma_f32_32x32x16_bf16 v[60:75], v[112:115], v[152:155], v[60:75]
s_waitcnt lgkmcnt(8)
v_mfma_f32_32x32x16_bf16 v[12:27], v[116:119], v[156:159], v[12:27]
v_mfma_f32_32x32x16_bf16 v[28:43], v[120:123], v[156:159], v[28:43]
v_mfma_f32_32x32x16_bf16 v[44:59], v[124:127], v[156:159], v[44:59]
v_mfma_f32_32x32x16_bf16 v[60:75], v[128:131], v[156:159], v[60:75]
s_waitcnt lgkmcnt(0)
v_mfma_f32_32x32x16_bf16 v[12:27], v[132:135], v[160:163], v[12:27]
v_mfma_f32_32x32x16_bf16 v[28:43], v[136:139], v[160:163], v[28:43]
v_mfma_f32_32x32x16_bf16 v[44:59], v[140:143], v[160:163], v[44:59]
v_mfma_f32_32x32x16_bf16 v[60:75], v[144:147], v[160:163], v[60:75]
ds_read_b128 v[84:87], v195 offset:0
ds_read_b128 v[88:91], v195 offset:64
ds_read_b128 v[92:95], v195 offset:128
ds_read_b128 v[96:99], v195 offset:192
ds_read_b128 v[100:103], v195 offset:256
ds_read_b128 v[104:107], v195 offset:320
ds_read_b128 v[108:111], v195 offset:384
ds_read_b128 v[112:115], v195 offset:448
ds_read_b128 v[116:119], v195 offset:512
ds_read_b128 v[120:123], v195 offset:576
ds_read_b128 v[124:127], v195 offset:640
ds_read_b128 v[128:131], v195 offset:704
ds_read_b128 v[132:135], v195 offset:768
ds_read_b128 v[136:139], v195 offset:832
ds_read_b128 v[140:143], v195 offset:896
ds_read_b128 v[144:147], v195 offset:960
s_waitcnt lgkmcnt(15)
v_mfma_f32_16x16x32_bf16 v[76:79], v[84:87], a[0:3], 0
v_mfma_f32_16x16x32_bf16 v[80:83], v[84:87], a[64:67], 0
s_waitcnt lgkmcnt(14)
v_mfma_f32_16x16x32_bf16 v[76:79], v[88:91], a[4:7], v[76:79]
v_mfma_f32_16x16x32_bf16 v[80:83], v[88:91], a[68:71], v[80:83]
s_waitcnt lgkmcnt(13)
v_mfma_f32_16x16x32_bf16 v[76:79], v[92:95], a[8:11], v[76:79]
v_mfma_f32_16x16x32_bf16 v[80:83], v[92:95], a[72:75], v[80:83]
s_waitcnt lgkmcnt(12)
v_mfma_f32_16x16x32_bf16 v[76:79], v[96:99], a[12:15], v[76:79]
v_mfma_f32_16x16x32_bf16 v[80:83], v[96:99], a[76:79], v[80:83]
s_waitcnt lgkmcnt(11)
v_mfma_f32_16x16x32_bf16 v[76:79], v[100:103], a[16:19], v[76:79]
v_mfma_f32_16x16x32_bf16 v[80:83], v[100:103], a[80:83], v[80:83]
s_waitcnt lgkmcnt(10)
v_mfma_f32_16x16x32_bf16 v[76:79], v[104:107], a[20:23], v[76:79]
v_mfma_f32_16x16x32_bf16 v[80:83], v[104:107], a[84:87], v[80:83]
s_waitcnt lgkmcnt(9)
v_mfma_f32_16x16x32_bf16 v[76:79], v[108:111], a[24:27], v[76:79]
v_mfma_f32_16x16x32_bf16 v[80:83], v[108:111], a[88:91], v[80:83]
s_waitcnt lgkmcnt(8)
v_mfma_f32_16x16x32_bf16 v[76:79], v[112:115], a[28:31], v[76:79]
v_mfma_f32_16x16x32_bf16 v[80:83], v[112:115], a[92:95], v[80:83]
s_waitcnt lgkmcnt(7)
v_mfma_f32_16x16x32_bf16 v[76:79], v[116:119], a[32:35], v[76:79]
v_mfma_f32_16x16x32_bf16 v[80:83], v[116:119], a[96:99], v[80:83]
s_waitcnt lgkmcnt(6)
v_mfma_f32_16x16x32_bf16 v[76:79], v[120:123], a[36:39], v[76:79]
v_mfma_f32_16x16x32_bf16 v[80:83], v[120:123], a[100:103], v[80:83]
s_waitcnt lgkmcnt(5)
v_mfma_f32_16x16x32_bf16 v[76:79], v[124:127], a[40:43], v[76:79]
v_mfma_f32_16x16x32_bf16 v[80:83], v[124:127], a[104:107], v[80:83]
s_waitcnt lgkmcnt(4)
v_mfma_f32_16x16x32_bf16 v[76:79], v[128:131], a[44:47], v[76:79]
v_mfma_f32_16x16x32_bf16 v[80:83], v[128:131], a[108:111], v[80:83]
s_waitcnt lgkmcnt(3)
v_mfma_f32_16x16x32_bf16 v[76:79], v[132:135], a[48:51], v[76:79]
v_mfma_f32_16x16x32_bf16 v[80:83], v[132:135], a[112:115], v[80:83]
s_waitcnt lgkmcnt(2)
v_mfma_f32_16x16x32_bf16 v[76:79], v[136:139], a[52:55], v[76:79]
v_mfma_f32_16x16x32_bf16 v[80:83], v[136:139], a[116:119], v[80:83]
s_waitcnt lgkmcnt(1)
v_mfma_f32_16x16x32_bf16 v[76:79], v[140:143], a[56:59], v[76:79]
v_mfma_f32_16x16x32_bf16 v[80:83], v[140:143], a[120:123], v[80:83]
s_waitcnt lgkmcnt(0)
v_mfma_f32_16x16x32_bf16 v[76:79], v[144:147], a[60:63], v[76:79]
v_mfma_f32_16x16x32_bf16 v[80:83], v[144:147], a[124:127], v[80:83]
s_nop 6
v_max_f32 v190, v76, v77
v_max3_f32 v190, v190, v78, v79
v_mov_b32 v192, v190
s_nop 1
v_permlane16_swap_b32 v190, v192
v_max_f32 v190, v190, v192
v_mov_b32 v192, v190
s_nop 1
v_permlane32_swap_b32 v190, v192
v_max_f32 v190, v190, v192
ds_write_b32 v198, v190 offset:0
v_max_f32 v191, v80, v81
v_max3_f32 v191, v191, v82, v83
v_mov_b32 v192, v191
s_nop 1
v_permlane16_swap_b32 v191, v192
v_max_f32 v191, v191, v192
v_mov_b32 v192, v191
s_nop 1
v_permlane32_swap_b32 v191, v192
v_max_f32 v191, v191, v192
ds_write_b32 v198, v191 offset:256
s_waitcnt lgkmcnt(0)
s_barrier
ds_read_b128 v[164:167], v199
ds_read_b128 v[168:171], v199 offset:256
ds_read_b128 v[172:175], v200
s_waitcnt lgkmcnt(0)
v_max_f32 v164, v164, v165
v_max3_f32 v164, v164, v166, v167
v_mul_f32 v164, v164, v185
v_max_f32 v164, v164, v176
v_sub_f32 v182, v176, v164
v_exp_f32 v182, v182
v_mov_b32 v176, v164
v_max_f32 v168, v168, v169
v_max3_f32 v168, v168, v170, v171
v_mul_f32 v168, v168, v185
v_max_f32 v168, v168, v177
v_sub_f32 v183, v177, v168
v_exp_f32 v183, v183
v_mov_b32 v177, v168
v_max_f32 v172, v172, v173
v_max3_f32 v172, v172, v174, v175
v_mul_f32 v172, v172, v185
v_max_f32 v172, v172, v178
v_sub_f32 v184, v178, v172
v_exp_f32 v184, v184
v_mov_b32 v178, v172
v_fma_f32 v76, v76, v185, -v176
v_fma_f32 v77, v77, v185, -v176
v_fma_f32 v78, v78, v185, -v176
v_fma_f32 v79, v79, v185, -v176
v_exp_f32 v76, v76
v_exp_f32 v77, v77
v_exp_f32 v78, v78
v_exp_f32 v79, v79
v_mul_f32 v180, v180, v182
v_cvt_pk_bf16_f32 v186, v76, v77
v_cvt_pk_bf16_f32 v187, v78, v79
ds_write_b64 v201, v[186:187] offset:0
v_add_f32 v180, v180, v76
v_add_f32 v180, v180, v77
v_add_f32 v180, v180, v78
v_add_f32 v180, v180, v79
v_fma_f32 v80, v80, v185, -v177
v_fma_f32 v81, v81, v185, -v177
v_fma_f32 v82, v82, v185, -v177
v_fma_f32 v83, v83, v185, -v177
v_exp_f32 v80, v80
v_exp_f32 v81, v81
v_exp_f32 v82, v82
v_exp_f32 v83, v83
v_mul_f32 v181, v181, v183
v_cvt_pk_bf16_f32 v188, v80, v81
v_cvt_pk_bf16_f32 v189, v82, v83
ds_write_b64 v201, v[188:189] offset:512
v_add_f32 v181, v181, v80
v_add_f32 v181, v181, v81
v_add_f32 v181, v181, v82
v_add_f32 v181, v181, v83
v_mul_f32 v12, v12, v184
v_mul_f32 v13, v13, v184
v_mul_f32 v14, v14, v184
v_mul_f32 v15, v15, v184
v_mul_f32 v16, v16, v184
v_mul_f32 v17, v17, v184
v_mul_f32 v18, v18, v184
v_mul_f32 v19, v19, v184
v_mul_f32 v20, v20, v184
v_mul_f32 v21, v21, v184
v_mul_f32 v22, v22, v184
v_mul_f32 v23, v23, v184
v_mul_f32 v24, v24, v184
v_mul_f32 v25, v25, v184
v_mul_f32 v26, v26, v184
v_mul_f32 v27, v27, v184
v_mul_f32 v28, v28, v184
v_mul_f32 v29, v29, v184
v_mul_f32 v30, v30, v184
v_mul_f32 v31, v31, v184
v_mul_f32 v32, v32, v184
v_mul_f32 v33, v33, v184
v_mul_f32 v34, v34, v184
v_mul_f32 v35, v35, v184
v_mul_f32 v36, v36, v184
v_mul_f32 v37, v37, v184
v_mul_f32 v38, v38, v184
v_mul_f32 v39, v39, v184
v_mul_f32 v40, v40, v184
v_mul_f32 v41, v41, v184
v_mul_f32 v42, v42, v184
v_mul_f32 v43, v43, v184
v_mul_f32 v44, v44, v184
v_mul_f32 v45, v45, v184
v_mul_f32 v46, v46, v184
v_mul_f32 v47, v47, v184
v_mul_f32 v48, v48, v184
v_mul_f32 v49, v49, v184
v_mul_f32 v50, v50, v184
v_mul_f32 v51, v51, v184
v_mul_f32 v52, v52, v184
v_mul_f32 v53, v53, v184
v_mul_f32 v54, v54, v184
v_mul_f32 v55, v55, v184
v_mul_f32 v56, v56, v184
v_mul_f32 v57, v57, v184
v_mul_f32 v58, v58, v184
v_mul_f32 v59, v59, v184
v_mul_f32 v60, v60, v184
v_mul_f32 v61, v61, v184
v_mul_f32 v62, v62, v184
v_mul_f32 v63, v63, v184
v_mul_f32 v64, v64, v184
v_mul_f32 v65, v65, v184
v_mul_f32 v66, v66, v184
v_mul_f32 v67, v67, v184
v_mul_f32 v68, v68, v184
v_mul_f32 v69, v69, v184
v_mul_f32 v70, v70, v184
v_mul_f32 v71, v71, v184
v_mul_f32 v72, v72, v184
v_mul_f32 v73, v73, v184
v_mul_f32 v74, v74, v184
v_mul_f32 v75, v75, v184
s_waitcnt lgkmcnt(0)
s_barrier
ds_read_b128 v[148:151], v202 offset:0
ds_read_b128 v[152:155], v202 offset:1024
ds_read_b128 v[156:159], v202 offset:2048
ds_read_b128 v[160:163], v202 offset:3072
ds_read_b64_tr_b16 v[84:85], v197 offset:0
ds_read_b64_tr_b16 v[86:87], v197 offset:4352
ds_read_b64_tr_b16 v[88:89], v197 offset:64
ds_read_b64_tr_b16 v[90:91], v197 offset:4416
ds_read_b64_tr_b16 v[92:93], v197 offset:128
ds_read_b64_tr_b16 v[94:95], v197 offset:4480
ds_read_b64_tr_b16 v[96:97], v197 offset:192
ds_read_b64_tr_b16 v[98:99], v197 offset:4544
ds_read_b64_tr_b16 v[100:101], v197 offset:17408
ds_read_b64_tr_b16 v[102:103], v197 offset:21760
ds_read_b64_tr_b16 v[104:105], v197 offset:17472
ds_read_b64_tr_b16 v[106:107], v197 offset:21824
ds_read_b64_tr_b16 v[108:109], v197 offset:17536
ds_read_b64_tr_b16 v[110:111], v197 offset:21888
ds_read_b64_tr_b16 v[112:113], v197 offset:17600
ds_read_b64_tr_b16 v[114:115], v197 offset:21952
ds_read_b64_tr_b16 v[116:117], v197 offset:34816
ds_read_b64_tr_b16 v[118:119], v197 offset:39168
ds_read_b64_tr_b16 v[120:121], v197 offset:34880
ds_read_b64_tr_b16 v[122:123], v197 offset:39232
ds_read_b64_tr_b16 v[124:125], v197 offset:34944
ds_read_b64_tr_b16 v[126:127], v197 offset:39296
ds_read_b64_tr_b16 v[128:129], v197 offset:35008
ds_read_b64_tr_b16 v[130:131], v197 offset:39360
ds_read_b64_tr_b16 v[132:133], v197 offset:52224
ds_read_b64_tr_b16 v[134:135], v197 offset:56576
ds_read_b64_tr_b16 v[136:137], v197 offset:52288
ds_read_b64_tr_b16 v[138:139], v197 offset:56640
ds_read_b64_tr_b16 v[140:141], v197 offset:52352
ds_read_b64_tr_b16 v[142:143], v197 offset:56704
ds_read_b64_tr_b16 v[144:145], v197 offset:52416
ds_read_b64_tr_b16 v[146:147], v197 offset:56768
s_waitcnt lgkmcnt(15)
v_mfma_f32_32x32x16_bf16 v[12:27], v[84:87], v[148:151], v[12:27]
v_mfma_f32_32x32x16_bf16 v[28:43], v[88:91], v[148:151], v[28:43]
v_mfma_f32_32x32x16_bf16 v[44:59], v[92:95], v[148:151], v[44:59]
v_mfma_f32_32x32x16_bf16 v[60:75], v[96:99], v[148:151], v[60:75]
s_waitcnt lgkmcnt(15)
v_mfma_f32_32x32x16_bf16 v[12:27], v[100:103], v[152:155], v[12:27]
v_mfma_f32_32x32x16_bf16 v[28:43], v[104:107], v[152:155], v[28:43]
v_mfma_f32_32x32x16_bf16 v[44:59], v[108:111], v[152:155], v[44:59]
v_mfma_f32_32x32x16_bf16 v[60:75], v[112:115], v[152:155], v[60:75]
s_waitcnt lgkmcnt(8)
v_mfma_f32_32x32x16_bf16 v[12:27], v[116:119], v[156:159], v[12:27]
v_mfma_f32_32x32x16_bf16 v[28:43], v[120:123], v[156:159], v[28:43]
v_mfma_f32_32x32x16_bf16 v[44:59], v[124:127], v[156:159], v[44:59]
v_mfma_f32_32x32x16_bf16 v[60:75], v[128:131], v[156:159], v[60:75]
s_waitcnt lgkmcnt(0)
v_mfma_f32_32x32x16_bf16 v[12:27], v[132:135], v[160:163], v[12:27]
v_mfma_f32_32x32x16_bf16 v[28:43], v[136:139], v[160:163], v[28:43]
v_mfma_f32_32x32x16_bf16 v[44:59], v[140:143], v[160:163], v[44:59]
v_mfma_f32_32x32x16_bf16 v[60:75], v[144:147], v[160:163], v[60:75]
v_mov_b32 v192, v180
s_nop 1
v_permlane16_swap_b32 v180, v192
v_add_f32 v180, v180, v192
v_mov_b32 v192, v180
s_nop 1
v_permlane32_swap_b32 v180, v192
v_add_f32 v180, v180, v192
ds_write_b32 v198, v180 offset:512
v_mov_b32 v192, v181
s_nop 1
v_permlane16_swap_b32 v181, v192
v_add_f32 v181, v181, v192
v_mov_b32 v192, v181
s_nop 1
v_permlane32_swap_b32 v181, v192
v_add_f32 v181, v181, v192
ds_write_b32 v198, v181 offset:768
v_and_b32 v5, 31, v1
v_mul_u32_u24 v5, 1040, v5
v_lshrrev_b32 v6, 5, v1
v_lshl_add_u32 v5, v6, 3, v5
s_lshl_b32 s6, s3, 8
v_add_u32 v5, s6, v5
v_cvt_pk_bf16_f32 v84, v12, v13
v_cvt_pk_bf16_f32 v85, v14, v15
ds_write_b64 v5, v[84:85] offset:0
v_cvt_pk_bf16_f32 v86, v16, v17
v_cvt_pk_bf16_f32 v87, v18, v19
ds_write_b64 v5, v[86:87] offset:16
v_cvt_pk_bf16_f32 v88, v20, v21
v_cvt_pk_bf16_f32 v89, v22, v23
ds_write_b64 v5, v[88:89] offset:32
v_cvt_pk_bf16_f32 v90, v24, v25
v_cvt_pk_bf16_f32 v91, v26, v27
ds_write_b64 v5, v[90:91] offset:48
v_cvt_pk_bf16_f32 v92, v28, v29
v_cvt_pk_bf16_f32 v93, v30, v31
ds_write_b64 v5, v[92:93] offset:64
v_cvt_pk_bf16_f32 v94, v32, v33
v_cvt_pk_bf16_f32 v95, v34, v35
ds_write_b64 v5, v[94:95] offset:80
v_cvt_pk_bf16_f32 v96, v36, v37
v_cvt_pk_bf16_f32 v97, v38, v39
ds_write_b64 v5, v[96:97] offset:96
v_cvt_pk_bf16_f32 v98, v40, v41
v_cvt_pk_bf16_f32 v99, v42, v43
ds_write_b64 v5, v[98:99] offset:112
v_cvt_pk_bf16_f32 v100, v44, v45
v_cvt_pk_bf16_f32 v101, v46, v47
ds_write_b64 v5, v[100:101] offset:128
v_cvt_pk_bf16_f32 v102, v48, v49
v_cvt_pk_bf16_f32 v103, v50, v51
ds_write_b64 v5, v[102:103] offset:144
v_cvt_pk_bf16_f32 v104, v52, v53
v_cvt_pk_bf16_f32 v105, v54, v55
ds_write_b64 v5, v[104:105] offset:160
v_cvt_pk_bf16_f32 v106, v56, v57
v_cvt_pk_bf16_f32 v107, v58, v59
ds_write_b64 v5, v[106:107] offset:176
v_cvt_pk_bf16_f32 v108, v60, v61
v_cvt_pk_bf16_f32 v109, v62, v63
ds_write_b64 v5, v[108:109] offset:192
v_cvt_pk_bf16_f32 v110, v64, v65
v_cvt_pk_bf16_f32 v111, v66, v67
ds_write_b64 v5, v[110:111] offset:208
v_cvt_pk_bf16_f32 v112, v68, v69
v_cvt_pk_bf16_f32 v113, v70, v71
ds_write_b64 v5, v[112:113] offset:224
v_cvt_pk_bf16_f32 v114, v72, v73
v_cvt_pk_bf16_f32 v115, v74, v75
ds_write_b64 v5, v[114:115] offset:240
s_waitcnt lgkmcnt(0)
s_barrier
s_mul_i32 s6, s3, 8320
v_add_u32 v5, s6, v2
ds_read_b128 v[116:119], v5 offset:0
ds_read_b128 v[120:123], v5 offset:1040
ds_read_b128 v[124:127], v5 offset:2080
ds_read_b128 v[128:131], v5 offset:3120
ds_read_b128 v[132:135], v5 offset:4160
ds_read_b128 v[136:139], v5 offset:5200
ds_read_b128 v[140:143], v5 offset:6240
ds_read_b128 v[144:147], v5 offset:7280
ds_read_b128 v[164:167], v200 offset:512
s_lshl_b32 s7, s3, 19
s_lshl_b32 s6, s9, 10
s_add_u32 s7, s7, s6
s_add_u32 s7, s7, 1048576
s_waitcnt lgkmcnt(8)
s_add_u32 s6, s7, 0
buffer_store_dwordx4 v[116:119], v2, s[64:67], s6 offen sc1
s_waitcnt lgkmcnt(7)
s_add_u32 s6, s7, 65536
buffer_store_dwordx4 v[120:123], v2, s[64:67], s6 offen sc1
s_waitcnt lgkmcnt(6)
s_add_u32 s6, s7, 131072
buffer_store_dwordx4 v[124:127], v2, s[64:67], s6 offen sc1
s_waitcnt lgkmcnt(5)
s_add_u32 s6, s7, 196608
buffer_store_dwordx4 v[128:131], v2, s[64:67], s6 offen sc1
s_waitcnt lgkmcnt(4)
s_add_u32 s6, s7, 262144
buffer_store_dwordx4 v[132:135], v2, s[64:67], s6 offen sc1
s_waitcnt lgkmcnt(3)
s_add_u32 s6, s7, 327680
buffer_store_dwordx4 v[136:139], v2, s[64:67], s6 offen sc1
s_waitcnt lgkmcnt(2)
s_add_u32 s6, s7, 393216
buffer_store_dwordx4 v[140:143], v2, s[64:67], s6 offen sc1
s_waitcnt lgkmcnt(1)
s_add_u32 s6, s7, 458752
buffer_store_dwordx4 v[144:147], v2, s[64:67], s6 offen sc1
s_waitcnt lgkmcnt(0)
v_add_f32 v164, v164, v165
v_add_f32 v166, v166, v167
v_add_f32 v187, v164, v166
v_mov_b32 v186, v178
v_and_b32 v5, 31, v1
v_lshrrev_b32 v6, 5, v1
v_lshl_add_u32 v5, v5, 1, v6
v_lshlrev_b32 v5, 9, v5
s_lshl_b32 s6, s9, 3
s_add_u32 s6, s6, 262144
v_min_u32 v186, -2, v186
v_min_u32 v187, -2, v187
s_waitcnt vmcnt(0)
s_barrier
s_cmp_lg_u32 s3, 0
s_cbranch_scc1 L_nops_22
buffer_store_dwordx2 v[186:187], v5, s[64:67], s6 offen sc1
L_nops_22:
s_mul_i32 s6, s9, 73728
s_add_u32 s60, s36, s6
s_addc_u32 s61, s37, 0
s_mov_b32 s62, 73728
s_mov_b32 s63, 0x20000
s_lshl_b32 s6, s9, 7
s_sub_u32 s7, 4194304, s6
s_add_u32 s76, s34, s6
s_addc_u32 s77, s35, 0
s_mov_b32 s78, s7
s_mov_b32 s79, 0x20000
v_lshrrev_b32 v5, 3, v1
v_and_b32 v6, 7, v1
v_and_b32 v7, 2, v5
v_xor_b32 v6, v6, v7
v_lshlrev_b32 v5, 13, v5
v_lshl_add_u32 v152, v6, 4, v5
v_xor_b32 v6, 4, v6
v_lshl_add_u32 v153, v6, 4, v5
s_lshl_b32 s12, s3, 14
s_lshl_b32 s13, s3, 20
s_add_u32 m0, s12, 73728
s_add_u32 s6, s13, 0
buffer_load_dwordx4 v152, s[76:79], s6 offen  lds
s_add_u32 m0, s12, 74752
s_add_u32 s6, s13, 65536
buffer_load_dwordx4 v153, s[76:79], s6 offen  lds
s_add_u32 m0, s12, 75776
s_add_u32 s6, s13, 131072
buffer_load_dwordx4 v152, s[76:79], s6 offen  lds
s_add_u32 m0, s12, 76800
s_add_u32 s6, s13, 196608
buffer_load_dwordx4 v153, s[76:79], s6 offen  lds
s_add_u32 m0, s12, 77824
s_add_u32 s6, s13, 262144
buffer_load_dwordx4 v152, s[76:79], s6 offen  lds
s_add_u32 m0, s12, 78848
s_add_u32 s6, s13, 327680
buffer_load_dwordx4 v153, s[76:79], s6 offen  lds
s_add_u32 m0, s12, 79872
s_add_u32 s6, s13, 393216
buffer_load_dwordx4 v152, s[76:79], s6 offen  lds
s_add_u32 m0, s12, 80896
s_add_u32 s6, s13, 458752
buffer_load_dwordx4 v153, s[76:79], s6 offen  lds
s_add_u32 m0, s12, 81920
s_add_u32 s6, s13, 524288
buffer_load_dwordx4 v152, s[76:79], s6 offen  lds
s_add_u32 m0, s12, 82944
s_add_u32 s6, s13, 589824
buffer_load_dwordx4 v153, s[76:79], s6 offen  lds
s_add_u32 m0, s12, 83968
s_add_u32 s6, s13, 655360
buffer_load_dwordx4 v152, s[76:79], s6 offen  lds
s_add_u32 m0, s12, 84992
s_add_u32 s6, s13, 720896
buffer_load_dwordx4 v153, s[76:79], s6 offen  lds
s_add_u32 m0, s12, 86016
s_add_u32 s6, s13, 786432
buffer_load_dwordx4 v152, s[76:79], s6 offen  lds
s_add_u32 m0, s12, 87040
s_add_u32 s6, s13, 851968
buffer_load_dwordx4 v153, s[76:79], s6 offen  lds
s_add_u32 m0, s12, 88064
s_add_u32 s6, s13, 917504
buffer_load_dwordx4 v152, s[76:79], s6 offen  lds
s_add_u32 m0, s12, 89088
s_add_u32 s6, s13, 983040
buffer_load_dwordx4 v153, s[76:79], s6 offen  lds
s_mul_i32 s12, s3, 18432
s_add_u32 s6, s12, 0
s_mov_b32 m0, s6
s_nop 0
buffer_load_dwordx4 v2, s[60:63], s6 offen  lds
s_add_u32 s6, s12, 1024
s_mov_b32 m0, s6
s_nop 0
buffer_load_dwordx4 v2, s[60:63], s6 offen  lds
s_add_u32 s6, s12, 2048
s_mov_b32 m0, s6
s_nop 0
buffer_load_dwordx4 v2, s[60:63], s6 offen  lds
s_add_u32 s6, s12, 3072
s_mov_b32 m0, s6
s_nop 0
buffer_load_dwordx4 v2, s[60:63], s6 offen  lds
s_add_u32 s6, s12, 4096
s_mov_b32 m0, s6
s_nop 0
buffer_load_dwordx4 v2, s[60:63], s6 offen  lds
s_add_u32 s6, s12, 5120
s_mov_b32 m0, s6
s_nop 0
buffer_load_dwordx4 v2, s[60:63], s6 offen  lds
s_add_u32 s6, s12, 6144
s_mov_b32 m0, s6
s_nop 0
buffer_load_dwordx4 v2, s[60:63], s6 offen  lds
s_add_u32 s6, s12, 7168
s_mov_b32 m0, s6
s_nop 0
buffer_load_dwordx4 v2, s[60:63], s6 offen  lds
s_add_u32 s6, s12, 8192
s_mov_b32 m0, s6
s_nop 0
buffer_load_dwordx4 v2, s[60:63], s6 offen  lds
s_add_u32 s6, s12, 9216
s_mov_b32 m0, s6
s_nop 0
buffer_load_dwordx4 v2, s[60:63], s6 offen  lds
s_add_u32 s6, s12, 10240
s_mov_b32 m0, s6
s_nop 0
buffer_load_dwordx4 v2, s[60:63], s6 offen  lds
s_add_u32 s6, s12, 11264
s_mov_b32 m0, s6
s_nop 0
buffer_load_dwordx4 v2, s[60:63], s6 offen  lds
s_add_u32 s6, s12, 12288
s_mov_b32 m0, s6
s_nop 0
buffer_load_dwordx4 v2, s[60:63], s6 offen  lds
s_add_u32 s6, s12, 13312
s_mov_b32 m0, s6
s_nop 0
buffer_load_dwordx4 v2, s[60:63], s6 offen  lds
s_add_u32 s6, s12, 14336
s_mov_b32 m0, s6
s_nop 0
buffer_load_dwordx4 v2, s[60:63], s6 offen  lds
s_add_u32 s6, s12, 15360
s_mov_b32 m0, s6
s_nop 0
buffer_load_dwordx4 v2, s[60:63], s6 offen  lds
s_add_u32 s6, s12, 16384
s_mov_b32 m0, s6
s_nop 0
buffer_load_dwordx4 v2, s[60:63], s6 offen  lds
s_add_u32 s6, s12, 17408
s_mov_b32 m0, s6
s_nop 0
buffer_load_dwordx4 v2, s[60:63], s6 offen  lds
v_lshrrev_b32 v5, 4, v1
v_lshlrev_b32 v5, 3, v5
v_bfe_u32 v6, v1, 2, 2
v_add_u32 v5, v5, v6
v_mul_u32_u24 v5, 1152, v5
s_mul_i32 s6, s3, 288
v_add_u32 v5, s6, v5
v_and_b32 v6, 3, v1
v_lshl_add_u32 v158, v6, 5, v5
v_lshl_add_u32 v159, v6, 3, v5
v_add_u32 v159, 256, v159
v_bfe_u32 v5, v1, 2, 2
v_lshl_add_u32 v5, v9, 3, v5
v_lshlrev_b32 v5, 7, v5
v_and_b32 v6, 3, v1
v_lshl_add_u32 v5, v6, 3, v5
v_add_u32 v5, 73728, v5
v_bfe_u32 v6, v1, 3, 2
v_xor_b32 v7, 0, v6
v_lshl_add_u32 v154, v7, 5, v5
v_xor_b32 v7, 1, v6
v_lshl_add_u32 v155, v7, 5, v5
v_xor_b32 v7, 2, v6
v_lshl_add_u32 v156, v7, 5, v5
v_xor_b32 v7, 3, v6
v_lshl_add_u32 v157, v7, 5, v5
v_lshlrev_b32 v5, 10, v8
v_lshl_add_u32 v5, v9, 4, v5
v_lshlrev_b32 v6, 3, v8
s_lshl_b32 s6, s9, 9
s_lshl_b32 s7, s3, 7
s_add_u32 s6, s6, s7
s_add_u32 s6, s6, 262144
s_mov_b32 s7, 400000
P_poll:
buffer_load_dwordx2 v[148:149], v6, s[64:67], s6 offen sc1
s_waitcnt vmcnt(0)
v_max_u32 v150, v148, v149
v_cmp_eq_u32 vcc, -1, v150
s_cbranch_vccz P_ok
s_sleep 16
s_sub_u32 s7, s7, 1
s_cmp_lg_u32 s7, 0
s_cbranch_scc1 P_poll
P_ok:
s_lshl_b32 s6, s4, 16
s_lshl_b32 s7, s3, 14
s_add_u32 s6, s6, s7
s_add_u32 s6, s6, 1048576
buffer_load_dwordx4 v[12:15], v5, s[64:67], s6 offen offset:0 sc1
buffer_load_dwordx4 v[16:19], v5, s[64:67], s6 offen offset:64 sc1
buffer_load_dwordx4 v[20:23], v5, s[64:67], s6 offen offset:128 sc1
buffer_load_dwordx4 v[24:27], v5, s[64:67], s6 offen offset:192 sc1
buffer_load_dwordx4 v[28:31], v5, s[64:67], s6 offen offset:256 sc1
buffer_load_dwordx4 v[32:35], v5, s[64:67], s6 offen offset:320 sc1
buffer_load_dwordx4 v[36:39], v5, s[64:67], s6 offen offset:384 sc1
buffer_load_dwordx4 v[40:43], v5, s[64:67], s6 offen offset:448 sc1
buffer_load_dwordx4 v[44:47], v5, s[64:67], s6 offen offset:512 sc1
buffer_load_dwordx4 v[48:51], v5, s[64:67], s6 offen offset:576 sc1
buffer_load_dwordx4 v[52:55], v5, s[64:67], s6 offen offset:640 sc1
buffer_load_dwordx4 v[56:59], v5, s[64:67], s6 offen offset:704 sc1
buffer_load_dwordx4 v[60:63], v5, s[64:67], s6 offen offset:768 sc1
buffer_load_dwordx4 v[64:67], v5, s[64:67], s6 offen offset:832 sc1
buffer_load_dwordx4 v[68:71], v5, s[64:67], s6 offen offset:896 sc1
buffer_load_dwordx4 v[72:75], v5, s[64:67], s6 offen offset:960 sc1
s_barrier
ds_read_b64_tr_b16 a[96:97], v158 offset:0
ds_read_b64_tr_b16 a[98:99], v158 offset:4608
ds_read_b64_tr_b16 a[100:101], v158 offset:36864
ds_read_b64_tr_b16 a[102:103], v158 offset:41472
ds_read_b64_tr_b16 a[104:105], v158 offset:8
ds_read_b64_tr_b16 a[106:107], v158 offset:4616
ds_read_b64_tr_b16 a[108:109], v158 offset:36872
ds_read_b64_tr_b16 a[110:111], v158 offset:41480
ds_read_b64_tr_b16 a[112:113], v158 offset:16
ds_read_b64_tr_b16 a[114:115], v158 offset:4624
ds_read_b64_tr_b16 a[116:117], v158 offset:36880
ds_read_b64_tr_b16 a[118:119], v158 offset:41488
ds_read_b64_tr_b16 a[120:121], v158 offset:24
ds_read_b64_tr_b16 a[122:123], v158 offset:4632
ds_read_b64_tr_b16 a[124:125], v158 offset:36888
ds_read_b64_tr_b16 a[126:127], v158 offset:41496
ds_read_b64_tr_b16 a[128:129], v158 offset:128
ds_read_b64_tr_b16 a[130:131], v158 offset:4736
ds_read_b64_tr_b16 a[132:133], v158 offset:36992
ds_read_b64_tr_b16 a[134:135], v158 offset:41600
ds_read_b64_tr_b16 a[136:137], v158 offset:136
ds_read_b64_tr_b16 a[138:139], v158 offset:4744
ds_read_b64_tr_b16 a[140:141], v158 offset:37000
ds_read_b64_tr_b16 a[142:143], v158 offset:41608
ds_read_b64_tr_b16 a[144:145], v158 offset:144
ds_read_b64_tr_b16 a[146:147], v158 offset:4752
ds_read_b64_tr_b16 a[148:149], v158 offset:37008
ds_read_b64_tr_b16 a[150:151], v158 offset:41616
ds_read_b64_tr_b16 a[152:153], v158 offset:152
ds_read_b64_tr_b16 a[154:155], v158 offset:4760
ds_read_b64_tr_b16 a[156:157], v158 offset:37016
ds_read_b64_tr_b16 a[158:159], v158 offset:41624
ds_read_b64_tr_b16 a[160:161], v159 offset:0
ds_read_b64_tr_b16 a[162:163], v159 offset:4608
ds_read_b64_tr_b16 a[164:165], v159 offset:36864
ds_read_b64_tr_b16 a[166:167], v159 offset:41472
v_mov_b32 v150, v148
s_nop 1
v_max_f32_dpp v150, v150, v150 row_ror:8 row_mask:0xf bank_mask:0xf
s_nop 1
v_max_f32_dpp v150, v150, v150 row_ror:4 row_mask:0xf bank_mask:0xf
s_nop 1
v_max_f32_dpp v150, v150, v150 row_ror:2 row_mask:0xf bank_mask:0xf
s_nop 1
v_max_f32_dpp v150, v150, v150 row_ror:1 row_mask:0xf bank_mask:0xf
v_sub_f32 v148, v148, v150
v_exp_f32 v148, v148
s_nop 0
v_mul_f32 v151, v148, v149
s_nop 1
v_add_f32_dpp v151, v151, v151 row_ror:8 row_mask:0xf bank_mask:0xf
s_nop 1
v_add_f32_dpp v151, v151, v151 row_ror:4 row_mask:0xf bank_mask:0xf
s_nop 1
v_add_f32_dpp v151, v151, v151 row_ror:2 row_mask:0xf bank_mask:0xf
s_nop 1
v_add_f32_dpp v151, v151, v151 row_ror:1 row_mask:0xf bank_mask:0xf
v_rcp_f32 v151, v151
s_nop 0
v_mul_f32 v148, v148, v151
s_nop 1
v_mov_b32_dpp v144, v148 row_newbcast:0 row_mask:0x1 bank_mask:0xf
v_mov_b32_dpp v144, v148 row_newbcast:4 row_mask:0x2 bank_mask:0xf
v_mov_b32_dpp v144, v148 row_newbcast:8 row_mask:0x4 bank_mask:0xf
v_mov_b32_dpp v144, v148 row_newbcast:12 row_mask:0x8 bank_mask:0xf
v_mov_b32_dpp v145, v148 row_newbcast:1 row_mask:0x1 bank_mask:0xf
v_mov_b32_dpp v145, v148 row_newbcast:5 row_mask:0x2 bank_mask:0xf
v_mov_b32_dpp v145, v148 row_newbcast:9 row_mask:0x4 bank_mask:0xf
v_mov_b32_dpp v145, v148 row_newbcast:13 row_mask:0x8 bank_mask:0xf
v_mov_b32_dpp v146, v148 row_newbcast:2 row_mask:0x1 bank_mask:0xf
v_mov_b32_dpp v146, v148 row_newbcast:6 row_mask:0x2 bank_mask:0xf
v_mov_b32_dpp v146, v148 row_newbcast:10 row_mask:0x4 bank_mask:0xf
v_mov_b32_dpp v146, v148 row_newbcast:14 row_mask:0x8 bank_mask:0xf
v_mov_b32_dpp v147, v148 row_newbcast:3 row_mask:0x1 bank_mask:0xf
v_mov_b32_dpp v147, v148 row_newbcast:7 row_mask:0x2 bank_mask:0xf
v_mov_b32_dpp v147, v148 row_newbcast:11 row_mask:0x4 bank_mask:0xf
v_mov_b32_dpp v147, v148 row_newbcast:15 row_mask:0x8 bank_mask:0xf
s_waitcnt lgkmcnt(0)
ds_read_b64_tr_b16 v[76:77], v154 offset:0
ds_read_b64_tr_b16 v[78:79], v154 offset:512
ds_read_b64_tr_b16 v[80:81], v155 offset:0
ds_read_b64_tr_b16 v[82:83], v155 offset:512
ds_read_b64_tr_b16 v[84:85], v156 offset:0
ds_read_b64_tr_b16 v[86:87], v156 offset:512
ds_read_b64_tr_b16 v[88:89], v157 offset:0
ds_read_b64_tr_b16 v[90:91], v157 offset:512
ds_read_b64_tr_b16 v[92:93], v154 offset:4096
ds_read_b64_tr_b16 v[94:95], v154 offset:4608
ds_read_b64_tr_b16 v[96:97], v155 offset:4096
ds_read_b64_tr_b16 v[98:99], v155 offset:4608
ds_read_b64_tr_b16 v[100:101], v156 offset:4096
ds_read_b64_tr_b16 v[102:103], v156 offset:4608
ds_read_b64_tr_b16 v[104:105], v157 offset:4096
ds_read_b64_tr_b16 v[106:107], v157 offset:4608
s_waitcnt vmcnt(15)
s_waitcnt lgkmcnt(8)
v_mfma_f32_16x16x32_bf16 v[108:111], v[12:15], v[76:79], 0
v_mfma_f32_16x16x32_bf16 v[112:115], v[12:15], v[80:83], 0
v_mfma_f32_16x16x32_bf16 v[116:119], v[12:15], v[84:87], 0
v_mfma_f32_16x16x32_bf16 v[120:123], v[12:15], v[88:91], 0
ds_read_b64_tr_b16 v[76:77], v154 offset:8192
ds_read_b64_tr_b16 v[78:79], v154 offset:8704
ds_read_b64_tr_b16 v[80:81], v155 offset:8192
ds_read_b64_tr_b16 v[82:83], v155 offset:8704
ds_read_b64_tr_b16 v[84:85], v156 offset:8192
ds_read_b64_tr_b16 v[86:87], v156 offset:8704
ds_read_b64_tr_b16 v[88:89], v157 offset:8192
ds_read_b64_tr_b16 v[90:91], v157 offset:8704
s_waitcnt vmcnt(14)
s_waitcnt lgkmcnt(8)
v_mfma_f32_16x16x32_bf16 v[108:111], v[16:19], v[92:95], v[108:111]
v_mfma_f32_16x16x32_bf16 v[112:115], v[16:19], v[96:99], v[112:115]
v_mfma_f32_16x16x32_bf16 v[116:119], v[16:19], v[100:103], v[116:119]
v_mfma_f32_16x16x32_bf16 v[120:123], v[16:19], v[104:107], v[120:123]
ds_read_b64_tr_b16 v[92:93], v154 offset:12288
ds_read_b64_tr_b16 v[94:95], v154 offset:12800
ds_read_b64_tr_b16 v[96:97], v155 offset:12288
ds_read_b64_tr_b16 v[98:99], v155 offset:12800
ds_read_b64_tr_b16 v[100:101], v156 offset:12288
ds_read_b64_tr_b16 v[102:103], v156 offset:12800
ds_read_b64_tr_b16 v[104:105], v157 offset:12288
ds_read_b64_tr_b16 v[106:107], v157 offset:12800
s_waitcnt vmcnt(13)
s_waitcnt lgkmcnt(8)
v_mfma_f32_16x16x32_bf16 v[108:111], v[20:23], v[76:79], v[108:111]
v_mfma_f32_16x16x32_bf16 v[112:115], v[20:23], v[80:83], v[112:115]
v_mfma_f32_16x16x32_bf16 v[116:119], v[20:23], v[84:87], v[116:119]
v_mfma_f32_16x16x32_bf16 v[120:123], v[20:23], v[88:91], v[120:123]
ds_read_b64_tr_b16 v[76:77], v154 offset:16384
ds_read_b64_tr_b16 v[78:79], v154 offset:16896
ds_read_b64_tr_b16 v[80:81], v155 offset:16384
ds_read_b64_tr_b16 v[82:83], v155 offset:16896
ds_read_b64_tr_b16 v[84:85], v156 offset:16384
ds_read_b64_tr_b16 v[86:87], v156 offset:16896
ds_read_b64_tr_b16 v[88:89], v157 offset:16384
ds_read_b64_tr_b16 v[90:91], v157 offset:16896
s_waitcnt vmcnt(12)
s_waitcnt lgkmcnt(8)
v_mfma_f32_16x16x32_bf16 v[108:111], v[24:27], v[92:95], v[108:111]
v_mfma_f32_16x16x32_bf16 v[112:115], v[24:27], v[96:99], v[112:115]
v_mfma_f32_16x16x32_bf16 v[116:119], v[24:27], v[100:103], v[116:119]
v_mfma_f32_16x16x32_bf16 v[120:123], v[24:27], v[104:107], v[120:123]
ds_read_b64_tr_b16 v[92:93], v154 offset:20480
ds_read_b64_tr_b16 v[94:95], v154 offset:20992
ds_read_b64_tr_b16 v[96:97], v155 offset:20480
ds_read_b64_tr_b16 v[98:99], v155 offset:20992
ds_read_b64_tr_b16 v[100:101], v156 offset:20480
ds_read_b64_tr_b16 v[102:103], v156 offset:20992
ds_read_b64_tr_b16 v[104:105], v157 offset:20480
ds_read_b64_tr_b16 v[106:107], v157 offset:20992
s_waitcnt vmcnt(11)
s_waitcnt lgkmcnt(8)
v_mfma_f32_16x16x32_bf16 v[108:111], v[28:31], v[76:79], v[108:111]
v_mfma_f32_16x16x32_bf16 v[112:115], v[28:31], v[80:83], v[112:115]
v_mfma_f32_16x16x32_bf16 v[116:119], v[28:31], v[84:87], v[116:119]
v_mfma_f32_16x16x32_bf16 v[120:123], v[28:31], v[88:91], v[120:123]
ds_read_b64_tr_b16 v[76:77], v154 offset:24576
ds_read_b64_tr_b16 v[78:79], v154 offset:25088
ds_read_b64_tr_b16 v[80:81], v155 offset:24576
ds_read_b64_tr_b16 v[82:83], v155 offset:25088
ds_read_b64_tr_b16 v[84:85], v156 offset:24576
ds_read_b64_tr_b16 v[86:87], v156 offset:25088
ds_read_b64_tr_b16 v[88:89], v157 offset:24576
ds_read_b64_tr_b16 v[90:91], v157 offset:25088
s_waitcnt vmcnt(10)
s_waitcnt lgkmcnt(8)
v_mfma_f32_16x16x32_bf16 v[108:111], v[32:35], v[92:95], v[108:111]
v_mfma_f32_16x16x32_bf16 v[112:115], v[32:35], v[96:99], v[112:115]
v_mfma_f32_16x16x32_bf16 v[116:119], v[32:35], v[100:103], v[116:119]
v_mfma_f32_16x16x32_bf16 v[120:123], v[32:35], v[104:107], v[120:123]
ds_read_b64_tr_b16 v[92:93], v154 offset:28672
ds_read_b64_tr_b16 v[94:95], v154 offset:29184
ds_read_b64_tr_b16 v[96:97], v155 offset:28672
ds_read_b64_tr_b16 v[98:99], v155 offset:29184
ds_read_b64_tr_b16 v[100:101], v156 offset:28672
ds_read_b64_tr_b16 v[102:103], v156 offset:29184
ds_read_b64_tr_b16 v[104:105], v157 offset:28672
ds_read_b64_tr_b16 v[106:107], v157 offset:29184
s_waitcnt vmcnt(9)
s_waitcnt lgkmcnt(8)
v_mfma_f32_16x16x32_bf16 v[108:111], v[36:39], v[76:79], v[108:111]
v_mfma_f32_16x16x32_bf16 v[112:115], v[36:39], v[80:83], v[112:115]
v_mfma_f32_16x16x32_bf16 v[116:119], v[36:39], v[84:87], v[116:119]
v_mfma_f32_16x16x32_bf16 v[120:123], v[36:39], v[88:91], v[120:123]
ds_read_b64_tr_b16 v[76:77], v154 offset:32768
ds_read_b64_tr_b16 v[78:79], v154 offset:33280
ds_read_b64_tr_b16 v[80:81], v155 offset:32768
ds_read_b64_tr_b16 v[82:83], v155 offset:33280
ds_read_b64_tr_b16 v[84:85], v156 offset:32768
ds_read_b64_tr_b16 v[86:87], v156 offset:33280
ds_read_b64_tr_b16 v[88:89], v157 offset:32768
ds_read_b64_tr_b16 v[90:91], v157 offset:33280
s_waitcnt vmcnt(8)
s_waitcnt lgkmcnt(8)
v_mfma_f32_16x16x32_bf16 v[108:111], v[40:43], v[92:95], v[108:111]
v_mfma_f32_16x16x32_bf16 v[112:115], v[40:43], v[96:99], v[112:115]
v_mfma_f32_16x16x32_bf16 v[116:119], v[40:43], v[100:103], v[116:119]
v_mfma_f32_16x16x32_bf16 v[120:123], v[40:43], v[104:107], v[120:123]
ds_read_b64_tr_b16 v[92:93], v154 offset:36864
ds_read_b64_tr_b16 v[94:95], v154 offset:37376
ds_read_b64_tr_b16 v[96:97], v155 offset:36864
ds_read_b64_tr_b16 v[98:99], v155 offset:37376
ds_read_b64_tr_b16 v[100:101], v156 offset:36864
ds_read_b64_tr_b16 v[102:103], v156 offset:37376
ds_read_b64_tr_b16 v[104:105], v157 offset:36864
ds_read_b64_tr_b16 v[106:107], v157 offset:37376
s_waitcnt vmcnt(7)
s_waitcnt lgkmcnt(8)
v_mfma_f32_16x16x32_bf16 v[108:111], v[44:47], v[76:79], v[108:111]
v_mfma_f32_16x16x32_bf16 v[112:115], v[44:47], v[80:83], v[112:115]
v_mfma_f32_16x16x32_bf16 v[116:119], v[44:47], v[84:87], v[116:119]
v_mfma_f32_16x16x32_bf16 v[120:123], v[44:47], v[88:91], v[120:123]
ds_read_b64_tr_b16 v[76:77], v154 offset:40960
ds_read_b64_tr_b16 v[78:79], v154 offset:41472
ds_read_b64_tr_b16 v[80:81], v155 offset:40960
ds_read_b64_tr_b16 v[82:83], v155 offset:41472
ds_read_b64_tr_b16 v[84:85], v156 offset:40960
ds_read_b64_tr_b16 v[86:87], v156 offset:41472
ds_read_b64_tr_b16 v[88:89], v157 offset:40960
ds_read_b64_tr_b16 v[90:91], v157 offset:41472
s_waitcnt vmcnt(6)
s_waitcnt lgkmcnt(8)
v_mfma_f32_16x16x32_bf16 v[108:111], v[48:51], v[92:95], v[108:111]
v_mfma_f32_16x16x32_bf16 v[112:115], v[48:51], v[96:99], v[112:115]
v_mfma_f32_16x16x32_bf16 v[116:119], v[48:51], v[100:103], v[116:119]
v_mfma_f32_16x16x32_bf16 v[120:123], v[48:51], v[104:107], v[120:123]
ds_read_b64_tr_b16 v[92:93], v154 offset:45056
ds_read_b64_tr_b16 v[94:95], v154 offset:45568
ds_read_b64_tr_b16 v[96:97], v155 offset:45056
ds_read_b64_tr_b16 v[98:99], v155 offset:45568
ds_read_b64_tr_b16 v[100:101], v156 offset:45056
ds_read_b64_tr_b16 v[102:103], v156 offset:45568
ds_read_b64_tr_b16 v[104:105], v157 offset:45056
ds_read_b64_tr_b16 v[106:107], v157 offset:45568
s_waitcnt vmcnt(5)
s_waitcnt lgkmcnt(8)
v_mfma_f32_16x16x32_bf16 v[108:111], v[52:55], v[76:79], v[108:111]
v_mfma_f32_16x16x32_bf16 v[112:115], v[52:55], v[80:83], v[112:115]
v_mfma_f32_16x16x32_bf16 v[116:119], v[52:55], v[84:87], v[116:119]
v_mfma_f32_16x16x32_bf16 v[120:123], v[52:55], v[88:91], v[120:123]
ds_read_b64_tr_b16 v[76:77], v154 offset:49152
ds_read_b64_tr_b16 v[78:79], v154 offset:49664
ds_read_b64_tr_b16 v[80:81], v155 offset:49152
ds_read_b64_tr_b16 v[82:83], v155 offset:49664
ds_read_b64_tr_b16 v[84:85], v156 offset:49152
ds_read_b64_tr_b16 v[86:87], v156 offset:49664
ds_read_b64_tr_b16 v[88:89], v157 offset:49152
ds_read_b64_tr_b16 v[90:91], v157 offset:49664
s_waitcnt vmcnt(4)
s_waitcnt lgkmcnt(8)
v_mfma_f32_16x16x32_bf16 v[108:111], v[56:59], v[92:95], v[108:111]
v_mfma_f32_16x16x32_bf16 v[112:115], v[56:59], v[96:99], v[112:115]
v_mfma_f32_16x16x32_bf16 v[116:119], v[56:59], v[100:103], v[116:119]
v_mfma_f32_16x16x32_bf16 v[120:123], v[56:59], v[104:107], v[120:123]
ds_read_b64_tr_b16 v[92:93], v154 offset:53248
ds_read_b64_tr_b16 v[94:95], v154 offset:53760
ds_read_b64_tr_b16 v[96:97], v155 offset:53248
ds_read_b64_tr_b16 v[98:99], v155 offset:53760
ds_read_b64_tr_b16 v[100:101], v156 offset:53248
ds_read_b64_tr_b16 v[102:103], v156 offset:53760
ds_read_b64_tr_b16 v[104:105], v157 offset:53248
ds_read_b64_tr_b16 v[106:107], v157 offset:53760
s_waitcnt vmcnt(3)
s_waitcnt lgkmcnt(8)
v_mfma_f32_16x16x32_bf16 v[108:111], v[60:63], v[76:79], v[108:111]
v_mfma_f32_16x16x32_bf16 v[112:115], v[60:63], v[80:83], v[112:115]
v_mfma_f32_16x16x32_bf16 v[116:119], v[60:63], v[84:87], v[116:119]
v_mfma_f32_16x16x32_bf16 v[120:123], v[60:63], v[88:91], v[120:123]
ds_read_b64_tr_b16 v[76:77], v154 offset:57344
ds_read_b64_tr_b16 v[78:79], v154 offset:57856
ds_read_b64_tr_b16 v[80:81], v155 offset:57344
ds_read_b64_tr_b16 v[82:83], v155 offset:57856
ds_read_b64_tr_b16 v[84:85], v156 offset:57344
ds_read_b64_tr_b16 v[86:87], v156 offset:57856
ds_read_b64_tr_b16 v[88:89], v157 offset:57344
ds_read_b64_tr_b16 v[90:91], v157 offset:57856
s_waitcnt vmcnt(2)
s_waitcnt lgkmcnt(8)
v_mfma_f32_16x16x32_bf16 v[108:111], v[64:67], v[92:95], v[108:111]
v_mfma_f32_16x16x32_bf16 v[112:115], v[64:67], v[96:99], v[112:115]
v_mfma_f32_16x16x32_bf16 v[116:119], v[64:67], v[100:103], v[116:119]
v_mfma_f32_16x16x32_bf16 v[120:123], v[64:67], v[104:107], v[120:123]
ds_read_b64_tr_b16 v[92:93], v154 offset:61440
ds_read_b64_tr_b16 v[94:95], v154 offset:61952
ds_read_b64_tr_b16 v[96:97], v155 offset:61440
ds_read_b64_tr_b16 v[98:99], v155 offset:61952
ds_read_b64_tr_b16 v[100:101], v156 offset:61440
ds_read_b64_tr_b16 v[102:103], v156 offset:61952
ds_read_b64_tr_b16 v[104:105], v157 offset:61440
ds_read_b64_tr_b16 v[106:107], v157 offset:61952
s_waitcnt vmcnt(1)
s_waitcnt lgkmcnt(8)
v_mfma_f32_16x16x32_bf16 v[108:111], v[68:71], v[76:79], v[108:111]
v_mfma_f32_16x16x32_bf16 v[112:115], v[68:71], v[80:83], v[112:115]
v_mfma_f32_16x16x32_bf16 v[116:119], v[68:71], v[84:87], v[116:119]
v_mfma_f32_16x16x32_bf16 v[120:123], v[68:71], v[88:91], v[120:123]
s_waitcnt vmcnt(0)
s_waitcnt lgkmcnt(0)
v_mfma_f32_16x16x32_bf16 v[108:111], v[72:75], v[92:95], v[108:111]
v_mfma_f32_16x16x32_bf16 v[112:115], v[72:75], v[96:99], v[112:115]
v_mfma_f32_16x16x32_bf16 v[116:119], v[72:75], v[100:103], v[116:119]
v_mfma_f32_16x16x32_bf16 v[120:123], v[72:75], v[104:107], v[120:123]
v_lshlrev_b32 v5, 7, v9
v_lshl_add_u32 v5, v8, 1, v5
s_lshl_b32 s6, s3, 9
s_add_u32 s6, s6, 139264
v_add_u32 v5, s6, v5
v_mul_f32 v172, v144, v108
v_fma_f32 v172, v145, v109, v172
v_fma_f32 v172, v146, v110, v172
v_fma_f32 v172, v147, v111, v172
v_cvt_pk_bf16_f32 v172, v172, v172
ds_write_b16 v5, v172 offset:0
v_mul_f32 v173, v144, v112
v_fma_f32 v173, v145, v113, v173
v_fma_f32 v173, v146, v114, v173
v_fma_f32 v173, v147, v115, v173
v_cvt_pk_bf16_f32 v173, v173, v173
ds_write_b16 v5, v173 offset:32
v_mul_f32 v174, v144, v116
v_fma_f32 v174, v145, v117, v174
v_fma_f32 v174, v146, v118, v174
v_fma_f32 v174, v147, v119, v174
v_cvt_pk_bf16_f32 v174, v174, v174
ds_write_b16 v5, v174 offset:64
v_mul_f32 v175, v144, v120
v_fma_f32 v175, v145, v121, v175
v_fma_f32 v175, v146, v122, v175
v_fma_f32 v175, v147, v123, v175
v_cvt_pk_bf16_f32 v175, v175, v175
ds_write_b16 v5, v175 offset:96
v_lshlrev_b32 v6, 7, v8
v_lshl_add_u32 v6, v9, 4, v6
v_add_u32 v6, 139264, v6
s_waitcnt lgkmcnt(0)
s_barrier
ds_read_b128 v[164:167], v6 offset:0
ds_read_b128 v[168:171], v6 offset:64
v_mul_u32_u24 v5, 147456, v9
v_and_b32 v6, 3, v1
v_bfe_u32 v7, v1, 2, 2
v_lshl_add_u32 v6, v6, 2, v7
v_lshl_add_u32 v6, v6, 2, v5
v_lshl_add_u32 v5, v8, 4, v5
s_mul_i32 s6, s9, 2304
s_mul_i32 s7, s3, 576
s_add_u32 s6, s6, s7
s_add_u32 s6, s6, 5242880
s_waitcnt lgkmcnt(0)
v_mfma_f32_16x16x32_bf16 v[108:111], v[164:167], a[96:99], 0
v_mfma_f32_16x16x32_bf16 v[108:111], v[168:171], a[100:103], v[108:111]
v_mfma_f32_16x16x32_bf16 v[112:115], v[164:167], a[104:107], 0
v_mfma_f32_16x16x32_bf16 v[112:115], v[168:171], a[108:111], v[112:115]
v_mfma_f32_16x16x32_bf16 v[116:119], v[164:167], a[112:115], 0
v_mfma_f32_16x16x32_bf16 v[116:119], v[168:171], a[116:119], v[116:119]
v_mfma_f32_16x16x32_bf16 v[120:123], v[164:167], a[120:123], 0
v_mfma_f32_16x16x32_bf16 v[120:123], v[168:171], a[124:127], v[120:123]
v_mfma_f32_16x16x32_bf16 v[124:127], v[164:167], a[128:131], 0
v_mfma_f32_16x16x32_bf16 v[124:127], v[168:171], a[132:135], v[124:127]
v_mfma_f32_16x16x32_bf16 v[128:131], v[164:167], a[136:139], 0
v_mfma_f32_16x16x32_bf16 v[128:131], v[168:171], a[140:143], v[128:131]
v_mfma_f32_16x16x32_bf16 v[132:135], v[164:167], a[144:147], 0
v_mfma_f32_16x16x32_bf16 v[132:135], v[168:171], a[148:151], v[132:135]
v_mfma_f32_16x16x32_bf16 v[136:139], v[164:167], a[152:155], 0
v_mfma_f32_16x16x32_bf16 v[136:139], v[168:171], a[156:159], v[136:139]
v_mfma_f32_16x16x32_bf16 v[140:143], v[164:167], a[160:163], 0
v_mfma_f32_16x16x32_bf16 v[140:143], v[168:171], a[164:167], v[140:143]
v_add_f32 v108, v108, v109
v_add_f32 v110, v110, v111
v_add_f32 v172, v108, v110
v_min_u32 v172, -2, v172
v_add_f32 v112, v112, v113
v_add_f32 v114, v114, v115
v_add_f32 v173, v112, v114
v_min_u32 v173, -2, v173
v_add_f32 v116, v116, v117
v_add_f32 v118, v118, v119
v_add_f32 v174, v116, v118
v_min_u32 v174, -2, v174
v_add_f32 v120, v120, v121
v_add_f32 v122, v122, v123
v_add_f32 v175, v120, v122
v_min_u32 v175, -2, v175
v_add_f32 v124, v124, v125
v_add_f32 v126, v126, v127
v_add_f32 v176, v124, v126
v_min_u32 v176, -2, v176
v_add_f32 v128, v128, v129
v_add_f32 v130, v130, v131
v_add_f32 v177, v128, v130
v_min_u32 v177, -2, v177
v_add_f32 v132, v132, v133
v_add_f32 v134, v134, v135
v_add_f32 v178, v132, v134
v_min_u32 v178, -2, v178
v_add_f32 v136, v136, v137
v_add_f32 v138, v138, v139
v_add_f32 v179, v136, v138
v_min_u32 v179, -2, v179
v_add_f32 v140, v140, v141
v_add_f32 v142, v142, v143
v_add_f32 v180, v140, v142
v_min_u32 v180, -2, v180
buffer_store_dwordx4 v[172:175], v5, s[64:67], s6 offen sc1
buffer_store_dwordx4 v[176:179], v5, s[64:67], s6 offen offset:256 sc1
buffer_store_dword v180, v6, s[64:67], s6 offen offset:512 sc1
s_and_b32 s6, s3, 1
s_lshl_b32 s6, s6, 6
s_add_u32 s14, s9, s6
s_cmp_ge_u32 s14, 72
s_cbranch_scc1 B_end
s_mul_i32 s15, s14, 57
s_lshr_b32 s15, s15, 10
s_mul_i32 s6, s15, 18
s_sub_u32 s80, s14, s6
s_lshr_b32 s7, s3, 1
s_mul_i32 s81, s15, 147456
s_lshl_b32 s6, s80, 7
s_add_u32 s81, s81, s6
s_mul_i32 s6, s7, 1048576
s_add_u32 s81, s81, s6
s_add_u32 s81, s81, 4194304
s_mul_i32 s83, s15, 2304
s_lshl_b32 s6, s80, 6
s_add_u32 s83, s83, s6
s_mul_i32 s6, s7, 1152
s_add_u32 s83, s83, s6
v_lshrrev_b32 v5, 3, v1
v_and_b32 v6, 7, v1
v_mul_u32_u24 v44, 2304, v5
v_lshl_add_u32 v44, v6, 4, v44
v_bfe_u32 v5, v1, 2, 1
v_lshl_add_u32 v5, v5, 2, v9
v_and_b32 v6, 3, v1
v_lshl_add_u32 v5, v5, 2, v6
v_lshlrev_b32 v45, 1, v5
s_mov_b32 s82, 0
s_mov_b32 s7, 400000
R_pass:
s_bitcmp1_b32 s82, 0
s_cbranch_scc1 L_ld_23
s_add_u32 s6, s81, 0
buffer_load_dwordx4 v[12:15], v44, s[64:67], s6 offen sc1
L_ld_23:
s_bitcmp1_b32 s82, 1
s_cbranch_scc1 L_ld_24
s_add_u32 s6, s81, 18432
buffer_load_dwordx4 v[16:19], v44, s[64:67], s6 offen sc1
L_ld_24:
s_bitcmp1_b32 s82, 2
s_cbranch_scc1 L_ld_25
s_add_u32 s6, s81, 36864
buffer_load_dwordx4 v[20:23], v44, s[64:67], s6 offen sc1
L_ld_25:
s_bitcmp1_b32 s82, 3
s_cbranch_scc1 L_ld_26
s_add_u32 s6, s81, 55296
buffer_load_dwordx4 v[24:27], v44, s[64:67], s6 offen sc1
L_ld_26:
s_bitcmp1_b32 s82, 4
s_cbranch_scc1 L_ld_27
s_add_u32 s6, s81, 73728
buffer_load_dwordx4 v[28:31], v44, s[64:67], s6 offen sc1
L_ld_27:
s_bitcmp1_b32 s82, 5
s_cbranch_scc1 L_ld_28
s_add_u32 s6, s81, 92160
buffer_load_dwordx4 v[32:35], v44, s[64:67], s6 offen sc1
L_ld_28:
s_bitcmp1_b32 s82, 6
s_cbranch_scc1 L_ld_29
s_add_u32 s6, s81, 110592
buffer_load_dwordx4 v[36:39], v44, s[64:67], s6 offen sc1
L_ld_29:
s_bitcmp1_b32 s82, 7
s_cbranch_scc1 L_ld_30
s_add_u32 s6, s81, 129024
buffer_load_dwordx4 v[40:43], v44, s[64:67], s6 offen sc1
L_ld_30:
s_waitcnt vmcnt(0)
s_bitcmp1_b32 s82, 0
s_cbranch_scc1 L_ck_31
v_max3_u32 v46, v12, v13, v14
v_max_u32 v46, v46, v15
v_cmp_eq_u32 vcc, -1, v46
s_cbranch_vccnz L_ck_31
s_bitset1_b32 s82, 0
L_ck_31:
s_bitcmp1_b32 s82, 1
s_cbranch_scc1 L_ck_32
v_max3_u32 v46, v16, v17, v18
v_max_u32 v46, v46, v19
v_cmp_eq_u32 vcc, -1, v46
s_cbranch_vccnz L_ck_32
s_bitset1_b32 s82, 1
L_ck_32:
s_bitcmp1_b32 s82, 2
s_cbranch_scc1 L_ck_33
v_max3_u32 v46, v20, v21, v22
v_max_u32 v46, v46, v23
v_cmp_eq_u32 vcc, -1, v46
s_cbranch_vccnz L_ck_33
s_bitset1_b32 s82, 2
L_ck_33:
s_bitcmp1_b32 s82, 3
s_cbranch_scc1 L_ck_34
v_max3_u32 v46, v24, v25, v26
v_max_u32 v46, v46, v27
v_cmp_eq_u32 vcc, -1, v46
s_cbranch_vccnz L_ck_34
s_bitset1_b32 s82, 3
L_ck_34:
s_bitcmp1_b32 s82, 4
s_cbranch_scc1 L_ck_35
v_max3_u32 v46, v28, v29, v30
v_max_u32 v46, v46, v31
v_cmp_eq_u32 vcc, -1, v46
s_cbranch_vccnz L_ck_35
s_bitset1_b32 s82, 4
L_ck_35:
s_bitcmp1_b32 s82, 5
s_cbranch_scc1 L_ck_36
v_max3_u32 v46, v32, v33, v34
v_max_u32 v46, v46, v35
v_cmp_eq_u32 vcc, -1, v46
s_cbranch_vccnz L_ck_36
s_bitset1_b32 s82, 5
L_ck_36:
s_bitcmp1_b32 s82, 6
s_cbranch_scc1 L_ck_37
v_max3_u32 v46, v36, v37, v38
v_max_u32 v46, v46, v39
v_cmp_eq_u32 vcc, -1, v46
s_cbranch_vccnz L_ck_37
s_bitset1_b32 s82, 6
L_ck_37:
s_bitcmp1_b32 s82, 7
s_cbranch_scc1 L_ck_38
v_max3_u32 v46, v40, v41, v42
v_max_u32 v46, v46, v43
v_cmp_eq_u32 vcc, -1, v46
s_cbranch_vccnz L_ck_38
s_bitset1_b32 s82, 7
L_ck_38:
s_cmp_eq_u32 s82, 255
s_cbranch_scc1 R_done
s_sleep 4
s_sub_u32 s7, s7, 1
s_cmp_lg_u32 s7, 0
s_cbranch_scc1 R_pass
R_done:
v_pk_add_f32 v[12:13], v[12:13], v[28:29]
v_pk_add_f32 v[14:15], v[14:15], v[30:31]
v_pk_add_f32 v[16:17], v[16:17], v[32:33]
v_pk_add_f32 v[18:19], v[18:19], v[34:35]
v_pk_add_f32 v[20:21], v[20:21], v[36:37]
v_pk_add_f32 v[22:23], v[22:23], v[38:39]
v_pk_add_f32 v[24:25], v[24:25], v[40:41]
v_pk_add_f32 v[26:27], v[26:27], v[42:43]
v_pk_add_f32 v[12:13], v[12:13], v[20:21]
v_pk_add_f32 v[14:15], v[14:15], v[22:23]
v_pk_add_f32 v[16:17], v[16:17], v[24:25]
v_pk_add_f32 v[18:19], v[18:19], v[26:27]
v_pk_add_f32 v[12:13], v[12:13], v[16:17]
v_pk_add_f32 v[14:15], v[14:15], v[18:19]
s_nop 1
v_permlane32_swap_b32 v12, v14
v_permlane32_swap_b32 v13, v15
v_add_f32 v12, v12, v14
v_add_f32 v13, v13, v15
s_nop 1
v_permlane16_swap_b32 v12, v13
v_add_f32 v12, v12, v13
s_nop 1
v_add_f32_dpp v12, v12, v12 row_ror:8 row_mask:0xf bank_mask:0xf
v_cvt_pk_bf16_f32 v12, v12, v12
s_mov_b32 exec_lo, 0x00ff00ff
s_mov_b32 exec_hi, 0x00ff00ff
buffer_store_short v12, v45, s[72:75], s83 offen
s_mov_b64 exec, -1
B_end:
s_endpgm
.section .rodata,"a"
.p2align 6
.amdhsa_kernel concat_heads__mha_block_cached__compressed_kv_cla__decode_kernel
  .amdhsa_next_free_vgpr 512
  .amdhsa_next_free_sgpr 102
  .amdhsa_accum_offset 256
  .amdhsa_group_segment_fixed_size 0
  .amdhsa_kernarg_size 112
  .amdhsa_user_sgpr_count 2
  .amdhsa_user_sgpr_kernarg_segment_ptr 1
  .amdhsa_system_sgpr_workgroup_id_x 1
.end_amdhsa_kernel
```

```asm
; @launch grid=(256,1,1) block=(256,1,1) lds=163840
.amdgcn_target "amdgcn-amd-amdhsa--gfx950"
.text
.globl concat_heads__mha_block_cached__compressed_kv_cla__decode_kernel
.p2align 8
.type concat_heads__mha_block_cached__compressed_kv_cla__decode_kernel,@function
concat_heads__mha_block_cached__compressed_kv_cla__decode_kernel:
s_cmp_ge_u32 s2, 256
s_cbranch_scc1 L_exit
s_load_dwordx16 s[16:31], s[0:1], 0
s_load_dwordx8 s[32:39], s[0:1], 64
s_load_dwordx4 s[40:43], s[0:1], 96
v_lshrrev_b32 v1, 6, v0
s_nop 0
v_readfirstlane_b32 s3, v1
s_and_b32 s6, s2, 7
s_bfe_u32 s7, s2, 0x20003
s_lshl_b32 s4, s6, 2
s_add_u32 s4, s4, s7
s_lshr_b32 s5, s2, 5
s_cmp_lt_u32 s5, 2
s_cbranch_scc1 B_role
A_role:
s_sub_u32 s8, s5, 2
s_cmp_ge_u32 s8, 3
s_cselect_b32 s9, 1, 0
s_cselect_b32 s6, 3, 0
s_sub_u32 s8, s8, s6
s_lshl_b32 s11, s8, 2
s_add_u32 s11, s11, s3
s_cmp_ge_u32 s11, 6
s_cselect_b32 s83, 1, 0
s_cselect_b32 s6, -1, 1
s_add_u32 s11, s11, s6
s_cmp_ge_u32 s11, 6
s_cselect_b32 s6, 6, 0
s_sub_u32 s11, s11, s6
s_lshl_b32 s10, s9, 1
s_add_u32 s10, s10, s83
v_and_b32 v1, 63, v0
v_lshlrev_b32 v2, 4, v1
s_sub_u32 s14, s11, 8
s_lshl_b32 s14, s14, 12
s_mov_b32 s13, s14
s_add_u32 s13, s13, 24576
s_min_u32 s12, s13, 2146435072
s_lshl_b32 s82, s10, 5
s_add_u32 s82, s82, s4
s_lshl_b32 s6, s82, 20
s_waitcnt lgkmcnt(0)
s_add_u32 s52, s18, s6
s_addc_u32 s53, s19, 0
s_mov_b32 s54, 1048576
s_mov_b32 s55, 0x20000
s_add_u32 s56, s20, s6
s_addc_u32 s57, s21, 0
s_mov_b32 s58, 1048576
s_mov_b32 s59, 0x20000
s_mul_i32 s6, s9, 2304
s_mul_i32 s7, s3, 288
s_add_u32 s6, s6, s7
s_sub_u32 s7, 4608, s6
s_add_u32 s44, s16, s6
s_addc_u32 s45, s17, 0
s_mov_b32 s46, s7
s_mov_b32 s47, 0x20000
s_mul_i32 s6, s3, 1179648
s_lshl_b32 s7, s4, 8
s_add_u32 s6, s6, s7
s_sub_u32 s7, 4718592, s6
s_add_u32 s48, s22, s6
s_addc_u32 s49, s23, 0
s_mov_b32 s50, s7
s_mov_b32 s51, 0x20000
v_lshrrev_b32 v5, 4, v1
v_and_b32 v6, 15, v1
v_mul_u32_u24 v3, 294912, v5
v_lshl_add_u32 v3, v6, 4, v3
v_mul_u32_u24 v4, 72, v5
v_lshrrev_b32 v6, 3, v6
v_mul_u32_u24 v6, 1152, v6
v_add_u32 v4, v4, v6
v_mov_b32 v7, 7168
s_lshr_b32 s6, s2, 3
s_sub_u32 s6, s6, 8
s_lshl_b32 s6, s6, 2
s_add_u32 s6, s6, s3
s_mul_i32 s6, s6, 49152
s_and_b32 s7, s2, 7
s_lshl_b32 s7, s7, 10
s_add_u32 s6, s6, s7
s_mov_b32 s60, s22
s_mov_b32 s61, s23
s_mov_b32 s62, 4718592
s_mov_b32 s63, 0x20000
v_min_u32 v35, 47, v1
v_lshrrev_b32 v36, 3, v35
v_lshlrev_b32 v35, 7, v35
v_mad_u32_u24 v36, v36, v7, v35
buffer_load_dword v120, v36, s[60:63], s6 offen
buffer_load_dwordx4 v[40:43], v4, s[44:47], 0 offen offset:0
buffer_load_dwordx4 v[44:47], v4, s[44:47], 0 offen offset:16
buffer_load_dwordx4 v[48:51], v4, s[44:47], 0 offen offset:32
buffer_load_dwordx4 v[52:55], v4, s[44:47], 0 offen offset:48
buffer_load_dwordx2 v[56:57], v4, s[44:47], 0 offen offset:64
s_waitcnt vmcnt(54)
buffer_load_dwordx4 v[136:139], v2, s[52:55], s12 offen offset:0 nt
buffer_load_dwordx4 v[140:143], v2, s[52:55], s12 offen offset:1024 nt
buffer_load_dwordx4 v[144:147], v2, s[52:55], s12 offen offset:2048 nt
buffer_load_dwordx4 v[148:151], v2, s[52:55], s12 offen offset:3072 nt
s_add_u32 s13, s13, 24576
s_min_u32 s12, s13, 2146435072
s_waitcnt vmcnt(54)
buffer_load_dwordx4 v[152:155], v2, s[52:55], s12 offen offset:0 nt
buffer_load_dwordx4 v[156:159], v2, s[52:55], s12 offen offset:1024 nt
buffer_load_dwordx4 v[160:163], v2, s[52:55], s12 offen offset:2048 nt
buffer_load_dwordx4 v[164:167], v2, s[52:55], s12 offen offset:3072 nt
s_add_u32 s13, s13, 24576
s_min_u32 s12, s13, 2146435072
s_cmp_lg_u32 s8, 0
s_cbranch_scc1 L_nowq_1
s_waitcnt vmcnt(20)
s_mov_b32 s6, 0
buffer_load_dwordx4 a[96:99], v3, s[48:51], s6 offen
s_mov_b32 s6, 8192
buffer_load_dwordx4 a[100:103], v3, s[48:51], s6 offen
s_mov_b32 s6, 16384
buffer_load_dwordx4 a[104:107], v3, s[48:51], s6 offen
s_mov_b32 s6, 24576
buffer_load_dwordx4 a[108:111], v3, s[48:51], s6 offen
s_mov_b32 s6, 32768
buffer_load_dwordx4 a[112:115], v3, s[48:51], s6 offen
s_mov_b32 s6, 40960
buffer_load_dwordx4 a[116:119], v3, s[48:51], s6 offen
s_mov_b32 s6, 49152
buffer_load_dwordx4 a[120:123], v3, s[48:51], s6 offen
s_mov_b32 s6, 57344
buffer_load_dwordx4 a[124:127], v3, s[48:51], s6 offen
s_mov_b32 s6, 65536
buffer_load_dwordx4 a[128:131], v3, s[48:51], s6 offen
s_mov_b32 s6, 73728
buffer_load_dwordx4 a[132:135], v3, s[48:51], s6 offen
s_mov_b32 s6, 81920
buffer_load_dwordx4 a[136:139], v3, s[48:51], s6 offen
s_mov_b32 s6, 90112
buffer_load_dwordx4 a[140:143], v3, s[48:51], s6 offen
s_mov_b32 s6, 98304
buffer_load_dwordx4 a[144:147], v3, s[48:51], s6 offen
s_mov_b32 s6, 106496
buffer_load_dwordx4 a[148:151], v3, s[48:51], s6 offen
s_mov_b32 s6, 114688
buffer_load_dwordx4 a[152:155], v3, s[48:51], s6 offen
s_mov_b32 s6, 122880
buffer_load_dwordx4 a[156:159], v3, s[48:51], s6 offen
s_mov_b32 s6, 131072
buffer_load_dwordx4 a[160:163], v3, s[48:51], s6 offen
s_mov_b32 s6, 139264
buffer_load_dwordx4 a[164:167], v3, s[48:51], s6 offen
s_mov_b32 s6, 147456
buffer_load_dwordx4 a[168:171], v3, s[48:51], s6 offen
s_mov_b32 s6, 155648
buffer_load_dwordx4 a[172:175], v3, s[48:51], s6 offen
s_mov_b32 s6, 163840
buffer_load_dwordx4 a[176:179], v3, s[48:51], s6 offen
s_mov_b32 s6, 172032
buffer_load_dwordx4 a[180:183], v3, s[48:51], s6 offen
s_mov_b32 s6, 180224
buffer_load_dwordx4 a[184:187], v3, s[48:51], s6 offen
s_mov_b32 s6, 188416
buffer_load_dwordx4 a[188:191], v3, s[48:51], s6 offen
s_mov_b32 s6, 196608
buffer_load_dwordx4 a[192:195], v3, s[48:51], s6 offen
s_mov_b32 s6, 204800
buffer_load_dwordx4 a[196:199], v3, s[48:51], s6 offen
s_mov_b32 s6, 212992
buffer_load_dwordx4 a[200:203], v3, s[48:51], s6 offen
s_mov_b32 s6, 221184
buffer_load_dwordx4 a[204:207], v3, s[48:51], s6 offen
s_mov_b32 s6, 229376
buffer_load_dwordx4 a[208:211], v3, s[48:51], s6 offen
s_mov_b32 s6, 237568
buffer_load_dwordx4 a[212:215], v3, s[48:51], s6 offen
s_mov_b32 s6, 245760
buffer_load_dwordx4 a[216:219], v3, s[48:51], s6 offen
s_mov_b32 s6, 253952
buffer_load_dwordx4 a[220:223], v3, s[48:51], s6 offen
s_mov_b32 s6, 262144
buffer_load_dwordx4 a[224:227], v3, s[48:51], s6 offen
s_mov_b32 s6, 270336
buffer_load_dwordx4 a[228:231], v3, s[48:51], s6 offen
s_mov_b32 s6, 278528
buffer_load_dwordx4 a[232:235], v3, s[48:51], s6 offen
s_mov_b32 s6, 286720
buffer_load_dwordx4 a[236:239], v3, s[48:51], s6 offen
L_nowq_1:
s_waitcnt vmcnt(54)
buffer_load_dwordx4 v[168:171], v2, s[52:55], s12 offen offset:0 nt
buffer_load_dwordx4 v[172:175], v2, s[52:55], s12 offen offset:1024 nt
buffer_load_dwordx4 v[176:179], v2, s[52:55], s12 offen offset:2048 nt
buffer_load_dwordx4 v[180:183], v2, s[52:55], s12 offen offset:3072 nt
s_add_u32 s13, s13, 24576
s_min_u32 s12, s13, 2146435072
s_waitcnt vmcnt(54)
buffer_load_dwordx4 v[184:187], v2, s[52:55], s12 offen offset:0 nt
buffer_load_dwordx4 v[188:191], v2, s[52:55], s12 offen offset:1024 nt
buffer_load_dwordx4 v[192:195], v2, s[52:55], s12 offen offset:2048 nt
buffer_load_dwordx4 v[196:199], v2, s[52:55], s12 offen offset:3072 nt
s_add_u32 s13, s13, 24576
s_min_u32 s12, s13, 2146435072
s_waitcnt vmcnt(54)
buffer_load_dwordx4 v[200:203], v2, s[52:55], s12 offen offset:0 nt
buffer_load_dwordx4 v[204:207], v2, s[52:55], s12 offen offset:1024 nt
buffer_load_dwordx4 v[208:211], v2, s[52:55], s12 offen offset:2048 nt
buffer_load_dwordx4 v[212:215], v2, s[52:55], s12 offen offset:3072 nt
s_add_u32 s13, s13, 24576
s_min_u32 s12, s13, 2146435072
s_cmp_lg_u32 s8, 1
s_cbranch_scc1 L_nowq_2
s_waitcnt vmcnt(20)
s_mov_b32 s6, 0
buffer_load_dwordx4 a[96:99], v3, s[48:51], s6 offen
s_mov_b32 s6, 8192
buffer_load_dwordx4 a[100:103], v3, s[48:51], s6 offen
s_mov_b32 s6, 16384
buffer_load_dwordx4 a[104:107], v3, s[48:51], s6 offen
s_mov_b32 s6, 24576
buffer_load_dwordx4 a[108:111], v3, s[48:51], s6 offen
s_mov_b32 s6, 32768
buffer_load_dwordx4 a[112:115], v3, s[48:51], s6 offen
s_mov_b32 s6, 40960
buffer_load_dwordx4 a[116:119], v3, s[48:51], s6 offen
s_mov_b32 s6, 49152
buffer_load_dwordx4 a[120:123], v3, s[48:51], s6 offen
s_mov_b32 s6, 57344
buffer_load_dwordx4 a[124:127], v3, s[48:51], s6 offen
s_mov_b32 s6, 65536
buffer_load_dwordx4 a[128:131], v3, s[48:51], s6 offen
s_mov_b32 s6, 73728
buffer_load_dwordx4 a[132:135], v3, s[48:51], s6 offen
s_mov_b32 s6, 81920
buffer_load_dwordx4 a[136:139], v3, s[48:51], s6 offen
s_mov_b32 s6, 90112
buffer_load_dwordx4 a[140:143], v3, s[48:51], s6 offen
s_mov_b32 s6, 98304
buffer_load_dwordx4 a[144:147], v3, s[48:51], s6 offen
s_mov_b32 s6, 106496
buffer_load_dwordx4 a[148:151], v3, s[48:51], s6 offen
s_mov_b32 s6, 114688
buffer_load_dwordx4 a[152:155], v3, s[48:51], s6 offen
s_mov_b32 s6, 122880
buffer_load_dwordx4 a[156:159], v3, s[48:51], s6 offen
s_mov_b32 s6, 131072
buffer_load_dwordx4 a[160:163], v3, s[48:51], s6 offen
s_mov_b32 s6, 139264
buffer_load_dwordx4 a[164:167], v3, s[48:51], s6 offen
s_mov_b32 s6, 147456
buffer_load_dwordx4 a[168:171], v3, s[48:51], s6 offen
s_mov_b32 s6, 155648
buffer_load_dwordx4 a[172:175], v3, s[48:51], s6 offen
s_mov_b32 s6, 163840
buffer_load_dwordx4 a[176:179], v3, s[48:51], s6 offen
s_mov_b32 s6, 172032
buffer_load_dwordx4 a[180:183], v3, s[48:51], s6 offen
s_mov_b32 s6, 180224
buffer_load_dwordx4 a[184:187], v3, s[48:51], s6 offen
s_mov_b32 s6, 188416
buffer_load_dwordx4 a[188:191], v3, s[48:51], s6 offen
s_mov_b32 s6, 196608
buffer_load_dwordx4 a[192:195], v3, s[48:51], s6 offen
s_mov_b32 s6, 204800
buffer_load_dwordx4 a[196:199], v3, s[48:51], s6 offen
s_mov_b32 s6, 212992
buffer_load_dwordx4 a[200:203], v3, s[48:51], s6 offen
s_mov_b32 s6, 221184
buffer_load_dwordx4 a[204:207], v3, s[48:51], s6 offen
s_mov_b32 s6, 229376
buffer_load_dwordx4 a[208:211], v3, s[48:51], s6 offen
s_mov_b32 s6, 237568
buffer_load_dwordx4 a[212:215], v3, s[48:51], s6 offen
s_mov_b32 s6, 245760
buffer_load_dwordx4 a[216:219], v3, s[48:51], s6 offen
s_mov_b32 s6, 253952
buffer_load_dwordx4 a[220:223], v3, s[48:51], s6 offen
s_mov_b32 s6, 262144
buffer_load_dwordx4 a[224:227], v3, s[48:51], s6 offen
s_mov_b32 s6, 270336
buffer_load_dwordx4 a[228:231], v3, s[48:51], s6 offen
s_mov_b32 s6, 278528
buffer_load_dwordx4 a[232:235], v3, s[48:51], s6 offen
s_mov_b32 s6, 286720
buffer_load_dwordx4 a[236:239], v3, s[48:51], s6 offen
L_nowq_2:
s_waitcnt vmcnt(54)
buffer_load_dwordx4 v[216:219], v2, s[52:55], s12 offen offset:0 nt
buffer_load_dwordx4 v[220:223], v2, s[52:55], s12 offen offset:1024 nt
buffer_load_dwordx4 v[224:227], v2, s[52:55], s12 offen offset:2048 nt
buffer_load_dwordx4 v[228:231], v2, s[52:55], s12 offen offset:3072 nt
s_add_u32 s13, s13, 24576
s_min_u32 s12, s13, 2146435072
s_waitcnt vmcnt(54)
buffer_load_dwordx4 v[232:235], v2, s[52:55], s12 offen offset:0 nt
buffer_load_dwordx4 v[236:239], v2, s[52:55], s12 offen offset:1024 nt
buffer_load_dwordx4 v[240:243], v2, s[52:55], s12 offen offset:2048 nt
buffer_load_dwordx4 v[244:247], v2, s[52:55], s12 offen offset:3072 nt
s_add_u32 s13, s13, 24576
s_min_u32 s12, s13, 2146435072
s_waitcnt vmcnt(54)
s_add_u32 s34, s14, 24576
s_min_u32 s34, s34, 2146435072
buffer_load_dwordx4 a[0:3], v2, s[56:59], s34 offen offset:0 nt
buffer_load_dwordx4 a[4:7], v2, s[56:59], s34 offen offset:1024 nt
buffer_load_dwordx4 a[8:11], v2, s[56:59], s34 offen offset:2048 nt
buffer_load_dwordx4 a[12:15], v2, s[56:59], s34 offen offset:3072 nt
s_cmp_lg_u32 s8, 2
s_cbranch_scc1 L_nowq_3
s_waitcnt vmcnt(20)
s_mov_b32 s6, 0
buffer_load_dwordx4 a[96:99], v3, s[48:51], s6 offen
s_mov_b32 s6, 8192
buffer_load_dwordx4 a[100:103], v3, s[48:51], s6 offen
s_mov_b32 s6, 16384
buffer_load_dwordx4 a[104:107], v3, s[48:51], s6 offen
s_mov_b32 s6, 24576
buffer_load_dwordx4 a[108:111], v3, s[48:51], s6 offen
s_mov_b32 s6, 32768
buffer_load_dwordx4 a[112:115], v3, s[48:51], s6 offen
s_mov_b32 s6, 40960
buffer_load_dwordx4 a[116:119], v3, s[48:51], s6 offen
s_mov_b32 s6, 49152
buffer_load_dwordx4 a[120:123], v3, s[48:51], s6 offen
s_mov_b32 s6, 57344
buffer_load_dwordx4 a[124:127], v3, s[48:51], s6 offen
s_mov_b32 s6, 65536
buffer_load_dwordx4 a[128:131], v3, s[48:51], s6 offen
s_mov_b32 s6, 73728
buffer_load_dwordx4 a[132:135], v3, s[48:51], s6 offen
s_mov_b32 s6, 81920
buffer_load_dwordx4 a[136:139], v3, s[48:51], s6 offen
s_mov_b32 s6, 90112
buffer_load_dwordx4 a[140:143], v3, s[48:51], s6 offen
s_mov_b32 s6, 98304
buffer_load_dwordx4 a[144:147], v3, s[48:51], s6 offen
s_mov_b32 s6, 106496
buffer_load_dwordx4 a[148:151], v3, s[48:51], s6 offen
s_mov_b32 s6, 114688
buffer_load_dwordx4 a[152:155], v3, s[48:51], s6 offen
s_mov_b32 s6, 122880
buffer_load_dwordx4 a[156:159], v3, s[48:51], s6 offen
s_mov_b32 s6, 131072
buffer_load_dwordx4 a[160:163], v3, s[48:51], s6 offen
s_mov_b32 s6, 139264
buffer_load_dwordx4 a[164:167], v3, s[48:51], s6 offen
s_mov_b32 s6, 147456
buffer_load_dwordx4 a[168:171], v3, s[48:51], s6 offen
s_mov_b32 s6, 155648
buffer_load_dwordx4 a[172:175], v3, s[48:51], s6 offen
s_mov_b32 s6, 163840
buffer_load_dwordx4 a[176:179], v3, s[48:51], s6 offen
s_mov_b32 s6, 172032
buffer_load_dwordx4 a[180:183], v3, s[48:51], s6 offen
s_mov_b32 s6, 180224
buffer_load_dwordx4 a[184:187], v3, s[48:51], s6 offen
s_mov_b32 s6, 188416
buffer_load_dwordx4 a[188:191], v3, s[48:51], s6 offen
s_mov_b32 s6, 196608
buffer_load_dwordx4 a[192:195], v3, s[48:51], s6 offen
s_mov_b32 s6, 204800
buffer_load_dwordx4 a[196:199], v3, s[48:51], s6 offen
s_mov_b32 s6, 212992
buffer_load_dwordx4 a[200:203], v3, s[48:51], s6 offen
s_mov_b32 s6, 221184
buffer_load_dwordx4 a[204:207], v3, s[48:51], s6 offen
s_mov_b32 s6, 229376
buffer_load_dwordx4 a[208:211], v3, s[48:51], s6 offen
s_mov_b32 s6, 237568
buffer_load_dwordx4 a[212:215], v3, s[48:51], s6 offen
s_mov_b32 s6, 245760
buffer_load_dwordx4 a[216:219], v3, s[48:51], s6 offen
s_mov_b32 s6, 253952
buffer_load_dwordx4 a[220:223], v3, s[48:51], s6 offen
s_mov_b32 s6, 262144
buffer_load_dwordx4 a[224:227], v3, s[48:51], s6 offen
s_mov_b32 s6, 270336
buffer_load_dwordx4 a[228:231], v3, s[48:51], s6 offen
s_mov_b32 s6, 278528
buffer_load_dwordx4 a[232:235], v3, s[48:51], s6 offen
s_mov_b32 s6, 286720
buffer_load_dwordx4 a[236:239], v3, s[48:51], s6 offen
L_nowq_3:
s_mov_b32 s64, s42
s_mov_b32 s65, s43
s_mov_b32 s66, 6291456
s_mov_b32 s67, 0x20000
s_mov_b32 s68, s40
s_mov_b32 s69, s41
s_mov_b32 s70, 256
s_mov_b32 s71, 0x20000
s_mul_i32 s6, s4, 147456
s_add_u32 s60, s24, s6
s_addc_u32 s61, s25, 0
s_mov_b32 s62, 147456
s_mov_b32 s63, 0x20000
v_and_b32 v5, 1, v1
v_lshlrev_b32 v5, 4, v5
v_mov_b32 v6, 0xffff
v_lshlrev_b32 v5, v5, v6
v_bfe_u32 v6, v1, 1, 2
v_cmp_eq_u32 vcc, 0, v6
s_nop 1
v_cndmask_b32 v8, 0, v5, vcc
v_cmp_eq_u32 vcc, 1, v6
s_nop 1
v_cndmask_b32 v9, 0, v5, vcc
v_cmp_eq_u32 vcc, 2, v6
s_nop 1
v_cndmask_b32 v10, 0, v5, vcc
v_cmp_eq_u32 vcc, 3, v6
s_nop 1
v_cndmask_b32 v11, 0, v5, vcc
v_mov_b32 v5, 0x0c0c0c0c
s_mov_b32 s6, 0x01000100
s_mov_b32 s7, 0x03020302
v_bfi_b32 v12, v8, s6, v5
v_bfi_b32 v13, v9, s6, v5
v_bfi_b32 v14, v10, s6, v5
v_bfi_b32 v15, v11, s6, v5
v_bfi_b32 v16, v8, s7, v5
v_bfi_b32 v17, v9, s7, v5
v_bfi_b32 v18, v10, s7, v5
v_bfi_b32 v19, v11, s7, v5
v_mov_b32 v7, 0x3e0293ee
v_mov_b32 v86, 0xff800000
v_lshrrev_b32 v5, 4, v1
v_lshlrev_b32 v5, 3, v5
v_bfe_u32 v6, v1, 2, 2
v_add_u32 v5, v5, v6
v_mul_u32_u24 v5, 1152, v5
s_mul_i32 s6, s3, 288
v_add_u32 v5, s6, v5
v_and_b32 v6, 3, v1
v_lshl_add_u32 v88, v6, 5, v5
v_lshl_add_u32 v89, v6, 3, v5
v_add_u32 v89, 256, v89
v_add_u32 v90, 73728, v88
v_add_u32 v91, 73728, v89
s_lshl_b32 s82, s82, 6
s_add_u32 s82, s82, 327680
s_mov_b64 s[72:73], 0
s_cmp_ge_u32 s11, 2
s_cselect_b32 s74, 0x22222222, 0
s_mov_b32 s75, s74
s_mov_b32 s76, 0x44444444
s_mov_b32 s77, s76
s_mov_b32 s78, 0x88888888
s_mov_b32 s79, s78
v_bfe_u32 v5, v1, 4, 1
s_lshl_b32 s6, s9, 7
s_lshl_b32 s7, s4, 1
s_add_u32 s6, s6, s7
s_add_u32 s6, s6, s8
v_mul_u32_u24 v6, 63, v5
v_add_u32 v6, s6, v6
v_mul_u32_u24 v92, 2304, v6
v_add_u32 v92, 4194304, v92
v_sub_u32 v6, s8, v5
v_cmp_lt_u32 vcc, 1, v6
v_mov_b32 v6, 2146435072
s_nop 0
v_cndmask_b32 v92, v92, v6, vcc
s_mul_i32 s6, s3, 576
v_add_u32 v92, s6, v92
v_and_b32 v35, 3, v1
v_bfe_u32 v36, v1, 2, 2
v_lshl_add_u32 v35, v35, 2, v36
v_lshl_add_u32 v93, v35, 2, v92
v_and_b32 v35, 15, v1
v_lshrrev_b32 v36, 5, v1
v_lshl_add_u32 v35, v36, 4, v35
v_lshl_add_u32 v92, v35, 4, v92
s_lshl_b32 s6, s8, 2
s_add_u32 s6, s6, 0
s_cmp_ge_u32 s6, 6
s_cselect_b32 s6, 1, 0
v_cmp_eq_u32 vcc, s6, v5
s_nop 1
v_cndmask_b32 v106, 0, 1.0, vcc
s_lshl_b32 s6, s8, 2
s_add_u32 s6, s6, 1
s_cmp_ge_u32 s6, 6
s_cselect_b32 s6, 1, 0
v_cmp_eq_u32 vcc, s6, v5
s_nop 1
v_cndmask_b32 v107, 0, 1.0, vcc
s_lshl_b32 s6, s8, 2
s_add_u32 s6, s6, 2
s_cmp_ge_u32 s6, 6
s_cselect_b32 s6, 1, 0
v_cmp_eq_u32 vcc, s6, v5
s_nop 1
v_cndmask_b32 v108, 0, 1.0, vcc
s_lshl_b32 s6, s8, 2
s_add_u32 s6, s6, 3
s_cmp_ge_u32 s6, 6
s_cselect_b32 s6, 1, 0
v_cmp_eq_u32 vcc, s6, v5
s_nop 1
v_cndmask_b32 v109, 0, 1.0, vcc
v_cmp_gt_u32 vcc, 32, v1
s_nop 1
v_cndmask_b32 v98, 0, v106, vcc
v_cndmask_b32 v102, v106, 0, vcc
v_cndmask_b32 v99, 0, v107, vcc
v_cndmask_b32 v103, v107, 0, vcc
v_cndmask_b32 v100, 0, v108, vcc
v_cndmask_b32 v104, v108, 0, vcc
v_cndmask_b32 v101, 0, v109, vcc
v_cndmask_b32 v105, v109, 0, vcc
v_and_b32 v35, 15, v1
v_lshlrev_b32 v35, 4, v35
v_lshl_add_u32 v94, v5, 3, v35
s_lshl_b32 s6, s3, 8
s_add_u32 s6, s6, 151552
v_add_u32 v94, s6, v94
v_and_b32 v35, 3, v1
v_lshlrev_b32 v35, 8, v35
v_lshrrev_b32 v36, 4, v1
v_lshl_add_u32 v95, v36, 4, v35
v_add_u32 v95, 151552, v95
s_mul_i32 s15, s3, 36864
s_mov_b32 s80, 0x0
s_mov_b32 s81, 0
v_and_b32 v35, 15, v1
v_lshlrev_b32 v35, 5, v35
v_lshl_add_u32 v36, v5, 4, v35
v_lshrrev_b32 v6, 5, v1
v_lshl_add_u32 v36, v6, 9, v36
s_lshl_b32 s6, s3, 10
s_add_u32 s6, s6, 147456
v_add_u32 v36, s6, v36
s_lshl_b32 s6, s83, 9
s_add_u32 s6, s6, 147456
v_add_u32 v35, s6, v35
s_waitcnt vmcnt(35)
v_perm_b32 v60, v40, v40, v12
v_perm_b32 v61, v40, v40, v13
v_perm_b32 v62, v40, v40, v14
v_perm_b32 v63, v40, v40, v15
s_nop 1
v_mfma_f32_16x16x32_bf16 v[20:23], v[60:63], a[96:99], 0
s_add_u32 s34, s14, 49152
s_min_u32 s34, s34, 2146435072
buffer_load_dwordx4 a[16:19], v2, s[56:59], s34 offen offset:0 nt
s_waitcnt vmcnt(35)
v_perm_b32 v64, v40, v40, v16
v_perm_b32 v65, v40, v40, v17
v_perm_b32 v66, v40, v40, v18
v_perm_b32 v67, v40, v40, v19
s_nop 1
v_mfma_f32_16x16x32_bf16 v[20:23], v[64:67], a[100:103], v[20:23]
buffer_load_dwordx4 a[20:23], v2, s[56:59], s34 offen offset:1024 nt
s_waitcnt vmcnt(35)
v_perm_b32 v68, v41, v41, v12
v_perm_b32 v69, v41, v41, v13
v_perm_b32 v70, v41, v41, v14
v_perm_b32 v71, v41, v41, v15
s_nop 1
v_mfma_f32_16x16x32_bf16 v[20:23], v[68:71], a[104:107], v[20:23]
buffer_load_dwordx4 a[24:27], v2, s[56:59], s34 offen offset:2048 nt
s_waitcnt vmcnt(35)
v_perm_b32 v72, v41, v41, v16
v_perm_b32 v73, v41, v41, v17
v_perm_b32 v74, v41, v41, v18
v_perm_b32 v75, v41, v41, v19
s_nop 1
v_mfma_f32_16x16x32_bf16 v[20:23], v[72:75], a[108:111], v[20:23]
buffer_load_dwordx4 a[28:31], v2, s[56:59], s34 offen offset:3072 nt
s_waitcnt vmcnt(35)
v_perm_b32 v60, v42, v42, v12
v_perm_b32 v61, v42, v42, v13
v_perm_b32 v62, v42, v42, v14
v_perm_b32 v63, v42, v42, v15
s_nop 1
v_mfma_f32_16x16x32_bf16 v[20:23], v[60:63], a[112:115], v[20:23]
s_add_u32 s34, s14, 73728
s_min_u32 s34, s34, 2146435072
buffer_load_dwordx4 a[32:35], v2, s[56:59], s34 offen offset:0 nt
s_waitcnt vmcnt(35)
v_perm_b32 v64, v42, v42, v16
v_perm_b32 v65, v42, v42, v17
v_perm_b32 v66, v42, v42, v18
v_perm_b32 v67, v42, v42, v19
s_nop 1
v_mfma_f32_16x16x32_bf16 v[20:23], v[64:67], a[116:119], v[20:23]
buffer_load_dwordx4 a[36:39], v2, s[56:59], s34 offen offset:1024 nt
s_waitcnt vmcnt(35)
v_perm_b32 v68, v43, v43, v12
v_perm_b32 v69, v43, v43, v13
v_perm_b32 v70, v43, v43, v14
v_perm_b32 v71, v43, v43, v15
s_nop 1
v_mfma_f32_16x16x32_bf16 v[20:23], v[68:71], a[120:123], v[20:23]
buffer_load_dwordx4 a[40:43], v2, s[56:59], s34 offen offset:2048 nt
s_waitcnt vmcnt(35)
v_perm_b32 v72, v43, v43, v16
v_perm_b32 v73, v43, v43, v17
v_perm_b32 v74, v43, v43, v18
v_perm_b32 v75, v43, v43, v19
s_nop 1
v_mfma_f32_16x16x32_bf16 v[20:23], v[72:75], a[124:127], v[20:23]
buffer_load_dwordx4 a[44:47], v2, s[56:59], s34 offen offset:3072 nt
s_waitcnt vmcnt(35)
v_perm_b32 v60, v44, v44, v12
v_perm_b32 v61, v44, v44, v13
v_perm_b32 v62, v44, v44, v14
v_perm_b32 v63, v44, v44, v15
s_nop 1
v_mfma_f32_16x16x32_bf16 v[20:23], v[60:63], a[128:131], v[20:23]
s_add_u32 s34, s14, 98304
s_min_u32 s34, s34, 2146435072
buffer_load_dwordx4 a[48:51], v2, s[56:59], s34 offen offset:0 nt
s_waitcnt vmcnt(35)
v_perm_b32 v64, v44, v44, v16
v_perm_b32 v65, v44, v44, v17
v_perm_b32 v66, v44, v44, v18
v_perm_b32 v67, v44, v44, v19
s_nop 1
v_mfma_f32_16x16x32_bf16 v[20:23], v[64:67], a[132:135], v[20:23]
buffer_load_dwordx4 a[52:55], v2, s[56:59], s34 offen offset:1024 nt
s_waitcnt vmcnt(35)
v_perm_b32 v68, v45, v45, v12
v_perm_b32 v69, v45, v45, v13
v_perm_b32 v70, v45, v45, v14
v_perm_b32 v71, v45, v45, v15
s_nop 1
v_mfma_f32_16x16x32_bf16 v[20:23], v[68:71], a[136:139], v[20:23]
buffer_load_dwordx4 a[56:59], v2, s[56:59], s34 offen offset:2048 nt
s_waitcnt vmcnt(35)
v_perm_b32 v72, v45, v45, v16
v_perm_b32 v73, v45, v45, v17
v_perm_b32 v74, v45, v45, v18
v_perm_b32 v75, v45, v45, v19
s_nop 1
v_mfma_f32_16x16x32_bf16 v[20:23], v[72:75], a[140:143], v[20:23]
buffer_load_dwordx4 a[60:63], v2, s[56:59], s34 offen offset:3072 nt
s_waitcnt vmcnt(35)
v_perm_b32 v60, v46, v46, v12
v_perm_b32 v61, v46, v46, v13
v_perm_b32 v62, v46, v46, v14
v_perm_b32 v63, v46, v46, v15
s_nop 1
v_mfma_f32_16x16x32_bf16 v[20:23], v[60:63], a[144:147], v[20:23]
s_add_u32 s34, s14, 122880
s_min_u32 s34, s34, 2146435072
buffer_load_dwordx4 a[64:67], v2, s[56:59], s34 offen offset:0 nt
s_waitcnt vmcnt(35)
v_perm_b32 v64, v46, v46, v16
v_perm_b32 v65, v46, v46, v17
v_perm_b32 v66, v46, v46, v18
v_perm_b32 v67, v46, v46, v19
s_nop 1
v_mfma_f32_16x16x32_bf16 v[20:23], v[64:67], a[148:151], v[20:23]
buffer_load_dwordx4 a[68:71], v2, s[56:59], s34 offen offset:1024 nt
s_waitcnt vmcnt(35)
v_perm_b32 v68, v47, v47, v12
v_perm_b32 v69, v47, v47, v13
v_perm_b32 v70, v47, v47, v14
v_perm_b32 v71, v47, v47, v15
s_nop 1
v_mfma_f32_16x16x32_bf16 v[20:23], v[68:71], a[152:155], v[20:23]
buffer_load_dwordx4 a[72:75], v2, s[56:59], s34 offen offset:2048 nt
s_waitcnt vmcnt(35)
v_perm_b32 v72, v47, v47, v16
v_perm_b32 v73, v47, v47, v17
v_perm_b32 v74, v47, v47, v18
v_perm_b32 v75, v47, v47, v19
s_nop 1
v_mfma_f32_16x16x32_bf16 v[20:23], v[72:75], a[156:159], v[20:23]
buffer_load_dwordx4 a[76:79], v2, s[56:59], s34 offen offset:3072 nt
s_waitcnt vmcnt(35)
v_perm_b32 v60, v48, v48, v12
v_perm_b32 v61, v48, v48, v13
v_perm_b32 v62, v48, v48, v14
v_perm_b32 v63, v48, v48, v15
s_nop 1
v_mfma_f32_16x16x32_bf16 v[20:23], v[60:63], a[160:163], v[20:23]
s_add_u32 s34, s14, 147456
s_min_u32 s34, s34, 2146435072
buffer_load_dwordx4 a[80:83], v2, s[56:59], s34 offen offset:0 nt
s_waitcnt vmcnt(35)
v_perm_b32 v64, v48, v48, v16
v_perm_b32 v65, v48, v48, v17
v_perm_b32 v66, v48, v48, v18
v_perm_b32 v67, v48, v48, v19
s_nop 1
v_mfma_f32_16x16x32_bf16 v[20:23], v[64:67], a[164:167], v[20:23]
buffer_load_dwordx4 a[84:87], v2, s[56:59], s34 offen offset:1024 nt
s_waitcnt vmcnt(35)
v_perm_b32 v68, v49, v49, v12
v_perm_b32 v69, v49, v49, v13
v_perm_b32 v70, v49, v49, v14
v_perm_b32 v71, v49, v49, v15
s_nop 1
v_mfma_f32_16x16x32_bf16 v[20:23], v[68:71], a[168:171], v[20:23]
buffer_load_dwordx4 a[88:91], v2, s[56:59], s34 offen offset:2048 nt
s_waitcnt vmcnt(35)
v_perm_b32 v72, v49, v49, v16
v_perm_b32 v73, v49, v49, v17
v_perm_b32 v74, v49, v49, v18
v_perm_b32 v75, v49, v49, v19
s_nop 1
v_mfma_f32_16x16x32_bf16 v[20:23], v[72:75], a[172:175], v[20:23]
buffer_load_dwordx4 a[92:95], v2, s[56:59], s34 offen offset:3072 nt
s_waitcnt vmcnt(35)
v_perm_b32 v60, v50, v50, v12
v_perm_b32 v61, v50, v50, v13
v_perm_b32 v62, v50, v50, v14
v_perm_b32 v63, v50, v50, v15
s_nop 1
v_mfma_f32_16x16x32_bf16 v[20:23], v[60:63], a[176:179], v[20:23]
s_add_u32 s34, s14, 172032
s_min_u32 s34, s34, 2146435072
buffer_load_dwordx4 a[240:243], v2, s[56:59], s34 offen offset:0 nt
s_waitcnt vmcnt(35)
v_perm_b32 v64, v50, v50, v16
v_perm_b32 v65, v50, v50, v17
v_perm_b32 v66, v50, v50, v18
v_perm_b32 v67, v50, v50, v19
s_nop 1
v_mfma_f32_16x16x32_bf16 v[20:23], v[64:67], a[180:183], v[20:23]
buffer_load_dwordx4 a[244:247], v2, s[56:59], s34 offen offset:1024 nt
s_waitcnt vmcnt(35)
v_perm_b32 v68, v51, v51, v12
v_perm_b32 v69, v51, v51, v13
v_perm_b32 v70, v51, v51, v14
v_perm_b32 v71, v51, v51, v15
s_nop 1
v_mfma_f32_16x16x32_bf16 v[20:23], v[68:71], a[184:187], v[20:23]
buffer_load_dwordx4 a[248:251], v2, s[56:59], s34 offen offset:2048 nt
s_waitcnt vmcnt(35)
v_perm_b32 v72, v51, v51, v16
v_perm_b32 v73, v51, v51, v17
v_perm_b32 v74, v51, v51, v18
v_perm_b32 v75, v51, v51, v19
s_nop 1
v_mfma_f32_16x16x32_bf16 v[20:23], v[72:75], a[188:191], v[20:23]
buffer_load_dwordx4 a[252:255], v2, s[56:59], s34 offen offset:3072 nt
s_waitcnt vmcnt(35)
v_perm_b32 v60, v52, v52, v12
v_perm_b32 v61, v52, v52, v13
v_perm_b32 v62, v52, v52, v14
v_perm_b32 v63, v52, v52, v15
s_nop 1
v_mfma_f32_16x16x32_bf16 v[20:23], v[60:63], a[192:195], v[20:23]
s_waitcnt vmcnt(34)
v_perm_b32 v64, v52, v52, v16
v_perm_b32 v65, v52, v52, v17
v_perm_b32 v66, v52, v52, v18
v_perm_b32 v67, v52, v52, v19
s_nop 1
v_mfma_f32_16x16x32_bf16 v[20:23], v[64:67], a[196:199], v[20:23]
s_waitcnt vmcnt(33)
v_perm_b32 v68, v53, v53, v12
v_perm_b32 v69, v53, v53, v13
v_perm_b32 v70, v53, v53, v14
v_perm_b32 v71, v53, v53, v15
s_nop 1
v_mfma_f32_16x16x32_bf16 v[20:23], v[68:71], a[200:203], v[20:23]
s_waitcnt vmcnt(32)
v_perm_b32 v72, v53, v53, v16
v_perm_b32 v73, v53, v53, v17
v_perm_b32 v74, v53, v53, v18
v_perm_b32 v75, v53, v53, v19
s_nop 1
v_mfma_f32_16x16x32_bf16 v[20:23], v[72:75], a[204:207], v[20:23]
s_waitcnt vmcnt(31)
v_perm_b32 v60, v54, v54, v12
v_perm_b32 v61, v54, v54, v13
v_perm_b32 v62, v54, v54, v14
v_perm_b32 v63, v54, v54, v15
s_nop 1
v_mfma_f32_16x16x32_bf16 v[20:23], v[60:63], a[208:211], v[20:23]
s_waitcnt vmcnt(30)
v_perm_b32 v64, v54, v54, v16
v_perm_b32 v65, v54, v54, v17
v_perm_b32 v66, v54, v54, v18
v_perm_b32 v67, v54, v54, v19
s_nop 1
v_mfma_f32_16x16x32_bf16 v[20:23], v[64:67], a[212:215], v[20:23]
s_waitcnt vmcnt(29)
v_perm_b32 v68, v55, v55, v12
v_perm_b32 v69, v55, v55, v13
v_perm_b32 v70, v55, v55, v14
v_perm_b32 v71, v55, v55, v15
s_nop 1
v_mfma_f32_16x16x32_bf16 v[20:23], v[68:71], a[216:219], v[20:23]
s_waitcnt vmcnt(28)
v_perm_b32 v72, v55, v55, v16
v_perm_b32 v73, v55, v55, v17
v_perm_b32 v74, v55, v55, v18
v_perm_b32 v75, v55, v55, v19
s_nop 1
v_mfma_f32_16x16x32_bf16 v[20:23], v[72:75], a[220:223], v[20:23]
s_waitcnt vmcnt(27)
v_perm_b32 v60, v56, v56, v12
v_perm_b32 v61, v56, v56, v13
v_perm_b32 v62, v56, v56, v14
v_perm_b32 v63, v56, v56, v15
s_nop 1
v_mfma_f32_16x16x32_bf16 v[20:23], v[60:63], a[224:227], v[20:23]
s_waitcnt vmcnt(26)
v_perm_b32 v64, v56, v56, v16
v_perm_b32 v65, v56, v56, v17
v_perm_b32 v66, v56, v56, v18
v_perm_b32 v67, v56, v56, v19
s_nop 1
v_mfma_f32_16x16x32_bf16 v[20:23], v[64:67], a[228:231], v[20:23]
s_waitcnt vmcnt(25)
v_perm_b32 v68, v57, v57, v12
v_perm_b32 v69, v57, v57, v13
v_perm_b32 v70, v57, v57, v14
v_perm_b32 v71, v57, v57, v15
s_nop 1
v_mfma_f32_16x16x32_bf16 v[20:23], v[68:71], a[232:235], v[20:23]
s_waitcnt vmcnt(24)
v_perm_b32 v72, v57, v57, v16
v_perm_b32 v73, v57, v57, v17
v_perm_b32 v74, v57, v57, v18
v_perm_b32 v75, v57, v57, v19
s_nop 1
v_mfma_f32_16x16x32_bf16 v[20:23], v[72:75], a[236:239], v[20:23]
s_nop 7
ds_write_b128 v36, v[20:23]
s_waitcnt lgkmcnt(0)
s_barrier
ds_read_b128 v[40:43], v35 offset:0
ds_read_b128 v[44:47], v35 offset:16
ds_read_b128 v[48:51], v35 offset:1024
ds_read_b128 v[52:55], v35 offset:1040
ds_read_b128 v[56:59], v35 offset:2048
ds_read_b128 v[60:63], v35 offset:2064
ds_read_b128 v[64:67], v35 offset:3072
ds_read_b128 v[68:71], v35 offset:3088
v_mov_b32 v20, 0
v_mov_b32 v21, 0
v_mov_b32 v22, 0
v_mov_b32 v23, 0
s_waitcnt lgkmcnt(0)
v_add_f32 v40, v40, v48
v_add_f32 v56, v56, v64
v_add_f32 v41, v41, v49
v_add_f32 v57, v57, v65
v_add_f32 v42, v42, v50
v_add_f32 v58, v58, v66
v_add_f32 v43, v43, v51
v_add_f32 v59, v59, v67
v_add_f32 v44, v44, v52
v_add_f32 v60, v60, v68
v_add_f32 v45, v45, v53
v_add_f32 v61, v61, v69
v_add_f32 v46, v46, v54
v_add_f32 v62, v62, v70
v_add_f32 v47, v47, v55
v_add_f32 v63, v63, v71
v_add_f32 v40, v40, v56
v_add_f32 v41, v41, v57
v_add_f32 v42, v42, v58
v_add_f32 v43, v43, v59
v_add_f32 v44, v44, v60
v_add_f32 v45, v45, v61
v_add_f32 v46, v46, v62
v_add_f32 v47, v47, v63
v_cvt_pk_bf16_f32 v24, v40, v41
v_cvt_pk_bf16_f32 v25, v42, v43
v_cvt_pk_bf16_f32 v26, v44, v45
v_cvt_pk_bf16_f32 v27, v46, v47
s_add_u32 s14, s14, 196608
K_loop:
s_cmp_lg_u32 s81, 8
s_cbranch_scc1 L_c0_4
buffer_load_dword v96, off, s[68:71], 0 offset:0 sc1
L_c0_4:
s_waitcnt vmcnt(28)
v_dot2_f32_bf16 v28, v120, v24, 0
v_dot2_f32_bf16 v29, v124, v24, 0
v_dot2_f32_bf16 v30, v128, v24, 0
v_dot2_f32_bf16 v31, v132, v24, 0
v_dot2_f32_bf16 v28, v121, v25, v28
v_dot2_f32_bf16 v29, v125, v25, v29
v_dot2_f32_bf16 v30, v129, v25, v30
v_dot2_f32_bf16 v31, v133, v25, v31
v_dot2_f32_bf16 v28, v122, v26, v28
v_dot2_f32_bf16 v29, v126, v26, v29
v_dot2_f32_bf16 v30, v130, v26, v30
v_dot2_f32_bf16 v31, v134, v26, v31
v_dot2_f32_bf16 v28, v123, v27, v28
v_dot2_f32_bf16 v29, v127, v27, v29
v_dot2_f32_bf16 v30, v131, v27, v30
v_dot2_f32_bf16 v31, v135, v27, v31
buffer_load_dwordx4 v[120:123], v2, s[52:55], s12 offen offset:0 nt
buffer_load_dwordx4 v[124:127], v2, s[52:55], s12 offen offset:1024 nt
buffer_load_dwordx4 v[128:131], v2, s[52:55], s12 offen offset:2048 nt
buffer_load_dwordx4 v[132:135], v2, s[52:55], s12 offen offset:3072 nt
s_add_u32 s13, s13, 24576
s_min_u32 s12, s13, 2146435072
s_cmp_ge_u32 s80, 36
s_cbranch_scc1 L_nodma_5
s_mov_b32 m0, s15
s_nop 0
buffer_load_dwordx4 v2, s[60:63], s15 offen  lds
s_add_u32 s15, s15, 1024
L_nodma_5:
s_add_u32 s80, s80, 1
v_add_f32_dpp v32, v28, v28 row_ror:8 row_mask:0xf bank_mask:0x3
v_add_f32_dpp v33, v29, v29 row_ror:8 row_mask:0xf bank_mask:0x3
v_add_f32_dpp v32, v30, v30 row_ror:8 row_mask:0xf bank_mask:0xc
v_add_f32_dpp v33, v31, v31 row_ror:8 row_mask:0xf bank_mask:0xc
s_nop 0
v_add_f32_dpp v34, v32, v32 row_half_mirror row_mask:0xf bank_mask:0x5
v_add_f32_dpp v34, v33, v33 row_half_mirror row_mask:0xf bank_mask:0xa
s_nop 1
v_add_f32_dpp v34, v34, v34 quad_perm:[1,0,3,2] row_mask:0xf bank_mask:0xf
s_nop 1
v_add_f32_dpp v34, v34, v34 quad_perm:[2,3,0,1] row_mask:0xf bank_mask:0xf
v_cndmask_b32 v86, v86, v34, s[72:73]
s_waitcnt vmcnt(28)
v_dot2_f32_bf16 v28, v136, v24, 0
v_dot2_f32_bf16 v29, v140, v24, 0
v_dot2_f32_bf16 v30, v144, v24, 0
v_dot2_f32_bf16 v31, v148, v24, 0
v_dot2_f32_bf16 v28, v137, v25, v28
v_dot2_f32_bf16 v29, v141, v25, v29
v_dot2_f32_bf16 v30, v145, v25, v30
v_dot2_f32_bf16 v31, v149, v25, v31
v_dot2_f32_bf16 v28, v138, v26, v28
v_dot2_f32_bf16 v29, v142, v26, v29
v_dot2_f32_bf16 v30, v146, v26, v30
v_dot2_f32_bf16 v31, v150, v26, v31
v_dot2_f32_bf16 v28, v139, v27, v28
v_dot2_f32_bf16 v29, v143, v27, v29
v_dot2_f32_bf16 v30, v147, v27, v30
v_dot2_f32_bf16 v31, v151, v27, v31
buffer_load_dwordx4 v[136:139], v2, s[52:55], s12 offen offset:0 nt
buffer_load_dwordx4 v[140:143], v2, s[52:55], s12 offen offset:1024 nt
buffer_load_dwordx4 v[144:147], v2, s[52:55], s12 offen offset:2048 nt
buffer_load_dwordx4 v[148:151], v2, s[52:55], s12 offen offset:3072 nt
s_add_u32 s13, s13, 24576
s_min_u32 s12, s13, 2146435072
s_cmp_ge_u32 s80, 36
s_cbranch_scc1 L_nodma_6
s_mov_b32 m0, s15
s_nop 0
buffer_load_dwordx4 v2, s[60:63], s15 offen  lds
s_add_u32 s15, s15, 1024
L_nodma_6:
s_add_u32 s80, s80, 1
v_add_f32_dpp v32, v28, v28 row_ror:8 row_mask:0xf bank_mask:0x3
v_add_f32_dpp v33, v29, v29 row_ror:8 row_mask:0xf bank_mask:0x3
v_add_f32_dpp v32, v30, v30 row_ror:8 row_mask:0xf bank_mask:0xc
v_add_f32_dpp v33, v31, v31 row_ror:8 row_mask:0xf bank_mask:0xc
s_nop 0
v_add_f32_dpp v34, v32, v32 row_half_mirror row_mask:0xf bank_mask:0x5
v_add_f32_dpp v34, v33, v33 row_half_mirror row_mask:0xf bank_mask:0xa
s_nop 1
v_add_f32_dpp v34, v34, v34 quad_perm:[1,0,3,2] row_mask:0xf bank_mask:0xf
s_nop 1
v_add_f32_dpp v34, v34, v34 quad_perm:[2,3,0,1] row_mask:0xf bank_mask:0xf
v_cndmask_b32 v86, v86, v34, s[74:75]
s_waitcnt vmcnt(28)
v_dot2_f32_bf16 v28, v152, v24, 0
v_dot2_f32_bf16 v29, v156, v24, 0
v_dot2_f32_bf16 v30, v160, v24, 0
v_dot2_f32_bf16 v31, v164, v24, 0
v_dot2_f32_bf16 v28, v153, v25, v28
v_dot2_f32_bf16 v29, v157, v25, v29
v_dot2_f32_bf16 v30, v161, v25, v30
v_dot2_f32_bf16 v31, v165, v25, v31
v_dot2_f32_bf16 v28, v154, v26, v28
v_dot2_f32_bf16 v29, v158, v26, v29
v_dot2_f32_bf16 v30, v162, v26, v30
v_dot2_f32_bf16 v31, v166, v26, v31
v_dot2_f32_bf16 v28, v155, v27, v28
v_dot2_f32_bf16 v29, v159, v27, v29
v_dot2_f32_bf16 v30, v163, v27, v30
v_dot2_f32_bf16 v31, v167, v27, v31
buffer_load_dwordx4 v[152:155], v2, s[52:55], s12 offen offset:0 nt
buffer_load_dwordx4 v[156:159], v2, s[52:55], s12 offen offset:1024 nt
buffer_load_dwordx4 v[160:163], v2, s[52:55], s12 offen offset:2048 nt
buffer_load_dwordx4 v[164:167], v2, s[52:55], s12 offen offset:3072 nt
s_add_u32 s13, s13, 24576
s_min_u32 s12, s13, 2146435072
s_cmp_ge_u32 s80, 36
s_cbranch_scc1 L_nodma_7
s_mov_b32 m0, s15
s_nop 0
buffer_load_dwordx4 v2, s[60:63], s15 offen  lds
s_add_u32 s15, s15, 1024
L_nodma_7:
s_add_u32 s80, s80, 1
v_add_f32_dpp v32, v28, v28 row_ror:8 row_mask:0xf bank_mask:0x3
v_add_f32_dpp v33, v29, v29 row_ror:8 row_mask:0xf bank_mask:0x3
v_add_f32_dpp v32, v30, v30 row_ror:8 row_mask:0xf bank_mask:0xc
v_add_f32_dpp v33, v31, v31 row_ror:8 row_mask:0xf bank_mask:0xc
s_nop 0
v_add_f32_dpp v34, v32, v32 row_half_mirror row_mask:0xf bank_mask:0x5
v_add_f32_dpp v34, v33, v33 row_half_mirror row_mask:0xf bank_mask:0xa
s_nop 1
v_add_f32_dpp v34, v34, v34 quad_perm:[1,0,3,2] row_mask:0xf bank_mask:0xf
s_nop 1
v_add_f32_dpp v34, v34, v34 quad_perm:[2,3,0,1] row_mask:0xf bank_mask:0xf
v_cndmask_b32 v86, v86, v34, s[76:77]
s_waitcnt vmcnt(28)
v_dot2_f32_bf16 v28, v168, v24, 0
v_dot2_f32_bf16 v29, v172, v24, 0
v_dot2_f32_bf16 v30, v176, v24, 0
v_dot2_f32_bf16 v31, v180, v24, 0
v_dot2_f32_bf16 v28, v169, v25, v28
v_dot2_f32_bf16 v29, v173, v25, v29
v_dot2_f32_bf16 v30, v177, v25, v30
v_dot2_f32_bf16 v31, v181, v25, v31
v_dot2_f32_bf16 v28, v170, v26, v28
v_dot2_f32_bf16 v29, v174, v26, v29
v_dot2_f32_bf16 v30, v178, v26, v30
v_dot2_f32_bf16 v31, v182, v26, v31
v_dot2_f32_bf16 v28, v171, v27, v28
v_dot2_f32_bf16 v29, v175, v27, v29
v_dot2_f32_bf16 v30, v179, v27, v30
v_dot2_f32_bf16 v31, v183, v27, v31
buffer_load_dwordx4 v[168:171], v2, s[52:55], s12 offen offset:0 nt
buffer_load_dwordx4 v[172:175], v2, s[52:55], s12 offen offset:1024 nt
buffer_load_dwordx4 v[176:179], v2, s[52:55], s12 offen offset:2048 nt
buffer_load_dwordx4 v[180:183], v2, s[52:55], s12 offen offset:3072 nt
s_add_u32 s13, s13, 24576
s_min_u32 s12, s13, 2146435072
s_cmp_ge_u32 s80, 36
s_cbranch_scc1 L_nodma_8
s_mov_b32 m0, s15
s_nop 0
buffer_load_dwordx4 v2, s[60:63], s15 offen  lds
s_add_u32 s15, s15, 1024
L_nodma_8:
s_add_u32 s80, s80, 1
v_add_f32_dpp v32, v28, v28 row_ror:8 row_mask:0xf bank_mask:0x3
v_add_f32_dpp v33, v29, v29 row_ror:8 row_mask:0xf bank_mask:0x3
v_add_f32_dpp v32, v30, v30 row_ror:8 row_mask:0xf bank_mask:0xc
v_add_f32_dpp v33, v31, v31 row_ror:8 row_mask:0xf bank_mask:0xc
s_nop 0
v_add_f32_dpp v34, v32, v32 row_half_mirror row_mask:0xf bank_mask:0x5
v_add_f32_dpp v34, v33, v33 row_half_mirror row_mask:0xf bank_mask:0xa
s_nop 1
v_add_f32_dpp v34, v34, v34 quad_perm:[1,0,3,2] row_mask:0xf bank_mask:0xf
s_nop 1
v_add_f32_dpp v34, v34, v34 quad_perm:[2,3,0,1] row_mask:0xf bank_mask:0xf
v_cndmask_b32 v86, v86, v34, s[78:79]
s_add_u32 s81, s81, 1
s_cmp_eq_u32 s81, 11
s_cbranch_scc1 A_mid
v_mov_b32 v76, v77
v_mov_b32 v77, v78
v_mov_b32 v78, v79
v_mov_b32 v79, v80
v_mov_b32 v80, v81
v_mov_b32 v81, v82
v_mov_b32 v82, v83
v_mov_b32 v83, v84
v_mov_b32 v84, v85
v_mov_b32 v85, v86
s_lshr_b64 s[72:73], s[76:77], 2
s_lshr_b64 s[74:75], s[76:77], 1
s_cmp_eq_u32 s81, 9
s_cselect_b32 s52, s56, s52
s_cselect_b32 s53, s57, s53
s_cselect_b32 s13, s14, s13
s_min_u32 s12, s13, 2146435072
s_waitcnt vmcnt(28)
v_dot2_f32_bf16 v28, v184, v24, 0
v_dot2_f32_bf16 v29, v188, v24, 0
v_dot2_f32_bf16 v30, v192, v24, 0
v_dot2_f32_bf16 v31, v196, v24, 0
v_dot2_f32_bf16 v28, v185, v25, v28
v_dot2_f32_bf16 v29, v189, v25, v29
v_dot2_f32_bf16 v30, v193, v25, v30
v_dot2_f32_bf16 v31, v197, v25, v31
v_dot2_f32_bf16 v28, v186, v26, v28
v_dot2_f32_bf16 v29, v190, v26, v29
v_dot2_f32_bf16 v30, v194, v26, v30
v_dot2_f32_bf16 v31, v198, v26, v31
v_dot2_f32_bf16 v28, v187, v27, v28
v_dot2_f32_bf16 v29, v191, v27, v29
v_dot2_f32_bf16 v30, v195, v27, v30
v_dot2_f32_bf16 v31, v199, v27, v31
buffer_load_dwordx4 v[184:187], v2, s[52:55], s12 offen offset:0 nt
buffer_load_dwordx4 v[188:191], v2, s[52:55], s12 offen offset:1024 nt
buffer_load_dwordx4 v[192:195], v2, s[52:55], s12 offen offset:2048 nt
buffer_load_dwordx4 v[196:199], v2, s[52:55], s12 offen offset:3072 nt
s_add_u32 s13, s13, 24576
s_min_u32 s12, s13, 2146435072
s_cmp_ge_u32 s80, 36
s_cbranch_scc1 L_nodma_9
s_mov_b32 m0, s15
s_nop 0
buffer_load_dwordx4 v2, s[60:63], s15 offen  lds
s_add_u32 s15, s15, 1024
L_nodma_9:
s_add_u32 s80, s80, 1
v_add_f32_dpp v32, v28, v28 row_ror:8 row_mask:0xf bank_mask:0x3
v_add_f32_dpp v33, v29, v29 row_ror:8 row_mask:0xf bank_mask:0x3
v_add_f32_dpp v32, v30, v30 row_ror:8 row_mask:0xf bank_mask:0xc
v_add_f32_dpp v33, v31, v31 row_ror:8 row_mask:0xf bank_mask:0xc
s_nop 0
v_add_f32_dpp v34, v32, v32 row_half_mirror row_mask:0xf bank_mask:0x5
v_add_f32_dpp v34, v33, v33 row_half_mirror row_mask:0xf bank_mask:0xa
s_nop 1
v_add_f32_dpp v34, v34, v34 quad_perm:[1,0,3,2] row_mask:0xf bank_mask:0xf
s_nop 1
v_add_f32_dpp v34, v34, v34 quad_perm:[2,3,0,1] row_mask:0xf bank_mask:0xf
v_cndmask_b32 v86, v86, v34, s[72:73]
s_waitcnt vmcnt(28)
v_dot2_f32_bf16 v28, v200, v24, 0
v_dot2_f32_bf16 v29, v204, v24, 0
v_dot2_f32_bf16 v30, v208, v24, 0
v_dot2_f32_bf16 v31, v212, v24, 0
v_dot2_f32_bf16 v28, v201, v25, v28
v_dot2_f32_bf16 v29, v205, v25, v29
v_dot2_f32_bf16 v30, v209, v25, v30
v_dot2_f32_bf16 v31, v213, v25, v31
v_dot2_f32_bf16 v28, v202, v26, v28
v_dot2_f32_bf16 v29, v206, v26, v29
v_dot2_f32_bf16 v30, v210, v26, v30
v_dot2_f32_bf16 v31, v214, v26, v31
v_dot2_f32_bf16 v28, v203, v27, v28
v_dot2_f32_bf16 v29, v207, v27, v29
v_dot2_f32_bf16 v30, v211, v27, v30
v_dot2_f32_bf16 v31, v215, v27, v31
buffer_load_dwordx4 v[200:203], v2, s[52:55], s12 offen offset:0 nt
buffer_load_dwordx4 v[204:207], v2, s[52:55], s12 offen offset:1024 nt
buffer_load_dwordx4 v[208:211], v2, s[52:55], s12 offen offset:2048 nt
buffer_load_dwordx4 v[212:215], v2, s[52:55], s12 offen offset:3072 nt
s_add_u32 s13, s13, 24576
s_min_u32 s12, s13, 2146435072
s_cmp_ge_u32 s80, 36
s_cbranch_scc1 L_nodma_10
s_mov_b32 m0, s15
s_nop 0
buffer_load_dwordx4 v2, s[60:63], s15 offen  lds
s_add_u32 s15, s15, 1024
L_nodma_10:
s_add_u32 s80, s80, 1
v_add_f32_dpp v32, v28, v28 row_ror:8 row_mask:0xf bank_mask:0x3
v_add_f32_dpp v33, v29, v29 row_ror:8 row_mask:0xf bank_mask:0x3
v_add_f32_dpp v32, v30, v30 row_ror:8 row_mask:0xf bank_mask:0xc
v_add_f32_dpp v33, v31, v31 row_ror:8 row_mask:0xf bank_mask:0xc
s_nop 0
v_add_f32_dpp v34, v32, v32 row_half_mirror row_mask:0xf bank_mask:0x5
v_add_f32_dpp v34, v33, v33 row_half_mirror row_mask:0xf bank_mask:0xa
s_nop 1
v_add_f32_dpp v34, v34, v34 quad_perm:[1,0,3,2] row_mask:0xf bank_mask:0xf
s_nop 1
v_add_f32_dpp v34, v34, v34 quad_perm:[2,3,0,1] row_mask:0xf bank_mask:0xf
v_cndmask_b32 v86, v86, v34, s[74:75]
s_waitcnt vmcnt(28)
v_dot2_f32_bf16 v28, v216, v24, 0
v_dot2_f32_bf16 v29, v220, v24, 0
v_dot2_f32_bf16 v30, v224, v24, 0
v_dot2_f32_bf16 v31, v228, v24, 0
v_dot2_f32_bf16 v28, v217, v25, v28
v_dot2_f32_bf16 v29, v221, v25, v29
v_dot2_f32_bf16 v30, v225, v25, v30
v_dot2_f32_bf16 v31, v229, v25, v31
v_dot2_f32_bf16 v28, v218, v26, v28
v_dot2_f32_bf16 v29, v222, v26, v29
v_dot2_f32_bf16 v30, v226, v26, v30
v_dot2_f32_bf16 v31, v230, v26, v31
v_dot2_f32_bf16 v28, v219, v27, v28
v_dot2_f32_bf16 v29, v223, v27, v29
v_dot2_f32_bf16 v30, v227, v27, v30
v_dot2_f32_bf16 v31, v231, v27, v31
buffer_load_dwordx4 v[216:219], v2, s[52:55], s12 offen offset:0 nt
buffer_load_dwordx4 v[220:223], v2, s[52:55], s12 offen offset:1024 nt
buffer_load_dwordx4 v[224:227], v2, s[52:55], s12 offen offset:2048 nt
buffer_load_dwordx4 v[228:231], v2, s[52:55], s12 offen offset:3072 nt
s_add_u32 s13, s13, 24576
s_min_u32 s12, s13, 2146435072
s_cmp_ge_u32 s80, 36
s_cbranch_scc1 L_nodma_11
s_mov_b32 m0, s15
s_nop 0
buffer_load_dwordx4 v2, s[60:63], s15 offen  lds
s_add_u32 s15, s15, 1024
L_nodma_11:
s_add_u32 s80, s80, 1
v_add_f32_dpp v32, v28, v28 row_ror:8 row_mask:0xf bank_mask:0x3
v_add_f32_dpp v33, v29, v29 row_ror:8 row_mask:0xf bank_mask:0x3
v_add_f32_dpp v32, v30, v30 row_ror:8 row_mask:0xf bank_mask:0xc
v_add_f32_dpp v33, v31, v31 row_ror:8 row_mask:0xf bank_mask:0xc
s_nop 0
v_add_f32_dpp v34, v32, v32 row_half_mirror row_mask:0xf bank_mask:0x5
v_add_f32_dpp v34, v33, v33 row_half_mirror row_mask:0xf bank_mask:0xa
s_nop 1
v_add_f32_dpp v34, v34, v34 quad_perm:[1,0,3,2] row_mask:0xf bank_mask:0xf
s_nop 1
v_add_f32_dpp v34, v34, v34 quad_perm:[2,3,0,1] row_mask:0xf bank_mask:0xf
v_cndmask_b32 v86, v86, v34, s[76:77]
s_waitcnt vmcnt(28)
v_dot2_f32_bf16 v28, v232, v24, 0
v_dot2_f32_bf16 v29, v236, v24, 0
v_dot2_f32_bf16 v30, v240, v24, 0
v_dot2_f32_bf16 v31, v244, v24, 0
v_dot2_f32_bf16 v28, v233, v25, v28
v_dot2_f32_bf16 v29, v237, v25, v29
v_dot2_f32_bf16 v30, v241, v25, v30
v_dot2_f32_bf16 v31, v245, v25, v31
v_dot2_f32_bf16 v28, v234, v26, v28
v_dot2_f32_bf16 v29, v238, v26, v29
v_dot2_f32_bf16 v30, v242, v26, v30
v_dot2_f32_bf16 v31, v246, v26, v31
v_dot2_f32_bf16 v28, v235, v27, v28
v_dot2_f32_bf16 v29, v239, v27, v29
v_dot2_f32_bf16 v30, v243, v27, v30
v_dot2_f32_bf16 v31, v247, v27, v31
buffer_load_dwordx4 v[232:235], v2, s[52:55], s12 offen offset:0 nt
buffer_load_dwordx4 v[236:239], v2, s[52:55], s12 offen offset:1024 nt
buffer_load_dwordx4 v[240:243], v2, s[52:55], s12 offen offset:2048 nt
buffer_load_dwordx4 v[244:247], v2, s[52:55], s12 offen offset:3072 nt
s_add_u32 s13, s13, 24576
s_min_u32 s12, s13, 2146435072
s_cmp_ge_u32 s80, 36
s_cbranch_scc1 L_nodma_12
s_mov_b32 m0, s15
s_nop 0
buffer_load_dwordx4 v2, s[60:63], s15 offen  lds
s_add_u32 s15, s15, 1024
L_nodma_12:
s_add_u32 s80, s80, 1
v_add_f32_dpp v32, v28, v28 row_ror:8 row_mask:0xf bank_mask:0x3
v_add_f32_dpp v33, v29, v29 row_ror:8 row_mask:0xf bank_mask:0x3
v_add_f32_dpp v32, v30, v30 row_ror:8 row_mask:0xf bank_mask:0xc
v_add_f32_dpp v33, v31, v31 row_ror:8 row_mask:0xf bank_mask:0xc
s_nop 0
v_add_f32_dpp v34, v32, v32 row_half_mirror row_mask:0xf bank_mask:0x5
v_add_f32_dpp v34, v33, v33 row_half_mirror row_mask:0xf bank_mask:0xa
s_nop 1
v_add_f32_dpp v34, v34, v34 quad_perm:[1,0,3,2] row_mask:0xf bank_mask:0xf
s_nop 1
v_add_f32_dpp v34, v34, v34 quad_perm:[2,3,0,1] row_mask:0xf bank_mask:0xf
v_cndmask_b32 v86, v86, v34, s[78:79]
s_add_u32 s81, s81, 1
v_mov_b32 v76, v77
v_mov_b32 v77, v78
v_mov_b32 v78, v79
v_mov_b32 v79, v80
v_mov_b32 v80, v81
v_mov_b32 v81, v82
v_mov_b32 v82, v83
v_mov_b32 v83, v84
v_mov_b32 v84, v85
v_mov_b32 v85, v86
s_branch K_loop
A_mid:
v_max3_f32 v35, v76, v77, v78
v_max3_f32 v35, v35, v79, v80
v_max3_f32 v35, v35, v81, v82
v_max3_f32 v35, v35, v83, v84
v_max3_f32 v35, v35, v85, v86
s_nop 1
v_max_f32_dpp v35, v35, v35 row_ror:8 row_mask:0xf bank_mask:0xf
s_nop 1
v_max_f32_dpp v35, v35, v35 row_ror:4 row_mask:0xf bank_mask:0xf
s_nop 1
v_max_f32_dpp v35, v35, v35 row_ror:2 row_mask:0xf bank_mask:0xf
s_nop 1
v_max_f32_dpp v35, v35, v35 row_ror:1 row_mask:0xf bank_mask:0xf
v_mov_b32 v36, v35
s_nop 1
v_permlane16_swap_b32 v35, v36
v_max_f32 v35, v35, v36
v_mov_b32 v36, v35
s_nop 1
v_permlane32_swap_b32 v35, v36
v_max_f32 v35, v35, v36
v_mul_f32 v32, v35, v7
v_fma_f32 v76, v76, v7, -v32
v_fma_f32 v77, v77, v7, -v32
v_fma_f32 v78, v78, v7, -v32
v_fma_f32 v79, v79, v7, -v32
v_fma_f32 v80, v80, v7, -v32
v_fma_f32 v81, v81, v7, -v32
v_fma_f32 v82, v82, v7, -v32
v_fma_f32 v83, v83, v7, -v32
v_fma_f32 v84, v84, v7, -v32
v_fma_f32 v85, v85, v7, -v32
v_fma_f32 v86, v86, v7, -v32
v_exp_f32 v76, v76
v_exp_f32 v77, v77
v_exp_f32 v78, v78
v_exp_f32 v79, v79
v_exp_f32 v80, v80
v_exp_f32 v81, v81
v_exp_f32 v82, v82
v_exp_f32 v83, v83
v_exp_f32 v84, v84
v_exp_f32 v85, v85
v_exp_f32 v86, v86
v_add_f32 v35, v76, v77
v_add_f32 v35, v35, v78
v_add_f32 v35, v35, v79
v_add_f32 v35, v35, v80
v_add_f32 v35, v35, v81
v_add_f32 v35, v35, v82
v_add_f32 v35, v35, v83
v_add_f32 v35, v35, v84
v_add_f32 v35, v35, v85
v_add_f32 v35, v35, v86
v_cvt_pk_bf16_f32 v76, v76, v76
v_cvt_pk_bf16_f32 v77, v77, v77
v_cvt_pk_bf16_f32 v78, v78, v78
v_cvt_pk_bf16_f32 v79, v79, v79
v_cvt_pk_bf16_f32 v80, v80, v80
v_cvt_pk_bf16_f32 v81, v81, v81
v_cvt_pk_bf16_f32 v82, v82, v82
v_cvt_pk_bf16_f32 v83, v83, v83
v_cvt_pk_bf16_f32 v84, v84, v84
v_cvt_pk_bf16_f32 v85, v85, v85
v_cvt_pk_bf16_f32 v86, v86, v86
v_add_f32_dpp v35, v35, v35 row_ror:8 row_mask:0xf bank_mask:0xf
s_nop 1
v_add_f32_dpp v35, v35, v35 row_ror:4 row_mask:0xf bank_mask:0xf
s_nop 1
v_add_f32_dpp v35, v35, v35 row_ror:2 row_mask:0xf bank_mask:0xf
s_nop 1
v_add_f32_dpp v35, v35, v35 row_ror:1 row_mask:0xf bank_mask:0xf
v_mov_b32 v36, v35
s_nop 1
v_permlane16_swap_b32 v35, v36
v_add_f32 v35, v35, v36
v_mov_b32 v36, v35
s_nop 1
v_permlane32_swap_b32 v35, v36
v_add_f32 v35, v35, v36
v_min_u32 v32, -2, v32
v_min_u32 v33, -2, v35
s_mov_b32 s7, 400000
L_ens_13:
v_readfirstlane_b32 s6, v96
s_cmp_ge_u32 s6, 128
s_cbranch_scc1 L_ensd_14
s_sleep 16
buffer_load_dword v96, off, s[68:71], 0 offset:0 sc1
s_waitcnt vmcnt(0)
s_sub_u32 s7, s7, 1
s_cmp_lg_u32 s7, 0
s_cbranch_scc1 L_ens_13
L_ensd_14:
s_lshl_b32 s6, s11, 3
s_add_u32 s6, s6, s82
s_mov_b64 exec, 1
buffer_store_dwordx2 v[32:33], off, s[64:67], s6 sc1
s_mov_b64 exec, -1
v_and_b32_dpp v60, v78, v8 row_newbcast:0 row_mask:0xf bank_mask:0xf
v_and_b32_dpp v61, v78, v9 row_newbcast:0 row_mask:0xf bank_mask:0xf
v_and_b32_dpp v62, v78, v10 row_newbcast:0 row_mask:0xf bank_mask:0xf
v_and_b32_dpp v63, v78, v11 row_newbcast:0 row_mask:0xf bank_mask:0xf
v_and_b32_dpp v64, v78, v8 row_newbcast:4 row_mask:0xf bank_mask:0xf
v_and_b32_dpp v65, v78, v9 row_newbcast:4 row_mask:0xf bank_mask:0xf
v_and_b32_dpp v66, v78, v10 row_newbcast:4 row_mask:0xf bank_mask:0xf
v_and_b32_dpp v67, v78, v11 row_newbcast:4 row_mask:0xf bank_mask:0xf
v_and_b32_dpp v68, v78, v8 row_newbcast:8 row_mask:0xf bank_mask:0xf
v_and_b32_dpp v69, v78, v9 row_newbcast:8 row_mask:0xf bank_mask:0xf
v_and_b32_dpp v70, v78, v10 row_newbcast:8 row_mask:0xf bank_mask:0xf
v_and_b32_dpp v71, v78, v11 row_newbcast:8 row_mask:0xf bank_mask:0xf
v_and_b32_dpp v72, v78, v8 row_newbcast:12 row_mask:0xf bank_mask:0xf
v_and_b32_dpp v73, v78, v9 row_newbcast:12 row_mask:0xf bank_mask:0xf
v_and_b32_dpp v74, v78, v10 row_newbcast:12 row_mask:0xf bank_mask:0xf
v_and_b32_dpp v75, v78, v11 row_newbcast:12 row_mask:0xf bank_mask:0xf
s_waitcnt vmcnt(28)
v_mfma_f32_16x16x32_bf16 v[20:23], v[60:63], v[184:187], v[20:23]
v_mfma_f32_16x16x32_bf16 v[20:23], v[64:67], v[188:191], v[20:23]
v_mfma_f32_16x16x32_bf16 v[20:23], v[68:71], v[192:195], v[20:23]
v_mfma_f32_16x16x32_bf16 v[20:23], v[72:75], v[196:199], v[20:23]
buffer_load_dwordx4 v[184:187], v2, s[52:55], s12 offen offset:0 nt
buffer_load_dwordx4 v[188:191], v2, s[52:55], s12 offen offset:1024 nt
buffer_load_dwordx4 v[192:195], v2, s[52:55], s12 offen offset:2048 nt
buffer_load_dwordx4 v[196:199], v2, s[52:55], s12 offen offset:3072 nt
s_add_u32 s13, s13, 24576
s_min_u32 s12, s13, 2146435072
v_and_b32_dpp v60, v78, v8 row_newbcast:1 row_mask:0xf bank_mask:0xf
v_and_b32_dpp v61, v78, v9 row_newbcast:1 row_mask:0xf bank_mask:0xf
v_and_b32_dpp v62, v78, v10 row_newbcast:1 row_mask:0xf bank_mask:0xf
v_and_b32_dpp v63, v78, v11 row_newbcast:1 row_mask:0xf bank_mask:0xf
v_and_b32_dpp v64, v78, v8 row_newbcast:5 row_mask:0xf bank_mask:0xf
v_and_b32_dpp v65, v78, v9 row_newbcast:5 row_mask:0xf bank_mask:0xf
v_and_b32_dpp v66, v78, v10 row_newbcast:5 row_mask:0xf bank_mask:0xf
v_and_b32_dpp v67, v78, v11 row_newbcast:5 row_mask:0xf bank_mask:0xf
v_and_b32_dpp v68, v78, v8 row_newbcast:9 row_mask:0xf bank_mask:0xf
v_and_b32_dpp v69, v78, v9 row_newbcast:9 row_mask:0xf bank_mask:0xf
v_and_b32_dpp v70, v78, v10 row_newbcast:9 row_mask:0xf bank_mask:0xf
v_and_b32_dpp v71, v78, v11 row_newbcast:9 row_mask:0xf bank_mask:0xf
v_and_b32_dpp v72, v78, v8 row_newbcast:13 row_mask:0xf bank_mask:0xf
v_and_b32_dpp v73, v78, v9 row_newbcast:13 row_mask:0xf bank_mask:0xf
v_and_b32_dpp v74, v78, v10 row_newbcast:13 row_mask:0xf bank_mask:0xf
v_and_b32_dpp v75, v78, v11 row_newbcast:13 row_mask:0xf bank_mask:0xf
s_waitcnt vmcnt(28)
v_mfma_f32_16x16x32_bf16 v[20:23], v[60:63], v[200:203], v[20:23]
v_mfma_f32_16x16x32_bf16 v[20:23], v[64:67], v[204:207], v[20:23]
v_mfma_f32_16x16x32_bf16 v[20:23], v[68:71], v[208:211], v[20:23]
v_mfma_f32_16x16x32_bf16 v[20:23], v[72:75], v[212:215], v[20:23]
buffer_load_dwordx4 v[200:203], v2, s[52:55], s12 offen offset:0 nt
buffer_load_dwordx4 v[204:207], v2, s[52:55], s12 offen offset:1024 nt
buffer_load_dwordx4 v[208:211], v2, s[52:55], s12 offen offset:2048 nt
buffer_load_dwordx4 v[212:215], v2, s[52:55], s12 offen offset:3072 nt
s_add_u32 s13, s13, 24576
s_min_u32 s12, s13, 2146435072
v_and_b32_dpp v60, v76, v8 row_newbcast:1 row_mask:0xf bank_mask:0xf
v_and_b32_dpp v61, v76, v9 row_newbcast:1 row_mask:0xf bank_mask:0xf
v_and_b32_dpp v62, v76, v10 row_newbcast:1 row_mask:0xf bank_mask:0xf
v_and_b32_dpp v63, v76, v11 row_newbcast:1 row_mask:0xf bank_mask:0xf
v_and_b32_dpp v64, v76, v8 row_newbcast:5 row_mask:0xf bank_mask:0xf
v_and_b32_dpp v65, v76, v9 row_newbcast:5 row_mask:0xf bank_mask:0xf
v_and_b32_dpp v66, v76, v10 row_newbcast:5 row_mask:0xf bank_mask:0xf
v_and_b32_dpp v67, v76, v11 row_newbcast:5 row_mask:0xf bank_mask:0xf
v_and_b32_dpp v68, v76, v8 row_newbcast:9 row_mask:0xf bank_mask:0xf
v_and_b32_dpp v69, v76, v9 row_newbcast:9 row_mask:0xf bank_mask:0xf
v_and_b32_dpp v70, v76, v10 row_newbcast:9 row_mask:0xf bank_mask:0xf
v_and_b32_dpp v71, v76, v11 row_newbcast:9 row_mask:0xf bank_mask:0xf
v_and_b32_dpp v72, v76, v8 row_newbcast:13 row_mask:0xf bank_mask:0xf
v_and_b32_dpp v73, v76, v9 row_newbcast:13 row_mask:0xf bank_mask:0xf
v_and_b32_dpp v74, v76, v10 row_newbcast:13 row_mask:0xf bank_mask:0xf
v_and_b32_dpp v75, v76, v11 row_newbcast:13 row_mask:0xf bank_mask:0xf
v_mfma_f32_16x16x32_bf16 v[20:23], v[60:63], a[0:3], v[20:23]
v_mfma_f32_16x16x32_bf16 v[20:23], v[64:67], a[4:7], v[20:23]
v_mfma_f32_16x16x32_bf16 v[20:23], v[68:71], a[8:11], v[20:23]
v_mfma_f32_16x16x32_bf16 v[20:23], v[72:75], a[12:15], v[20:23]
s_nop 3
v_and_b32_dpp v60, v78, v8 row_newbcast:2 row_mask:0xf bank_mask:0xf
v_and_b32_dpp v61, v78, v9 row_newbcast:2 row_mask:0xf bank_mask:0xf
v_and_b32_dpp v62, v78, v10 row_newbcast:2 row_mask:0xf bank_mask:0xf
v_and_b32_dpp v63, v78, v11 row_newbcast:2 row_mask:0xf bank_mask:0xf
v_and_b32_dpp v64, v78, v8 row_newbcast:6 row_mask:0xf bank_mask:0xf
v_and_b32_dpp v65, v78, v9 row_newbcast:6 row_mask:0xf bank_mask:0xf
v_and_b32_dpp v66, v78, v10 row_newbcast:6 row_mask:0xf bank_mask:0xf
v_and_b32_dpp v67, v78, v11 row_newbcast:6 row_mask:0xf bank_mask:0xf
v_and_b32_dpp v68, v78, v8 row_newbcast:10 row_mask:0xf bank_mask:0xf
v_and_b32_dpp v69, v78, v9 row_newbcast:10 row_mask:0xf bank_mask:0xf
v_and_b32_dpp v70, v78, v10 row_newbcast:10 row_mask:0xf bank_mask:0xf
v_and_b32_dpp v71, v78, v11 row_newbcast:10 row_mask:0xf bank_mask:0xf
v_and_b32_dpp v72, v78, v8 row_newbcast:14 row_mask:0xf bank_mask:0xf
v_and_b32_dpp v73, v78, v9 row_newbcast:14 row_mask:0xf bank_mask:0xf
v_and_b32_dpp v74, v78, v10 row_newbcast:14 row_mask:0xf bank_mask:0xf
v_and_b32_dpp v75, v78, v11 row_newbcast:14 row_mask:0xf bank_mask:0xf
s_waitcnt vmcnt(28)
v_mfma_f32_16x16x32_bf16 v[20:23], v[60:63], v[216:219], v[20:23]
v_mfma_f32_16x16x32_bf16 v[20:23], v[64:67], v[220:223], v[20:23]
v_mfma_f32_16x16x32_bf16 v[20:23], v[68:71], v[224:227], v[20:23]
v_mfma_f32_16x16x32_bf16 v[20:23], v[72:75], v[228:231], v[20:23]
buffer_load_dwordx4 v[216:219], v2, s[52:55], s12 offen offset:0 nt
buffer_load_dwordx4 v[220:223], v2, s[52:55], s12 offen offset:1024 nt
buffer_load_dwordx4 v[224:227], v2, s[52:55], s12 offen offset:2048 nt
buffer_load_dwordx4 v[228:231], v2, s[52:55], s12 offen offset:3072 nt
s_add_u32 s13, s13, 24576
s_min_u32 s12, s13, 2146435072
v_and_b32_dpp v60, v78, v8 row_newbcast:3 row_mask:0xf bank_mask:0xf
v_and_b32_dpp v61, v78, v9 row_newbcast:3 row_mask:0xf bank_mask:0xf
v_and_b32_dpp v62, v78, v10 row_newbcast:3 row_mask:0xf bank_mask:0xf
v_and_b32_dpp v63, v78, v11 row_newbcast:3 row_mask:0xf bank_mask:0xf
v_and_b32_dpp v64, v78, v8 row_newbcast:7 row_mask:0xf bank_mask:0xf
v_and_b32_dpp v65, v78, v9 row_newbcast:7 row_mask:0xf bank_mask:0xf
v_and_b32_dpp v66, v78, v10 row_newbcast:7 row_mask:0xf bank_mask:0xf
v_and_b32_dpp v67, v78, v11 row_newbcast:7 row_mask:0xf bank_mask:0xf
v_and_b32_dpp v68, v78, v8 row_newbcast:11 row_mask:0xf bank_mask:0xf
v_and_b32_dpp v69, v78, v9 row_newbcast:11 row_mask:0xf bank_mask:0xf
v_and_b32_dpp v70, v78, v10 row_newbcast:11 row_mask:0xf bank_mask:0xf
v_and_b32_dpp v71, v78, v11 row_newbcast:11 row_mask:0xf bank_mask:0xf
v_and_b32_dpp v72, v78, v8 row_newbcast:15 row_mask:0xf bank_mask:0xf
v_and_b32_dpp v73, v78, v9 row_newbcast:15 row_mask:0xf bank_mask:0xf
v_and_b32_dpp v74, v78, v10 row_newbcast:15 row_mask:0xf bank_mask:0xf
v_and_b32_dpp v75, v78, v11 row_newbcast:15 row_mask:0xf bank_mask:0xf
s_waitcnt vmcnt(28)
v_mfma_f32_16x16x32_bf16 v[20:23], v[60:63], v[232:235], v[20:23]
v_mfma_f32_16x16x32_bf16 v[20:23], v[64:67], v[236:239], v[20:23]
v_mfma_f32_16x16x32_bf16 v[20:23], v[68:71], v[240:243], v[20:23]
v_mfma_f32_16x16x32_bf16 v[20:23], v[72:75], v[244:247], v[20:23]
buffer_load_dwordx4 v[232:235], v2, s[52:55], s12 offen offset:0 nt
buffer_load_dwordx4 v[236:239], v2, s[52:55], s12 offen offset:1024 nt
buffer_load_dwordx4 v[240:243], v2, s[52:55], s12 offen offset:2048 nt
buffer_load_dwordx4 v[244:247], v2, s[52:55], s12 offen offset:3072 nt
s_add_u32 s13, s13, 24576
s_min_u32 s12, s13, 2146435072
s_barrier
ds_read_b64_tr_b16 a[96:97], v88 offset:0
ds_read_b64_tr_b16 a[98:99], v88 offset:4608
ds_read_b64_tr_b16 a[100:101], v88 offset:36864
ds_read_b64_tr_b16 a[102:103], v88 offset:41472
v_and_b32_dpp v60, v79, v8 row_newbcast:0 row_mask:0xf bank_mask:0xf
v_and_b32_dpp v61, v79, v9 row_newbcast:0 row_mask:0xf bank_mask:0xf
v_and_b32_dpp v62, v79, v10 row_newbcast:0 row_mask:0xf bank_mask:0xf
v_and_b32_dpp v63, v79, v11 row_newbcast:0 row_mask:0xf bank_mask:0xf
v_and_b32_dpp v64, v79, v8 row_newbcast:4 row_mask:0xf bank_mask:0xf
v_and_b32_dpp v65, v79, v9 row_newbcast:4 row_mask:0xf bank_mask:0xf
v_and_b32_dpp v66, v79, v10 row_newbcast:4 row_mask:0xf bank_mask:0xf
v_and_b32_dpp v67, v79, v11 row_newbcast:4 row_mask:0xf bank_mask:0xf
v_and_b32_dpp v68, v79, v8 row_newbcast:8 row_mask:0xf bank_mask:0xf
v_and_b32_dpp v69, v79, v9 row_newbcast:8 row_mask:0xf bank_mask:0xf
v_and_b32_dpp v70, v79, v10 row_newbcast:8 row_mask:0xf bank_mask:0xf
v_and_b32_dpp v71, v79, v11 row_newbcast:8 row_mask:0xf bank_mask:0xf
v_and_b32_dpp v72, v79, v8 row_newbcast:12 row_mask:0xf bank_mask:0xf
v_and_b32_dpp v73, v79, v9 row_newbcast:12 row_mask:0xf bank_mask:0xf
v_and_b32_dpp v74, v79, v10 row_newbcast:12 row_mask:0xf bank_mask:0xf
v_and_b32_dpp v75, v79, v11 row_newbcast:12 row_mask:0xf bank_mask:0xf
s_waitcnt vmcnt(28)
v_mfma_f32_16x16x32_bf16 v[20:23], v[60:63], v[120:123], v[20:23]
v_mfma_f32_16x16x32_bf16 v[20:23], v[64:67], v[124:127], v[20:23]
v_mfma_f32_16x16x32_bf16 v[20:23], v[68:71], v[128:131], v[20:23]
v_mfma_f32_16x16x32_bf16 v[20:23], v[72:75], v[132:135], v[20:23]
buffer_load_dwordx4 v[120:123], v2, s[52:55], s12 offen offset:0 nt
buffer_load_dwordx4 v[124:127], v2, s[52:55], s12 offen offset:1024 nt
buffer_load_dwordx4 v[128:131], v2, s[52:55], s12 offen offset:2048 nt
buffer_load_dwordx4 v[132:135], v2, s[52:55], s12 offen offset:3072 nt
s_add_u32 s13, s13, 24576
s_min_u32 s12, s13, 2146435072
ds_read_b64_tr_b16 a[104:105], v90 offset:0
ds_read_b64_tr_b16 a[106:107], v90 offset:4608
ds_read_b64_tr_b16 a[108:109], v90 offset:36864
ds_read_b64_tr_b16 a[110:111], v90 offset:41472
v_and_b32_dpp v60, v79, v8 row_newbcast:1 row_mask:0xf bank_mask:0xf
v_and_b32_dpp v61, v79, v9 row_newbcast:1 row_mask:0xf bank_mask:0xf
v_and_b32_dpp v62, v79, v10 row_newbcast:1 row_mask:0xf bank_mask:0xf
v_and_b32_dpp v63, v79, v11 row_newbcast:1 row_mask:0xf bank_mask:0xf
v_and_b32_dpp v64, v79, v8 row_newbcast:5 row_mask:0xf bank_mask:0xf
v_and_b32_dpp v65, v79, v9 row_newbcast:5 row_mask:0xf bank_mask:0xf
v_and_b32_dpp v66, v79, v10 row_newbcast:5 row_mask:0xf bank_mask:0xf
v_and_b32_dpp v67, v79, v11 row_newbcast:5 row_mask:0xf bank_mask:0xf
v_and_b32_dpp v68, v79, v8 row_newbcast:9 row_mask:0xf bank_mask:0xf
v_and_b32_dpp v69, v79, v9 row_newbcast:9 row_mask:0xf bank_mask:0xf
v_and_b32_dpp v70, v79, v10 row_newbcast:9 row_mask:0xf bank_mask:0xf
v_and_b32_dpp v71, v79, v11 row_newbcast:9 row_mask:0xf bank_mask:0xf
v_and_b32_dpp v72, v79, v8 row_newbcast:13 row_mask:0xf bank_mask:0xf
v_and_b32_dpp v73, v79, v9 row_newbcast:13 row_mask:0xf bank_mask:0xf
v_and_b32_dpp v74, v79, v10 row_newbcast:13 row_mask:0xf bank_mask:0xf
v_and_b32_dpp v75, v79, v11 row_newbcast:13 row_mask:0xf bank_mask:0xf
s_waitcnt vmcnt(28)
v_mfma_f32_16x16x32_bf16 v[20:23], v[60:63], v[136:139], v[20:23]
v_mfma_f32_16x16x32_bf16 v[20:23], v[64:67], v[140:143], v[20:23]
v_mfma_f32_16x16x32_bf16 v[20:23], v[68:71], v[144:147], v[20:23]
v_mfma_f32_16x16x32_bf16 v[20:23], v[72:75], v[148:151], v[20:23]
buffer_load_dwordx4 v[136:139], v2, s[52:55], s12 offen offset:0 nt
buffer_load_dwordx4 v[140:143], v2, s[52:55], s12 offen offset:1024 nt
buffer_load_dwordx4 v[144:147], v2, s[52:55], s12 offen offset:2048 nt
buffer_load_dwordx4 v[148:151], v2, s[52:55], s12 offen offset:3072 nt
s_add_u32 s13, s13, 24576
s_min_u32 s12, s13, 2146435072
ds_read_b64_tr_b16 a[112:113], v88 offset:8
ds_read_b64_tr_b16 a[114:115], v88 offset:4616
ds_read_b64_tr_b16 a[116:117], v88 offset:36872
ds_read_b64_tr_b16 a[118:119], v88 offset:41480
v_and_b32_dpp v60, v76, v8 row_newbcast:2 row_mask:0xf bank_mask:0xf
v_and_b32_dpp v61, v76, v9 row_newbcast:2 row_mask:0xf bank_mask:0xf
v_and_b32_dpp v62, v76, v10 row_newbcast:2 row_mask:0xf bank_mask:0xf
v_and_b32_dpp v63, v76, v11 row_newbcast:2 row_mask:0xf bank_mask:0xf
v_and_b32_dpp v64, v76, v8 row_newbcast:6 row_mask:0xf bank_mask:0xf
v_and_b32_dpp v65, v76, v9 row_newbcast:6 row_mask:0xf bank_mask:0xf
v_and_b32_dpp v66, v76, v10 row_newbcast:6 row_mask:0xf bank_mask:0xf
v_and_b32_dpp v67, v76, v11 row_newbcast:6 row_mask:0xf bank_mask:0xf
v_and_b32_dpp v68, v76, v8 row_newbcast:10 row_mask:0xf bank_mask:0xf
v_and_b32_dpp v69, v76, v9 row_newbcast:10 row_mask:0xf bank_mask:0xf
v_and_b32_dpp v70, v76, v10 row_newbcast:10 row_mask:0xf bank_mask:0xf
v_and_b32_dpp v71, v76, v11 row_newbcast:10 row_mask:0xf bank_mask:0xf
v_and_b32_dpp v72, v76, v8 row_newbcast:14 row_mask:0xf bank_mask:0xf
v_and_b32_dpp v73, v76, v9 row_newbcast:14 row_mask:0xf bank_mask:0xf
v_and_b32_dpp v74, v76, v10 row_newbcast:14 row_mask:0xf bank_mask:0xf
v_and_b32_dpp v75, v76, v11 row_newbcast:14 row_mask:0xf bank_mask:0xf
v_mfma_f32_16x16x32_bf16 v[20:23], v[60:63], a[16:19], v[20:23]
v_mfma_f32_16x16x32_bf16 v[20:23], v[64:67], a[20:23], v[20:23]
v_mfma_f32_16x16x32_bf16 v[20:23], v[68:71], a[24:27], v[20:23]
v_mfma_f32_16x16x32_bf16 v[20:23], v[72:75], a[28:31], v[20:23]
s_nop 3
v_and_b32_dpp v60, v79, v8 row_newbcast:2 row_mask:0xf bank_mask:0xf
v_and_b32_dpp v61, v79, v9 row_newbcast:2 row_mask:0xf bank_mask:0xf
v_and_b32_dpp v62, v79, v10 row_newbcast:2 row_mask:0xf bank_mask:0xf
v_and_b32_dpp v63, v79, v11 row_newbcast:2 row_mask:0xf bank_mask:0xf
v_and_b32_dpp v64, v79, v8 row_newbcast:6 row_mask:0xf bank_mask:0xf
v_and_b32_dpp v65, v79, v9 row_newbcast:6 row_mask:0xf bank_mask:0xf
v_and_b32_dpp v66, v79, v10 row_newbcast:6 row_mask:0xf bank_mask:0xf
v_and_b32_dpp v67, v79, v11 row_newbcast:6 row_mask:0xf bank_mask:0xf
v_and_b32_dpp v68, v79, v8 row_newbcast:10 row_mask:0xf bank_mask:0xf
v_and_b32_dpp v69, v79, v9 row_newbcast:10 row_mask:0xf bank_mask:0xf
v_and_b32_dpp v70, v79, v10 row_newbcast:10 row_mask:0xf bank_mask:0xf
v_and_b32_dpp v71, v79, v11 row_newbcast:10 row_mask:0xf bank_mask:0xf
v_and_b32_dpp v72, v79, v8 row_newbcast:14 row_mask:0xf bank_mask:0xf
v_and_b32_dpp v73, v79, v9 row_newbcast:14 row_mask:0xf bank_mask:0xf
v_and_b32_dpp v74, v79, v10 row_newbcast:14 row_mask:0xf bank_mask:0xf
v_and_b32_dpp v75, v79, v11 row_newbcast:14 row_mask:0xf bank_mask:0xf
s_waitcnt vmcnt(28)
v_mfma_f32_16x16x32_bf16 v[20:23], v[60:63], v[152:155], v[20:23]
v_mfma_f32_16x16x32_bf16 v[20:23], v[64:67], v[156:159], v[20:23]
v_mfma_f32_16x16x32_bf16 v[20:23], v[68:71], v[160:163], v[20:23]
v_mfma_f32_16x16x32_bf16 v[20:23], v[72:75], v[164:167], v[20:23]
buffer_load_dwordx4 v[152:155], v2, s[52:55], s12 offen offset:0 nt
buffer_load_dwordx4 v[156:159], v2, s[52:55], s12 offen offset:1024 nt
buffer_load_dwordx4 v[160:163], v2, s[52:55], s12 offen offset:2048 nt
buffer_load_dwordx4 v[164:167], v2, s[52:55], s12 offen offset:3072 nt
s_add_u32 s13, s13, 24576
s_min_u32 s12, s13, 2146435072
ds_read_b64_tr_b16 a[120:121], v90 offset:8
ds_read_b64_tr_b16 a[122:123], v90 offset:4616
ds_read_b64_tr_b16 a[124:125], v90 offset:36872
ds_read_b64_tr_b16 a[126:127], v90 offset:41480
v_and_b32_dpp v60, v79, v8 row_newbcast:3 row_mask:0xf bank_mask:0xf
v_and_b32_dpp v61, v79, v9 row_newbcast:3 row_mask:0xf bank_mask:0xf
v_and_b32_dpp v62, v79, v10 row_newbcast:3 row_mask:0xf bank_mask:0xf
v_and_b32_dpp v63, v79, v11 row_newbcast:3 row_mask:0xf bank_mask:0xf
v_and_b32_dpp v64, v79, v8 row_newbcast:7 row_mask:0xf bank_mask:0xf
v_and_b32_dpp v65, v79, v9 row_newbcast:7 row_mask:0xf bank_mask:0xf
v_and_b32_dpp v66, v79, v10 row_newbcast:7 row_mask:0xf bank_mask:0xf
v_and_b32_dpp v67, v79, v11 row_newbcast:7 row_mask:0xf bank_mask:0xf
v_and_b32_dpp v68, v79, v8 row_newbcast:11 row_mask:0xf bank_mask:0xf
v_and_b32_dpp v69, v79, v9 row_newbcast:11 row_mask:0xf bank_mask:0xf
v_and_b32_dpp v70, v79, v10 row_newbcast:11 row_mask:0xf bank_mask:0xf
v_and_b32_dpp v71, v79, v11 row_newbcast:11 row_mask:0xf bank_mask:0xf
v_and_b32_dpp v72, v79, v8 row_newbcast:15 row_mask:0xf bank_mask:0xf
v_and_b32_dpp v73, v79, v9 row_newbcast:15 row_mask:0xf bank_mask:0xf
v_and_b32_dpp v74, v79, v10 row_newbcast:15 row_mask:0xf bank_mask:0xf
v_and_b32_dpp v75, v79, v11 row_newbcast:15 row_mask:0xf bank_mask:0xf
s_waitcnt vmcnt(28)
v_mfma_f32_16x16x32_bf16 v[20:23], v[60:63], v[168:171], v[20:23]
v_mfma_f32_16x16x32_bf16 v[20:23], v[64:67], v[172:175], v[20:23]
v_mfma_f32_16x16x32_bf16 v[20:23], v[68:71], v[176:179], v[20:23]
v_mfma_f32_16x16x32_bf16 v[20:23], v[72:75], v[180:183], v[20:23]
buffer_load_dwordx4 v[168:171], v2, s[52:55], s12 offen offset:0 nt
buffer_load_dwordx4 v[172:175], v2, s[52:55], s12 offen offset:1024 nt
buffer_load_dwordx4 v[176:179], v2, s[52:55], s12 offen offset:2048 nt
buffer_load_dwordx4 v[180:183], v2, s[52:55], s12 offen offset:3072 nt
s_add_u32 s13, s13, 24576
s_min_u32 s12, s13, 2146435072
ds_read_b64_tr_b16 a[128:129], v88 offset:16
ds_read_b64_tr_b16 a[130:131], v88 offset:4624
ds_read_b64_tr_b16 a[132:133], v88 offset:36880
ds_read_b64_tr_b16 a[134:135], v88 offset:41488
v_and_b32_dpp v60, v80, v8 row_newbcast:0 row_mask:0xf bank_mask:0xf
v_and_b32_dpp v61, v80, v9 row_newbcast:0 row_mask:0xf bank_mask:0xf
v_and_b32_dpp v62, v80, v10 row_newbcast:0 row_mask:0xf bank_mask:0xf
v_and_b32_dpp v63, v80, v11 row_newbcast:0 row_mask:0xf bank_mask:0xf
v_and_b32_dpp v64, v80, v8 row_newbcast:4 row_mask:0xf bank_mask:0xf
v_and_b32_dpp v65, v80, v9 row_newbcast:4 row_mask:0xf bank_mask:0xf
v_and_b32_dpp v66, v80, v10 row_newbcast:4 row_mask:0xf bank_mask:0xf
v_and_b32_dpp v67, v80, v11 row_newbcast:4 row_mask:0xf bank_mask:0xf
v_and_b32_dpp v68, v80, v8 row_newbcast:8 row_mask:0xf bank_mask:0xf
v_and_b32_dpp v69, v80, v9 row_newbcast:8 row_mask:0xf bank_mask:0xf
v_and_b32_dpp v70, v80, v10 row_newbcast:8 row_mask:0xf bank_mask:0xf
v_and_b32_dpp v71, v80, v11 row_newbcast:8 row_mask:0xf bank_mask:0xf
v_and_b32_dpp v72, v80, v8 row_newbcast:12 row_mask:0xf bank_mask:0xf
v_and_b32_dpp v73, v80, v9 row_newbcast:12 row_mask:0xf bank_mask:0xf
v_and_b32_dpp v74, v80, v10 row_newbcast:12 row_mask:0xf bank_mask:0xf
v_and_b32_dpp v75, v80, v11 row_newbcast:12 row_mask:0xf bank_mask:0xf
s_waitcnt vmcnt(28)
v_mfma_f32_16x16x32_bf16 v[20:23], v[60:63], v[184:187], v[20:23]
v_mfma_f32_16x16x32_bf16 v[20:23], v[64:67], v[188:191], v[20:23]
v_mfma_f32_16x16x32_bf16 v[20:23], v[68:71], v[192:195], v[20:23]
v_mfma_f32_16x16x32_bf16 v[20:23], v[72:75], v[196:199], v[20:23]
buffer_load_dwordx4 v[184:187], v2, s[52:55], s12 offen offset:0 nt
buffer_load_dwordx4 v[188:191], v2, s[52:55], s12 offen offset:1024 nt
buffer_load_dwordx4 v[192:195], v2, s[52:55], s12 offen offset:2048 nt
buffer_load_dwordx4 v[196:199], v2, s[52:55], s12 offen offset:3072 nt
s_add_u32 s13, s13, 24576
s_min_u32 s12, s13, 2146435072
ds_read_b64_tr_b16 a[136:137], v90 offset:16
ds_read_b64_tr_b16 a[138:139], v90 offset:4624
ds_read_b64_tr_b16 a[140:141], v90 offset:36880
ds_read_b64_tr_b16 a[142:143], v90 offset:41488
v_and_b32_dpp v60, v80, v8 row_newbcast:1 row_mask:0xf bank_mask:0xf
v_and_b32_dpp v61, v80, v9 row_newbcast:1 row_mask:0xf bank_mask:0xf
v_and_b32_dpp v62, v80, v10 row_newbcast:1 row_mask:0xf bank_mask:0xf
v_and_b32_dpp v63, v80, v11 row_newbcast:1 row_mask:0xf bank_mask:0xf
v_and_b32_dpp v64, v80, v8 row_newbcast:5 row_mask:0xf bank_mask:0xf
v_and_b32_dpp v65, v80, v9 row_newbcast:5 row_mask:0xf bank_mask:0xf
v_and_b32_dpp v66, v80, v10 row_newbcast:5 row_mask:0xf bank_mask:0xf
v_and_b32_dpp v67, v80, v11 row_newbcast:5 row_mask:0xf bank_mask:0xf
v_and_b32_dpp v68, v80, v8 row_newbcast:9 row_mask:0xf bank_mask:0xf
v_and_b32_dpp v69, v80, v9 row_newbcast:9 row_mask:0xf bank_mask:0xf
v_and_b32_dpp v70, v80, v10 row_newbcast:9 row_mask:0xf bank_mask:0xf
v_and_b32_dpp v71, v80, v11 row_newbcast:9 row_mask:0xf bank_mask:0xf
v_and_b32_dpp v72, v80, v8 row_newbcast:13 row_mask:0xf bank_mask:0xf
v_and_b32_dpp v73, v80, v9 row_newbcast:13 row_mask:0xf bank_mask:0xf
v_and_b32_dpp v74, v80, v10 row_newbcast:13 row_mask:0xf bank_mask:0xf
v_and_b32_dpp v75, v80, v11 row_newbcast:13 row_mask:0xf bank_mask:0xf
s_waitcnt vmcnt(28)
v_mfma_f32_16x16x32_bf16 v[20:23], v[60:63], v[200:203], v[20:23]
v_mfma_f32_16x16x32_bf16 v[20:23], v[64:67], v[204:207], v[20:23]
v_mfma_f32_16x16x32_bf16 v[20:23], v[68:71], v[208:211], v[20:23]
v_mfma_f32_16x16x32_bf16 v[20:23], v[72:75], v[212:215], v[20:23]
buffer_load_dwordx4 v[200:203], v2, s[52:55], s12 offen offset:0 nt
buffer_load_dwordx4 v[204:207], v2, s[52:55], s12 offen offset:1024 nt
buffer_load_dwordx4 v[208:211], v2, s[52:55], s12 offen offset:2048 nt
buffer_load_dwordx4 v[212:215], v2, s[52:55], s12 offen offset:3072 nt
s_add_u32 s13, s13, 24576
s_min_u32 s12, s13, 2146435072
ds_read_b64_tr_b16 a[144:145], v88 offset:24
ds_read_b64_tr_b16 a[146:147], v88 offset:4632
ds_read_b64_tr_b16 a[148:149], v88 offset:36888
ds_read_b64_tr_b16 a[150:151], v88 offset:41496
v_and_b32_dpp v60, v76, v8 row_newbcast:3 row_mask:0xf bank_mask:0xf
v_and_b32_dpp v61, v76, v9 row_newbcast:3 row_mask:0xf bank_mask:0xf
v_and_b32_dpp v62, v76, v10 row_newbcast:3 row_mask:0xf bank_mask:0xf
v_and_b32_dpp v63, v76, v11 row_newbcast:3 row_mask:0xf bank_mask:0xf
v_and_b32_dpp v64, v76, v8 row_newbcast:7 row_mask:0xf bank_mask:0xf
v_and_b32_dpp v65, v76, v9 row_newbcast:7 row_mask:0xf bank_mask:0xf
v_and_b32_dpp v66, v76, v10 row_newbcast:7 row_mask:0xf bank_mask:0xf
v_and_b32_dpp v67, v76, v11 row_newbcast:7 row_mask:0xf bank_mask:0xf
v_and_b32_dpp v68, v76, v8 row_newbcast:11 row_mask:0xf bank_mask:0xf
v_and_b32_dpp v69, v76, v9 row_newbcast:11 row_mask:0xf bank_mask:0xf
v_and_b32_dpp v70, v76, v10 row_newbcast:11 row_mask:0xf bank_mask:0xf
v_and_b32_dpp v71, v76, v11 row_newbcast:11 row_mask:0xf bank_mask:0xf
v_and_b32_dpp v72, v76, v8 row_newbcast:15 row_mask:0xf bank_mask:0xf
v_and_b32_dpp v73, v76, v9 row_newbcast:15 row_mask:0xf bank_mask:0xf
v_and_b32_dpp v74, v76, v10 row_newbcast:15 row_mask:0xf bank_mask:0xf
v_and_b32_dpp v75, v76, v11 row_newbcast:15 row_mask:0xf bank_mask:0xf
v_mfma_f32_16x16x32_bf16 v[20:23], v[60:63], a[32:35], v[20:23]
v_mfma_f32_16x16x32_bf16 v[20:23], v[64:67], a[36:39], v[20:23]
v_mfma_f32_16x16x32_bf16 v[20:23], v[68:71], a[40:43], v[20:23]
v_mfma_f32_16x16x32_bf16 v[20:23], v[72:75], a[44:47], v[20:23]
s_nop 3
v_and_b32_dpp v60, v80, v8 row_newbcast:2 row_mask:0xf bank_mask:0xf
v_and_b32_dpp v61, v80, v9 row_newbcast:2 row_mask:0xf bank_mask:0xf
v_and_b32_dpp v62, v80, v10 row_newbcast:2 row_mask:0xf bank_mask:0xf
v_and_b32_dpp v63, v80, v11 row_newbcast:2 row_mask:0xf bank_mask:0xf
v_and_b32_dpp v64, v80, v8 row_newbcast:6 row_mask:0xf bank_mask:0xf
v_and_b32_dpp v65, v80, v9 row_newbcast:6 row_mask:0xf bank_mask:0xf
v_and_b32_dpp v66, v80, v10 row_newbcast:6 row_mask:0xf bank_mask:0xf
v_and_b32_dpp v67, v80, v11 row_newbcast:6 row_mask:0xf bank_mask:0xf
v_and_b32_dpp v68, v80, v8 row_newbcast:10 row_mask:0xf bank_mask:0xf
v_and_b32_dpp v69, v80, v9 row_newbcast:10 row_mask:0xf bank_mask:0xf
v_and_b32_dpp v70, v80, v10 row_newbcast:10 row_mask:0xf bank_mask:0xf
v_and_b32_dpp v71, v80, v11 row_newbcast:10 row_mask:0xf bank_mask:0xf
v_and_b32_dpp v72, v80, v8 row_newbcast:14 row_mask:0xf bank_mask:0xf
v_and_b32_dpp v73, v80, v9 row_newbcast:14 row_mask:0xf bank_mask:0xf
v_and_b32_dpp v74, v80, v10 row_newbcast:14 row_mask:0xf bank_mask:0xf
v_and_b32_dpp v75, v80, v11 row_newbcast:14 row_mask:0xf bank_mask:0xf
s_waitcnt vmcnt(28)
v_mfma_f32_16x16x32_bf16 v[20:23], v[60:63], v[216:219], v[20:23]
v_mfma_f32_16x16x32_bf16 v[20:23], v[64:67], v[220:223], v[20:23]
v_mfma_f32_16x16x32_bf16 v[20:23], v[68:71], v[224:227], v[20:23]
v_mfma_f32_16x16x32_bf16 v[20:23], v[72:75], v[228:231], v[20:23]
buffer_load_dwordx4 v[216:219], v2, s[52:55], s12 offen offset:0 nt
buffer_load_dwordx4 v[220:223], v2, s[52:55], s12 offen offset:1024 nt
buffer_load_dwordx4 v[224:227], v2, s[52:55], s12 offen offset:2048 nt
buffer_load_dwordx4 v[228:231], v2, s[52:55], s12 offen offset:3072 nt
s_add_u32 s13, s13, 24576
s_min_u32 s12, s13, 2146435072
ds_read_b64_tr_b16 a[152:153], v90 offset:24
ds_read_b64_tr_b16 a[154:155], v90 offset:4632
ds_read_b64_tr_b16 a[156:157], v90 offset:36888
ds_read_b64_tr_b16 a[158:159], v90 offset:41496
v_and_b32_dpp v60, v80, v8 row_newbcast:3 row_mask:0xf bank_mask:0xf
v_and_b32_dpp v61, v80, v9 row_newbcast:3 row_mask:0xf bank_mask:0xf
v_and_b32_dpp v62, v80, v10 row_newbcast:3 row_mask:0xf bank_mask:0xf
v_and_b32_dpp v63, v80, v11 row_newbcast:3 row_mask:0xf bank_mask:0xf
v_and_b32_dpp v64, v80, v8 row_newbcast:7 row_mask:0xf bank_mask:0xf
v_and_b32_dpp v65, v80, v9 row_newbcast:7 row_mask:0xf bank_mask:0xf
v_and_b32_dpp v66, v80, v10 row_newbcast:7 row_mask:0xf bank_mask:0xf
v_and_b32_dpp v67, v80, v11 row_newbcast:7 row_mask:0xf bank_mask:0xf
v_and_b32_dpp v68, v80, v8 row_newbcast:11 row_mask:0xf bank_mask:0xf
v_and_b32_dpp v69, v80, v9 row_newbcast:11 row_mask:0xf bank_mask:0xf
v_and_b32_dpp v70, v80, v10 row_newbcast:11 row_mask:0xf bank_mask:0xf
v_and_b32_dpp v71, v80, v11 row_newbcast:11 row_mask:0xf bank_mask:0xf
v_and_b32_dpp v72, v80, v8 row_newbcast:15 row_mask:0xf bank_mask:0xf
v_and_b32_dpp v73, v80, v9 row_newbcast:15 row_mask:0xf bank_mask:0xf
v_and_b32_dpp v74, v80, v10 row_newbcast:15 row_mask:0xf bank_mask:0xf
v_and_b32_dpp v75, v80, v11 row_newbcast:15 row_mask:0xf bank_mask:0xf
s_waitcnt vmcnt(28)
v_mfma_f32_16x16x32_bf16 v[20:23], v[60:63], v[232:235], v[20:23]
v_mfma_f32_16x16x32_bf16 v[20:23], v[64:67], v[236:239], v[20:23]
v_mfma_f32_16x16x32_bf16 v[20:23], v[68:71], v[240:243], v[20:23]
v_mfma_f32_16x16x32_bf16 v[20:23], v[72:75], v[244:247], v[20:23]
buffer_load_dwordx4 v[232:235], v2, s[52:55], s12 offen offset:0 nt
buffer_load_dwordx4 v[236:239], v2, s[52:55], s12 offen offset:1024 nt
buffer_load_dwordx4 v[240:243], v2, s[52:55], s12 offen offset:2048 nt
buffer_load_dwordx4 v[244:247], v2, s[52:55], s12 offen offset:3072 nt
s_add_u32 s13, s13, 24576
s_min_u32 s12, s13, 2146435072
ds_read_b64_tr_b16 a[160:161], v88 offset:128
ds_read_b64_tr_b16 a[162:163], v88 offset:4736
ds_read_b64_tr_b16 a[164:165], v88 offset:36992
ds_read_b64_tr_b16 a[166:167], v88 offset:41600
v_and_b32_dpp v60, v81, v8 row_newbcast:0 row_mask:0xf bank_mask:0xf
v_and_b32_dpp v61, v81, v9 row_newbcast:0 row_mask:0xf bank_mask:0xf
v_and_b32_dpp v62, v81, v10 row_newbcast:0 row_mask:0xf bank_mask:0xf
v_and_b32_dpp v63, v81, v11 row_newbcast:0 row_mask:0xf bank_mask:0xf
v_and_b32_dpp v64, v81, v8 row_newbcast:4 row_mask:0xf bank_mask:0xf
v_and_b32_dpp v65, v81, v9 row_newbcast:4 row_mask:0xf bank_mask:0xf
v_and_b32_dpp v66, v81, v10 row_newbcast:4 row_mask:0xf bank_mask:0xf
v_and_b32_dpp v67, v81, v11 row_newbcast:4 row_mask:0xf bank_mask:0xf
v_and_b32_dpp v68, v81, v8 row_newbcast:8 row_mask:0xf bank_mask:0xf
v_and_b32_dpp v69, v81, v9 row_newbcast:8 row_mask:0xf bank_mask:0xf
v_and_b32_dpp v70, v81, v10 row_newbcast:8 row_mask:0xf bank_mask:0xf
v_and_b32_dpp v71, v81, v11 row_newbcast:8 row_mask:0xf bank_mask:0xf
v_and_b32_dpp v72, v81, v8 row_newbcast:12 row_mask:0xf bank_mask:0xf
v_and_b32_dpp v73, v81, v9 row_newbcast:12 row_mask:0xf bank_mask:0xf
v_and_b32_dpp v74, v81, v10 row_newbcast:12 row_mask:0xf bank_mask:0xf
v_and_b32_dpp v75, v81, v11 row_newbcast:12 row_mask:0xf bank_mask:0xf
s_waitcnt vmcnt(28)
v_mfma_f32_16x16x32_bf16 v[20:23], v[60:63], v[120:123], v[20:23]
v_mfma_f32_16x16x32_bf16 v[20:23], v[64:67], v[124:127], v[20:23]
v_mfma_f32_16x16x32_bf16 v[20:23], v[68:71], v[128:131], v[20:23]
v_mfma_f32_16x16x32_bf16 v[20:23], v[72:75], v[132:135], v[20:23]
buffer_load_dwordx4 v[120:123], v2, s[52:55], s12 offen offset:0 nt
buffer_load_dwordx4 v[124:127], v2, s[52:55], s12 offen offset:1024 nt
buffer_load_dwordx4 v[128:131], v2, s[52:55], s12 offen offset:2048 nt
buffer_load_dwordx4 v[132:135], v2, s[52:55], s12 offen offset:3072 nt
s_add_u32 s13, s13, 24576
s_min_u32 s12, s13, 2146435072
ds_read_b64_tr_b16 a[168:169], v90 offset:128
ds_read_b64_tr_b16 a[170:171], v90 offset:4736
ds_read_b64_tr_b16 a[172:173], v90 offset:36992
ds_read_b64_tr_b16 a[174:175], v90 offset:41600
v_and_b32_dpp v60, v81, v8 row_newbcast:1 row_mask:0xf bank_mask:0xf
v_and_b32_dpp v61, v81, v9 row_newbcast:1 row_mask:0xf bank_mask:0xf
v_and_b32_dpp v62, v81, v10 row_newbcast:1 row_mask:0xf bank_mask:0xf
v_and_b32_dpp v63, v81, v11 row_newbcast:1 row_mask:0xf bank_mask:0xf
v_and_b32_dpp v64, v81, v8 row_newbcast:5 row_mask:0xf bank_mask:0xf
v_and_b32_dpp v65, v81, v9 row_newbcast:5 row_mask:0xf bank_mask:0xf
v_and_b32_dpp v66, v81, v10 row_newbcast:5 row_mask:0xf bank_mask:0xf
v_and_b32_dpp v67, v81, v11 row_newbcast:5 row_mask:0xf bank_mask:0xf
v_and_b32_dpp v68, v81, v8 row_newbcast:9 row_mask:0xf bank_mask:0xf
v_and_b32_dpp v69, v81, v9 row_newbcast:9 row_mask:0xf bank_mask:0xf
v_and_b32_dpp v70, v81, v10 row_newbcast:9 row_mask:0xf bank_mask:0xf
v_and_b32_dpp v71, v81, v11 row_newbcast:9 row_mask:0xf bank_mask:0xf
v_and_b32_dpp v72, v81, v8 row_newbcast:13 row_mask:0xf bank_mask:0xf
v_and_b32_dpp v73, v81, v9 row_newbcast:13 row_mask:0xf bank_mask:0xf
v_and_b32_dpp v74, v81, v10 row_newbcast:13 row_mask:0xf bank_mask:0xf
v_and_b32_dpp v75, v81, v11 row_newbcast:13 row_mask:0xf bank_mask:0xf
s_waitcnt vmcnt(28)
v_mfma_f32_16x16x32_bf16 v[20:23], v[60:63], v[136:139], v[20:23]
v_mfma_f32_16x16x32_bf16 v[20:23], v[64:67], v[140:143], v[20:23]
v_mfma_f32_16x16x32_bf16 v[20:23], v[68:71], v[144:147], v[20:23]
v_mfma_f32_16x16x32_bf16 v[20:23], v[72:75], v[148:151], v[20:23]
buffer_load_dwordx4 v[136:139], v2, s[52:55], s12 offen offset:0 nt
buffer_load_dwordx4 v[140:143], v2, s[52:55], s12 offen offset:1024 nt
buffer_load_dwordx4 v[144:147], v2, s[52:55], s12 offen offset:2048 nt
buffer_load_dwordx4 v[148:151], v2, s[52:55], s12 offen offset:3072 nt
s_add_u32 s13, s13, 24576
s_min_u32 s12, s13, 2146435072
ds_read_b64_tr_b16 a[176:177], v88 offset:136
ds_read_b64_tr_b16 a[178:179], v88 offset:4744
ds_read_b64_tr_b16 a[180:181], v88 offset:37000
ds_read_b64_tr_b16 a[182:183], v88 offset:41608
v_and_b32_dpp v60, v77, v8 row_newbcast:0 row_mask:0xf bank_mask:0xf
v_and_b32_dpp v61, v77, v9 row_newbcast:0 row_mask:0xf bank_mask:0xf
v_and_b32_dpp v62, v77, v10 row_newbcast:0 row_mask:0xf bank_mask:0xf
v_and_b32_dpp v63, v77, v11 row_newbcast:0 row_mask:0xf bank_mask:0xf
v_and_b32_dpp v64, v77, v8 row_newbcast:4 row_mask:0xf bank_mask:0xf
v_and_b32_dpp v65, v77, v9 row_newbcast:4 row_mask:0xf bank_mask:0xf
v_and_b32_dpp v66, v77, v10 row_newbcast:4 row_mask:0xf bank_mask:0xf
v_and_b32_dpp v67, v77, v11 row_newbcast:4 row_mask:0xf bank_mask:0xf
v_and_b32_dpp v68, v77, v8 row_newbcast:8 row_mask:0xf bank_mask:0xf
v_and_b32_dpp v69, v77, v9 row_newbcast:8 row_mask:0xf bank_mask:0xf
v_and_b32_dpp v70, v77, v10 row_newbcast:8 row_mask:0xf bank_mask:0xf
v_and_b32_dpp v71, v77, v11 row_newbcast:8 row_mask:0xf bank_mask:0xf
v_and_b32_dpp v72, v77, v8 row_newbcast:12 row_mask:0xf bank_mask:0xf
v_and_b32_dpp v73, v77, v9 row_newbcast:12 row_mask:0xf bank_mask:0xf
v_and_b32_dpp v74, v77, v10 row_newbcast:12 row_mask:0xf bank_mask:0xf
v_and_b32_dpp v75, v77, v11 row_newbcast:12 row_mask:0xf bank_mask:0xf
v_mfma_f32_16x16x32_bf16 v[20:23], v[60:63], a[48:51], v[20:23]
v_mfma_f32_16x16x32_bf16 v[20:23], v[64:67], a[52:55], v[20:23]
v_mfma_f32_16x16x32_bf16 v[20:23], v[68:71], a[56:59], v[20:23]
v_mfma_f32_16x16x32_bf16 v[20:23], v[72:75], a[60:63], v[20:23]
s_nop 3
v_and_b32_dpp v60, v81, v8 row_newbcast:2 row_mask:0xf bank_mask:0xf
v_and_b32_dpp v61, v81, v9 row_newbcast:2 row_mask:0xf bank_mask:0xf
v_and_b32_dpp v62, v81, v10 row_newbcast:2 row_mask:0xf bank_mask:0xf
v_and_b32_dpp v63, v81, v11 row_newbcast:2 row_mask:0xf bank_mask:0xf
v_and_b32_dpp v64, v81, v8 row_newbcast:6 row_mask:0xf bank_mask:0xf
v_and_b32_dpp v65, v81, v9 row_newbcast:6 row_mask:0xf bank_mask:0xf
v_and_b32_dpp v66, v81, v10 row_newbcast:6 row_mask:0xf bank_mask:0xf
v_and_b32_dpp v67, v81, v11 row_newbcast:6 row_mask:0xf bank_mask:0xf
v_and_b32_dpp v68, v81, v8 row_newbcast:10 row_mask:0xf bank_mask:0xf
v_and_b32_dpp v69, v81, v9 row_newbcast:10 row_mask:0xf bank_mask:0xf
v_and_b32_dpp v70, v81, v10 row_newbcast:10 row_mask:0xf bank_mask:0xf
v_and_b32_dpp v71, v81, v11 row_newbcast:10 row_mask:0xf bank_mask:0xf
v_and_b32_dpp v72, v81, v8 row_newbcast:14 row_mask:0xf bank_mask:0xf
v_and_b32_dpp v73, v81, v9 row_newbcast:14 row_mask:0xf bank_mask:0xf
v_and_b32_dpp v74, v81, v10 row_newbcast:14 row_mask:0xf bank_mask:0xf
v_and_b32_dpp v75, v81, v11 row_newbcast:14 row_mask:0xf bank_mask:0xf
s_waitcnt vmcnt(28)
v_mfma_f32_16x16x32_bf16 v[20:23], v[60:63], v[152:155], v[20:23]
v_mfma_f32_16x16x32_bf16 v[20:23], v[64:67], v[156:159], v[20:23]
v_mfma_f32_16x16x32_bf16 v[20:23], v[68:71], v[160:163], v[20:23]
v_mfma_f32_16x16x32_bf16 v[20:23], v[72:75], v[164:167], v[20:23]
buffer_load_dwordx4 v[152:155], v2, s[52:55], s12 offen offset:0 nt
buffer_load_dwordx4 v[156:159], v2, s[52:55], s12 offen offset:1024 nt
buffer_load_dwordx4 v[160:163], v2, s[52:55], s12 offen offset:2048 nt
buffer_load_dwordx4 v[164:167], v2, s[52:55], s12 offen offset:3072 nt
s_add_u32 s13, s13, 24576
s_min_u32 s12, s13, 2146435072
ds_read_b64_tr_b16 a[184:185], v90 offset:136
ds_read_b64_tr_b16 a[186:187], v90 offset:4744
ds_read_b64_tr_b16 a[188:189], v90 offset:37000
ds_read_b64_tr_b16 a[190:191], v90 offset:41608
v_and_b32_dpp v60, v81, v8 row_newbcast:3 row_mask:0xf bank_mask:0xf
v_and_b32_dpp v61, v81, v9 row_newbcast:3 row_mask:0xf bank_mask:0xf
v_and_b32_dpp v62, v81, v10 row_newbcast:3 row_mask:0xf bank_mask:0xf
v_and_b32_dpp v63, v81, v11 row_newbcast:3 row_mask:0xf bank_mask:0xf
v_and_b32_dpp v64, v81, v8 row_newbcast:7 row_mask:0xf bank_mask:0xf
v_and_b32_dpp v65, v81, v9 row_newbcast:7 row_mask:0xf bank_mask:0xf
v_and_b32_dpp v66, v81, v10 row_newbcast:7 row_mask:0xf bank_mask:0xf
v_and_b32_dpp v67, v81, v11 row_newbcast:7 row_mask:0xf bank_mask:0xf
v_and_b32_dpp v68, v81, v8 row_newbcast:11 row_mask:0xf bank_mask:0xf
v_and_b32_dpp v69, v81, v9 row_newbcast:11 row_mask:0xf bank_mask:0xf
v_and_b32_dpp v70, v81, v10 row_newbcast:11 row_mask:0xf bank_mask:0xf
v_and_b32_dpp v71, v81, v11 row_newbcast:11 row_mask:0xf bank_mask:0xf
v_and_b32_dpp v72, v81, v8 row_newbcast:15 row_mask:0xf bank_mask:0xf
v_and_b32_dpp v73, v81, v9 row_newbcast:15 row_mask:0xf bank_mask:0xf
v_and_b32_dpp v74, v81, v10 row_newbcast:15 row_mask:0xf bank_mask:0xf
v_and_b32_dpp v75, v81, v11 row_newbcast:15 row_mask:0xf bank_mask:0xf
s_waitcnt vmcnt(28)
v_mfma_f32_16x16x32_bf16 v[20:23], v[60:63], v[168:171], v[20:23]
v_mfma_f32_16x16x32_bf16 v[20:23], v[64:67], v[172:175], v[20:23]
v_mfma_f32_16x16x32_bf16 v[20:23], v[68:71], v[176:179], v[20:23]
v_mfma_f32_16x16x32_bf16 v[20:23], v[72:75], v[180:183], v[20:23]
buffer_load_dwordx4 v[168:171], v2, s[52:55], s12 offen offset:0 nt
buffer_load_dwordx4 v[172:175], v2, s[52:55], s12 offen offset:1024 nt
buffer_load_dwordx4 v[176:179], v2, s[52:55], s12 offen offset:2048 nt
buffer_load_dwordx4 v[180:183], v2, s[52:55], s12 offen offset:3072 nt
s_add_u32 s13, s13, 24576
s_min_u32 s12, s13, 2146435072
ds_read_b64_tr_b16 a[192:193], v88 offset:144
ds_read_b64_tr_b16 a[194:195], v88 offset:4752
ds_read_b64_tr_b16 a[196:197], v88 offset:37008
ds_read_b64_tr_b16 a[198:199], v88 offset:41616
v_and_b32_dpp v60, v82, v8 row_newbcast:0 row_mask:0xf bank_mask:0xf
v_and_b32_dpp v61, v82, v9 row_newbcast:0 row_mask:0xf bank_mask:0xf
v_and_b32_dpp v62, v82, v10 row_newbcast:0 row_mask:0xf bank_mask:0xf
v_and_b32_dpp v63, v82, v11 row_newbcast:0 row_mask:0xf bank_mask:0xf
v_and_b32_dpp v64, v82, v8 row_newbcast:4 row_mask:0xf bank_mask:0xf
v_and_b32_dpp v65, v82, v9 row_newbcast:4 row_mask:0xf bank_mask:0xf
v_and_b32_dpp v66, v82, v10 row_newbcast:4 row_mask:0xf bank_mask:0xf
v_and_b32_dpp v67, v82, v11 row_newbcast:4 row_mask:0xf bank_mask:0xf
v_and_b32_dpp v68, v82, v8 row_newbcast:8 row_mask:0xf bank_mask:0xf
v_and_b32_dpp v69, v82, v9 row_newbcast:8 row_mask:0xf bank_mask:0xf
v_and_b32_dpp v70, v82, v10 row_newbcast:8 row_mask:0xf bank_mask:0xf
v_and_b32_dpp v71, v82, v11 row_newbcast:8 row_mask:0xf bank_mask:0xf
v_and_b32_dpp v72, v82, v8 row_newbcast:12 row_mask:0xf bank_mask:0xf
v_and_b32_dpp v73, v82, v9 row_newbcast:12 row_mask:0xf bank_mask:0xf
v_and_b32_dpp v74, v82, v10 row_newbcast:12 row_mask:0xf bank_mask:0xf
v_and_b32_dpp v75, v82, v11 row_newbcast:12 row_mask:0xf bank_mask:0xf
s_waitcnt vmcnt(28)
v_mfma_f32_16x16x32_bf16 v[20:23], v[60:63], v[184:187], v[20:23]
v_mfma_f32_16x16x32_bf16 v[20:23], v[64:67], v[188:191], v[20:23]
v_mfma_f32_16x16x32_bf16 v[20:23], v[68:71], v[192:195], v[20:23]
v_mfma_f32_16x16x32_bf16 v[20:23], v[72:75], v[196:199], v[20:23]
buffer_load_dwordx4 v[184:187], v2, s[52:55], s12 offen offset:0 nt
buffer_load_dwordx4 v[188:191], v2, s[52:55], s12 offen offset:1024 nt
buffer_load_dwordx4 v[192:195], v2, s[52:55], s12 offen offset:2048 nt
buffer_load_dwordx4 v[196:199], v2, s[52:55], s12 offen offset:3072 nt
s_add_u32 s13, s13, 24576
s_min_u32 s12, s13, 2146435072
ds_read_b64_tr_b16 a[200:201], v90 offset:144
ds_read_b64_tr_b16 a[202:203], v90 offset:4752
ds_read_b64_tr_b16 a[204:205], v90 offset:37008
ds_read_b64_tr_b16 a[206:207], v90 offset:41616
v_and_b32_dpp v60, v82, v8 row_newbcast:1 row_mask:0xf bank_mask:0xf
v_and_b32_dpp v61, v82, v9 row_newbcast:1 row_mask:0xf bank_mask:0xf
v_and_b32_dpp v62, v82, v10 row_newbcast:1 row_mask:0xf bank_mask:0xf
v_and_b32_dpp v63, v82, v11 row_newbcast:1 row_mask:0xf bank_mask:0xf
v_and_b32_dpp v64, v82, v8 row_newbcast:5 row_mask:0xf bank_mask:0xf
v_and_b32_dpp v65, v82, v9 row_newbcast:5 row_mask:0xf bank_mask:0xf
v_and_b32_dpp v66, v82, v10 row_newbcast:5 row_mask:0xf bank_mask:0xf
v_and_b32_dpp v67, v82, v11 row_newbcast:5 row_mask:0xf bank_mask:0xf
v_and_b32_dpp v68, v82, v8 row_newbcast:9 row_mask:0xf bank_mask:0xf
v_and_b32_dpp v69, v82, v9 row_newbcast:9 row_mask:0xf bank_mask:0xf
v_and_b32_dpp v70, v82, v10 row_newbcast:9 row_mask:0xf bank_mask:0xf
v_and_b32_dpp v71, v82, v11 row_newbcast:9 row_mask:0xf bank_mask:0xf
v_and_b32_dpp v72, v82, v8 row_newbcast:13 row_mask:0xf bank_mask:0xf
v_and_b32_dpp v73, v82, v9 row_newbcast:13 row_mask:0xf bank_mask:0xf
v_and_b32_dpp v74, v82, v10 row_newbcast:13 row_mask:0xf bank_mask:0xf
v_and_b32_dpp v75, v82, v11 row_newbcast:13 row_mask:0xf bank_mask:0xf
s_waitcnt vmcnt(28)
v_mfma_f32_16x16x32_bf16 v[20:23], v[60:63], v[200:203], v[20:23]
v_mfma_f32_16x16x32_bf16 v[20:23], v[64:67], v[204:207], v[20:23]
v_mfma_f32_16x16x32_bf16 v[20:23], v[68:71], v[208:211], v[20:23]
v_mfma_f32_16x16x32_bf16 v[20:23], v[72:75], v[212:215], v[20:23]
buffer_load_dwordx4 v[200:203], v2, s[52:55], s12 offen offset:0 nt
buffer_load_dwordx4 v[204:207], v2, s[52:55], s12 offen offset:1024 nt
buffer_load_dwordx4 v[208:211], v2, s[52:55], s12 offen offset:2048 nt
buffer_load_dwordx4 v[212:215], v2, s[52:55], s12 offen offset:3072 nt
s_add_u32 s13, s13, 24576
s_min_u32 s12, s13, 2146435072
ds_read_b64_tr_b16 a[208:209], v88 offset:152
ds_read_b64_tr_b16 a[210:211], v88 offset:4760
ds_read_b64_tr_b16 a[212:213], v88 offset:37016
ds_read_b64_tr_b16 a[214:215], v88 offset:41624
v_and_b32_dpp v60, v77, v8 row_newbcast:1 row_mask:0xf bank_mask:0xf
v_and_b32_dpp v61, v77, v9 row_newbcast:1 row_mask:0xf bank_mask:0xf
v_and_b32_dpp v62, v77, v10 row_newbcast:1 row_mask:0xf bank_mask:0xf
v_and_b32_dpp v63, v77, v11 row_newbcast:1 row_mask:0xf bank_mask:0xf
v_and_b32_dpp v64, v77, v8 row_newbcast:5 row_mask:0xf bank_mask:0xf
v_and_b32_dpp v65, v77, v9 row_newbcast:5 row_mask:0xf bank_mask:0xf
v_and_b32_dpp v66, v77, v10 row_newbcast:5 row_mask:0xf bank_mask:0xf
v_and_b32_dpp v67, v77, v11 row_newbcast:5 row_mask:0xf bank_mask:0xf
v_and_b32_dpp v68, v77, v8 row_newbcast:9 row_mask:0xf bank_mask:0xf
v_and_b32_dpp v69, v77, v9 row_newbcast:9 row_mask:0xf bank_mask:0xf
v_and_b32_dpp v70, v77, v10 row_newbcast:9 row_mask:0xf bank_mask:0xf
v_and_b32_dpp v71, v77, v11 row_newbcast:9 row_mask:0xf bank_mask:0xf
v_and_b32_dpp v72, v77, v8 row_newbcast:13 row_mask:0xf bank_mask:0xf
v_and_b32_dpp v73, v77, v9 row_newbcast:13 row_mask:0xf bank_mask:0xf
v_and_b32_dpp v74, v77, v10 row_newbcast:13 row_mask:0xf bank_mask:0xf
v_and_b32_dpp v75, v77, v11 row_newbcast:13 row_mask:0xf bank_mask:0xf
v_mfma_f32_16x16x32_bf16 v[20:23], v[60:63], a[64:67], v[20:23]
v_mfma_f32_16x16x32_bf16 v[20:23], v[64:67], a[68:71], v[20:23]
v_mfma_f32_16x16x32_bf16 v[20:23], v[68:71], a[72:75], v[20:23]
v_mfma_f32_16x16x32_bf16 v[20:23], v[72:75], a[76:79], v[20:23]
s_nop 3
v_and_b32_dpp v60, v82, v8 row_newbcast:2 row_mask:0xf bank_mask:0xf
v_and_b32_dpp v61, v82, v9 row_newbcast:2 row_mask:0xf bank_mask:0xf
v_and_b32_dpp v62, v82, v10 row_newbcast:2 row_mask:0xf bank_mask:0xf
v_and_b32_dpp v63, v82, v11 row_newbcast:2 row_mask:0xf bank_mask:0xf
v_and_b32_dpp v64, v82, v8 row_newbcast:6 row_mask:0xf bank_mask:0xf
v_and_b32_dpp v65, v82, v9 row_newbcast:6 row_mask:0xf bank_mask:0xf
v_and_b32_dpp v66, v82, v10 row_newbcast:6 row_mask:0xf bank_mask:0xf
v_and_b32_dpp v67, v82, v11 row_newbcast:6 row_mask:0xf bank_mask:0xf
v_and_b32_dpp v68, v82, v8 row_newbcast:10 row_mask:0xf bank_mask:0xf
v_and_b32_dpp v69, v82, v9 row_newbcast:10 row_mask:0xf bank_mask:0xf
v_and_b32_dpp v70, v82, v10 row_newbcast:10 row_mask:0xf bank_mask:0xf
v_and_b32_dpp v71, v82, v11 row_newbcast:10 row_mask:0xf bank_mask:0xf
v_and_b32_dpp v72, v82, v8 row_newbcast:14 row_mask:0xf bank_mask:0xf
v_and_b32_dpp v73, v82, v9 row_newbcast:14 row_mask:0xf bank_mask:0xf
v_and_b32_dpp v74, v82, v10 row_newbcast:14 row_mask:0xf bank_mask:0xf
v_and_b32_dpp v75, v82, v11 row_newbcast:14 row_mask:0xf bank_mask:0xf
s_waitcnt vmcnt(28)
v_mfma_f32_16x16x32_bf16 v[20:23], v[60:63], v[216:219], v[20:23]
v_mfma_f32_16x16x32_bf16 v[20:23], v[64:67], v[220:223], v[20:23]
v_mfma_f32_16x16x32_bf16 v[20:23], v[68:71], v[224:227], v[20:23]
v_mfma_f32_16x16x32_bf16 v[20:23], v[72:75], v[228:231], v[20:23]
buffer_load_dwordx4 v[216:219], v2, s[52:55], s12 offen offset:0 nt
buffer_load_dwordx4 v[220:223], v2, s[52:55], s12 offen offset:1024 nt
buffer_load_dwordx4 v[224:227], v2, s[52:55], s12 offen offset:2048 nt
buffer_load_dwordx4 v[228:231], v2, s[52:55], s12 offen offset:3072 nt
s_add_u32 s13, s13, 24576
s_min_u32 s12, s13, 2146435072
ds_read_b64_tr_b16 a[216:217], v90 offset:152
ds_read_b64_tr_b16 a[218:219], v90 offset:4760
ds_read_b64_tr_b16 a[220:221], v90 offset:37016
ds_read_b64_tr_b16 a[222:223], v90 offset:41624
v_and_b32_dpp v60, v82, v8 row_newbcast:3 row_mask:0xf bank_mask:0xf
v_and_b32_dpp v61, v82, v9 row_newbcast:3 row_mask:0xf bank_mask:0xf
v_and_b32_dpp v62, v82, v10 row_newbcast:3 row_mask:0xf bank_mask:0xf
v_and_b32_dpp v63, v82, v11 row_newbcast:3 row_mask:0xf bank_mask:0xf
v_and_b32_dpp v64, v82, v8 row_newbcast:7 row_mask:0xf bank_mask:0xf
v_and_b32_dpp v65, v82, v9 row_newbcast:7 row_mask:0xf bank_mask:0xf
v_and_b32_dpp v66, v82, v10 row_newbcast:7 row_mask:0xf bank_mask:0xf
v_and_b32_dpp v67, v82, v11 row_newbcast:7 row_mask:0xf bank_mask:0xf
v_and_b32_dpp v68, v82, v8 row_newbcast:11 row_mask:0xf bank_mask:0xf
v_and_b32_dpp v69, v82, v9 row_newbcast:11 row_mask:0xf bank_mask:0xf
v_and_b32_dpp v70, v82, v10 row_newbcast:11 row_mask:0xf bank_mask:0xf
v_and_b32_dpp v71, v82, v11 row_newbcast:11 row_mask:0xf bank_mask:0xf
v_and_b32_dpp v72, v82, v8 row_newbcast:15 row_mask:0xf bank_mask:0xf
v_and_b32_dpp v73, v82, v9 row_newbcast:15 row_mask:0xf bank_mask:0xf
v_and_b32_dpp v74, v82, v10 row_newbcast:15 row_mask:0xf bank_mask:0xf
v_and_b32_dpp v75, v82, v11 row_newbcast:15 row_mask:0xf bank_mask:0xf
s_waitcnt vmcnt(28)
v_mfma_f32_16x16x32_bf16 v[20:23], v[60:63], v[232:235], v[20:23]
v_mfma_f32_16x16x32_bf16 v[20:23], v[64:67], v[236:239], v[20:23]
v_mfma_f32_16x16x32_bf16 v[20:23], v[68:71], v[240:243], v[20:23]
v_mfma_f32_16x16x32_bf16 v[20:23], v[72:75], v[244:247], v[20:23]
buffer_load_dwordx4 v[232:235], v2, s[52:55], s12 offen offset:0 nt
buffer_load_dwordx4 v[236:239], v2, s[52:55], s12 offen offset:1024 nt
buffer_load_dwordx4 v[240:243], v2, s[52:55], s12 offen offset:2048 nt
buffer_load_dwordx4 v[244:247], v2, s[52:55], s12 offen offset:3072 nt
s_add_u32 s13, s13, 24576
s_min_u32 s12, s13, 2146435072
ds_read_b64_tr_b16 a[224:225], v89 offset:0
ds_read_b64_tr_b16 a[226:227], v89 offset:4608
ds_read_b64_tr_b16 a[228:229], v89 offset:36864
ds_read_b64_tr_b16 a[230:231], v89 offset:41472
buffer_load_dwordx4 v[40:43], off, s[64:67], s82 offset:0 sc1
buffer_load_dwordx4 v[44:47], off, s[64:67], s82 offset:16 sc1
buffer_load_dwordx4 v[48:51], off, s[64:67], s82 offset:32 sc1
v_and_b32_dpp v60, v83, v8 row_newbcast:0 row_mask:0xf bank_mask:0xf
v_and_b32_dpp v61, v83, v9 row_newbcast:0 row_mask:0xf bank_mask:0xf
v_and_b32_dpp v62, v83, v10 row_newbcast:0 row_mask:0xf bank_mask:0xf
v_and_b32_dpp v63, v83, v11 row_newbcast:0 row_mask:0xf bank_mask:0xf
v_and_b32_dpp v64, v83, v8 row_newbcast:4 row_mask:0xf bank_mask:0xf
v_and_b32_dpp v65, v83, v9 row_newbcast:4 row_mask:0xf bank_mask:0xf
v_and_b32_dpp v66, v83, v10 row_newbcast:4 row_mask:0xf bank_mask:0xf
v_and_b32_dpp v67, v83, v11 row_newbcast:4 row_mask:0xf bank_mask:0xf
v_and_b32_dpp v68, v83, v8 row_newbcast:8 row_mask:0xf bank_mask:0xf
v_and_b32_dpp v69, v83, v9 row_newbcast:8 row_mask:0xf bank_mask:0xf
v_and_b32_dpp v70, v83, v10 row_newbcast:8 row_mask:0xf bank_mask:0xf
v_and_b32_dpp v71, v83, v11 row_newbcast:8 row_mask:0xf bank_mask:0xf
v_and_b32_dpp v72, v83, v8 row_newbcast:12 row_mask:0xf bank_mask:0xf
v_and_b32_dpp v73, v83, v9 row_newbcast:12 row_mask:0xf bank_mask:0xf
v_and_b32_dpp v74, v83, v10 row_newbcast:12 row_mask:0xf bank_mask:0xf
v_and_b32_dpp v75, v83, v11 row_newbcast:12 row_mask:0xf bank_mask:0xf
s_waitcnt vmcnt(28)
v_mfma_f32_16x16x32_bf16 v[20:23], v[60:63], v[120:123], v[20:23]
v_mfma_f32_16x16x32_bf16 v[20:23], v[64:67], v[124:127], v[20:23]
v_mfma_f32_16x16x32_bf16 v[20:23], v[68:71], v[128:131], v[20:23]
v_mfma_f32_16x16x32_bf16 v[20:23], v[72:75], v[132:135], v[20:23]
buffer_load_dwordx4 v[120:123], v2, s[52:55], s12 offen offset:0 nt
buffer_load_dwordx4 v[124:127], v2, s[52:55], s12 offen offset:1024 nt
buffer_load_dwordx4 v[128:131], v2, s[52:55], s12 offen offset:2048 nt
buffer_load_dwordx4 v[132:135], v2, s[52:55], s12 offen offset:3072 nt
s_add_u32 s13, s13, 24576
s_min_u32 s12, s13, 2146435072
ds_read_b64_tr_b16 a[232:233], v91 offset:0
ds_read_b64_tr_b16 a[234:235], v91 offset:4608
ds_read_b64_tr_b16 a[236:237], v91 offset:36864
ds_read_b64_tr_b16 a[238:239], v91 offset:41472
v_and_b32_dpp v60, v83, v8 row_newbcast:1 row_mask:0xf bank_mask:0xf
v_and_b32_dpp v61, v83, v9 row_newbcast:1 row_mask:0xf bank_mask:0xf
v_and_b32_dpp v62, v83, v10 row_newbcast:1 row_mask:0xf bank_mask:0xf
v_and_b32_dpp v63, v83, v11 row_newbcast:1 row_mask:0xf bank_mask:0xf
v_and_b32_dpp v64, v83, v8 row_newbcast:5 row_mask:0xf bank_mask:0xf
v_and_b32_dpp v65, v83, v9 row_newbcast:5 row_mask:0xf bank_mask:0xf
v_and_b32_dpp v66, v83, v10 row_newbcast:5 row_mask:0xf bank_mask:0xf
v_and_b32_dpp v67, v83, v11 row_newbcast:5 row_mask:0xf bank_mask:0xf
v_and_b32_dpp v68, v83, v8 row_newbcast:9 row_mask:0xf bank_mask:0xf
v_and_b32_dpp v69, v83, v9 row_newbcast:9 row_mask:0xf bank_mask:0xf
v_and_b32_dpp v70, v83, v10 row_newbcast:9 row_mask:0xf bank_mask:0xf
v_and_b32_dpp v71, v83, v11 row_newbcast:9 row_mask:0xf bank_mask:0xf
v_and_b32_dpp v72, v83, v8 row_newbcast:13 row_mask:0xf bank_mask:0xf
v_and_b32_dpp v73, v83, v9 row_newbcast:13 row_mask:0xf bank_mask:0xf
v_and_b32_dpp v74, v83, v10 row_newbcast:13 row_mask:0xf bank_mask:0xf
v_and_b32_dpp v75, v83, v11 row_newbcast:13 row_mask:0xf bank_mask:0xf
s_waitcnt vmcnt(28)
v_mfma_f32_16x16x32_bf16 v[20:23], v[60:63], v[136:139], v[20:23]
v_mfma_f32_16x16x32_bf16 v[20:23], v[64:67], v[140:143], v[20:23]
v_mfma_f32_16x16x32_bf16 v[20:23], v[68:71], v[144:147], v[20:23]
v_mfma_f32_16x16x32_bf16 v[20:23], v[72:75], v[148:151], v[20:23]
buffer_load_dwordx4 v[136:139], v2, s[52:55], s12 offen offset:0 nt
buffer_load_dwordx4 v[140:143], v2, s[52:55], s12 offen offset:1024 nt
buffer_load_dwordx4 v[144:147], v2, s[52:55], s12 offen offset:2048 nt
buffer_load_dwordx4 v[148:151], v2, s[52:55], s12 offen offset:3072 nt
s_add_u32 s13, s13, 24576
s_min_u32 s12, s13, 2146435072
v_and_b32_dpp v60, v77, v8 row_newbcast:2 row_mask:0xf bank_mask:0xf
v_and_b32_dpp v61, v77, v9 row_newbcast:2 row_mask:0xf bank_mask:0xf
v_and_b32_dpp v62, v77, v10 row_newbcast:2 row_mask:0xf bank_mask:0xf
v_and_b32_dpp v63, v77, v11 row_newbcast:2 row_mask:0xf bank_mask:0xf
v_and_b32_dpp v64, v77, v8 row_newbcast:6 row_mask:0xf bank_mask:0xf
v_and_b32_dpp v65, v77, v9 row_newbcast:6 row_mask:0xf bank_mask:0xf
v_and_b32_dpp v66, v77, v10 row_newbcast:6 row_mask:0xf bank_mask:0xf
v_and_b32_dpp v67, v77, v11 row_newbcast:6 row_mask:0xf bank_mask:0xf
v_and_b32_dpp v68, v77, v8 row_newbcast:10 row_mask:0xf bank_mask:0xf
v_and_b32_dpp v69, v77, v9 row_newbcast:10 row_mask:0xf bank_mask:0xf
v_and_b32_dpp v70, v77, v10 row_newbcast:10 row_mask:0xf bank_mask:0xf
v_and_b32_dpp v71, v77, v11 row_newbcast:10 row_mask:0xf bank_mask:0xf
v_and_b32_dpp v72, v77, v8 row_newbcast:14 row_mask:0xf bank_mask:0xf
v_and_b32_dpp v73, v77, v9 row_newbcast:14 row_mask:0xf bank_mask:0xf
v_and_b32_dpp v74, v77, v10 row_newbcast:14 row_mask:0xf bank_mask:0xf
v_and_b32_dpp v75, v77, v11 row_newbcast:14 row_mask:0xf bank_mask:0xf
v_mfma_f32_16x16x32_bf16 v[20:23], v[60:63], a[80:83], v[20:23]
v_mfma_f32_16x16x32_bf16 v[20:23], v[64:67], a[84:87], v[20:23]
v_mfma_f32_16x16x32_bf16 v[20:23], v[68:71], a[88:91], v[20:23]
v_mfma_f32_16x16x32_bf16 v[20:23], v[72:75], a[92:95], v[20:23]
s_nop 3
v_and_b32_dpp v60, v83, v8 row_newbcast:2 row_mask:0xf bank_mask:0xf
v_and_b32_dpp v61, v83, v9 row_newbcast:2 row_mask:0xf bank_mask:0xf
v_and_b32_dpp v62, v83, v10 row_newbcast:2 row_mask:0xf bank_mask:0xf
v_and_b32_dpp v63, v83, v11 row_newbcast:2 row_mask:0xf bank_mask:0xf
v_and_b32_dpp v64, v83, v8 row_newbcast:6 row_mask:0xf bank_mask:0xf
v_and_b32_dpp v65, v83, v9 row_newbcast:6 row_mask:0xf bank_mask:0xf
v_and_b32_dpp v66, v83, v10 row_newbcast:6 row_mask:0xf bank_mask:0xf
v_and_b32_dpp v67, v83, v11 row_newbcast:6 row_mask:0xf bank_mask:0xf
v_and_b32_dpp v68, v83, v8 row_newbcast:10 row_mask:0xf bank_mask:0xf
v_and_b32_dpp v69, v83, v9 row_newbcast:10 row_mask:0xf bank_mask:0xf
v_and_b32_dpp v70, v83, v10 row_newbcast:10 row_mask:0xf bank_mask:0xf
v_and_b32_dpp v71, v83, v11 row_newbcast:10 row_mask:0xf bank_mask:0xf
v_and_b32_dpp v72, v83, v8 row_newbcast:14 row_mask:0xf bank_mask:0xf
v_and_b32_dpp v73, v83, v9 row_newbcast:14 row_mask:0xf bank_mask:0xf
v_and_b32_dpp v74, v83, v10 row_newbcast:14 row_mask:0xf bank_mask:0xf
v_and_b32_dpp v75, v83, v11 row_newbcast:14 row_mask:0xf bank_mask:0xf
s_waitcnt vmcnt(28)
v_mfma_f32_16x16x32_bf16 v[20:23], v[60:63], v[152:155], v[20:23]
v_mfma_f32_16x16x32_bf16 v[20:23], v[64:67], v[156:159], v[20:23]
v_mfma_f32_16x16x32_bf16 v[20:23], v[68:71], v[160:163], v[20:23]
v_mfma_f32_16x16x32_bf16 v[20:23], v[72:75], v[164:167], v[20:23]
buffer_load_dwordx4 v[152:155], v2, s[52:55], s12 offen offset:0 nt
buffer_load_dwordx4 v[156:159], v2, s[52:55], s12 offen offset:1024 nt
buffer_load_dwordx4 v[160:163], v2, s[52:55], s12 offen offset:2048 nt
buffer_load_dwordx4 v[164:167], v2, s[52:55], s12 offen offset:3072 nt
s_add_u32 s13, s13, 24576
s_min_u32 s12, s13, 2146435072
v_and_b32_dpp v60, v83, v8 row_newbcast:3 row_mask:0xf bank_mask:0xf
v_and_b32_dpp v61, v83, v9 row_newbcast:3 row_mask:0xf bank_mask:0xf
v_and_b32_dpp v62, v83, v10 row_newbcast:3 row_mask:0xf bank_mask:0xf
v_and_b32_dpp v63, v83, v11 row_newbcast:3 row_mask:0xf bank_mask:0xf
v_and_b32_dpp v64, v83, v8 row_newbcast:7 row_mask:0xf bank_mask:0xf
v_and_b32_dpp v65, v83, v9 row_newbcast:7 row_mask:0xf bank_mask:0xf
v_and_b32_dpp v66, v83, v10 row_newbcast:7 row_mask:0xf bank_mask:0xf
v_and_b32_dpp v67, v83, v11 row_newbcast:7 row_mask:0xf bank_mask:0xf
v_and_b32_dpp v68, v83, v8 row_newbcast:11 row_mask:0xf bank_mask:0xf
v_and_b32_dpp v69, v83, v9 row_newbcast:11 row_mask:0xf bank_mask:0xf
v_and_b32_dpp v70, v83, v10 row_newbcast:11 row_mask:0xf bank_mask:0xf
v_and_b32_dpp v71, v83, v11 row_newbcast:11 row_mask:0xf bank_mask:0xf
v_and_b32_dpp v72, v83, v8 row_newbcast:15 row_mask:0xf bank_mask:0xf
v_and_b32_dpp v73, v83, v9 row_newbcast:15 row_mask:0xf bank_mask:0xf
v_and_b32_dpp v74, v83, v10 row_newbcast:15 row_mask:0xf bank_mask:0xf
v_and_b32_dpp v75, v83, v11 row_newbcast:15 row_mask:0xf bank_mask:0xf
s_waitcnt vmcnt(28)
v_mfma_f32_16x16x32_bf16 v[20:23], v[60:63], v[168:171], v[20:23]
v_mfma_f32_16x16x32_bf16 v[20:23], v[64:67], v[172:175], v[20:23]
v_mfma_f32_16x16x32_bf16 v[20:23], v[68:71], v[176:179], v[20:23]
v_mfma_f32_16x16x32_bf16 v[20:23], v[72:75], v[180:183], v[20:23]
buffer_load_dwordx4 v[168:171], v2, s[52:55], s12 offen offset:0 nt
buffer_load_dwordx4 v[172:175], v2, s[52:55], s12 offen offset:1024 nt
buffer_load_dwordx4 v[176:179], v2, s[52:55], s12 offen offset:2048 nt
buffer_load_dwordx4 v[180:183], v2, s[52:55], s12 offen offset:3072 nt
s_add_u32 s13, s13, 24576
s_min_u32 s12, s13, 2146435072
v_and_b32_dpp v60, v84, v8 row_newbcast:0 row_mask:0xf bank_mask:0xf
v_and_b32_dpp v61, v84, v9 row_newbcast:0 row_mask:0xf bank_mask:0xf
v_and_b32_dpp v62, v84, v10 row_newbcast:0 row_mask:0xf bank_mask:0xf
v_and_b32_dpp v63, v84, v11 row_newbcast:0 row_mask:0xf bank_mask:0xf
v_and_b32_dpp v64, v84, v8 row_newbcast:4 row_mask:0xf bank_mask:0xf
v_and_b32_dpp v65, v84, v9 row_newbcast:4 row_mask:0xf bank_mask:0xf
v_and_b32_dpp v66, v84, v10 row_newbcast:4 row_mask:0xf bank_mask:0xf
v_and_b32_dpp v67, v84, v11 row_newbcast:4 row_mask:0xf bank_mask:0xf
v_and_b32_dpp v68, v84, v8 row_newbcast:8 row_mask:0xf bank_mask:0xf
v_and_b32_dpp v69, v84, v9 row_newbcast:8 row_mask:0xf bank_mask:0xf
v_and_b32_dpp v70, v84, v10 row_newbcast:8 row_mask:0xf bank_mask:0xf
v_and_b32_dpp v71, v84, v11 row_newbcast:8 row_mask:0xf bank_mask:0xf
v_and_b32_dpp v72, v84, v8 row_newbcast:12 row_mask:0xf bank_mask:0xf
v_and_b32_dpp v73, v84, v9 row_newbcast:12 row_mask:0xf bank_mask:0xf
v_and_b32_dpp v74, v84, v10 row_newbcast:12 row_mask:0xf bank_mask:0xf
v_and_b32_dpp v75, v84, v11 row_newbcast:12 row_mask:0xf bank_mask:0xf
s_waitcnt vmcnt(28)
v_mfma_f32_16x16x32_bf16 v[20:23], v[60:63], v[184:187], v[20:23]
v_mfma_f32_16x16x32_bf16 v[20:23], v[64:67], v[188:191], v[20:23]
v_mfma_f32_16x16x32_bf16 v[20:23], v[68:71], v[192:195], v[20:23]
v_mfma_f32_16x16x32_bf16 v[20:23], v[72:75], v[196:199], v[20:23]
buffer_load_dwordx4 v[184:187], v2, s[52:55], s12 offen offset:0 nt
buffer_load_dwordx4 v[188:191], v2, s[52:55], s12 offen offset:1024 nt
buffer_load_dwordx4 v[192:195], v2, s[52:55], s12 offen offset:2048 nt
buffer_load_dwordx4 v[196:199], v2, s[52:55], s12 offen offset:3072 nt
s_add_u32 s13, s13, 24576
s_min_u32 s12, s13, 2146435072
v_and_b32_dpp v60, v84, v8 row_newbcast:1 row_mask:0xf bank_mask:0xf
v_and_b32_dpp v61, v84, v9 row_newbcast:1 row_mask:0xf bank_mask:0xf
v_and_b32_dpp v62, v84, v10 row_newbcast:1 row_mask:0xf bank_mask:0xf
v_and_b32_dpp v63, v84, v11 row_newbcast:1 row_mask:0xf bank_mask:0xf
v_and_b32_dpp v64, v84, v8 row_newbcast:5 row_mask:0xf bank_mask:0xf
v_and_b32_dpp v65, v84, v9 row_newbcast:5 row_mask:0xf bank_mask:0xf
v_and_b32_dpp v66, v84, v10 row_newbcast:5 row_mask:0xf bank_mask:0xf
v_and_b32_dpp v67, v84, v11 row_newbcast:5 row_mask:0xf bank_mask:0xf
v_and_b32_dpp v68, v84, v8 row_newbcast:9 row_mask:0xf bank_mask:0xf
v_and_b32_dpp v69, v84, v9 row_newbcast:9 row_mask:0xf bank_mask:0xf
v_and_b32_dpp v70, v84, v10 row_newbcast:9 row_mask:0xf bank_mask:0xf
v_and_b32_dpp v71, v84, v11 row_newbcast:9 row_mask:0xf bank_mask:0xf
v_and_b32_dpp v72, v84, v8 row_newbcast:13 row_mask:0xf bank_mask:0xf
v_and_b32_dpp v73, v84, v9 row_newbcast:13 row_mask:0xf bank_mask:0xf
v_and_b32_dpp v74, v84, v10 row_newbcast:13 row_mask:0xf bank_mask:0xf
v_and_b32_dpp v75, v84, v11 row_newbcast:13 row_mask:0xf bank_mask:0xf
s_waitcnt vmcnt(28)
v_mfma_f32_16x16x32_bf16 v[20:23], v[60:63], v[200:203], v[20:23]
v_mfma_f32_16x16x32_bf16 v[20:23], v[64:67], v[204:207], v[20:23]
v_mfma_f32_16x16x32_bf16 v[20:23], v[68:71], v[208:211], v[20:23]
v_mfma_f32_16x16x32_bf16 v[20:23], v[72:75], v[212:215], v[20:23]
buffer_load_dwordx4 v[200:203], v2, s[52:55], s12 offen offset:0 nt
buffer_load_dwordx4 v[204:207], v2, s[52:55], s12 offen offset:1024 nt
buffer_load_dwordx4 v[208:211], v2, s[52:55], s12 offen offset:2048 nt
buffer_load_dwordx4 v[212:215], v2, s[52:55], s12 offen offset:3072 nt
s_add_u32 s13, s13, 24576
s_min_u32 s12, s13, 2146435072
v_and_b32_dpp v60, v77, v8 row_newbcast:3 row_mask:0xf bank_mask:0xf
v_and_b32_dpp v61, v77, v9 row_newbcast:3 row_mask:0xf bank_mask:0xf
v_and_b32_dpp v62, v77, v10 row_newbcast:3 row_mask:0xf bank_mask:0xf
v_and_b32_dpp v63, v77, v11 row_newbcast:3 row_mask:0xf bank_mask:0xf
v_and_b32_dpp v64, v77, v8 row_newbcast:7 row_mask:0xf bank_mask:0xf
v_and_b32_dpp v65, v77, v9 row_newbcast:7 row_mask:0xf bank_mask:0xf
v_and_b32_dpp v66, v77, v10 row_newbcast:7 row_mask:0xf bank_mask:0xf
v_and_b32_dpp v67, v77, v11 row_newbcast:7 row_mask:0xf bank_mask:0xf
v_and_b32_dpp v68, v77, v8 row_newbcast:11 row_mask:0xf bank_mask:0xf
v_and_b32_dpp v69, v77, v9 row_newbcast:11 row_mask:0xf bank_mask:0xf
v_and_b32_dpp v70, v77, v10 row_newbcast:11 row_mask:0xf bank_mask:0xf
v_and_b32_dpp v71, v77, v11 row_newbcast:11 row_mask:0xf bank_mask:0xf
v_and_b32_dpp v72, v77, v8 row_newbcast:15 row_mask:0xf bank_mask:0xf
v_and_b32_dpp v73, v77, v9 row_newbcast:15 row_mask:0xf bank_mask:0xf
v_and_b32_dpp v74, v77, v10 row_newbcast:15 row_mask:0xf bank_mask:0xf
v_and_b32_dpp v75, v77, v11 row_newbcast:15 row_mask:0xf bank_mask:0xf
v_mfma_f32_16x16x32_bf16 v[20:23], v[60:63], a[240:243], v[20:23]
v_mfma_f32_16x16x32_bf16 v[20:23], v[64:67], a[244:247], v[20:23]
v_mfma_f32_16x16x32_bf16 v[20:23], v[68:71], a[248:251], v[20:23]
v_mfma_f32_16x16x32_bf16 v[20:23], v[72:75], a[252:255], v[20:23]
s_nop 3
v_and_b32_dpp v60, v84, v8 row_newbcast:2 row_mask:0xf bank_mask:0xf
v_and_b32_dpp v61, v84, v9 row_newbcast:2 row_mask:0xf bank_mask:0xf
v_and_b32_dpp v62, v84, v10 row_newbcast:2 row_mask:0xf bank_mask:0xf
v_and_b32_dpp v63, v84, v11 row_newbcast:2 row_mask:0xf bank_mask:0xf
v_and_b32_dpp v64, v84, v8 row_newbcast:6 row_mask:0xf bank_mask:0xf
v_and_b32_dpp v65, v84, v9 row_newbcast:6 row_mask:0xf bank_mask:0xf
v_and_b32_dpp v66, v84, v10 row_newbcast:6 row_mask:0xf bank_mask:0xf
v_and_b32_dpp v67, v84, v11 row_newbcast:6 row_mask:0xf bank_mask:0xf
v_and_b32_dpp v68, v84, v8 row_newbcast:10 row_mask:0xf bank_mask:0xf
v_and_b32_dpp v69, v84, v9 row_newbcast:10 row_mask:0xf bank_mask:0xf
v_and_b32_dpp v70, v84, v10 row_newbcast:10 row_mask:0xf bank_mask:0xf
v_and_b32_dpp v71, v84, v11 row_newbcast:10 row_mask:0xf bank_mask:0xf
v_and_b32_dpp v72, v84, v8 row_newbcast:14 row_mask:0xf bank_mask:0xf
v_and_b32_dpp v73, v84, v9 row_newbcast:14 row_mask:0xf bank_mask:0xf
v_and_b32_dpp v74, v84, v10 row_newbcast:14 row_mask:0xf bank_mask:0xf
v_and_b32_dpp v75, v84, v11 row_newbcast:14 row_mask:0xf bank_mask:0xf
s_waitcnt vmcnt(28)
v_mfma_f32_16x16x32_bf16 v[20:23], v[60:63], v[216:219], v[20:23]
v_mfma_f32_16x16x32_bf16 v[20:23], v[64:67], v[220:223], v[20:23]
v_mfma_f32_16x16x32_bf16 v[20:23], v[68:71], v[224:227], v[20:23]
v_mfma_f32_16x16x32_bf16 v[20:23], v[72:75], v[228:231], v[20:23]
buffer_load_dwordx4 v[216:219], v2, s[52:55], s12 offen offset:0 nt
buffer_load_dwordx4 v[220:223], v2, s[52:55], s12 offen offset:1024 nt
buffer_load_dwordx4 v[224:227], v2, s[52:55], s12 offen offset:2048 nt
buffer_load_dwordx4 v[228:231], v2, s[52:55], s12 offen offset:3072 nt
s_add_u32 s13, s13, 24576
s_min_u32 s12, s13, 2146435072
v_and_b32_dpp v60, v84, v8 row_newbcast:3 row_mask:0xf bank_mask:0xf
v_and_b32_dpp v61, v84, v9 row_newbcast:3 row_mask:0xf bank_mask:0xf
v_and_b32_dpp v62, v84, v10 row_newbcast:3 row_mask:0xf bank_mask:0xf
v_and_b32_dpp v63, v84, v11 row_newbcast:3 row_mask:0xf bank_mask:0xf
v_and_b32_dpp v64, v84, v8 row_newbcast:7 row_mask:0xf bank_mask:0xf
v_and_b32_dpp v65, v84, v9 row_newbcast:7 row_mask:0xf bank_mask:0xf
v_and_b32_dpp v66, v84, v10 row_newbcast:7 row_mask:0xf bank_mask:0xf
v_and_b32_dpp v67, v84, v11 row_newbcast:7 row_mask:0xf bank_mask:0xf
v_and_b32_dpp v68, v84, v8 row_newbcast:11 row_mask:0xf bank_mask:0xf
v_and_b32_dpp v69, v84, v9 row_newbcast:11 row_mask:0xf bank_mask:0xf
v_and_b32_dpp v70, v84, v10 row_newbcast:11 row_mask:0xf bank_mask:0xf
v_and_b32_dpp v71, v84, v11 row_newbcast:11 row_mask:0xf bank_mask:0xf
v_and_b32_dpp v72, v84, v8 row_newbcast:15 row_mask:0xf bank_mask:0xf
v_and_b32_dpp v73, v84, v9 row_newbcast:15 row_mask:0xf bank_mask:0xf
v_and_b32_dpp v74, v84, v10 row_newbcast:15 row_mask:0xf bank_mask:0xf
v_and_b32_dpp v75, v84, v11 row_newbcast:15 row_mask:0xf bank_mask:0xf
s_waitcnt vmcnt(28)
v_mfma_f32_16x16x32_bf16 v[20:23], v[60:63], v[232:235], v[20:23]
v_mfma_f32_16x16x32_bf16 v[20:23], v[64:67], v[236:239], v[20:23]
v_mfma_f32_16x16x32_bf16 v[20:23], v[68:71], v[240:243], v[20:23]
v_mfma_f32_16x16x32_bf16 v[20:23], v[72:75], v[244:247], v[20:23]
buffer_load_dwordx4 v[232:235], v2, s[52:55], s12 offen offset:0 nt
buffer_load_dwordx4 v[236:239], v2, s[52:55], s12 offen offset:1024 nt
buffer_load_dwordx4 v[240:243], v2, s[52:55], s12 offen offset:2048 nt
buffer_load_dwordx4 v[244:247], v2, s[52:55], s12 offen offset:3072 nt
s_add_u32 s13, s13, 24576
s_min_u32 s12, s13, 2146435072
s_branch A_ev2
A_ev2_ret:
s_nop 1
v_and_b32_dpp v60, v85, v8 row_newbcast:0 row_mask:0xf bank_mask:0xf
v_and_b32_dpp v61, v85, v9 row_newbcast:0 row_mask:0xf bank_mask:0xf
v_and_b32_dpp v62, v85, v10 row_newbcast:0 row_mask:0xf bank_mask:0xf
v_and_b32_dpp v63, v85, v11 row_newbcast:0 row_mask:0xf bank_mask:0xf
v_and_b32_dpp v64, v85, v8 row_newbcast:4 row_mask:0xf bank_mask:0xf
v_and_b32_dpp v65, v85, v9 row_newbcast:4 row_mask:0xf bank_mask:0xf
v_and_b32_dpp v66, v85, v10 row_newbcast:4 row_mask:0xf bank_mask:0xf
v_and_b32_dpp v67, v85, v11 row_newbcast:4 row_mask:0xf bank_mask:0xf
v_and_b32_dpp v68, v85, v8 row_newbcast:8 row_mask:0xf bank_mask:0xf
v_and_b32_dpp v69, v85, v9 row_newbcast:8 row_mask:0xf bank_mask:0xf
v_and_b32_dpp v70, v85, v10 row_newbcast:8 row_mask:0xf bank_mask:0xf
v_and_b32_dpp v71, v85, v11 row_newbcast:8 row_mask:0xf bank_mask:0xf
v_and_b32_dpp v72, v85, v8 row_newbcast:12 row_mask:0xf bank_mask:0xf
v_and_b32_dpp v73, v85, v9 row_newbcast:12 row_mask:0xf bank_mask:0xf
v_and_b32_dpp v74, v85, v10 row_newbcast:12 row_mask:0xf bank_mask:0xf
v_and_b32_dpp v75, v85, v11 row_newbcast:12 row_mask:0xf bank_mask:0xf
s_waitcnt vmcnt(28)
v_mfma_f32_16x16x32_bf16 v[20:23], v[60:63], v[120:123], v[20:23]
v_mfma_f32_16x16x32_bf16 v[20:23], v[64:67], v[124:127], v[20:23]
v_mfma_f32_16x16x32_bf16 v[20:23], v[68:71], v[128:131], v[20:23]
v_mfma_f32_16x16x32_bf16 v[20:23], v[72:75], v[132:135], v[20:23]
s_nop 3
v_and_b32_dpp v60, v85, v8 row_newbcast:1 row_mask:0xf bank_mask:0xf
v_and_b32_dpp v61, v85, v9 row_newbcast:1 row_mask:0xf bank_mask:0xf
v_and_b32_dpp v62, v85, v10 row_newbcast:1 row_mask:0xf bank_mask:0xf
v_and_b32_dpp v63, v85, v11 row_newbcast:1 row_mask:0xf bank_mask:0xf
v_and_b32_dpp v64, v85, v8 row_newbcast:5 row_mask:0xf bank_mask:0xf
v_and_b32_dpp v65, v85, v9 row_newbcast:5 row_mask:0xf bank_mask:0xf
v_and_b32_dpp v66, v85, v10 row_newbcast:5 row_mask:0xf bank_mask:0xf
v_and_b32_dpp v67, v85, v11 row_newbcast:5 row_mask:0xf bank_mask:0xf
v_and_b32_dpp v68, v85, v8 row_newbcast:9 row_mask:0xf bank_mask:0xf
v_and_b32_dpp v69, v85, v9 row_newbcast:9 row_mask:0xf bank_mask:0xf
v_and_b32_dpp v70, v85, v10 row_newbcast:9 row_mask:0xf bank_mask:0xf
v_and_b32_dpp v71, v85, v11 row_newbcast:9 row_mask:0xf bank_mask:0xf
v_and_b32_dpp v72, v85, v8 row_newbcast:13 row_mask:0xf bank_mask:0xf
v_and_b32_dpp v73, v85, v9 row_newbcast:13 row_mask:0xf bank_mask:0xf
v_and_b32_dpp v74, v85, v10 row_newbcast:13 row_mask:0xf bank_mask:0xf
v_and_b32_dpp v75, v85, v11 row_newbcast:13 row_mask:0xf bank_mask:0xf
s_waitcnt vmcnt(24)
v_mfma_f32_16x16x32_bf16 v[20:23], v[60:63], v[136:139], v[20:23]
v_mfma_f32_16x16x32_bf16 v[20:23], v[64:67], v[140:143], v[20:23]
v_mfma_f32_16x16x32_bf16 v[20:23], v[68:71], v[144:147], v[20:23]
v_mfma_f32_16x16x32_bf16 v[20:23], v[72:75], v[148:151], v[20:23]
s_nop 3
v_and_b32_dpp v60, v85, v8 row_newbcast:2 row_mask:0xf bank_mask:0xf
v_and_b32_dpp v61, v85, v9 row_newbcast:2 row_mask:0xf bank_mask:0xf
v_and_b32_dpp v62, v85, v10 row_newbcast:2 row_mask:0xf bank_mask:0xf
v_and_b32_dpp v63, v85, v11 row_newbcast:2 row_mask:0xf bank_mask:0xf
v_and_b32_dpp v64, v85, v8 row_newbcast:6 row_mask:0xf bank_mask:0xf
v_and_b32_dpp v65, v85, v9 row_newbcast:6 row_mask:0xf bank_mask:0xf
v_and_b32_dpp v66, v85, v10 row_newbcast:6 row_mask:0xf bank_mask:0xf
v_and_b32_dpp v67, v85, v11 row_newbcast:6 row_mask:0xf bank_mask:0xf
v_and_b32_dpp v68, v85, v8 row_newbcast:10 row_mask:0xf bank_mask:0xf
v_and_b32_dpp v69, v85, v9 row_newbcast:10 row_mask:0xf bank_mask:0xf
v_and_b32_dpp v70, v85, v10 row_newbcast:10 row_mask:0xf bank_mask:0xf
v_and_b32_dpp v71, v85, v11 row_newbcast:10 row_mask:0xf bank_mask:0xf
v_and_b32_dpp v72, v85, v8 row_newbcast:14 row_mask:0xf bank_mask:0xf
v_and_b32_dpp v73, v85, v9 row_newbcast:14 row_mask:0xf bank_mask:0xf
v_and_b32_dpp v74, v85, v10 row_newbcast:14 row_mask:0xf bank_mask:0xf
v_and_b32_dpp v75, v85, v11 row_newbcast:14 row_mask:0xf bank_mask:0xf
s_waitcnt vmcnt(20)
v_mfma_f32_16x16x32_bf16 v[20:23], v[60:63], v[152:155], v[20:23]
v_mfma_f32_16x16x32_bf16 v[20:23], v[64:67], v[156:159], v[20:23]
v_mfma_f32_16x16x32_bf16 v[20:23], v[68:71], v[160:163], v[20:23]
v_mfma_f32_16x16x32_bf16 v[20:23], v[72:75], v[164:167], v[20:23]
s_nop 3
v_and_b32_dpp v60, v85, v8 row_newbcast:3 row_mask:0xf bank_mask:0xf
v_and_b32_dpp v61, v85, v9 row_newbcast:3 row_mask:0xf bank_mask:0xf
v_and_b32_dpp v62, v85, v10 row_newbcast:3 row_mask:0xf bank_mask:0xf
v_and_b32_dpp v63, v85, v11 row_newbcast:3 row_mask:0xf bank_mask:0xf
v_and_b32_dpp v64, v85, v8 row_newbcast:7 row_mask:0xf bank_mask:0xf
v_and_b32_dpp v65, v85, v9 row_newbcast:7 row_mask:0xf bank_mask:0xf
v_and_b32_dpp v66, v85, v10 row_newbcast:7 row_mask:0xf bank_mask:0xf
v_and_b32_dpp v67, v85, v11 row_newbcast:7 row_mask:0xf bank_mask:0xf
v_and_b32_dpp v68, v85, v8 row_newbcast:11 row_mask:0xf bank_mask:0xf
v_and_b32_dpp v69, v85, v9 row_newbcast:11 row_mask:0xf bank_mask:0xf
v_and_b32_dpp v70, v85, v10 row_newbcast:11 row_mask:0xf bank_mask:0xf
v_and_b32_dpp v71, v85, v11 row_newbcast:11 row_mask:0xf bank_mask:0xf
v_and_b32_dpp v72, v85, v8 row_newbcast:15 row_mask:0xf bank_mask:0xf
v_and_b32_dpp v73, v85, v9 row_newbcast:15 row_mask:0xf bank_mask:0xf
v_and_b32_dpp v74, v85, v10 row_newbcast:15 row_mask:0xf bank_mask:0xf
v_and_b32_dpp v75, v85, v11 row_newbcast:15 row_mask:0xf bank_mask:0xf
s_waitcnt vmcnt(16)
v_mfma_f32_16x16x32_bf16 v[20:23], v[60:63], v[168:171], v[20:23]
v_mfma_f32_16x16x32_bf16 v[20:23], v[64:67], v[172:175], v[20:23]
v_mfma_f32_16x16x32_bf16 v[20:23], v[68:71], v[176:179], v[20:23]
v_mfma_f32_16x16x32_bf16 v[20:23], v[72:75], v[180:183], v[20:23]
s_nop 3
v_and_b32_dpp v60, v86, v8 row_newbcast:0 row_mask:0xf bank_mask:0xf
v_and_b32_dpp v61, v86, v9 row_newbcast:0 row_mask:0xf bank_mask:0xf
v_and_b32_dpp v62, v86, v10 row_newbcast:0 row_mask:0xf bank_mask:0xf
v_and_b32_dpp v63, v86, v11 row_newbcast:0 row_mask:0xf bank_mask:0xf
v_and_b32_dpp v64, v86, v8 row_newbcast:4 row_mask:0xf bank_mask:0xf
v_and_b32_dpp v65, v86, v9 row_newbcast:4 row_mask:0xf bank_mask:0xf
v_and_b32_dpp v66, v86, v10 row_newbcast:4 row_mask:0xf bank_mask:0xf
v_and_b32_dpp v67, v86, v11 row_newbcast:4 row_mask:0xf bank_mask:0xf
v_and_b32_dpp v68, v86, v8 row_newbcast:8 row_mask:0xf bank_mask:0xf
v_and_b32_dpp v69, v86, v9 row_newbcast:8 row_mask:0xf bank_mask:0xf
v_and_b32_dpp v70, v86, v10 row_newbcast:8 row_mask:0xf bank_mask:0xf
v_and_b32_dpp v71, v86, v11 row_newbcast:8 row_mask:0xf bank_mask:0xf
v_and_b32_dpp v72, v86, v8 row_newbcast:12 row_mask:0xf bank_mask:0xf
v_and_b32_dpp v73, v86, v9 row_newbcast:12 row_mask:0xf bank_mask:0xf
v_and_b32_dpp v74, v86, v10 row_newbcast:12 row_mask:0xf bank_mask:0xf
v_and_b32_dpp v75, v86, v11 row_newbcast:12 row_mask:0xf bank_mask:0xf
s_waitcnt vmcnt(12)
v_mfma_f32_16x16x32_bf16 v[20:23], v[60:63], v[184:187], v[20:23]
v_mfma_f32_16x16x32_bf16 v[20:23], v[64:67], v[188:191], v[20:23]
v_mfma_f32_16x16x32_bf16 v[20:23], v[68:71], v[192:195], v[20:23]
v_mfma_f32_16x16x32_bf16 v[20:23], v[72:75], v[196:199], v[20:23]
s_nop 3
v_and_b32_dpp v60, v86, v8 row_newbcast:1 row_mask:0xf bank_mask:0xf
v_and_b32_dpp v61, v86, v9 row_newbcast:1 row_mask:0xf bank_mask:0xf
v_and_b32_dpp v62, v86, v10 row_newbcast:1 row_mask:0xf bank_mask:0xf
v_and_b32_dpp v63, v86, v11 row_newbcast:1 row_mask:0xf bank_mask:0xf
v_and_b32_dpp v64, v86, v8 row_newbcast:5 row_mask:0xf bank_mask:0xf
v_and_b32_dpp v65, v86, v9 row_newbcast:5 row_mask:0xf bank_mask:0xf
v_and_b32_dpp v66, v86, v10 row_newbcast:5 row_mask:0xf bank_mask:0xf
v_and_b32_dpp v67, v86, v11 row_newbcast:5 row_mask:0xf bank_mask:0xf
v_and_b32_dpp v68, v86, v8 row_newbcast:9 row_mask:0xf bank_mask:0xf
v_and_b32_dpp v69, v86, v9 row_newbcast:9 row_mask:0xf bank_mask:0xf
v_and_b32_dpp v70, v86, v10 row_newbcast:9 row_mask:0xf bank_mask:0xf
v_and_b32_dpp v71, v86, v11 row_newbcast:9 row_mask:0xf bank_mask:0xf
v_and_b32_dpp v72, v86, v8 row_newbcast:13 row_mask:0xf bank_mask:0xf
v_and_b32_dpp v73, v86, v9 row_newbcast:13 row_mask:0xf bank_mask:0xf
v_and_b32_dpp v74, v86, v10 row_newbcast:13 row_mask:0xf bank_mask:0xf
v_and_b32_dpp v75, v86, v11 row_newbcast:13 row_mask:0xf bank_mask:0xf
s_waitcnt vmcnt(8)
v_mfma_f32_16x16x32_bf16 v[20:23], v[60:63], v[200:203], v[20:23]
v_mfma_f32_16x16x32_bf16 v[20:23], v[64:67], v[204:207], v[20:23]
v_mfma_f32_16x16x32_bf16 v[20:23], v[68:71], v[208:211], v[20:23]
v_mfma_f32_16x16x32_bf16 v[20:23], v[72:75], v[212:215], v[20:23]
s_nop 3
v_and_b32_dpp v60, v86, v8 row_newbcast:2 row_mask:0xf bank_mask:0xf
v_and_b32_dpp v61, v86, v9 row_newbcast:2 row_mask:0xf bank_mask:0xf
v_and_b32_dpp v62, v86, v10 row_newbcast:2 row_mask:0xf bank_mask:0xf
v_and_b32_dpp v63, v86, v11 row_newbcast:2 row_mask:0xf bank_mask:0xf
v_and_b32_dpp v64, v86, v8 row_newbcast:6 row_mask:0xf bank_mask:0xf
v_and_b32_dpp v65, v86, v9 row_newbcast:6 row_mask:0xf bank_mask:0xf
v_and_b32_dpp v66, v86, v10 row_newbcast:6 row_mask:0xf bank_mask:0xf
v_and_b32_dpp v67, v86, v11 row_newbcast:6 row_mask:0xf bank_mask:0xf
v_and_b32_dpp v68, v86, v8 row_newbcast:10 row_mask:0xf bank_mask:0xf
v_and_b32_dpp v69, v86, v9 row_newbcast:10 row_mask:0xf bank_mask:0xf
v_and_b32_dpp v70, v86, v10 row_newbcast:10 row_mask:0xf bank_mask:0xf
v_and_b32_dpp v71, v86, v11 row_newbcast:10 row_mask:0xf bank_mask:0xf
v_and_b32_dpp v72, v86, v8 row_newbcast:14 row_mask:0xf bank_mask:0xf
v_and_b32_dpp v73, v86, v9 row_newbcast:14 row_mask:0xf bank_mask:0xf
v_and_b32_dpp v74, v86, v10 row_newbcast:14 row_mask:0xf bank_mask:0xf
v_and_b32_dpp v75, v86, v11 row_newbcast:14 row_mask:0xf bank_mask:0xf
s_waitcnt vmcnt(4)
v_mfma_f32_16x16x32_bf16 v[20:23], v[60:63], v[216:219], v[20:23]
v_mfma_f32_16x16x32_bf16 v[20:23], v[64:67], v[220:223], v[20:23]
v_mfma_f32_16x16x32_bf16 v[20:23], v[68:71], v[224:227], v[20:23]
v_mfma_f32_16x16x32_bf16 v[20:23], v[72:75], v[228:231], v[20:23]
s_nop 3
v_and_b32_dpp v60, v86, v8 row_newbcast:3 row_mask:0xf bank_mask:0xf
v_and_b32_dpp v61, v86, v9 row_newbcast:3 row_mask:0xf bank_mask:0xf
v_and_b32_dpp v62, v86, v10 row_newbcast:3 row_mask:0xf bank_mask:0xf
v_and_b32_dpp v63, v86, v11 row_newbcast:3 row_mask:0xf bank_mask:0xf
v_and_b32_dpp v64, v86, v8 row_newbcast:7 row_mask:0xf bank_mask:0xf
v_and_b32_dpp v65, v86, v9 row_newbcast:7 row_mask:0xf bank_mask:0xf
v_and_b32_dpp v66, v86, v10 row_newbcast:7 row_mask:0xf bank_mask:0xf
v_and_b32_dpp v67, v86, v11 row_newbcast:7 row_mask:0xf bank_mask:0xf
v_and_b32_dpp v68, v86, v8 row_newbcast:11 row_mask:0xf bank_mask:0xf
v_and_b32_dpp v69, v86, v9 row_newbcast:11 row_mask:0xf bank_mask:0xf
v_and_b32_dpp v70, v86, v10 row_newbcast:11 row_mask:0xf bank_mask:0xf
v_and_b32_dpp v71, v86, v11 row_newbcast:11 row_mask:0xf bank_mask:0xf
v_and_b32_dpp v72, v86, v8 row_newbcast:15 row_mask:0xf bank_mask:0xf
v_and_b32_dpp v73, v86, v9 row_newbcast:15 row_mask:0xf bank_mask:0xf
v_and_b32_dpp v74, v86, v10 row_newbcast:15 row_mask:0xf bank_mask:0xf
v_and_b32_dpp v75, v86, v11 row_newbcast:15 row_mask:0xf bank_mask:0xf
s_waitcnt vmcnt(0)
v_mfma_f32_16x16x32_bf16 v[20:23], v[60:63], v[232:235], v[20:23]
v_mfma_f32_16x16x32_bf16 v[20:23], v[64:67], v[236:239], v[20:23]
v_mfma_f32_16x16x32_bf16 v[20:23], v[68:71], v[240:243], v[20:23]
v_mfma_f32_16x16x32_bf16 v[20:23], v[72:75], v[244:247], v[20:23]
s_nop 3
s_branch A_tail
A_ev2:
s_mov_b32 s7, 400000
A_ev2_chk:
v_max3_u32 v35, v40, v41, v42
v_max3_u32 v35, v35, v43, v44
v_max3_u32 v35, v35, v45, v46
v_max3_u32 v35, v35, v47, v48
v_max3_u32 v35, v35, v49, v50
v_max_u32 v35, v35, v51
v_cmp_eq_u32 vcc, -1, v35
s_cbranch_vccz A_ev2_ok
buffer_load_dwordx4 v[40:43], off, s[64:67], s82 offset:0 sc1
buffer_load_dwordx4 v[44:47], off, s[64:67], s82 offset:16 sc1
buffer_load_dwordx4 v[48:51], off, s[64:67], s82 offset:32 sc1
s_waitcnt vmcnt(0)
s_sub_u32 s7, s7, 1
s_cmp_lg_u32 s7, 0
s_cbranch_scc1 A_ev2_chk
A_ev2_ok:
v_max3_f32 v35, v40, v42, v44
v_max3_f32 v36, v46, v48, v50
v_max_f32 v35, v35, v36
v_sub_f32 v40, v40, v35
v_sub_f32 v42, v42, v35
v_sub_f32 v44, v44, v35
v_sub_f32 v46, v46, v35
v_sub_f32 v48, v48, v35
v_sub_f32 v50, v50, v35
v_sub_f32 v37, v32, v35
v_exp_f32 v40, v40
v_exp_f32 v42, v42
v_exp_f32 v44, v44
v_exp_f32 v46, v46
v_exp_f32 v48, v48
v_exp_f32 v50, v50
v_exp_f32 v37, v37
v_mul_f32 v35, v40, v41
v_fma_f32 v35, v42, v43, v35
v_fma_f32 v35, v44, v45, v35
v_fma_f32 v35, v46, v47, v35
v_fma_f32 v35, v48, v49, v35
v_fma_f32 v35, v50, v51, v35
v_rcp_f32 v35, v35
s_nop 0
v_mul_f32 v37, v37, v35
s_branch A_ev2_ret
A_tail:
s_nop 4
v_mul_f32 v20, v20, v37
v_mul_f32 v21, v21, v37
v_mul_f32 v22, v22, v37
v_mul_f32 v23, v23, v37
v_cvt_pk_bf16_f32 v28, v20, v21
v_cvt_pk_bf16_f32 v29, v22, v23
ds_write_b64 v94, v[28:29]
s_waitcnt lgkmcnt(0)
s_barrier
ds_read_b128 a[0:3], v95 offset:0
ds_read_b128 a[4:7], v95 offset:64
ds_read_b128 a[8:11], v95 offset:128
ds_read_b128 a[12:15], v95 offset:192
s_waitcnt lgkmcnt(0)
v_mfma_f32_16x16x32_bf16 v[72:75], a[0:3], a[224:227], 0
v_mfma_f32_16x16x32_bf16 v[72:75], a[4:7], a[228:231], v[72:75]
v_mfma_f32_16x16x32_bf16 v[72:75], a[8:11], a[232:235], v[72:75]
v_mfma_f32_16x16x32_bf16 v[72:75], a[12:15], a[236:239], v[72:75]
v_mfma_f32_16x16x32_bf16 v[40:43], a[0:3], a[96:99], 0
v_mfma_f32_16x16x32_bf16 v[40:43], a[4:7], a[100:103], v[40:43]
v_mfma_f32_16x16x32_bf16 v[40:43], a[8:11], a[104:107], v[40:43]
v_mfma_f32_16x16x32_bf16 v[40:43], a[12:15], a[108:111], v[40:43]
v_mfma_f32_16x16x32_bf16 v[44:47], a[0:3], a[112:115], 0
v_mfma_f32_16x16x32_bf16 v[44:47], a[4:7], a[116:119], v[44:47]
v_mfma_f32_16x16x32_bf16 v[44:47], a[8:11], a[120:123], v[44:47]
v_mfma_f32_16x16x32_bf16 v[44:47], a[12:15], a[124:127], v[44:47]
v_mul_f32 v114, v106, v72
v_fma_f32 v114, v107, v73, v114
v_fma_f32 v114, v108, v74, v114
v_fma_f32 v114, v109, v75, v114
v_mfma_f32_16x16x32_bf16 v[48:51], a[0:3], a[128:131], 0
v_mfma_f32_16x16x32_bf16 v[48:51], a[4:7], a[132:135], v[48:51]
v_mfma_f32_16x16x32_bf16 v[48:51], a[8:11], a[136:139], v[48:51]
v_mfma_f32_16x16x32_bf16 v[48:51], a[12:15], a[140:143], v[48:51]
v_min_u32 v114, -2, v114
s_mov_b64 exec, 0xffffffff
buffer_store_dword v114, v93, s[64:67], 0 offen offset:512 sc1
s_mov_b64 exec, -1
v_mul_f32 v110, v98, v40
v_fma_f32 v110, v99, v41, v110
v_fma_f32 v110, v100, v42, v110
v_fma_f32 v110, v101, v43, v110
v_mfma_f32_16x16x32_bf16 v[52:55], a[0:3], a[144:147], 0
v_mfma_f32_16x16x32_bf16 v[52:55], a[4:7], a[148:151], v[52:55]
v_mfma_f32_16x16x32_bf16 v[52:55], a[8:11], a[152:155], v[52:55]
v_mfma_f32_16x16x32_bf16 v[52:55], a[12:15], a[156:159], v[52:55]
v_mul_f32 v111, v98, v44
v_fma_f32 v111, v99, v45, v111
v_fma_f32 v111, v100, v46, v111
v_fma_f32 v111, v101, v47, v111
v_mfma_f32_16x16x32_bf16 v[56:59], a[0:3], a[160:163], 0
v_mfma_f32_16x16x32_bf16 v[56:59], a[4:7], a[164:167], v[56:59]
v_mfma_f32_16x16x32_bf16 v[56:59], a[8:11], a[168:171], v[56:59]
v_mfma_f32_16x16x32_bf16 v[56:59], a[12:15], a[172:175], v[56:59]
v_mul_f32 v112, v98, v48
v_fma_f32 v112, v99, v49, v112
v_fma_f32 v112, v100, v50, v112
v_fma_f32 v112, v101, v51, v112
v_mfma_f32_16x16x32_bf16 v[60:63], a[0:3], a[176:179], 0
v_mfma_f32_16x16x32_bf16 v[60:63], a[4:7], a[180:183], v[60:63]
v_mfma_f32_16x16x32_bf16 v[60:63], a[8:11], a[184:187], v[60:63]
v_mfma_f32_16x16x32_bf16 v[60:63], a[12:15], a[188:191], v[60:63]
v_mul_f32 v113, v98, v52
v_fma_f32 v113, v99, v53, v113
v_fma_f32 v113, v100, v54, v113
v_fma_f32 v113, v101, v55, v113
v_mfma_f32_16x16x32_bf16 v[64:67], a[0:3], a[192:195], 0
v_mfma_f32_16x16x32_bf16 v[64:67], a[4:7], a[196:199], v[64:67]
v_mfma_f32_16x16x32_bf16 v[64:67], a[8:11], a[200:203], v[64:67]
v_mfma_f32_16x16x32_bf16 v[64:67], a[12:15], a[204:207], v[64:67]
v_fma_f32 v110, v102, v56, v110
v_fma_f32 v110, v103, v57, v110
v_fma_f32 v110, v104, v58, v110
v_fma_f32 v110, v105, v59, v110
v_mfma_f32_16x16x32_bf16 v[68:71], a[0:3], a[208:211], 0
v_mfma_f32_16x16x32_bf16 v[68:71], a[4:7], a[212:215], v[68:71]
v_mfma_f32_16x16x32_bf16 v[68:71], a[8:11], a[216:219], v[68:71]
v_mfma_f32_16x16x32_bf16 v[68:71], a[12:15], a[220:223], v[68:71]
v_fma_f32 v111, v102, v60, v111
v_fma_f32 v111, v103, v61, v111
v_fma_f32 v111, v104, v62, v111
v_fma_f32 v111, v105, v63, v111
v_fma_f32 v112, v102, v64, v112
v_fma_f32 v112, v103, v65, v112
v_fma_f32 v112, v104, v66, v112
v_fma_f32 v112, v105, v67, v112
v_min_u32 v110, -2, v110
v_min_u32 v111, -2, v111
v_min_u32 v112, -2, v112
v_fma_f32 v113, v102, v68, v113
v_fma_f32 v113, v103, v69, v113
v_fma_f32 v113, v104, v70, v113
v_fma_f32 v113, v105, v71, v113
v_min_u32 v113, -2, v113
buffer_store_dwordx4 v[110:113], v92, s[64:67], 0 offen sc1
s_endpgm
L_exit:
s_endpgm
B_role:
s_mov_b32 s8, s5
s_lshl_b32 s9, s4, 1
s_add_u32 s9, s9, s8
s_lshr_b32 s10, s9, 4
s_and_b32 s11, s9, 15
v_and_b32 v1, 63, v0
v_lshlrev_b32 v2, 4, v1
v_lshrrev_b32 v9, 4, v1
v_and_b32 v8, 15, v1
s_waitcnt lgkmcnt(0)
s_mul_i32 s6, s3, 288
s_sub_u32 s7, 4608, s6
s_add_u32 s44, s26, s6
s_addc_u32 s45, s27, 0
s_mov_b32 s46, s7
s_mov_b32 s47, 0x20000
s_mul_i32 s6, s3, 1179648
s_lshl_b32 s7, s4, 8
s_add_u32 s6, s6, s7
s_sub_u32 s7, 4718592, s6
s_add_u32 s48, s30, s6
s_addc_u32 s49, s31, 0
s_mov_b32 s50, s7
s_mov_b32 s51, 0x20000
s_lshl_b32 s6, s8, 2
s_add_u32 s6, s6, s3
s_lshl_b32 s6, s6, 19
s_lshl_b32 s7, s4, 8
s_add_u32 s6, s6, s7
s_sub_u32 s7, 4194304, s6
s_add_u32 s76, s32, s6
s_addc_u32 s77, s33, 0
s_mov_b32 s78, s7
s_mov_b32 s79, 0x20000
s_lshl_b32 s6, s10, 22
s_add_u32 s52, s28, s6
s_addc_u32 s53, s29, 0
s_mov_b32 s54, 4194304
s_mov_b32 s55, 0x20000
v_mul_u32_u24 v3, 294912, v9
v_lshl_add_u32 v3, v8, 4, v3
v_mul_u32_u24 v4, 72, v9
v_lshrrev_b32 v6, 3, v8
v_mul_u32_u24 v6, 1152, v6
v_add_u32 v4, v4, v6
v_lshlrev_b32 v220, 17, v9
v_lshl_add_u32 v220, v8, 4, v220
v_xor_b32 v10, 32, v2
s_mov_b32 s64, s42
s_mov_b32 s65, s43
s_mov_b32 s66, 6291456
s_mov_b32 s67, 0x20000
buffer_load_dwordx4 v[24:27], v4, s[44:47], 0 offen offset:0
buffer_load_dwordx4 v[28:31], v4, s[44:47], 0 offen offset:16
buffer_load_dwordx4 v[32:35], v4, s[44:47], 0 offen offset:32
buffer_load_dwordx4 v[36:39], v4, s[44:47], 0 offen offset:48
buffer_load_dwordx2 v[40:41], v4, s[44:47], 0 offen offset:64
buffer_load_dwordx4 v[42:45], v4, s[44:47], 0 offen offset:2304
buffer_load_dwordx4 v[46:49], v4, s[44:47], 0 offen offset:2320
buffer_load_dwordx4 v[50:53], v4, s[44:47], 0 offen offset:2336
buffer_load_dwordx4 v[54:57], v4, s[44:47], 0 offen offset:2352
buffer_load_dwordx2 v[58:59], v4, s[44:47], 0 offen offset:2368
s_cmp_ge_u32 s3, 2
s_cbranch_scc1 L_noclr_15
v_mov_b32 v188, -1
v_mov_b32 v189, -1
v_mov_b32 v190, -1
v_mov_b32 v191, -1
s_cmp_eq_u32 s3, 1
s_cbranch_scc1 L_clr1_16
v_lshrrev_b32 v5, 5, v1
v_lshlrev_b32 v5, 15, v5
v_and_b32 v6, 31, v1
v_lshl_add_u32 v5, v6, 4, v5
s_lshl_b32 s6, s9, 9
s_add_u32 s7, s6, 65536
s_add_u32 s6, s6, 0
buffer_store_dwordx4 v[188:191], v5, s[64:67], s6 offen sc1
buffer_store_dwordx4 v[188:191], v5, s[64:67], s7 offen sc1
s_add_u32 s6, s6, 262144
s_mov_b64 exec, 0xffffffff
buffer_store_dwordx4 v[188:191], v2, s[64:67], s6 offen sc1
s_lshl_b32 s6, s9, 7
s_add_u32 s6, s6, 327680
s_mov_b64 exec, 0xff
buffer_store_dwordx4 v[188:191], v2, s[64:67], s6 offen sc1
s_mov_b64 exec, -1
L_clr1_16:
s_mul_i32 s6, s9, 9216
s_mul_i32 s7, s3, 1048576
s_add_u32 s6, s6, s7
s_add_u32 s6, s6, 4194304
buffer_store_dwordx4 v[188:191], v2, s[64:67], s6 offen offset:0 sc1
buffer_store_dwordx4 v[188:191], v2, s[64:67], s6 offen offset:1024 sc1
buffer_store_dwordx4 v[188:191], v2, s[64:67], s6 offen offset:2048 sc1
buffer_store_dwordx4 v[188:191], v2, s[64:67], s6 offen offset:3072 sc1
s_add_u32 s6, s6, 4096
buffer_store_dwordx4 v[188:191], v2, s[64:67], s6 offen offset:0 sc1
buffer_store_dwordx4 v[188:191], v2, s[64:67], s6 offen offset:1024 sc1
buffer_store_dwordx4 v[188:191], v2, s[64:67], s6 offen offset:2048 sc1
buffer_store_dwordx4 v[188:191], v2, s[64:67], s6 offen offset:3072 sc1
s_add_u32 s6, s6, 4096
buffer_store_dwordx4 v[188:191], v2, s[64:67], s6 offen offset:0 sc1
L_noclr_15:
s_mov_b32 s6, 0
buffer_load_dwordx4 a[96:99], v3, s[48:51], s6 offen
s_mov_b32 s6, 8192
buffer_load_dwordx4 a[100:103], v3, s[48:51], s6 offen
s_mov_b32 s6, 16384
buffer_load_dwordx4 a[104:107], v3, s[48:51], s6 offen
s_mov_b32 s6, 24576
buffer_load_dwordx4 a[108:111], v3, s[48:51], s6 offen
s_mov_b32 s6, 32768
buffer_load_dwordx4 a[112:115], v3, s[48:51], s6 offen
s_mov_b32 s6, 40960
buffer_load_dwordx4 a[116:119], v3, s[48:51], s6 offen
s_mov_b32 s6, 49152
buffer_load_dwordx4 a[120:123], v3, s[48:51], s6 offen
s_mov_b32 s6, 57344
buffer_load_dwordx4 a[124:127], v3, s[48:51], s6 offen
s_mov_b32 s6, 65536
buffer_load_dwordx4 a[128:131], v3, s[48:51], s6 offen
s_mov_b32 s6, 73728
buffer_load_dwordx4 a[132:135], v3, s[48:51], s6 offen
s_mov_b32 s6, 81920
buffer_load_dwordx4 a[136:139], v3, s[48:51], s6 offen
s_mov_b32 s6, 90112
buffer_load_dwordx4 a[140:143], v3, s[48:51], s6 offen
s_mov_b32 s6, 98304
buffer_load_dwordx4 a[144:147], v3, s[48:51], s6 offen
s_mov_b32 s6, 106496
buffer_load_dwordx4 a[148:151], v3, s[48:51], s6 offen
s_mov_b32 s6, 114688
buffer_load_dwordx4 a[152:155], v3, s[48:51], s6 offen
s_mov_b32 s6, 122880
buffer_load_dwordx4 a[156:159], v3, s[48:51], s6 offen
s_mov_b32 s6, 131072
buffer_load_dwordx4 a[160:163], v3, s[48:51], s6 offen
s_mov_b32 s6, 139264
buffer_load_dwordx4 a[164:167], v3, s[48:51], s6 offen
s_mov_b32 s6, 147456
buffer_load_dwordx4 a[168:171], v3, s[48:51], s6 offen
s_mov_b32 s6, 155648
buffer_load_dwordx4 a[172:175], v3, s[48:51], s6 offen
s_mov_b32 s6, 163840
buffer_load_dwordx4 a[176:179], v3, s[48:51], s6 offen
s_mov_b32 s6, 172032
buffer_load_dwordx4 a[180:183], v3, s[48:51], s6 offen
s_mov_b32 s6, 180224
buffer_load_dwordx4 a[184:187], v3, s[48:51], s6 offen
s_mov_b32 s6, 188416
buffer_load_dwordx4 a[188:191], v3, s[48:51], s6 offen
s_mov_b32 s6, 196608
buffer_load_dwordx4 a[192:195], v3, s[48:51], s6 offen
s_mov_b32 s6, 204800
buffer_load_dwordx4 a[196:199], v3, s[48:51], s6 offen
s_mov_b32 s6, 212992
buffer_load_dwordx4 a[200:203], v3, s[48:51], s6 offen
s_mov_b32 s6, 221184
buffer_load_dwordx4 a[204:207], v3, s[48:51], s6 offen
s_mov_b32 s6, 229376
buffer_load_dwordx4 a[208:211], v3, s[48:51], s6 offen
s_mov_b32 s6, 237568
buffer_load_dwordx4 a[212:215], v3, s[48:51], s6 offen
s_mov_b32 s6, 245760
buffer_load_dwordx4 a[216:219], v3, s[48:51], s6 offen
s_mov_b32 s6, 253952
buffer_load_dwordx4 a[220:223], v3, s[48:51], s6 offen
s_mov_b32 s6, 262144
buffer_load_dwordx4 a[224:227], v3, s[48:51], s6 offen
s_mov_b32 s6, 270336
buffer_load_dwordx4 a[228:231], v3, s[48:51], s6 offen
s_mov_b32 s6, 278528
buffer_load_dwordx4 a[232:235], v3, s[48:51], s6 offen
s_mov_b32 s6, 286720
buffer_load_dwordx4 a[236:239], v3, s[48:51], s6 offen
s_mov_b32 s6, 0
buffer_load_dwordx4 v[84:87], v220, s[76:79], s6 offen nt
s_mov_b32 s6, 8192
buffer_load_dwordx4 v[88:91], v220, s[76:79], s6 offen nt
s_mov_b32 s6, 16384
buffer_load_dwordx4 v[92:95], v220, s[76:79], s6 offen nt
s_mov_b32 s68, s40
s_mov_b32 s69, s41
s_mov_b32 s70, 256
s_mov_b32 s71, 0x20000
s_mov_b32 s72, s38
s_mov_b32 s73, s39
s_mov_b32 s74, 9216
s_mov_b32 s75, 0x20000
v_and_b32 v5, 1, v1
v_lshlrev_b32 v5, 4, v5
v_mov_b32 v6, 0xffff
v_lshlrev_b32 v5, v5, v6
v_bfe_u32 v6, v1, 1, 2
v_cmp_eq_u32 vcc, 0, v6
s_nop 1
v_cndmask_b32 v12, 0, v5, vcc
v_cmp_eq_u32 vcc, 1, v6
s_nop 1
v_cndmask_b32 v13, 0, v5, vcc
v_cmp_eq_u32 vcc, 2, v6
s_nop 1
v_cndmask_b32 v14, 0, v5, vcc
v_cmp_eq_u32 vcc, 3, v6
s_nop 1
v_cndmask_b32 v15, 0, v5, vcc
v_mov_b32 v5, 0x0c0c0c0c
s_mov_b32 s6, 0x01000100
s_mov_b32 s7, 0x03020302
v_bfi_b32 v16, v12, s6, v5
v_bfi_b32 v17, v13, s6, v5
v_bfi_b32 v18, v14, s6, v5
v_bfi_b32 v19, v15, s6, v5
v_bfi_b32 v20, v12, s7, v5
v_bfi_b32 v21, v13, s7, v5
v_bfi_b32 v22, v14, s7, v5
v_bfi_b32 v23, v15, s7, v5
s_mul_i32 s12, s3, 17408
s_lshl_b32 s13, s3, 14
s_lshl_b32 s6, s11, 16
s_add_u32 s13, s13, s6
s_lshr_b32 s13, s13, 2
s_waitcnt vmcnt(38)
s_cmp_ge_u32 s3, 2
s_cbranch_scc1 L_sig0_17
v_mov_b32 v7, 1
s_mov_b64 exec, 1
buffer_atomic_add v7, off, s[68:71], 0 offset:0
s_mov_b64 exec, -1
L_sig0_17:
s_mov_b32 s6, 24576
buffer_load_dwordx4 v[96:99], v220, s[76:79], s6 offen nt
s_mov_b32 s6, 32768
buffer_load_dwordx4 v[100:103], v220, s[76:79], s6 offen nt
s_mov_b32 s6, 40960
buffer_load_dwordx4 v[104:107], v220, s[76:79], s6 offen nt
s_mov_b32 s6, 49152
buffer_load_dwordx4 v[108:111], v220, s[76:79], s6 offen nt
s_mov_b32 s6, 57344
buffer_load_dwordx4 v[112:115], v220, s[76:79], s6 offen nt
s_mov_b32 s6, 65536
buffer_load_dwordx4 v[116:119], v220, s[76:79], s6 offen nt
s_mov_b32 s6, 73728
buffer_load_dwordx4 v[120:123], v220, s[76:79], s6 offen nt
s_mov_b32 s6, 81920
buffer_load_dwordx4 v[124:127], v220, s[76:79], s6 offen nt
s_mov_b32 s6, 90112
buffer_load_dwordx4 v[128:131], v220, s[76:79], s6 offen nt
s_mov_b32 s6, 98304
buffer_load_dwordx4 v[132:135], v220, s[76:79], s6 offen nt
s_mov_b32 s6, 106496
buffer_load_dwordx4 v[136:139], v220, s[76:79], s6 offen nt
s_mov_b32 s6, 114688
buffer_load_dwordx4 v[140:143], v220, s[76:79], s6 offen nt
s_mov_b32 s6, 122880
buffer_load_dwordx4 v[144:147], v220, s[76:79], s6 offen nt
v_perm_b32 v60, v24, v24, v16
v_perm_b32 v61, v24, v24, v17
v_perm_b32 v62, v24, v24, v18
v_perm_b32 v63, v24, v24, v19
s_nop 1
v_mfma_f32_16x16x32_bf16 v[76:79], v[60:63], a[96:99], 0
v_perm_b32 v64, v42, v42, v16
v_perm_b32 v65, v42, v42, v17
v_perm_b32 v66, v42, v42, v18
v_perm_b32 v67, v42, v42, v19
s_nop 1
v_mfma_f32_16x16x32_bf16 v[80:83], v[64:67], a[96:99], 0
s_add_u32 m0, s12, 0
s_add_u32 s6, s13, 0
buffer_load_dwordx4 v2, s[52:55], s6 offen nt lds
s_waitcnt vmcnt(51)
v_perm_b32 v68, v24, v24, v20
v_perm_b32 v69, v24, v24, v21
v_perm_b32 v70, v24, v24, v22
v_perm_b32 v71, v24, v24, v23
s_nop 1
v_mfma_f32_16x16x32_bf16 v[76:79], v[68:71], a[100:103], v[76:79]
v_perm_b32 v72, v42, v42, v20
v_perm_b32 v73, v42, v42, v21
v_perm_b32 v74, v42, v42, v22
v_perm_b32 v75, v42, v42, v23
s_nop 1
v_mfma_f32_16x16x32_bf16 v[80:83], v[72:75], a[100:103], v[80:83]
s_add_u32 m0, s12, 1088
s_add_u32 s6, s13, 1024
buffer_load_dwordx4 v2, s[52:55], s6 offen nt lds
s_waitcnt vmcnt(51)
v_perm_b32 v60, v25, v25, v16
v_perm_b32 v61, v25, v25, v17
v_perm_b32 v62, v25, v25, v18
v_perm_b32 v63, v25, v25, v19
s_nop 1
v_mfma_f32_16x16x32_bf16 v[76:79], v[60:63], a[104:107], v[76:79]
v_perm_b32 v64, v43, v43, v16
v_perm_b32 v65, v43, v43, v17
v_perm_b32 v66, v43, v43, v18
v_perm_b32 v67, v43, v43, v19
s_nop 1
v_mfma_f32_16x16x32_bf16 v[80:83], v[64:67], a[104:107], v[80:83]
s_add_u32 m0, s12, 2176
s_add_u32 s6, s13, 2048
buffer_load_dwordx4 v2, s[52:55], s6 offen nt lds
s_waitcnt vmcnt(51)
v_perm_b32 v68, v25, v25, v20
v_perm_b32 v69, v25, v25, v21
v_perm_b32 v70, v25, v25, v22
v_perm_b32 v71, v25, v25, v23
s_nop 1
v_mfma_f32_16x16x32_bf16 v[76:79], v[68:71], a[108:111], v[76:79]
v_perm_b32 v72, v43, v43, v20
v_perm_b32 v73, v43, v43, v21
v_perm_b32 v74, v43, v43, v22
v_perm_b32 v75, v43, v43, v23
s_nop 1
v_mfma_f32_16x16x32_bf16 v[80:83], v[72:75], a[108:111], v[80:83]
s_add_u32 m0, s12, 3264
s_add_u32 s6, s13, 3072
buffer_load_dwordx4 v2, s[52:55], s6 offen nt lds
s_waitcnt vmcnt(51)
v_perm_b32 v60, v26, v26, v16
v_perm_b32 v61, v26, v26, v17
v_perm_b32 v62, v26, v26, v18
v_perm_b32 v63, v26, v26, v19
s_nop 1
v_mfma_f32_16x16x32_bf16 v[76:79], v[60:63], a[112:115], v[76:79]
v_perm_b32 v64, v44, v44, v16
v_perm_b32 v65, v44, v44, v17
v_perm_b32 v66, v44, v44, v18
v_perm_b32 v67, v44, v44, v19
s_nop 1
v_mfma_f32_16x16x32_bf16 v[80:83], v[64:67], a[112:115], v[80:83]
s_add_u32 m0, s12, 4352
s_add_u32 s6, s13, 262144
buffer_load_dwordx4 v2, s[52:55], s6 offen nt lds
s_waitcnt vmcnt(51)
v_perm_b32 v68, v26, v26, v20
v_perm_b32 v69, v26, v26, v21
v_perm_b32 v70, v26, v26, v22
v_perm_b32 v71, v26, v26, v23
s_nop 1
v_mfma_f32_16x16x32_bf16 v[76:79], v[68:71], a[116:119], v[76:79]
v_perm_b32 v72, v44, v44, v20
v_perm_b32 v73, v44, v44, v21
v_perm_b32 v74, v44, v44, v22
v_perm_b32 v75, v44, v44, v23
s_nop 1
v_mfma_f32_16x16x32_bf16 v[80:83], v[72:75], a[116:119], v[80:83]
s_add_u32 m0, s12, 5440
s_add_u32 s6, s13, 263168
buffer_load_dwordx4 v2, s[52:55], s6 offen nt lds
s_waitcnt vmcnt(51)
v_perm_b32 v60, v27, v27, v16
v_perm_b32 v61, v27, v27, v17
v_perm_b32 v62, v27, v27, v18
v_perm_b32 v63, v27, v27, v19
s_nop 1
v_mfma_f32_16x16x32_bf16 v[76:79], v[60:63], a[120:123], v[76:79]
v_perm_b32 v64, v45, v45, v16
v_perm_b32 v65, v45, v45, v17
v_perm_b32 v66, v45, v45, v18
v_perm_b32 v67, v45, v45, v19
s_nop 1
v_mfma_f32_16x16x32_bf16 v[80:83], v[64:67], a[120:123], v[80:83]
s_add_u32 m0, s12, 6528
s_add_u32 s6, s13, 264192
buffer_load_dwordx4 v2, s[52:55], s6 offen nt lds
s_waitcnt vmcnt(51)
v_perm_b32 v68, v27, v27, v20
v_perm_b32 v69, v27, v27, v21
v_perm_b32 v70, v27, v27, v22
v_perm_b32 v71, v27, v27, v23
s_nop 1
v_mfma_f32_16x16x32_bf16 v[76:79], v[68:71], a[124:127], v[76:79]
v_perm_b32 v72, v45, v45, v20
v_perm_b32 v73, v45, v45, v21
v_perm_b32 v74, v45, v45, v22
v_perm_b32 v75, v45, v45, v23
s_nop 1
v_mfma_f32_16x16x32_bf16 v[80:83], v[72:75], a[124:127], v[80:83]
s_add_u32 m0, s12, 7616
s_add_u32 s6, s13, 265216
buffer_load_dwordx4 v2, s[52:55], s6 offen nt lds
s_waitcnt vmcnt(51)
v_perm_b32 v60, v28, v28, v16
v_perm_b32 v61, v28, v28, v17
v_perm_b32 v62, v28, v28, v18
v_perm_b32 v63, v28, v28, v19
s_nop 1
v_mfma_f32_16x16x32_bf16 v[76:79], v[60:63], a[128:131], v[76:79]
v_perm_b32 v64, v46, v46, v16
v_perm_b32 v65, v46, v46, v17
v_perm_b32 v66, v46, v46, v18
v_perm_b32 v67, v46, v46, v19
s_nop 1
v_mfma_f32_16x16x32_bf16 v[80:83], v[64:67], a[128:131], v[80:83]
s_add_u32 m0, s12, 8704
s_add_u32 s6, s13, 524288
buffer_load_dwordx4 v10, s[52:55], s6 offen nt lds
s_waitcnt vmcnt(51)
v_perm_b32 v68, v28, v28, v20
v_perm_b32 v69, v28, v28, v21
v_perm_b32 v70, v28, v28, v22
v_perm_b32 v71, v28, v28, v23
s_nop 1
v_mfma_f32_16x16x32_bf16 v[76:79], v[68:71], a[132:135], v[76:79]
v_perm_b32 v72, v46, v46, v20
v_perm_b32 v73, v46, v46, v21
v_perm_b32 v74, v46, v46, v22
v_perm_b32 v75, v46, v46, v23
s_nop 1
v_mfma_f32_16x16x32_bf16 v[80:83], v[72:75], a[132:135], v[80:83]
s_add_u32 m0, s12, 9792
s_add_u32 s6, s13, 525312
buffer_load_dwordx4 v10, s[52:55], s6 offen nt lds
s_waitcnt vmcnt(51)
v_perm_b32 v60, v29, v29, v16
v_perm_b32 v61, v29, v29, v17
v_perm_b32 v62, v29, v29, v18
v_perm_b32 v63, v29, v29, v19
s_nop 1
v_mfma_f32_16x16x32_bf16 v[76:79], v[60:63], a[136:139], v[76:79]
v_perm_b32 v64, v47, v47, v16
v_perm_b32 v65, v47, v47, v17
v_perm_b32 v66, v47, v47, v18
v_perm_b32 v67, v47, v47, v19
s_nop 1
v_mfma_f32_16x16x32_bf16 v[80:83], v[64:67], a[136:139], v[80:83]
s_add_u32 m0, s12, 10880
s_add_u32 s6, s13, 526336
buffer_load_dwordx4 v10, s[52:55], s6 offen nt lds
s_waitcnt vmcnt(51)
v_perm_b32 v68, v29, v29, v20
v_perm_b32 v69, v29, v29, v21
v_perm_b32 v70, v29, v29, v22
v_perm_b32 v71, v29, v29, v23
s_nop 1
v_mfma_f32_16x16x32_bf16 v[76:79], v[68:71], a[140:143], v[76:79]
v_perm_b32 v72, v47, v47, v20
v_perm_b32 v73, v47, v47, v21
v_perm_b32 v74, v47, v47, v22
v_perm_b32 v75, v47, v47, v23
s_nop 1
v_mfma_f32_16x16x32_bf16 v[80:83], v[72:75], a[140:143], v[80:83]
s_add_u32 m0, s12, 11968
s_add_u32 s6, s13, 527360
buffer_load_dwordx4 v10, s[52:55], s6 offen nt lds
s_waitcnt vmcnt(51)
v_perm_b32 v60, v30, v30, v16
v_perm_b32 v61, v30, v30, v17
v_perm_b32 v62, v30, v30, v18
v_perm_b32 v63, v30, v30, v19
s_nop 1
v_mfma_f32_16x16x32_bf16 v[76:79], v[60:63], a[144:147], v[76:79]
v_perm_b32 v64, v48, v48, v16
v_perm_b32 v65, v48, v48, v17
v_perm_b32 v66, v48, v48, v18
v_perm_b32 v67, v48, v48, v19
s_nop 1
v_mfma_f32_16x16x32_bf16 v[80:83], v[64:67], a[144:147], v[80:83]
s_add_u32 m0, s12, 13056
s_add_u32 s6, s13, 786432
buffer_load_dwordx4 v10, s[52:55], s6 offen nt lds
s_waitcnt vmcnt(51)
v_perm_b32 v68, v30, v30, v20
v_perm_b32 v69, v30, v30, v21
v_perm_b32 v70, v30, v30, v22
v_perm_b32 v71, v30, v30, v23
s_nop 1
v_mfma_f32_16x16x32_bf16 v[76:79], v[68:71], a[148:151], v[76:79]
v_perm_b32 v72, v48, v48, v20
v_perm_b32 v73, v48, v48, v21
v_perm_b32 v74, v48, v48, v22
v_perm_b32 v75, v48, v48, v23
s_nop 1
v_mfma_f32_16x16x32_bf16 v[80:83], v[72:75], a[148:151], v[80:83]
s_add_u32 m0, s12, 14144
s_add_u32 s6, s13, 787456
buffer_load_dwordx4 v10, s[52:55], s6 offen nt lds
s_waitcnt vmcnt(51)
v_perm_b32 v60, v31, v31, v16
v_perm_b32 v61, v31, v31, v17
v_perm_b32 v62, v31, v31, v18
v_perm_b32 v63, v31, v31, v19
s_nop 1
v_mfma_f32_16x16x32_bf16 v[76:79], v[60:63], a[152:155], v[76:79]
v_perm_b32 v64, v49, v49, v16
v_perm_b32 v65, v49, v49, v17
v_perm_b32 v66, v49, v49, v18
v_perm_b32 v67, v49, v49, v19
s_nop 1
v_mfma_f32_16x16x32_bf16 v[80:83], v[64:67], a[152:155], v[80:83]
s_add_u32 m0, s12, 15232
s_add_u32 s6, s13, 788480
buffer_load_dwordx4 v10, s[52:55], s6 offen nt lds
s_waitcnt vmcnt(51)
v_perm_b32 v68, v31, v31, v20
v_perm_b32 v69, v31, v31, v21
v_perm_b32 v70, v31, v31, v22
v_perm_b32 v71, v31, v31, v23
s_nop 1
v_mfma_f32_16x16x32_bf16 v[76:79], v[68:71], a[156:159], v[76:79]
v_perm_b32 v72, v49, v49, v20
v_perm_b32 v73, v49, v49, v21
v_perm_b32 v74, v49, v49, v22
v_perm_b32 v75, v49, v49, v23
s_nop 1
v_mfma_f32_16x16x32_bf16 v[80:83], v[72:75], a[156:159], v[80:83]
s_add_u32 m0, s12, 16320
s_add_u32 s6, s13, 789504
buffer_load_dwordx4 v10, s[52:55], s6 offen nt lds
s_waitcnt vmcnt(51)
v_perm_b32 v60, v32, v32, v16
v_perm_b32 v61, v32, v32, v17
v_perm_b32 v62, v32, v32, v18
v_perm_b32 v63, v32, v32, v19
s_nop 1
v_mfma_f32_16x16x32_bf16 v[76:79], v[60:63], a[160:163], v[76:79]
v_perm_b32 v64, v50, v50, v16
v_perm_b32 v65, v50, v50, v17
v_perm_b32 v66, v50, v50, v18
v_perm_b32 v67, v50, v50, v19
s_nop 1
v_mfma_f32_16x16x32_bf16 v[80:83], v[64:67], a[160:163], v[80:83]
s_add_u32 m0, s12, 69632
s_add_u32 s6, s13, 1048576
buffer_load_dwordx4 v2, s[52:55], s6 offen nt lds
s_waitcnt vmcnt(51)
v_perm_b32 v68, v32, v32, v20
v_perm_b32 v69, v32, v32, v21
v_perm_b32 v70, v32, v32, v22
v_perm_b32 v71, v32, v32, v23
s_nop 1
v_mfma_f32_16x16x32_bf16 v[76:79], v[68:71], a[164:167], v[76:79]
v_perm_b32 v72, v50, v50, v20
v_perm_b32 v73, v50, v50, v21
v_perm_b32 v74, v50, v50, v22
v_perm_b32 v75, v50, v50, v23
s_nop 1
v_mfma_f32_16x16x32_bf16 v[80:83], v[72:75], a[164:167], v[80:83]
s_add_u32 m0, s12, 70720
s_add_u32 s6, s13, 1049600
buffer_load_dwordx4 v2, s[52:55], s6 offen nt lds
s_waitcnt vmcnt(51)
v_perm_b32 v60, v33, v33, v16
v_perm_b32 v61, v33, v33, v17
v_perm_b32 v62, v33, v33, v18
v_perm_b32 v63, v33, v33, v19
s_nop 1
v_mfma_f32_16x16x32_bf16 v[76:79], v[60:63], a[168:171], v[76:79]
v_perm_b32 v64, v51, v51, v16
v_perm_b32 v65, v51, v51, v17
v_perm_b32 v66, v51, v51, v18
v_perm_b32 v67, v51, v51, v19
s_nop 1
v_mfma_f32_16x16x32_bf16 v[80:83], v[64:67], a[168:171], v[80:83]
s_add_u32 m0, s12, 71808
s_add_u32 s6, s13, 1050624
buffer_load_dwordx4 v2, s[52:55], s6 offen nt lds
s_waitcnt vmcnt(51)
v_perm_b32 v68, v33, v33, v20
v_perm_b32 v69, v33, v33, v21
v_perm_b32 v70, v33, v33, v22
v_perm_b32 v71, v33, v33, v23
s_nop 1
v_mfma_f32_16x16x32_bf16 v[76:79], v[68:71], a[172:175], v[76:79]
v_perm_b32 v72, v51, v51, v20
v_perm_b32 v73, v51, v51, v21
v_perm_b32 v74, v51, v51, v22
v_perm_b32 v75, v51, v51, v23
s_nop 1
v_mfma_f32_16x16x32_bf16 v[80:83], v[72:75], a[172:175], v[80:83]
s_add_u32 m0, s12, 72896
s_add_u32 s6, s13, 1051648
buffer_load_dwordx4 v2, s[52:55], s6 offen nt lds
s_waitcnt vmcnt(51)
v_perm_b32 v60, v34, v34, v16
v_perm_b32 v61, v34, v34, v17
v_perm_b32 v62, v34, v34, v18
v_perm_b32 v63, v34, v34, v19
s_nop 1
v_mfma_f32_16x16x32_bf16 v[76:79], v[60:63], a[176:179], v[76:79]
v_perm_b32 v64, v52, v52, v16
v_perm_b32 v65, v52, v52, v17
v_perm_b32 v66, v52, v52, v18
v_perm_b32 v67, v52, v52, v19
s_nop 1
v_mfma_f32_16x16x32_bf16 v[80:83], v[64:67], a[176:179], v[80:83]
s_add_u32 m0, s12, 73984
s_add_u32 s6, s13, 1310720
buffer_load_dwordx4 v2, s[52:55], s6 offen nt lds
s_waitcnt vmcnt(51)
v_perm_b32 v68, v34, v34, v20
v_perm_b32 v69, v34, v34, v21
v_perm_b32 v70, v34, v34, v22
v_perm_b32 v71, v34, v34, v23
s_nop 1
v_mfma_f32_16x16x32_bf16 v[76:79], v[68:71], a[180:183], v[76:79]
v_perm_b32 v72, v52, v52, v20
v_perm_b32 v73, v52, v52, v21
v_perm_b32 v74, v52, v52, v22
v_perm_b32 v75, v52, v52, v23
s_nop 1
v_mfma_f32_16x16x32_bf16 v[80:83], v[72:75], a[180:183], v[80:83]
s_add_u32 m0, s12, 75072
s_add_u32 s6, s13, 1311744
buffer_load_dwordx4 v2, s[52:55], s6 offen nt lds
s_waitcnt vmcnt(51)
v_perm_b32 v60, v35, v35, v16
v_perm_b32 v61, v35, v35, v17
v_perm_b32 v62, v35, v35, v18
v_perm_b32 v63, v35, v35, v19
s_nop 1
v_mfma_f32_16x16x32_bf16 v[76:79], v[60:63], a[184:187], v[76:79]
v_perm_b32 v64, v53, v53, v16
v_perm_b32 v65, v53, v53, v17
v_perm_b32 v66, v53, v53, v18
v_perm_b32 v67, v53, v53, v19
s_nop 1
v_mfma_f32_16x16x32_bf16 v[80:83], v[64:67], a[184:187], v[80:83]
s_add_u32 m0, s12, 76160
s_add_u32 s6, s13, 1312768
buffer_load_dwordx4 v2, s[52:55], s6 offen nt lds
s_waitcnt vmcnt(51)
v_perm_b32 v68, v35, v35, v20
v_perm_b32 v69, v35, v35, v21
v_perm_b32 v70, v35, v35, v22
v_perm_b32 v71, v35, v35, v23
s_nop 1
v_mfma_f32_16x16x32_bf16 v[76:79], v[68:71], a[188:191], v[76:79]
v_perm_b32 v72, v53, v53, v20
v_perm_b32 v73, v53, v53, v21
v_perm_b32 v74, v53, v53, v22
v_perm_b32 v75, v53, v53, v23
s_nop 1
v_mfma_f32_16x16x32_bf16 v[80:83], v[72:75], a[188:191], v[80:83]
s_add_u32 m0, s12, 77248
s_add_u32 s6, s13, 1313792
buffer_load_dwordx4 v2, s[52:55], s6 offen nt lds
s_waitcnt vmcnt(51)
v_perm_b32 v60, v36, v36, v16
v_perm_b32 v61, v36, v36, v17
v_perm_b32 v62, v36, v36, v18
v_perm_b32 v63, v36, v36, v19
s_nop 1
v_mfma_f32_16x16x32_bf16 v[76:79], v[60:63], a[192:195], v[76:79]
v_perm_b32 v64, v54, v54, v16
v_perm_b32 v65, v54, v54, v17
v_perm_b32 v66, v54, v54, v18
v_perm_b32 v67, v54, v54, v19
s_nop 1
v_mfma_f32_16x16x32_bf16 v[80:83], v[64:67], a[192:195], v[80:83]
s_add_u32 m0, s12, 78336
s_add_u32 s6, s13, 1572864
buffer_load_dwordx4 v10, s[52:55], s6 offen nt lds
s_waitcnt vmcnt(51)
v_perm_b32 v68, v36, v36, v20
v_perm_b32 v69, v36, v36, v21
v_perm_b32 v70, v36, v36, v22
v_perm_b32 v71, v36, v36, v23
s_nop 1
v_mfma_f32_16x16x32_bf16 v[76:79], v[68:71], a[196:199], v[76:79]
v_perm_b32 v72, v54, v54, v20
v_perm_b32 v73, v54, v54, v21
v_perm_b32 v74, v54, v54, v22
v_perm_b32 v75, v54, v54, v23
s_nop 1
v_mfma_f32_16x16x32_bf16 v[80:83], v[72:75], a[196:199], v[80:83]
s_add_u32 m0, s12, 79424
s_add_u32 s6, s13, 1573888
buffer_load_dwordx4 v10, s[52:55], s6 offen nt lds
s_waitcnt vmcnt(51)
v_perm_b32 v60, v37, v37, v16
v_perm_b32 v61, v37, v37, v17
v_perm_b32 v62, v37, v37, v18
v_perm_b32 v63, v37, v37, v19
s_nop 1
v_mfma_f32_16x16x32_bf16 v[76:79], v[60:63], a[200:203], v[76:79]
v_perm_b32 v64, v55, v55, v16
v_perm_b32 v65, v55, v55, v17
v_perm_b32 v66, v55, v55, v18
v_perm_b32 v67, v55, v55, v19
s_nop 1
v_mfma_f32_16x16x32_bf16 v[80:83], v[64:67], a[200:203], v[80:83]
s_add_u32 m0, s12, 80512
s_add_u32 s6, s13, 1574912
buffer_load_dwordx4 v10, s[52:55], s6 offen nt lds
s_waitcnt vmcnt(51)
v_perm_b32 v68, v37, v37, v20
v_perm_b32 v69, v37, v37, v21
v_perm_b32 v70, v37, v37, v22
v_perm_b32 v71, v37, v37, v23
s_nop 1
v_mfma_f32_16x16x32_bf16 v[76:79], v[68:71], a[204:207], v[76:79]
v_perm_b32 v72, v55, v55, v20
v_perm_b32 v73, v55, v55, v21
v_perm_b32 v74, v55, v55, v22
v_perm_b32 v75, v55, v55, v23
s_nop 1
v_mfma_f32_16x16x32_bf16 v[80:83], v[72:75], a[204:207], v[80:83]
s_add_u32 m0, s12, 81600
s_add_u32 s6, s13, 1575936
buffer_load_dwordx4 v10, s[52:55], s6 offen nt lds
s_waitcnt vmcnt(51)
v_perm_b32 v60, v38, v38, v16
v_perm_b32 v61, v38, v38, v17
v_perm_b32 v62, v38, v38, v18
v_perm_b32 v63, v38, v38, v19
s_nop 1
v_mfma_f32_16x16x32_bf16 v[76:79], v[60:63], a[208:211], v[76:79]
v_perm_b32 v64, v56, v56, v16
v_perm_b32 v65, v56, v56, v17
v_perm_b32 v66, v56, v56, v18
v_perm_b32 v67, v56, v56, v19
s_nop 1
v_mfma_f32_16x16x32_bf16 v[80:83], v[64:67], a[208:211], v[80:83]
buffer_load_dword v11, off, s[68:71], 0 offset:0 sc1
s_add_u32 m0, s12, 82688
s_add_u32 s6, s13, 1835008
buffer_load_dwordx4 v10, s[52:55], s6 offen nt lds
s_waitcnt vmcnt(52)
v_perm_b32 v68, v38, v38, v20
v_perm_b32 v69, v38, v38, v21
v_perm_b32 v70, v38, v38, v22
v_perm_b32 v71, v38, v38, v23
s_nop 1
v_mfma_f32_16x16x32_bf16 v[76:79], v[68:71], a[212:215], v[76:79]
v_perm_b32 v72, v56, v56, v20
v_perm_b32 v73, v56, v56, v21
v_perm_b32 v74, v56, v56, v22
v_perm_b32 v75, v56, v56, v23
s_nop 1
v_mfma_f32_16x16x32_bf16 v[80:83], v[72:75], a[212:215], v[80:83]
s_add_u32 m0, s12, 83776
s_add_u32 s6, s13, 1836032
buffer_load_dwordx4 v10, s[52:55], s6 offen nt lds
s_waitcnt vmcnt(52)
v_perm_b32 v60, v39, v39, v16
v_perm_b32 v61, v39, v39, v17
v_perm_b32 v62, v39, v39, v18
v_perm_b32 v63, v39, v39, v19
s_nop 1
v_mfma_f32_16x16x32_bf16 v[76:79], v[60:63], a[216:219], v[76:79]
v_perm_b32 v64, v57, v57, v16
v_perm_b32 v65, v57, v57, v17
v_perm_b32 v66, v57, v57, v18
v_perm_b32 v67, v57, v57, v19
s_nop 1
v_mfma_f32_16x16x32_bf16 v[80:83], v[64:67], a[216:219], v[80:83]
s_add_u32 m0, s12, 84864
s_add_u32 s6, s13, 1837056
buffer_load_dwordx4 v10, s[52:55], s6 offen nt lds
s_waitcnt vmcnt(52)
v_perm_b32 v68, v39, v39, v20
v_perm_b32 v69, v39, v39, v21
v_perm_b32 v70, v39, v39, v22
v_perm_b32 v71, v39, v39, v23
s_nop 1
v_mfma_f32_16x16x32_bf16 v[76:79], v[68:71], a[220:223], v[76:79]
v_perm_b32 v72, v57, v57, v20
v_perm_b32 v73, v57, v57, v21
v_perm_b32 v74, v57, v57, v22
v_perm_b32 v75, v57, v57, v23
s_nop 1
v_mfma_f32_16x16x32_bf16 v[80:83], v[72:75], a[220:223], v[80:83]
s_add_u32 m0, s12, 85952
s_add_u32 s6, s13, 1838080
buffer_load_dwordx4 v10, s[52:55], s6 offen nt lds
s_waitcnt vmcnt(52)
v_perm_b32 v60, v40, v40, v16
v_perm_b32 v61, v40, v40, v17
v_perm_b32 v62, v40, v40, v18
v_perm_b32 v63, v40, v40, v19
s_nop 1
v_mfma_f32_16x16x32_bf16 v[76:79], v[60:63], a[224:227], v[76:79]
v_perm_b32 v64, v58, v58, v16
v_perm_b32 v65, v58, v58, v17
v_perm_b32 v66, v58, v58, v18
v_perm_b32 v67, v58, v58, v19
s_nop 1
v_mfma_f32_16x16x32_bf16 v[80:83], v[64:67], a[224:227], v[80:83]
s_waitcnt vmcnt(51)
v_perm_b32 v68, v40, v40, v20
v_perm_b32 v69, v40, v40, v21
v_perm_b32 v70, v40, v40, v22
v_perm_b32 v71, v40, v40, v23
s_nop 1
v_mfma_f32_16x16x32_bf16 v[76:79], v[68:71], a[228:231], v[76:79]
v_perm_b32 v72, v58, v58, v20
v_perm_b32 v73, v58, v58, v21
v_perm_b32 v74, v58, v58, v22
v_perm_b32 v75, v58, v58, v23
s_nop 1
v_mfma_f32_16x16x32_bf16 v[80:83], v[72:75], a[228:231], v[80:83]
s_waitcnt vmcnt(50)
v_perm_b32 v60, v41, v41, v16
v_perm_b32 v61, v41, v41, v17
v_perm_b32 v62, v41, v41, v18
v_perm_b32 v63, v41, v41, v19
s_nop 1
v_mfma_f32_16x16x32_bf16 v[76:79], v[60:63], a[232:235], v[76:79]
v_perm_b32 v64, v59, v59, v16
v_perm_b32 v65, v59, v59, v17
v_perm_b32 v66, v59, v59, v18
v_perm_b32 v67, v59, v59, v19
s_nop 1
v_mfma_f32_16x16x32_bf16 v[80:83], v[64:67], a[232:235], v[80:83]
s_waitcnt vmcnt(49)
v_perm_b32 v68, v41, v41, v20
v_perm_b32 v69, v41, v41, v21
v_perm_b32 v70, v41, v41, v22
v_perm_b32 v71, v41, v41, v23
s_nop 1
v_mfma_f32_16x16x32_bf16 v[76:79], v[68:71], a[236:239], v[76:79]
v_perm_b32 v72, v59, v59, v20
v_perm_b32 v73, v59, v59, v21
v_perm_b32 v74, v59, v59, v22
v_perm_b32 v75, v59, v59, v23
s_nop 1
v_mfma_f32_16x16x32_bf16 v[80:83], v[72:75], a[236:239], v[80:83]
v_lshlrev_b32 v5, 5, v8
v_and_b32 v6, 1, v9
v_lshl_add_u32 v6, v6, 4, v5
v_lshrrev_b32 v7, 5, v1
v_lshl_add_u32 v6, v7, 9, v6
s_lshl_b32 s6, s3, 11
s_add_u32 s6, s6, 139264
v_add_u32 v6, s6, v6
ds_write_b128 v6, v[76:79]
ds_write_b128 v6, v[80:83] offset:1024
v_add_u32 v5, 139264, v5
s_waitcnt lgkmcnt(0)
s_barrier
ds_read_b128 v[188:191], v5 offset:0
ds_read_b128 v[192:195], v5 offset:16
ds_read_b128 v[196:199], v5 offset:2048
ds_read_b128 v[200:203], v5 offset:2064
ds_read_b128 v[204:207], v5 offset:4096
ds_read_b128 v[208:211], v5 offset:4112
ds_read_b128 v[212:215], v5 offset:6144
ds_read_b128 v[216:219], v5 offset:6160
s_waitcnt lgkmcnt(0)
v_add_f32 v188, v188, v196
v_add_f32 v204, v204, v212
v_add_f32 v189, v189, v197
v_add_f32 v205, v205, v213
v_add_f32 v190, v190, v198
v_add_f32 v206, v206, v214
v_add_f32 v191, v191, v199
v_add_f32 v207, v207, v215
v_add_f32 v192, v192, v200
v_add_f32 v208, v208, v216
v_add_f32 v193, v193, v201
v_add_f32 v209, v209, v217
v_add_f32 v194, v194, v202
v_add_f32 v210, v210, v218
v_add_f32 v195, v195, v203
v_add_f32 v211, v211, v219
v_add_f32 v188, v188, v204
v_add_f32 v189, v189, v205
v_add_f32 v190, v190, v206
v_add_f32 v191, v191, v207
v_add_f32 v192, v192, v208
v_add_f32 v193, v193, v209
v_add_f32 v194, v194, v210
v_add_f32 v195, v195, v211
v_cvt_pk_bf16_f32 v148, v188, v189
v_cvt_pk_bf16_f32 v149, v190, v191
v_cvt_pk_bf16_f32 v150, v192, v193
v_cvt_pk_bf16_f32 v151, v194, v195
ds_read_b128 v[188:191], v5 offset:512
ds_read_b128 v[192:195], v5 offset:528
ds_read_b128 v[196:199], v5 offset:2560
ds_read_b128 v[200:203], v5 offset:2576
ds_read_b128 v[204:207], v5 offset:4608
ds_read_b128 v[208:211], v5 offset:4624
ds_read_b128 v[212:215], v5 offset:6656
ds_read_b128 v[216:219], v5 offset:6672
s_waitcnt lgkmcnt(0)
v_add_f32 v188, v188, v196
v_add_f32 v204, v204, v212
v_add_f32 v189, v189, v197
v_add_f32 v205, v205, v213
v_add_f32 v190, v190, v198
v_add_f32 v206, v206, v214
v_add_f32 v191, v191, v199
v_add_f32 v207, v207, v215
v_add_f32 v192, v192, v200
v_add_f32 v208, v208, v216
v_add_f32 v193, v193, v201
v_add_f32 v209, v209, v217
v_add_f32 v194, v194, v202
v_add_f32 v210, v210, v218
v_add_f32 v195, v195, v203
v_add_f32 v211, v211, v219
v_add_f32 v188, v188, v204
v_add_f32 v189, v189, v205
v_add_f32 v190, v190, v206
v_add_f32 v191, v191, v207
v_add_f32 v192, v192, v208
v_add_f32 v193, v193, v209
v_add_f32 v194, v194, v210
v_add_f32 v195, v195, v211
v_cvt_pk_bf16_f32 v152, v188, v189
v_cvt_pk_bf16_f32 v153, v190, v191
v_cvt_pk_bf16_f32 v154, v192, v193
v_cvt_pk_bf16_f32 v155, v194, v195
ds_read_b128 v[188:191], v5 offset:1024
ds_read_b128 v[192:195], v5 offset:1040
ds_read_b128 v[196:199], v5 offset:3072
ds_read_b128 v[200:203], v5 offset:3088
ds_read_b128 v[204:207], v5 offset:5120
ds_read_b128 v[208:211], v5 offset:5136
ds_read_b128 v[212:215], v5 offset:7168
ds_read_b128 v[216:219], v5 offset:7184
s_waitcnt lgkmcnt(0)
v_add_f32 v188, v188, v196
v_add_f32 v204, v204, v212
v_add_f32 v189, v189, v197
v_add_f32 v205, v205, v213
v_add_f32 v190, v190, v198
v_add_f32 v206, v206, v214
v_add_f32 v191, v191, v199
v_add_f32 v207, v207, v215
v_add_f32 v192, v192, v200
v_add_f32 v208, v208, v216
v_add_f32 v193, v193, v201
v_add_f32 v209, v209, v217
v_add_f32 v194, v194, v202
v_add_f32 v210, v210, v218
v_add_f32 v195, v195, v203
v_add_f32 v211, v211, v219
v_add_f32 v188, v188, v204
v_add_f32 v189, v189, v205
v_add_f32 v190, v190, v206
v_add_f32 v191, v191, v207
v_add_f32 v192, v192, v208
v_add_f32 v193, v193, v209
v_add_f32 v194, v194, v210
v_add_f32 v195, v195, v211
v_cvt_pk_bf16_f32 v156, v188, v189
v_cvt_pk_bf16_f32 v157, v190, v191
v_cvt_pk_bf16_f32 v158, v192, v193
v_cvt_pk_bf16_f32 v159, v194, v195
ds_read_b128 v[188:191], v5 offset:1536
ds_read_b128 v[192:195], v5 offset:1552
ds_read_b128 v[196:199], v5 offset:3584
ds_read_b128 v[200:203], v5 offset:3600
ds_read_b128 v[204:207], v5 offset:5632
ds_read_b128 v[208:211], v5 offset:5648
ds_read_b128 v[212:215], v5 offset:7680
ds_read_b128 v[216:219], v5 offset:7696
s_waitcnt lgkmcnt(0)
v_add_f32 v188, v188, v196
v_add_f32 v204, v204, v212
v_add_f32 v189, v189, v197
v_add_f32 v205, v205, v213
v_add_f32 v190, v190, v198
v_add_f32 v206, v206, v214
v_add_f32 v191, v191, v199
v_add_f32 v207, v207, v215
v_add_f32 v192, v192, v200
v_add_f32 v208, v208, v216
v_add_f32 v193, v193, v201
v_add_f32 v209, v209, v217
v_add_f32 v194, v194, v202
v_add_f32 v210, v210, v218
v_add_f32 v195, v195, v203
v_add_f32 v211, v211, v219
v_add_f32 v188, v188, v204
v_add_f32 v189, v189, v205
v_add_f32 v190, v190, v206
v_add_f32 v191, v191, v207
v_add_f32 v192, v192, v208
v_add_f32 v193, v193, v209
v_add_f32 v194, v194, v210
v_add_f32 v195, v195, v211
v_cvt_pk_bf16_f32 v160, v188, v189
v_cvt_pk_bf16_f32 v161, v190, v191
v_cvt_pk_bf16_f32 v162, v192, v193
v_cvt_pk_bf16_f32 v163, v194, v195
s_waitcnt vmcnt(33)
v_dot2_f32_bf16 v164, v84, v148, 0
v_dot2_f32_bf16 v165, v84, v152, 0
v_dot2_f32_bf16 v166, v84, v156, 0
v_dot2_f32_bf16 v167, v84, v160, 0
v_dot2_f32_bf16 v164, v85, v149, v164
v_dot2_f32_bf16 v165, v85, v153, v165
v_dot2_f32_bf16 v166, v85, v157, v166
v_dot2_f32_bf16 v167, v85, v161, v167
v_dot2_f32_bf16 v164, v86, v150, v164
v_dot2_f32_bf16 v165, v86, v154, v165
v_dot2_f32_bf16 v166, v86, v158, v166
v_dot2_f32_bf16 v167, v86, v162, v167
v_dot2_f32_bf16 v164, v87, v151, v164
v_dot2_f32_bf16 v165, v87, v155, v165
v_dot2_f32_bf16 v166, v87, v159, v166
v_dot2_f32_bf16 v167, v87, v163, v167
v_add_f32_dpp v168, v164, v164 row_ror:8 row_mask:0xf bank_mask:0x3
v_add_f32_dpp v169, v165, v165 row_ror:8 row_mask:0xf bank_mask:0x3
v_add_f32_dpp v168, v166, v166 row_ror:8 row_mask:0xf bank_mask:0xc
v_add_f32_dpp v169, v167, v167 row_ror:8 row_mask:0xf bank_mask:0xc
s_nop 0
v_add_f32_dpp v172, v168, v168 row_half_mirror row_mask:0xf bank_mask:0x5
v_add_f32_dpp v172, v169, v169 row_half_mirror row_mask:0xf bank_mask:0xa
s_nop 1
v_add_f32_dpp v172, v172, v172 quad_perm:[1,0,3,2] row_mask:0xf bank_mask:0xf
s_nop 1
v_add_f32_dpp v172, v172, v172 quad_perm:[2,3,0,1] row_mask:0xf bank_mask:0xf
v_dot2_f32_bf16 v164, v88, v148, 0
v_dot2_f32_bf16 v165, v88, v152, 0
v_dot2_f32_bf16 v166, v88, v156, 0
v_dot2_f32_bf16 v167, v88, v160, 0
v_dot2_f32_bf16 v164, v89, v149, v164
v_dot2_f32_bf16 v165, v89, v153, v165
v_dot2_f32_bf16 v166, v89, v157, v166
v_dot2_f32_bf16 v167, v89, v161, v167
v_dot2_f32_bf16 v164, v90, v150, v164
v_dot2_f32_bf16 v165, v90, v154, v165
v_dot2_f32_bf16 v166, v90, v158, v166
v_dot2_f32_bf16 v167, v90, v162, v167
v_dot2_f32_bf16 v164, v91, v151, v164
v_dot2_f32_bf16 v165, v91, v155, v165
v_dot2_f32_bf16 v166, v91, v159, v166
v_dot2_f32_bf16 v167, v91, v163, v167
v_add_f32_dpp v168, v164, v164 row_ror:8 row_mask:0xf bank_mask:0x3
v_add_f32_dpp v169, v165, v165 row_ror:8 row_mask:0xf bank_mask:0x3
v_add_f32_dpp v168, v166, v166 row_ror:8 row_mask:0xf bank_mask:0xc
v_add_f32_dpp v169, v167, v167 row_ror:8 row_mask:0xf bank_mask:0xc
s_nop 0
v_add_f32_dpp v173, v168, v168 row_half_mirror row_mask:0xf bank_mask:0x5
v_add_f32_dpp v173, v169, v169 row_half_mirror row_mask:0xf bank_mask:0xa
s_nop 1
v_add_f32_dpp v173, v173, v173 quad_perm:[1,0,3,2] row_mask:0xf bank_mask:0xf
s_nop 1
v_add_f32_dpp v173, v173, v173 quad_perm:[2,3,0,1] row_mask:0xf bank_mask:0xf
v_dot2_f32_bf16 v164, v92, v148, 0
v_dot2_f32_bf16 v165, v92, v152, 0
v_dot2_f32_bf16 v166, v92, v156, 0
v_dot2_f32_bf16 v167, v92, v160, 0
v_dot2_f32_bf16 v164, v93, v149, v164
v_dot2_f32_bf16 v165, v93, v153, v165
v_dot2_f32_bf16 v166, v93, v157, v166
v_dot2_f32_bf16 v167, v93, v161, v167
v_dot2_f32_bf16 v164, v94, v150, v164
v_dot2_f32_bf16 v165, v94, v154, v165
v_dot2_f32_bf16 v166, v94, v158, v166
v_dot2_f32_bf16 v167, v94, v162, v167
v_dot2_f32_bf16 v164, v95, v151, v164
v_dot2_f32_bf16 v165, v95, v155, v165
v_dot2_f32_bf16 v166, v95, v159, v166
v_dot2_f32_bf16 v167, v95, v163, v167
v_add_f32_dpp v168, v164, v164 row_ror:8 row_mask:0xf bank_mask:0x3
v_add_f32_dpp v169, v165, v165 row_ror:8 row_mask:0xf bank_mask:0x3
v_add_f32_dpp v168, v166, v166 row_ror:8 row_mask:0xf bank_mask:0xc
v_add_f32_dpp v169, v167, v167 row_ror:8 row_mask:0xf bank_mask:0xc
s_nop 0
v_add_f32_dpp v174, v168, v168 row_half_mirror row_mask:0xf bank_mask:0x5
v_add_f32_dpp v174, v169, v169 row_half_mirror row_mask:0xf bank_mask:0xa
s_nop 1
v_add_f32_dpp v174, v174, v174 quad_perm:[1,0,3,2] row_mask:0xf bank_mask:0xf
s_nop 1
v_add_f32_dpp v174, v174, v174 quad_perm:[2,3,0,1] row_mask:0xf bank_mask:0xf
v_dot2_f32_bf16 v164, v96, v148, 0
v_dot2_f32_bf16 v165, v96, v152, 0
v_dot2_f32_bf16 v166, v96, v156, 0
v_dot2_f32_bf16 v167, v96, v160, 0
v_dot2_f32_bf16 v164, v97, v149, v164
v_dot2_f32_bf16 v165, v97, v153, v165
v_dot2_f32_bf16 v166, v97, v157, v166
v_dot2_f32_bf16 v167, v97, v161, v167
v_dot2_f32_bf16 v164, v98, v150, v164
v_dot2_f32_bf16 v165, v98, v154, v165
v_dot2_f32_bf16 v166, v98, v158, v166
v_dot2_f32_bf16 v167, v98, v162, v167
v_dot2_f32_bf16 v164, v99, v151, v164
v_dot2_f32_bf16 v165, v99, v155, v165
v_dot2_f32_bf16 v166, v99, v159, v166
v_dot2_f32_bf16 v167, v99, v163, v167
v_add_f32_dpp v168, v164, v164 row_ror:8 row_mask:0xf bank_mask:0x3
v_add_f32_dpp v169, v165, v165 row_ror:8 row_mask:0xf bank_mask:0x3
v_add_f32_dpp v168, v166, v166 row_ror:8 row_mask:0xf bank_mask:0xc
v_add_f32_dpp v169, v167, v167 row_ror:8 row_mask:0xf bank_mask:0xc
s_nop 0
v_add_f32_dpp v175, v168, v168 row_half_mirror row_mask:0xf bank_mask:0x5
v_add_f32_dpp v175, v169, v169 row_half_mirror row_mask:0xf bank_mask:0xa
s_nop 1
v_add_f32_dpp v175, v175, v175 quad_perm:[1,0,3,2] row_mask:0xf bank_mask:0xf
s_nop 1
v_add_f32_dpp v175, v175, v175 quad_perm:[2,3,0,1] row_mask:0xf bank_mask:0xf
v_dot2_f32_bf16 v164, v100, v148, 0
v_dot2_f32_bf16 v165, v100, v152, 0
v_dot2_f32_bf16 v166, v100, v156, 0
v_dot2_f32_bf16 v167, v100, v160, 0
v_dot2_f32_bf16 v164, v101, v149, v164
v_dot2_f32_bf16 v165, v101, v153, v165
v_dot2_f32_bf16 v166, v101, v157, v166
v_dot2_f32_bf16 v167, v101, v161, v167
v_dot2_f32_bf16 v164, v102, v150, v164
v_dot2_f32_bf16 v165, v102, v154, v165
v_dot2_f32_bf16 v166, v102, v158, v166
v_dot2_f32_bf16 v167, v102, v162, v167
v_dot2_f32_bf16 v164, v103, v151, v164
v_dot2_f32_bf16 v165, v103, v155, v165
v_dot2_f32_bf16 v166, v103, v159, v166
v_dot2_f32_bf16 v167, v103, v163, v167
v_add_f32_dpp v168, v164, v164 row_ror:8 row_mask:0xf bank_mask:0x3
v_add_f32_dpp v169, v165, v165 row_ror:8 row_mask:0xf bank_mask:0x3
v_add_f32_dpp v168, v166, v166 row_ror:8 row_mask:0xf bank_mask:0xc
v_add_f32_dpp v169, v167, v167 row_ror:8 row_mask:0xf bank_mask:0xc
s_nop 0
v_add_f32_dpp v176, v168, v168 row_half_mirror row_mask:0xf bank_mask:0x5
v_add_f32_dpp v176, v169, v169 row_half_mirror row_mask:0xf bank_mask:0xa
s_nop 1
v_add_f32_dpp v176, v176, v176 quad_perm:[1,0,3,2] row_mask:0xf bank_mask:0xf
s_nop 1
v_add_f32_dpp v176, v176, v176 quad_perm:[2,3,0,1] row_mask:0xf bank_mask:0xf
v_dot2_f32_bf16 v164, v104, v148, 0
v_dot2_f32_bf16 v165, v104, v152, 0
v_dot2_f32_bf16 v166, v104, v156, 0
v_dot2_f32_bf16 v167, v104, v160, 0
v_dot2_f32_bf16 v164, v105, v149, v164
v_dot2_f32_bf16 v165, v105, v153, v165
v_dot2_f32_bf16 v166, v105, v157, v166
v_dot2_f32_bf16 v167, v105, v161, v167
v_dot2_f32_bf16 v164, v106, v150, v164
v_dot2_f32_bf16 v165, v106, v154, v165
v_dot2_f32_bf16 v166, v106, v158, v166
v_dot2_f32_bf16 v167, v106, v162, v167
v_dot2_f32_bf16 v164, v107, v151, v164
v_dot2_f32_bf16 v165, v107, v155, v165
v_dot2_f32_bf16 v166, v107, v159, v166
v_dot2_f32_bf16 v167, v107, v163, v167
v_add_f32_dpp v168, v164, v164 row_ror:8 row_mask:0xf bank_mask:0x3
v_add_f32_dpp v169, v165, v165 row_ror:8 row_mask:0xf bank_mask:0x3
v_add_f32_dpp v168, v166, v166 row_ror:8 row_mask:0xf bank_mask:0xc
v_add_f32_dpp v169, v167, v167 row_ror:8 row_mask:0xf bank_mask:0xc
s_nop 0
v_add_f32_dpp v177, v168, v168 row_half_mirror row_mask:0xf bank_mask:0x5
v_add_f32_dpp v177, v169, v169 row_half_mirror row_mask:0xf bank_mask:0xa
s_nop 1
v_add_f32_dpp v177, v177, v177 quad_perm:[1,0,3,2] row_mask:0xf bank_mask:0xf
s_nop 1
v_add_f32_dpp v177, v177, v177 quad_perm:[2,3,0,1] row_mask:0xf bank_mask:0xf
v_dot2_f32_bf16 v164, v108, v148, 0
v_dot2_f32_bf16 v165, v108, v152, 0
v_dot2_f32_bf16 v166, v108, v156, 0
v_dot2_f32_bf16 v167, v108, v160, 0
v_dot2_f32_bf16 v164, v109, v149, v164
v_dot2_f32_bf16 v165, v109, v153, v165
v_dot2_f32_bf16 v166, v109, v157, v166
v_dot2_f32_bf16 v167, v109, v161, v167
v_dot2_f32_bf16 v164, v110, v150, v164
v_dot2_f32_bf16 v165, v110, v154, v165
v_dot2_f32_bf16 v166, v110, v158, v166
v_dot2_f32_bf16 v167, v110, v162, v167
v_dot2_f32_bf16 v164, v111, v151, v164
v_dot2_f32_bf16 v165, v111, v155, v165
v_dot2_f32_bf16 v166, v111, v159, v166
v_dot2_f32_bf16 v167, v111, v163, v167
v_add_f32_dpp v168, v164, v164 row_ror:8 row_mask:0xf bank_mask:0x3
v_add_f32_dpp v169, v165, v165 row_ror:8 row_mask:0xf bank_mask:0x3
v_add_f32_dpp v168, v166, v166 row_ror:8 row_mask:0xf bank_mask:0xc
v_add_f32_dpp v169, v167, v167 row_ror:8 row_mask:0xf bank_mask:0xc
s_nop 0
v_add_f32_dpp v178, v168, v168 row_half_mirror row_mask:0xf bank_mask:0x5
v_add_f32_dpp v178, v169, v169 row_half_mirror row_mask:0xf bank_mask:0xa
s_nop 1
v_add_f32_dpp v178, v178, v178 quad_perm:[1,0,3,2] row_mask:0xf bank_mask:0xf
s_nop 1
v_add_f32_dpp v178, v178, v178 quad_perm:[2,3,0,1] row_mask:0xf bank_mask:0xf
v_dot2_f32_bf16 v164, v112, v148, 0
v_dot2_f32_bf16 v165, v112, v152, 0
v_dot2_f32_bf16 v166, v112, v156, 0
v_dot2_f32_bf16 v167, v112, v160, 0
v_dot2_f32_bf16 v164, v113, v149, v164
v_dot2_f32_bf16 v165, v113, v153, v165
v_dot2_f32_bf16 v166, v113, v157, v166
v_dot2_f32_bf16 v167, v113, v161, v167
v_dot2_f32_bf16 v164, v114, v150, v164
v_dot2_f32_bf16 v165, v114, v154, v165
v_dot2_f32_bf16 v166, v114, v158, v166
v_dot2_f32_bf16 v167, v114, v162, v167
v_dot2_f32_bf16 v164, v115, v151, v164
v_dot2_f32_bf16 v165, v115, v155, v165
v_dot2_f32_bf16 v166, v115, v159, v166
v_dot2_f32_bf16 v167, v115, v163, v167
v_add_f32_dpp v168, v164, v164 row_ror:8 row_mask:0xf bank_mask:0x3
v_add_f32_dpp v169, v165, v165 row_ror:8 row_mask:0xf bank_mask:0x3
v_add_f32_dpp v168, v166, v166 row_ror:8 row_mask:0xf bank_mask:0xc
v_add_f32_dpp v169, v167, v167 row_ror:8 row_mask:0xf bank_mask:0xc
s_nop 0
v_add_f32_dpp v179, v168, v168 row_half_mirror row_mask:0xf bank_mask:0x5
v_add_f32_dpp v179, v169, v169 row_half_mirror row_mask:0xf bank_mask:0xa
s_nop 1
v_add_f32_dpp v179, v179, v179 quad_perm:[1,0,3,2] row_mask:0xf bank_mask:0xf
s_nop 1
v_add_f32_dpp v179, v179, v179 quad_perm:[2,3,0,1] row_mask:0xf bank_mask:0xf
v_dot2_f32_bf16 v164, v116, v148, 0
v_dot2_f32_bf16 v165, v116, v152, 0
v_dot2_f32_bf16 v166, v116, v156, 0
v_dot2_f32_bf16 v167, v116, v160, 0
v_dot2_f32_bf16 v164, v117, v149, v164
v_dot2_f32_bf16 v165, v117, v153, v165
v_dot2_f32_bf16 v166, v117, v157, v166
v_dot2_f32_bf16 v167, v117, v161, v167
v_dot2_f32_bf16 v164, v118, v150, v164
v_dot2_f32_bf16 v165, v118, v154, v165
v_dot2_f32_bf16 v166, v118, v158, v166
v_dot2_f32_bf16 v167, v118, v162, v167
v_dot2_f32_bf16 v164, v119, v151, v164
v_dot2_f32_bf16 v165, v119, v155, v165
v_dot2_f32_bf16 v166, v119, v159, v166
v_dot2_f32_bf16 v167, v119, v163, v167
v_add_f32_dpp v168, v164, v164 row_ror:8 row_mask:0xf bank_mask:0x3
v_add_f32_dpp v169, v165, v165 row_ror:8 row_mask:0xf bank_mask:0x3
v_add_f32_dpp v168, v166, v166 row_ror:8 row_mask:0xf bank_mask:0xc
v_add_f32_dpp v169, v167, v167 row_ror:8 row_mask:0xf bank_mask:0xc
s_nop 0
v_add_f32_dpp v180, v168, v168 row_half_mirror row_mask:0xf bank_mask:0x5
v_add_f32_dpp v180, v169, v169 row_half_mirror row_mask:0xf bank_mask:0xa
s_nop 1
v_add_f32_dpp v180, v180, v180 quad_perm:[1,0,3,2] row_mask:0xf bank_mask:0xf
s_nop 1
v_add_f32_dpp v180, v180, v180 quad_perm:[2,3,0,1] row_mask:0xf bank_mask:0xf
v_dot2_f32_bf16 v164, v120, v148, 0
v_dot2_f32_bf16 v165, v120, v152, 0
v_dot2_f32_bf16 v166, v120, v156, 0
v_dot2_f32_bf16 v167, v120, v160, 0
v_dot2_f32_bf16 v164, v121, v149, v164
v_dot2_f32_bf16 v165, v121, v153, v165
v_dot2_f32_bf16 v166, v121, v157, v166
v_dot2_f32_bf16 v167, v121, v161, v167
v_dot2_f32_bf16 v164, v122, v150, v164
v_dot2_f32_bf16 v165, v122, v154, v165
v_dot2_f32_bf16 v166, v122, v158, v166
v_dot2_f32_bf16 v167, v122, v162, v167
v_dot2_f32_bf16 v164, v123, v151, v164
v_dot2_f32_bf16 v165, v123, v155, v165
v_dot2_f32_bf16 v166, v123, v159, v166
v_dot2_f32_bf16 v167, v123, v163, v167
v_add_f32_dpp v168, v164, v164 row_ror:8 row_mask:0xf bank_mask:0x3
v_add_f32_dpp v169, v165, v165 row_ror:8 row_mask:0xf bank_mask:0x3
v_add_f32_dpp v168, v166, v166 row_ror:8 row_mask:0xf bank_mask:0xc
v_add_f32_dpp v169, v167, v167 row_ror:8 row_mask:0xf bank_mask:0xc
s_nop 0
v_add_f32_dpp v181, v168, v168 row_half_mirror row_mask:0xf bank_mask:0x5
v_add_f32_dpp v181, v169, v169 row_half_mirror row_mask:0xf bank_mask:0xa
s_nop 1
v_add_f32_dpp v181, v181, v181 quad_perm:[1,0,3,2] row_mask:0xf bank_mask:0xf
s_nop 1
v_add_f32_dpp v181, v181, v181 quad_perm:[2,3,0,1] row_mask:0xf bank_mask:0xf
v_dot2_f32_bf16 v164, v124, v148, 0
v_dot2_f32_bf16 v165, v124, v152, 0
v_dot2_f32_bf16 v166, v124, v156, 0
v_dot2_f32_bf16 v167, v124, v160, 0
v_dot2_f32_bf16 v164, v125, v149, v164
v_dot2_f32_bf16 v165, v125, v153, v165
v_dot2_f32_bf16 v166, v125, v157, v166
v_dot2_f32_bf16 v167, v125, v161, v167
v_dot2_f32_bf16 v164, v126, v150, v164
v_dot2_f32_bf16 v165, v126, v154, v165
v_dot2_f32_bf16 v166, v126, v158, v166
v_dot2_f32_bf16 v167, v126, v162, v167
v_dot2_f32_bf16 v164, v127, v151, v164
v_dot2_f32_bf16 v165, v127, v155, v165
v_dot2_f32_bf16 v166, v127, v159, v166
v_dot2_f32_bf16 v167, v127, v163, v167
v_add_f32_dpp v168, v164, v164 row_ror:8 row_mask:0xf bank_mask:0x3
v_add_f32_dpp v169, v165, v165 row_ror:8 row_mask:0xf bank_mask:0x3
v_add_f32_dpp v168, v166, v166 row_ror:8 row_mask:0xf bank_mask:0xc
v_add_f32_dpp v169, v167, v167 row_ror:8 row_mask:0xf bank_mask:0xc
s_nop 0
v_add_f32_dpp v182, v168, v168 row_half_mirror row_mask:0xf bank_mask:0x5
v_add_f32_dpp v182, v169, v169 row_half_mirror row_mask:0xf bank_mask:0xa
s_nop 1
v_add_f32_dpp v182, v182, v182 quad_perm:[1,0,3,2] row_mask:0xf bank_mask:0xf
s_nop 1
v_add_f32_dpp v182, v182, v182 quad_perm:[2,3,0,1] row_mask:0xf bank_mask:0xf
v_dot2_f32_bf16 v164, v128, v148, 0
v_dot2_f32_bf16 v165, v128, v152, 0
v_dot2_f32_bf16 v166, v128, v156, 0
v_dot2_f32_bf16 v167, v128, v160, 0
v_dot2_f32_bf16 v164, v129, v149, v164
v_dot2_f32_bf16 v165, v129, v153, v165
v_dot2_f32_bf16 v166, v129, v157, v166
v_dot2_f32_bf16 v167, v129, v161, v167
v_dot2_f32_bf16 v164, v130, v150, v164
v_dot2_f32_bf16 v165, v130, v154, v165
v_dot2_f32_bf16 v166, v130, v158, v166
v_dot2_f32_bf16 v167, v130, v162, v167
v_dot2_f32_bf16 v164, v131, v151, v164
v_dot2_f32_bf16 v165, v131, v155, v165
v_dot2_f32_bf16 v166, v131, v159, v166
v_dot2_f32_bf16 v167, v131, v163, v167
v_add_f32_dpp v168, v164, v164 row_ror:8 row_mask:0xf bank_mask:0x3
v_add_f32_dpp v169, v165, v165 row_ror:8 row_mask:0xf bank_mask:0x3
v_add_f32_dpp v168, v166, v166 row_ror:8 row_mask:0xf bank_mask:0xc
v_add_f32_dpp v169, v167, v167 row_ror:8 row_mask:0xf bank_mask:0xc
s_nop 0
v_add_f32_dpp v183, v168, v168 row_half_mirror row_mask:0xf bank_mask:0x5
v_add_f32_dpp v183, v169, v169 row_half_mirror row_mask:0xf bank_mask:0xa
s_nop 1
v_add_f32_dpp v183, v183, v183 quad_perm:[1,0,3,2] row_mask:0xf bank_mask:0xf
s_nop 1
v_add_f32_dpp v183, v183, v183 quad_perm:[2,3,0,1] row_mask:0xf bank_mask:0xf
v_dot2_f32_bf16 v164, v132, v148, 0
v_dot2_f32_bf16 v165, v132, v152, 0
v_dot2_f32_bf16 v166, v132, v156, 0
v_dot2_f32_bf16 v167, v132, v160, 0
v_dot2_f32_bf16 v164, v133, v149, v164
v_dot2_f32_bf16 v165, v133, v153, v165
v_dot2_f32_bf16 v166, v133, v157, v166
v_dot2_f32_bf16 v167, v133, v161, v167
v_dot2_f32_bf16 v164, v134, v150, v164
v_dot2_f32_bf16 v165, v134, v154, v165
v_dot2_f32_bf16 v166, v134, v158, v166
v_dot2_f32_bf16 v167, v134, v162, v167
v_dot2_f32_bf16 v164, v135, v151, v164
v_dot2_f32_bf16 v165, v135, v155, v165
v_dot2_f32_bf16 v166, v135, v159, v166
v_dot2_f32_bf16 v167, v135, v163, v167
v_add_f32_dpp v168, v164, v164 row_ror:8 row_mask:0xf bank_mask:0x3
v_add_f32_dpp v169, v165, v165 row_ror:8 row_mask:0xf bank_mask:0x3
v_add_f32_dpp v168, v166, v166 row_ror:8 row_mask:0xf bank_mask:0xc
v_add_f32_dpp v169, v167, v167 row_ror:8 row_mask:0xf bank_mask:0xc
s_nop 0
v_add_f32_dpp v184, v168, v168 row_half_mirror row_mask:0xf bank_mask:0x5
v_add_f32_dpp v184, v169, v169 row_half_mirror row_mask:0xf bank_mask:0xa
s_nop 1
v_add_f32_dpp v184, v184, v184 quad_perm:[1,0,3,2] row_mask:0xf bank_mask:0xf
s_nop 1
v_add_f32_dpp v184, v184, v184 quad_perm:[2,3,0,1] row_mask:0xf bank_mask:0xf
v_dot2_f32_bf16 v164, v136, v148, 0
v_dot2_f32_bf16 v165, v136, v152, 0
v_dot2_f32_bf16 v166, v136, v156, 0
v_dot2_f32_bf16 v167, v136, v160, 0
v_dot2_f32_bf16 v164, v137, v149, v164
v_dot2_f32_bf16 v165, v137, v153, v165
v_dot2_f32_bf16 v166, v137, v157, v166
v_dot2_f32_bf16 v167, v137, v161, v167
v_dot2_f32_bf16 v164, v138, v150, v164
v_dot2_f32_bf16 v165, v138, v154, v165
v_dot2_f32_bf16 v166, v138, v158, v166
v_dot2_f32_bf16 v167, v138, v162, v167
v_dot2_f32_bf16 v164, v139, v151, v164
v_dot2_f32_bf16 v165, v139, v155, v165
v_dot2_f32_bf16 v166, v139, v159, v166
v_dot2_f32_bf16 v167, v139, v163, v167
v_add_f32_dpp v168, v164, v164 row_ror:8 row_mask:0xf bank_mask:0x3
v_add_f32_dpp v169, v165, v165 row_ror:8 row_mask:0xf bank_mask:0x3
v_add_f32_dpp v168, v166, v166 row_ror:8 row_mask:0xf bank_mask:0xc
v_add_f32_dpp v169, v167, v167 row_ror:8 row_mask:0xf bank_mask:0xc
s_nop 0
v_add_f32_dpp v185, v168, v168 row_half_mirror row_mask:0xf bank_mask:0x5
v_add_f32_dpp v185, v169, v169 row_half_mirror row_mask:0xf bank_mask:0xa
s_nop 1
v_add_f32_dpp v185, v185, v185 quad_perm:[1,0,3,2] row_mask:0xf bank_mask:0xf
s_nop 1
v_add_f32_dpp v185, v185, v185 quad_perm:[2,3,0,1] row_mask:0xf bank_mask:0xf
v_dot2_f32_bf16 v164, v140, v148, 0
v_dot2_f32_bf16 v165, v140, v152, 0
v_dot2_f32_bf16 v166, v140, v156, 0
v_dot2_f32_bf16 v167, v140, v160, 0
v_dot2_f32_bf16 v164, v141, v149, v164
v_dot2_f32_bf16 v165, v141, v153, v165
v_dot2_f32_bf16 v166, v141, v157, v166
v_dot2_f32_bf16 v167, v141, v161, v167
v_dot2_f32_bf16 v164, v142, v150, v164
v_dot2_f32_bf16 v165, v142, v154, v165
v_dot2_f32_bf16 v166, v142, v158, v166
v_dot2_f32_bf16 v167, v142, v162, v167
v_dot2_f32_bf16 v164, v143, v151, v164
v_dot2_f32_bf16 v165, v143, v155, v165
v_dot2_f32_bf16 v166, v143, v159, v166
v_dot2_f32_bf16 v167, v143, v163, v167
v_add_f32_dpp v168, v164, v164 row_ror:8 row_mask:0xf bank_mask:0x3
v_add_f32_dpp v169, v165, v165 row_ror:8 row_mask:0xf bank_mask:0x3
v_add_f32_dpp v168, v166, v166 row_ror:8 row_mask:0xf bank_mask:0xc
v_add_f32_dpp v169, v167, v167 row_ror:8 row_mask:0xf bank_mask:0xc
s_nop 0
v_add_f32_dpp v186, v168, v168 row_half_mirror row_mask:0xf bank_mask:0x5
v_add_f32_dpp v186, v169, v169 row_half_mirror row_mask:0xf bank_mask:0xa
s_nop 1
v_add_f32_dpp v186, v186, v186 quad_perm:[1,0,3,2] row_mask:0xf bank_mask:0xf
s_nop 1
v_add_f32_dpp v186, v186, v186 quad_perm:[2,3,0,1] row_mask:0xf bank_mask:0xf
v_dot2_f32_bf16 v164, v144, v148, 0
v_dot2_f32_bf16 v165, v144, v152, 0
v_dot2_f32_bf16 v166, v144, v156, 0
v_dot2_f32_bf16 v167, v144, v160, 0
v_dot2_f32_bf16 v164, v145, v149, v164
v_dot2_f32_bf16 v165, v145, v153, v165
v_dot2_f32_bf16 v166, v145, v157, v166
v_dot2_f32_bf16 v167, v145, v161, v167
v_dot2_f32_bf16 v164, v146, v150, v164
v_dot2_f32_bf16 v165, v146, v154, v165
v_dot2_f32_bf16 v166, v146, v158, v166
v_dot2_f32_bf16 v167, v146, v162, v167
v_dot2_f32_bf16 v164, v147, v151, v164
v_dot2_f32_bf16 v165, v147, v155, v165
v_dot2_f32_bf16 v166, v147, v159, v166
v_dot2_f32_bf16 v167, v147, v163, v167
v_add_f32_dpp v168, v164, v164 row_ror:8 row_mask:0xf bank_mask:0x3
v_add_f32_dpp v169, v165, v165 row_ror:8 row_mask:0xf bank_mask:0x3
v_add_f32_dpp v168, v166, v166 row_ror:8 row_mask:0xf bank_mask:0xc
v_add_f32_dpp v169, v167, v167 row_ror:8 row_mask:0xf bank_mask:0xc
s_nop 0
v_add_f32_dpp v187, v168, v168 row_half_mirror row_mask:0xf bank_mask:0x5
v_add_f32_dpp v187, v169, v169 row_half_mirror row_mask:0xf bank_mask:0xa
s_nop 1
v_add_f32_dpp v187, v187, v187 quad_perm:[1,0,3,2] row_mask:0xf bank_mask:0xf
s_nop 1
v_add_f32_dpp v187, v187, v187 quad_perm:[2,3,0,1] row_mask:0xf bank_mask:0xf
v_cvt_pk_bf16_f32 v188, v172, v173
v_cvt_pk_bf16_f32 v189, v174, v175
v_cvt_pk_bf16_f32 v190, v176, v177
v_cvt_pk_bf16_f32 v191, v178, v179
v_cvt_pk_bf16_f32 v192, v180, v181
v_cvt_pk_bf16_f32 v193, v182, v183
v_cvt_pk_bf16_f32 v194, v184, v185
v_cvt_pk_bf16_f32 v195, v186, v187
v_min_u32 v188, -2, v188
v_min_u32 v189, -2, v189
v_min_u32 v190, -2, v190
v_min_u32 v191, -2, v191
v_min_u32 v192, -2, v192
v_min_u32 v193, -2, v193
v_min_u32 v194, -2, v194
v_min_u32 v195, -2, v195
v_bfe_u32 v5, v1, 2, 2
v_lshlrev_b32 v5, 15, v5
v_lshl_add_u32 v5, v9, 5, v5
s_lshl_b32 s6, s4, 10
s_lshl_b32 s7, s8, 9
s_add_u32 s6, s6, s7
s_lshl_b32 s7, s3, 7
s_add_u32 s6, s6, s7
s_add_u32 s6, s6, 0
s_mov_b32 exec_lo, 0x11111111
s_mov_b32 exec_hi, 0x11111111
buffer_store_dwordx4 v[188:191], v5, s[64:67], s6 offen sc1
buffer_store_dwordx4 v[192:195], v5, s[64:67], s6 offen offset:16 sc1
s_mov_b64 exec, -1
s_waitcnt vmcnt(6)
s_mov_b32 s7, 400000
L_ens_18:
v_readfirstlane_b32 s6, v11
s_cmp_ge_u32 s6, 128
s_cbranch_scc1 L_ensd_19
s_sleep 16
buffer_load_dword v11, off, s[68:71], 0 offset:0 sc1
s_waitcnt vmcnt(0)
s_sub_u32 s7, s7, 1
s_cmp_lg_u32 s7, 0
s_cbranch_scc1 L_ens_18
L_ensd_19:
s_lshl_b32 s14, s10, 15
s_lshl_b32 s6, s3, 12
s_add_u32 s14, s14, s6
s_add_u32 s14, s14, 0
s_add_u32 s15, s14, 16384
s_nop 1
buffer_load_dwordx4 v[84:87], v2, s[64:67], s14 offen offset:0 sc1
buffer_load_dwordx4 v[88:91], v2, s[64:67], s14 offen offset:1024 sc1
buffer_load_dwordx4 v[92:95], v2, s[64:67], s14 offen offset:2048 sc1
buffer_load_dwordx4 v[96:99], v2, s[64:67], s14 offen offset:3072 sc1
buffer_load_dwordx4 v[100:103], v2, s[64:67], s15 offen offset:0 sc1
buffer_load_dwordx4 v[104:107], v2, s[64:67], s15 offen offset:1024 sc1
buffer_load_dwordx4 v[108:111], v2, s[64:67], s15 offen offset:2048 sc1
buffer_load_dwordx4 v[112:115], v2, s[64:67], s15 offen offset:3072 sc1
s_add_u32 s6, s13, 2097152
buffer_load_dwordx4 a[128:131], v2, s[52:55], s6 offen nt
s_add_u32 s6, s13, 2098176
buffer_load_dwordx4 a[132:135], v2, s[52:55], s6 offen nt
s_add_u32 s6, s13, 2099200
buffer_load_dwordx4 a[136:139], v2, s[52:55], s6 offen nt
s_add_u32 s6, s13, 2100224
buffer_load_dwordx4 a[140:143], v2, s[52:55], s6 offen nt
s_add_u32 s6, s13, 2359296
buffer_load_dwordx4 a[144:147], v2, s[52:55], s6 offen nt
s_add_u32 s6, s13, 2360320
buffer_load_dwordx4 a[148:151], v2, s[52:55], s6 offen nt
s_add_u32 s6, s13, 2361344
buffer_load_dwordx4 a[152:155], v2, s[52:55], s6 offen nt
s_add_u32 s6, s13, 2362368
buffer_load_dwordx4 a[156:159], v2, s[52:55], s6 offen nt
s_add_u32 s6, s13, 2621440
buffer_load_dwordx4 a[160:163], v10, s[52:55], s6 offen nt
s_add_u32 s6, s13, 2622464
buffer_load_dwordx4 a[164:167], v10, s[52:55], s6 offen nt
s_add_u32 s6, s13, 2623488
buffer_load_dwordx4 a[168:171], v10, s[52:55], s6 offen nt
s_add_u32 s6, s13, 2624512
buffer_load_dwordx4 a[172:175], v10, s[52:55], s6 offen nt
s_add_u32 s6, s13, 2883584
buffer_load_dwordx4 a[176:179], v10, s[52:55], s6 offen nt
s_add_u32 s6, s13, 2884608
buffer_load_dwordx4 a[180:183], v10, s[52:55], s6 offen nt
s_add_u32 s6, s13, 2885632
buffer_load_dwordx4 a[184:187], v10, s[52:55], s6 offen nt
s_add_u32 s6, s13, 2886656
buffer_load_dwordx4 a[188:191], v10, s[52:55], s6 offen nt
s_add_u32 s6, s13, 3145728
buffer_load_dwordx4 a[192:195], v2, s[52:55], s6 offen nt
s_add_u32 s6, s13, 3146752
buffer_load_dwordx4 a[196:199], v2, s[52:55], s6 offen nt
s_add_u32 s6, s13, 3147776
buffer_load_dwordx4 a[200:203], v2, s[52:55], s6 offen nt
s_add_u32 s6, s13, 3148800
buffer_load_dwordx4 a[204:207], v2, s[52:55], s6 offen nt
s_add_u32 s6, s13, 3407872
buffer_load_dwordx4 a[208:211], v2, s[52:55], s6 offen nt
s_add_u32 s6, s13, 3408896
buffer_load_dwordx4 a[212:215], v2, s[52:55], s6 offen nt
s_add_u32 s6, s13, 3409920
buffer_load_dwordx4 a[216:219], v2, s[52:55], s6 offen nt
s_add_u32 s6, s13, 3410944
buffer_load_dwordx4 a[220:223], v2, s[52:55], s6 offen nt
s_add_u32 s6, s13, 3670016
buffer_load_dwordx4 a[224:227], v10, s[52:55], s6 offen nt
s_add_u32 s6, s13, 3671040
buffer_load_dwordx4 a[228:231], v10, s[52:55], s6 offen nt
s_add_u32 s6, s13, 3672064
buffer_load_dwordx4 a[232:235], v10, s[52:55], s6 offen nt
s_add_u32 s6, s13, 3673088
buffer_load_dwordx4 a[236:239], v10, s[52:55], s6 offen nt
s_add_u32 s6, s13, 3932160
buffer_load_dwordx4 a[240:243], v10, s[52:55], s6 offen nt
s_add_u32 s6, s13, 3933184
buffer_load_dwordx4 a[244:247], v10, s[52:55], s6 offen nt
s_add_u32 s6, s13, 3934208
buffer_load_dwordx4 a[248:251], v10, s[52:55], s6 offen nt
s_add_u32 s6, s13, 3935232
buffer_load_dwordx4 a[252:255], v10, s[52:55], s6 offen nt
s_lshl_b32 s6, s3, 4
v_add_u32 v5, s6, v8
v_mul_u32_u24 v5, 1088, v5
v_lshrrev_b32 v6, 3, v8
v_lshlrev_b32 v6, 1, v6
v_xor_b32 v6, v6, v9
v_lshl_add_u32 v194, v6, 4, v5
v_add_u32 v195, 69632, v194
v_lshrrev_b32 v5, 5, v1
v_lshlrev_b32 v5, 3, v5
v_bfe_u32 v6, v1, 2, 2
v_add_u32 v5, v5, v6
v_mul_u32_u24 v5, 1088, v5
v_lshrrev_b32 v6, 1, v9
v_xor_b32 v6, v6, v9
v_and_b32 v6, 1, v6
v_lshl_add_u32 v5, v6, 5, v5
v_and_b32 v6, 3, v1
v_lshl_add_u32 v5, v6, 3, v5
s_lshl_b32 s6, s3, 8
v_add_u32 v196, s6, v5
v_add_u32 v197, 69632, v196
v_lshlrev_b32 v199, 4, v8
v_add_u32 v199, 160256, v199
s_lshl_b32 s6, s3, 2
v_add_u32 v198, s6, v199
v_and_b32 v5, 31, v1
v_lshlrev_b32 v200, 4, v5
v_add_u32 v200, 160256, v200
v_lshlrev_b32 v202, 5, v5
v_lshrrev_b32 v6, 5, v1
v_lshl_add_u32 v202, v6, 4, v202
v_add_u32 v202, 156160, v202
v_lshlrev_b32 v201, 5, v8
v_lshl_add_u32 v201, v9, 3, v201
s_lshl_b32 s6, s3, 10
s_add_u32 s6, s6, 156160
v_add_u32 v201, s6, v201
v_mul_u32_u24 v203, 1056, v8
v_lshl_add_u32 v203, v9, 4, v203
v_add_u32 v203, 139264, v203
s_mul_i32 s6, s3, 4224
s_add_u32 s6, s6, 139264
v_add_u32 v204, s6, v2
v_add_u32 v206, s12, v2
v_add_u32 v207, 69632, v206
v_mov_b32 v185, 0x3e0293ee
v_mov_b32 v176, 0xff800000
v_mov_b32 v177, 0xff800000
v_mov_b32 v178, 0xff800000
v_mov_b32 v180, 0
v_mov_b32 v181, 0
s_waitcnt vmcnt(32)
s_mov_b32 s7, 400000
Q_chk:
v_max3_u32 v192, v84, v85, v86
v_max3_u32 v192, v192, v87, v88
v_max3_u32 v192, v192, v89, v90
v_max3_u32 v192, v192, v91, v92
v_max3_u32 v192, v192, v93, v94
v_max3_u32 v192, v192, v95, v96
v_max3_u32 v192, v192, v97, v98
v_max3_u32 v192, v192, v99, v100
v_max3_u32 v192, v192, v101, v102
v_max3_u32 v192, v192, v103, v104
v_max3_u32 v192, v192, v105, v106
v_max3_u32 v192, v192, v107, v108
v_max3_u32 v192, v192, v109, v110
v_max3_u32 v192, v192, v111, v112
v_max3_u32 v192, v192, v113, v114
v_max_u32 v192, v192, v115
v_cmp_eq_u32 vcc, -1, v192
s_cbranch_vccz Q_ok
s_sleep 16
buffer_load_dwordx4 v[84:87], v2, s[64:67], s14 offen offset:0 sc1
buffer_load_dwordx4 v[88:91], v2, s[64:67], s14 offen offset:1024 sc1
buffer_load_dwordx4 v[92:95], v2, s[64:67], s14 offen offset:2048 sc1
buffer_load_dwordx4 v[96:99], v2, s[64:67], s14 offen offset:3072 sc1
buffer_load_dwordx4 v[100:103], v2, s[64:67], s15 offen offset:0 sc1
buffer_load_dwordx4 v[104:107], v2, s[64:67], s15 offen offset:1024 sc1
buffer_load_dwordx4 v[108:111], v2, s[64:67], s15 offen offset:2048 sc1
buffer_load_dwordx4 v[112:115], v2, s[64:67], s15 offen offset:3072 sc1
s_waitcnt vmcnt(0)
s_sub_u32 s7, s7, 1
s_cmp_lg_u32 s7, 0
s_cbranch_scc1 Q_chk
Q_ok:
s_barrier
ds_write_b128 v204, v[84:87] offset:0
ds_write_b128 v204, v[88:91] offset:1056
ds_write_b128 v204, v[92:95] offset:2112
ds_write_b128 v204, v[96:99] offset:3168
s_waitcnt lgkmcnt(0)
s_barrier
ds_read_b128 a[0:3], v203 offset:0
ds_read_b128 a[4:7], v203 offset:64
ds_read_b128 a[8:11], v203 offset:128
ds_read_b128 a[12:15], v203 offset:192
ds_read_b128 a[16:19], v203 offset:256
ds_read_b128 a[20:23], v203 offset:320
ds_read_b128 a[24:27], v203 offset:384
ds_read_b128 a[28:31], v203 offset:448
ds_read_b128 a[32:35], v203 offset:512
ds_read_b128 a[36:39], v203 offset:576
ds_read_b128 a[40:43], v203 offset:640
ds_read_b128 a[44:47], v203 offset:704
ds_read_b128 a[48:51], v203 offset:768
ds_read_b128 a[52:55], v203 offset:832
ds_read_b128 a[56:59], v203 offset:896
ds_read_b128 a[60:63], v203 offset:960
s_waitcnt lgkmcnt(0)
s_barrier
ds_write_b128 v204, v[100:103] offset:0
ds_write_b128 v204, v[104:107] offset:1056
ds_write_b128 v204, v[108:111] offset:2112
ds_write_b128 v204, v[112:115] offset:3168
s_waitcnt lgkmcnt(0)
s_barrier
ds_read_b128 a[64:67], v203 offset:0
ds_read_b128 a[68:71], v203 offset:64
ds_read_b128 a[72:75], v203 offset:128
ds_read_b128 a[76:79], v203 offset:192
ds_read_b128 a[80:83], v203 offset:256
ds_read_b128 a[84:87], v203 offset:320
ds_read_b128 a[88:91], v203 offset:384
ds_read_b128 a[92:95], v203 offset:448
ds_read_b128 a[96:99], v203 offset:512
ds_read_b128 a[100:103], v203 offset:576
ds_read_b128 a[104:107], v203 offset:640
ds_read_b128 a[108:111], v203 offset:704
ds_read_b128 a[112:115], v203 offset:768
ds_read_b128 a[116:119], v203 offset:832
ds_read_b128 a[120:123], v203 offset:896
ds_read_b128 a[124:127], v203 offset:960
s_waitcnt lgkmcnt(0)
ds_read_b128 v[84:87], v194 offset:0
ds_read_b128 v[88:91], v194 offset:64
ds_read_b128 v[92:95], v194 offset:128
ds_read_b128 v[96:99], v194 offset:192
ds_read_b128 v[100:103], v194 offset:256
ds_read_b128 v[104:107], v194 offset:320
ds_read_b128 v[108:111], v194 offset:384
ds_read_b128 v[112:115], v194 offset:448
ds_read_b128 v[116:119], v194 offset:512
ds_read_b128 v[120:123], v194 offset:576
ds_read_b128 v[124:127], v194 offset:640
ds_read_b128 v[128:131], v194 offset:704
ds_read_b128 v[132:135], v194 offset:768
ds_read_b128 v[136:139], v194 offset:832
ds_read_b128 v[140:143], v194 offset:896
ds_read_b128 v[144:147], v194 offset:960
s_waitcnt lgkmcnt(15)
v_mfma_f32_16x16x32_bf16 v[76:79], v[84:87], a[0:3], 0
v_mfma_f32_16x16x32_bf16 v[80:83], v[84:87], a[64:67], 0
s_waitcnt lgkmcnt(14)
v_mfma_f32_16x16x32_bf16 v[76:79], v[88:91], a[4:7], v[76:79]
v_mfma_f32_16x16x32_bf16 v[80:83], v[88:91], a[68:71], v[80:83]
s_waitcnt lgkmcnt(13)
v_mfma_f32_16x16x32_bf16 v[76:79], v[92:95], a[8:11], v[76:79]
v_mfma_f32_16x16x32_bf16 v[80:83], v[92:95], a[72:75], v[80:83]
s_waitcnt lgkmcnt(12)
v_mfma_f32_16x16x32_bf16 v[76:79], v[96:99], a[12:15], v[76:79]
v_mfma_f32_16x16x32_bf16 v[80:83], v[96:99], a[76:79], v[80:83]
s_waitcnt lgkmcnt(11)
v_mfma_f32_16x16x32_bf16 v[76:79], v[100:103], a[16:19], v[76:79]
v_mfma_f32_16x16x32_bf16 v[80:83], v[100:103], a[80:83], v[80:83]
s_waitcnt lgkmcnt(10)
v_mfma_f32_16x16x32_bf16 v[76:79], v[104:107], a[20:23], v[76:79]
v_mfma_f32_16x16x32_bf16 v[80:83], v[104:107], a[84:87], v[80:83]
s_waitcnt lgkmcnt(9)
v_mfma_f32_16x16x32_bf16 v[76:79], v[108:111], a[24:27], v[76:79]
v_mfma_f32_16x16x32_bf16 v[80:83], v[108:111], a[88:91], v[80:83]
s_waitcnt lgkmcnt(8)
v_mfma_f32_16x16x32_bf16 v[76:79], v[112:115], a[28:31], v[76:79]
v_mfma_f32_16x16x32_bf16 v[80:83], v[112:115], a[92:95], v[80:83]
s_waitcnt lgkmcnt(7)
v_mfma_f32_16x16x32_bf16 v[76:79], v[116:119], a[32:35], v[76:79]
v_mfma_f32_16x16x32_bf16 v[80:83], v[116:119], a[96:99], v[80:83]
s_waitcnt lgkmcnt(6)
v_mfma_f32_16x16x32_bf16 v[76:79], v[120:123], a[36:39], v[76:79]
v_mfma_f32_16x16x32_bf16 v[80:83], v[120:123], a[100:103], v[80:83]
s_waitcnt lgkmcnt(5)
v_mfma_f32_16x16x32_bf16 v[76:79], v[124:127], a[40:43], v[76:79]
v_mfma_f32_16x16x32_bf16 v[80:83], v[124:127], a[104:107], v[80:83]
s_waitcnt lgkmcnt(4)
v_mfma_f32_16x16x32_bf16 v[76:79], v[128:131], a[44:47], v[76:79]
v_mfma_f32_16x16x32_bf16 v[80:83], v[128:131], a[108:111], v[80:83]
s_waitcnt lgkmcnt(3)
v_mfma_f32_16x16x32_bf16 v[76:79], v[132:135], a[48:51], v[76:79]
v_mfma_f32_16x16x32_bf16 v[80:83], v[132:135], a[112:115], v[80:83]
s_waitcnt lgkmcnt(2)
v_mfma_f32_16x16x32_bf16 v[76:79], v[136:139], a[52:55], v[76:79]
v_mfma_f32_16x16x32_bf16 v[80:83], v[136:139], a[116:119], v[80:83]
s_waitcnt lgkmcnt(1)
v_mfma_f32_16x16x32_bf16 v[76:79], v[140:143], a[56:59], v[76:79]
v_mfma_f32_16x16x32_bf16 v[80:83], v[140:143], a[120:123], v[80:83]
s_waitcnt lgkmcnt(0)
v_mfma_f32_16x16x32_bf16 v[76:79], v[144:147], a[60:63], v[76:79]
v_mfma_f32_16x16x32_bf16 v[80:83], v[144:147], a[124:127], v[80:83]
s_nop 6
v_max_f32 v190, v76, v77
v_max3_f32 v190, v190, v78, v79
v_mov_b32 v192, v190
s_nop 1
v_permlane16_swap_b32 v190, v192
v_max_f32 v190, v190, v192
v_mov_b32 v192, v190
s_nop 1
v_permlane32_swap_b32 v190, v192
v_max_f32 v190, v190, v192
ds_write_b32 v198, v190 offset:0
v_max_f32 v191, v80, v81
v_max3_f32 v191, v191, v82, v83
v_mov_b32 v192, v191
s_nop 1
v_permlane16_swap_b32 v191, v192
v_max_f32 v191, v191, v192
v_mov_b32 v192, v191
s_nop 1
v_permlane32_swap_b32 v191, v192
v_max_f32 v191, v191, v192
ds_write_b32 v198, v191 offset:256
s_waitcnt lgkmcnt(0)
s_barrier
ds_read_b128 v[164:167], v199
ds_read_b128 v[168:171], v199 offset:256
ds_read_b128 v[172:175], v200
s_waitcnt lgkmcnt(0)
v_max_f32 v164, v164, v165
v_max3_f32 v164, v164, v166, v167
v_mul_f32 v164, v164, v185
v_max_f32 v164, v164, v176
v_sub_f32 v182, v176, v164
v_exp_f32 v182, v182
v_mov_b32 v176, v164
v_max_f32 v168, v168, v169
v_max3_f32 v168, v168, v170, v171
v_mul_f32 v168, v168, v185
v_max_f32 v168, v168, v177
v_sub_f32 v183, v177, v168
v_exp_f32 v183, v183
v_mov_b32 v177, v168
v_max_f32 v172, v172, v173
v_max3_f32 v172, v172, v174, v175
v_mul_f32 v172, v172, v185
v_max_f32 v172, v172, v178
v_sub_f32 v184, v178, v172
v_exp_f32 v184, v184
v_mov_b32 v178, v172
v_fma_f32 v76, v76, v185, -v176
v_fma_f32 v77, v77, v185, -v176
v_fma_f32 v78, v78, v185, -v176
v_fma_f32 v79, v79, v185, -v176
v_exp_f32 v76, v76
v_exp_f32 v77, v77
v_exp_f32 v78, v78
v_exp_f32 v79, v79
v_mul_f32 v180, v180, v182
v_cvt_pk_bf16_f32 v186, v76, v77
v_cvt_pk_bf16_f32 v187, v78, v79
ds_write_b64 v201, v[186:187] offset:0
v_add_f32 v180, v180, v76
v_add_f32 v180, v180, v77
v_add_f32 v180, v180, v78
v_add_f32 v180, v180, v79
v_fma_f32 v80, v80, v185, -v177
v_fma_f32 v81, v81, v185, -v177
v_fma_f32 v82, v82, v185, -v177
v_fma_f32 v83, v83, v185, -v177
v_exp_f32 v80, v80
v_exp_f32 v81, v81
v_exp_f32 v82, v82
v_exp_f32 v83, v83
v_mul_f32 v181, v181, v183
v_cvt_pk_bf16_f32 v188, v80, v81
v_cvt_pk_bf16_f32 v189, v82, v83
ds_write_b64 v201, v[188:189] offset:512
v_add_f32 v181, v181, v80
v_add_f32 v181, v181, v81
v_add_f32 v181, v181, v82
v_add_f32 v181, v181, v83
s_waitcnt lgkmcnt(0)
s_barrier
ds_read_b128 v[148:151], v202 offset:0
ds_read_b128 v[152:155], v202 offset:1024
ds_read_b128 v[156:159], v202 offset:2048
ds_read_b128 v[160:163], v202 offset:3072
ds_read_b64_tr_b16 v[84:85], v196 offset:0
ds_read_b64_tr_b16 v[86:87], v196 offset:4352
ds_read_b64_tr_b16 v[88:89], v196 offset:64
ds_read_b64_tr_b16 v[90:91], v196 offset:4416
ds_read_b64_tr_b16 v[92:93], v196 offset:128
ds_read_b64_tr_b16 v[94:95], v196 offset:4480
ds_read_b64_tr_b16 v[96:97], v196 offset:192
ds_read_b64_tr_b16 v[98:99], v196 offset:4544
ds_read_b64_tr_b16 v[100:101], v196 offset:17408
ds_read_b64_tr_b16 v[102:103], v196 offset:21760
ds_read_b64_tr_b16 v[104:105], v196 offset:17472
ds_read_b64_tr_b16 v[106:107], v196 offset:21824
ds_read_b64_tr_b16 v[108:109], v196 offset:17536
ds_read_b64_tr_b16 v[110:111], v196 offset:21888
ds_read_b64_tr_b16 v[112:113], v196 offset:17600
ds_read_b64_tr_b16 v[114:115], v196 offset:21952
ds_read_b64_tr_b16 v[116:117], v196 offset:34816
ds_read_b64_tr_b16 v[118:119], v196 offset:39168
ds_read_b64_tr_b16 v[120:121], v196 offset:34880
ds_read_b64_tr_b16 v[122:123], v196 offset:39232
ds_read_b64_tr_b16 v[124:125], v196 offset:34944
ds_read_b64_tr_b16 v[126:127], v196 offset:39296
ds_read_b64_tr_b16 v[128:129], v196 offset:35008
ds_read_b64_tr_b16 v[130:131], v196 offset:39360
ds_read_b64_tr_b16 v[132:133], v196 offset:52224
ds_read_b64_tr_b16 v[134:135], v196 offset:56576
ds_read_b64_tr_b16 v[136:137], v196 offset:52288
ds_read_b64_tr_b16 v[138:139], v196 offset:56640
ds_read_b64_tr_b16 v[140:141], v196 offset:52352
ds_read_b64_tr_b16 v[142:143], v196 offset:56704
ds_read_b64_tr_b16 v[144:145], v196 offset:52416
ds_read_b64_tr_b16 v[146:147], v196 offset:56768
s_waitcnt lgkmcnt(15)
v_mfma_f32_32x32x16_bf16 v[12:27], v[84:87], v[148:151], 0
v_mfma_f32_32x32x16_bf16 v[28:43], v[88:91], v[148:151], 0
v_mfma_f32_32x32x16_bf16 v[44:59], v[92:95], v[148:151], 0
v_mfma_f32_32x32x16_bf16 v[60:75], v[96:99], v[148:151], 0
s_waitcnt lgkmcnt(15)
v_mfma_f32_32x32x16_bf16 v[12:27], v[100:103], v[152:155], v[12:27]
v_mfma_f32_32x32x16_bf16 v[28:43], v[104:107], v[152:155], v[28:43]
v_mfma_f32_32x32x16_bf16 v[44:59], v[108:111], v[152:155], v[44:59]
v_mfma_f32_32x32x16_bf16 v[60:75], v[112:115], v[152:155], v[60:75]
s_waitcnt lgkmcnt(8)
v_mfma_f32_32x32x16_bf16 v[12:27], v[116:119], v[156:159], v[12:27]
v_mfma_f32_32x32x16_bf16 v[28:43], v[120:123], v[156:159], v[28:43]
v_mfma_f32_32x32x16_bf16 v[44:59], v[124:127], v[156:159], v[44:59]
v_mfma_f32_32x32x16_bf16 v[60:75], v[128:131], v[156:159], v[60:75]
s_waitcnt lgkmcnt(0)
v_mfma_f32_32x32x16_bf16 v[12:27], v[132:135], v[160:163], v[12:27]
v_mfma_f32_32x32x16_bf16 v[28:43], v[136:139], v[160:163], v[28:43]
v_mfma_f32_32x32x16_bf16 v[44:59], v[140:143], v[160:163], v[44:59]
v_mfma_f32_32x32x16_bf16 v[60:75], v[144:147], v[160:163], v[60:75]
ds_read_b128 v[84:87], v195 offset:0
ds_read_b128 v[88:91], v195 offset:64
ds_read_b128 v[92:95], v195 offset:128
ds_read_b128 v[96:99], v195 offset:192
ds_read_b128 v[100:103], v195 offset:256
ds_read_b128 v[104:107], v195 offset:320
ds_read_b128 v[108:111], v195 offset:384
ds_read_b128 v[112:115], v195 offset:448
ds_read_b128 v[116:119], v195 offset:512
ds_read_b128 v[120:123], v195 offset:576
ds_read_b128 v[124:127], v195 offset:640
ds_read_b128 v[128:131], v195 offset:704
ds_read_b128 v[132:135], v195 offset:768
ds_read_b128 v[136:139], v195 offset:832
ds_read_b128 v[140:143], v195 offset:896
ds_read_b128 v[144:147], v195 offset:960
s_waitcnt lgkmcnt(15)
v_mfma_f32_16x16x32_bf16 v[76:79], v[84:87], a[0:3], 0
v_mfma_f32_16x16x32_bf16 v[80:83], v[84:87], a[64:67], 0
s_waitcnt lgkmcnt(14)
v_mfma_f32_16x16x32_bf16 v[76:79], v[88:91], a[4:7], v[76:79]
v_mfma_f32_16x16x32_bf16 v[80:83], v[88:91], a[68:71], v[80:83]
s_waitcnt lgkmcnt(13)
v_mfma_f32_16x16x32_bf16 v[76:79], v[92:95], a[8:11], v[76:79]
v_mfma_f32_16x16x32_bf16 v[80:83], v[92:95], a[72:75], v[80:83]
s_waitcnt lgkmcnt(12)
v_mfma_f32_16x16x32_bf16 v[76:79], v[96:99], a[12:15], v[76:79]
v_mfma_f32_16x16x32_bf16 v[80:83], v[96:99], a[76:79], v[80:83]
s_waitcnt lgkmcnt(11)
v_mfma_f32_16x16x32_bf16 v[76:79], v[100:103], a[16:19], v[76:79]
v_mfma_f32_16x16x32_bf16 v[80:83], v[100:103], a[80:83], v[80:83]
s_waitcnt lgkmcnt(10)
v_mfma_f32_16x16x32_bf16 v[76:79], v[104:107], a[20:23], v[76:79]
v_mfma_f32_16x16x32_bf16 v[80:83], v[104:107], a[84:87], v[80:83]
s_waitcnt lgkmcnt(9)
v_mfma_f32_16x16x32_bf16 v[76:79], v[108:111], a[24:27], v[76:79]
v_mfma_f32_16x16x32_bf16 v[80:83], v[108:111], a[88:91], v[80:83]
s_waitcnt lgkmcnt(8)
v_mfma_f32_16x16x32_bf16 v[76:79], v[112:115], a[28:31], v[76:79]
v_mfma_f32_16x16x32_bf16 v[80:83], v[112:115], a[92:95], v[80:83]
s_waitcnt lgkmcnt(7)
v_mfma_f32_16x16x32_bf16 v[76:79], v[116:119], a[32:35], v[76:79]
v_mfma_f32_16x16x32_bf16 v[80:83], v[116:119], a[96:99], v[80:83]
s_waitcnt lgkmcnt(6)
v_mfma_f32_16x16x32_bf16 v[76:79], v[120:123], a[36:39], v[76:79]
v_mfma_f32_16x16x32_bf16 v[80:83], v[120:123], a[100:103], v[80:83]
s_waitcnt lgkmcnt(5)
v_mfma_f32_16x16x32_bf16 v[76:79], v[124:127], a[40:43], v[76:79]
v_mfma_f32_16x16x32_bf16 v[80:83], v[124:127], a[104:107], v[80:83]
s_waitcnt lgkmcnt(4)
v_mfma_f32_16x16x32_bf16 v[76:79], v[128:131], a[44:47], v[76:79]
v_mfma_f32_16x16x32_bf16 v[80:83], v[128:131], a[108:111], v[80:83]
s_waitcnt lgkmcnt(3)
v_mfma_f32_16x16x32_bf16 v[76:79], v[132:135], a[48:51], v[76:79]
v_mfma_f32_16x16x32_bf16 v[80:83], v[132:135], a[112:115], v[80:83]
s_waitcnt lgkmcnt(2)
v_mfma_f32_16x16x32_bf16 v[76:79], v[136:139], a[52:55], v[76:79]
v_mfma_f32_16x16x32_bf16 v[80:83], v[136:139], a[116:119], v[80:83]
s_waitcnt lgkmcnt(1)
v_mfma_f32_16x16x32_bf16 v[76:79], v[140:143], a[56:59], v[76:79]
v_mfma_f32_16x16x32_bf16 v[80:83], v[140:143], a[120:123], v[80:83]
s_waitcnt lgkmcnt(0)
v_mfma_f32_16x16x32_bf16 v[76:79], v[144:147], a[60:63], v[76:79]
v_mfma_f32_16x16x32_bf16 v[80:83], v[144:147], a[124:127], v[80:83]
s_nop 6
v_max_f32 v190, v76, v77
v_max3_f32 v190, v190, v78, v79
v_mov_b32 v192, v190
s_nop 1
v_permlane16_swap_b32 v190, v192
v_max_f32 v190, v190, v192
v_mov_b32 v192, v190
s_nop 1
v_permlane32_swap_b32 v190, v192
v_max_f32 v190, v190, v192
ds_write_b32 v198, v190 offset:0
v_max_f32 v191, v80, v81
v_max3_f32 v191, v191, v82, v83
v_mov_b32 v192, v191
s_nop 1
v_permlane16_swap_b32 v191, v192
v_max_f32 v191, v191, v192
v_mov_b32 v192, v191
s_nop 1
v_permlane32_swap_b32 v191, v192
v_max_f32 v191, v191, v192
ds_write_b32 v198, v191 offset:256
s_waitcnt lgkmcnt(0)
s_barrier
ds_read_b128 v[164:167], v199
ds_read_b128 v[168:171], v199 offset:256
ds_read_b128 v[172:175], v200
s_waitcnt vmcnt(16)
ds_write_b128 v206, a[128:131] offset:0
ds_write_b128 v206, a[132:135] offset:1088
ds_write_b128 v206, a[136:139] offset:2176
ds_write_b128 v206, a[140:143] offset:3264
ds_write_b128 v206, a[144:147] offset:4352
ds_write_b128 v206, a[148:151] offset:5440
ds_write_b128 v206, a[152:155] offset:6528
ds_write_b128 v206, a[156:159] offset:7616
ds_write_b128 v206, a[160:163] offset:8704
ds_write_b128 v206, a[164:167] offset:9792
ds_write_b128 v206, a[168:171] offset:10880
ds_write_b128 v206, a[172:175] offset:11968
ds_write_b128 v206, a[176:179] offset:13056
ds_write_b128 v206, a[180:183] offset:14144
ds_write_b128 v206, a[184:187] offset:15232
ds_write_b128 v206, a[188:191] offset:16320
s_waitcnt lgkmcnt(15)
v_max_f32 v164, v164, v165
v_max3_f32 v164, v164, v166, v167
v_mul_f32 v164, v164, v185
v_max_f32 v164, v164, v176
v_sub_f32 v182, v176, v164
v_exp_f32 v182, v182
v_mov_b32 v176, v164
v_max_f32 v168, v168, v169
v_max3_f32 v168, v168, v170, v171
v_mul_f32 v168, v168, v185
v_max_f32 v168, v168, v177
v_sub_f32 v183, v177, v168
v_exp_f32 v183, v183
v_mov_b32 v177, v168
v_max_f32 v172, v172, v173
v_max3_f32 v172, v172, v174, v175
v_mul_f32 v172, v172, v185
v_max_f32 v172, v172, v178
v_sub_f32 v184, v178, v172
v_exp_f32 v184, v184
v_mov_b32 v178, v172
v_fma_f32 v76, v76, v185, -v176
v_fma_f32 v77, v77, v185, -v176
v_fma_f32 v78, v78, v185, -v176
v_fma_f32 v79, v79, v185, -v176
v_exp_f32 v76, v76
v_exp_f32 v77, v77
v_exp_f32 v78, v78
v_exp_f32 v79, v79
v_mul_f32 v180, v180, v182
v_cvt_pk_bf16_f32 v186, v76, v77
v_cvt_pk_bf16_f32 v187, v78, v79
ds_write_b64 v201, v[186:187] offset:0
v_add_f32 v180, v180, v76
v_add_f32 v180, v180, v77
v_add_f32 v180, v180, v78
v_add_f32 v180, v180, v79
v_fma_f32 v80, v80, v185, -v177
v_fma_f32 v81, v81, v185, -v177
v_fma_f32 v82, v82, v185, -v177
v_fma_f32 v83, v83, v185, -v177
v_exp_f32 v80, v80
v_exp_f32 v81, v81
v_exp_f32 v82, v82
v_exp_f32 v83, v83
v_mul_f32 v181, v181, v183
v_cvt_pk_bf16_f32 v188, v80, v81
v_cvt_pk_bf16_f32 v189, v82, v83
ds_write_b64 v201, v[188:189] offset:512
v_add_f32 v181, v181, v80
v_add_f32 v181, v181, v81
v_add_f32 v181, v181, v82
v_add_f32 v181, v181, v83
v_mul_f32 v12, v12, v184
v_mul_f32 v13, v13, v184
v_mul_f32 v14, v14, v184
v_mul_f32 v15, v15, v184
v_mul_f32 v16, v16, v184
v_mul_f32 v17, v17, v184
v_mul_f32 v18, v18, v184
v_mul_f32 v19, v19, v184
v_mul_f32 v20, v20, v184
v_mul_f32 v21, v21, v184
v_mul_f32 v22, v22, v184
v_mul_f32 v23, v23, v184
v_mul_f32 v24, v24, v184
v_mul_f32 v25, v25, v184
v_mul_f32 v26, v26, v184
v_mul_f32 v27, v27, v184
v_mul_f32 v28, v28, v184
v_mul_f32 v29, v29, v184
v_mul_f32 v30, v30, v184
v_mul_f32 v31, v31, v184
v_mul_f32 v32, v32, v184
v_mul_f32 v33, v33, v184
v_mul_f32 v34, v34, v184
v_mul_f32 v35, v35, v184
v_mul_f32 v36, v36, v184
v_mul_f32 v37, v37, v184
v_mul_f32 v38, v38, v184
v_mul_f32 v39, v39, v184
v_mul_f32 v40, v40, v184
v_mul_f32 v41, v41, v184
v_mul_f32 v42, v42, v184
v_mul_f32 v43, v43, v184
v_mul_f32 v44, v44, v184
v_mul_f32 v45, v45, v184
v_mul_f32 v46, v46, v184
v_mul_f32 v47, v47, v184
v_mul_f32 v48, v48, v184
v_mul_f32 v49, v49, v184
v_mul_f32 v50, v50, v184
v_mul_f32 v51, v51, v184
v_mul_f32 v52, v52, v184
v_mul_f32 v53, v53, v184
v_mul_f32 v54, v54, v184
v_mul_f32 v55, v55, v184
v_mul_f32 v56, v56, v184
v_mul_f32 v57, v57, v184
v_mul_f32 v58, v58, v184
v_mul_f32 v59, v59, v184
v_mul_f32 v60, v60, v184
v_mul_f32 v61, v61, v184
v_mul_f32 v62, v62, v184
v_mul_f32 v63, v63, v184
v_mul_f32 v64, v64, v184
v_mul_f32 v65, v65, v184
v_mul_f32 v66, v66, v184
v_mul_f32 v67, v67, v184
v_mul_f32 v68, v68, v184
v_mul_f32 v69, v69, v184
v_mul_f32 v70, v70, v184
v_mul_f32 v71, v71, v184
v_mul_f32 v72, v72, v184
v_mul_f32 v73, v73, v184
v_mul_f32 v74, v74, v184
v_mul_f32 v75, v75, v184
s_waitcnt lgkmcnt(0)
s_barrier
ds_read_b128 v[148:151], v202 offset:0
ds_read_b128 v[152:155], v202 offset:1024
ds_read_b128 v[156:159], v202 offset:2048
ds_read_b128 v[160:163], v202 offset:3072
ds_read_b64_tr_b16 v[84:85], v197 offset:0
ds_read_b64_tr_b16 v[86:87], v197 offset:4352
ds_read_b64_tr_b16 v[88:89], v197 offset:64
ds_read_b64_tr_b16 v[90:91], v197 offset:4416
ds_read_b64_tr_b16 v[92:93], v197 offset:128
ds_read_b64_tr_b16 v[94:95], v197 offset:4480
ds_read_b64_tr_b16 v[96:97], v197 offset:192
ds_read_b64_tr_b16 v[98:99], v197 offset:4544
ds_read_b64_tr_b16 v[100:101], v197 offset:17408
ds_read_b64_tr_b16 v[102:103], v197 offset:21760
ds_read_b64_tr_b16 v[104:105], v197 offset:17472
ds_read_b64_tr_b16 v[106:107], v197 offset:21824
ds_read_b64_tr_b16 v[108:109], v197 offset:17536
ds_read_b64_tr_b16 v[110:111], v197 offset:21888
ds_read_b64_tr_b16 v[112:113], v197 offset:17600
ds_read_b64_tr_b16 v[114:115], v197 offset:21952
ds_read_b64_tr_b16 v[116:117], v197 offset:34816
ds_read_b64_tr_b16 v[118:119], v197 offset:39168
ds_read_b64_tr_b16 v[120:121], v197 offset:34880
ds_read_b64_tr_b16 v[122:123], v197 offset:39232
ds_read_b64_tr_b16 v[124:125], v197 offset:34944
ds_read_b64_tr_b16 v[126:127], v197 offset:39296
ds_read_b64_tr_b16 v[128:129], v197 offset:35008
ds_read_b64_tr_b16 v[130:131], v197 offset:39360
ds_read_b64_tr_b16 v[132:133], v197 offset:52224
ds_read_b64_tr_b16 v[134:135], v197 offset:56576
ds_read_b64_tr_b16 v[136:137], v197 offset:52288
ds_read_b64_tr_b16 v[138:139], v197 offset:56640
ds_read_b64_tr_b16 v[140:141], v197 offset:52352
ds_read_b64_tr_b16 v[142:143], v197 offset:56704
ds_read_b64_tr_b16 v[144:145], v197 offset:52416
ds_read_b64_tr_b16 v[146:147], v197 offset:56768
s_waitcnt lgkmcnt(15)
v_mfma_f32_32x32x16_bf16 v[12:27], v[84:87], v[148:151], v[12:27]
v_mfma_f32_32x32x16_bf16 v[28:43], v[88:91], v[148:151], v[28:43]
v_mfma_f32_32x32x16_bf16 v[44:59], v[92:95], v[148:151], v[44:59]
v_mfma_f32_32x32x16_bf16 v[60:75], v[96:99], v[148:151], v[60:75]
s_waitcnt lgkmcnt(15)
v_mfma_f32_32x32x16_bf16 v[12:27], v[100:103], v[152:155], v[12:27]
v_mfma_f32_32x32x16_bf16 v[28:43], v[104:107], v[152:155], v[28:43]
v_mfma_f32_32x32x16_bf16 v[44:59], v[108:111], v[152:155], v[44:59]
v_mfma_f32_32x32x16_bf16 v[60:75], v[112:115], v[152:155], v[60:75]
s_waitcnt lgkmcnt(8)
v_mfma_f32_32x32x16_bf16 v[12:27], v[116:119], v[156:159], v[12:27]
v_mfma_f32_32x32x16_bf16 v[28:43], v[120:123], v[156:159], v[28:43]
v_mfma_f32_32x32x16_bf16 v[44:59], v[124:127], v[156:159], v[44:59]
v_mfma_f32_32x32x16_bf16 v[60:75], v[128:131], v[156:159], v[60:75]
s_waitcnt lgkmcnt(0)
v_mfma_f32_32x32x16_bf16 v[12:27], v[132:135], v[160:163], v[12:27]
v_mfma_f32_32x32x16_bf16 v[28:43], v[136:139], v[160:163], v[28:43]
v_mfma_f32_32x32x16_bf16 v[44:59], v[140:143], v[160:163], v[44:59]
v_mfma_f32_32x32x16_bf16 v[60:75], v[144:147], v[160:163], v[60:75]
ds_read_b128 v[84:87], v194 offset:0
ds_read_b128 v[88:91], v194 offset:64
ds_read_b128 v[92:95], v194 offset:128
ds_read_b128 v[96:99], v194 offset:192
ds_read_b128 v[100:103], v194 offset:256
ds_read_b128 v[104:107], v194 offset:320
ds_read_b128 v[108:111], v194 offset:384
ds_read_b128 v[112:115], v194 offset:448
ds_read_b128 v[116:119], v194 offset:512
ds_read_b128 v[120:123], v194 offset:576
ds_read_b128 v[124:127], v194 offset:640
ds_read_b128 v[128:131], v194 offset:704
ds_read_b128 v[132:135], v194 offset:768
ds_read_b128 v[136:139], v194 offset:832
ds_read_b128 v[140:143], v194 offset:896
ds_read_b128 v[144:147], v194 offset:960
s_waitcnt lgkmcnt(15)
v_mfma_f32_16x16x32_bf16 v[76:79], v[84:87], a[0:3], 0
v_mfma_f32_16x16x32_bf16 v[80:83], v[84:87], a[64:67], 0
s_waitcnt lgkmcnt(14)
v_mfma_f32_16x16x32_bf16 v[76:79], v[88:91], a[4:7], v[76:79]
v_mfma_f32_16x16x32_bf16 v[80:83], v[88:91], a[68:71], v[80:83]
s_waitcnt lgkmcnt(13)
v_mfma_f32_16x16x32_bf16 v[76:79], v[92:95], a[8:11], v[76:79]
v_mfma_f32_16x16x32_bf16 v[80:83], v[92:95], a[72:75], v[80:83]
s_waitcnt lgkmcnt(12)
v_mfma_f32_16x16x32_bf16 v[76:79], v[96:99], a[12:15], v[76:79]
v_mfma_f32_16x16x32_bf16 v[80:83], v[96:99], a[76:79], v[80:83]
s_waitcnt lgkmcnt(11)
v_mfma_f32_16x16x32_bf16 v[76:79], v[100:103], a[16:19], v[76:79]
v_mfma_f32_16x16x32_bf16 v[80:83], v[100:103], a[80:83], v[80:83]
s_waitcnt lgkmcnt(10)
v_mfma_f32_16x16x32_bf16 v[76:79], v[104:107], a[20:23], v[76:79]
v_mfma_f32_16x16x32_bf16 v[80:83], v[104:107], a[84:87], v[80:83]
s_waitcnt lgkmcnt(9)
v_mfma_f32_16x16x32_bf16 v[76:79], v[108:111], a[24:27], v[76:79]
v_mfma_f32_16x16x32_bf16 v[80:83], v[108:111], a[88:91], v[80:83]
s_waitcnt lgkmcnt(8)
v_mfma_f32_16x16x32_bf16 v[76:79], v[112:115], a[28:31], v[76:79]
v_mfma_f32_16x16x32_bf16 v[80:83], v[112:115], a[92:95], v[80:83]
s_waitcnt lgkmcnt(7)
v_mfma_f32_16x16x32_bf16 v[76:79], v[116:119], a[32:35], v[76:79]
v_mfma_f32_16x16x32_bf16 v[80:83], v[116:119], a[96:99], v[80:83]
s_waitcnt lgkmcnt(6)
v_mfma_f32_16x16x32_bf16 v[76:79], v[120:123], a[36:39], v[76:79]
v_mfma_f32_16x16x32_bf16 v[80:83], v[120:123], a[100:103], v[80:83]
s_waitcnt lgkmcnt(5)
v_mfma_f32_16x16x32_bf16 v[76:79], v[124:127], a[40:43], v[76:79]
v_mfma_f32_16x16x32_bf16 v[80:83], v[124:127], a[104:107], v[80:83]
s_waitcnt lgkmcnt(4)
v_mfma_f32_16x16x32_bf16 v[76:79], v[128:131], a[44:47], v[76:79]
v_mfma_f32_16x16x32_bf16 v[80:83], v[128:131], a[108:111], v[80:83]
s_waitcnt lgkmcnt(3)
v_mfma_f32_16x16x32_bf16 v[76:79], v[132:135], a[48:51], v[76:79]
v_mfma_f32_16x16x32_bf16 v[80:83], v[132:135], a[112:115], v[80:83]
s_waitcnt lgkmcnt(2)
v_mfma_f32_16x16x32_bf16 v[76:79], v[136:139], a[52:55], v[76:79]
v_mfma_f32_16x16x32_bf16 v[80:83], v[136:139], a[116:119], v[80:83]
s_waitcnt lgkmcnt(1)
v_mfma_f32_16x16x32_bf16 v[76:79], v[140:143], a[56:59], v[76:79]
v_mfma_f32_16x16x32_bf16 v[80:83], v[140:143], a[120:123], v[80:83]
s_waitcnt lgkmcnt(0)
v_mfma_f32_16x16x32_bf16 v[76:79], v[144:147], a[60:63], v[76:79]
v_mfma_f32_16x16x32_bf16 v[80:83], v[144:147], a[124:127], v[80:83]
s_nop 6
v_max_f32 v190, v76, v77
v_max3_f32 v190, v190, v78, v79
v_mov_b32 v192, v190
s_nop 1
v_permlane16_swap_b32 v190, v192
v_max_f32 v190, v190, v192
v_mov_b32 v192, v190
s_nop 1
v_permlane32_swap_b32 v190, v192
v_max_f32 v190, v190, v192
ds_write_b32 v198, v190 offset:0
v_max_f32 v191, v80, v81
v_max3_f32 v191, v191, v82, v83
v_mov_b32 v192, v191
s_nop 1
v_permlane16_swap_b32 v191, v192
v_max_f32 v191, v191, v192
v_mov_b32 v192, v191
s_nop 1
v_permlane32_swap_b32 v191, v192
v_max_f32 v191, v191, v192
ds_write_b32 v198, v191 offset:256
s_waitcnt lgkmcnt(0)
s_barrier
ds_read_b128 v[164:167], v199
ds_read_b128 v[168:171], v199 offset:256
ds_read_b128 v[172:175], v200
s_waitcnt vmcnt(0)
ds_write_b128 v207, a[192:195] offset:0
ds_write_b128 v207, a[196:199] offset:1088
ds_write_b128 v207, a[200:203] offset:2176
ds_write_b128 v207, a[204:207] offset:3264
ds_write_b128 v207, a[208:211] offset:4352
ds_write_b128 v207, a[212:215] offset:5440
ds_write_b128 v207, a[216:219] offset:6528
ds_write_b128 v207, a[220:223] offset:7616
ds_write_b128 v207, a[224:227] offset:8704
ds_write_b128 v207, a[228:231] offset:9792
ds_write_b128 v207, a[232:235] offset:10880
ds_write_b128 v207, a[236:239] offset:11968
ds_write_b128 v207, a[240:243] offset:13056
ds_write_b128 v207, a[244:247] offset:14144
ds_write_b128 v207, a[248:251] offset:15232
ds_write_b128 v207, a[252:255] offset:16320
s_waitcnt lgkmcnt(15)
v_max_f32 v164, v164, v165
v_max3_f32 v164, v164, v166, v167
v_mul_f32 v164, v164, v185
v_max_f32 v164, v164, v176
v_sub_f32 v182, v176, v164
v_exp_f32 v182, v182
v_mov_b32 v176, v164
v_max_f32 v168, v168, v169
v_max3_f32 v168, v168, v170, v171
v_mul_f32 v168, v168, v185
v_max_f32 v168, v168, v177
v_sub_f32 v183, v177, v168
v_exp_f32 v183, v183
v_mov_b32 v177, v168
v_max_f32 v172, v172, v173
v_max3_f32 v172, v172, v174, v175
v_mul_f32 v172, v172, v185
v_max_f32 v172, v172, v178
v_sub_f32 v184, v178, v172
v_exp_f32 v184, v184
v_mov_b32 v178, v172
v_fma_f32 v76, v76, v185, -v176
v_fma_f32 v77, v77, v185, -v176
v_fma_f32 v78, v78, v185, -v176
v_fma_f32 v79, v79, v185, -v176
v_exp_f32 v76, v76
v_exp_f32 v77, v77
v_exp_f32 v78, v78
v_exp_f32 v79, v79
v_mul_f32 v180, v180, v182
v_cvt_pk_bf16_f32 v186, v76, v77
v_cvt_pk_bf16_f32 v187, v78, v79
ds_write_b64 v201, v[186:187] offset:0
v_add_f32 v180, v180, v76
v_add_f32 v180, v180, v77
v_add_f32 v180, v180, v78
v_add_f32 v180, v180, v79
v_fma_f32 v80, v80, v185, -v177
v_fma_f32 v81, v81, v185, -v177
v_fma_f32 v82, v82, v185, -v177
v_fma_f32 v83, v83, v185, -v177
v_exp_f32 v80, v80
v_exp_f32 v81, v81
v_exp_f32 v82, v82
v_exp_f32 v83, v83
v_mul_f32 v181, v181, v183
v_cvt_pk_bf16_f32 v188, v80, v81
v_cvt_pk_bf16_f32 v189, v82, v83
ds_write_b64 v201, v[188:189] offset:512
v_add_f32 v181, v181, v80
v_add_f32 v181, v181, v81
v_add_f32 v181, v181, v82
v_add_f32 v181, v181, v83
v_mul_f32 v12, v12, v184
v_mul_f32 v13, v13, v184
v_mul_f32 v14, v14, v184
v_mul_f32 v15, v15, v184
v_mul_f32 v16, v16, v184
v_mul_f32 v17, v17, v184
v_mul_f32 v18, v18, v184
v_mul_f32 v19, v19, v184
v_mul_f32 v20, v20, v184
v_mul_f32 v21, v21, v184
v_mul_f32 v22, v22, v184
v_mul_f32 v23, v23, v184
v_mul_f32 v24, v24, v184
v_mul_f32 v25, v25, v184
v_mul_f32 v26, v26, v184
v_mul_f32 v27, v27, v184
v_mul_f32 v28, v28, v184
v_mul_f32 v29, v29, v184
v_mul_f32 v30, v30, v184
v_mul_f32 v31, v31, v184
v_mul_f32 v32, v32, v184
v_mul_f32 v33, v33, v184
v_mul_f32 v34, v34, v184
v_mul_f32 v35, v35, v184
v_mul_f32 v36, v36, v184
v_mul_f32 v37, v37, v184
v_mul_f32 v38, v38, v184
v_mul_f32 v39, v39, v184
v_mul_f32 v40, v40, v184
v_mul_f32 v41, v41, v184
v_mul_f32 v42, v42, v184
v_mul_f32 v43, v43, v184
v_mul_f32 v44, v44, v184
v_mul_f32 v45, v45, v184
v_mul_f32 v46, v46, v184
v_mul_f32 v47, v47, v184
v_mul_f32 v48, v48, v184
v_mul_f32 v49, v49, v184
v_mul_f32 v50, v50, v184
v_mul_f32 v51, v51, v184
v_mul_f32 v52, v52, v184
v_mul_f32 v53, v53, v184
v_mul_f32 v54, v54, v184
v_mul_f32 v55, v55, v184
v_mul_f32 v56, v56, v184
v_mul_f32 v57, v57, v184
v_mul_f32 v58, v58, v184
v_mul_f32 v59, v59, v184
v_mul_f32 v60, v60, v184
v_mul_f32 v61, v61, v184
v_mul_f32 v62, v62, v184
v_mul_f32 v63, v63, v184
v_mul_f32 v64, v64, v184
v_mul_f32 v65, v65, v184
v_mul_f32 v66, v66, v184
v_mul_f32 v67, v67, v184
v_mul_f32 v68, v68, v184
v_mul_f32 v69, v69, v184
v_mul_f32 v70, v70, v184
v_mul_f32 v71, v71, v184
v_mul_f32 v72, v72, v184
v_mul_f32 v73, v73, v184
v_mul_f32 v74, v74, v184
v_mul_f32 v75, v75, v184
s_waitcnt lgkmcnt(0)
s_barrier
ds_read_b128 v[148:151], v202 offset:0
ds_read_b128 v[152:155], v202 offset:1024
ds_read_b128 v[156:159], v202 offset:2048
ds_read_b128 v[160:163], v202 offset:3072
ds_read_b64_tr_b16 v[84:85], v196 offset:0
ds_read_b64_tr_b16 v[86:87], v196 offset:4352
ds_read_b64_tr_b16 v[88:89], v196 offset:64
ds_read_b64_tr_b16 v[90:91], v196 offset:4416
ds_read_b64_tr_b16 v[92:93], v196 offset:128
ds_read_b64_tr_b16 v[94:95], v196 offset:4480
ds_read_b64_tr_b16 v[96:97], v196 offset:192
ds_read_b64_tr_b16 v[98:99], v196 offset:4544
ds_read_b64_tr_b16 v[100:101], v196 offset:17408
ds_read_b64_tr_b16 v[102:103], v196 offset:21760
ds_read_b64_tr_b16 v[104:105], v196 offset:17472
ds_read_b64_tr_b16 v[106:107], v196 offset:21824
ds_read_b64_tr_b16 v[108:109], v196 offset:17536
ds_read_b64_tr_b16 v[110:111], v196 offset:21888
ds_read_b64_tr_b16 v[112:113], v196 offset:17600
ds_read_b64_tr_b16 v[114:115], v196 offset:21952
ds_read_b64_tr_b16 v[116:117], v196 offset:34816
ds_read_b64_tr_b16 v[118:119], v196 offset:39168
ds_read_b64_tr_b16 v[120:121], v196 offset:34880
ds_read_b64_tr_b16 v[122:123], v196 offset:39232
ds_read_b64_tr_b16 v[124:125], v196 offset:34944
ds_read_b64_tr_b16 v[126:127], v196 offset:39296
ds_read_b64_tr_b16 v[128:129], v196 offset:35008
ds_read_b64_tr_b16 v[130:131], v196 offset:39360
ds_read_b64_tr_b16 v[132:133], v196 offset:52224
ds_read_b64_tr_b16 v[134:135], v196 offset:56576
ds_read_b64_tr_b16 v[136:137], v196 offset:52288
ds_read_b64_tr_b16 v[138:139], v196 offset:56640
ds_read_b64_tr_b16 v[140:141], v196 offset:52352
ds_read_b64_tr_b16 v[142:143], v196 offset:56704
ds_read_b64_tr_b16 v[144:145], v196 offset:52416
ds_read_b64_tr_b16 v[146:147], v196 offset:56768
s_waitcnt lgkmcnt(15)
v_mfma_f32_32x32x16_bf16 v[12:27], v[84:87], v[148:151], v[12:27]
v_mfma_f32_32x32x16_bf16 v[28:43], v[88:91], v[148:151], v[28:43]
v_mfma_f32_32x32x16_bf16 v[44:59], v[92:95], v[148:151], v[44:59]
v_mfma_f32_32x32x16_bf16 v[60:75], v[96:99], v[148:151], v[60:75]
s_waitcnt lgkmcnt(15)
v_mfma_f32_32x32x16_bf16 v[12:27], v[100:103], v[152:155], v[12:27]
v_mfma_f32_32x32x16_bf16 v[28:43], v[104:107], v[152:155], v[28:43]
v_mfma_f32_32x32x16_bf16 v[44:59], v[108:111], v[152:155], v[44:59]
v_mfma_f32_32x32x16_bf16 v[60:75], v[112:115], v[152:155], v[60:75]
s_waitcnt lgkmcnt(8)
v_mfma_f32_32x32x16_bf16 v[12:27], v[116:119], v[156:159], v[12:27]
v_mfma_f32_32x32x16_bf16 v[28:43], v[120:123], v[156:159], v[28:43]
v_mfma_f32_32x32x16_bf16 v[44:59], v[124:127], v[156:159], v[44:59]
v_mfma_f32_32x32x16_bf16 v[60:75], v[128:131], v[156:159], v[60:75]
s_waitcnt lgkmcnt(0)
v_mfma_f32_32x32x16_bf16 v[12:27], v[132:135], v[160:163], v[12:27]
v_mfma_f32_32x32x16_bf16 v[28:43], v[136:139], v[160:163], v[28:43]
v_mfma_f32_32x32x16_bf16 v[44:59], v[140:143], v[160:163], v[44:59]
v_mfma_f32_32x32x16_bf16 v[60:75], v[144:147], v[160:163], v[60:75]
ds_read_b128 v[84:87], v195 offset:0
ds_read_b128 v[88:91], v195 offset:64
ds_read_b128 v[92:95], v195 offset:128
ds_read_b128 v[96:99], v195 offset:192
ds_read_b128 v[100:103], v195 offset:256
ds_read_b128 v[104:107], v195 offset:320
ds_read_b128 v[108:111], v195 offset:384
ds_read_b128 v[112:115], v195 offset:448
ds_read_b128 v[116:119], v195 offset:512
ds_read_b128 v[120:123], v195 offset:576
ds_read_b128 v[124:127], v195 offset:640
ds_read_b128 v[128:131], v195 offset:704
ds_read_b128 v[132:135], v195 offset:768
ds_read_b128 v[136:139], v195 offset:832
ds_read_b128 v[140:143], v195 offset:896
ds_read_b128 v[144:147], v195 offset:960
s_waitcnt lgkmcnt(15)
v_mfma_f32_16x16x32_bf16 v[76:79], v[84:87], a[0:3], 0
v_mfma_f32_16x16x32_bf16 v[80:83], v[84:87], a[64:67], 0
s_waitcnt lgkmcnt(14)
v_mfma_f32_16x16x32_bf16 v[76:79], v[88:91], a[4:7], v[76:79]
v_mfma_f32_16x16x32_bf16 v[80:83], v[88:91], a[68:71], v[80:83]
s_waitcnt lgkmcnt(13)
v_mfma_f32_16x16x32_bf16 v[76:79], v[92:95], a[8:11], v[76:79]
v_mfma_f32_16x16x32_bf16 v[80:83], v[92:95], a[72:75], v[80:83]
s_waitcnt lgkmcnt(12)
v_mfma_f32_16x16x32_bf16 v[76:79], v[96:99], a[12:15], v[76:79]
v_mfma_f32_16x16x32_bf16 v[80:83], v[96:99], a[76:79], v[80:83]
s_waitcnt lgkmcnt(11)
v_mfma_f32_16x16x32_bf16 v[76:79], v[100:103], a[16:19], v[76:79]
v_mfma_f32_16x16x32_bf16 v[80:83], v[100:103], a[80:83], v[80:83]
s_waitcnt lgkmcnt(10)
v_mfma_f32_16x16x32_bf16 v[76:79], v[104:107], a[20:23], v[76:79]
v_mfma_f32_16x16x32_bf16 v[80:83], v[104:107], a[84:87], v[80:83]
s_waitcnt lgkmcnt(9)
v_mfma_f32_16x16x32_bf16 v[76:79], v[108:111], a[24:27], v[76:79]
v_mfma_f32_16x16x32_bf16 v[80:83], v[108:111], a[88:91], v[80:83]
s_waitcnt lgkmcnt(8)
v_mfma_f32_16x16x32_bf16 v[76:79], v[112:115], a[28:31], v[76:79]
v_mfma_f32_16x16x32_bf16 v[80:83], v[112:115], a[92:95], v[80:83]
s_waitcnt lgkmcnt(7)
v_mfma_f32_16x16x32_bf16 v[76:79], v[116:119], a[32:35], v[76:79]
v_mfma_f32_16x16x32_bf16 v[80:83], v[116:119], a[96:99], v[80:83]
s_waitcnt lgkmcnt(6)
v_mfma_f32_16x16x32_bf16 v[76:79], v[120:123], a[36:39], v[76:79]
v_mfma_f32_16x16x32_bf16 v[80:83], v[120:123], a[100:103], v[80:83]
s_waitcnt lgkmcnt(5)
v_mfma_f32_16x16x32_bf16 v[76:79], v[124:127], a[40:43], v[76:79]
v_mfma_f32_16x16x32_bf16 v[80:83], v[124:127], a[104:107], v[80:83]
s_waitcnt lgkmcnt(4)
v_mfma_f32_16x16x32_bf16 v[76:79], v[128:131], a[44:47], v[76:79]
v_mfma_f32_16x16x32_bf16 v[80:83], v[128:131], a[108:111], v[80:83]
s_waitcnt lgkmcnt(3)
v_mfma_f32_16x16x32_bf16 v[76:79], v[132:135], a[48:51], v[76:79]
v_mfma_f32_16x16x32_bf16 v[80:83], v[132:135], a[112:115], v[80:83]
s_waitcnt lgkmcnt(2)
v_mfma_f32_16x16x32_bf16 v[76:79], v[136:139], a[52:55], v[76:79]
v_mfma_f32_16x16x32_bf16 v[80:83], v[136:139], a[116:119], v[80:83]
s_waitcnt lgkmcnt(1)
v_mfma_f32_16x16x32_bf16 v[76:79], v[140:143], a[56:59], v[76:79]
v_mfma_f32_16x16x32_bf16 v[80:83], v[140:143], a[120:123], v[80:83]
s_waitcnt lgkmcnt(0)
v_mfma_f32_16x16x32_bf16 v[76:79], v[144:147], a[60:63], v[76:79]
v_mfma_f32_16x16x32_bf16 v[80:83], v[144:147], a[124:127], v[80:83]
s_nop 6
v_max_f32 v190, v76, v77
v_max3_f32 v190, v190, v78, v79
v_mov_b32 v192, v190
s_nop 1
v_permlane16_swap_b32 v190, v192
v_max_f32 v190, v190, v192
v_mov_b32 v192, v190
s_nop 1
v_permlane32_swap_b32 v190, v192
v_max_f32 v190, v190, v192
ds_write_b32 v198, v190 offset:0
v_max_f32 v191, v80, v81
v_max3_f32 v191, v191, v82, v83
v_mov_b32 v192, v191
s_nop 1
v_permlane16_swap_b32 v191, v192
v_max_f32 v191, v191, v192
v_mov_b32 v192, v191
s_nop 1
v_permlane32_swap_b32 v191, v192
v_max_f32 v191, v191, v192
ds_write_b32 v198, v191 offset:256
s_waitcnt lgkmcnt(0)
s_barrier
ds_read_b128 v[164:167], v199
ds_read_b128 v[168:171], v199 offset:256
ds_read_b128 v[172:175], v200
s_waitcnt lgkmcnt(0)
v_max_f32 v164, v164, v165
v_max3_f32 v164, v164, v166, v167
v_mul_f32 v164, v164, v185
v_max_f32 v164, v164, v176
v_sub_f32 v182, v176, v164
v_exp_f32 v182, v182
v_mov_b32 v176, v164
v_max_f32 v168, v168, v169
v_max3_f32 v168, v168, v170, v171
v_mul_f32 v168, v168, v185
v_max_f32 v168, v168, v177
v_sub_f32 v183, v177, v168
v_exp_f32 v183, v183
v_mov_b32 v177, v168
v_max_f32 v172, v172, v173
v_max3_f32 v172, v172, v174, v175
v_mul_f32 v172, v172, v185
v_max_f32 v172, v172, v178
v_sub_f32 v184, v178, v172
v_exp_f32 v184, v184
v_mov_b32 v178, v172
v_fma_f32 v76, v76, v185, -v176
v_fma_f32 v77, v77, v185, -v176
v_fma_f32 v78, v78, v185, -v176
v_fma_f32 v79, v79, v185, -v176
v_exp_f32 v76, v76
v_exp_f32 v77, v77
v_exp_f32 v78, v78
v_exp_f32 v79, v79
v_mul_f32 v180, v180, v182
v_cvt_pk_bf16_f32 v186, v76, v77
v_cvt_pk_bf16_f32 v187, v78, v79
ds_write_b64 v201, v[186:187] offset:0
v_add_f32 v180, v180, v76
v_add_f32 v180, v180, v77
v_add_f32 v180, v180, v78
v_add_f32 v180, v180, v79
v_fma_f32 v80, v80, v185, -v177
v_fma_f32 v81, v81, v185, -v177
v_fma_f32 v82, v82, v185, -v177
v_fma_f32 v83, v83, v185, -v177
v_exp_f32 v80, v80
v_exp_f32 v81, v81
v_exp_f32 v82, v82
v_exp_f32 v83, v83
v_mul_f32 v181, v181, v183
v_cvt_pk_bf16_f32 v188, v80, v81
v_cvt_pk_bf16_f32 v189, v82, v83
ds_write_b64 v201, v[188:189] offset:512
v_add_f32 v181, v181, v80
v_add_f32 v181, v181, v81
v_add_f32 v181, v181, v82
v_add_f32 v181, v181, v83
v_mul_f32 v12, v12, v184
v_mul_f32 v13, v13, v184
v_mul_f32 v14, v14, v184
v_mul_f32 v15, v15, v184
v_mul_f32 v16, v16, v184
v_mul_f32 v17, v17, v184
v_mul_f32 v18, v18, v184
v_mul_f32 v19, v19, v184
v_mul_f32 v20, v20, v184
v_mul_f32 v21, v21, v184
v_mul_f32 v22, v22, v184
v_mul_f32 v23, v23, v184
v_mul_f32 v24, v24, v184
v_mul_f32 v25, v25, v184
v_mul_f32 v26, v26, v184
v_mul_f32 v27, v27, v184
v_mul_f32 v28, v28, v184
v_mul_f32 v29, v29, v184
v_mul_f32 v30, v30, v184
v_mul_f32 v31, v31, v184
v_mul_f32 v32, v32, v184
v_mul_f32 v33, v33, v184
v_mul_f32 v34, v34, v184
v_mul_f32 v35, v35, v184
v_mul_f32 v36, v36, v184
v_mul_f32 v37, v37, v184
v_mul_f32 v38, v38, v184
v_mul_f32 v39, v39, v184
v_mul_f32 v40, v40, v184
v_mul_f32 v41, v41, v184
v_mul_f32 v42, v42, v184
v_mul_f32 v43, v43, v184
v_mul_f32 v44, v44, v184
v_mul_f32 v45, v45, v184
v_mul_f32 v46, v46, v184
v_mul_f32 v47, v47, v184
v_mul_f32 v48, v48, v184
v_mul_f32 v49, v49, v184
v_mul_f32 v50, v50, v184
v_mul_f32 v51, v51, v184
v_mul_f32 v52, v52, v184
v_mul_f32 v53, v53, v184
v_mul_f32 v54, v54, v184
v_mul_f32 v55, v55, v184
v_mul_f32 v56, v56, v184
v_mul_f32 v57, v57, v184
v_mul_f32 v58, v58, v184
v_mul_f32 v59, v59, v184
v_mul_f32 v60, v60, v184
v_mul_f32 v61, v61, v184
v_mul_f32 v62, v62, v184
v_mul_f32 v63, v63, v184
v_mul_f32 v64, v64, v184
v_mul_f32 v65, v65, v184
v_mul_f32 v66, v66, v184
v_mul_f32 v67, v67, v184
v_mul_f32 v68, v68, v184
v_mul_f32 v69, v69, v184
v_mul_f32 v70, v70, v184
v_mul_f32 v71, v71, v184
v_mul_f32 v72, v72, v184
v_mul_f32 v73, v73, v184
v_mul_f32 v74, v74, v184
v_mul_f32 v75, v75, v184
s_waitcnt lgkmcnt(0)
s_barrier
ds_read_b128 v[148:151], v202 offset:0
ds_read_b128 v[152:155], v202 offset:1024
ds_read_b128 v[156:159], v202 offset:2048
ds_read_b128 v[160:163], v202 offset:3072
ds_read_b64_tr_b16 v[84:85], v197 offset:0
ds_read_b64_tr_b16 v[86:87], v197 offset:4352
ds_read_b64_tr_b16 v[88:89], v197 offset:64
ds_read_b64_tr_b16 v[90:91], v197 offset:4416
ds_read_b64_tr_b16 v[92:93], v197 offset:128
ds_read_b64_tr_b16 v[94:95], v197 offset:4480
ds_read_b64_tr_b16 v[96:97], v197 offset:192
ds_read_b64_tr_b16 v[98:99], v197 offset:4544
ds_read_b64_tr_b16 v[100:101], v197 offset:17408
ds_read_b64_tr_b16 v[102:103], v197 offset:21760
ds_read_b64_tr_b16 v[104:105], v197 offset:17472
ds_read_b64_tr_b16 v[106:107], v197 offset:21824
ds_read_b64_tr_b16 v[108:109], v197 offset:17536
ds_read_b64_tr_b16 v[110:111], v197 offset:21888
ds_read_b64_tr_b16 v[112:113], v197 offset:17600
ds_read_b64_tr_b16 v[114:115], v197 offset:21952
ds_read_b64_tr_b16 v[116:117], v197 offset:34816
ds_read_b64_tr_b16 v[118:119], v197 offset:39168
ds_read_b64_tr_b16 v[120:121], v197 offset:34880
ds_read_b64_tr_b16 v[122:123], v197 offset:39232
ds_read_b64_tr_b16 v[124:125], v197 offset:34944
ds_read_b64_tr_b16 v[126:127], v197 offset:39296
ds_read_b64_tr_b16 v[128:129], v197 offset:35008
ds_read_b64_tr_b16 v[130:131], v197 offset:39360
ds_read_b64_tr_b16 v[132:133], v197 offset:52224
ds_read_b64_tr_b16 v[134:135], v197 offset:56576
ds_read_b64_tr_b16 v[136:137], v197 offset:52288
ds_read_b64_tr_b16 v[138:139], v197 offset:56640
ds_read_b64_tr_b16 v[140:141], v197 offset:52352
ds_read_b64_tr_b16 v[142:143], v197 offset:56704
ds_read_b64_tr_b16 v[144:145], v197 offset:52416
ds_read_b64_tr_b16 v[146:147], v197 offset:56768
s_waitcnt lgkmcnt(15)
v_mfma_f32_32x32x16_bf16 v[12:27], v[84:87], v[148:151], v[12:27]
v_mfma_f32_32x32x16_bf16 v[28:43], v[88:91], v[148:151], v[28:43]
v_mfma_f32_32x32x16_bf16 v[44:59], v[92:95], v[148:151], v[44:59]
v_mfma_f32_32x32x16_bf16 v[60:75], v[96:99], v[148:151], v[60:75]
s_waitcnt lgkmcnt(15)
v_mfma_f32_32x32x16_bf16 v[12:27], v[100:103], v[152:155], v[12:27]
v_mfma_f32_32x32x16_bf16 v[28:43], v[104:107], v[152:155], v[28:43]
v_mfma_f32_32x32x16_bf16 v[44:59], v[108:111], v[152:155], v[44:59]
v_mfma_f32_32x32x16_bf16 v[60:75], v[112:115], v[152:155], v[60:75]
s_waitcnt lgkmcnt(8)
v_mfma_f32_32x32x16_bf16 v[12:27], v[116:119], v[156:159], v[12:27]
v_mfma_f32_32x32x16_bf16 v[28:43], v[120:123], v[156:159], v[28:43]
v_mfma_f32_32x32x16_bf16 v[44:59], v[124:127], v[156:159], v[44:59]
v_mfma_f32_32x32x16_bf16 v[60:75], v[128:131], v[156:159], v[60:75]
s_waitcnt lgkmcnt(0)
v_mfma_f32_32x32x16_bf16 v[12:27], v[132:135], v[160:163], v[12:27]
v_mfma_f32_32x32x16_bf16 v[28:43], v[136:139], v[160:163], v[28:43]
v_mfma_f32_32x32x16_bf16 v[44:59], v[140:143], v[160:163], v[44:59]
v_mfma_f32_32x32x16_bf16 v[60:75], v[144:147], v[160:163], v[60:75]
v_mov_b32 v192, v180
s_nop 1
v_permlane16_swap_b32 v180, v192
v_add_f32 v180, v180, v192
v_mov_b32 v192, v180
s_nop 1
v_permlane32_swap_b32 v180, v192
v_add_f32 v180, v180, v192
ds_write_b32 v198, v180 offset:512
v_mov_b32 v192, v181
s_nop 1
v_permlane16_swap_b32 v181, v192
v_add_f32 v181, v181, v192
v_mov_b32 v192, v181
s_nop 1
v_permlane32_swap_b32 v181, v192
v_add_f32 v181, v181, v192
ds_write_b32 v198, v181 offset:768
v_and_b32 v5, 31, v1
v_mul_u32_u24 v5, 1040, v5
v_lshrrev_b32 v6, 5, v1
v_lshl_add_u32 v5, v6, 3, v5
s_lshl_b32 s6, s3, 8
v_add_u32 v5, s6, v5
v_cvt_pk_bf16_f32 v84, v12, v13
v_cvt_pk_bf16_f32 v85, v14, v15
ds_write_b64 v5, v[84:85] offset:0
v_cvt_pk_bf16_f32 v86, v16, v17
v_cvt_pk_bf16_f32 v87, v18, v19
ds_write_b64 v5, v[86:87] offset:16
v_cvt_pk_bf16_f32 v88, v20, v21
v_cvt_pk_bf16_f32 v89, v22, v23
ds_write_b64 v5, v[88:89] offset:32
v_cvt_pk_bf16_f32 v90, v24, v25
v_cvt_pk_bf16_f32 v91, v26, v27
ds_write_b64 v5, v[90:91] offset:48
v_cvt_pk_bf16_f32 v92, v28, v29
v_cvt_pk_bf16_f32 v93, v30, v31
ds_write_b64 v5, v[92:93] offset:64
v_cvt_pk_bf16_f32 v94, v32, v33
v_cvt_pk_bf16_f32 v95, v34, v35
ds_write_b64 v5, v[94:95] offset:80
v_cvt_pk_bf16_f32 v96, v36, v37
v_cvt_pk_bf16_f32 v97, v38, v39
ds_write_b64 v5, v[96:97] offset:96
v_cvt_pk_bf16_f32 v98, v40, v41
v_cvt_pk_bf16_f32 v99, v42, v43
ds_write_b64 v5, v[98:99] offset:112
v_cvt_pk_bf16_f32 v100, v44, v45
v_cvt_pk_bf16_f32 v101, v46, v47
ds_write_b64 v5, v[100:101] offset:128
v_cvt_pk_bf16_f32 v102, v48, v49
v_cvt_pk_bf16_f32 v103, v50, v51
ds_write_b64 v5, v[102:103] offset:144
v_cvt_pk_bf16_f32 v104, v52, v53
v_cvt_pk_bf16_f32 v105, v54, v55
ds_write_b64 v5, v[104:105] offset:160
v_cvt_pk_bf16_f32 v106, v56, v57
v_cvt_pk_bf16_f32 v107, v58, v59
ds_write_b64 v5, v[106:107] offset:176
v_cvt_pk_bf16_f32 v108, v60, v61
v_cvt_pk_bf16_f32 v109, v62, v63
ds_write_b64 v5, v[108:109] offset:192
v_cvt_pk_bf16_f32 v110, v64, v65
v_cvt_pk_bf16_f32 v111, v66, v67
ds_write_b64 v5, v[110:111] offset:208
v_cvt_pk_bf16_f32 v112, v68, v69
v_cvt_pk_bf16_f32 v113, v70, v71
ds_write_b64 v5, v[112:113] offset:224
v_cvt_pk_bf16_f32 v114, v72, v73
v_cvt_pk_bf16_f32 v115, v74, v75
ds_write_b64 v5, v[114:115] offset:240
s_waitcnt lgkmcnt(0)
s_barrier
s_mul_i32 s6, s3, 8320
v_add_u32 v5, s6, v2
ds_read_b128 v[116:119], v5 offset:0
ds_read_b128 v[120:123], v5 offset:1040
ds_read_b128 v[124:127], v5 offset:2080
ds_read_b128 v[128:131], v5 offset:3120
ds_read_b128 v[132:135], v5 offset:4160
ds_read_b128 v[136:139], v5 offset:5200
ds_read_b128 v[140:143], v5 offset:6240
ds_read_b128 v[144:147], v5 offset:7280
ds_read_b128 v[164:167], v200 offset:512
s_lshl_b32 s7, s3, 19
s_lshl_b32 s6, s9, 10
s_add_u32 s7, s7, s6
s_add_u32 s7, s7, 1048576
s_waitcnt lgkmcnt(8)
s_add_u32 s6, s7, 0
buffer_store_dwordx4 v[116:119], v2, s[64:67], s6 offen sc1
s_waitcnt lgkmcnt(7)
s_add_u32 s6, s7, 65536
buffer_store_dwordx4 v[120:123], v2, s[64:67], s6 offen sc1
s_waitcnt lgkmcnt(6)
s_add_u32 s6, s7, 131072
buffer_store_dwordx4 v[124:127], v2, s[64:67], s6 offen sc1
s_waitcnt lgkmcnt(5)
s_add_u32 s6, s7, 196608
buffer_store_dwordx4 v[128:131], v2, s[64:67], s6 offen sc1
s_waitcnt lgkmcnt(4)
s_add_u32 s6, s7, 262144
buffer_store_dwordx4 v[132:135], v2, s[64:67], s6 offen sc1
s_waitcnt lgkmcnt(3)
s_add_u32 s6, s7, 327680
buffer_store_dwordx4 v[136:139], v2, s[64:67], s6 offen sc1
s_waitcnt lgkmcnt(2)
s_add_u32 s6, s7, 393216
buffer_store_dwordx4 v[140:143], v2, s[64:67], s6 offen sc1
s_waitcnt lgkmcnt(1)
s_add_u32 s6, s7, 458752
buffer_store_dwordx4 v[144:147], v2, s[64:67], s6 offen sc1
s_waitcnt lgkmcnt(0)
v_add_f32 v164, v164, v165
v_add_f32 v166, v166, v167
v_add_f32 v187, v164, v166
v_mov_b32 v186, v178
v_and_b32 v5, 31, v1
v_lshrrev_b32 v6, 5, v1
v_lshl_add_u32 v5, v5, 1, v6
v_lshlrev_b32 v5, 9, v5
s_lshl_b32 s6, s9, 3
s_add_u32 s6, s6, 262144
v_min_u32 v186, -2, v186
v_min_u32 v187, -2, v187
s_waitcnt vmcnt(0)
s_barrier
s_cmp_lg_u32 s3, 0
s_cbranch_scc1 L_nops_20
buffer_store_dwordx2 v[186:187], v5, s[64:67], s6 offen sc1
L_nops_20:
s_mul_i32 s6, s9, 73728
s_add_u32 s60, s36, s6
s_addc_u32 s61, s37, 0
s_mov_b32 s62, 73728
s_mov_b32 s63, 0x20000
s_lshl_b32 s6, s9, 7
s_sub_u32 s7, 4194304, s6
s_add_u32 s76, s34, s6
s_addc_u32 s77, s35, 0
s_mov_b32 s78, s7
s_mov_b32 s79, 0x20000
v_lshrrev_b32 v5, 3, v1
v_and_b32 v6, 7, v1
v_and_b32 v7, 2, v5
v_xor_b32 v6, v6, v7
v_lshlrev_b32 v5, 13, v5
v_lshl_add_u32 v152, v6, 4, v5
v_xor_b32 v6, 4, v6
v_lshl_add_u32 v153, v6, 4, v5
s_lshl_b32 s12, s3, 14
s_lshl_b32 s13, s3, 20
s_add_u32 m0, s12, 73728
s_add_u32 s6, s13, 0
buffer_load_dwordx4 v152, s[76:79], s6 offen nt lds
s_add_u32 m0, s12, 74752
s_add_u32 s6, s13, 65536
buffer_load_dwordx4 v153, s[76:79], s6 offen nt lds
s_add_u32 m0, s12, 75776
s_add_u32 s6, s13, 131072
buffer_load_dwordx4 v152, s[76:79], s6 offen nt lds
s_add_u32 m0, s12, 76800
s_add_u32 s6, s13, 196608
buffer_load_dwordx4 v153, s[76:79], s6 offen nt lds
s_add_u32 m0, s12, 77824
s_add_u32 s6, s13, 262144
buffer_load_dwordx4 v152, s[76:79], s6 offen nt lds
s_add_u32 m0, s12, 78848
s_add_u32 s6, s13, 327680
buffer_load_dwordx4 v153, s[76:79], s6 offen nt lds
s_add_u32 m0, s12, 79872
s_add_u32 s6, s13, 393216
buffer_load_dwordx4 v152, s[76:79], s6 offen nt lds
s_add_u32 m0, s12, 80896
s_add_u32 s6, s13, 458752
buffer_load_dwordx4 v153, s[76:79], s6 offen nt lds
s_add_u32 m0, s12, 81920
s_add_u32 s6, s13, 524288
buffer_load_dwordx4 v152, s[76:79], s6 offen nt lds
s_add_u32 m0, s12, 82944
s_add_u32 s6, s13, 589824
buffer_load_dwordx4 v153, s[76:79], s6 offen nt lds
s_add_u32 m0, s12, 83968
s_add_u32 s6, s13, 655360
buffer_load_dwordx4 v152, s[76:79], s6 offen nt lds
s_add_u32 m0, s12, 84992
s_add_u32 s6, s13, 720896
buffer_load_dwordx4 v153, s[76:79], s6 offen nt lds
s_add_u32 m0, s12, 86016
s_add_u32 s6, s13, 786432
buffer_load_dwordx4 v152, s[76:79], s6 offen nt lds
s_add_u32 m0, s12, 87040
s_add_u32 s6, s13, 851968
buffer_load_dwordx4 v153, s[76:79], s6 offen nt lds
s_add_u32 m0, s12, 88064
s_add_u32 s6, s13, 917504
buffer_load_dwordx4 v152, s[76:79], s6 offen nt lds
s_add_u32 m0, s12, 89088
s_add_u32 s6, s13, 983040
buffer_load_dwordx4 v153, s[76:79], s6 offen nt lds
s_mul_i32 s12, s3, 18432
s_add_u32 s6, s12, 0
s_mov_b32 m0, s6
s_nop 0
buffer_load_dwordx4 v2, s[60:63], s6 offen nt lds
s_add_u32 s6, s12, 1024
s_mov_b32 m0, s6
s_nop 0
buffer_load_dwordx4 v2, s[60:63], s6 offen nt lds
s_add_u32 s6, s12, 2048
s_mov_b32 m0, s6
s_nop 0
buffer_load_dwordx4 v2, s[60:63], s6 offen nt lds
s_add_u32 s6, s12, 3072
s_mov_b32 m0, s6
s_nop 0
buffer_load_dwordx4 v2, s[60:63], s6 offen nt lds
s_add_u32 s6, s12, 4096
s_mov_b32 m0, s6
s_nop 0
buffer_load_dwordx4 v2, s[60:63], s6 offen nt lds
s_add_u32 s6, s12, 5120
s_mov_b32 m0, s6
s_nop 0
buffer_load_dwordx4 v2, s[60:63], s6 offen nt lds
s_add_u32 s6, s12, 6144
s_mov_b32 m0, s6
s_nop 0
buffer_load_dwordx4 v2, s[60:63], s6 offen nt lds
s_add_u32 s6, s12, 7168
s_mov_b32 m0, s6
s_nop 0
buffer_load_dwordx4 v2, s[60:63], s6 offen nt lds
s_add_u32 s6, s12, 8192
s_mov_b32 m0, s6
s_nop 0
buffer_load_dwordx4 v2, s[60:63], s6 offen nt lds
s_add_u32 s6, s12, 9216
s_mov_b32 m0, s6
s_nop 0
buffer_load_dwordx4 v2, s[60:63], s6 offen nt lds
s_add_u32 s6, s12, 10240
s_mov_b32 m0, s6
s_nop 0
buffer_load_dwordx4 v2, s[60:63], s6 offen nt lds
s_add_u32 s6, s12, 11264
s_mov_b32 m0, s6
s_nop 0
buffer_load_dwordx4 v2, s[60:63], s6 offen nt lds
s_add_u32 s6, s12, 12288
s_mov_b32 m0, s6
s_nop 0
buffer_load_dwordx4 v2, s[60:63], s6 offen nt lds
s_add_u32 s6, s12, 13312
s_mov_b32 m0, s6
s_nop 0
buffer_load_dwordx4 v2, s[60:63], s6 offen nt lds
s_add_u32 s6, s12, 14336
s_mov_b32 m0, s6
s_nop 0
buffer_load_dwordx4 v2, s[60:63], s6 offen nt lds
s_add_u32 s6, s12, 15360
s_mov_b32 m0, s6
s_nop 0
buffer_load_dwordx4 v2, s[60:63], s6 offen nt lds
s_add_u32 s6, s12, 16384
s_mov_b32 m0, s6
s_nop 0
buffer_load_dwordx4 v2, s[60:63], s6 offen nt lds
s_add_u32 s6, s12, 17408
s_mov_b32 m0, s6
s_nop 0
buffer_load_dwordx4 v2, s[60:63], s6 offen nt lds
v_lshrrev_b32 v5, 4, v1
v_lshlrev_b32 v5, 3, v5
v_bfe_u32 v6, v1, 2, 2
v_add_u32 v5, v5, v6
v_mul_u32_u24 v5, 1152, v5
s_mul_i32 s6, s3, 288
v_add_u32 v5, s6, v5
v_and_b32 v6, 3, v1
v_lshl_add_u32 v158, v6, 5, v5
v_lshl_add_u32 v159, v6, 3, v5
v_add_u32 v159, 256, v159
v_bfe_u32 v5, v1, 2, 2
v_lshl_add_u32 v5, v9, 3, v5
v_lshlrev_b32 v5, 7, v5
v_and_b32 v6, 3, v1
v_lshl_add_u32 v5, v6, 3, v5
v_add_u32 v5, 73728, v5
v_bfe_u32 v6, v1, 3, 2
v_xor_b32 v7, 0, v6
v_lshl_add_u32 v154, v7, 5, v5
v_xor_b32 v7, 1, v6
v_lshl_add_u32 v155, v7, 5, v5
v_xor_b32 v7, 2, v6
v_lshl_add_u32 v156, v7, 5, v5
v_xor_b32 v7, 3, v6
v_lshl_add_u32 v157, v7, 5, v5
v_lshlrev_b32 v5, 10, v8
v_lshl_add_u32 v5, v9, 4, v5
v_lshlrev_b32 v6, 3, v8
s_lshl_b32 s6, s9, 9
s_lshl_b32 s7, s3, 7
s_add_u32 s6, s6, s7
s_add_u32 s6, s6, 262144
s_mov_b32 s7, 400000
P_poll:
buffer_load_dwordx2 v[148:149], v6, s[64:67], s6 offen sc1
s_waitcnt vmcnt(0)
v_max_u32 v150, v148, v149
v_cmp_eq_u32 vcc, -1, v150
s_cbranch_vccz P_ok
s_sleep 16
s_sub_u32 s7, s7, 1
s_cmp_lg_u32 s7, 0
s_cbranch_scc1 P_poll
P_ok:
s_lshl_b32 s6, s4, 16
s_lshl_b32 s7, s3, 14
s_add_u32 s6, s6, s7
s_add_u32 s6, s6, 1048576
buffer_load_dwordx4 v[12:15], v5, s[64:67], s6 offen offset:0 sc1
buffer_load_dwordx4 v[16:19], v5, s[64:67], s6 offen offset:64 sc1
buffer_load_dwordx4 v[20:23], v5, s[64:67], s6 offen offset:128 sc1
buffer_load_dwordx4 v[24:27], v5, s[64:67], s6 offen offset:192 sc1
buffer_load_dwordx4 v[28:31], v5, s[64:67], s6 offen offset:256 sc1
buffer_load_dwordx4 v[32:35], v5, s[64:67], s6 offen offset:320 sc1
buffer_load_dwordx4 v[36:39], v5, s[64:67], s6 offen offset:384 sc1
buffer_load_dwordx4 v[40:43], v5, s[64:67], s6 offen offset:448 sc1
buffer_load_dwordx4 v[44:47], v5, s[64:67], s6 offen offset:512 sc1
buffer_load_dwordx4 v[48:51], v5, s[64:67], s6 offen offset:576 sc1
buffer_load_dwordx4 v[52:55], v5, s[64:67], s6 offen offset:640 sc1
buffer_load_dwordx4 v[56:59], v5, s[64:67], s6 offen offset:704 sc1
buffer_load_dwordx4 v[60:63], v5, s[64:67], s6 offen offset:768 sc1
buffer_load_dwordx4 v[64:67], v5, s[64:67], s6 offen offset:832 sc1
buffer_load_dwordx4 v[68:71], v5, s[64:67], s6 offen offset:896 sc1
buffer_load_dwordx4 v[72:75], v5, s[64:67], s6 offen offset:960 sc1
s_barrier
ds_read_b64_tr_b16 a[96:97], v158 offset:0
ds_read_b64_tr_b16 a[98:99], v158 offset:4608
ds_read_b64_tr_b16 a[100:101], v158 offset:36864
ds_read_b64_tr_b16 a[102:103], v158 offset:41472
ds_read_b64_tr_b16 a[104:105], v158 offset:8
ds_read_b64_tr_b16 a[106:107], v158 offset:4616
ds_read_b64_tr_b16 a[108:109], v158 offset:36872
ds_read_b64_tr_b16 a[110:111], v158 offset:41480
ds_read_b64_tr_b16 a[112:113], v158 offset:16
ds_read_b64_tr_b16 a[114:115], v158 offset:4624
ds_read_b64_tr_b16 a[116:117], v158 offset:36880
ds_read_b64_tr_b16 a[118:119], v158 offset:41488
ds_read_b64_tr_b16 a[120:121], v158 offset:24
ds_read_b64_tr_b16 a[122:123], v158 offset:4632
ds_read_b64_tr_b16 a[124:125], v158 offset:36888
ds_read_b64_tr_b16 a[126:127], v158 offset:41496
ds_read_b64_tr_b16 a[128:129], v158 offset:128
ds_read_b64_tr_b16 a[130:131], v158 offset:4736
ds_read_b64_tr_b16 a[132:133], v158 offset:36992
ds_read_b64_tr_b16 a[134:135], v158 offset:41600
ds_read_b64_tr_b16 a[136:137], v158 offset:136
ds_read_b64_tr_b16 a[138:139], v158 offset:4744
ds_read_b64_tr_b16 a[140:141], v158 offset:37000
ds_read_b64_tr_b16 a[142:143], v158 offset:41608
ds_read_b64_tr_b16 a[144:145], v158 offset:144
ds_read_b64_tr_b16 a[146:147], v158 offset:4752
ds_read_b64_tr_b16 a[148:149], v158 offset:37008
ds_read_b64_tr_b16 a[150:151], v158 offset:41616
ds_read_b64_tr_b16 a[152:153], v158 offset:152
ds_read_b64_tr_b16 a[154:155], v158 offset:4760
ds_read_b64_tr_b16 a[156:157], v158 offset:37016
ds_read_b64_tr_b16 a[158:159], v158 offset:41624
ds_read_b64_tr_b16 a[160:161], v159 offset:0
ds_read_b64_tr_b16 a[162:163], v159 offset:4608
ds_read_b64_tr_b16 a[164:165], v159 offset:36864
ds_read_b64_tr_b16 a[166:167], v159 offset:41472
v_mov_b32 v150, v148
s_nop 1
v_max_f32_dpp v150, v150, v150 row_ror:8 row_mask:0xf bank_mask:0xf
s_nop 1
v_max_f32_dpp v150, v150, v150 row_ror:4 row_mask:0xf bank_mask:0xf
s_nop 1
v_max_f32_dpp v150, v150, v150 row_ror:2 row_mask:0xf bank_mask:0xf
s_nop 1
v_max_f32_dpp v150, v150, v150 row_ror:1 row_mask:0xf bank_mask:0xf
v_sub_f32 v148, v148, v150
v_exp_f32 v148, v148
s_nop 0
v_mul_f32 v151, v148, v149
s_nop 1
v_add_f32_dpp v151, v151, v151 row_ror:8 row_mask:0xf bank_mask:0xf
s_nop 1
v_add_f32_dpp v151, v151, v151 row_ror:4 row_mask:0xf bank_mask:0xf
s_nop 1
v_add_f32_dpp v151, v151, v151 row_ror:2 row_mask:0xf bank_mask:0xf
s_nop 1
v_add_f32_dpp v151, v151, v151 row_ror:1 row_mask:0xf bank_mask:0xf
v_rcp_f32 v151, v151
s_nop 0
v_mul_f32 v148, v148, v151
s_nop 1
v_mov_b32_dpp v144, v148 row_newbcast:0 row_mask:0x1 bank_mask:0xf
v_mov_b32_dpp v144, v148 row_newbcast:4 row_mask:0x2 bank_mask:0xf
v_mov_b32_dpp v144, v148 row_newbcast:8 row_mask:0x4 bank_mask:0xf
v_mov_b32_dpp v144, v148 row_newbcast:12 row_mask:0x8 bank_mask:0xf
v_mov_b32_dpp v145, v148 row_newbcast:1 row_mask:0x1 bank_mask:0xf
v_mov_b32_dpp v145, v148 row_newbcast:5 row_mask:0x2 bank_mask:0xf
v_mov_b32_dpp v145, v148 row_newbcast:9 row_mask:0x4 bank_mask:0xf
v_mov_b32_dpp v145, v148 row_newbcast:13 row_mask:0x8 bank_mask:0xf
v_mov_b32_dpp v146, v148 row_newbcast:2 row_mask:0x1 bank_mask:0xf
v_mov_b32_dpp v146, v148 row_newbcast:6 row_mask:0x2 bank_mask:0xf
v_mov_b32_dpp v146, v148 row_newbcast:10 row_mask:0x4 bank_mask:0xf
v_mov_b32_dpp v146, v148 row_newbcast:14 row_mask:0x8 bank_mask:0xf
v_mov_b32_dpp v147, v148 row_newbcast:3 row_mask:0x1 bank_mask:0xf
v_mov_b32_dpp v147, v148 row_newbcast:7 row_mask:0x2 bank_mask:0xf
v_mov_b32_dpp v147, v148 row_newbcast:11 row_mask:0x4 bank_mask:0xf
v_mov_b32_dpp v147, v148 row_newbcast:15 row_mask:0x8 bank_mask:0xf
s_waitcnt lgkmcnt(0)
ds_read_b64_tr_b16 v[76:77], v154 offset:0
ds_read_b64_tr_b16 v[78:79], v154 offset:512
ds_read_b64_tr_b16 v[80:81], v155 offset:0
ds_read_b64_tr_b16 v[82:83], v155 offset:512
ds_read_b64_tr_b16 v[84:85], v156 offset:0
ds_read_b64_tr_b16 v[86:87], v156 offset:512
ds_read_b64_tr_b16 v[88:89], v157 offset:0
ds_read_b64_tr_b16 v[90:91], v157 offset:512
ds_read_b64_tr_b16 v[92:93], v154 offset:4096
ds_read_b64_tr_b16 v[94:95], v154 offset:4608
ds_read_b64_tr_b16 v[96:97], v155 offset:4096
ds_read_b64_tr_b16 v[98:99], v155 offset:4608
ds_read_b64_tr_b16 v[100:101], v156 offset:4096
ds_read_b64_tr_b16 v[102:103], v156 offset:4608
ds_read_b64_tr_b16 v[104:105], v157 offset:4096
ds_read_b64_tr_b16 v[106:107], v157 offset:4608
s_waitcnt vmcnt(15)
s_waitcnt lgkmcnt(8)
v_mfma_f32_16x16x32_bf16 v[108:111], v[12:15], v[76:79], 0
v_mfma_f32_16x16x32_bf16 v[112:115], v[12:15], v[80:83], 0
v_mfma_f32_16x16x32_bf16 v[116:119], v[12:15], v[84:87], 0
v_mfma_f32_16x16x32_bf16 v[120:123], v[12:15], v[88:91], 0
ds_read_b64_tr_b16 v[76:77], v154 offset:8192
ds_read_b64_tr_b16 v[78:79], v154 offset:8704
ds_read_b64_tr_b16 v[80:81], v155 offset:8192
ds_read_b64_tr_b16 v[82:83], v155 offset:8704
ds_read_b64_tr_b16 v[84:85], v156 offset:8192
ds_read_b64_tr_b16 v[86:87], v156 offset:8704
ds_read_b64_tr_b16 v[88:89], v157 offset:8192
ds_read_b64_tr_b16 v[90:91], v157 offset:8704
s_waitcnt vmcnt(14)
s_waitcnt lgkmcnt(8)
v_mfma_f32_16x16x32_bf16 v[108:111], v[16:19], v[92:95], v[108:111]
v_mfma_f32_16x16x32_bf16 v[112:115], v[16:19], v[96:99], v[112:115]
v_mfma_f32_16x16x32_bf16 v[116:119], v[16:19], v[100:103], v[116:119]
v_mfma_f32_16x16x32_bf16 v[120:123], v[16:19], v[104:107], v[120:123]
ds_read_b64_tr_b16 v[92:93], v154 offset:12288
ds_read_b64_tr_b16 v[94:95], v154 offset:12800
ds_read_b64_tr_b16 v[96:97], v155 offset:12288
ds_read_b64_tr_b16 v[98:99], v155 offset:12800
ds_read_b64_tr_b16 v[100:101], v156 offset:12288
ds_read_b64_tr_b16 v[102:103], v156 offset:12800
ds_read_b64_tr_b16 v[104:105], v157 offset:12288
ds_read_b64_tr_b16 v[106:107], v157 offset:12800
s_waitcnt vmcnt(13)
s_waitcnt lgkmcnt(8)
v_mfma_f32_16x16x32_bf16 v[108:111], v[20:23], v[76:79], v[108:111]
v_mfma_f32_16x16x32_bf16 v[112:115], v[20:23], v[80:83], v[112:115]
v_mfma_f32_16x16x32_bf16 v[116:119], v[20:23], v[84:87], v[116:119]
v_mfma_f32_16x16x32_bf16 v[120:123], v[20:23], v[88:91], v[120:123]
ds_read_b64_tr_b16 v[76:77], v154 offset:16384
ds_read_b64_tr_b16 v[78:79], v154 offset:16896
ds_read_b64_tr_b16 v[80:81], v155 offset:16384
ds_read_b64_tr_b16 v[82:83], v155 offset:16896
ds_read_b64_tr_b16 v[84:85], v156 offset:16384
ds_read_b64_tr_b16 v[86:87], v156 offset:16896
ds_read_b64_tr_b16 v[88:89], v157 offset:16384
ds_read_b64_tr_b16 v[90:91], v157 offset:16896
s_waitcnt vmcnt(12)
s_waitcnt lgkmcnt(8)
v_mfma_f32_16x16x32_bf16 v[108:111], v[24:27], v[92:95], v[108:111]
v_mfma_f32_16x16x32_bf16 v[112:115], v[24:27], v[96:99], v[112:115]
v_mfma_f32_16x16x32_bf16 v[116:119], v[24:27], v[100:103], v[116:119]
v_mfma_f32_16x16x32_bf16 v[120:123], v[24:27], v[104:107], v[120:123]
ds_read_b64_tr_b16 v[92:93], v154 offset:20480
ds_read_b64_tr_b16 v[94:95], v154 offset:20992
ds_read_b64_tr_b16 v[96:97], v155 offset:20480
ds_read_b64_tr_b16 v[98:99], v155 offset:20992
ds_read_b64_tr_b16 v[100:101], v156 offset:20480
ds_read_b64_tr_b16 v[102:103], v156 offset:20992
ds_read_b64_tr_b16 v[104:105], v157 offset:20480
ds_read_b64_tr_b16 v[106:107], v157 offset:20992
s_waitcnt vmcnt(11)
s_waitcnt lgkmcnt(8)
v_mfma_f32_16x16x32_bf16 v[108:111], v[28:31], v[76:79], v[108:111]
v_mfma_f32_16x16x32_bf16 v[112:115], v[28:31], v[80:83], v[112:115]
v_mfma_f32_16x16x32_bf16 v[116:119], v[28:31], v[84:87], v[116:119]
v_mfma_f32_16x16x32_bf16 v[120:123], v[28:31], v[88:91], v[120:123]
ds_read_b64_tr_b16 v[76:77], v154 offset:24576
ds_read_b64_tr_b16 v[78:79], v154 offset:25088
ds_read_b64_tr_b16 v[80:81], v155 offset:24576
ds_read_b64_tr_b16 v[82:83], v155 offset:25088
ds_read_b64_tr_b16 v[84:85], v156 offset:24576
ds_read_b64_tr_b16 v[86:87], v156 offset:25088
ds_read_b64_tr_b16 v[88:89], v157 offset:24576
ds_read_b64_tr_b16 v[90:91], v157 offset:25088
s_waitcnt vmcnt(10)
s_waitcnt lgkmcnt(8)
v_mfma_f32_16x16x32_bf16 v[108:111], v[32:35], v[92:95], v[108:111]
v_mfma_f32_16x16x32_bf16 v[112:115], v[32:35], v[96:99], v[112:115]
v_mfma_f32_16x16x32_bf16 v[116:119], v[32:35], v[100:103], v[116:119]
v_mfma_f32_16x16x32_bf16 v[120:123], v[32:35], v[104:107], v[120:123]
ds_read_b64_tr_b16 v[92:93], v154 offset:28672
ds_read_b64_tr_b16 v[94:95], v154 offset:29184
ds_read_b64_tr_b16 v[96:97], v155 offset:28672
ds_read_b64_tr_b16 v[98:99], v155 offset:29184
ds_read_b64_tr_b16 v[100:101], v156 offset:28672
ds_read_b64_tr_b16 v[102:103], v156 offset:29184
ds_read_b64_tr_b16 v[104:105], v157 offset:28672
ds_read_b64_tr_b16 v[106:107], v157 offset:29184
s_waitcnt vmcnt(9)
s_waitcnt lgkmcnt(8)
v_mfma_f32_16x16x32_bf16 v[108:111], v[36:39], v[76:79], v[108:111]
v_mfma_f32_16x16x32_bf16 v[112:115], v[36:39], v[80:83], v[112:115]
v_mfma_f32_16x16x32_bf16 v[116:119], v[36:39], v[84:87], v[116:119]
v_mfma_f32_16x16x32_bf16 v[120:123], v[36:39], v[88:91], v[120:123]
ds_read_b64_tr_b16 v[76:77], v154 offset:32768
ds_read_b64_tr_b16 v[78:79], v154 offset:33280
ds_read_b64_tr_b16 v[80:81], v155 offset:32768
ds_read_b64_tr_b16 v[82:83], v155 offset:33280
ds_read_b64_tr_b16 v[84:85], v156 offset:32768
ds_read_b64_tr_b16 v[86:87], v156 offset:33280
ds_read_b64_tr_b16 v[88:89], v157 offset:32768
ds_read_b64_tr_b16 v[90:91], v157 offset:33280
s_waitcnt vmcnt(8)
s_waitcnt lgkmcnt(8)
v_mfma_f32_16x16x32_bf16 v[108:111], v[40:43], v[92:95], v[108:111]
v_mfma_f32_16x16x32_bf16 v[112:115], v[40:43], v[96:99], v[112:115]
v_mfma_f32_16x16x32_bf16 v[116:119], v[40:43], v[100:103], v[116:119]
v_mfma_f32_16x16x32_bf16 v[120:123], v[40:43], v[104:107], v[120:123]
ds_read_b64_tr_b16 v[92:93], v154 offset:36864
ds_read_b64_tr_b16 v[94:95], v154 offset:37376
ds_read_b64_tr_b16 v[96:97], v155 offset:36864
ds_read_b64_tr_b16 v[98:99], v155 offset:37376
ds_read_b64_tr_b16 v[100:101], v156 offset:36864
ds_read_b64_tr_b16 v[102:103], v156 offset:37376
ds_read_b64_tr_b16 v[104:105], v157 offset:36864
ds_read_b64_tr_b16 v[106:107], v157 offset:37376
s_waitcnt vmcnt(7)
s_waitcnt lgkmcnt(8)
v_mfma_f32_16x16x32_bf16 v[108:111], v[44:47], v[76:79], v[108:111]
v_mfma_f32_16x16x32_bf16 v[112:115], v[44:47], v[80:83], v[112:115]
v_mfma_f32_16x16x32_bf16 v[116:119], v[44:47], v[84:87], v[116:119]
v_mfma_f32_16x16x32_bf16 v[120:123], v[44:47], v[88:91], v[120:123]
ds_read_b64_tr_b16 v[76:77], v154 offset:40960
ds_read_b64_tr_b16 v[78:79], v154 offset:41472
ds_read_b64_tr_b16 v[80:81], v155 offset:40960
ds_read_b64_tr_b16 v[82:83], v155 offset:41472
ds_read_b64_tr_b16 v[84:85], v156 offset:40960
ds_read_b64_tr_b16 v[86:87], v156 offset:41472
ds_read_b64_tr_b16 v[88:89], v157 offset:40960
ds_read_b64_tr_b16 v[90:91], v157 offset:41472
s_waitcnt vmcnt(6)
s_waitcnt lgkmcnt(8)
v_mfma_f32_16x16x32_bf16 v[108:111], v[48:51], v[92:95], v[108:111]
v_mfma_f32_16x16x32_bf16 v[112:115], v[48:51], v[96:99], v[112:115]
v_mfma_f32_16x16x32_bf16 v[116:119], v[48:51], v[100:103], v[116:119]
v_mfma_f32_16x16x32_bf16 v[120:123], v[48:51], v[104:107], v[120:123]
ds_read_b64_tr_b16 v[92:93], v154 offset:45056
ds_read_b64_tr_b16 v[94:95], v154 offset:45568
ds_read_b64_tr_b16 v[96:97], v155 offset:45056
ds_read_b64_tr_b16 v[98:99], v155 offset:45568
ds_read_b64_tr_b16 v[100:101], v156 offset:45056
ds_read_b64_tr_b16 v[102:103], v156 offset:45568
ds_read_b64_tr_b16 v[104:105], v157 offset:45056
ds_read_b64_tr_b16 v[106:107], v157 offset:45568
s_waitcnt vmcnt(5)
s_waitcnt lgkmcnt(8)
v_mfma_f32_16x16x32_bf16 v[108:111], v[52:55], v[76:79], v[108:111]
v_mfma_f32_16x16x32_bf16 v[112:115], v[52:55], v[80:83], v[112:115]
v_mfma_f32_16x16x32_bf16 v[116:119], v[52:55], v[84:87], v[116:119]
v_mfma_f32_16x16x32_bf16 v[120:123], v[52:55], v[88:91], v[120:123]
ds_read_b64_tr_b16 v[76:77], v154 offset:49152
ds_read_b64_tr_b16 v[78:79], v154 offset:49664
ds_read_b64_tr_b16 v[80:81], v155 offset:49152
ds_read_b64_tr_b16 v[82:83], v155 offset:49664
ds_read_b64_tr_b16 v[84:85], v156 offset:49152
ds_read_b64_tr_b16 v[86:87], v156 offset:49664
ds_read_b64_tr_b16 v[88:89], v157 offset:49152
ds_read_b64_tr_b16 v[90:91], v157 offset:49664
s_waitcnt vmcnt(4)
s_waitcnt lgkmcnt(8)
v_mfma_f32_16x16x32_bf16 v[108:111], v[56:59], v[92:95], v[108:111]
v_mfma_f32_16x16x32_bf16 v[112:115], v[56:59], v[96:99], v[112:115]
v_mfma_f32_16x16x32_bf16 v[116:119], v[56:59], v[100:103], v[116:119]
v_mfma_f32_16x16x32_bf16 v[120:123], v[56:59], v[104:107], v[120:123]
ds_read_b64_tr_b16 v[92:93], v154 offset:53248
ds_read_b64_tr_b16 v[94:95], v154 offset:53760
ds_read_b64_tr_b16 v[96:97], v155 offset:53248
ds_read_b64_tr_b16 v[98:99], v155 offset:53760
ds_read_b64_tr_b16 v[100:101], v156 offset:53248
ds_read_b64_tr_b16 v[102:103], v156 offset:53760
ds_read_b64_tr_b16 v[104:105], v157 offset:53248
ds_read_b64_tr_b16 v[106:107], v157 offset:53760
s_waitcnt vmcnt(3)
s_waitcnt lgkmcnt(8)
v_mfma_f32_16x16x32_bf16 v[108:111], v[60:63], v[76:79], v[108:111]
v_mfma_f32_16x16x32_bf16 v[112:115], v[60:63], v[80:83], v[112:115]
v_mfma_f32_16x16x32_bf16 v[116:119], v[60:63], v[84:87], v[116:119]
v_mfma_f32_16x16x32_bf16 v[120:123], v[60:63], v[88:91], v[120:123]
ds_read_b64_tr_b16 v[76:77], v154 offset:57344
ds_read_b64_tr_b16 v[78:79], v154 offset:57856
ds_read_b64_tr_b16 v[80:81], v155 offset:57344
ds_read_b64_tr_b16 v[82:83], v155 offset:57856
ds_read_b64_tr_b16 v[84:85], v156 offset:57344
ds_read_b64_tr_b16 v[86:87], v156 offset:57856
ds_read_b64_tr_b16 v[88:89], v157 offset:57344
ds_read_b64_tr_b16 v[90:91], v157 offset:57856
s_waitcnt vmcnt(2)
s_waitcnt lgkmcnt(8)
v_mfma_f32_16x16x32_bf16 v[108:111], v[64:67], v[92:95], v[108:111]
v_mfma_f32_16x16x32_bf16 v[112:115], v[64:67], v[96:99], v[112:115]
v_mfma_f32_16x16x32_bf16 v[116:119], v[64:67], v[100:103], v[116:119]
v_mfma_f32_16x16x32_bf16 v[120:123], v[64:67], v[104:107], v[120:123]
ds_read_b64_tr_b16 v[92:93], v154 offset:61440
ds_read_b64_tr_b16 v[94:95], v154 offset:61952
ds_read_b64_tr_b16 v[96:97], v155 offset:61440
ds_read_b64_tr_b16 v[98:99], v155 offset:61952
ds_read_b64_tr_b16 v[100:101], v156 offset:61440
ds_read_b64_tr_b16 v[102:103], v156 offset:61952
ds_read_b64_tr_b16 v[104:105], v157 offset:61440
ds_read_b64_tr_b16 v[106:107], v157 offset:61952
s_waitcnt vmcnt(1)
s_waitcnt lgkmcnt(8)
v_mfma_f32_16x16x32_bf16 v[108:111], v[68:71], v[76:79], v[108:111]
v_mfma_f32_16x16x32_bf16 v[112:115], v[68:71], v[80:83], v[112:115]
v_mfma_f32_16x16x32_bf16 v[116:119], v[68:71], v[84:87], v[116:119]
v_mfma_f32_16x16x32_bf16 v[120:123], v[68:71], v[88:91], v[120:123]
s_waitcnt vmcnt(0)
s_waitcnt lgkmcnt(0)
v_mfma_f32_16x16x32_bf16 v[108:111], v[72:75], v[92:95], v[108:111]
v_mfma_f32_16x16x32_bf16 v[112:115], v[72:75], v[96:99], v[112:115]
v_mfma_f32_16x16x32_bf16 v[116:119], v[72:75], v[100:103], v[116:119]
v_mfma_f32_16x16x32_bf16 v[120:123], v[72:75], v[104:107], v[120:123]
v_lshlrev_b32 v5, 7, v9
v_lshl_add_u32 v5, v8, 1, v5
s_lshl_b32 s6, s3, 9
s_add_u32 s6, s6, 139264
v_add_u32 v5, s6, v5
v_mul_f32 v172, v144, v108
v_fma_f32 v172, v145, v109, v172
v_fma_f32 v172, v146, v110, v172
v_fma_f32 v172, v147, v111, v172
v_cvt_pk_bf16_f32 v172, v172, v172
ds_write_b16 v5, v172 offset:0
v_mul_f32 v173, v144, v112
v_fma_f32 v173, v145, v113, v173
v_fma_f32 v173, v146, v114, v173
v_fma_f32 v173, v147, v115, v173
v_cvt_pk_bf16_f32 v173, v173, v173
ds_write_b16 v5, v173 offset:32
v_mul_f32 v174, v144, v116
v_fma_f32 v174, v145, v117, v174
v_fma_f32 v174, v146, v118, v174
v_fma_f32 v174, v147, v119, v174
v_cvt_pk_bf16_f32 v174, v174, v174
ds_write_b16 v5, v174 offset:64
v_mul_f32 v175, v144, v120
v_fma_f32 v175, v145, v121, v175
v_fma_f32 v175, v146, v122, v175
v_fma_f32 v175, v147, v123, v175
v_cvt_pk_bf16_f32 v175, v175, v175
ds_write_b16 v5, v175 offset:96
v_lshlrev_b32 v6, 7, v8
v_lshl_add_u32 v6, v9, 4, v6
v_add_u32 v6, 139264, v6
s_waitcnt lgkmcnt(0)
s_barrier
ds_read_b128 v[164:167], v6 offset:0
ds_read_b128 v[168:171], v6 offset:64
v_mul_u32_u24 v5, 147456, v9
v_and_b32 v6, 3, v1
v_bfe_u32 v7, v1, 2, 2
v_lshl_add_u32 v6, v6, 2, v7
v_lshl_add_u32 v6, v6, 2, v5
v_lshl_add_u32 v5, v8, 4, v5
s_mul_i32 s6, s9, 2304
s_mul_i32 s7, s3, 576
s_add_u32 s6, s6, s7
s_add_u32 s6, s6, 5242880
s_waitcnt lgkmcnt(0)
v_mfma_f32_16x16x32_bf16 v[108:111], v[164:167], a[96:99], 0
v_mfma_f32_16x16x32_bf16 v[108:111], v[168:171], a[100:103], v[108:111]
v_mfma_f32_16x16x32_bf16 v[112:115], v[164:167], a[104:107], 0
v_mfma_f32_16x16x32_bf16 v[112:115], v[168:171], a[108:111], v[112:115]
v_mfma_f32_16x16x32_bf16 v[116:119], v[164:167], a[112:115], 0
v_mfma_f32_16x16x32_bf16 v[116:119], v[168:171], a[116:119], v[116:119]
v_mfma_f32_16x16x32_bf16 v[120:123], v[164:167], a[120:123], 0
v_mfma_f32_16x16x32_bf16 v[120:123], v[168:171], a[124:127], v[120:123]
v_mfma_f32_16x16x32_bf16 v[124:127], v[164:167], a[128:131], 0
v_mfma_f32_16x16x32_bf16 v[124:127], v[168:171], a[132:135], v[124:127]
v_mfma_f32_16x16x32_bf16 v[128:131], v[164:167], a[136:139], 0
v_mfma_f32_16x16x32_bf16 v[128:131], v[168:171], a[140:143], v[128:131]
v_mfma_f32_16x16x32_bf16 v[132:135], v[164:167], a[144:147], 0
v_mfma_f32_16x16x32_bf16 v[132:135], v[168:171], a[148:151], v[132:135]
v_mfma_f32_16x16x32_bf16 v[136:139], v[164:167], a[152:155], 0
v_mfma_f32_16x16x32_bf16 v[136:139], v[168:171], a[156:159], v[136:139]
v_mfma_f32_16x16x32_bf16 v[140:143], v[164:167], a[160:163], 0
v_mfma_f32_16x16x32_bf16 v[140:143], v[168:171], a[164:167], v[140:143]
v_add_f32 v108, v108, v109
v_add_f32 v110, v110, v111
v_add_f32 v172, v108, v110
v_min_u32 v172, -2, v172
v_add_f32 v112, v112, v113
v_add_f32 v114, v114, v115
v_add_f32 v173, v112, v114
v_min_u32 v173, -2, v173
v_add_f32 v116, v116, v117
v_add_f32 v118, v118, v119
v_add_f32 v174, v116, v118
v_min_u32 v174, -2, v174
v_add_f32 v120, v120, v121
v_add_f32 v122, v122, v123
v_add_f32 v175, v120, v122
v_min_u32 v175, -2, v175
v_add_f32 v124, v124, v125
v_add_f32 v126, v126, v127
v_add_f32 v176, v124, v126
v_min_u32 v176, -2, v176
v_add_f32 v128, v128, v129
v_add_f32 v130, v130, v131
v_add_f32 v177, v128, v130
v_min_u32 v177, -2, v177
v_add_f32 v132, v132, v133
v_add_f32 v134, v134, v135
v_add_f32 v178, v132, v134
v_min_u32 v178, -2, v178
v_add_f32 v136, v136, v137
v_add_f32 v138, v138, v139
v_add_f32 v179, v136, v138
v_min_u32 v179, -2, v179
v_add_f32 v140, v140, v141
v_add_f32 v142, v142, v143
v_add_f32 v180, v140, v142
v_min_u32 v180, -2, v180
buffer_store_dwordx4 v[172:175], v5, s[64:67], s6 offen sc1
buffer_store_dwordx4 v[176:179], v5, s[64:67], s6 offen offset:256 sc1
buffer_store_dword v180, v6, s[64:67], s6 offen offset:512 sc1
s_and_b32 s6, s3, 1
s_lshl_b32 s6, s6, 6
s_add_u32 s14, s9, s6
s_cmp_ge_u32 s14, 72
s_cbranch_scc1 B_end
s_mul_i32 s15, s14, 57
s_lshr_b32 s15, s15, 10
s_mul_i32 s6, s15, 18
s_sub_u32 s80, s14, s6
s_lshr_b32 s7, s3, 1
s_mul_i32 s81, s15, 147456
s_lshl_b32 s6, s80, 7
s_add_u32 s81, s81, s6
s_mul_i32 s6, s7, 1048576
s_add_u32 s81, s81, s6
s_add_u32 s81, s81, 4194304
s_mul_i32 s83, s15, 2304
s_lshl_b32 s6, s80, 6
s_add_u32 s83, s83, s6
s_mul_i32 s6, s7, 1152
s_add_u32 s83, s83, s6
v_lshrrev_b32 v5, 3, v1
v_and_b32 v6, 7, v1
v_mul_u32_u24 v44, 2304, v5
v_lshl_add_u32 v44, v6, 4, v44
v_bfe_u32 v5, v1, 2, 1
v_lshl_add_u32 v5, v5, 2, v9
v_and_b32 v6, 3, v1
v_lshl_add_u32 v5, v5, 2, v6
v_lshlrev_b32 v45, 1, v5
s_mov_b32 s82, 0
s_mov_b32 s7, 400000
R_pass:
s_bitcmp1_b32 s82, 0
s_cbranch_scc1 L_ld_21
s_add_u32 s6, s81, 0
buffer_load_dwordx4 v[12:15], v44, s[64:67], s6 offen sc1
L_ld_21:
s_bitcmp1_b32 s82, 1
s_cbranch_scc1 L_ld_22
s_add_u32 s6, s81, 18432
buffer_load_dwordx4 v[16:19], v44, s[64:67], s6 offen sc1
L_ld_22:
s_bitcmp1_b32 s82, 2
s_cbranch_scc1 L_ld_23
s_add_u32 s6, s81, 36864
buffer_load_dwordx4 v[20:23], v44, s[64:67], s6 offen sc1
L_ld_23:
s_bitcmp1_b32 s82, 3
s_cbranch_scc1 L_ld_24
s_add_u32 s6, s81, 55296
buffer_load_dwordx4 v[24:27], v44, s[64:67], s6 offen sc1
L_ld_24:
s_bitcmp1_b32 s82, 4
s_cbranch_scc1 L_ld_25
s_add_u32 s6, s81, 73728
buffer_load_dwordx4 v[28:31], v44, s[64:67], s6 offen sc1
L_ld_25:
s_bitcmp1_b32 s82, 5
s_cbranch_scc1 L_ld_26
s_add_u32 s6, s81, 92160
buffer_load_dwordx4 v[32:35], v44, s[64:67], s6 offen sc1
L_ld_26:
s_bitcmp1_b32 s82, 6
s_cbranch_scc1 L_ld_27
s_add_u32 s6, s81, 110592
buffer_load_dwordx4 v[36:39], v44, s[64:67], s6 offen sc1
L_ld_27:
s_bitcmp1_b32 s82, 7
s_cbranch_scc1 L_ld_28
s_add_u32 s6, s81, 129024
buffer_load_dwordx4 v[40:43], v44, s[64:67], s6 offen sc1
L_ld_28:
s_waitcnt vmcnt(0)
s_bitcmp1_b32 s82, 0
s_cbranch_scc1 L_ck_29
v_max3_u32 v46, v12, v13, v14
v_max_u32 v46, v46, v15
v_cmp_eq_u32 vcc, -1, v46
s_cbranch_vccnz L_ck_29
s_bitset1_b32 s82, 0
L_ck_29:
s_bitcmp1_b32 s82, 1
s_cbranch_scc1 L_ck_30
v_max3_u32 v46, v16, v17, v18
v_max_u32 v46, v46, v19
v_cmp_eq_u32 vcc, -1, v46
s_cbranch_vccnz L_ck_30
s_bitset1_b32 s82, 1
L_ck_30:
s_bitcmp1_b32 s82, 2
s_cbranch_scc1 L_ck_31
v_max3_u32 v46, v20, v21, v22
v_max_u32 v46, v46, v23
v_cmp_eq_u32 vcc, -1, v46
s_cbranch_vccnz L_ck_31
s_bitset1_b32 s82, 2
L_ck_31:
s_bitcmp1_b32 s82, 3
s_cbranch_scc1 L_ck_32
v_max3_u32 v46, v24, v25, v26
v_max_u32 v46, v46, v27
v_cmp_eq_u32 vcc, -1, v46
s_cbranch_vccnz L_ck_32
s_bitset1_b32 s82, 3
L_ck_32:
s_bitcmp1_b32 s82, 4
s_cbranch_scc1 L_ck_33
v_max3_u32 v46, v28, v29, v30
v_max_u32 v46, v46, v31
v_cmp_eq_u32 vcc, -1, v46
s_cbranch_vccnz L_ck_33
s_bitset1_b32 s82, 4
L_ck_33:
s_bitcmp1_b32 s82, 5
s_cbranch_scc1 L_ck_34
v_max3_u32 v46, v32, v33, v34
v_max_u32 v46, v46, v35
v_cmp_eq_u32 vcc, -1, v46
s_cbranch_vccnz L_ck_34
s_bitset1_b32 s82, 5
L_ck_34:
s_bitcmp1_b32 s82, 6
s_cbranch_scc1 L_ck_35
v_max3_u32 v46, v36, v37, v38
v_max_u32 v46, v46, v39
v_cmp_eq_u32 vcc, -1, v46
s_cbranch_vccnz L_ck_35
s_bitset1_b32 s82, 6
L_ck_35:
s_bitcmp1_b32 s82, 7
s_cbranch_scc1 L_ck_36
v_max3_u32 v46, v40, v41, v42
v_max_u32 v46, v46, v43
v_cmp_eq_u32 vcc, -1, v46
s_cbranch_vccnz L_ck_36
s_bitset1_b32 s82, 7
L_ck_36:
s_cmp_eq_u32 s82, 255
s_cbranch_scc1 R_done
s_sleep 4
s_sub_u32 s7, s7, 1
s_cmp_lg_u32 s7, 0
s_cbranch_scc1 R_pass
R_done:
v_pk_add_f32 v[12:13], v[12:13], v[28:29]
v_pk_add_f32 v[14:15], v[14:15], v[30:31]
v_pk_add_f32 v[16:17], v[16:17], v[32:33]
v_pk_add_f32 v[18:19], v[18:19], v[34:35]
v_pk_add_f32 v[20:21], v[20:21], v[36:37]
v_pk_add_f32 v[22:23], v[22:23], v[38:39]
v_pk_add_f32 v[24:25], v[24:25], v[40:41]
v_pk_add_f32 v[26:27], v[26:27], v[42:43]
v_pk_add_f32 v[12:13], v[12:13], v[20:21]
v_pk_add_f32 v[14:15], v[14:15], v[22:23]
v_pk_add_f32 v[16:17], v[16:17], v[24:25]
v_pk_add_f32 v[18:19], v[18:19], v[26:27]
v_pk_add_f32 v[12:13], v[12:13], v[16:17]
v_pk_add_f32 v[14:15], v[14:15], v[18:19]
s_nop 1
v_permlane32_swap_b32 v12, v14
v_permlane32_swap_b32 v13, v15
v_add_f32 v12, v12, v14
v_add_f32 v13, v13, v15
s_nop 1
v_permlane16_swap_b32 v12, v13
v_add_f32 v12, v12, v13
s_nop 1
v_add_f32_dpp v12, v12, v12 row_ror:8 row_mask:0xf bank_mask:0xf
v_cvt_pk_bf16_f32 v12, v12, v12
s_mov_b32 exec_lo, 0x00ff00ff
s_mov_b32 exec_hi, 0x00ff00ff
buffer_store_short v12, v45, s[72:75], s83 offen
s_mov_b64 exec, -1
B_end:
s_endpgm
.section .rodata,"a"
.p2align 6
.amdhsa_kernel concat_heads__mha_block_cached__compressed_kv_cla__decode_kernel
  .amdhsa_next_free_vgpr 512
  .amdhsa_next_free_sgpr 102
  .amdhsa_accum_offset 256
  .amdhsa_group_segment_fixed_size 0
  .amdhsa_kernarg_size 112
  .amdhsa_user_sgpr_count 2
  .amdhsa_user_sgpr_kernarg_segment_ptr 1
  .amdhsa_system_sgpr_workgroup_id_x 1
.end_amdhsa_kernel
```

```asm
; @launch grid=(256,1,1) block=(256,1,1) lds=163840
.amdgcn_target "amdgcn-amd-amdhsa--gfx950"
.text
.globl concat_heads__mha_block_cached__compressed_kv_cla__decode_kernel
.p2align 8
.type concat_heads__mha_block_cached__compressed_kv_cla__decode_kernel,@function
concat_heads__mha_block_cached__compressed_kv_cla__decode_kernel:
s_cmp_ge_u32 s2, 256
s_cbranch_scc1 L_exit
s_load_dwordx16 s[16:31], s[0:1], 0
s_load_dwordx8 s[32:39], s[0:1], 64
s_load_dwordx4 s[40:43], s[0:1], 96
v_lshrrev_b32 v1, 6, v0
s_nop 0
v_readfirstlane_b32 s3, v1
s_and_b32 s6, s2, 7
s_bfe_u32 s7, s2, 0x20003
s_lshl_b32 s4, s6, 2
s_add_u32 s4, s4, s7
s_lshr_b32 s5, s2, 5
s_cmp_lt_u32 s5, 2
s_cbranch_scc1 B_role
A_role:
s_sub_u32 s8, s5, 2
s_cmp_ge_u32 s8, 3
s_cselect_b32 s9, 1, 0
s_cselect_b32 s6, 3, 0
s_sub_u32 s8, s8, s6
s_lshl_b32 s11, s8, 2
s_add_u32 s11, s11, s3
s_cmp_ge_u32 s11, 6
s_cselect_b32 s83, 1, 0
s_cselect_b32 s6, -1, 1
s_add_u32 s11, s11, s6
s_cmp_ge_u32 s11, 6
s_cselect_b32 s6, 6, 0
s_sub_u32 s11, s11, s6
s_lshl_b32 s10, s9, 1
s_add_u32 s10, s10, s83
v_and_b32 v1, 63, v0
v_lshlrev_b32 v2, 4, v1
s_sub_u32 s14, s11, 8
s_lshl_b32 s14, s14, 12
s_mov_b32 s13, s14
s_add_u32 s13, s13, 24576
s_min_u32 s12, s13, 2146435072
s_lshl_b32 s82, s10, 5
s_add_u32 s82, s82, s4
s_lshl_b32 s6, s82, 20
s_waitcnt lgkmcnt(0)
s_add_u32 s52, s18, s6
s_addc_u32 s53, s19, 0
s_mov_b32 s54, 1048576
s_mov_b32 s55, 0x20000
s_add_u32 s56, s20, s6
s_addc_u32 s57, s21, 0
s_mov_b32 s58, 1048576
s_mov_b32 s59, 0x20000
s_mul_i32 s6, s9, 2304
s_mul_i32 s7, s3, 288
s_add_u32 s6, s6, s7
s_sub_u32 s7, 4608, s6
s_add_u32 s44, s16, s6
s_addc_u32 s45, s17, 0
s_mov_b32 s46, s7
s_mov_b32 s47, 0x20000
s_mul_i32 s6, s3, 1179648
s_lshl_b32 s7, s4, 8
s_add_u32 s6, s6, s7
s_sub_u32 s7, 4718592, s6
s_add_u32 s48, s22, s6
s_addc_u32 s49, s23, 0
s_mov_b32 s50, s7
s_mov_b32 s51, 0x20000
v_lshrrev_b32 v5, 4, v1
v_and_b32 v6, 15, v1
v_mul_u32_u24 v3, 294912, v5
v_lshl_add_u32 v3, v6, 4, v3
v_mul_u32_u24 v4, 72, v5
v_lshrrev_b32 v6, 3, v6
v_mul_u32_u24 v6, 1152, v6
v_add_u32 v4, v4, v6
v_mov_b32 v7, 7168
s_lshr_b32 s6, s2, 3
s_sub_u32 s6, s6, 8
s_lshl_b32 s6, s6, 2
s_add_u32 s6, s6, s3
s_mul_i32 s6, s6, 49152
s_and_b32 s7, s2, 7
s_lshl_b32 s7, s7, 10
s_add_u32 s6, s6, s7
s_mov_b32 s60, s22
s_mov_b32 s61, s23
s_mov_b32 s62, 4718592
s_mov_b32 s63, 0x20000
v_min_u32 v35, 47, v1
v_lshrrev_b32 v36, 3, v35
v_lshlrev_b32 v35, 7, v35
v_mad_u32_u24 v36, v36, v7, v35
buffer_load_dword v120, v36, s[60:63], s6 offen
buffer_load_dwordx4 v[40:43], v4, s[44:47], 0 offen offset:0
buffer_load_dwordx4 v[44:47], v4, s[44:47], 0 offen offset:16
buffer_load_dwordx4 v[48:51], v4, s[44:47], 0 offen offset:32
buffer_load_dwordx4 v[52:55], v4, s[44:47], 0 offen offset:48
buffer_load_dwordx2 v[56:57], v4, s[44:47], 0 offen offset:64
s_waitcnt vmcnt(54)
buffer_load_dwordx4 v[136:139], v2, s[52:55], s12 offen offset:0 nt
buffer_load_dwordx4 v[140:143], v2, s[52:55], s12 offen offset:1024 nt
buffer_load_dwordx4 v[144:147], v2, s[52:55], s12 offen offset:2048 nt
buffer_load_dwordx4 v[148:151], v2, s[52:55], s12 offen offset:3072 nt
s_add_u32 s13, s13, 24576
s_min_u32 s12, s13, 2146435072
s_waitcnt vmcnt(54)
buffer_load_dwordx4 v[152:155], v2, s[52:55], s12 offen offset:0 nt
buffer_load_dwordx4 v[156:159], v2, s[52:55], s12 offen offset:1024 nt
buffer_load_dwordx4 v[160:163], v2, s[52:55], s12 offen offset:2048 nt
buffer_load_dwordx4 v[164:167], v2, s[52:55], s12 offen offset:3072 nt
s_add_u32 s13, s13, 24576
s_min_u32 s12, s13, 2146435072
s_cmp_lg_u32 s8, 0
s_cbranch_scc1 L_nowq_1
s_waitcnt vmcnt(20)
s_mov_b32 s6, 0
buffer_load_dwordx4 a[96:99], v3, s[48:51], s6 offen
s_mov_b32 s6, 8192
buffer_load_dwordx4 a[100:103], v3, s[48:51], s6 offen
s_mov_b32 s6, 16384
buffer_load_dwordx4 a[104:107], v3, s[48:51], s6 offen
s_mov_b32 s6, 24576
buffer_load_dwordx4 a[108:111], v3, s[48:51], s6 offen
s_mov_b32 s6, 32768
buffer_load_dwordx4 a[112:115], v3, s[48:51], s6 offen
s_mov_b32 s6, 40960
buffer_load_dwordx4 a[116:119], v3, s[48:51], s6 offen
s_mov_b32 s6, 49152
buffer_load_dwordx4 a[120:123], v3, s[48:51], s6 offen
s_mov_b32 s6, 57344
buffer_load_dwordx4 a[124:127], v3, s[48:51], s6 offen
s_mov_b32 s6, 65536
buffer_load_dwordx4 a[128:131], v3, s[48:51], s6 offen
s_mov_b32 s6, 73728
buffer_load_dwordx4 a[132:135], v3, s[48:51], s6 offen
s_mov_b32 s6, 81920
buffer_load_dwordx4 a[136:139], v3, s[48:51], s6 offen
s_mov_b32 s6, 90112
buffer_load_dwordx4 a[140:143], v3, s[48:51], s6 offen
s_mov_b32 s6, 98304
buffer_load_dwordx4 a[144:147], v3, s[48:51], s6 offen
s_mov_b32 s6, 106496
buffer_load_dwordx4 a[148:151], v3, s[48:51], s6 offen
s_mov_b32 s6, 114688
buffer_load_dwordx4 a[152:155], v3, s[48:51], s6 offen
s_mov_b32 s6, 122880
buffer_load_dwordx4 a[156:159], v3, s[48:51], s6 offen
s_mov_b32 s6, 131072
buffer_load_dwordx4 a[160:163], v3, s[48:51], s6 offen
s_mov_b32 s6, 139264
buffer_load_dwordx4 a[164:167], v3, s[48:51], s6 offen
s_mov_b32 s6, 147456
buffer_load_dwordx4 a[168:171], v3, s[48:51], s6 offen
s_mov_b32 s6, 155648
buffer_load_dwordx4 a[172:175], v3, s[48:51], s6 offen
s_mov_b32 s6, 163840
buffer_load_dwordx4 a[176:179], v3, s[48:51], s6 offen
s_mov_b32 s6, 172032
buffer_load_dwordx4 a[180:183], v3, s[48:51], s6 offen
s_mov_b32 s6, 180224
buffer_load_dwordx4 a[184:187], v3, s[48:51], s6 offen
s_mov_b32 s6, 188416
buffer_load_dwordx4 a[188:191], v3, s[48:51], s6 offen
s_mov_b32 s6, 196608
buffer_load_dwordx4 a[192:195], v3, s[48:51], s6 offen
s_mov_b32 s6, 204800
buffer_load_dwordx4 a[196:199], v3, s[48:51], s6 offen
s_mov_b32 s6, 212992
buffer_load_dwordx4 a[200:203], v3, s[48:51], s6 offen
s_mov_b32 s6, 221184
buffer_load_dwordx4 a[204:207], v3, s[48:51], s6 offen
s_mov_b32 s6, 229376
buffer_load_dwordx4 a[208:211], v3, s[48:51], s6 offen
s_mov_b32 s6, 237568
buffer_load_dwordx4 a[212:215], v3, s[48:51], s6 offen
s_mov_b32 s6, 245760
buffer_load_dwordx4 a[216:219], v3, s[48:51], s6 offen
s_mov_b32 s6, 253952
buffer_load_dwordx4 a[220:223], v3, s[48:51], s6 offen
s_mov_b32 s6, 262144
buffer_load_dwordx4 a[224:227], v3, s[48:51], s6 offen
s_mov_b32 s6, 270336
buffer_load_dwordx4 a[228:231], v3, s[48:51], s6 offen
s_mov_b32 s6, 278528
buffer_load_dwordx4 a[232:235], v3, s[48:51], s6 offen
s_mov_b32 s6, 286720
buffer_load_dwordx4 a[236:239], v3, s[48:51], s6 offen
L_nowq_1:
s_waitcnt vmcnt(54)
buffer_load_dwordx4 v[168:171], v2, s[52:55], s12 offen offset:0 nt
buffer_load_dwordx4 v[172:175], v2, s[52:55], s12 offen offset:1024 nt
buffer_load_dwordx4 v[176:179], v2, s[52:55], s12 offen offset:2048 nt
buffer_load_dwordx4 v[180:183], v2, s[52:55], s12 offen offset:3072 nt
s_add_u32 s13, s13, 24576
s_min_u32 s12, s13, 2146435072
s_waitcnt vmcnt(54)
buffer_load_dwordx4 v[184:187], v2, s[52:55], s12 offen offset:0 nt
buffer_load_dwordx4 v[188:191], v2, s[52:55], s12 offen offset:1024 nt
buffer_load_dwordx4 v[192:195], v2, s[52:55], s12 offen offset:2048 nt
buffer_load_dwordx4 v[196:199], v2, s[52:55], s12 offen offset:3072 nt
s_add_u32 s13, s13, 24576
s_min_u32 s12, s13, 2146435072
s_waitcnt vmcnt(54)
buffer_load_dwordx4 v[200:203], v2, s[52:55], s12 offen offset:0 nt
buffer_load_dwordx4 v[204:207], v2, s[52:55], s12 offen offset:1024 nt
buffer_load_dwordx4 v[208:211], v2, s[52:55], s12 offen offset:2048 nt
buffer_load_dwordx4 v[212:215], v2, s[52:55], s12 offen offset:3072 nt
s_add_u32 s13, s13, 24576
s_min_u32 s12, s13, 2146435072
s_cmp_lg_u32 s8, 1
s_cbranch_scc1 L_nowq_2
s_waitcnt vmcnt(20)
s_mov_b32 s6, 0
buffer_load_dwordx4 a[96:99], v3, s[48:51], s6 offen
s_mov_b32 s6, 8192
buffer_load_dwordx4 a[100:103], v3, s[48:51], s6 offen
s_mov_b32 s6, 16384
buffer_load_dwordx4 a[104:107], v3, s[48:51], s6 offen
s_mov_b32 s6, 24576
buffer_load_dwordx4 a[108:111], v3, s[48:51], s6 offen
s_mov_b32 s6, 32768
buffer_load_dwordx4 a[112:115], v3, s[48:51], s6 offen
s_mov_b32 s6, 40960
buffer_load_dwordx4 a[116:119], v3, s[48:51], s6 offen
s_mov_b32 s6, 49152
buffer_load_dwordx4 a[120:123], v3, s[48:51], s6 offen
s_mov_b32 s6, 57344
buffer_load_dwordx4 a[124:127], v3, s[48:51], s6 offen
s_mov_b32 s6, 65536
buffer_load_dwordx4 a[128:131], v3, s[48:51], s6 offen
s_mov_b32 s6, 73728
buffer_load_dwordx4 a[132:135], v3, s[48:51], s6 offen
s_mov_b32 s6, 81920
buffer_load_dwordx4 a[136:139], v3, s[48:51], s6 offen
s_mov_b32 s6, 90112
buffer_load_dwordx4 a[140:143], v3, s[48:51], s6 offen
s_mov_b32 s6, 98304
buffer_load_dwordx4 a[144:147], v3, s[48:51], s6 offen
s_mov_b32 s6, 106496
buffer_load_dwordx4 a[148:151], v3, s[48:51], s6 offen
s_mov_b32 s6, 114688
buffer_load_dwordx4 a[152:155], v3, s[48:51], s6 offen
s_mov_b32 s6, 122880
buffer_load_dwordx4 a[156:159], v3, s[48:51], s6 offen
s_mov_b32 s6, 131072
buffer_load_dwordx4 a[160:163], v3, s[48:51], s6 offen
s_mov_b32 s6, 139264
buffer_load_dwordx4 a[164:167], v3, s[48:51], s6 offen
s_mov_b32 s6, 147456
buffer_load_dwordx4 a[168:171], v3, s[48:51], s6 offen
s_mov_b32 s6, 155648
buffer_load_dwordx4 a[172:175], v3, s[48:51], s6 offen
s_mov_b32 s6, 163840
buffer_load_dwordx4 a[176:179], v3, s[48:51], s6 offen
s_mov_b32 s6, 172032
buffer_load_dwordx4 a[180:183], v3, s[48:51], s6 offen
s_mov_b32 s6, 180224
buffer_load_dwordx4 a[184:187], v3, s[48:51], s6 offen
s_mov_b32 s6, 188416
buffer_load_dwordx4 a[188:191], v3, s[48:51], s6 offen
s_mov_b32 s6, 196608
buffer_load_dwordx4 a[192:195], v3, s[48:51], s6 offen
s_mov_b32 s6, 204800
buffer_load_dwordx4 a[196:199], v3, s[48:51], s6 offen
s_mov_b32 s6, 212992
buffer_load_dwordx4 a[200:203], v3, s[48:51], s6 offen
s_mov_b32 s6, 221184
buffer_load_dwordx4 a[204:207], v3, s[48:51], s6 offen
s_mov_b32 s6, 229376
buffer_load_dwordx4 a[208:211], v3, s[48:51], s6 offen
s_mov_b32 s6, 237568
buffer_load_dwordx4 a[212:215], v3, s[48:51], s6 offen
s_mov_b32 s6, 245760
buffer_load_dwordx4 a[216:219], v3, s[48:51], s6 offen
s_mov_b32 s6, 253952
buffer_load_dwordx4 a[220:223], v3, s[48:51], s6 offen
s_mov_b32 s6, 262144
buffer_load_dwordx4 a[224:227], v3, s[48:51], s6 offen
s_mov_b32 s6, 270336
buffer_load_dwordx4 a[228:231], v3, s[48:51], s6 offen
s_mov_b32 s6, 278528
buffer_load_dwordx4 a[232:235], v3, s[48:51], s6 offen
s_mov_b32 s6, 286720
buffer_load_dwordx4 a[236:239], v3, s[48:51], s6 offen
L_nowq_2:
s_waitcnt vmcnt(54)
buffer_load_dwordx4 v[216:219], v2, s[52:55], s12 offen offset:0 nt
buffer_load_dwordx4 v[220:223], v2, s[52:55], s12 offen offset:1024 nt
buffer_load_dwordx4 v[224:227], v2, s[52:55], s12 offen offset:2048 nt
buffer_load_dwordx4 v[228:231], v2, s[52:55], s12 offen offset:3072 nt
s_add_u32 s13, s13, 24576
s_min_u32 s12, s13, 2146435072
s_waitcnt vmcnt(54)
buffer_load_dwordx4 v[232:235], v2, s[52:55], s12 offen offset:0 nt
buffer_load_dwordx4 v[236:239], v2, s[52:55], s12 offen offset:1024 nt
buffer_load_dwordx4 v[240:243], v2, s[52:55], s12 offen offset:2048 nt
buffer_load_dwordx4 v[244:247], v2, s[52:55], s12 offen offset:3072 nt
s_add_u32 s13, s13, 24576
s_min_u32 s12, s13, 2146435072
s_waitcnt vmcnt(54)
s_add_u32 s34, s14, 24576
s_min_u32 s34, s34, 2146435072
buffer_load_dwordx4 a[0:3], v2, s[56:59], s34 offen offset:0 nt
buffer_load_dwordx4 a[4:7], v2, s[56:59], s34 offen offset:1024 nt
buffer_load_dwordx4 a[8:11], v2, s[56:59], s34 offen offset:2048 nt
buffer_load_dwordx4 a[12:15], v2, s[56:59], s34 offen offset:3072 nt
s_cmp_lg_u32 s8, 2
s_cbranch_scc1 L_nowq_3
s_waitcnt vmcnt(20)
s_mov_b32 s6, 0
buffer_load_dwordx4 a[96:99], v3, s[48:51], s6 offen
s_mov_b32 s6, 8192
buffer_load_dwordx4 a[100:103], v3, s[48:51], s6 offen
s_mov_b32 s6, 16384
buffer_load_dwordx4 a[104:107], v3, s[48:51], s6 offen
s_mov_b32 s6, 24576
buffer_load_dwordx4 a[108:111], v3, s[48:51], s6 offen
s_mov_b32 s6, 32768
buffer_load_dwordx4 a[112:115], v3, s[48:51], s6 offen
s_mov_b32 s6, 40960
buffer_load_dwordx4 a[116:119], v3, s[48:51], s6 offen
s_mov_b32 s6, 49152
buffer_load_dwordx4 a[120:123], v3, s[48:51], s6 offen
s_mov_b32 s6, 57344
buffer_load_dwordx4 a[124:127], v3, s[48:51], s6 offen
s_mov_b32 s6, 65536
buffer_load_dwordx4 a[128:131], v3, s[48:51], s6 offen
s_mov_b32 s6, 73728
buffer_load_dwordx4 a[132:135], v3, s[48:51], s6 offen
s_mov_b32 s6, 81920
buffer_load_dwordx4 a[136:139], v3, s[48:51], s6 offen
s_mov_b32 s6, 90112
buffer_load_dwordx4 a[140:143], v3, s[48:51], s6 offen
s_mov_b32 s6, 98304
buffer_load_dwordx4 a[144:147], v3, s[48:51], s6 offen
s_mov_b32 s6, 106496
buffer_load_dwordx4 a[148:151], v3, s[48:51], s6 offen
s_mov_b32 s6, 114688
buffer_load_dwordx4 a[152:155], v3, s[48:51], s6 offen
s_mov_b32 s6, 122880
buffer_load_dwordx4 a[156:159], v3, s[48:51], s6 offen
s_mov_b32 s6, 131072
buffer_load_dwordx4 a[160:163], v3, s[48:51], s6 offen
s_mov_b32 s6, 139264
buffer_load_dwordx4 a[164:167], v3, s[48:51], s6 offen
s_mov_b32 s6, 147456
buffer_load_dwordx4 a[168:171], v3, s[48:51], s6 offen
s_mov_b32 s6, 155648
buffer_load_dwordx4 a[172:175], v3, s[48:51], s6 offen
s_mov_b32 s6, 163840
buffer_load_dwordx4 a[176:179], v3, s[48:51], s6 offen
s_mov_b32 s6, 172032
buffer_load_dwordx4 a[180:183], v3, s[48:51], s6 offen
s_mov_b32 s6, 180224
buffer_load_dwordx4 a[184:187], v3, s[48:51], s6 offen
s_mov_b32 s6, 188416
buffer_load_dwordx4 a[188:191], v3, s[48:51], s6 offen
s_mov_b32 s6, 196608
buffer_load_dwordx4 a[192:195], v3, s[48:51], s6 offen
s_mov_b32 s6, 204800
buffer_load_dwordx4 a[196:199], v3, s[48:51], s6 offen
s_mov_b32 s6, 212992
buffer_load_dwordx4 a[200:203], v3, s[48:51], s6 offen
s_mov_b32 s6, 221184
buffer_load_dwordx4 a[204:207], v3, s[48:51], s6 offen
s_mov_b32 s6, 229376
buffer_load_dwordx4 a[208:211], v3, s[48:51], s6 offen
s_mov_b32 s6, 237568
buffer_load_dwordx4 a[212:215], v3, s[48:51], s6 offen
s_mov_b32 s6, 245760
buffer_load_dwordx4 a[216:219], v3, s[48:51], s6 offen
s_mov_b32 s6, 253952
buffer_load_dwordx4 a[220:223], v3, s[48:51], s6 offen
s_mov_b32 s6, 262144
buffer_load_dwordx4 a[224:227], v3, s[48:51], s6 offen
s_mov_b32 s6, 270336
buffer_load_dwordx4 a[228:231], v3, s[48:51], s6 offen
s_mov_b32 s6, 278528
buffer_load_dwordx4 a[232:235], v3, s[48:51], s6 offen
s_mov_b32 s6, 286720
buffer_load_dwordx4 a[236:239], v3, s[48:51], s6 offen
L_nowq_3:
s_mov_b32 s64, s42
s_mov_b32 s65, s43
s_mov_b32 s66, 6291456
s_mov_b32 s67, 0x20000
s_mov_b32 s68, s40
s_mov_b32 s69, s41
s_mov_b32 s70, 256
s_mov_b32 s71, 0x20000
s_mul_i32 s6, s4, 147456
s_add_u32 s60, s24, s6
s_addc_u32 s61, s25, 0
s_mov_b32 s62, 147456
s_mov_b32 s63, 0x20000
v_and_b32 v5, 1, v1
v_lshlrev_b32 v5, 4, v5
v_mov_b32 v6, 0xffff
v_lshlrev_b32 v5, v5, v6
v_bfe_u32 v6, v1, 1, 2
v_cmp_eq_u32 vcc, 0, v6
s_nop 1
v_cndmask_b32 v8, 0, v5, vcc
v_cmp_eq_u32 vcc, 1, v6
s_nop 1
v_cndmask_b32 v9, 0, v5, vcc
v_cmp_eq_u32 vcc, 2, v6
s_nop 1
v_cndmask_b32 v10, 0, v5, vcc
v_cmp_eq_u32 vcc, 3, v6
s_nop 1
v_cndmask_b32 v11, 0, v5, vcc
v_mov_b32 v5, 0x0c0c0c0c
s_mov_b32 s6, 0x01000100
s_mov_b32 s7, 0x03020302
v_bfi_b32 v12, v8, s6, v5
v_bfi_b32 v13, v9, s6, v5
v_bfi_b32 v14, v10, s6, v5
v_bfi_b32 v15, v11, s6, v5
v_bfi_b32 v16, v8, s7, v5
v_bfi_b32 v17, v9, s7, v5
v_bfi_b32 v18, v10, s7, v5
v_bfi_b32 v19, v11, s7, v5
v_mov_b32 v7, 0x3e0293ee
v_mov_b32 v86, 0xff800000
v_lshrrev_b32 v5, 4, v1
v_lshlrev_b32 v5, 3, v5
v_bfe_u32 v6, v1, 2, 2
v_add_u32 v5, v5, v6
v_mul_u32_u24 v5, 1152, v5
s_mul_i32 s6, s3, 288
v_add_u32 v5, s6, v5
v_and_b32 v6, 3, v1
v_lshl_add_u32 v88, v6, 5, v5
v_lshl_add_u32 v89, v6, 3, v5
v_add_u32 v89, 256, v89
v_add_u32 v90, 73728, v88
v_add_u32 v91, 73728, v89
s_lshl_b32 s82, s82, 6
s_add_u32 s82, s82, 327680
s_mov_b64 s[72:73], 0
s_cmp_ge_u32 s11, 2
s_cselect_b32 s74, 0x22222222, 0
s_mov_b32 s75, s74
s_mov_b32 s76, 0x44444444
s_mov_b32 s77, s76
s_mov_b32 s78, 0x88888888
s_mov_b32 s79, s78
v_bfe_u32 v5, v1, 4, 1
s_lshl_b32 s6, s9, 7
s_lshl_b32 s7, s4, 1
s_add_u32 s6, s6, s7
s_add_u32 s6, s6, s8
v_mul_u32_u24 v6, 63, v5
v_add_u32 v6, s6, v6
v_mul_u32_u24 v92, 2304, v6
v_add_u32 v92, 4194304, v92
v_sub_u32 v6, s8, v5
v_cmp_lt_u32 vcc, 1, v6
v_mov_b32 v6, 2146435072
s_nop 0
v_cndmask_b32 v92, v92, v6, vcc
s_mul_i32 s6, s3, 576
v_add_u32 v92, s6, v92
v_and_b32 v35, 3, v1
v_bfe_u32 v36, v1, 2, 2
v_lshl_add_u32 v35, v35, 2, v36
v_lshl_add_u32 v93, v35, 2, v92
v_and_b32 v35, 15, v1
v_lshrrev_b32 v36, 5, v1
v_lshl_add_u32 v35, v36, 4, v35
v_lshl_add_u32 v92, v35, 4, v92
s_lshl_b32 s6, s8, 2
s_add_u32 s6, s6, 0
s_cmp_ge_u32 s6, 6
s_cselect_b32 s6, 1, 0
v_cmp_eq_u32 vcc, s6, v5
s_nop 1
v_cndmask_b32 v106, 0, 1.0, vcc
s_lshl_b32 s6, s8, 2
s_add_u32 s6, s6, 1
s_cmp_ge_u32 s6, 6
s_cselect_b32 s6, 1, 0
v_cmp_eq_u32 vcc, s6, v5
s_nop 1
v_cndmask_b32 v107, 0, 1.0, vcc
s_lshl_b32 s6, s8, 2
s_add_u32 s6, s6, 2
s_cmp_ge_u32 s6, 6
s_cselect_b32 s6, 1, 0
v_cmp_eq_u32 vcc, s6, v5
s_nop 1
v_cndmask_b32 v108, 0, 1.0, vcc
s_lshl_b32 s6, s8, 2
s_add_u32 s6, s6, 3
s_cmp_ge_u32 s6, 6
s_cselect_b32 s6, 1, 0
v_cmp_eq_u32 vcc, s6, v5
s_nop 1
v_cndmask_b32 v109, 0, 1.0, vcc
v_cmp_gt_u32 vcc, 32, v1
s_nop 1
v_cndmask_b32 v98, 0, v106, vcc
v_cndmask_b32 v102, v106, 0, vcc
v_cndmask_b32 v99, 0, v107, vcc
v_cndmask_b32 v103, v107, 0, vcc
v_cndmask_b32 v100, 0, v108, vcc
v_cndmask_b32 v104, v108, 0, vcc
v_cndmask_b32 v101, 0, v109, vcc
v_cndmask_b32 v105, v109, 0, vcc
v_and_b32 v35, 15, v1
v_lshlrev_b32 v35, 4, v35
v_lshl_add_u32 v94, v5, 3, v35
s_lshl_b32 s6, s3, 8
s_add_u32 s6, s6, 151552
v_add_u32 v94, s6, v94
v_and_b32 v35, 3, v1
v_lshlrev_b32 v35, 8, v35
v_lshrrev_b32 v36, 4, v1
v_lshl_add_u32 v95, v36, 4, v35
v_add_u32 v95, 151552, v95
s_mul_i32 s15, s3, 36864
s_mov_b32 s80, 0x0
s_mov_b32 s81, 0
s_lshl_b32 s6, s4, 1
s_add_u32 s6, s6, s9
s_mul_i32 s6, s6, 4
s_add_u32 s6, s6, s8
s_lshl_b32 s6, s6, 2
s_add_u32 s6, s6, 393216
v_mov_b32 v118, 2146435072
v_mov_b32 v117, s6
v_cmp_eq_u32 vcc, 0, v0
s_nop 1
v_cndmask_b32 v118, v118, v117, vcc
v_mov_b32 v117, 3
v_and_b32 v35, 15, v1
v_lshlrev_b32 v35, 5, v35
v_lshl_add_u32 v36, v5, 4, v35
v_lshrrev_b32 v6, 5, v1
v_lshl_add_u32 v36, v6, 9, v36
s_lshl_b32 s6, s3, 10
s_add_u32 s6, s6, 147456
v_add_u32 v36, s6, v36
s_lshl_b32 s6, s83, 9
s_add_u32 s6, s6, 147456
v_add_u32 v35, s6, v35
s_waitcnt vmcnt(35)
v_perm_b32 v60, v40, v40, v12
v_perm_b32 v61, v40, v40, v13
v_perm_b32 v62, v40, v40, v14
v_perm_b32 v63, v40, v40, v15
s_nop 1
v_mfma_f32_16x16x32_bf16 v[20:23], v[60:63], a[96:99], 0
s_add_u32 s34, s14, 49152
s_min_u32 s34, s34, 2146435072
buffer_load_dwordx4 a[16:19], v2, s[56:59], s34 offen offset:0 nt
s_waitcnt vmcnt(35)
v_perm_b32 v64, v40, v40, v16
v_perm_b32 v65, v40, v40, v17
v_perm_b32 v66, v40, v40, v18
v_perm_b32 v67, v40, v40, v19
s_nop 1
v_mfma_f32_16x16x32_bf16 v[20:23], v[64:67], a[100:103], v[20:23]
buffer_load_dwordx4 a[20:23], v2, s[56:59], s34 offen offset:1024 nt
s_waitcnt vmcnt(35)
v_perm_b32 v68, v41, v41, v12
v_perm_b32 v69, v41, v41, v13
v_perm_b32 v70, v41, v41, v14
v_perm_b32 v71, v41, v41, v15
s_nop 1
v_mfma_f32_16x16x32_bf16 v[20:23], v[68:71], a[104:107], v[20:23]
buffer_load_dwordx4 a[24:27], v2, s[56:59], s34 offen offset:2048 nt
s_waitcnt vmcnt(35)
v_perm_b32 v72, v41, v41, v16
v_perm_b32 v73, v41, v41, v17
v_perm_b32 v74, v41, v41, v18
v_perm_b32 v75, v41, v41, v19
s_nop 1
v_mfma_f32_16x16x32_bf16 v[20:23], v[72:75], a[108:111], v[20:23]
buffer_load_dwordx4 a[28:31], v2, s[56:59], s34 offen offset:3072 nt
s_waitcnt vmcnt(35)
v_perm_b32 v60, v42, v42, v12
v_perm_b32 v61, v42, v42, v13
v_perm_b32 v62, v42, v42, v14
v_perm_b32 v63, v42, v42, v15
s_nop 1
v_mfma_f32_16x16x32_bf16 v[20:23], v[60:63], a[112:115], v[20:23]
s_add_u32 s34, s14, 73728
s_min_u32 s34, s34, 2146435072
buffer_load_dwordx4 a[32:35], v2, s[56:59], s34 offen offset:0 nt
s_waitcnt vmcnt(35)
v_perm_b32 v64, v42, v42, v16
v_perm_b32 v65, v42, v42, v17
v_perm_b32 v66, v42, v42, v18
v_perm_b32 v67, v42, v42, v19
s_nop 1
v_mfma_f32_16x16x32_bf16 v[20:23], v[64:67], a[116:119], v[20:23]
buffer_load_dwordx4 a[36:39], v2, s[56:59], s34 offen offset:1024 nt
s_waitcnt vmcnt(35)
v_perm_b32 v68, v43, v43, v12
v_perm_b32 v69, v43, v43, v13
v_perm_b32 v70, v43, v43, v14
v_perm_b32 v71, v43, v43, v15
s_nop 1
v_mfma_f32_16x16x32_bf16 v[20:23], v[68:71], a[120:123], v[20:23]
buffer_load_dwordx4 a[40:43], v2, s[56:59], s34 offen offset:2048 nt
s_waitcnt vmcnt(35)
v_perm_b32 v72, v43, v43, v16
v_perm_b32 v73, v43, v43, v17
v_perm_b32 v74, v43, v43, v18
v_perm_b32 v75, v43, v43, v19
s_nop 1
v_mfma_f32_16x16x32_bf16 v[20:23], v[72:75], a[124:127], v[20:23]
buffer_load_dwordx4 a[44:47], v2, s[56:59], s34 offen offset:3072 nt
s_waitcnt vmcnt(35)
v_perm_b32 v60, v44, v44, v12
v_perm_b32 v61, v44, v44, v13
v_perm_b32 v62, v44, v44, v14
v_perm_b32 v63, v44, v44, v15
s_nop 1
v_mfma_f32_16x16x32_bf16 v[20:23], v[60:63], a[128:131], v[20:23]
s_add_u32 s34, s14, 98304
s_min_u32 s34, s34, 2146435072
buffer_load_dwordx4 a[48:51], v2, s[56:59], s34 offen offset:0 nt
s_waitcnt vmcnt(35)
v_perm_b32 v64, v44, v44, v16
v_perm_b32 v65, v44, v44, v17
v_perm_b32 v66, v44, v44, v18
v_perm_b32 v67, v44, v44, v19
s_nop 1
v_mfma_f32_16x16x32_bf16 v[20:23], v[64:67], a[132:135], v[20:23]
buffer_load_dwordx4 a[52:55], v2, s[56:59], s34 offen offset:1024 nt
s_waitcnt vmcnt(35)
v_perm_b32 v68, v45, v45, v12
v_perm_b32 v69, v45, v45, v13
v_perm_b32 v70, v45, v45, v14
v_perm_b32 v71, v45, v45, v15
s_nop 1
v_mfma_f32_16x16x32_bf16 v[20:23], v[68:71], a[136:139], v[20:23]
buffer_load_dwordx4 a[56:59], v2, s[56:59], s34 offen offset:2048 nt
s_waitcnt vmcnt(35)
v_perm_b32 v72, v45, v45, v16
v_perm_b32 v73, v45, v45, v17
v_perm_b32 v74, v45, v45, v18
v_perm_b32 v75, v45, v45, v19
s_nop 1
v_mfma_f32_16x16x32_bf16 v[20:23], v[72:75], a[140:143], v[20:23]
buffer_load_dwordx4 a[60:63], v2, s[56:59], s34 offen offset:3072 nt
s_waitcnt vmcnt(35)
v_perm_b32 v60, v46, v46, v12
v_perm_b32 v61, v46, v46, v13
v_perm_b32 v62, v46, v46, v14
v_perm_b32 v63, v46, v46, v15
s_nop 1
v_mfma_f32_16x16x32_bf16 v[20:23], v[60:63], a[144:147], v[20:23]
s_add_u32 s34, s14, 122880
s_min_u32 s34, s34, 2146435072
buffer_load_dwordx4 a[64:67], v2, s[56:59], s34 offen offset:0 nt
s_waitcnt vmcnt(35)
v_perm_b32 v64, v46, v46, v16
v_perm_b32 v65, v46, v46, v17
v_perm_b32 v66, v46, v46, v18
v_perm_b32 v67, v46, v46, v19
s_nop 1
v_mfma_f32_16x16x32_bf16 v[20:23], v[64:67], a[148:151], v[20:23]
buffer_load_dwordx4 a[68:71], v2, s[56:59], s34 offen offset:1024 nt
s_waitcnt vmcnt(35)
v_perm_b32 v68, v47, v47, v12
v_perm_b32 v69, v47, v47, v13
v_perm_b32 v70, v47, v47, v14
v_perm_b32 v71, v47, v47, v15
s_nop 1
v_mfma_f32_16x16x32_bf16 v[20:23], v[68:71], a[152:155], v[20:23]
buffer_load_dwordx4 a[72:75], v2, s[56:59], s34 offen offset:2048 nt
s_waitcnt vmcnt(35)
v_perm_b32 v72, v47, v47, v16
v_perm_b32 v73, v47, v47, v17
v_perm_b32 v74, v47, v47, v18
v_perm_b32 v75, v47, v47, v19
s_nop 1
v_mfma_f32_16x16x32_bf16 v[20:23], v[72:75], a[156:159], v[20:23]
buffer_load_dwordx4 a[76:79], v2, s[56:59], s34 offen offset:3072 nt
s_waitcnt vmcnt(35)
v_perm_b32 v60, v48, v48, v12
v_perm_b32 v61, v48, v48, v13
v_perm_b32 v62, v48, v48, v14
v_perm_b32 v63, v48, v48, v15
s_nop 1
v_mfma_f32_16x16x32_bf16 v[20:23], v[60:63], a[160:163], v[20:23]
s_add_u32 s34, s14, 147456
s_min_u32 s34, s34, 2146435072
buffer_load_dwordx4 a[80:83], v2, s[56:59], s34 offen offset:0 nt
s_waitcnt vmcnt(35)
v_perm_b32 v64, v48, v48, v16
v_perm_b32 v65, v48, v48, v17
v_perm_b32 v66, v48, v48, v18
v_perm_b32 v67, v48, v48, v19
s_nop 1
v_mfma_f32_16x16x32_bf16 v[20:23], v[64:67], a[164:167], v[20:23]
buffer_load_dwordx4 a[84:87], v2, s[56:59], s34 offen offset:1024 nt
s_waitcnt vmcnt(35)
v_perm_b32 v68, v49, v49, v12
v_perm_b32 v69, v49, v49, v13
v_perm_b32 v70, v49, v49, v14
v_perm_b32 v71, v49, v49, v15
s_nop 1
v_mfma_f32_16x16x32_bf16 v[20:23], v[68:71], a[168:171], v[20:23]
buffer_load_dwordx4 a[88:91], v2, s[56:59], s34 offen offset:2048 nt
s_waitcnt vmcnt(35)
v_perm_b32 v72, v49, v49, v16
v_perm_b32 v73, v49, v49, v17
v_perm_b32 v74, v49, v49, v18
v_perm_b32 v75, v49, v49, v19
s_nop 1
v_mfma_f32_16x16x32_bf16 v[20:23], v[72:75], a[172:175], v[20:23]
buffer_load_dwordx4 a[92:95], v2, s[56:59], s34 offen offset:3072 nt
s_waitcnt vmcnt(35)
v_perm_b32 v60, v50, v50, v12
v_perm_b32 v61, v50, v50, v13
v_perm_b32 v62, v50, v50, v14
v_perm_b32 v63, v50, v50, v15
s_nop 1
v_mfma_f32_16x16x32_bf16 v[20:23], v[60:63], a[176:179], v[20:23]
s_add_u32 s34, s14, 172032
s_min_u32 s34, s34, 2146435072
buffer_load_dwordx4 a[240:243], v2, s[56:59], s34 offen offset:0 nt
s_waitcnt vmcnt(35)
v_perm_b32 v64, v50, v50, v16
v_perm_b32 v65, v50, v50, v17
v_perm_b32 v66, v50, v50, v18
v_perm_b32 v67, v50, v50, v19
s_nop 1
v_mfma_f32_16x16x32_bf16 v[20:23], v[64:67], a[180:183], v[20:23]
buffer_load_dwordx4 a[244:247], v2, s[56:59], s34 offen offset:1024 nt
s_waitcnt vmcnt(35)
v_perm_b32 v68, v51, v51, v12
v_perm_b32 v69, v51, v51, v13
v_perm_b32 v70, v51, v51, v14
v_perm_b32 v71, v51, v51, v15
s_nop 1
v_mfma_f32_16x16x32_bf16 v[20:23], v[68:71], a[184:187], v[20:23]
buffer_load_dwordx4 a[248:251], v2, s[56:59], s34 offen offset:2048 nt
s_waitcnt vmcnt(35)
v_perm_b32 v72, v51, v51, v16
v_perm_b32 v73, v51, v51, v17
v_perm_b32 v74, v51, v51, v18
v_perm_b32 v75, v51, v51, v19
s_nop 1
v_mfma_f32_16x16x32_bf16 v[20:23], v[72:75], a[188:191], v[20:23]
buffer_load_dwordx4 a[252:255], v2, s[56:59], s34 offen offset:3072 nt
s_waitcnt vmcnt(35)
v_perm_b32 v60, v52, v52, v12
v_perm_b32 v61, v52, v52, v13
v_perm_b32 v62, v52, v52, v14
v_perm_b32 v63, v52, v52, v15
s_nop 1
v_mfma_f32_16x16x32_bf16 v[20:23], v[60:63], a[192:195], v[20:23]
s_waitcnt vmcnt(34)
v_perm_b32 v64, v52, v52, v16
v_perm_b32 v65, v52, v52, v17
v_perm_b32 v66, v52, v52, v18
v_perm_b32 v67, v52, v52, v19
s_nop 1
v_mfma_f32_16x16x32_bf16 v[20:23], v[64:67], a[196:199], v[20:23]
s_waitcnt vmcnt(33)
v_perm_b32 v68, v53, v53, v12
v_perm_b32 v69, v53, v53, v13
v_perm_b32 v70, v53, v53, v14
v_perm_b32 v71, v53, v53, v15
s_nop 1
v_mfma_f32_16x16x32_bf16 v[20:23], v[68:71], a[200:203], v[20:23]
s_waitcnt vmcnt(32)
v_perm_b32 v72, v53, v53, v16
v_perm_b32 v73, v53, v53, v17
v_perm_b32 v74, v53, v53, v18
v_perm_b32 v75, v53, v53, v19
s_nop 1
v_mfma_f32_16x16x32_bf16 v[20:23], v[72:75], a[204:207], v[20:23]
s_waitcnt vmcnt(31)
v_perm_b32 v60, v54, v54, v12
v_perm_b32 v61, v54, v54, v13
v_perm_b32 v62, v54, v54, v14
v_perm_b32 v63, v54, v54, v15
s_nop 1
v_mfma_f32_16x16x32_bf16 v[20:23], v[60:63], a[208:211], v[20:23]
s_waitcnt vmcnt(30)
v_perm_b32 v64, v54, v54, v16
v_perm_b32 v65, v54, v54, v17
v_perm_b32 v66, v54, v54, v18
v_perm_b32 v67, v54, v54, v19
s_nop 1
v_mfma_f32_16x16x32_bf16 v[20:23], v[64:67], a[212:215], v[20:23]
s_waitcnt vmcnt(29)
v_perm_b32 v68, v55, v55, v12
v_perm_b32 v69, v55, v55, v13
v_perm_b32 v70, v55, v55, v14
v_perm_b32 v71, v55, v55, v15
s_nop 1
v_mfma_f32_16x16x32_bf16 v[20:23], v[68:71], a[216:219], v[20:23]
s_waitcnt vmcnt(28)
v_perm_b32 v72, v55, v55, v16
v_perm_b32 v73, v55, v55, v17
v_perm_b32 v74, v55, v55, v18
v_perm_b32 v75, v55, v55, v19
s_nop 1
v_mfma_f32_16x16x32_bf16 v[20:23], v[72:75], a[220:223], v[20:23]
s_waitcnt vmcnt(27)
v_perm_b32 v60, v56, v56, v12
v_perm_b32 v61, v56, v56, v13
v_perm_b32 v62, v56, v56, v14
v_perm_b32 v63, v56, v56, v15
s_nop 1
v_mfma_f32_16x16x32_bf16 v[20:23], v[60:63], a[224:227], v[20:23]
s_waitcnt vmcnt(26)
v_perm_b32 v64, v56, v56, v16
v_perm_b32 v65, v56, v56, v17
v_perm_b32 v66, v56, v56, v18
v_perm_b32 v67, v56, v56, v19
s_nop 1
v_mfma_f32_16x16x32_bf16 v[20:23], v[64:67], a[228:231], v[20:23]
s_waitcnt vmcnt(25)
v_perm_b32 v68, v57, v57, v12
v_perm_b32 v69, v57, v57, v13
v_perm_b32 v70, v57, v57, v14
v_perm_b32 v71, v57, v57, v15
s_nop 1
v_mfma_f32_16x16x32_bf16 v[20:23], v[68:71], a[232:235], v[20:23]
s_waitcnt vmcnt(24)
v_perm_b32 v72, v57, v57, v16
v_perm_b32 v73, v57, v57, v17
v_perm_b32 v74, v57, v57, v18
v_perm_b32 v75, v57, v57, v19
s_nop 1
v_mfma_f32_16x16x32_bf16 v[20:23], v[72:75], a[236:239], v[20:23]
s_nop 7
ds_write_b128 v36, v[20:23]
s_waitcnt lgkmcnt(0)
s_barrier
ds_read_b128 v[40:43], v35 offset:0
ds_read_b128 v[44:47], v35 offset:16
ds_read_b128 v[48:51], v35 offset:1024
ds_read_b128 v[52:55], v35 offset:1040
ds_read_b128 v[56:59], v35 offset:2048
ds_read_b128 v[60:63], v35 offset:2064
ds_read_b128 v[64:67], v35 offset:3072
ds_read_b128 v[68:71], v35 offset:3088
v_mov_b32 v20, 0
v_mov_b32 v21, 0
v_mov_b32 v22, 0
v_mov_b32 v23, 0
s_waitcnt lgkmcnt(0)
v_add_f32 v40, v40, v48
v_add_f32 v56, v56, v64
v_add_f32 v41, v41, v49
v_add_f32 v57, v57, v65
v_add_f32 v42, v42, v50
v_add_f32 v58, v58, v66
v_add_f32 v43, v43, v51
v_add_f32 v59, v59, v67
v_add_f32 v44, v44, v52
v_add_f32 v60, v60, v68
v_add_f32 v45, v45, v53
v_add_f32 v61, v61, v69
v_add_f32 v46, v46, v54
v_add_f32 v62, v62, v70
v_add_f32 v47, v47, v55
v_add_f32 v63, v63, v71
v_add_f32 v40, v40, v56
v_add_f32 v41, v41, v57
v_add_f32 v42, v42, v58
v_add_f32 v43, v43, v59
v_add_f32 v44, v44, v60
v_add_f32 v45, v45, v61
v_add_f32 v46, v46, v62
v_add_f32 v47, v47, v63
v_cvt_pk_bf16_f32 v24, v40, v41
v_cvt_pk_bf16_f32 v25, v42, v43
v_cvt_pk_bf16_f32 v26, v44, v45
v_cvt_pk_bf16_f32 v27, v46, v47
s_add_u32 s14, s14, 196608
K_loop:
s_cmp_lg_u32 s81, 8
s_cbranch_scc1 L_c0_4
buffer_load_dword v96, off, s[68:71], 0 offset:0 sc1
L_c0_4:
s_waitcnt vmcnt(28)
v_dot2_f32_bf16 v28, v120, v24, 0
v_dot2_f32_bf16 v29, v124, v24, 0
v_dot2_f32_bf16 v30, v128, v24, 0
v_dot2_f32_bf16 v31, v132, v24, 0
v_dot2_f32_bf16 v28, v121, v25, v28
v_dot2_f32_bf16 v29, v125, v25, v29
v_dot2_f32_bf16 v30, v129, v25, v30
v_dot2_f32_bf16 v31, v133, v25, v31
v_dot2_f32_bf16 v28, v122, v26, v28
v_dot2_f32_bf16 v29, v126, v26, v29
v_dot2_f32_bf16 v30, v130, v26, v30
v_dot2_f32_bf16 v31, v134, v26, v31
v_dot2_f32_bf16 v28, v123, v27, v28
v_dot2_f32_bf16 v29, v127, v27, v29
v_dot2_f32_bf16 v30, v131, v27, v30
v_dot2_f32_bf16 v31, v135, v27, v31
buffer_load_dwordx4 v[120:123], v2, s[52:55], s12 offen offset:0 nt
buffer_load_dwordx4 v[124:127], v2, s[52:55], s12 offen offset:1024 nt
buffer_load_dwordx4 v[128:131], v2, s[52:55], s12 offen offset:2048 nt
buffer_load_dwordx4 v[132:135], v2, s[52:55], s12 offen offset:3072 nt
s_add_u32 s13, s13, 24576
s_min_u32 s12, s13, 2146435072
s_cmp_ge_u32 s80, 36
s_cbranch_scc1 L_nodma_5
s_mov_b32 m0, s15
s_nop 0
buffer_load_dwordx4 v2, s[60:63], s15 offen  lds
s_add_u32 s15, s15, 1024
L_nodma_5:
s_add_u32 s80, s80, 1
v_add_f32_dpp v32, v28, v28 row_ror:8 row_mask:0xf bank_mask:0x3
v_add_f32_dpp v33, v29, v29 row_ror:8 row_mask:0xf bank_mask:0x3
v_add_f32_dpp v32, v30, v30 row_ror:8 row_mask:0xf bank_mask:0xc
v_add_f32_dpp v33, v31, v31 row_ror:8 row_mask:0xf bank_mask:0xc
s_nop 0
v_add_f32_dpp v34, v32, v32 row_half_mirror row_mask:0xf bank_mask:0x5
v_add_f32_dpp v34, v33, v33 row_half_mirror row_mask:0xf bank_mask:0xa
s_nop 1
v_add_f32_dpp v34, v34, v34 quad_perm:[1,0,3,2] row_mask:0xf bank_mask:0xf
s_nop 1
v_add_f32_dpp v34, v34, v34 quad_perm:[2,3,0,1] row_mask:0xf bank_mask:0xf
v_cndmask_b32 v86, v86, v34, s[72:73]
s_waitcnt vmcnt(28)
v_dot2_f32_bf16 v28, v136, v24, 0
v_dot2_f32_bf16 v29, v140, v24, 0
v_dot2_f32_bf16 v30, v144, v24, 0
v_dot2_f32_bf16 v31, v148, v24, 0
v_dot2_f32_bf16 v28, v137, v25, v28
v_dot2_f32_bf16 v29, v141, v25, v29
v_dot2_f32_bf16 v30, v145, v25, v30
v_dot2_f32_bf16 v31, v149, v25, v31
v_dot2_f32_bf16 v28, v138, v26, v28
v_dot2_f32_bf16 v29, v142, v26, v29
v_dot2_f32_bf16 v30, v146, v26, v30
v_dot2_f32_bf16 v31, v150, v26, v31
v_dot2_f32_bf16 v28, v139, v27, v28
v_dot2_f32_bf16 v29, v143, v27, v29
v_dot2_f32_bf16 v30, v147, v27, v30
v_dot2_f32_bf16 v31, v151, v27, v31
buffer_load_dwordx4 v[136:139], v2, s[52:55], s12 offen offset:0 nt
buffer_load_dwordx4 v[140:143], v2, s[52:55], s12 offen offset:1024 nt
buffer_load_dwordx4 v[144:147], v2, s[52:55], s12 offen offset:2048 nt
buffer_load_dwordx4 v[148:151], v2, s[52:55], s12 offen offset:3072 nt
s_add_u32 s13, s13, 24576
s_min_u32 s12, s13, 2146435072
s_cmp_ge_u32 s80, 36
s_cbranch_scc1 L_nodma_6
s_mov_b32 m0, s15
s_nop 0
buffer_load_dwordx4 v2, s[60:63], s15 offen  lds
s_add_u32 s15, s15, 1024
L_nodma_6:
s_add_u32 s80, s80, 1
v_add_f32_dpp v32, v28, v28 row_ror:8 row_mask:0xf bank_mask:0x3
v_add_f32_dpp v33, v29, v29 row_ror:8 row_mask:0xf bank_mask:0x3
v_add_f32_dpp v32, v30, v30 row_ror:8 row_mask:0xf bank_mask:0xc
v_add_f32_dpp v33, v31, v31 row_ror:8 row_mask:0xf bank_mask:0xc
s_nop 0
v_add_f32_dpp v34, v32, v32 row_half_mirror row_mask:0xf bank_mask:0x5
v_add_f32_dpp v34, v33, v33 row_half_mirror row_mask:0xf bank_mask:0xa
s_nop 1
v_add_f32_dpp v34, v34, v34 quad_perm:[1,0,3,2] row_mask:0xf bank_mask:0xf
s_nop 1
v_add_f32_dpp v34, v34, v34 quad_perm:[2,3,0,1] row_mask:0xf bank_mask:0xf
v_cndmask_b32 v86, v86, v34, s[74:75]
s_waitcnt vmcnt(28)
v_dot2_f32_bf16 v28, v152, v24, 0
v_dot2_f32_bf16 v29, v156, v24, 0
v_dot2_f32_bf16 v30, v160, v24, 0
v_dot2_f32_bf16 v31, v164, v24, 0
v_dot2_f32_bf16 v28, v153, v25, v28
v_dot2_f32_bf16 v29, v157, v25, v29
v_dot2_f32_bf16 v30, v161, v25, v30
v_dot2_f32_bf16 v31, v165, v25, v31
v_dot2_f32_bf16 v28, v154, v26, v28
v_dot2_f32_bf16 v29, v158, v26, v29
v_dot2_f32_bf16 v30, v162, v26, v30
v_dot2_f32_bf16 v31, v166, v26, v31
v_dot2_f32_bf16 v28, v155, v27, v28
v_dot2_f32_bf16 v29, v159, v27, v29
v_dot2_f32_bf16 v30, v163, v27, v30
v_dot2_f32_bf16 v31, v167, v27, v31
buffer_load_dwordx4 v[152:155], v2, s[52:55], s12 offen offset:0 nt
buffer_load_dwordx4 v[156:159], v2, s[52:55], s12 offen offset:1024 nt
buffer_load_dwordx4 v[160:163], v2, s[52:55], s12 offen offset:2048 nt
buffer_load_dwordx4 v[164:167], v2, s[52:55], s12 offen offset:3072 nt
s_add_u32 s13, s13, 24576
s_min_u32 s12, s13, 2146435072
s_cmp_ge_u32 s80, 36
s_cbranch_scc1 L_nodma_7
s_mov_b32 m0, s15
s_nop 0
buffer_load_dwordx4 v2, s[60:63], s15 offen  lds
s_add_u32 s15, s15, 1024
L_nodma_7:
s_add_u32 s80, s80, 1
v_add_f32_dpp v32, v28, v28 row_ror:8 row_mask:0xf bank_mask:0x3
v_add_f32_dpp v33, v29, v29 row_ror:8 row_mask:0xf bank_mask:0x3
v_add_f32_dpp v32, v30, v30 row_ror:8 row_mask:0xf bank_mask:0xc
v_add_f32_dpp v33, v31, v31 row_ror:8 row_mask:0xf bank_mask:0xc
s_nop 0
v_add_f32_dpp v34, v32, v32 row_half_mirror row_mask:0xf bank_mask:0x5
v_add_f32_dpp v34, v33, v33 row_half_mirror row_mask:0xf bank_mask:0xa
s_nop 1
v_add_f32_dpp v34, v34, v34 quad_perm:[1,0,3,2] row_mask:0xf bank_mask:0xf
s_nop 1
v_add_f32_dpp v34, v34, v34 quad_perm:[2,3,0,1] row_mask:0xf bank_mask:0xf
v_cndmask_b32 v86, v86, v34, s[76:77]
s_waitcnt vmcnt(28)
v_dot2_f32_bf16 v28, v168, v24, 0
v_dot2_f32_bf16 v29, v172, v24, 0
v_dot2_f32_bf16 v30, v176, v24, 0
v_dot2_f32_bf16 v31, v180, v24, 0
v_dot2_f32_bf16 v28, v169, v25, v28
v_dot2_f32_bf16 v29, v173, v25, v29
v_dot2_f32_bf16 v30, v177, v25, v30
v_dot2_f32_bf16 v31, v181, v25, v31
v_dot2_f32_bf16 v28, v170, v26, v28
v_dot2_f32_bf16 v29, v174, v26, v29
v_dot2_f32_bf16 v30, v178, v26, v30
v_dot2_f32_bf16 v31, v182, v26, v31
v_dot2_f32_bf16 v28, v171, v27, v28
v_dot2_f32_bf16 v29, v175, v27, v29
v_dot2_f32_bf16 v30, v179, v27, v30
v_dot2_f32_bf16 v31, v183, v27, v31
buffer_load_dwordx4 v[168:171], v2, s[52:55], s12 offen offset:0 nt
buffer_load_dwordx4 v[172:175], v2, s[52:55], s12 offen offset:1024 nt
buffer_load_dwordx4 v[176:179], v2, s[52:55], s12 offen offset:2048 nt
buffer_load_dwordx4 v[180:183], v2, s[52:55], s12 offen offset:3072 nt
s_add_u32 s13, s13, 24576
s_min_u32 s12, s13, 2146435072
s_cmp_ge_u32 s80, 36
s_cbranch_scc1 L_nodma_8
s_mov_b32 m0, s15
s_nop 0
buffer_load_dwordx4 v2, s[60:63], s15 offen  lds
s_add_u32 s15, s15, 1024
L_nodma_8:
s_add_u32 s80, s80, 1
v_add_f32_dpp v32, v28, v28 row_ror:8 row_mask:0xf bank_mask:0x3
v_add_f32_dpp v33, v29, v29 row_ror:8 row_mask:0xf bank_mask:0x3
v_add_f32_dpp v32, v30, v30 row_ror:8 row_mask:0xf bank_mask:0xc
v_add_f32_dpp v33, v31, v31 row_ror:8 row_mask:0xf bank_mask:0xc
s_nop 0
v_add_f32_dpp v34, v32, v32 row_half_mirror row_mask:0xf bank_mask:0x5
v_add_f32_dpp v34, v33, v33 row_half_mirror row_mask:0xf bank_mask:0xa
s_nop 1
v_add_f32_dpp v34, v34, v34 quad_perm:[1,0,3,2] row_mask:0xf bank_mask:0xf
s_nop 1
v_add_f32_dpp v34, v34, v34 quad_perm:[2,3,0,1] row_mask:0xf bank_mask:0xf
v_cndmask_b32 v86, v86, v34, s[78:79]
s_add_u32 s81, s81, 1
s_cmp_eq_u32 s81, 11
s_cbranch_scc1 A_mid
v_mov_b32 v76, v77
v_mov_b32 v77, v78
v_mov_b32 v78, v79
v_mov_b32 v79, v80
v_mov_b32 v80, v81
v_mov_b32 v81, v82
v_mov_b32 v82, v83
v_mov_b32 v83, v84
v_mov_b32 v84, v85
v_mov_b32 v85, v86
s_lshr_b64 s[72:73], s[76:77], 2
s_lshr_b64 s[74:75], s[76:77], 1
s_cmp_eq_u32 s81, 9
s_cselect_b32 s52, s56, s52
s_cselect_b32 s53, s57, s53
s_cselect_b32 s13, s14, s13
s_min_u32 s12, s13, 2146435072
s_waitcnt vmcnt(28)
v_dot2_f32_bf16 v28, v184, v24, 0
v_dot2_f32_bf16 v29, v188, v24, 0
v_dot2_f32_bf16 v30, v192, v24, 0
v_dot2_f32_bf16 v31, v196, v24, 0
v_dot2_f32_bf16 v28, v185, v25, v28
v_dot2_f32_bf16 v29, v189, v25, v29
v_dot2_f32_bf16 v30, v193, v25, v30
v_dot2_f32_bf16 v31, v197, v25, v31
v_dot2_f32_bf16 v28, v186, v26, v28
v_dot2_f32_bf16 v29, v190, v26, v29
v_dot2_f32_bf16 v30, v194, v26, v30
v_dot2_f32_bf16 v31, v198, v26, v31
v_dot2_f32_bf16 v28, v187, v27, v28
v_dot2_f32_bf16 v29, v191, v27, v29
v_dot2_f32_bf16 v30, v195, v27, v30
v_dot2_f32_bf16 v31, v199, v27, v31
buffer_load_dwordx4 v[184:187], v2, s[52:55], s12 offen offset:0 nt
buffer_load_dwordx4 v[188:191], v2, s[52:55], s12 offen offset:1024 nt
buffer_load_dwordx4 v[192:195], v2, s[52:55], s12 offen offset:2048 nt
buffer_load_dwordx4 v[196:199], v2, s[52:55], s12 offen offset:3072 nt
s_add_u32 s13, s13, 24576
s_min_u32 s12, s13, 2146435072
s_cmp_ge_u32 s80, 36
s_cbranch_scc1 L_nodma_9
s_mov_b32 m0, s15
s_nop 0
buffer_load_dwordx4 v2, s[60:63], s15 offen  lds
s_add_u32 s15, s15, 1024
L_nodma_9:
s_add_u32 s80, s80, 1
v_add_f32_dpp v32, v28, v28 row_ror:8 row_mask:0xf bank_mask:0x3
v_add_f32_dpp v33, v29, v29 row_ror:8 row_mask:0xf bank_mask:0x3
v_add_f32_dpp v32, v30, v30 row_ror:8 row_mask:0xf bank_mask:0xc
v_add_f32_dpp v33, v31, v31 row_ror:8 row_mask:0xf bank_mask:0xc
s_nop 0
v_add_f32_dpp v34, v32, v32 row_half_mirror row_mask:0xf bank_mask:0x5
v_add_f32_dpp v34, v33, v33 row_half_mirror row_mask:0xf bank_mask:0xa
s_nop 1
v_add_f32_dpp v34, v34, v34 quad_perm:[1,0,3,2] row_mask:0xf bank_mask:0xf
s_nop 1
v_add_f32_dpp v34, v34, v34 quad_perm:[2,3,0,1] row_mask:0xf bank_mask:0xf
v_cndmask_b32 v86, v86, v34, s[72:73]
s_waitcnt vmcnt(28)
v_dot2_f32_bf16 v28, v200, v24, 0
v_dot2_f32_bf16 v29, v204, v24, 0
v_dot2_f32_bf16 v30, v208, v24, 0
v_dot2_f32_bf16 v31, v212, v24, 0
v_dot2_f32_bf16 v28, v201, v25, v28
v_dot2_f32_bf16 v29, v205, v25, v29
v_dot2_f32_bf16 v30, v209, v25, v30
v_dot2_f32_bf16 v31, v213, v25, v31
v_dot2_f32_bf16 v28, v202, v26, v28
v_dot2_f32_bf16 v29, v206, v26, v29
v_dot2_f32_bf16 v30, v210, v26, v30
v_dot2_f32_bf16 v31, v214, v26, v31
v_dot2_f32_bf16 v28, v203, v27, v28
v_dot2_f32_bf16 v29, v207, v27, v29
v_dot2_f32_bf16 v30, v211, v27, v30
v_dot2_f32_bf16 v31, v215, v27, v31
buffer_load_dwordx4 v[200:203], v2, s[52:55], s12 offen offset:0 nt
buffer_load_dwordx4 v[204:207], v2, s[52:55], s12 offen offset:1024 nt
buffer_load_dwordx4 v[208:211], v2, s[52:55], s12 offen offset:2048 nt
buffer_load_dwordx4 v[212:215], v2, s[52:55], s12 offen offset:3072 nt
s_add_u32 s13, s13, 24576
s_min_u32 s12, s13, 2146435072
s_cmp_ge_u32 s80, 36
s_cbranch_scc1 L_nodma_10
s_mov_b32 m0, s15
s_nop 0
buffer_load_dwordx4 v2, s[60:63], s15 offen  lds
s_add_u32 s15, s15, 1024
L_nodma_10:
s_add_u32 s80, s80, 1
v_add_f32_dpp v32, v28, v28 row_ror:8 row_mask:0xf bank_mask:0x3
v_add_f32_dpp v33, v29, v29 row_ror:8 row_mask:0xf bank_mask:0x3
v_add_f32_dpp v32, v30, v30 row_ror:8 row_mask:0xf bank_mask:0xc
v_add_f32_dpp v33, v31, v31 row_ror:8 row_mask:0xf bank_mask:0xc
s_nop 0
v_add_f32_dpp v34, v32, v32 row_half_mirror row_mask:0xf bank_mask:0x5
v_add_f32_dpp v34, v33, v33 row_half_mirror row_mask:0xf bank_mask:0xa
s_nop 1
v_add_f32_dpp v34, v34, v34 quad_perm:[1,0,3,2] row_mask:0xf bank_mask:0xf
s_nop 1
v_add_f32_dpp v34, v34, v34 quad_perm:[2,3,0,1] row_mask:0xf bank_mask:0xf
v_cndmask_b32 v86, v86, v34, s[74:75]
s_waitcnt vmcnt(28)
v_dot2_f32_bf16 v28, v216, v24, 0
v_dot2_f32_bf16 v29, v220, v24, 0
v_dot2_f32_bf16 v30, v224, v24, 0
v_dot2_f32_bf16 v31, v228, v24, 0
v_dot2_f32_bf16 v28, v217, v25, v28
v_dot2_f32_bf16 v29, v221, v25, v29
v_dot2_f32_bf16 v30, v225, v25, v30
v_dot2_f32_bf16 v31, v229, v25, v31
v_dot2_f32_bf16 v28, v218, v26, v28
v_dot2_f32_bf16 v29, v222, v26, v29
v_dot2_f32_bf16 v30, v226, v26, v30
v_dot2_f32_bf16 v31, v230, v26, v31
v_dot2_f32_bf16 v28, v219, v27, v28
v_dot2_f32_bf16 v29, v223, v27, v29
v_dot2_f32_bf16 v30, v227, v27, v30
v_dot2_f32_bf16 v31, v231, v27, v31
buffer_load_dwordx4 v[216:219], v2, s[52:55], s12 offen offset:0 nt
buffer_load_dwordx4 v[220:223], v2, s[52:55], s12 offen offset:1024 nt
buffer_load_dwordx4 v[224:227], v2, s[52:55], s12 offen offset:2048 nt
buffer_load_dwordx4 v[228:231], v2, s[52:55], s12 offen offset:3072 nt
s_add_u32 s13, s13, 24576
s_min_u32 s12, s13, 2146435072
s_cmp_ge_u32 s80, 36
s_cbranch_scc1 L_nodma_11
s_mov_b32 m0, s15
s_nop 0
buffer_load_dwordx4 v2, s[60:63], s15 offen  lds
s_add_u32 s15, s15, 1024
L_nodma_11:
s_add_u32 s80, s80, 1
v_add_f32_dpp v32, v28, v28 row_ror:8 row_mask:0xf bank_mask:0x3
v_add_f32_dpp v33, v29, v29 row_ror:8 row_mask:0xf bank_mask:0x3
v_add_f32_dpp v32, v30, v30 row_ror:8 row_mask:0xf bank_mask:0xc
v_add_f32_dpp v33, v31, v31 row_ror:8 row_mask:0xf bank_mask:0xc
s_nop 0
v_add_f32_dpp v34, v32, v32 row_half_mirror row_mask:0xf bank_mask:0x5
v_add_f32_dpp v34, v33, v33 row_half_mirror row_mask:0xf bank_mask:0xa
s_nop 1
v_add_f32_dpp v34, v34, v34 quad_perm:[1,0,3,2] row_mask:0xf bank_mask:0xf
s_nop 1
v_add_f32_dpp v34, v34, v34 quad_perm:[2,3,0,1] row_mask:0xf bank_mask:0xf
v_cndmask_b32 v86, v86, v34, s[76:77]
s_waitcnt vmcnt(28)
v_dot2_f32_bf16 v28, v232, v24, 0
v_dot2_f32_bf16 v29, v236, v24, 0
v_dot2_f32_bf16 v30, v240, v24, 0
v_dot2_f32_bf16 v31, v244, v24, 0
v_dot2_f32_bf16 v28, v233, v25, v28
v_dot2_f32_bf16 v29, v237, v25, v29
v_dot2_f32_bf16 v30, v241, v25, v30
v_dot2_f32_bf16 v31, v245, v25, v31
v_dot2_f32_bf16 v28, v234, v26, v28
v_dot2_f32_bf16 v29, v238, v26, v29
v_dot2_f32_bf16 v30, v242, v26, v30
v_dot2_f32_bf16 v31, v246, v26, v31
v_dot2_f32_bf16 v28, v235, v27, v28
v_dot2_f32_bf16 v29, v239, v27, v29
v_dot2_f32_bf16 v30, v243, v27, v30
v_dot2_f32_bf16 v31, v247, v27, v31
buffer_load_dwordx4 v[232:235], v2, s[52:55], s12 offen offset:0 nt
buffer_load_dwordx4 v[236:239], v2, s[52:55], s12 offen offset:1024 nt
buffer_load_dwordx4 v[240:243], v2, s[52:55], s12 offen offset:2048 nt
buffer_load_dwordx4 v[244:247], v2, s[52:55], s12 offen offset:3072 nt
s_add_u32 s13, s13, 24576
s_min_u32 s12, s13, 2146435072
s_cmp_ge_u32 s80, 36
s_cbranch_scc1 L_nodma_12
s_mov_b32 m0, s15
s_nop 0
buffer_load_dwordx4 v2, s[60:63], s15 offen  lds
s_add_u32 s15, s15, 1024
L_nodma_12:
s_add_u32 s80, s80, 1
v_add_f32_dpp v32, v28, v28 row_ror:8 row_mask:0xf bank_mask:0x3
v_add_f32_dpp v33, v29, v29 row_ror:8 row_mask:0xf bank_mask:0x3
v_add_f32_dpp v32, v30, v30 row_ror:8 row_mask:0xf bank_mask:0xc
v_add_f32_dpp v33, v31, v31 row_ror:8 row_mask:0xf bank_mask:0xc
s_nop 0
v_add_f32_dpp v34, v32, v32 row_half_mirror row_mask:0xf bank_mask:0x5
v_add_f32_dpp v34, v33, v33 row_half_mirror row_mask:0xf bank_mask:0xa
s_nop 1
v_add_f32_dpp v34, v34, v34 quad_perm:[1,0,3,2] row_mask:0xf bank_mask:0xf
s_nop 1
v_add_f32_dpp v34, v34, v34 quad_perm:[2,3,0,1] row_mask:0xf bank_mask:0xf
v_cndmask_b32 v86, v86, v34, s[78:79]
s_add_u32 s81, s81, 1
v_mov_b32 v76, v77
v_mov_b32 v77, v78
v_mov_b32 v78, v79
v_mov_b32 v79, v80
v_mov_b32 v80, v81
v_mov_b32 v81, v82
v_mov_b32 v82, v83
v_mov_b32 v83, v84
v_mov_b32 v84, v85
v_mov_b32 v85, v86
s_branch K_loop
A_mid:
v_max3_f32 v35, v76, v77, v78
v_max3_f32 v35, v35, v79, v80
v_max3_f32 v35, v35, v81, v82
v_max3_f32 v35, v35, v83, v84
v_max3_f32 v35, v35, v85, v86
s_nop 1
v_max_f32_dpp v35, v35, v35 row_ror:8 row_mask:0xf bank_mask:0xf
s_nop 1
v_max_f32_dpp v35, v35, v35 row_ror:4 row_mask:0xf bank_mask:0xf
s_nop 1
v_max_f32_dpp v35, v35, v35 row_ror:2 row_mask:0xf bank_mask:0xf
s_nop 1
v_max_f32_dpp v35, v35, v35 row_ror:1 row_mask:0xf bank_mask:0xf
v_mov_b32 v36, v35
s_nop 1
v_permlane16_swap_b32 v35, v36
v_max_f32 v35, v35, v36
v_mov_b32 v36, v35
s_nop 1
v_permlane32_swap_b32 v35, v36
v_max_f32 v35, v35, v36
v_mul_f32 v32, v35, v7
v_fma_f32 v76, v76, v7, -v32
v_fma_f32 v77, v77, v7, -v32
v_fma_f32 v78, v78, v7, -v32
v_fma_f32 v79, v79, v7, -v32
v_fma_f32 v80, v80, v7, -v32
v_fma_f32 v81, v81, v7, -v32
v_fma_f32 v82, v82, v7, -v32
v_fma_f32 v83, v83, v7, -v32
v_fma_f32 v84, v84, v7, -v32
v_fma_f32 v85, v85, v7, -v32
v_fma_f32 v86, v86, v7, -v32
v_exp_f32 v76, v76
v_exp_f32 v77, v77
v_exp_f32 v78, v78
v_exp_f32 v79, v79
v_exp_f32 v80, v80
v_exp_f32 v81, v81
v_exp_f32 v82, v82
v_exp_f32 v83, v83
v_exp_f32 v84, v84
v_exp_f32 v85, v85
v_exp_f32 v86, v86
v_add_f32 v35, v76, v77
v_add_f32 v35, v35, v78
v_add_f32 v35, v35, v79
v_add_f32 v35, v35, v80
v_add_f32 v35, v35, v81
v_add_f32 v35, v35, v82
v_add_f32 v35, v35, v83
v_add_f32 v35, v35, v84
v_add_f32 v35, v35, v85
v_add_f32 v35, v35, v86
v_cvt_pk_bf16_f32 v76, v76, v76
v_cvt_pk_bf16_f32 v77, v77, v77
v_cvt_pk_bf16_f32 v78, v78, v78
v_cvt_pk_bf16_f32 v79, v79, v79
v_cvt_pk_bf16_f32 v80, v80, v80
v_cvt_pk_bf16_f32 v81, v81, v81
v_cvt_pk_bf16_f32 v82, v82, v82
v_cvt_pk_bf16_f32 v83, v83, v83
v_cvt_pk_bf16_f32 v84, v84, v84
v_cvt_pk_bf16_f32 v85, v85, v85
v_cvt_pk_bf16_f32 v86, v86, v86
v_add_f32_dpp v35, v35, v35 row_ror:8 row_mask:0xf bank_mask:0xf
s_nop 1
v_add_f32_dpp v35, v35, v35 row_ror:4 row_mask:0xf bank_mask:0xf
s_nop 1
v_add_f32_dpp v35, v35, v35 row_ror:2 row_mask:0xf bank_mask:0xf
s_nop 1
v_add_f32_dpp v35, v35, v35 row_ror:1 row_mask:0xf bank_mask:0xf
v_mov_b32 v36, v35
s_nop 1
v_permlane16_swap_b32 v35, v36
v_add_f32 v35, v35, v36
v_mov_b32 v36, v35
s_nop 1
v_permlane32_swap_b32 v35, v36
v_add_f32 v35, v35, v36
v_min_u32 v32, -2, v32
v_min_u32 v33, -2, v35
s_mov_b32 s7, 400000
L_ens_13:
v_readfirstlane_b32 s6, v96
s_cmp_ge_u32 s6, 128
s_cbranch_scc1 L_ensd_14
s_sleep 16
buffer_load_dword v96, off, s[68:71], 0 offset:0 sc1
s_waitcnt vmcnt(0)
s_sub_u32 s7, s7, 1
s_cmp_lg_u32 s7, 0
s_cbranch_scc1 L_ens_13
L_ensd_14:
s_lshl_b32 s6, s11, 3
s_add_u32 s6, s6, s82
s_mov_b64 exec, 1
buffer_store_dwordx2 v[32:33], off, s[64:67], s6 sc1
s_mov_b64 exec, -1
v_and_b32_dpp v60, v78, v8 row_newbcast:0 row_mask:0xf bank_mask:0xf
v_and_b32_dpp v61, v78, v9 row_newbcast:0 row_mask:0xf bank_mask:0xf
v_and_b32_dpp v62, v78, v10 row_newbcast:0 row_mask:0xf bank_mask:0xf
v_and_b32_dpp v63, v78, v11 row_newbcast:0 row_mask:0xf bank_mask:0xf
v_and_b32_dpp v64, v78, v8 row_newbcast:4 row_mask:0xf bank_mask:0xf
v_and_b32_dpp v65, v78, v9 row_newbcast:4 row_mask:0xf bank_mask:0xf
v_and_b32_dpp v66, v78, v10 row_newbcast:4 row_mask:0xf bank_mask:0xf
v_and_b32_dpp v67, v78, v11 row_newbcast:4 row_mask:0xf bank_mask:0xf
v_and_b32_dpp v68, v78, v8 row_newbcast:8 row_mask:0xf bank_mask:0xf
v_and_b32_dpp v69, v78, v9 row_newbcast:8 row_mask:0xf bank_mask:0xf
v_and_b32_dpp v70, v78, v10 row_newbcast:8 row_mask:0xf bank_mask:0xf
v_and_b32_dpp v71, v78, v11 row_newbcast:8 row_mask:0xf bank_mask:0xf
v_and_b32_dpp v72, v78, v8 row_newbcast:12 row_mask:0xf bank_mask:0xf
v_and_b32_dpp v73, v78, v9 row_newbcast:12 row_mask:0xf bank_mask:0xf
v_and_b32_dpp v74, v78, v10 row_newbcast:12 row_mask:0xf bank_mask:0xf
v_and_b32_dpp v75, v78, v11 row_newbcast:12 row_mask:0xf bank_mask:0xf
s_waitcnt vmcnt(28)
v_mfma_f32_16x16x32_bf16 v[20:23], v[60:63], v[184:187], v[20:23]
v_mfma_f32_16x16x32_bf16 v[20:23], v[64:67], v[188:191], v[20:23]
v_mfma_f32_16x16x32_bf16 v[20:23], v[68:71], v[192:195], v[20:23]
v_mfma_f32_16x16x32_bf16 v[20:23], v[72:75], v[196:199], v[20:23]
v_add_u32 v117, 1, v117
buffer_store_dword v117, v118, s[64:67], 0 offen
buffer_load_dwordx4 v[184:187], v2, s[52:55], s12 offen offset:0 nt
buffer_load_dwordx4 v[188:191], v2, s[52:55], s12 offen offset:1024 nt
buffer_load_dwordx4 v[192:195], v2, s[52:55], s12 offen offset:2048 nt
buffer_load_dwordx4 v[196:199], v2, s[52:55], s12 offen offset:3072 nt
s_add_u32 s13, s13, 24576
s_min_u32 s12, s13, 2146435072
v_and_b32_dpp v60, v78, v8 row_newbcast:1 row_mask:0xf bank_mask:0xf
v_and_b32_dpp v61, v78, v9 row_newbcast:1 row_mask:0xf bank_mask:0xf
v_and_b32_dpp v62, v78, v10 row_newbcast:1 row_mask:0xf bank_mask:0xf
v_and_b32_dpp v63, v78, v11 row_newbcast:1 row_mask:0xf bank_mask:0xf
v_and_b32_dpp v64, v78, v8 row_newbcast:5 row_mask:0xf bank_mask:0xf
v_and_b32_dpp v65, v78, v9 row_newbcast:5 row_mask:0xf bank_mask:0xf
v_and_b32_dpp v66, v78, v10 row_newbcast:5 row_mask:0xf bank_mask:0xf
v_and_b32_dpp v67, v78, v11 row_newbcast:5 row_mask:0xf bank_mask:0xf
v_and_b32_dpp v68, v78, v8 row_newbcast:9 row_mask:0xf bank_mask:0xf
v_and_b32_dpp v69, v78, v9 row_newbcast:9 row_mask:0xf bank_mask:0xf
v_and_b32_dpp v70, v78, v10 row_newbcast:9 row_mask:0xf bank_mask:0xf
v_and_b32_dpp v71, v78, v11 row_newbcast:9 row_mask:0xf bank_mask:0xf
v_and_b32_dpp v72, v78, v8 row_newbcast:13 row_mask:0xf bank_mask:0xf
v_and_b32_dpp v73, v78, v9 row_newbcast:13 row_mask:0xf bank_mask:0xf
v_and_b32_dpp v74, v78, v10 row_newbcast:13 row_mask:0xf bank_mask:0xf
v_and_b32_dpp v75, v78, v11 row_newbcast:13 row_mask:0xf bank_mask:0xf
s_waitcnt vmcnt(28)
v_mfma_f32_16x16x32_bf16 v[20:23], v[60:63], v[200:203], v[20:23]
v_mfma_f32_16x16x32_bf16 v[20:23], v[64:67], v[204:207], v[20:23]
v_mfma_f32_16x16x32_bf16 v[20:23], v[68:71], v[208:211], v[20:23]
v_mfma_f32_16x16x32_bf16 v[20:23], v[72:75], v[212:215], v[20:23]
v_add_u32 v117, 1, v117
buffer_store_dword v117, v118, s[64:67], 0 offen
buffer_load_dwordx4 v[200:203], v2, s[52:55], s12 offen offset:0 nt
buffer_load_dwordx4 v[204:207], v2, s[52:55], s12 offen offset:1024 nt
buffer_load_dwordx4 v[208:211], v2, s[52:55], s12 offen offset:2048 nt
buffer_load_dwordx4 v[212:215], v2, s[52:55], s12 offen offset:3072 nt
s_add_u32 s13, s13, 24576
s_min_u32 s12, s13, 2146435072
v_and_b32_dpp v60, v76, v8 row_newbcast:1 row_mask:0xf bank_mask:0xf
v_and_b32_dpp v61, v76, v9 row_newbcast:1 row_mask:0xf bank_mask:0xf
v_and_b32_dpp v62, v76, v10 row_newbcast:1 row_mask:0xf bank_mask:0xf
v_and_b32_dpp v63, v76, v11 row_newbcast:1 row_mask:0xf bank_mask:0xf
v_and_b32_dpp v64, v76, v8 row_newbcast:5 row_mask:0xf bank_mask:0xf
v_and_b32_dpp v65, v76, v9 row_newbcast:5 row_mask:0xf bank_mask:0xf
v_and_b32_dpp v66, v76, v10 row_newbcast:5 row_mask:0xf bank_mask:0xf
v_and_b32_dpp v67, v76, v11 row_newbcast:5 row_mask:0xf bank_mask:0xf
v_and_b32_dpp v68, v76, v8 row_newbcast:9 row_mask:0xf bank_mask:0xf
v_and_b32_dpp v69, v76, v9 row_newbcast:9 row_mask:0xf bank_mask:0xf
v_and_b32_dpp v70, v76, v10 row_newbcast:9 row_mask:0xf bank_mask:0xf
v_and_b32_dpp v71, v76, v11 row_newbcast:9 row_mask:0xf bank_mask:0xf
v_and_b32_dpp v72, v76, v8 row_newbcast:13 row_mask:0xf bank_mask:0xf
v_and_b32_dpp v73, v76, v9 row_newbcast:13 row_mask:0xf bank_mask:0xf
v_and_b32_dpp v74, v76, v10 row_newbcast:13 row_mask:0xf bank_mask:0xf
v_and_b32_dpp v75, v76, v11 row_newbcast:13 row_mask:0xf bank_mask:0xf
v_mfma_f32_16x16x32_bf16 v[20:23], v[60:63], a[0:3], v[20:23]
v_mfma_f32_16x16x32_bf16 v[20:23], v[64:67], a[4:7], v[20:23]
v_mfma_f32_16x16x32_bf16 v[20:23], v[68:71], a[8:11], v[20:23]
v_mfma_f32_16x16x32_bf16 v[20:23], v[72:75], a[12:15], v[20:23]
s_nop 3
v_and_b32_dpp v60, v78, v8 row_newbcast:2 row_mask:0xf bank_mask:0xf
v_and_b32_dpp v61, v78, v9 row_newbcast:2 row_mask:0xf bank_mask:0xf
v_and_b32_dpp v62, v78, v10 row_newbcast:2 row_mask:0xf bank_mask:0xf
v_and_b32_dpp v63, v78, v11 row_newbcast:2 row_mask:0xf bank_mask:0xf
v_and_b32_dpp v64, v78, v8 row_newbcast:6 row_mask:0xf bank_mask:0xf
v_and_b32_dpp v65, v78, v9 row_newbcast:6 row_mask:0xf bank_mask:0xf
v_and_b32_dpp v66, v78, v10 row_newbcast:6 row_mask:0xf bank_mask:0xf
v_and_b32_dpp v67, v78, v11 row_newbcast:6 row_mask:0xf bank_mask:0xf
v_and_b32_dpp v68, v78, v8 row_newbcast:10 row_mask:0xf bank_mask:0xf
v_and_b32_dpp v69, v78, v9 row_newbcast:10 row_mask:0xf bank_mask:0xf
v_and_b32_dpp v70, v78, v10 row_newbcast:10 row_mask:0xf bank_mask:0xf
v_and_b32_dpp v71, v78, v11 row_newbcast:10 row_mask:0xf bank_mask:0xf
v_and_b32_dpp v72, v78, v8 row_newbcast:14 row_mask:0xf bank_mask:0xf
v_and_b32_dpp v73, v78, v9 row_newbcast:14 row_mask:0xf bank_mask:0xf
v_and_b32_dpp v74, v78, v10 row_newbcast:14 row_mask:0xf bank_mask:0xf
v_and_b32_dpp v75, v78, v11 row_newbcast:14 row_mask:0xf bank_mask:0xf
s_waitcnt vmcnt(28)
v_mfma_f32_16x16x32_bf16 v[20:23], v[60:63], v[216:219], v[20:23]
v_mfma_f32_16x16x32_bf16 v[20:23], v[64:67], v[220:223], v[20:23]
v_mfma_f32_16x16x32_bf16 v[20:23], v[68:71], v[224:227], v[20:23]
v_mfma_f32_16x16x32_bf16 v[20:23], v[72:75], v[228:231], v[20:23]
v_add_u32 v117, 1, v117
buffer_store_dword v117, v118, s[64:67], 0 offen
buffer_load_dwordx4 v[216:219], v2, s[52:55], s12 offen offset:0 nt
buffer_load_dwordx4 v[220:223], v2, s[52:55], s12 offen offset:1024 nt
buffer_load_dwordx4 v[224:227], v2, s[52:55], s12 offen offset:2048 nt
buffer_load_dwordx4 v[228:231], v2, s[52:55], s12 offen offset:3072 nt
s_add_u32 s13, s13, 24576
s_min_u32 s12, s13, 2146435072
v_and_b32_dpp v60, v78, v8 row_newbcast:3 row_mask:0xf bank_mask:0xf
v_and_b32_dpp v61, v78, v9 row_newbcast:3 row_mask:0xf bank_mask:0xf
v_and_b32_dpp v62, v78, v10 row_newbcast:3 row_mask:0xf bank_mask:0xf
v_and_b32_dpp v63, v78, v11 row_newbcast:3 row_mask:0xf bank_mask:0xf
v_and_b32_dpp v64, v78, v8 row_newbcast:7 row_mask:0xf bank_mask:0xf
v_and_b32_dpp v65, v78, v9 row_newbcast:7 row_mask:0xf bank_mask:0xf
v_and_b32_dpp v66, v78, v10 row_newbcast:7 row_mask:0xf bank_mask:0xf
v_and_b32_dpp v67, v78, v11 row_newbcast:7 row_mask:0xf bank_mask:0xf
v_and_b32_dpp v68, v78, v8 row_newbcast:11 row_mask:0xf bank_mask:0xf
v_and_b32_dpp v69, v78, v9 row_newbcast:11 row_mask:0xf bank_mask:0xf
v_and_b32_dpp v70, v78, v10 row_newbcast:11 row_mask:0xf bank_mask:0xf
v_and_b32_dpp v71, v78, v11 row_newbcast:11 row_mask:0xf bank_mask:0xf
v_and_b32_dpp v72, v78, v8 row_newbcast:15 row_mask:0xf bank_mask:0xf
v_and_b32_dpp v73, v78, v9 row_newbcast:15 row_mask:0xf bank_mask:0xf
v_and_b32_dpp v74, v78, v10 row_newbcast:15 row_mask:0xf bank_mask:0xf
v_and_b32_dpp v75, v78, v11 row_newbcast:15 row_mask:0xf bank_mask:0xf
s_waitcnt vmcnt(28)
v_mfma_f32_16x16x32_bf16 v[20:23], v[60:63], v[232:235], v[20:23]
v_mfma_f32_16x16x32_bf16 v[20:23], v[64:67], v[236:239], v[20:23]
v_mfma_f32_16x16x32_bf16 v[20:23], v[68:71], v[240:243], v[20:23]
v_mfma_f32_16x16x32_bf16 v[20:23], v[72:75], v[244:247], v[20:23]
v_add_u32 v117, 1, v117
buffer_store_dword v117, v118, s[64:67], 0 offen
buffer_load_dwordx4 v[232:235], v2, s[52:55], s12 offen offset:0 nt
buffer_load_dwordx4 v[236:239], v2, s[52:55], s12 offen offset:1024 nt
buffer_load_dwordx4 v[240:243], v2, s[52:55], s12 offen offset:2048 nt
buffer_load_dwordx4 v[244:247], v2, s[52:55], s12 offen offset:3072 nt
s_add_u32 s13, s13, 24576
s_min_u32 s12, s13, 2146435072
s_barrier
ds_read_b64_tr_b16 a[96:97], v88 offset:0
ds_read_b64_tr_b16 a[98:99], v88 offset:4608
ds_read_b64_tr_b16 a[100:101], v88 offset:36864
ds_read_b64_tr_b16 a[102:103], v88 offset:41472
v_and_b32_dpp v60, v79, v8 row_newbcast:0 row_mask:0xf bank_mask:0xf
v_and_b32_dpp v61, v79, v9 row_newbcast:0 row_mask:0xf bank_mask:0xf
v_and_b32_dpp v62, v79, v10 row_newbcast:0 row_mask:0xf bank_mask:0xf
v_and_b32_dpp v63, v79, v11 row_newbcast:0 row_mask:0xf bank_mask:0xf
v_and_b32_dpp v64, v79, v8 row_newbcast:4 row_mask:0xf bank_mask:0xf
v_and_b32_dpp v65, v79, v9 row_newbcast:4 row_mask:0xf bank_mask:0xf
v_and_b32_dpp v66, v79, v10 row_newbcast:4 row_mask:0xf bank_mask:0xf
v_and_b32_dpp v67, v79, v11 row_newbcast:4 row_mask:0xf bank_mask:0xf
v_and_b32_dpp v68, v79, v8 row_newbcast:8 row_mask:0xf bank_mask:0xf
v_and_b32_dpp v69, v79, v9 row_newbcast:8 row_mask:0xf bank_mask:0xf
v_and_b32_dpp v70, v79, v10 row_newbcast:8 row_mask:0xf bank_mask:0xf
v_and_b32_dpp v71, v79, v11 row_newbcast:8 row_mask:0xf bank_mask:0xf
v_and_b32_dpp v72, v79, v8 row_newbcast:12 row_mask:0xf bank_mask:0xf
v_and_b32_dpp v73, v79, v9 row_newbcast:12 row_mask:0xf bank_mask:0xf
v_and_b32_dpp v74, v79, v10 row_newbcast:12 row_mask:0xf bank_mask:0xf
v_and_b32_dpp v75, v79, v11 row_newbcast:12 row_mask:0xf bank_mask:0xf
s_waitcnt vmcnt(28)
v_mfma_f32_16x16x32_bf16 v[20:23], v[60:63], v[120:123], v[20:23]
v_mfma_f32_16x16x32_bf16 v[20:23], v[64:67], v[124:127], v[20:23]
v_mfma_f32_16x16x32_bf16 v[20:23], v[68:71], v[128:131], v[20:23]
v_mfma_f32_16x16x32_bf16 v[20:23], v[72:75], v[132:135], v[20:23]
v_add_u32 v117, 1, v117
buffer_store_dword v117, v118, s[64:67], 0 offen
buffer_load_dwordx4 v[120:123], v2, s[52:55], s12 offen offset:0 nt
buffer_load_dwordx4 v[124:127], v2, s[52:55], s12 offen offset:1024 nt
buffer_load_dwordx4 v[128:131], v2, s[52:55], s12 offen offset:2048 nt
buffer_load_dwordx4 v[132:135], v2, s[52:55], s12 offen offset:3072 nt
s_add_u32 s13, s13, 24576
s_min_u32 s12, s13, 2146435072
ds_read_b64_tr_b16 a[104:105], v90 offset:0
ds_read_b64_tr_b16 a[106:107], v90 offset:4608
ds_read_b64_tr_b16 a[108:109], v90 offset:36864
ds_read_b64_tr_b16 a[110:111], v90 offset:41472
v_and_b32_dpp v60, v79, v8 row_newbcast:1 row_mask:0xf bank_mask:0xf
v_and_b32_dpp v61, v79, v9 row_newbcast:1 row_mask:0xf bank_mask:0xf
v_and_b32_dpp v62, v79, v10 row_newbcast:1 row_mask:0xf bank_mask:0xf
v_and_b32_dpp v63, v79, v11 row_newbcast:1 row_mask:0xf bank_mask:0xf
v_and_b32_dpp v64, v79, v8 row_newbcast:5 row_mask:0xf bank_mask:0xf
v_and_b32_dpp v65, v79, v9 row_newbcast:5 row_mask:0xf bank_mask:0xf
v_and_b32_dpp v66, v79, v10 row_newbcast:5 row_mask:0xf bank_mask:0xf
v_and_b32_dpp v67, v79, v11 row_newbcast:5 row_mask:0xf bank_mask:0xf
v_and_b32_dpp v68, v79, v8 row_newbcast:9 row_mask:0xf bank_mask:0xf
v_and_b32_dpp v69, v79, v9 row_newbcast:9 row_mask:0xf bank_mask:0xf
v_and_b32_dpp v70, v79, v10 row_newbcast:9 row_mask:0xf bank_mask:0xf
v_and_b32_dpp v71, v79, v11 row_newbcast:9 row_mask:0xf bank_mask:0xf
v_and_b32_dpp v72, v79, v8 row_newbcast:13 row_mask:0xf bank_mask:0xf
v_and_b32_dpp v73, v79, v9 row_newbcast:13 row_mask:0xf bank_mask:0xf
v_and_b32_dpp v74, v79, v10 row_newbcast:13 row_mask:0xf bank_mask:0xf
v_and_b32_dpp v75, v79, v11 row_newbcast:13 row_mask:0xf bank_mask:0xf
s_waitcnt vmcnt(28)
v_mfma_f32_16x16x32_bf16 v[20:23], v[60:63], v[136:139], v[20:23]
v_mfma_f32_16x16x32_bf16 v[20:23], v[64:67], v[140:143], v[20:23]
v_mfma_f32_16x16x32_bf16 v[20:23], v[68:71], v[144:147], v[20:23]
v_mfma_f32_16x16x32_bf16 v[20:23], v[72:75], v[148:151], v[20:23]
v_add_u32 v117, 1, v117
buffer_store_dword v117, v118, s[64:67], 0 offen
buffer_load_dwordx4 v[136:139], v2, s[52:55], s12 offen offset:0 nt
buffer_load_dwordx4 v[140:143], v2, s[52:55], s12 offen offset:1024 nt
buffer_load_dwordx4 v[144:147], v2, s[52:55], s12 offen offset:2048 nt
buffer_load_dwordx4 v[148:151], v2, s[52:55], s12 offen offset:3072 nt
s_add_u32 s13, s13, 24576
s_min_u32 s12, s13, 2146435072
ds_read_b64_tr_b16 a[112:113], v88 offset:8
ds_read_b64_tr_b16 a[114:115], v88 offset:4616
ds_read_b64_tr_b16 a[116:117], v88 offset:36872
ds_read_b64_tr_b16 a[118:119], v88 offset:41480
v_and_b32_dpp v60, v76, v8 row_newbcast:2 row_mask:0xf bank_mask:0xf
v_and_b32_dpp v61, v76, v9 row_newbcast:2 row_mask:0xf bank_mask:0xf
v_and_b32_dpp v62, v76, v10 row_newbcast:2 row_mask:0xf bank_mask:0xf
v_and_b32_dpp v63, v76, v11 row_newbcast:2 row_mask:0xf bank_mask:0xf
v_and_b32_dpp v64, v76, v8 row_newbcast:6 row_mask:0xf bank_mask:0xf
v_and_b32_dpp v65, v76, v9 row_newbcast:6 row_mask:0xf bank_mask:0xf
v_and_b32_dpp v66, v76, v10 row_newbcast:6 row_mask:0xf bank_mask:0xf
v_and_b32_dpp v67, v76, v11 row_newbcast:6 row_mask:0xf bank_mask:0xf
v_and_b32_dpp v68, v76, v8 row_newbcast:10 row_mask:0xf bank_mask:0xf
v_and_b32_dpp v69, v76, v9 row_newbcast:10 row_mask:0xf bank_mask:0xf
v_and_b32_dpp v70, v76, v10 row_newbcast:10 row_mask:0xf bank_mask:0xf
v_and_b32_dpp v71, v76, v11 row_newbcast:10 row_mask:0xf bank_mask:0xf
v_and_b32_dpp v72, v76, v8 row_newbcast:14 row_mask:0xf bank_mask:0xf
v_and_b32_dpp v73, v76, v9 row_newbcast:14 row_mask:0xf bank_mask:0xf
v_and_b32_dpp v74, v76, v10 row_newbcast:14 row_mask:0xf bank_mask:0xf
v_and_b32_dpp v75, v76, v11 row_newbcast:14 row_mask:0xf bank_mask:0xf
v_mfma_f32_16x16x32_bf16 v[20:23], v[60:63], a[16:19], v[20:23]
v_mfma_f32_16x16x32_bf16 v[20:23], v[64:67], a[20:23], v[20:23]
v_mfma_f32_16x16x32_bf16 v[20:23], v[68:71], a[24:27], v[20:23]
v_mfma_f32_16x16x32_bf16 v[20:23], v[72:75], a[28:31], v[20:23]
s_nop 3
v_and_b32_dpp v60, v79, v8 row_newbcast:2 row_mask:0xf bank_mask:0xf
v_and_b32_dpp v61, v79, v9 row_newbcast:2 row_mask:0xf bank_mask:0xf
v_and_b32_dpp v62, v79, v10 row_newbcast:2 row_mask:0xf bank_mask:0xf
v_and_b32_dpp v63, v79, v11 row_newbcast:2 row_mask:0xf bank_mask:0xf
v_and_b32_dpp v64, v79, v8 row_newbcast:6 row_mask:0xf bank_mask:0xf
v_and_b32_dpp v65, v79, v9 row_newbcast:6 row_mask:0xf bank_mask:0xf
v_and_b32_dpp v66, v79, v10 row_newbcast:6 row_mask:0xf bank_mask:0xf
v_and_b32_dpp v67, v79, v11 row_newbcast:6 row_mask:0xf bank_mask:0xf
v_and_b32_dpp v68, v79, v8 row_newbcast:10 row_mask:0xf bank_mask:0xf
v_and_b32_dpp v69, v79, v9 row_newbcast:10 row_mask:0xf bank_mask:0xf
v_and_b32_dpp v70, v79, v10 row_newbcast:10 row_mask:0xf bank_mask:0xf
v_and_b32_dpp v71, v79, v11 row_newbcast:10 row_mask:0xf bank_mask:0xf
v_and_b32_dpp v72, v79, v8 row_newbcast:14 row_mask:0xf bank_mask:0xf
v_and_b32_dpp v73, v79, v9 row_newbcast:14 row_mask:0xf bank_mask:0xf
v_and_b32_dpp v74, v79, v10 row_newbcast:14 row_mask:0xf bank_mask:0xf
v_and_b32_dpp v75, v79, v11 row_newbcast:14 row_mask:0xf bank_mask:0xf
s_waitcnt vmcnt(28)
v_mfma_f32_16x16x32_bf16 v[20:23], v[60:63], v[152:155], v[20:23]
v_mfma_f32_16x16x32_bf16 v[20:23], v[64:67], v[156:159], v[20:23]
v_mfma_f32_16x16x32_bf16 v[20:23], v[68:71], v[160:163], v[20:23]
v_mfma_f32_16x16x32_bf16 v[20:23], v[72:75], v[164:167], v[20:23]
v_add_u32 v117, 1, v117
buffer_store_dword v117, v118, s[64:67], 0 offen
buffer_load_dwordx4 v[152:155], v2, s[52:55], s12 offen offset:0 nt
buffer_load_dwordx4 v[156:159], v2, s[52:55], s12 offen offset:1024 nt
buffer_load_dwordx4 v[160:163], v2, s[52:55], s12 offen offset:2048 nt
buffer_load_dwordx4 v[164:167], v2, s[52:55], s12 offen offset:3072 nt
s_add_u32 s13, s13, 24576
s_min_u32 s12, s13, 2146435072
ds_read_b64_tr_b16 a[120:121], v90 offset:8
ds_read_b64_tr_b16 a[122:123], v90 offset:4616
ds_read_b64_tr_b16 a[124:125], v90 offset:36872
ds_read_b64_tr_b16 a[126:127], v90 offset:41480
v_and_b32_dpp v60, v79, v8 row_newbcast:3 row_mask:0xf bank_mask:0xf
v_and_b32_dpp v61, v79, v9 row_newbcast:3 row_mask:0xf bank_mask:0xf
v_and_b32_dpp v62, v79, v10 row_newbcast:3 row_mask:0xf bank_mask:0xf
v_and_b32_dpp v63, v79, v11 row_newbcast:3 row_mask:0xf bank_mask:0xf
v_and_b32_dpp v64, v79, v8 row_newbcast:7 row_mask:0xf bank_mask:0xf
v_and_b32_dpp v65, v79, v9 row_newbcast:7 row_mask:0xf bank_mask:0xf
v_and_b32_dpp v66, v79, v10 row_newbcast:7 row_mask:0xf bank_mask:0xf
v_and_b32_dpp v67, v79, v11 row_newbcast:7 row_mask:0xf bank_mask:0xf
v_and_b32_dpp v68, v79, v8 row_newbcast:11 row_mask:0xf bank_mask:0xf
v_and_b32_dpp v69, v79, v9 row_newbcast:11 row_mask:0xf bank_mask:0xf
v_and_b32_dpp v70, v79, v10 row_newbcast:11 row_mask:0xf bank_mask:0xf
v_and_b32_dpp v71, v79, v11 row_newbcast:11 row_mask:0xf bank_mask:0xf
v_and_b32_dpp v72, v79, v8 row_newbcast:15 row_mask:0xf bank_mask:0xf
v_and_b32_dpp v73, v79, v9 row_newbcast:15 row_mask:0xf bank_mask:0xf
v_and_b32_dpp v74, v79, v10 row_newbcast:15 row_mask:0xf bank_mask:0xf
v_and_b32_dpp v75, v79, v11 row_newbcast:15 row_mask:0xf bank_mask:0xf
s_waitcnt vmcnt(28)
v_mfma_f32_16x16x32_bf16 v[20:23], v[60:63], v[168:171], v[20:23]
v_mfma_f32_16x16x32_bf16 v[20:23], v[64:67], v[172:175], v[20:23]
v_mfma_f32_16x16x32_bf16 v[20:23], v[68:71], v[176:179], v[20:23]
v_mfma_f32_16x16x32_bf16 v[20:23], v[72:75], v[180:183], v[20:23]
v_add_u32 v117, 1, v117
buffer_store_dword v117, v118, s[64:67], 0 offen
buffer_load_dwordx4 v[168:171], v2, s[52:55], s12 offen offset:0 nt
buffer_load_dwordx4 v[172:175], v2, s[52:55], s12 offen offset:1024 nt
buffer_load_dwordx4 v[176:179], v2, s[52:55], s12 offen offset:2048 nt
buffer_load_dwordx4 v[180:183], v2, s[52:55], s12 offen offset:3072 nt
s_add_u32 s13, s13, 24576
s_min_u32 s12, s13, 2146435072
ds_read_b64_tr_b16 a[128:129], v88 offset:16
ds_read_b64_tr_b16 a[130:131], v88 offset:4624
ds_read_b64_tr_b16 a[132:133], v88 offset:36880
ds_read_b64_tr_b16 a[134:135], v88 offset:41488
v_and_b32_dpp v60, v80, v8 row_newbcast:0 row_mask:0xf bank_mask:0xf
v_and_b32_dpp v61, v80, v9 row_newbcast:0 row_mask:0xf bank_mask:0xf
v_and_b32_dpp v62, v80, v10 row_newbcast:0 row_mask:0xf bank_mask:0xf
v_and_b32_dpp v63, v80, v11 row_newbcast:0 row_mask:0xf bank_mask:0xf
v_and_b32_dpp v64, v80, v8 row_newbcast:4 row_mask:0xf bank_mask:0xf
v_and_b32_dpp v65, v80, v9 row_newbcast:4 row_mask:0xf bank_mask:0xf
v_and_b32_dpp v66, v80, v10 row_newbcast:4 row_mask:0xf bank_mask:0xf
v_and_b32_dpp v67, v80, v11 row_newbcast:4 row_mask:0xf bank_mask:0xf
v_and_b32_dpp v68, v80, v8 row_newbcast:8 row_mask:0xf bank_mask:0xf
v_and_b32_dpp v69, v80, v9 row_newbcast:8 row_mask:0xf bank_mask:0xf
v_and_b32_dpp v70, v80, v10 row_newbcast:8 row_mask:0xf bank_mask:0xf
v_and_b32_dpp v71, v80, v11 row_newbcast:8 row_mask:0xf bank_mask:0xf
v_and_b32_dpp v72, v80, v8 row_newbcast:12 row_mask:0xf bank_mask:0xf
v_and_b32_dpp v73, v80, v9 row_newbcast:12 row_mask:0xf bank_mask:0xf
v_and_b32_dpp v74, v80, v10 row_newbcast:12 row_mask:0xf bank_mask:0xf
v_and_b32_dpp v75, v80, v11 row_newbcast:12 row_mask:0xf bank_mask:0xf
s_waitcnt vmcnt(28)
v_mfma_f32_16x16x32_bf16 v[20:23], v[60:63], v[184:187], v[20:23]
v_mfma_f32_16x16x32_bf16 v[20:23], v[64:67], v[188:191], v[20:23]
v_mfma_f32_16x16x32_bf16 v[20:23], v[68:71], v[192:195], v[20:23]
v_mfma_f32_16x16x32_bf16 v[20:23], v[72:75], v[196:199], v[20:23]
v_add_u32 v117, 1, v117
buffer_store_dword v117, v118, s[64:67], 0 offen
buffer_load_dwordx4 v[184:187], v2, s[52:55], s12 offen offset:0 nt
buffer_load_dwordx4 v[188:191], v2, s[52:55], s12 offen offset:1024 nt
buffer_load_dwordx4 v[192:195], v2, s[52:55], s12 offen offset:2048 nt
buffer_load_dwordx4 v[196:199], v2, s[52:55], s12 offen offset:3072 nt
s_add_u32 s13, s13, 24576
s_min_u32 s12, s13, 2146435072
ds_read_b64_tr_b16 a[136:137], v90 offset:16
ds_read_b64_tr_b16 a[138:139], v90 offset:4624
ds_read_b64_tr_b16 a[140:141], v90 offset:36880
ds_read_b64_tr_b16 a[142:143], v90 offset:41488
v_and_b32_dpp v60, v80, v8 row_newbcast:1 row_mask:0xf bank_mask:0xf
v_and_b32_dpp v61, v80, v9 row_newbcast:1 row_mask:0xf bank_mask:0xf
v_and_b32_dpp v62, v80, v10 row_newbcast:1 row_mask:0xf bank_mask:0xf
v_and_b32_dpp v63, v80, v11 row_newbcast:1 row_mask:0xf bank_mask:0xf
v_and_b32_dpp v64, v80, v8 row_newbcast:5 row_mask:0xf bank_mask:0xf
v_and_b32_dpp v65, v80, v9 row_newbcast:5 row_mask:0xf bank_mask:0xf
v_and_b32_dpp v66, v80, v10 row_newbcast:5 row_mask:0xf bank_mask:0xf
v_and_b32_dpp v67, v80, v11 row_newbcast:5 row_mask:0xf bank_mask:0xf
v_and_b32_dpp v68, v80, v8 row_newbcast:9 row_mask:0xf bank_mask:0xf
v_and_b32_dpp v69, v80, v9 row_newbcast:9 row_mask:0xf bank_mask:0xf
v_and_b32_dpp v70, v80, v10 row_newbcast:9 row_mask:0xf bank_mask:0xf
v_and_b32_dpp v71, v80, v11 row_newbcast:9 row_mask:0xf bank_mask:0xf
v_and_b32_dpp v72, v80, v8 row_newbcast:13 row_mask:0xf bank_mask:0xf
v_and_b32_dpp v73, v80, v9 row_newbcast:13 row_mask:0xf bank_mask:0xf
v_and_b32_dpp v74, v80, v10 row_newbcast:13 row_mask:0xf bank_mask:0xf
v_and_b32_dpp v75, v80, v11 row_newbcast:13 row_mask:0xf bank_mask:0xf
s_waitcnt vmcnt(28)
v_mfma_f32_16x16x32_bf16 v[20:23], v[60:63], v[200:203], v[20:23]
v_mfma_f32_16x16x32_bf16 v[20:23], v[64:67], v[204:207], v[20:23]
v_mfma_f32_16x16x32_bf16 v[20:23], v[68:71], v[208:211], v[20:23]
v_mfma_f32_16x16x32_bf16 v[20:23], v[72:75], v[212:215], v[20:23]
v_add_u32 v117, 1, v117
buffer_store_dword v117, v118, s[64:67], 0 offen
buffer_load_dwordx4 v[200:203], v2, s[52:55], s12 offen offset:0 nt
buffer_load_dwordx4 v[204:207], v2, s[52:55], s12 offen offset:1024 nt
buffer_load_dwordx4 v[208:211], v2, s[52:55], s12 offen offset:2048 nt
buffer_load_dwordx4 v[212:215], v2, s[52:55], s12 offen offset:3072 nt
s_add_u32 s13, s13, 24576
s_min_u32 s12, s13, 2146435072
ds_read_b64_tr_b16 a[144:145], v88 offset:24
ds_read_b64_tr_b16 a[146:147], v88 offset:4632
ds_read_b64_tr_b16 a[148:149], v88 offset:36888
ds_read_b64_tr_b16 a[150:151], v88 offset:41496
v_and_b32_dpp v60, v76, v8 row_newbcast:3 row_mask:0xf bank_mask:0xf
v_and_b32_dpp v61, v76, v9 row_newbcast:3 row_mask:0xf bank_mask:0xf
v_and_b32_dpp v62, v76, v10 row_newbcast:3 row_mask:0xf bank_mask:0xf
v_and_b32_dpp v63, v76, v11 row_newbcast:3 row_mask:0xf bank_mask:0xf
v_and_b32_dpp v64, v76, v8 row_newbcast:7 row_mask:0xf bank_mask:0xf
v_and_b32_dpp v65, v76, v9 row_newbcast:7 row_mask:0xf bank_mask:0xf
v_and_b32_dpp v66, v76, v10 row_newbcast:7 row_mask:0xf bank_mask:0xf
v_and_b32_dpp v67, v76, v11 row_newbcast:7 row_mask:0xf bank_mask:0xf
v_and_b32_dpp v68, v76, v8 row_newbcast:11 row_mask:0xf bank_mask:0xf
v_and_b32_dpp v69, v76, v9 row_newbcast:11 row_mask:0xf bank_mask:0xf
v_and_b32_dpp v70, v76, v10 row_newbcast:11 row_mask:0xf bank_mask:0xf
v_and_b32_dpp v71, v76, v11 row_newbcast:11 row_mask:0xf bank_mask:0xf
v_and_b32_dpp v72, v76, v8 row_newbcast:15 row_mask:0xf bank_mask:0xf
v_and_b32_dpp v73, v76, v9 row_newbcast:15 row_mask:0xf bank_mask:0xf
v_and_b32_dpp v74, v76, v10 row_newbcast:15 row_mask:0xf bank_mask:0xf
v_and_b32_dpp v75, v76, v11 row_newbcast:15 row_mask:0xf bank_mask:0xf
v_mfma_f32_16x16x32_bf16 v[20:23], v[60:63], a[32:35], v[20:23]
v_mfma_f32_16x16x32_bf16 v[20:23], v[64:67], a[36:39], v[20:23]
v_mfma_f32_16x16x32_bf16 v[20:23], v[68:71], a[40:43], v[20:23]
v_mfma_f32_16x16x32_bf16 v[20:23], v[72:75], a[44:47], v[20:23]
s_nop 3
v_and_b32_dpp v60, v80, v8 row_newbcast:2 row_mask:0xf bank_mask:0xf
v_and_b32_dpp v61, v80, v9 row_newbcast:2 row_mask:0xf bank_mask:0xf
v_and_b32_dpp v62, v80, v10 row_newbcast:2 row_mask:0xf bank_mask:0xf
v_and_b32_dpp v63, v80, v11 row_newbcast:2 row_mask:0xf bank_mask:0xf
v_and_b32_dpp v64, v80, v8 row_newbcast:6 row_mask:0xf bank_mask:0xf
v_and_b32_dpp v65, v80, v9 row_newbcast:6 row_mask:0xf bank_mask:0xf
v_and_b32_dpp v66, v80, v10 row_newbcast:6 row_mask:0xf bank_mask:0xf
v_and_b32_dpp v67, v80, v11 row_newbcast:6 row_mask:0xf bank_mask:0xf
v_and_b32_dpp v68, v80, v8 row_newbcast:10 row_mask:0xf bank_mask:0xf
v_and_b32_dpp v69, v80, v9 row_newbcast:10 row_mask:0xf bank_mask:0xf
v_and_b32_dpp v70, v80, v10 row_newbcast:10 row_mask:0xf bank_mask:0xf
v_and_b32_dpp v71, v80, v11 row_newbcast:10 row_mask:0xf bank_mask:0xf
v_and_b32_dpp v72, v80, v8 row_newbcast:14 row_mask:0xf bank_mask:0xf
v_and_b32_dpp v73, v80, v9 row_newbcast:14 row_mask:0xf bank_mask:0xf
v_and_b32_dpp v74, v80, v10 row_newbcast:14 row_mask:0xf bank_mask:0xf
v_and_b32_dpp v75, v80, v11 row_newbcast:14 row_mask:0xf bank_mask:0xf
s_waitcnt vmcnt(28)
v_mfma_f32_16x16x32_bf16 v[20:23], v[60:63], v[216:219], v[20:23]
v_mfma_f32_16x16x32_bf16 v[20:23], v[64:67], v[220:223], v[20:23]
v_mfma_f32_16x16x32_bf16 v[20:23], v[68:71], v[224:227], v[20:23]
v_mfma_f32_16x16x32_bf16 v[20:23], v[72:75], v[228:231], v[20:23]
v_add_u32 v117, 1, v117
buffer_store_dword v117, v118, s[64:67], 0 offen
buffer_load_dwordx4 v[216:219], v2, s[52:55], s12 offen offset:0 nt
buffer_load_dwordx4 v[220:223], v2, s[52:55], s12 offen offset:1024 nt
buffer_load_dwordx4 v[224:227], v2, s[52:55], s12 offen offset:2048 nt
buffer_load_dwordx4 v[228:231], v2, s[52:55], s12 offen offset:3072 nt
s_add_u32 s13, s13, 24576
s_min_u32 s12, s13, 2146435072
ds_read_b64_tr_b16 a[152:153], v90 offset:24
ds_read_b64_tr_b16 a[154:155], v90 offset:4632
ds_read_b64_tr_b16 a[156:157], v90 offset:36888
ds_read_b64_tr_b16 a[158:159], v90 offset:41496
v_and_b32_dpp v60, v80, v8 row_newbcast:3 row_mask:0xf bank_mask:0xf
v_and_b32_dpp v61, v80, v9 row_newbcast:3 row_mask:0xf bank_mask:0xf
v_and_b32_dpp v62, v80, v10 row_newbcast:3 row_mask:0xf bank_mask:0xf
v_and_b32_dpp v63, v80, v11 row_newbcast:3 row_mask:0xf bank_mask:0xf
v_and_b32_dpp v64, v80, v8 row_newbcast:7 row_mask:0xf bank_mask:0xf
v_and_b32_dpp v65, v80, v9 row_newbcast:7 row_mask:0xf bank_mask:0xf
v_and_b32_dpp v66, v80, v10 row_newbcast:7 row_mask:0xf bank_mask:0xf
v_and_b32_dpp v67, v80, v11 row_newbcast:7 row_mask:0xf bank_mask:0xf
v_and_b32_dpp v68, v80, v8 row_newbcast:11 row_mask:0xf bank_mask:0xf
v_and_b32_dpp v69, v80, v9 row_newbcast:11 row_mask:0xf bank_mask:0xf
v_and_b32_dpp v70, v80, v10 row_newbcast:11 row_mask:0xf bank_mask:0xf
v_and_b32_dpp v71, v80, v11 row_newbcast:11 row_mask:0xf bank_mask:0xf
v_and_b32_dpp v72, v80, v8 row_newbcast:15 row_mask:0xf bank_mask:0xf
v_and_b32_dpp v73, v80, v9 row_newbcast:15 row_mask:0xf bank_mask:0xf
v_and_b32_dpp v74, v80, v10 row_newbcast:15 row_mask:0xf bank_mask:0xf
v_and_b32_dpp v75, v80, v11 row_newbcast:15 row_mask:0xf bank_mask:0xf
s_waitcnt vmcnt(28)
v_mfma_f32_16x16x32_bf16 v[20:23], v[60:63], v[232:235], v[20:23]
v_mfma_f32_16x16x32_bf16 v[20:23], v[64:67], v[236:239], v[20:23]
v_mfma_f32_16x16x32_bf16 v[20:23], v[68:71], v[240:243], v[20:23]
v_mfma_f32_16x16x32_bf16 v[20:23], v[72:75], v[244:247], v[20:23]
v_add_u32 v117, 1, v117
buffer_store_dword v117, v118, s[64:67], 0 offen
buffer_load_dwordx4 v[232:235], v2, s[52:55], s12 offen offset:0 nt
buffer_load_dwordx4 v[236:239], v2, s[52:55], s12 offen offset:1024 nt
buffer_load_dwordx4 v[240:243], v2, s[52:55], s12 offen offset:2048 nt
buffer_load_dwordx4 v[244:247], v2, s[52:55], s12 offen offset:3072 nt
s_add_u32 s13, s13, 24576
s_min_u32 s12, s13, 2146435072
ds_read_b64_tr_b16 a[160:161], v88 offset:128
ds_read_b64_tr_b16 a[162:163], v88 offset:4736
ds_read_b64_tr_b16 a[164:165], v88 offset:36992
ds_read_b64_tr_b16 a[166:167], v88 offset:41600
v_and_b32_dpp v60, v81, v8 row_newbcast:0 row_mask:0xf bank_mask:0xf
v_and_b32_dpp v61, v81, v9 row_newbcast:0 row_mask:0xf bank_mask:0xf
v_and_b32_dpp v62, v81, v10 row_newbcast:0 row_mask:0xf bank_mask:0xf
v_and_b32_dpp v63, v81, v11 row_newbcast:0 row_mask:0xf bank_mask:0xf
v_and_b32_dpp v64, v81, v8 row_newbcast:4 row_mask:0xf bank_mask:0xf
v_and_b32_dpp v65, v81, v9 row_newbcast:4 row_mask:0xf bank_mask:0xf
v_and_b32_dpp v66, v81, v10 row_newbcast:4 row_mask:0xf bank_mask:0xf
v_and_b32_dpp v67, v81, v11 row_newbcast:4 row_mask:0xf bank_mask:0xf
v_and_b32_dpp v68, v81, v8 row_newbcast:8 row_mask:0xf bank_mask:0xf
v_and_b32_dpp v69, v81, v9 row_newbcast:8 row_mask:0xf bank_mask:0xf
v_and_b32_dpp v70, v81, v10 row_newbcast:8 row_mask:0xf bank_mask:0xf
v_and_b32_dpp v71, v81, v11 row_newbcast:8 row_mask:0xf bank_mask:0xf
v_and_b32_dpp v72, v81, v8 row_newbcast:12 row_mask:0xf bank_mask:0xf
v_and_b32_dpp v73, v81, v9 row_newbcast:12 row_mask:0xf bank_mask:0xf
v_and_b32_dpp v74, v81, v10 row_newbcast:12 row_mask:0xf bank_mask:0xf
v_and_b32_dpp v75, v81, v11 row_newbcast:12 row_mask:0xf bank_mask:0xf
s_waitcnt vmcnt(28)
v_mfma_f32_16x16x32_bf16 v[20:23], v[60:63], v[120:123], v[20:23]
v_mfma_f32_16x16x32_bf16 v[20:23], v[64:67], v[124:127], v[20:23]
v_mfma_f32_16x16x32_bf16 v[20:23], v[68:71], v[128:131], v[20:23]
v_mfma_f32_16x16x32_bf16 v[20:23], v[72:75], v[132:135], v[20:23]
v_add_u32 v117, 1, v117
buffer_store_dword v117, v118, s[64:67], 0 offen
buffer_load_dwordx4 v[120:123], v2, s[52:55], s12 offen offset:0 nt
buffer_load_dwordx4 v[124:127], v2, s[52:55], s12 offen offset:1024 nt
buffer_load_dwordx4 v[128:131], v2, s[52:55], s12 offen offset:2048 nt
buffer_load_dwordx4 v[132:135], v2, s[52:55], s12 offen offset:3072 nt
s_add_u32 s13, s13, 24576
s_min_u32 s12, s13, 2146435072
ds_read_b64_tr_b16 a[168:169], v90 offset:128
ds_read_b64_tr_b16 a[170:171], v90 offset:4736
ds_read_b64_tr_b16 a[172:173], v90 offset:36992
ds_read_b64_tr_b16 a[174:175], v90 offset:41600
v_and_b32_dpp v60, v81, v8 row_newbcast:1 row_mask:0xf bank_mask:0xf
v_and_b32_dpp v61, v81, v9 row_newbcast:1 row_mask:0xf bank_mask:0xf
v_and_b32_dpp v62, v81, v10 row_newbcast:1 row_mask:0xf bank_mask:0xf
v_and_b32_dpp v63, v81, v11 row_newbcast:1 row_mask:0xf bank_mask:0xf
v_and_b32_dpp v64, v81, v8 row_newbcast:5 row_mask:0xf bank_mask:0xf
v_and_b32_dpp v65, v81, v9 row_newbcast:5 row_mask:0xf bank_mask:0xf
v_and_b32_dpp v66, v81, v10 row_newbcast:5 row_mask:0xf bank_mask:0xf
v_and_b32_dpp v67, v81, v11 row_newbcast:5 row_mask:0xf bank_mask:0xf
v_and_b32_dpp v68, v81, v8 row_newbcast:9 row_mask:0xf bank_mask:0xf
v_and_b32_dpp v69, v81, v9 row_newbcast:9 row_mask:0xf bank_mask:0xf
v_and_b32_dpp v70, v81, v10 row_newbcast:9 row_mask:0xf bank_mask:0xf
v_and_b32_dpp v71, v81, v11 row_newbcast:9 row_mask:0xf bank_mask:0xf
v_and_b32_dpp v72, v81, v8 row_newbcast:13 row_mask:0xf bank_mask:0xf
v_and_b32_dpp v73, v81, v9 row_newbcast:13 row_mask:0xf bank_mask:0xf
v_and_b32_dpp v74, v81, v10 row_newbcast:13 row_mask:0xf bank_mask:0xf
v_and_b32_dpp v75, v81, v11 row_newbcast:13 row_mask:0xf bank_mask:0xf
s_waitcnt vmcnt(28)
v_mfma_f32_16x16x32_bf16 v[20:23], v[60:63], v[136:139], v[20:23]
v_mfma_f32_16x16x32_bf16 v[20:23], v[64:67], v[140:143], v[20:23]
v_mfma_f32_16x16x32_bf16 v[20:23], v[68:71], v[144:147], v[20:23]
v_mfma_f32_16x16x32_bf16 v[20:23], v[72:75], v[148:151], v[20:23]
v_add_u32 v117, 1, v117
buffer_store_dword v117, v118, s[64:67], 0 offen
buffer_load_dwordx4 v[136:139], v2, s[52:55], s12 offen offset:0 nt
buffer_load_dwordx4 v[140:143], v2, s[52:55], s12 offen offset:1024 nt
buffer_load_dwordx4 v[144:147], v2, s[52:55], s12 offen offset:2048 nt
buffer_load_dwordx4 v[148:151], v2, s[52:55], s12 offen offset:3072 nt
s_add_u32 s13, s13, 24576
s_min_u32 s12, s13, 2146435072
ds_read_b64_tr_b16 a[176:177], v88 offset:136
ds_read_b64_tr_b16 a[178:179], v88 offset:4744
ds_read_b64_tr_b16 a[180:181], v88 offset:37000
ds_read_b64_tr_b16 a[182:183], v88 offset:41608
v_and_b32_dpp v60, v77, v8 row_newbcast:0 row_mask:0xf bank_mask:0xf
v_and_b32_dpp v61, v77, v9 row_newbcast:0 row_mask:0xf bank_mask:0xf
v_and_b32_dpp v62, v77, v10 row_newbcast:0 row_mask:0xf bank_mask:0xf
v_and_b32_dpp v63, v77, v11 row_newbcast:0 row_mask:0xf bank_mask:0xf
v_and_b32_dpp v64, v77, v8 row_newbcast:4 row_mask:0xf bank_mask:0xf
v_and_b32_dpp v65, v77, v9 row_newbcast:4 row_mask:0xf bank_mask:0xf
v_and_b32_dpp v66, v77, v10 row_newbcast:4 row_mask:0xf bank_mask:0xf
v_and_b32_dpp v67, v77, v11 row_newbcast:4 row_mask:0xf bank_mask:0xf
v_and_b32_dpp v68, v77, v8 row_newbcast:8 row_mask:0xf bank_mask:0xf
v_and_b32_dpp v69, v77, v9 row_newbcast:8 row_mask:0xf bank_mask:0xf
v_and_b32_dpp v70, v77, v10 row_newbcast:8 row_mask:0xf bank_mask:0xf
v_and_b32_dpp v71, v77, v11 row_newbcast:8 row_mask:0xf bank_mask:0xf
v_and_b32_dpp v72, v77, v8 row_newbcast:12 row_mask:0xf bank_mask:0xf
v_and_b32_dpp v73, v77, v9 row_newbcast:12 row_mask:0xf bank_mask:0xf
v_and_b32_dpp v74, v77, v10 row_newbcast:12 row_mask:0xf bank_mask:0xf
v_and_b32_dpp v75, v77, v11 row_newbcast:12 row_mask:0xf bank_mask:0xf
v_mfma_f32_16x16x32_bf16 v[20:23], v[60:63], a[48:51], v[20:23]
v_mfma_f32_16x16x32_bf16 v[20:23], v[64:67], a[52:55], v[20:23]
v_mfma_f32_16x16x32_bf16 v[20:23], v[68:71], a[56:59], v[20:23]
v_mfma_f32_16x16x32_bf16 v[20:23], v[72:75], a[60:63], v[20:23]
s_nop 3
v_and_b32_dpp v60, v81, v8 row_newbcast:2 row_mask:0xf bank_mask:0xf
v_and_b32_dpp v61, v81, v9 row_newbcast:2 row_mask:0xf bank_mask:0xf
v_and_b32_dpp v62, v81, v10 row_newbcast:2 row_mask:0xf bank_mask:0xf
v_and_b32_dpp v63, v81, v11 row_newbcast:2 row_mask:0xf bank_mask:0xf
v_and_b32_dpp v64, v81, v8 row_newbcast:6 row_mask:0xf bank_mask:0xf
v_and_b32_dpp v65, v81, v9 row_newbcast:6 row_mask:0xf bank_mask:0xf
v_and_b32_dpp v66, v81, v10 row_newbcast:6 row_mask:0xf bank_mask:0xf
v_and_b32_dpp v67, v81, v11 row_newbcast:6 row_mask:0xf bank_mask:0xf
v_and_b32_dpp v68, v81, v8 row_newbcast:10 row_mask:0xf bank_mask:0xf
v_and_b32_dpp v69, v81, v9 row_newbcast:10 row_mask:0xf bank_mask:0xf
v_and_b32_dpp v70, v81, v10 row_newbcast:10 row_mask:0xf bank_mask:0xf
v_and_b32_dpp v71, v81, v11 row_newbcast:10 row_mask:0xf bank_mask:0xf
v_and_b32_dpp v72, v81, v8 row_newbcast:14 row_mask:0xf bank_mask:0xf
v_and_b32_dpp v73, v81, v9 row_newbcast:14 row_mask:0xf bank_mask:0xf
v_and_b32_dpp v74, v81, v10 row_newbcast:14 row_mask:0xf bank_mask:0xf
v_and_b32_dpp v75, v81, v11 row_newbcast:14 row_mask:0xf bank_mask:0xf
s_waitcnt vmcnt(28)
v_mfma_f32_16x16x32_bf16 v[20:23], v[60:63], v[152:155], v[20:23]
v_mfma_f32_16x16x32_bf16 v[20:23], v[64:67], v[156:159], v[20:23]
v_mfma_f32_16x16x32_bf16 v[20:23], v[68:71], v[160:163], v[20:23]
v_mfma_f32_16x16x32_bf16 v[20:23], v[72:75], v[164:167], v[20:23]
v_add_u32 v117, 1, v117
buffer_store_dword v117, v118, s[64:67], 0 offen
buffer_load_dwordx4 v[152:155], v2, s[52:55], s12 offen offset:0 nt
buffer_load_dwordx4 v[156:159], v2, s[52:55], s12 offen offset:1024 nt
buffer_load_dwordx4 v[160:163], v2, s[52:55], s12 offen offset:2048 nt
buffer_load_dwordx4 v[164:167], v2, s[52:55], s12 offen offset:3072 nt
s_add_u32 s13, s13, 24576
s_min_u32 s12, s13, 2146435072
ds_read_b64_tr_b16 a[184:185], v90 offset:136
ds_read_b64_tr_b16 a[186:187], v90 offset:4744
ds_read_b64_tr_b16 a[188:189], v90 offset:37000
ds_read_b64_tr_b16 a[190:191], v90 offset:41608
v_and_b32_dpp v60, v81, v8 row_newbcast:3 row_mask:0xf bank_mask:0xf
v_and_b32_dpp v61, v81, v9 row_newbcast:3 row_mask:0xf bank_mask:0xf
v_and_b32_dpp v62, v81, v10 row_newbcast:3 row_mask:0xf bank_mask:0xf
v_and_b32_dpp v63, v81, v11 row_newbcast:3 row_mask:0xf bank_mask:0xf
v_and_b32_dpp v64, v81, v8 row_newbcast:7 row_mask:0xf bank_mask:0xf
v_and_b32_dpp v65, v81, v9 row_newbcast:7 row_mask:0xf bank_mask:0xf
v_and_b32_dpp v66, v81, v10 row_newbcast:7 row_mask:0xf bank_mask:0xf
v_and_b32_dpp v67, v81, v11 row_newbcast:7 row_mask:0xf bank_mask:0xf
v_and_b32_dpp v68, v81, v8 row_newbcast:11 row_mask:0xf bank_mask:0xf
v_and_b32_dpp v69, v81, v9 row_newbcast:11 row_mask:0xf bank_mask:0xf
v_and_b32_dpp v70, v81, v10 row_newbcast:11 row_mask:0xf bank_mask:0xf
v_and_b32_dpp v71, v81, v11 row_newbcast:11 row_mask:0xf bank_mask:0xf
v_and_b32_dpp v72, v81, v8 row_newbcast:15 row_mask:0xf bank_mask:0xf
v_and_b32_dpp v73, v81, v9 row_newbcast:15 row_mask:0xf bank_mask:0xf
v_and_b32_dpp v74, v81, v10 row_newbcast:15 row_mask:0xf bank_mask:0xf
v_and_b32_dpp v75, v81, v11 row_newbcast:15 row_mask:0xf bank_mask:0xf
s_waitcnt vmcnt(28)
v_mfma_f32_16x16x32_bf16 v[20:23], v[60:63], v[168:171], v[20:23]
v_mfma_f32_16x16x32_bf16 v[20:23], v[64:67], v[172:175], v[20:23]
v_mfma_f32_16x16x32_bf16 v[20:23], v[68:71], v[176:179], v[20:23]
v_mfma_f32_16x16x32_bf16 v[20:23], v[72:75], v[180:183], v[20:23]
v_add_u32 v117, 1, v117
buffer_store_dword v117, v118, s[64:67], 0 offen
buffer_load_dwordx4 v[168:171], v2, s[52:55], s12 offen offset:0 nt
buffer_load_dwordx4 v[172:175], v2, s[52:55], s12 offen offset:1024 nt
buffer_load_dwordx4 v[176:179], v2, s[52:55], s12 offen offset:2048 nt
buffer_load_dwordx4 v[180:183], v2, s[52:55], s12 offen offset:3072 nt
s_add_u32 s13, s13, 24576
s_min_u32 s12, s13, 2146435072
ds_read_b64_tr_b16 a[192:193], v88 offset:144
ds_read_b64_tr_b16 a[194:195], v88 offset:4752
ds_read_b64_tr_b16 a[196:197], v88 offset:37008
ds_read_b64_tr_b16 a[198:199], v88 offset:41616
v_and_b32_dpp v60, v82, v8 row_newbcast:0 row_mask:0xf bank_mask:0xf
v_and_b32_dpp v61, v82, v9 row_newbcast:0 row_mask:0xf bank_mask:0xf
v_and_b32_dpp v62, v82, v10 row_newbcast:0 row_mask:0xf bank_mask:0xf
v_and_b32_dpp v63, v82, v11 row_newbcast:0 row_mask:0xf bank_mask:0xf
v_and_b32_dpp v64, v82, v8 row_newbcast:4 row_mask:0xf bank_mask:0xf
v_and_b32_dpp v65, v82, v9 row_newbcast:4 row_mask:0xf bank_mask:0xf
v_and_b32_dpp v66, v82, v10 row_newbcast:4 row_mask:0xf bank_mask:0xf
v_and_b32_dpp v67, v82, v11 row_newbcast:4 row_mask:0xf bank_mask:0xf
v_and_b32_dpp v68, v82, v8 row_newbcast:8 row_mask:0xf bank_mask:0xf
v_and_b32_dpp v69, v82, v9 row_newbcast:8 row_mask:0xf bank_mask:0xf
v_and_b32_dpp v70, v82, v10 row_newbcast:8 row_mask:0xf bank_mask:0xf
v_and_b32_dpp v71, v82, v11 row_newbcast:8 row_mask:0xf bank_mask:0xf
v_and_b32_dpp v72, v82, v8 row_newbcast:12 row_mask:0xf bank_mask:0xf
v_and_b32_dpp v73, v82, v9 row_newbcast:12 row_mask:0xf bank_mask:0xf
v_and_b32_dpp v74, v82, v10 row_newbcast:12 row_mask:0xf bank_mask:0xf
v_and_b32_dpp v75, v82, v11 row_newbcast:12 row_mask:0xf bank_mask:0xf
s_waitcnt vmcnt(28)
v_mfma_f32_16x16x32_bf16 v[20:23], v[60:63], v[184:187], v[20:23]
v_mfma_f32_16x16x32_bf16 v[20:23], v[64:67], v[188:191], v[20:23]
v_mfma_f32_16x16x32_bf16 v[20:23], v[68:71], v[192:195], v[20:23]
v_mfma_f32_16x16x32_bf16 v[20:23], v[72:75], v[196:199], v[20:23]
v_add_u32 v117, 1, v117
buffer_store_dword v117, v118, s[64:67], 0 offen
buffer_load_dwordx4 v[184:187], v2, s[52:55], s12 offen offset:0 nt
buffer_load_dwordx4 v[188:191], v2, s[52:55], s12 offen offset:1024 nt
buffer_load_dwordx4 v[192:195], v2, s[52:55], s12 offen offset:2048 nt
buffer_load_dwordx4 v[196:199], v2, s[52:55], s12 offen offset:3072 nt
s_add_u32 s13, s13, 24576
s_min_u32 s12, s13, 2146435072
ds_read_b64_tr_b16 a[200:201], v90 offset:144
ds_read_b64_tr_b16 a[202:203], v90 offset:4752
ds_read_b64_tr_b16 a[204:205], v90 offset:37008
ds_read_b64_tr_b16 a[206:207], v90 offset:41616
v_and_b32_dpp v60, v82, v8 row_newbcast:1 row_mask:0xf bank_mask:0xf
v_and_b32_dpp v61, v82, v9 row_newbcast:1 row_mask:0xf bank_mask:0xf
v_and_b32_dpp v62, v82, v10 row_newbcast:1 row_mask:0xf bank_mask:0xf
v_and_b32_dpp v63, v82, v11 row_newbcast:1 row_mask:0xf bank_mask:0xf
v_and_b32_dpp v64, v82, v8 row_newbcast:5 row_mask:0xf bank_mask:0xf
v_and_b32_dpp v65, v82, v9 row_newbcast:5 row_mask:0xf bank_mask:0xf
v_and_b32_dpp v66, v82, v10 row_newbcast:5 row_mask:0xf bank_mask:0xf
v_and_b32_dpp v67, v82, v11 row_newbcast:5 row_mask:0xf bank_mask:0xf
v_and_b32_dpp v68, v82, v8 row_newbcast:9 row_mask:0xf bank_mask:0xf
v_and_b32_dpp v69, v82, v9 row_newbcast:9 row_mask:0xf bank_mask:0xf
v_and_b32_dpp v70, v82, v10 row_newbcast:9 row_mask:0xf bank_mask:0xf
v_and_b32_dpp v71, v82, v11 row_newbcast:9 row_mask:0xf bank_mask:0xf
v_and_b32_dpp v72, v82, v8 row_newbcast:13 row_mask:0xf bank_mask:0xf
v_and_b32_dpp v73, v82, v9 row_newbcast:13 row_mask:0xf bank_mask:0xf
v_and_b32_dpp v74, v82, v10 row_newbcast:13 row_mask:0xf bank_mask:0xf
v_and_b32_dpp v75, v82, v11 row_newbcast:13 row_mask:0xf bank_mask:0xf
s_waitcnt vmcnt(28)
v_mfma_f32_16x16x32_bf16 v[20:23], v[60:63], v[200:203], v[20:23]
v_mfma_f32_16x16x32_bf16 v[20:23], v[64:67], v[204:207], v[20:23]
v_mfma_f32_16x16x32_bf16 v[20:23], v[68:71], v[208:211], v[20:23]
v_mfma_f32_16x16x32_bf16 v[20:23], v[72:75], v[212:215], v[20:23]
v_add_u32 v117, 1, v117
buffer_store_dword v117, v118, s[64:67], 0 offen
buffer_load_dwordx4 v[200:203], v2, s[52:55], s12 offen offset:0 nt
buffer_load_dwordx4 v[204:207], v2, s[52:55], s12 offen offset:1024 nt
buffer_load_dwordx4 v[208:211], v2, s[52:55], s12 offen offset:2048 nt
buffer_load_dwordx4 v[212:215], v2, s[52:55], s12 offen offset:3072 nt
s_add_u32 s13, s13, 24576
s_min_u32 s12, s13, 2146435072
ds_read_b64_tr_b16 a[208:209], v88 offset:152
ds_read_b64_tr_b16 a[210:211], v88 offset:4760
ds_read_b64_tr_b16 a[212:213], v88 offset:37016
ds_read_b64_tr_b16 a[214:215], v88 offset:41624
v_and_b32_dpp v60, v77, v8 row_newbcast:1 row_mask:0xf bank_mask:0xf
v_and_b32_dpp v61, v77, v9 row_newbcast:1 row_mask:0xf bank_mask:0xf
v_and_b32_dpp v62, v77, v10 row_newbcast:1 row_mask:0xf bank_mask:0xf
v_and_b32_dpp v63, v77, v11 row_newbcast:1 row_mask:0xf bank_mask:0xf
v_and_b32_dpp v64, v77, v8 row_newbcast:5 row_mask:0xf bank_mask:0xf
v_and_b32_dpp v65, v77, v9 row_newbcast:5 row_mask:0xf bank_mask:0xf
v_and_b32_dpp v66, v77, v10 row_newbcast:5 row_mask:0xf bank_mask:0xf
v_and_b32_dpp v67, v77, v11 row_newbcast:5 row_mask:0xf bank_mask:0xf
v_and_b32_dpp v68, v77, v8 row_newbcast:9 row_mask:0xf bank_mask:0xf
v_and_b32_dpp v69, v77, v9 row_newbcast:9 row_mask:0xf bank_mask:0xf
v_and_b32_dpp v70, v77, v10 row_newbcast:9 row_mask:0xf bank_mask:0xf
v_and_b32_dpp v71, v77, v11 row_newbcast:9 row_mask:0xf bank_mask:0xf
v_and_b32_dpp v72, v77, v8 row_newbcast:13 row_mask:0xf bank_mask:0xf
v_and_b32_dpp v73, v77, v9 row_newbcast:13 row_mask:0xf bank_mask:0xf
v_and_b32_dpp v74, v77, v10 row_newbcast:13 row_mask:0xf bank_mask:0xf
v_and_b32_dpp v75, v77, v11 row_newbcast:13 row_mask:0xf bank_mask:0xf
v_mfma_f32_16x16x32_bf16 v[20:23], v[60:63], a[64:67], v[20:23]
v_mfma_f32_16x16x32_bf16 v[20:23], v[64:67], a[68:71], v[20:23]
v_mfma_f32_16x16x32_bf16 v[20:23], v[68:71], a[72:75], v[20:23]
v_mfma_f32_16x16x32_bf16 v[20:23], v[72:75], a[76:79], v[20:23]
s_nop 3
v_and_b32_dpp v60, v82, v8 row_newbcast:2 row_mask:0xf bank_mask:0xf
v_and_b32_dpp v61, v82, v9 row_newbcast:2 row_mask:0xf bank_mask:0xf
v_and_b32_dpp v62, v82, v10 row_newbcast:2 row_mask:0xf bank_mask:0xf
v_and_b32_dpp v63, v82, v11 row_newbcast:2 row_mask:0xf bank_mask:0xf
v_and_b32_dpp v64, v82, v8 row_newbcast:6 row_mask:0xf bank_mask:0xf
v_and_b32_dpp v65, v82, v9 row_newbcast:6 row_mask:0xf bank_mask:0xf
v_and_b32_dpp v66, v82, v10 row_newbcast:6 row_mask:0xf bank_mask:0xf
v_and_b32_dpp v67, v82, v11 row_newbcast:6 row_mask:0xf bank_mask:0xf
v_and_b32_dpp v68, v82, v8 row_newbcast:10 row_mask:0xf bank_mask:0xf
v_and_b32_dpp v69, v82, v9 row_newbcast:10 row_mask:0xf bank_mask:0xf
v_and_b32_dpp v70, v82, v10 row_newbcast:10 row_mask:0xf bank_mask:0xf
v_and_b32_dpp v71, v82, v11 row_newbcast:10 row_mask:0xf bank_mask:0xf
v_and_b32_dpp v72, v82, v8 row_newbcast:14 row_mask:0xf bank_mask:0xf
v_and_b32_dpp v73, v82, v9 row_newbcast:14 row_mask:0xf bank_mask:0xf
v_and_b32_dpp v74, v82, v10 row_newbcast:14 row_mask:0xf bank_mask:0xf
v_and_b32_dpp v75, v82, v11 row_newbcast:14 row_mask:0xf bank_mask:0xf
s_waitcnt vmcnt(28)
v_mfma_f32_16x16x32_bf16 v[20:23], v[60:63], v[216:219], v[20:23]
v_mfma_f32_16x16x32_bf16 v[20:23], v[64:67], v[220:223], v[20:23]
v_mfma_f32_16x16x32_bf16 v[20:23], v[68:71], v[224:227], v[20:23]
v_mfma_f32_16x16x32_bf16 v[20:23], v[72:75], v[228:231], v[20:23]
v_add_u32 v117, 1, v117
buffer_store_dword v117, v118, s[64:67], 0 offen
buffer_load_dwordx4 v[216:219], v2, s[52:55], s12 offen offset:0 nt
buffer_load_dwordx4 v[220:223], v2, s[52:55], s12 offen offset:1024 nt
buffer_load_dwordx4 v[224:227], v2, s[52:55], s12 offen offset:2048 nt
buffer_load_dwordx4 v[228:231], v2, s[52:55], s12 offen offset:3072 nt
s_add_u32 s13, s13, 24576
s_min_u32 s12, s13, 2146435072
ds_read_b64_tr_b16 a[216:217], v90 offset:152
ds_read_b64_tr_b16 a[218:219], v90 offset:4760
ds_read_b64_tr_b16 a[220:221], v90 offset:37016
ds_read_b64_tr_b16 a[222:223], v90 offset:41624
v_and_b32_dpp v60, v82, v8 row_newbcast:3 row_mask:0xf bank_mask:0xf
v_and_b32_dpp v61, v82, v9 row_newbcast:3 row_mask:0xf bank_mask:0xf
v_and_b32_dpp v62, v82, v10 row_newbcast:3 row_mask:0xf bank_mask:0xf
v_and_b32_dpp v63, v82, v11 row_newbcast:3 row_mask:0xf bank_mask:0xf
v_and_b32_dpp v64, v82, v8 row_newbcast:7 row_mask:0xf bank_mask:0xf
v_and_b32_dpp v65, v82, v9 row_newbcast:7 row_mask:0xf bank_mask:0xf
v_and_b32_dpp v66, v82, v10 row_newbcast:7 row_mask:0xf bank_mask:0xf
v_and_b32_dpp v67, v82, v11 row_newbcast:7 row_mask:0xf bank_mask:0xf
v_and_b32_dpp v68, v82, v8 row_newbcast:11 row_mask:0xf bank_mask:0xf
v_and_b32_dpp v69, v82, v9 row_newbcast:11 row_mask:0xf bank_mask:0xf
v_and_b32_dpp v70, v82, v10 row_newbcast:11 row_mask:0xf bank_mask:0xf
v_and_b32_dpp v71, v82, v11 row_newbcast:11 row_mask:0xf bank_mask:0xf
v_and_b32_dpp v72, v82, v8 row_newbcast:15 row_mask:0xf bank_mask:0xf
v_and_b32_dpp v73, v82, v9 row_newbcast:15 row_mask:0xf bank_mask:0xf
v_and_b32_dpp v74, v82, v10 row_newbcast:15 row_mask:0xf bank_mask:0xf
v_and_b32_dpp v75, v82, v11 row_newbcast:15 row_mask:0xf bank_mask:0xf
s_waitcnt vmcnt(28)
v_mfma_f32_16x16x32_bf16 v[20:23], v[60:63], v[232:235], v[20:23]
v_mfma_f32_16x16x32_bf16 v[20:23], v[64:67], v[236:239], v[20:23]
v_mfma_f32_16x16x32_bf16 v[20:23], v[68:71], v[240:243], v[20:23]
v_mfma_f32_16x16x32_bf16 v[20:23], v[72:75], v[244:247], v[20:23]
v_add_u32 v117, 1, v117
buffer_store_dword v117, v118, s[64:67], 0 offen
buffer_load_dwordx4 v[232:235], v2, s[52:55], s12 offen offset:0 nt
buffer_load_dwordx4 v[236:239], v2, s[52:55], s12 offen offset:1024 nt
buffer_load_dwordx4 v[240:243], v2, s[52:55], s12 offen offset:2048 nt
buffer_load_dwordx4 v[244:247], v2, s[52:55], s12 offen offset:3072 nt
s_add_u32 s13, s13, 24576
s_min_u32 s12, s13, 2146435072
ds_read_b64_tr_b16 a[224:225], v89 offset:0
ds_read_b64_tr_b16 a[226:227], v89 offset:4608
ds_read_b64_tr_b16 a[228:229], v89 offset:36864
ds_read_b64_tr_b16 a[230:231], v89 offset:41472
buffer_load_dwordx4 v[40:43], off, s[64:67], s82 offset:0 sc1
buffer_load_dwordx4 v[44:47], off, s[64:67], s82 offset:16 sc1
buffer_load_dwordx4 v[48:51], off, s[64:67], s82 offset:32 sc1
v_and_b32_dpp v60, v83, v8 row_newbcast:0 row_mask:0xf bank_mask:0xf
v_and_b32_dpp v61, v83, v9 row_newbcast:0 row_mask:0xf bank_mask:0xf
v_and_b32_dpp v62, v83, v10 row_newbcast:0 row_mask:0xf bank_mask:0xf
v_and_b32_dpp v63, v83, v11 row_newbcast:0 row_mask:0xf bank_mask:0xf
v_and_b32_dpp v64, v83, v8 row_newbcast:4 row_mask:0xf bank_mask:0xf
v_and_b32_dpp v65, v83, v9 row_newbcast:4 row_mask:0xf bank_mask:0xf
v_and_b32_dpp v66, v83, v10 row_newbcast:4 row_mask:0xf bank_mask:0xf
v_and_b32_dpp v67, v83, v11 row_newbcast:4 row_mask:0xf bank_mask:0xf
v_and_b32_dpp v68, v83, v8 row_newbcast:8 row_mask:0xf bank_mask:0xf
v_and_b32_dpp v69, v83, v9 row_newbcast:8 row_mask:0xf bank_mask:0xf
v_and_b32_dpp v70, v83, v10 row_newbcast:8 row_mask:0xf bank_mask:0xf
v_and_b32_dpp v71, v83, v11 row_newbcast:8 row_mask:0xf bank_mask:0xf
v_and_b32_dpp v72, v83, v8 row_newbcast:12 row_mask:0xf bank_mask:0xf
v_and_b32_dpp v73, v83, v9 row_newbcast:12 row_mask:0xf bank_mask:0xf
v_and_b32_dpp v74, v83, v10 row_newbcast:12 row_mask:0xf bank_mask:0xf
v_and_b32_dpp v75, v83, v11 row_newbcast:12 row_mask:0xf bank_mask:0xf
s_waitcnt vmcnt(28)
v_mfma_f32_16x16x32_bf16 v[20:23], v[60:63], v[120:123], v[20:23]
v_mfma_f32_16x16x32_bf16 v[20:23], v[64:67], v[124:127], v[20:23]
v_mfma_f32_16x16x32_bf16 v[20:23], v[68:71], v[128:131], v[20:23]
v_mfma_f32_16x16x32_bf16 v[20:23], v[72:75], v[132:135], v[20:23]
v_add_u32 v117, 1, v117
buffer_store_dword v117, v118, s[64:67], 0 offen
buffer_load_dwordx4 v[120:123], v2, s[52:55], s12 offen offset:0 nt
buffer_load_dwordx4 v[124:127], v2, s[52:55], s12 offen offset:1024 nt
buffer_load_dwordx4 v[128:131], v2, s[52:55], s12 offen offset:2048 nt
buffer_load_dwordx4 v[132:135], v2, s[52:55], s12 offen offset:3072 nt
s_add_u32 s13, s13, 24576
s_min_u32 s12, s13, 2146435072
ds_read_b64_tr_b16 a[232:233], v91 offset:0
ds_read_b64_tr_b16 a[234:235], v91 offset:4608
ds_read_b64_tr_b16 a[236:237], v91 offset:36864
ds_read_b64_tr_b16 a[238:239], v91 offset:41472
v_and_b32_dpp v60, v83, v8 row_newbcast:1 row_mask:0xf bank_mask:0xf
v_and_b32_dpp v61, v83, v9 row_newbcast:1 row_mask:0xf bank_mask:0xf
v_and_b32_dpp v62, v83, v10 row_newbcast:1 row_mask:0xf bank_mask:0xf
v_and_b32_dpp v63, v83, v11 row_newbcast:1 row_mask:0xf bank_mask:0xf
v_and_b32_dpp v64, v83, v8 row_newbcast:5 row_mask:0xf bank_mask:0xf
v_and_b32_dpp v65, v83, v9 row_newbcast:5 row_mask:0xf bank_mask:0xf
v_and_b32_dpp v66, v83, v10 row_newbcast:5 row_mask:0xf bank_mask:0xf
v_and_b32_dpp v67, v83, v11 row_newbcast:5 row_mask:0xf bank_mask:0xf
v_and_b32_dpp v68, v83, v8 row_newbcast:9 row_mask:0xf bank_mask:0xf
v_and_b32_dpp v69, v83, v9 row_newbcast:9 row_mask:0xf bank_mask:0xf
v_and_b32_dpp v70, v83, v10 row_newbcast:9 row_mask:0xf bank_mask:0xf
v_and_b32_dpp v71, v83, v11 row_newbcast:9 row_mask:0xf bank_mask:0xf
v_and_b32_dpp v72, v83, v8 row_newbcast:13 row_mask:0xf bank_mask:0xf
v_and_b32_dpp v73, v83, v9 row_newbcast:13 row_mask:0xf bank_mask:0xf
v_and_b32_dpp v74, v83, v10 row_newbcast:13 row_mask:0xf bank_mask:0xf
v_and_b32_dpp v75, v83, v11 row_newbcast:13 row_mask:0xf bank_mask:0xf
s_waitcnt vmcnt(28)
v_mfma_f32_16x16x32_bf16 v[20:23], v[60:63], v[136:139], v[20:23]
v_mfma_f32_16x16x32_bf16 v[20:23], v[64:67], v[140:143], v[20:23]
v_mfma_f32_16x16x32_bf16 v[20:23], v[68:71], v[144:147], v[20:23]
v_mfma_f32_16x16x32_bf16 v[20:23], v[72:75], v[148:151], v[20:23]
v_add_u32 v117, 1, v117
buffer_store_dword v117, v118, s[64:67], 0 offen
buffer_load_dwordx4 v[136:139], v2, s[52:55], s12 offen offset:0 nt
buffer_load_dwordx4 v[140:143], v2, s[52:55], s12 offen offset:1024 nt
buffer_load_dwordx4 v[144:147], v2, s[52:55], s12 offen offset:2048 nt
buffer_load_dwordx4 v[148:151], v2, s[52:55], s12 offen offset:3072 nt
s_add_u32 s13, s13, 24576
s_min_u32 s12, s13, 2146435072
v_and_b32_dpp v60, v77, v8 row_newbcast:2 row_mask:0xf bank_mask:0xf
v_and_b32_dpp v61, v77, v9 row_newbcast:2 row_mask:0xf bank_mask:0xf
v_and_b32_dpp v62, v77, v10 row_newbcast:2 row_mask:0xf bank_mask:0xf
v_and_b32_dpp v63, v77, v11 row_newbcast:2 row_mask:0xf bank_mask:0xf
v_and_b32_dpp v64, v77, v8 row_newbcast:6 row_mask:0xf bank_mask:0xf
v_and_b32_dpp v65, v77, v9 row_newbcast:6 row_mask:0xf bank_mask:0xf
v_and_b32_dpp v66, v77, v10 row_newbcast:6 row_mask:0xf bank_mask:0xf
v_and_b32_dpp v67, v77, v11 row_newbcast:6 row_mask:0xf bank_mask:0xf
v_and_b32_dpp v68, v77, v8 row_newbcast:10 row_mask:0xf bank_mask:0xf
v_and_b32_dpp v69, v77, v9 row_newbcast:10 row_mask:0xf bank_mask:0xf
v_and_b32_dpp v70, v77, v10 row_newbcast:10 row_mask:0xf bank_mask:0xf
v_and_b32_dpp v71, v77, v11 row_newbcast:10 row_mask:0xf bank_mask:0xf
v_and_b32_dpp v72, v77, v8 row_newbcast:14 row_mask:0xf bank_mask:0xf
v_and_b32_dpp v73, v77, v9 row_newbcast:14 row_mask:0xf bank_mask:0xf
v_and_b32_dpp v74, v77, v10 row_newbcast:14 row_mask:0xf bank_mask:0xf
v_and_b32_dpp v75, v77, v11 row_newbcast:14 row_mask:0xf bank_mask:0xf
v_mfma_f32_16x16x32_bf16 v[20:23], v[60:63], a[80:83], v[20:23]
v_mfma_f32_16x16x32_bf16 v[20:23], v[64:67], a[84:87], v[20:23]
v_mfma_f32_16x16x32_bf16 v[20:23], v[68:71], a[88:91], v[20:23]
v_mfma_f32_16x16x32_bf16 v[20:23], v[72:75], a[92:95], v[20:23]
s_nop 3
v_and_b32_dpp v60, v83, v8 row_newbcast:2 row_mask:0xf bank_mask:0xf
v_and_b32_dpp v61, v83, v9 row_newbcast:2 row_mask:0xf bank_mask:0xf
v_and_b32_dpp v62, v83, v10 row_newbcast:2 row_mask:0xf bank_mask:0xf
v_and_b32_dpp v63, v83, v11 row_newbcast:2 row_mask:0xf bank_mask:0xf
v_and_b32_dpp v64, v83, v8 row_newbcast:6 row_mask:0xf bank_mask:0xf
v_and_b32_dpp v65, v83, v9 row_newbcast:6 row_mask:0xf bank_mask:0xf
v_and_b32_dpp v66, v83, v10 row_newbcast:6 row_mask:0xf bank_mask:0xf
v_and_b32_dpp v67, v83, v11 row_newbcast:6 row_mask:0xf bank_mask:0xf
v_and_b32_dpp v68, v83, v8 row_newbcast:10 row_mask:0xf bank_mask:0xf
v_and_b32_dpp v69, v83, v9 row_newbcast:10 row_mask:0xf bank_mask:0xf
v_and_b32_dpp v70, v83, v10 row_newbcast:10 row_mask:0xf bank_mask:0xf
v_and_b32_dpp v71, v83, v11 row_newbcast:10 row_mask:0xf bank_mask:0xf
v_and_b32_dpp v72, v83, v8 row_newbcast:14 row_mask:0xf bank_mask:0xf
v_and_b32_dpp v73, v83, v9 row_newbcast:14 row_mask:0xf bank_mask:0xf
v_and_b32_dpp v74, v83, v10 row_newbcast:14 row_mask:0xf bank_mask:0xf
v_and_b32_dpp v75, v83, v11 row_newbcast:14 row_mask:0xf bank_mask:0xf
s_waitcnt vmcnt(28)
v_mfma_f32_16x16x32_bf16 v[20:23], v[60:63], v[152:155], v[20:23]
v_mfma_f32_16x16x32_bf16 v[20:23], v[64:67], v[156:159], v[20:23]
v_mfma_f32_16x16x32_bf16 v[20:23], v[68:71], v[160:163], v[20:23]
v_mfma_f32_16x16x32_bf16 v[20:23], v[72:75], v[164:167], v[20:23]
v_add_u32 v117, 1, v117
buffer_store_dword v117, v118, s[64:67], 0 offen
buffer_load_dwordx4 v[152:155], v2, s[52:55], s12 offen offset:0 nt
buffer_load_dwordx4 v[156:159], v2, s[52:55], s12 offen offset:1024 nt
buffer_load_dwordx4 v[160:163], v2, s[52:55], s12 offen offset:2048 nt
buffer_load_dwordx4 v[164:167], v2, s[52:55], s12 offen offset:3072 nt
s_add_u32 s13, s13, 24576
s_min_u32 s12, s13, 2146435072
v_and_b32_dpp v60, v83, v8 row_newbcast:3 row_mask:0xf bank_mask:0xf
v_and_b32_dpp v61, v83, v9 row_newbcast:3 row_mask:0xf bank_mask:0xf
v_and_b32_dpp v62, v83, v10 row_newbcast:3 row_mask:0xf bank_mask:0xf
v_and_b32_dpp v63, v83, v11 row_newbcast:3 row_mask:0xf bank_mask:0xf
v_and_b32_dpp v64, v83, v8 row_newbcast:7 row_mask:0xf bank_mask:0xf
v_and_b32_dpp v65, v83, v9 row_newbcast:7 row_mask:0xf bank_mask:0xf
v_and_b32_dpp v66, v83, v10 row_newbcast:7 row_mask:0xf bank_mask:0xf
v_and_b32_dpp v67, v83, v11 row_newbcast:7 row_mask:0xf bank_mask:0xf
v_and_b32_dpp v68, v83, v8 row_newbcast:11 row_mask:0xf bank_mask:0xf
v_and_b32_dpp v69, v83, v9 row_newbcast:11 row_mask:0xf bank_mask:0xf
v_and_b32_dpp v70, v83, v10 row_newbcast:11 row_mask:0xf bank_mask:0xf
v_and_b32_dpp v71, v83, v11 row_newbcast:11 row_mask:0xf bank_mask:0xf
v_and_b32_dpp v72, v83, v8 row_newbcast:15 row_mask:0xf bank_mask:0xf
v_and_b32_dpp v73, v83, v9 row_newbcast:15 row_mask:0xf bank_mask:0xf
v_and_b32_dpp v74, v83, v10 row_newbcast:15 row_mask:0xf bank_mask:0xf
v_and_b32_dpp v75, v83, v11 row_newbcast:15 row_mask:0xf bank_mask:0xf
s_waitcnt vmcnt(28)
v_mfma_f32_16x16x32_bf16 v[20:23], v[60:63], v[168:171], v[20:23]
v_mfma_f32_16x16x32_bf16 v[20:23], v[64:67], v[172:175], v[20:23]
v_mfma_f32_16x16x32_bf16 v[20:23], v[68:71], v[176:179], v[20:23]
v_mfma_f32_16x16x32_bf16 v[20:23], v[72:75], v[180:183], v[20:23]
v_add_u32 v117, 1, v117
buffer_store_dword v117, v118, s[64:67], 0 offen
buffer_load_dwordx4 v[168:171], v2, s[52:55], s12 offen offset:0 nt
buffer_load_dwordx4 v[172:175], v2, s[52:55], s12 offen offset:1024 nt
buffer_load_dwordx4 v[176:179], v2, s[52:55], s12 offen offset:2048 nt
buffer_load_dwordx4 v[180:183], v2, s[52:55], s12 offen offset:3072 nt
s_add_u32 s13, s13, 24576
s_min_u32 s12, s13, 2146435072
v_and_b32_dpp v60, v84, v8 row_newbcast:0 row_mask:0xf bank_mask:0xf
v_and_b32_dpp v61, v84, v9 row_newbcast:0 row_mask:0xf bank_mask:0xf
v_and_b32_dpp v62, v84, v10 row_newbcast:0 row_mask:0xf bank_mask:0xf
v_and_b32_dpp v63, v84, v11 row_newbcast:0 row_mask:0xf bank_mask:0xf
v_and_b32_dpp v64, v84, v8 row_newbcast:4 row_mask:0xf bank_mask:0xf
v_and_b32_dpp v65, v84, v9 row_newbcast:4 row_mask:0xf bank_mask:0xf
v_and_b32_dpp v66, v84, v10 row_newbcast:4 row_mask:0xf bank_mask:0xf
v_and_b32_dpp v67, v84, v11 row_newbcast:4 row_mask:0xf bank_mask:0xf
v_and_b32_dpp v68, v84, v8 row_newbcast:8 row_mask:0xf bank_mask:0xf
v_and_b32_dpp v69, v84, v9 row_newbcast:8 row_mask:0xf bank_mask:0xf
v_and_b32_dpp v70, v84, v10 row_newbcast:8 row_mask:0xf bank_mask:0xf
v_and_b32_dpp v71, v84, v11 row_newbcast:8 row_mask:0xf bank_mask:0xf
v_and_b32_dpp v72, v84, v8 row_newbcast:12 row_mask:0xf bank_mask:0xf
v_and_b32_dpp v73, v84, v9 row_newbcast:12 row_mask:0xf bank_mask:0xf
v_and_b32_dpp v74, v84, v10 row_newbcast:12 row_mask:0xf bank_mask:0xf
v_and_b32_dpp v75, v84, v11 row_newbcast:12 row_mask:0xf bank_mask:0xf
s_waitcnt vmcnt(28)
v_mfma_f32_16x16x32_bf16 v[20:23], v[60:63], v[184:187], v[20:23]
v_mfma_f32_16x16x32_bf16 v[20:23], v[64:67], v[188:191], v[20:23]
v_mfma_f32_16x16x32_bf16 v[20:23], v[68:71], v[192:195], v[20:23]
v_mfma_f32_16x16x32_bf16 v[20:23], v[72:75], v[196:199], v[20:23]
v_add_u32 v117, 1, v117
buffer_store_dword v117, v118, s[64:67], 0 offen
buffer_load_dwordx4 v[184:187], v2, s[52:55], s12 offen offset:0 nt
buffer_load_dwordx4 v[188:191], v2, s[52:55], s12 offen offset:1024 nt
buffer_load_dwordx4 v[192:195], v2, s[52:55], s12 offen offset:2048 nt
buffer_load_dwordx4 v[196:199], v2, s[52:55], s12 offen offset:3072 nt
s_add_u32 s13, s13, 24576
s_min_u32 s12, s13, 2146435072
v_and_b32_dpp v60, v84, v8 row_newbcast:1 row_mask:0xf bank_mask:0xf
v_and_b32_dpp v61, v84, v9 row_newbcast:1 row_mask:0xf bank_mask:0xf
v_and_b32_dpp v62, v84, v10 row_newbcast:1 row_mask:0xf bank_mask:0xf
v_and_b32_dpp v63, v84, v11 row_newbcast:1 row_mask:0xf bank_mask:0xf
v_and_b32_dpp v64, v84, v8 row_newbcast:5 row_mask:0xf bank_mask:0xf
v_and_b32_dpp v65, v84, v9 row_newbcast:5 row_mask:0xf bank_mask:0xf
v_and_b32_dpp v66, v84, v10 row_newbcast:5 row_mask:0xf bank_mask:0xf
v_and_b32_dpp v67, v84, v11 row_newbcast:5 row_mask:0xf bank_mask:0xf
v_and_b32_dpp v68, v84, v8 row_newbcast:9 row_mask:0xf bank_mask:0xf
v_and_b32_dpp v69, v84, v9 row_newbcast:9 row_mask:0xf bank_mask:0xf
v_and_b32_dpp v70, v84, v10 row_newbcast:9 row_mask:0xf bank_mask:0xf
v_and_b32_dpp v71, v84, v11 row_newbcast:9 row_mask:0xf bank_mask:0xf
v_and_b32_dpp v72, v84, v8 row_newbcast:13 row_mask:0xf bank_mask:0xf
v_and_b32_dpp v73, v84, v9 row_newbcast:13 row_mask:0xf bank_mask:0xf
v_and_b32_dpp v74, v84, v10 row_newbcast:13 row_mask:0xf bank_mask:0xf
v_and_b32_dpp v75, v84, v11 row_newbcast:13 row_mask:0xf bank_mask:0xf
s_waitcnt vmcnt(28)
v_mfma_f32_16x16x32_bf16 v[20:23], v[60:63], v[200:203], v[20:23]
v_mfma_f32_16x16x32_bf16 v[20:23], v[64:67], v[204:207], v[20:23]
v_mfma_f32_16x16x32_bf16 v[20:23], v[68:71], v[208:211], v[20:23]
v_mfma_f32_16x16x32_bf16 v[20:23], v[72:75], v[212:215], v[20:23]
v_add_u32 v117, 1, v117
buffer_store_dword v117, v118, s[64:67], 0 offen
buffer_load_dwordx4 v[200:203], v2, s[52:55], s12 offen offset:0 nt
buffer_load_dwordx4 v[204:207], v2, s[52:55], s12 offen offset:1024 nt
buffer_load_dwordx4 v[208:211], v2, s[52:55], s12 offen offset:2048 nt
buffer_load_dwordx4 v[212:215], v2, s[52:55], s12 offen offset:3072 nt
s_add_u32 s13, s13, 24576
s_min_u32 s12, s13, 2146435072
v_and_b32_dpp v60, v77, v8 row_newbcast:3 row_mask:0xf bank_mask:0xf
v_and_b32_dpp v61, v77, v9 row_newbcast:3 row_mask:0xf bank_mask:0xf
v_and_b32_dpp v62, v77, v10 row_newbcast:3 row_mask:0xf bank_mask:0xf
v_and_b32_dpp v63, v77, v11 row_newbcast:3 row_mask:0xf bank_mask:0xf
v_and_b32_dpp v64, v77, v8 row_newbcast:7 row_mask:0xf bank_mask:0xf
v_and_b32_dpp v65, v77, v9 row_newbcast:7 row_mask:0xf bank_mask:0xf
v_and_b32_dpp v66, v77, v10 row_newbcast:7 row_mask:0xf bank_mask:0xf
v_and_b32_dpp v67, v77, v11 row_newbcast:7 row_mask:0xf bank_mask:0xf
v_and_b32_dpp v68, v77, v8 row_newbcast:11 row_mask:0xf bank_mask:0xf
v_and_b32_dpp v69, v77, v9 row_newbcast:11 row_mask:0xf bank_mask:0xf
v_and_b32_dpp v70, v77, v10 row_newbcast:11 row_mask:0xf bank_mask:0xf
v_and_b32_dpp v71, v77, v11 row_newbcast:11 row_mask:0xf bank_mask:0xf
v_and_b32_dpp v72, v77, v8 row_newbcast:15 row_mask:0xf bank_mask:0xf
v_and_b32_dpp v73, v77, v9 row_newbcast:15 row_mask:0xf bank_mask:0xf
v_and_b32_dpp v74, v77, v10 row_newbcast:15 row_mask:0xf bank_mask:0xf
v_and_b32_dpp v75, v77, v11 row_newbcast:15 row_mask:0xf bank_mask:0xf
v_mfma_f32_16x16x32_bf16 v[20:23], v[60:63], a[240:243], v[20:23]
v_mfma_f32_16x16x32_bf16 v[20:23], v[64:67], a[244:247], v[20:23]
v_mfma_f32_16x16x32_bf16 v[20:23], v[68:71], a[248:251], v[20:23]
v_mfma_f32_16x16x32_bf16 v[20:23], v[72:75], a[252:255], v[20:23]
s_nop 3
v_and_b32_dpp v60, v84, v8 row_newbcast:2 row_mask:0xf bank_mask:0xf
v_and_b32_dpp v61, v84, v9 row_newbcast:2 row_mask:0xf bank_mask:0xf
v_and_b32_dpp v62, v84, v10 row_newbcast:2 row_mask:0xf bank_mask:0xf
v_and_b32_dpp v63, v84, v11 row_newbcast:2 row_mask:0xf bank_mask:0xf
v_and_b32_dpp v64, v84, v8 row_newbcast:6 row_mask:0xf bank_mask:0xf
v_and_b32_dpp v65, v84, v9 row_newbcast:6 row_mask:0xf bank_mask:0xf
v_and_b32_dpp v66, v84, v10 row_newbcast:6 row_mask:0xf bank_mask:0xf
v_and_b32_dpp v67, v84, v11 row_newbcast:6 row_mask:0xf bank_mask:0xf
v_and_b32_dpp v68, v84, v8 row_newbcast:10 row_mask:0xf bank_mask:0xf
v_and_b32_dpp v69, v84, v9 row_newbcast:10 row_mask:0xf bank_mask:0xf
v_and_b32_dpp v70, v84, v10 row_newbcast:10 row_mask:0xf bank_mask:0xf
v_and_b32_dpp v71, v84, v11 row_newbcast:10 row_mask:0xf bank_mask:0xf
v_and_b32_dpp v72, v84, v8 row_newbcast:14 row_mask:0xf bank_mask:0xf
v_and_b32_dpp v73, v84, v9 row_newbcast:14 row_mask:0xf bank_mask:0xf
v_and_b32_dpp v74, v84, v10 row_newbcast:14 row_mask:0xf bank_mask:0xf
v_and_b32_dpp v75, v84, v11 row_newbcast:14 row_mask:0xf bank_mask:0xf
s_waitcnt vmcnt(28)
v_mfma_f32_16x16x32_bf16 v[20:23], v[60:63], v[216:219], v[20:23]
v_mfma_f32_16x16x32_bf16 v[20:23], v[64:67], v[220:223], v[20:23]
v_mfma_f32_16x16x32_bf16 v[20:23], v[68:71], v[224:227], v[20:23]
v_mfma_f32_16x16x32_bf16 v[20:23], v[72:75], v[228:231], v[20:23]
v_add_u32 v117, 1, v117
buffer_store_dword v117, v118, s[64:67], 0 offen
buffer_load_dwordx4 v[216:219], v2, s[52:55], s12 offen offset:0 nt
buffer_load_dwordx4 v[220:223], v2, s[52:55], s12 offen offset:1024 nt
buffer_load_dwordx4 v[224:227], v2, s[52:55], s12 offen offset:2048 nt
buffer_load_dwordx4 v[228:231], v2, s[52:55], s12 offen offset:3072 nt
s_add_u32 s13, s13, 24576
s_min_u32 s12, s13, 2146435072
v_and_b32_dpp v60, v84, v8 row_newbcast:3 row_mask:0xf bank_mask:0xf
v_and_b32_dpp v61, v84, v9 row_newbcast:3 row_mask:0xf bank_mask:0xf
v_and_b32_dpp v62, v84, v10 row_newbcast:3 row_mask:0xf bank_mask:0xf
v_and_b32_dpp v63, v84, v11 row_newbcast:3 row_mask:0xf bank_mask:0xf
v_and_b32_dpp v64, v84, v8 row_newbcast:7 row_mask:0xf bank_mask:0xf
v_and_b32_dpp v65, v84, v9 row_newbcast:7 row_mask:0xf bank_mask:0xf
v_and_b32_dpp v66, v84, v10 row_newbcast:7 row_mask:0xf bank_mask:0xf
v_and_b32_dpp v67, v84, v11 row_newbcast:7 row_mask:0xf bank_mask:0xf
v_and_b32_dpp v68, v84, v8 row_newbcast:11 row_mask:0xf bank_mask:0xf
v_and_b32_dpp v69, v84, v9 row_newbcast:11 row_mask:0xf bank_mask:0xf
v_and_b32_dpp v70, v84, v10 row_newbcast:11 row_mask:0xf bank_mask:0xf
v_and_b32_dpp v71, v84, v11 row_newbcast:11 row_mask:0xf bank_mask:0xf
v_and_b32_dpp v72, v84, v8 row_newbcast:15 row_mask:0xf bank_mask:0xf
v_and_b32_dpp v73, v84, v9 row_newbcast:15 row_mask:0xf bank_mask:0xf
v_and_b32_dpp v74, v84, v10 row_newbcast:15 row_mask:0xf bank_mask:0xf
v_and_b32_dpp v75, v84, v11 row_newbcast:15 row_mask:0xf bank_mask:0xf
s_waitcnt vmcnt(28)
v_mfma_f32_16x16x32_bf16 v[20:23], v[60:63], v[232:235], v[20:23]
v_mfma_f32_16x16x32_bf16 v[20:23], v[64:67], v[236:239], v[20:23]
v_mfma_f32_16x16x32_bf16 v[20:23], v[68:71], v[240:243], v[20:23]
v_mfma_f32_16x16x32_bf16 v[20:23], v[72:75], v[244:247], v[20:23]
v_add_u32 v117, 1, v117
buffer_store_dword v117, v118, s[64:67], 0 offen
buffer_load_dwordx4 v[232:235], v2, s[52:55], s12 offen offset:0 nt
buffer_load_dwordx4 v[236:239], v2, s[52:55], s12 offen offset:1024 nt
buffer_load_dwordx4 v[240:243], v2, s[52:55], s12 offen offset:2048 nt
buffer_load_dwordx4 v[244:247], v2, s[52:55], s12 offen offset:3072 nt
s_add_u32 s13, s13, 24576
s_min_u32 s12, s13, 2146435072
s_branch A_ev2
A_ev2_ret:
s_nop 1
v_and_b32_dpp v60, v85, v8 row_newbcast:0 row_mask:0xf bank_mask:0xf
v_and_b32_dpp v61, v85, v9 row_newbcast:0 row_mask:0xf bank_mask:0xf
v_and_b32_dpp v62, v85, v10 row_newbcast:0 row_mask:0xf bank_mask:0xf
v_and_b32_dpp v63, v85, v11 row_newbcast:0 row_mask:0xf bank_mask:0xf
v_and_b32_dpp v64, v85, v8 row_newbcast:4 row_mask:0xf bank_mask:0xf
v_and_b32_dpp v65, v85, v9 row_newbcast:4 row_mask:0xf bank_mask:0xf
v_and_b32_dpp v66, v85, v10 row_newbcast:4 row_mask:0xf bank_mask:0xf
v_and_b32_dpp v67, v85, v11 row_newbcast:4 row_mask:0xf bank_mask:0xf
v_and_b32_dpp v68, v85, v8 row_newbcast:8 row_mask:0xf bank_mask:0xf
v_and_b32_dpp v69, v85, v9 row_newbcast:8 row_mask:0xf bank_mask:0xf
v_and_b32_dpp v70, v85, v10 row_newbcast:8 row_mask:0xf bank_mask:0xf
v_and_b32_dpp v71, v85, v11 row_newbcast:8 row_mask:0xf bank_mask:0xf
v_and_b32_dpp v72, v85, v8 row_newbcast:12 row_mask:0xf bank_mask:0xf
v_and_b32_dpp v73, v85, v9 row_newbcast:12 row_mask:0xf bank_mask:0xf
v_and_b32_dpp v74, v85, v10 row_newbcast:12 row_mask:0xf bank_mask:0xf
v_and_b32_dpp v75, v85, v11 row_newbcast:12 row_mask:0xf bank_mask:0xf
s_waitcnt vmcnt(28)
v_mfma_f32_16x16x32_bf16 v[20:23], v[60:63], v[120:123], v[20:23]
v_mfma_f32_16x16x32_bf16 v[20:23], v[64:67], v[124:127], v[20:23]
v_mfma_f32_16x16x32_bf16 v[20:23], v[68:71], v[128:131], v[20:23]
v_mfma_f32_16x16x32_bf16 v[20:23], v[72:75], v[132:135], v[20:23]
s_nop 3
v_and_b32_dpp v60, v85, v8 row_newbcast:1 row_mask:0xf bank_mask:0xf
v_and_b32_dpp v61, v85, v9 row_newbcast:1 row_mask:0xf bank_mask:0xf
v_and_b32_dpp v62, v85, v10 row_newbcast:1 row_mask:0xf bank_mask:0xf
v_and_b32_dpp v63, v85, v11 row_newbcast:1 row_mask:0xf bank_mask:0xf
v_and_b32_dpp v64, v85, v8 row_newbcast:5 row_mask:0xf bank_mask:0xf
v_and_b32_dpp v65, v85, v9 row_newbcast:5 row_mask:0xf bank_mask:0xf
v_and_b32_dpp v66, v85, v10 row_newbcast:5 row_mask:0xf bank_mask:0xf
v_and_b32_dpp v67, v85, v11 row_newbcast:5 row_mask:0xf bank_mask:0xf
v_and_b32_dpp v68, v85, v8 row_newbcast:9 row_mask:0xf bank_mask:0xf
v_and_b32_dpp v69, v85, v9 row_newbcast:9 row_mask:0xf bank_mask:0xf
v_and_b32_dpp v70, v85, v10 row_newbcast:9 row_mask:0xf bank_mask:0xf
v_and_b32_dpp v71, v85, v11 row_newbcast:9 row_mask:0xf bank_mask:0xf
v_and_b32_dpp v72, v85, v8 row_newbcast:13 row_mask:0xf bank_mask:0xf
v_and_b32_dpp v73, v85, v9 row_newbcast:13 row_mask:0xf bank_mask:0xf
v_and_b32_dpp v74, v85, v10 row_newbcast:13 row_mask:0xf bank_mask:0xf
v_and_b32_dpp v75, v85, v11 row_newbcast:13 row_mask:0xf bank_mask:0xf
s_waitcnt vmcnt(24)
v_mfma_f32_16x16x32_bf16 v[20:23], v[60:63], v[136:139], v[20:23]
v_mfma_f32_16x16x32_bf16 v[20:23], v[64:67], v[140:143], v[20:23]
v_mfma_f32_16x16x32_bf16 v[20:23], v[68:71], v[144:147], v[20:23]
v_mfma_f32_16x16x32_bf16 v[20:23], v[72:75], v[148:151], v[20:23]
s_nop 3
v_and_b32_dpp v60, v85, v8 row_newbcast:2 row_mask:0xf bank_mask:0xf
v_and_b32_dpp v61, v85, v9 row_newbcast:2 row_mask:0xf bank_mask:0xf
v_and_b32_dpp v62, v85, v10 row_newbcast:2 row_mask:0xf bank_mask:0xf
v_and_b32_dpp v63, v85, v11 row_newbcast:2 row_mask:0xf bank_mask:0xf
v_and_b32_dpp v64, v85, v8 row_newbcast:6 row_mask:0xf bank_mask:0xf
v_and_b32_dpp v65, v85, v9 row_newbcast:6 row_mask:0xf bank_mask:0xf
v_and_b32_dpp v66, v85, v10 row_newbcast:6 row_mask:0xf bank_mask:0xf
v_and_b32_dpp v67, v85, v11 row_newbcast:6 row_mask:0xf bank_mask:0xf
v_and_b32_dpp v68, v85, v8 row_newbcast:10 row_mask:0xf bank_mask:0xf
v_and_b32_dpp v69, v85, v9 row_newbcast:10 row_mask:0xf bank_mask:0xf
v_and_b32_dpp v70, v85, v10 row_newbcast:10 row_mask:0xf bank_mask:0xf
v_and_b32_dpp v71, v85, v11 row_newbcast:10 row_mask:0xf bank_mask:0xf
v_and_b32_dpp v72, v85, v8 row_newbcast:14 row_mask:0xf bank_mask:0xf
v_and_b32_dpp v73, v85, v9 row_newbcast:14 row_mask:0xf bank_mask:0xf
v_and_b32_dpp v74, v85, v10 row_newbcast:14 row_mask:0xf bank_mask:0xf
v_and_b32_dpp v75, v85, v11 row_newbcast:14 row_mask:0xf bank_mask:0xf
s_waitcnt vmcnt(20)
v_mfma_f32_16x16x32_bf16 v[20:23], v[60:63], v[152:155], v[20:23]
v_mfma_f32_16x16x32_bf16 v[20:23], v[64:67], v[156:159], v[20:23]
v_mfma_f32_16x16x32_bf16 v[20:23], v[68:71], v[160:163], v[20:23]
v_mfma_f32_16x16x32_bf16 v[20:23], v[72:75], v[164:167], v[20:23]
s_nop 3
v_and_b32_dpp v60, v85, v8 row_newbcast:3 row_mask:0xf bank_mask:0xf
v_and_b32_dpp v61, v85, v9 row_newbcast:3 row_mask:0xf bank_mask:0xf
v_and_b32_dpp v62, v85, v10 row_newbcast:3 row_mask:0xf bank_mask:0xf
v_and_b32_dpp v63, v85, v11 row_newbcast:3 row_mask:0xf bank_mask:0xf
v_and_b32_dpp v64, v85, v8 row_newbcast:7 row_mask:0xf bank_mask:0xf
v_and_b32_dpp v65, v85, v9 row_newbcast:7 row_mask:0xf bank_mask:0xf
v_and_b32_dpp v66, v85, v10 row_newbcast:7 row_mask:0xf bank_mask:0xf
v_and_b32_dpp v67, v85, v11 row_newbcast:7 row_mask:0xf bank_mask:0xf
v_and_b32_dpp v68, v85, v8 row_newbcast:11 row_mask:0xf bank_mask:0xf
v_and_b32_dpp v69, v85, v9 row_newbcast:11 row_mask:0xf bank_mask:0xf
v_and_b32_dpp v70, v85, v10 row_newbcast:11 row_mask:0xf bank_mask:0xf
v_and_b32_dpp v71, v85, v11 row_newbcast:11 row_mask:0xf bank_mask:0xf
v_and_b32_dpp v72, v85, v8 row_newbcast:15 row_mask:0xf bank_mask:0xf
v_and_b32_dpp v73, v85, v9 row_newbcast:15 row_mask:0xf bank_mask:0xf
v_and_b32_dpp v74, v85, v10 row_newbcast:15 row_mask:0xf bank_mask:0xf
v_and_b32_dpp v75, v85, v11 row_newbcast:15 row_mask:0xf bank_mask:0xf
s_waitcnt vmcnt(16)
v_mfma_f32_16x16x32_bf16 v[20:23], v[60:63], v[168:171], v[20:23]
v_mfma_f32_16x16x32_bf16 v[20:23], v[64:67], v[172:175], v[20:23]
v_mfma_f32_16x16x32_bf16 v[20:23], v[68:71], v[176:179], v[20:23]
v_mfma_f32_16x16x32_bf16 v[20:23], v[72:75], v[180:183], v[20:23]
s_nop 3
v_and_b32_dpp v60, v86, v8 row_newbcast:0 row_mask:0xf bank_mask:0xf
v_and_b32_dpp v61, v86, v9 row_newbcast:0 row_mask:0xf bank_mask:0xf
v_and_b32_dpp v62, v86, v10 row_newbcast:0 row_mask:0xf bank_mask:0xf
v_and_b32_dpp v63, v86, v11 row_newbcast:0 row_mask:0xf bank_mask:0xf
v_and_b32_dpp v64, v86, v8 row_newbcast:4 row_mask:0xf bank_mask:0xf
v_and_b32_dpp v65, v86, v9 row_newbcast:4 row_mask:0xf bank_mask:0xf
v_and_b32_dpp v66, v86, v10 row_newbcast:4 row_mask:0xf bank_mask:0xf
v_and_b32_dpp v67, v86, v11 row_newbcast:4 row_mask:0xf bank_mask:0xf
v_and_b32_dpp v68, v86, v8 row_newbcast:8 row_mask:0xf bank_mask:0xf
v_and_b32_dpp v69, v86, v9 row_newbcast:8 row_mask:0xf bank_mask:0xf
v_and_b32_dpp v70, v86, v10 row_newbcast:8 row_mask:0xf bank_mask:0xf
v_and_b32_dpp v71, v86, v11 row_newbcast:8 row_mask:0xf bank_mask:0xf
v_and_b32_dpp v72, v86, v8 row_newbcast:12 row_mask:0xf bank_mask:0xf
v_and_b32_dpp v73, v86, v9 row_newbcast:12 row_mask:0xf bank_mask:0xf
v_and_b32_dpp v74, v86, v10 row_newbcast:12 row_mask:0xf bank_mask:0xf
v_and_b32_dpp v75, v86, v11 row_newbcast:12 row_mask:0xf bank_mask:0xf
s_waitcnt vmcnt(12)
v_mfma_f32_16x16x32_bf16 v[20:23], v[60:63], v[184:187], v[20:23]
v_mfma_f32_16x16x32_bf16 v[20:23], v[64:67], v[188:191], v[20:23]
v_mfma_f32_16x16x32_bf16 v[20:23], v[68:71], v[192:195], v[20:23]
v_mfma_f32_16x16x32_bf16 v[20:23], v[72:75], v[196:199], v[20:23]
s_nop 3
v_and_b32_dpp v60, v86, v8 row_newbcast:1 row_mask:0xf bank_mask:0xf
v_and_b32_dpp v61, v86, v9 row_newbcast:1 row_mask:0xf bank_mask:0xf
v_and_b32_dpp v62, v86, v10 row_newbcast:1 row_mask:0xf bank_mask:0xf
v_and_b32_dpp v63, v86, v11 row_newbcast:1 row_mask:0xf bank_mask:0xf
v_and_b32_dpp v64, v86, v8 row_newbcast:5 row_mask:0xf bank_mask:0xf
v_and_b32_dpp v65, v86, v9 row_newbcast:5 row_mask:0xf bank_mask:0xf
v_and_b32_dpp v66, v86, v10 row_newbcast:5 row_mask:0xf bank_mask:0xf
v_and_b32_dpp v67, v86, v11 row_newbcast:5 row_mask:0xf bank_mask:0xf
v_and_b32_dpp v68, v86, v8 row_newbcast:9 row_mask:0xf bank_mask:0xf
v_and_b32_dpp v69, v86, v9 row_newbcast:9 row_mask:0xf bank_mask:0xf
v_and_b32_dpp v70, v86, v10 row_newbcast:9 row_mask:0xf bank_mask:0xf
v_and_b32_dpp v71, v86, v11 row_newbcast:9 row_mask:0xf bank_mask:0xf
v_and_b32_dpp v72, v86, v8 row_newbcast:13 row_mask:0xf bank_mask:0xf
v_and_b32_dpp v73, v86, v9 row_newbcast:13 row_mask:0xf bank_mask:0xf
v_and_b32_dpp v74, v86, v10 row_newbcast:13 row_mask:0xf bank_mask:0xf
v_and_b32_dpp v75, v86, v11 row_newbcast:13 row_mask:0xf bank_mask:0xf
s_waitcnt vmcnt(8)
v_mfma_f32_16x16x32_bf16 v[20:23], v[60:63], v[200:203], v[20:23]
v_mfma_f32_16x16x32_bf16 v[20:23], v[64:67], v[204:207], v[20:23]
v_mfma_f32_16x16x32_bf16 v[20:23], v[68:71], v[208:211], v[20:23]
v_mfma_f32_16x16x32_bf16 v[20:23], v[72:75], v[212:215], v[20:23]
s_nop 3
v_and_b32_dpp v60, v86, v8 row_newbcast:2 row_mask:0xf bank_mask:0xf
v_and_b32_dpp v61, v86, v9 row_newbcast:2 row_mask:0xf bank_mask:0xf
v_and_b32_dpp v62, v86, v10 row_newbcast:2 row_mask:0xf bank_mask:0xf
v_and_b32_dpp v63, v86, v11 row_newbcast:2 row_mask:0xf bank_mask:0xf
v_and_b32_dpp v64, v86, v8 row_newbcast:6 row_mask:0xf bank_mask:0xf
v_and_b32_dpp v65, v86, v9 row_newbcast:6 row_mask:0xf bank_mask:0xf
v_and_b32_dpp v66, v86, v10 row_newbcast:6 row_mask:0xf bank_mask:0xf
v_and_b32_dpp v67, v86, v11 row_newbcast:6 row_mask:0xf bank_mask:0xf
v_and_b32_dpp v68, v86, v8 row_newbcast:10 row_mask:0xf bank_mask:0xf
v_and_b32_dpp v69, v86, v9 row_newbcast:10 row_mask:0xf bank_mask:0xf
v_and_b32_dpp v70, v86, v10 row_newbcast:10 row_mask:0xf bank_mask:0xf
v_and_b32_dpp v71, v86, v11 row_newbcast:10 row_mask:0xf bank_mask:0xf
v_and_b32_dpp v72, v86, v8 row_newbcast:14 row_mask:0xf bank_mask:0xf
v_and_b32_dpp v73, v86, v9 row_newbcast:14 row_mask:0xf bank_mask:0xf
v_and_b32_dpp v74, v86, v10 row_newbcast:14 row_mask:0xf bank_mask:0xf
v_and_b32_dpp v75, v86, v11 row_newbcast:14 row_mask:0xf bank_mask:0xf
s_waitcnt vmcnt(4)
v_mfma_f32_16x16x32_bf16 v[20:23], v[60:63], v[216:219], v[20:23]
v_mfma_f32_16x16x32_bf16 v[20:23], v[64:67], v[220:223], v[20:23]
v_mfma_f32_16x16x32_bf16 v[20:23], v[68:71], v[224:227], v[20:23]
v_mfma_f32_16x16x32_bf16 v[20:23], v[72:75], v[228:231], v[20:23]
s_nop 3
v_and_b32_dpp v60, v86, v8 row_newbcast:3 row_mask:0xf bank_mask:0xf
v_and_b32_dpp v61, v86, v9 row_newbcast:3 row_mask:0xf bank_mask:0xf
v_and_b32_dpp v62, v86, v10 row_newbcast:3 row_mask:0xf bank_mask:0xf
v_and_b32_dpp v63, v86, v11 row_newbcast:3 row_mask:0xf bank_mask:0xf
v_and_b32_dpp v64, v86, v8 row_newbcast:7 row_mask:0xf bank_mask:0xf
v_and_b32_dpp v65, v86, v9 row_newbcast:7 row_mask:0xf bank_mask:0xf
v_and_b32_dpp v66, v86, v10 row_newbcast:7 row_mask:0xf bank_mask:0xf
v_and_b32_dpp v67, v86, v11 row_newbcast:7 row_mask:0xf bank_mask:0xf
v_and_b32_dpp v68, v86, v8 row_newbcast:11 row_mask:0xf bank_mask:0xf
v_and_b32_dpp v69, v86, v9 row_newbcast:11 row_mask:0xf bank_mask:0xf
v_and_b32_dpp v70, v86, v10 row_newbcast:11 row_mask:0xf bank_mask:0xf
v_and_b32_dpp v71, v86, v11 row_newbcast:11 row_mask:0xf bank_mask:0xf
v_and_b32_dpp v72, v86, v8 row_newbcast:15 row_mask:0xf bank_mask:0xf
v_and_b32_dpp v73, v86, v9 row_newbcast:15 row_mask:0xf bank_mask:0xf
v_and_b32_dpp v74, v86, v10 row_newbcast:15 row_mask:0xf bank_mask:0xf
v_and_b32_dpp v75, v86, v11 row_newbcast:15 row_mask:0xf bank_mask:0xf
s_waitcnt vmcnt(0)
v_mfma_f32_16x16x32_bf16 v[20:23], v[60:63], v[232:235], v[20:23]
v_mfma_f32_16x16x32_bf16 v[20:23], v[64:67], v[236:239], v[20:23]
v_mfma_f32_16x16x32_bf16 v[20:23], v[68:71], v[240:243], v[20:23]
v_mfma_f32_16x16x32_bf16 v[20:23], v[72:75], v[244:247], v[20:23]
s_nop 3
s_branch A_tail
A_ev2:
s_mov_b32 s7, 400000
A_ev2_chk:
v_max3_u32 v35, v40, v41, v42
v_max3_u32 v35, v35, v43, v44
v_max3_u32 v35, v35, v45, v46
v_max3_u32 v35, v35, v47, v48
v_max3_u32 v35, v35, v49, v50
v_max_u32 v35, v35, v51
v_cmp_eq_u32 vcc, -1, v35
s_cbranch_vccz A_ev2_ok
buffer_load_dwordx4 v[40:43], off, s[64:67], s82 offset:0 sc1
buffer_load_dwordx4 v[44:47], off, s[64:67], s82 offset:16 sc1
buffer_load_dwordx4 v[48:51], off, s[64:67], s82 offset:32 sc1
s_waitcnt vmcnt(0)
s_sub_u32 s7, s7, 1
s_cmp_lg_u32 s7, 0
s_cbranch_scc1 A_ev2_chk
A_ev2_ok:
v_max3_f32 v35, v40, v42, v44
v_max3_f32 v36, v46, v48, v50
v_max_f32 v35, v35, v36
v_sub_f32 v40, v40, v35
v_sub_f32 v42, v42, v35
v_sub_f32 v44, v44, v35
v_sub_f32 v46, v46, v35
v_sub_f32 v48, v48, v35
v_sub_f32 v50, v50, v35
v_sub_f32 v37, v32, v35
v_exp_f32 v40, v40
v_exp_f32 v42, v42
v_exp_f32 v44, v44
v_exp_f32 v46, v46
v_exp_f32 v48, v48
v_exp_f32 v50, v50
v_exp_f32 v37, v37
v_mul_f32 v35, v40, v41
v_fma_f32 v35, v42, v43, v35
v_fma_f32 v35, v44, v45, v35
v_fma_f32 v35, v46, v47, v35
v_fma_f32 v35, v48, v49, v35
v_fma_f32 v35, v50, v51, v35
v_rcp_f32 v35, v35
s_nop 0
v_mul_f32 v37, v37, v35
s_branch A_ev2_ret
A_tail:
s_nop 4
v_mul_f32 v20, v20, v37
v_mul_f32 v21, v21, v37
v_mul_f32 v22, v22, v37
v_mul_f32 v23, v23, v37
v_cvt_pk_bf16_f32 v28, v20, v21
v_cvt_pk_bf16_f32 v29, v22, v23
ds_write_b64 v94, v[28:29]
s_waitcnt lgkmcnt(0)
s_barrier
ds_read_b128 a[0:3], v95 offset:0
ds_read_b128 a[4:7], v95 offset:64
ds_read_b128 a[8:11], v95 offset:128
ds_read_b128 a[12:15], v95 offset:192
s_waitcnt lgkmcnt(0)
v_mfma_f32_16x16x32_bf16 v[72:75], a[0:3], a[224:227], 0
v_mfma_f32_16x16x32_bf16 v[72:75], a[4:7], a[228:231], v[72:75]
v_mfma_f32_16x16x32_bf16 v[72:75], a[8:11], a[232:235], v[72:75]
v_mfma_f32_16x16x32_bf16 v[72:75], a[12:15], a[236:239], v[72:75]
v_mfma_f32_16x16x32_bf16 v[40:43], a[0:3], a[96:99], 0
v_mfma_f32_16x16x32_bf16 v[40:43], a[4:7], a[100:103], v[40:43]
v_mfma_f32_16x16x32_bf16 v[40:43], a[8:11], a[104:107], v[40:43]
v_mfma_f32_16x16x32_bf16 v[40:43], a[12:15], a[108:111], v[40:43]
v_mfma_f32_16x16x32_bf16 v[44:47], a[0:3], a[112:115], 0
v_mfma_f32_16x16x32_bf16 v[44:47], a[4:7], a[116:119], v[44:47]
v_mfma_f32_16x16x32_bf16 v[44:47], a[8:11], a[120:123], v[44:47]
v_mfma_f32_16x16x32_bf16 v[44:47], a[12:15], a[124:127], v[44:47]
v_mul_f32 v114, v106, v72
v_fma_f32 v114, v107, v73, v114
v_fma_f32 v114, v108, v74, v114
v_fma_f32 v114, v109, v75, v114
v_mfma_f32_16x16x32_bf16 v[48:51], a[0:3], a[128:131], 0
v_mfma_f32_16x16x32_bf16 v[48:51], a[4:7], a[132:135], v[48:51]
v_mfma_f32_16x16x32_bf16 v[48:51], a[8:11], a[136:139], v[48:51]
v_mfma_f32_16x16x32_bf16 v[48:51], a[12:15], a[140:143], v[48:51]
v_min_u32 v114, -2, v114
s_mov_b64 exec, 0xffffffff
buffer_store_dword v114, v93, s[64:67], 0 offen offset:512 sc1
s_mov_b64 exec, -1
v_mul_f32 v110, v98, v40
v_fma_f32 v110, v99, v41, v110
v_fma_f32 v110, v100, v42, v110
v_fma_f32 v110, v101, v43, v110
v_mfma_f32_16x16x32_bf16 v[52:55], a[0:3], a[144:147], 0
v_mfma_f32_16x16x32_bf16 v[52:55], a[4:7], a[148:151], v[52:55]
v_mfma_f32_16x16x32_bf16 v[52:55], a[8:11], a[152:155], v[52:55]
v_mfma_f32_16x16x32_bf16 v[52:55], a[12:15], a[156:159], v[52:55]
v_mul_f32 v111, v98, v44
v_fma_f32 v111, v99, v45, v111
v_fma_f32 v111, v100, v46, v111
v_fma_f32 v111, v101, v47, v111
v_mfma_f32_16x16x32_bf16 v[56:59], a[0:3], a[160:163], 0
v_mfma_f32_16x16x32_bf16 v[56:59], a[4:7], a[164:167], v[56:59]
v_mfma_f32_16x16x32_bf16 v[56:59], a[8:11], a[168:171], v[56:59]
v_mfma_f32_16x16x32_bf16 v[56:59], a[12:15], a[172:175], v[56:59]
v_mul_f32 v112, v98, v48
v_fma_f32 v112, v99, v49, v112
v_fma_f32 v112, v100, v50, v112
v_fma_f32 v112, v101, v51, v112
v_mfma_f32_16x16x32_bf16 v[60:63], a[0:3], a[176:179], 0
v_mfma_f32_16x16x32_bf16 v[60:63], a[4:7], a[180:183], v[60:63]
v_mfma_f32_16x16x32_bf16 v[60:63], a[8:11], a[184:187], v[60:63]
v_mfma_f32_16x16x32_bf16 v[60:63], a[12:15], a[188:191], v[60:63]
v_mul_f32 v113, v98, v52
v_fma_f32 v113, v99, v53, v113
v_fma_f32 v113, v100, v54, v113
v_fma_f32 v113, v101, v55, v113
v_mfma_f32_16x16x32_bf16 v[64:67], a[0:3], a[192:195], 0
v_mfma_f32_16x16x32_bf16 v[64:67], a[4:7], a[196:199], v[64:67]
v_mfma_f32_16x16x32_bf16 v[64:67], a[8:11], a[200:203], v[64:67]
v_mfma_f32_16x16x32_bf16 v[64:67], a[12:15], a[204:207], v[64:67]
v_fma_f32 v110, v102, v56, v110
v_fma_f32 v110, v103, v57, v110
v_fma_f32 v110, v104, v58, v110
v_fma_f32 v110, v105, v59, v110
v_mfma_f32_16x16x32_bf16 v[68:71], a[0:3], a[208:211], 0
v_mfma_f32_16x16x32_bf16 v[68:71], a[4:7], a[212:215], v[68:71]
v_mfma_f32_16x16x32_bf16 v[68:71], a[8:11], a[216:219], v[68:71]
v_mfma_f32_16x16x32_bf16 v[68:71], a[12:15], a[220:223], v[68:71]
v_fma_f32 v111, v102, v60, v111
v_fma_f32 v111, v103, v61, v111
v_fma_f32 v111, v104, v62, v111
v_fma_f32 v111, v105, v63, v111
v_fma_f32 v112, v102, v64, v112
v_fma_f32 v112, v103, v65, v112
v_fma_f32 v112, v104, v66, v112
v_fma_f32 v112, v105, v67, v112
v_min_u32 v110, -2, v110
v_min_u32 v111, -2, v111
v_min_u32 v112, -2, v112
v_fma_f32 v113, v102, v68, v113
v_fma_f32 v113, v103, v69, v113
v_fma_f32 v113, v104, v70, v113
v_fma_f32 v113, v105, v71, v113
v_min_u32 v113, -2, v113
buffer_store_dwordx4 v[110:113], v92, s[64:67], 0 offen sc1
s_endpgm
L_exit:
s_endpgm
B_role:
s_mov_b32 s8, s5
s_lshl_b32 s9, s4, 1
s_add_u32 s9, s9, s8
s_lshr_b32 s10, s9, 4
s_and_b32 s11, s9, 15
v_and_b32 v1, 63, v0
v_lshlrev_b32 v2, 4, v1
v_lshrrev_b32 v9, 4, v1
v_and_b32 v8, 15, v1
s_waitcnt lgkmcnt(0)
s_mul_i32 s6, s3, 288
s_sub_u32 s7, 4608, s6
s_add_u32 s44, s26, s6
s_addc_u32 s45, s27, 0
s_mov_b32 s46, s7
s_mov_b32 s47, 0x20000
s_mul_i32 s6, s3, 1179648
s_lshl_b32 s7, s4, 8
s_add_u32 s6, s6, s7
s_sub_u32 s7, 4718592, s6
s_add_u32 s48, s30, s6
s_addc_u32 s49, s31, 0
s_mov_b32 s50, s7
s_mov_b32 s51, 0x20000
s_lshl_b32 s6, s8, 2
s_add_u32 s6, s6, s3
s_lshl_b32 s6, s6, 19
s_lshl_b32 s7, s4, 8
s_add_u32 s6, s6, s7
s_sub_u32 s7, 4194304, s6
s_add_u32 s76, s32, s6
s_addc_u32 s77, s33, 0
s_mov_b32 s78, s7
s_mov_b32 s79, 0x20000
s_lshl_b32 s6, s10, 22
s_add_u32 s52, s28, s6
s_addc_u32 s53, s29, 0
s_mov_b32 s54, 4194304
s_mov_b32 s55, 0x20000
v_mul_u32_u24 v3, 294912, v9
v_lshl_add_u32 v3, v8, 4, v3
v_mul_u32_u24 v4, 72, v9
v_lshrrev_b32 v6, 3, v8
v_mul_u32_u24 v6, 1152, v6
v_add_u32 v4, v4, v6
v_lshlrev_b32 v220, 17, v9
v_lshl_add_u32 v220, v8, 4, v220
v_xor_b32 v10, 32, v2
s_mov_b32 s64, s42
s_mov_b32 s65, s43
s_mov_b32 s66, 6291456
s_mov_b32 s67, 0x20000
buffer_load_dwordx4 v[24:27], v4, s[44:47], 0 offen offset:0
buffer_load_dwordx4 v[28:31], v4, s[44:47], 0 offen offset:16
buffer_load_dwordx4 v[32:35], v4, s[44:47], 0 offen offset:32
buffer_load_dwordx4 v[36:39], v4, s[44:47], 0 offen offset:48
buffer_load_dwordx2 v[40:41], v4, s[44:47], 0 offen offset:64
buffer_load_dwordx4 v[42:45], v4, s[44:47], 0 offen offset:2304
buffer_load_dwordx4 v[46:49], v4, s[44:47], 0 offen offset:2320
buffer_load_dwordx4 v[50:53], v4, s[44:47], 0 offen offset:2336
buffer_load_dwordx4 v[54:57], v4, s[44:47], 0 offen offset:2352
buffer_load_dwordx2 v[58:59], v4, s[44:47], 0 offen offset:2368
s_cmp_ge_u32 s3, 2
s_cbranch_scc1 L_noclr_15
v_mov_b32 v188, -1
v_mov_b32 v189, -1
v_mov_b32 v190, -1
v_mov_b32 v191, -1
s_cmp_eq_u32 s3, 1
s_cbranch_scc1 L_clr1_16
v_lshrrev_b32 v5, 5, v1
v_lshlrev_b32 v5, 15, v5
v_and_b32 v6, 31, v1
v_lshl_add_u32 v5, v6, 4, v5
s_lshl_b32 s6, s9, 9
s_add_u32 s7, s6, 65536
s_add_u32 s6, s6, 0
buffer_store_dwordx4 v[188:191], v5, s[64:67], s6 offen sc1
buffer_store_dwordx4 v[188:191], v5, s[64:67], s7 offen sc1
s_add_u32 s6, s6, 262144
s_mov_b64 exec, 0xffffffff
buffer_store_dwordx4 v[188:191], v2, s[64:67], s6 offen sc1
s_lshl_b32 s6, s9, 7
s_add_u32 s6, s6, 327680
s_mov_b64 exec, 0xff
buffer_store_dwordx4 v[188:191], v2, s[64:67], s6 offen sc1
s_mul_i32 s6, s9, 16
s_add_u32 s6, s6, 393216
s_mov_b64 exec, 1
buffer_store_dwordx4 v[188:191], v2, s[64:67], s6 offen sc1
s_mov_b64 exec, -1
L_clr1_16:
s_mul_i32 s6, s9, 9216
s_mul_i32 s7, s3, 1048576
s_add_u32 s6, s6, s7
s_add_u32 s6, s6, 4194304
buffer_store_dwordx4 v[188:191], v2, s[64:67], s6 offen offset:0 sc1
buffer_store_dwordx4 v[188:191], v2, s[64:67], s6 offen offset:1024 sc1
buffer_store_dwordx4 v[188:191], v2, s[64:67], s6 offen offset:2048 sc1
buffer_store_dwordx4 v[188:191], v2, s[64:67], s6 offen offset:3072 sc1
s_add_u32 s6, s6, 4096
buffer_store_dwordx4 v[188:191], v2, s[64:67], s6 offen offset:0 sc1
buffer_store_dwordx4 v[188:191], v2, s[64:67], s6 offen offset:1024 sc1
buffer_store_dwordx4 v[188:191], v2, s[64:67], s6 offen offset:2048 sc1
buffer_store_dwordx4 v[188:191], v2, s[64:67], s6 offen offset:3072 sc1
s_add_u32 s6, s6, 4096
buffer_store_dwordx4 v[188:191], v2, s[64:67], s6 offen offset:0 sc1
L_noclr_15:
s_mov_b32 s6, 0
buffer_load_dwordx4 a[96:99], v3, s[48:51], s6 offen
s_mov_b32 s6, 8192
buffer_load_dwordx4 a[100:103], v3, s[48:51], s6 offen
s_mov_b32 s6, 16384
buffer_load_dwordx4 a[104:107], v3, s[48:51], s6 offen
s_mov_b32 s6, 24576
buffer_load_dwordx4 a[108:111], v3, s[48:51], s6 offen
s_mov_b32 s6, 32768
buffer_load_dwordx4 a[112:115], v3, s[48:51], s6 offen
s_mov_b32 s6, 40960
buffer_load_dwordx4 a[116:119], v3, s[48:51], s6 offen
s_mov_b32 s6, 49152
buffer_load_dwordx4 a[120:123], v3, s[48:51], s6 offen
s_mov_b32 s6, 57344
buffer_load_dwordx4 a[124:127], v3, s[48:51], s6 offen
s_mov_b32 s6, 65536
buffer_load_dwordx4 a[128:131], v3, s[48:51], s6 offen
s_mov_b32 s6, 73728
buffer_load_dwordx4 a[132:135], v3, s[48:51], s6 offen
s_mov_b32 s6, 81920
buffer_load_dwordx4 a[136:139], v3, s[48:51], s6 offen
s_mov_b32 s6, 90112
buffer_load_dwordx4 a[140:143], v3, s[48:51], s6 offen
s_mov_b32 s6, 98304
buffer_load_dwordx4 a[144:147], v3, s[48:51], s6 offen
s_mov_b32 s6, 106496
buffer_load_dwordx4 a[148:151], v3, s[48:51], s6 offen
s_mov_b32 s6, 114688
buffer_load_dwordx4 a[152:155], v3, s[48:51], s6 offen
s_mov_b32 s6, 122880
buffer_load_dwordx4 a[156:159], v3, s[48:51], s6 offen
s_mov_b32 s6, 131072
buffer_load_dwordx4 a[160:163], v3, s[48:51], s6 offen
s_mov_b32 s6, 139264
buffer_load_dwordx4 a[164:167], v3, s[48:51], s6 offen
s_mov_b32 s6, 147456
buffer_load_dwordx4 a[168:171], v3, s[48:51], s6 offen
s_mov_b32 s6, 155648
buffer_load_dwordx4 a[172:175], v3, s[48:51], s6 offen
s_mov_b32 s6, 163840
buffer_load_dwordx4 a[176:179], v3, s[48:51], s6 offen
s_mov_b32 s6, 172032
buffer_load_dwordx4 a[180:183], v3, s[48:51], s6 offen
s_mov_b32 s6, 180224
buffer_load_dwordx4 a[184:187], v3, s[48:51], s6 offen
s_mov_b32 s6, 188416
buffer_load_dwordx4 a[188:191], v3, s[48:51], s6 offen
s_mov_b32 s6, 196608
buffer_load_dwordx4 a[192:195], v3, s[48:51], s6 offen
s_mov_b32 s6, 204800
buffer_load_dwordx4 a[196:199], v3, s[48:51], s6 offen
s_mov_b32 s6, 212992
buffer_load_dwordx4 a[200:203], v3, s[48:51], s6 offen
s_mov_b32 s6, 221184
buffer_load_dwordx4 a[204:207], v3, s[48:51], s6 offen
s_mov_b32 s6, 229376
buffer_load_dwordx4 a[208:211], v3, s[48:51], s6 offen
s_mov_b32 s6, 237568
buffer_load_dwordx4 a[212:215], v3, s[48:51], s6 offen
s_mov_b32 s6, 245760
buffer_load_dwordx4 a[216:219], v3, s[48:51], s6 offen
s_mov_b32 s6, 253952
buffer_load_dwordx4 a[220:223], v3, s[48:51], s6 offen
s_mov_b32 s6, 262144
buffer_load_dwordx4 a[224:227], v3, s[48:51], s6 offen
s_mov_b32 s6, 270336
buffer_load_dwordx4 a[228:231], v3, s[48:51], s6 offen
s_mov_b32 s6, 278528
buffer_load_dwordx4 a[232:235], v3, s[48:51], s6 offen
s_mov_b32 s6, 286720
buffer_load_dwordx4 a[236:239], v3, s[48:51], s6 offen
s_mov_b32 s6, 0
buffer_load_dwordx4 v[84:87], v220, s[76:79], s6 offen nt
s_mov_b32 s6, 8192
buffer_load_dwordx4 v[88:91], v220, s[76:79], s6 offen nt
s_mov_b32 s6, 16384
buffer_load_dwordx4 v[92:95], v220, s[76:79], s6 offen nt
s_mov_b32 s68, s40
s_mov_b32 s69, s41
s_mov_b32 s70, 256
s_mov_b32 s71, 0x20000
s_mov_b32 s72, s38
s_mov_b32 s73, s39
s_mov_b32 s74, 9216
s_mov_b32 s75, 0x20000
v_and_b32 v5, 1, v1
v_lshlrev_b32 v5, 4, v5
v_mov_b32 v6, 0xffff
v_lshlrev_b32 v5, v5, v6
v_bfe_u32 v6, v1, 1, 2
v_cmp_eq_u32 vcc, 0, v6
s_nop 1
v_cndmask_b32 v12, 0, v5, vcc
v_cmp_eq_u32 vcc, 1, v6
s_nop 1
v_cndmask_b32 v13, 0, v5, vcc
v_cmp_eq_u32 vcc, 2, v6
s_nop 1
v_cndmask_b32 v14, 0, v5, vcc
v_cmp_eq_u32 vcc, 3, v6
s_nop 1
v_cndmask_b32 v15, 0, v5, vcc
v_mov_b32 v5, 0x0c0c0c0c
s_mov_b32 s6, 0x01000100
s_mov_b32 s7, 0x03020302
v_bfi_b32 v16, v12, s6, v5
v_bfi_b32 v17, v13, s6, v5
v_bfi_b32 v18, v14, s6, v5
v_bfi_b32 v19, v15, s6, v5
v_bfi_b32 v20, v12, s7, v5
v_bfi_b32 v21, v13, s7, v5
v_bfi_b32 v22, v14, s7, v5
v_bfi_b32 v23, v15, s7, v5
s_mul_i32 s12, s3, 17408
s_lshl_b32 s13, s3, 14
s_lshl_b32 s6, s11, 16
s_add_u32 s13, s13, s6
s_lshr_b32 s13, s13, 2
s_waitcnt vmcnt(38)
s_cmp_ge_u32 s3, 2
s_cbranch_scc1 L_sig0_17
v_mov_b32 v7, 1
s_mov_b64 exec, 1
buffer_atomic_add v7, off, s[68:71], 0 offset:0
s_mov_b64 exec, -1
L_sig0_17:
s_mov_b32 s6, 24576
buffer_load_dwordx4 v[96:99], v220, s[76:79], s6 offen nt
s_mov_b32 s6, 32768
buffer_load_dwordx4 v[100:103], v220, s[76:79], s6 offen nt
s_mov_b32 s6, 40960
buffer_load_dwordx4 v[104:107], v220, s[76:79], s6 offen nt
s_mov_b32 s6, 49152
buffer_load_dwordx4 v[108:111], v220, s[76:79], s6 offen nt
s_mov_b32 s6, 57344
buffer_load_dwordx4 v[112:115], v220, s[76:79], s6 offen nt
s_mov_b32 s6, 65536
buffer_load_dwordx4 v[116:119], v220, s[76:79], s6 offen nt
s_mov_b32 s6, 73728
buffer_load_dwordx4 v[120:123], v220, s[76:79], s6 offen nt
s_mov_b32 s6, 81920
buffer_load_dwordx4 v[124:127], v220, s[76:79], s6 offen nt
s_mov_b32 s6, 90112
buffer_load_dwordx4 v[128:131], v220, s[76:79], s6 offen nt
s_mov_b32 s6, 98304
buffer_load_dwordx4 v[132:135], v220, s[76:79], s6 offen nt
s_mov_b32 s6, 106496
buffer_load_dwordx4 v[136:139], v220, s[76:79], s6 offen nt
s_mov_b32 s6, 114688
buffer_load_dwordx4 v[140:143], v220, s[76:79], s6 offen nt
s_mov_b32 s6, 122880
buffer_load_dwordx4 v[144:147], v220, s[76:79], s6 offen nt
v_perm_b32 v60, v24, v24, v16
v_perm_b32 v61, v24, v24, v17
v_perm_b32 v62, v24, v24, v18
v_perm_b32 v63, v24, v24, v19
s_nop 1
v_mfma_f32_16x16x32_bf16 v[76:79], v[60:63], a[96:99], 0
v_perm_b32 v64, v42, v42, v16
v_perm_b32 v65, v42, v42, v17
v_perm_b32 v66, v42, v42, v18
v_perm_b32 v67, v42, v42, v19
s_nop 1
v_mfma_f32_16x16x32_bf16 v[80:83], v[64:67], a[96:99], 0
s_add_u32 m0, s12, 0
s_add_u32 s6, s13, 0
buffer_load_dwordx4 v2, s[52:55], s6 offen nt lds
s_waitcnt vmcnt(51)
v_perm_b32 v68, v24, v24, v20
v_perm_b32 v69, v24, v24, v21
v_perm_b32 v70, v24, v24, v22
v_perm_b32 v71, v24, v24, v23
s_nop 1
v_mfma_f32_16x16x32_bf16 v[76:79], v[68:71], a[100:103], v[76:79]
v_perm_b32 v72, v42, v42, v20
v_perm_b32 v73, v42, v42, v21
v_perm_b32 v74, v42, v42, v22
v_perm_b32 v75, v42, v42, v23
s_nop 1
v_mfma_f32_16x16x32_bf16 v[80:83], v[72:75], a[100:103], v[80:83]
s_add_u32 m0, s12, 1088
s_add_u32 s6, s13, 1024
buffer_load_dwordx4 v2, s[52:55], s6 offen nt lds
s_waitcnt vmcnt(51)
v_perm_b32 v60, v25, v25, v16
v_perm_b32 v61, v25, v25, v17
v_perm_b32 v62, v25, v25, v18
v_perm_b32 v63, v25, v25, v19
s_nop 1
v_mfma_f32_16x16x32_bf16 v[76:79], v[60:63], a[104:107], v[76:79]
v_perm_b32 v64, v43, v43, v16
v_perm_b32 v65, v43, v43, v17
v_perm_b32 v66, v43, v43, v18
v_perm_b32 v67, v43, v43, v19
s_nop 1
v_mfma_f32_16x16x32_bf16 v[80:83], v[64:67], a[104:107], v[80:83]
s_add_u32 m0, s12, 2176
s_add_u32 s6, s13, 2048
buffer_load_dwordx4 v2, s[52:55], s6 offen nt lds
s_waitcnt vmcnt(51)
v_perm_b32 v68, v25, v25, v20
v_perm_b32 v69, v25, v25, v21
v_perm_b32 v70, v25, v25, v22
v_perm_b32 v71, v25, v25, v23
s_nop 1
v_mfma_f32_16x16x32_bf16 v[76:79], v[68:71], a[108:111], v[76:79]
v_perm_b32 v72, v43, v43, v20
v_perm_b32 v73, v43, v43, v21
v_perm_b32 v74, v43, v43, v22
v_perm_b32 v75, v43, v43, v23
s_nop 1
v_mfma_f32_16x16x32_bf16 v[80:83], v[72:75], a[108:111], v[80:83]
s_add_u32 m0, s12, 3264
s_add_u32 s6, s13, 3072
buffer_load_dwordx4 v2, s[52:55], s6 offen nt lds
s_waitcnt vmcnt(51)
v_perm_b32 v60, v26, v26, v16
v_perm_b32 v61, v26, v26, v17
v_perm_b32 v62, v26, v26, v18
v_perm_b32 v63, v26, v26, v19
s_nop 1
v_mfma_f32_16x16x32_bf16 v[76:79], v[60:63], a[112:115], v[76:79]
v_perm_b32 v64, v44, v44, v16
v_perm_b32 v65, v44, v44, v17
v_perm_b32 v66, v44, v44, v18
v_perm_b32 v67, v44, v44, v19
s_nop 1
v_mfma_f32_16x16x32_bf16 v[80:83], v[64:67], a[112:115], v[80:83]
s_add_u32 m0, s12, 4352
s_add_u32 s6, s13, 262144
buffer_load_dwordx4 v2, s[52:55], s6 offen nt lds
s_waitcnt vmcnt(51)
v_perm_b32 v68, v26, v26, v20
v_perm_b32 v69, v26, v26, v21
v_perm_b32 v70, v26, v26, v22
v_perm_b32 v71, v26, v26, v23
s_nop 1
v_mfma_f32_16x16x32_bf16 v[76:79], v[68:71], a[116:119], v[76:79]
v_perm_b32 v72, v44, v44, v20
v_perm_b32 v73, v44, v44, v21
v_perm_b32 v74, v44, v44, v22
v_perm_b32 v75, v44, v44, v23
s_nop 1
v_mfma_f32_16x16x32_bf16 v[80:83], v[72:75], a[116:119], v[80:83]
s_add_u32 m0, s12, 5440
s_add_u32 s6, s13, 263168
buffer_load_dwordx4 v2, s[52:55], s6 offen nt lds
s_waitcnt vmcnt(51)
v_perm_b32 v60, v27, v27, v16
v_perm_b32 v61, v27, v27, v17
v_perm_b32 v62, v27, v27, v18
v_perm_b32 v63, v27, v27, v19
s_nop 1
v_mfma_f32_16x16x32_bf16 v[76:79], v[60:63], a[120:123], v[76:79]
v_perm_b32 v64, v45, v45, v16
v_perm_b32 v65, v45, v45, v17
v_perm_b32 v66, v45, v45, v18
v_perm_b32 v67, v45, v45, v19
s_nop 1
v_mfma_f32_16x16x32_bf16 v[80:83], v[64:67], a[120:123], v[80:83]
s_add_u32 m0, s12, 6528
s_add_u32 s6, s13, 264192
buffer_load_dwordx4 v2, s[52:55], s6 offen nt lds
s_waitcnt vmcnt(51)
v_perm_b32 v68, v27, v27, v20
v_perm_b32 v69, v27, v27, v21
v_perm_b32 v70, v27, v27, v22
v_perm_b32 v71, v27, v27, v23
s_nop 1
v_mfma_f32_16x16x32_bf16 v[76:79], v[68:71], a[124:127], v[76:79]
v_perm_b32 v72, v45, v45, v20
v_perm_b32 v73, v45, v45, v21
v_perm_b32 v74, v45, v45, v22
v_perm_b32 v75, v45, v45, v23
s_nop 1
v_mfma_f32_16x16x32_bf16 v[80:83], v[72:75], a[124:127], v[80:83]
s_add_u32 m0, s12, 7616
s_add_u32 s6, s13, 265216
buffer_load_dwordx4 v2, s[52:55], s6 offen nt lds
s_waitcnt vmcnt(51)
v_perm_b32 v60, v28, v28, v16
v_perm_b32 v61, v28, v28, v17
v_perm_b32 v62, v28, v28, v18
v_perm_b32 v63, v28, v28, v19
s_nop 1
v_mfma_f32_16x16x32_bf16 v[76:79], v[60:63], a[128:131], v[76:79]
v_perm_b32 v64, v46, v46, v16
v_perm_b32 v65, v46, v46, v17
v_perm_b32 v66, v46, v46, v18
v_perm_b32 v67, v46, v46, v19
s_nop 1
v_mfma_f32_16x16x32_bf16 v[80:83], v[64:67], a[128:131], v[80:83]
s_add_u32 m0, s12, 8704
s_add_u32 s6, s13, 524288
buffer_load_dwordx4 v10, s[52:55], s6 offen nt lds
s_waitcnt vmcnt(51)
v_perm_b32 v68, v28, v28, v20
v_perm_b32 v69, v28, v28, v21
v_perm_b32 v70, v28, v28, v22
v_perm_b32 v71, v28, v28, v23
s_nop 1
v_mfma_f32_16x16x32_bf16 v[76:79], v[68:71], a[132:135], v[76:79]
v_perm_b32 v72, v46, v46, v20
v_perm_b32 v73, v46, v46, v21
v_perm_b32 v74, v46, v46, v22
v_perm_b32 v75, v46, v46, v23
s_nop 1
v_mfma_f32_16x16x32_bf16 v[80:83], v[72:75], a[132:135], v[80:83]
s_add_u32 m0, s12, 9792
s_add_u32 s6, s13, 525312
buffer_load_dwordx4 v10, s[52:55], s6 offen nt lds
s_waitcnt vmcnt(51)
v_perm_b32 v60, v29, v29, v16
v_perm_b32 v61, v29, v29, v17
v_perm_b32 v62, v29, v29, v18
v_perm_b32 v63, v29, v29, v19
s_nop 1
v_mfma_f32_16x16x32_bf16 v[76:79], v[60:63], a[136:139], v[76:79]
v_perm_b32 v64, v47, v47, v16
v_perm_b32 v65, v47, v47, v17
v_perm_b32 v66, v47, v47, v18
v_perm_b32 v67, v47, v47, v19
s_nop 1
v_mfma_f32_16x16x32_bf16 v[80:83], v[64:67], a[136:139], v[80:83]
s_add_u32 m0, s12, 10880
s_add_u32 s6, s13, 526336
buffer_load_dwordx4 v10, s[52:55], s6 offen nt lds
s_waitcnt vmcnt(51)
v_perm_b32 v68, v29, v29, v20
v_perm_b32 v69, v29, v29, v21
v_perm_b32 v70, v29, v29, v22
v_perm_b32 v71, v29, v29, v23
s_nop 1
v_mfma_f32_16x16x32_bf16 v[76:79], v[68:71], a[140:143], v[76:79]
v_perm_b32 v72, v47, v47, v20
v_perm_b32 v73, v47, v47, v21
v_perm_b32 v74, v47, v47, v22
v_perm_b32 v75, v47, v47, v23
s_nop 1
v_mfma_f32_16x16x32_bf16 v[80:83], v[72:75], a[140:143], v[80:83]
s_add_u32 m0, s12, 11968
s_add_u32 s6, s13, 527360
buffer_load_dwordx4 v10, s[52:55], s6 offen nt lds
s_waitcnt vmcnt(51)
v_perm_b32 v60, v30, v30, v16
v_perm_b32 v61, v30, v30, v17
v_perm_b32 v62, v30, v30, v18
v_perm_b32 v63, v30, v30, v19
s_nop 1
v_mfma_f32_16x16x32_bf16 v[76:79], v[60:63], a[144:147], v[76:79]
v_perm_b32 v64, v48, v48, v16
v_perm_b32 v65, v48, v48, v17
v_perm_b32 v66, v48, v48, v18
v_perm_b32 v67, v48, v48, v19
s_nop 1
v_mfma_f32_16x16x32_bf16 v[80:83], v[64:67], a[144:147], v[80:83]
s_add_u32 m0, s12, 13056
s_add_u32 s6, s13, 786432
buffer_load_dwordx4 v10, s[52:55], s6 offen nt lds
s_waitcnt vmcnt(51)
v_perm_b32 v68, v30, v30, v20
v_perm_b32 v69, v30, v30, v21
v_perm_b32 v70, v30, v30, v22
v_perm_b32 v71, v30, v30, v23
s_nop 1
v_mfma_f32_16x16x32_bf16 v[76:79], v[68:71], a[148:151], v[76:79]
v_perm_b32 v72, v48, v48, v20
v_perm_b32 v73, v48, v48, v21
v_perm_b32 v74, v48, v48, v22
v_perm_b32 v75, v48, v48, v23
s_nop 1
v_mfma_f32_16x16x32_bf16 v[80:83], v[72:75], a[148:151], v[80:83]
s_add_u32 m0, s12, 14144
s_add_u32 s6, s13, 787456
buffer_load_dwordx4 v10, s[52:55], s6 offen nt lds
s_waitcnt vmcnt(51)
v_perm_b32 v60, v31, v31, v16
v_perm_b32 v61, v31, v31, v17
v_perm_b32 v62, v31, v31, v18
v_perm_b32 v63, v31, v31, v19
s_nop 1
v_mfma_f32_16x16x32_bf16 v[76:79], v[60:63], a[152:155], v[76:79]
v_perm_b32 v64, v49, v49, v16
v_perm_b32 v65, v49, v49, v17
v_perm_b32 v66, v49, v49, v18
v_perm_b32 v67, v49, v49, v19
s_nop 1
v_mfma_f32_16x16x32_bf16 v[80:83], v[64:67], a[152:155], v[80:83]
s_add_u32 m0, s12, 15232
s_add_u32 s6, s13, 788480
buffer_load_dwordx4 v10, s[52:55], s6 offen nt lds
s_waitcnt vmcnt(51)
v_perm_b32 v68, v31, v31, v20
v_perm_b32 v69, v31, v31, v21
v_perm_b32 v70, v31, v31, v22
v_perm_b32 v71, v31, v31, v23
s_nop 1
v_mfma_f32_16x16x32_bf16 v[76:79], v[68:71], a[156:159], v[76:79]
v_perm_b32 v72, v49, v49, v20
v_perm_b32 v73, v49, v49, v21
v_perm_b32 v74, v49, v49, v22
v_perm_b32 v75, v49, v49, v23
s_nop 1
v_mfma_f32_16x16x32_bf16 v[80:83], v[72:75], a[156:159], v[80:83]
s_add_u32 m0, s12, 16320
s_add_u32 s6, s13, 789504
buffer_load_dwordx4 v10, s[52:55], s6 offen nt lds
s_waitcnt vmcnt(51)
v_perm_b32 v60, v32, v32, v16
v_perm_b32 v61, v32, v32, v17
v_perm_b32 v62, v32, v32, v18
v_perm_b32 v63, v32, v32, v19
s_nop 1
v_mfma_f32_16x16x32_bf16 v[76:79], v[60:63], a[160:163], v[76:79]
v_perm_b32 v64, v50, v50, v16
v_perm_b32 v65, v50, v50, v17
v_perm_b32 v66, v50, v50, v18
v_perm_b32 v67, v50, v50, v19
s_nop 1
v_mfma_f32_16x16x32_bf16 v[80:83], v[64:67], a[160:163], v[80:83]
s_add_u32 m0, s12, 69632
s_add_u32 s6, s13, 1048576
buffer_load_dwordx4 v2, s[52:55], s6 offen nt lds
s_waitcnt vmcnt(51)
v_perm_b32 v68, v32, v32, v20
v_perm_b32 v69, v32, v32, v21
v_perm_b32 v70, v32, v32, v22
v_perm_b32 v71, v32, v32, v23
s_nop 1
v_mfma_f32_16x16x32_bf16 v[76:79], v[68:71], a[164:167], v[76:79]
v_perm_b32 v72, v50, v50, v20
v_perm_b32 v73, v50, v50, v21
v_perm_b32 v74, v50, v50, v22
v_perm_b32 v75, v50, v50, v23
s_nop 1
v_mfma_f32_16x16x32_bf16 v[80:83], v[72:75], a[164:167], v[80:83]
s_add_u32 m0, s12, 70720
s_add_u32 s6, s13, 1049600
buffer_load_dwordx4 v2, s[52:55], s6 offen nt lds
s_waitcnt vmcnt(51)
v_perm_b32 v60, v33, v33, v16
v_perm_b32 v61, v33, v33, v17
v_perm_b32 v62, v33, v33, v18
v_perm_b32 v63, v33, v33, v19
s_nop 1
v_mfma_f32_16x16x32_bf16 v[76:79], v[60:63], a[168:171], v[76:79]
v_perm_b32 v64, v51, v51, v16
v_perm_b32 v65, v51, v51, v17
v_perm_b32 v66, v51, v51, v18
v_perm_b32 v67, v51, v51, v19
s_nop 1
v_mfma_f32_16x16x32_bf16 v[80:83], v[64:67], a[168:171], v[80:83]
s_add_u32 m0, s12, 71808
s_add_u32 s6, s13, 1050624
buffer_load_dwordx4 v2, s[52:55], s6 offen nt lds
s_waitcnt vmcnt(51)
v_perm_b32 v68, v33, v33, v20
v_perm_b32 v69, v33, v33, v21
v_perm_b32 v70, v33, v33, v22
v_perm_b32 v71, v33, v33, v23
s_nop 1
v_mfma_f32_16x16x32_bf16 v[76:79], v[68:71], a[172:175], v[76:79]
v_perm_b32 v72, v51, v51, v20
v_perm_b32 v73, v51, v51, v21
v_perm_b32 v74, v51, v51, v22
v_perm_b32 v75, v51, v51, v23
s_nop 1
v_mfma_f32_16x16x32_bf16 v[80:83], v[72:75], a[172:175], v[80:83]
s_add_u32 m0, s12, 72896
s_add_u32 s6, s13, 1051648
buffer_load_dwordx4 v2, s[52:55], s6 offen nt lds
s_waitcnt vmcnt(51)
v_perm_b32 v60, v34, v34, v16
v_perm_b32 v61, v34, v34, v17
v_perm_b32 v62, v34, v34, v18
v_perm_b32 v63, v34, v34, v19
s_nop 1
v_mfma_f32_16x16x32_bf16 v[76:79], v[60:63], a[176:179], v[76:79]
v_perm_b32 v64, v52, v52, v16
v_perm_b32 v65, v52, v52, v17
v_perm_b32 v66, v52, v52, v18
v_perm_b32 v67, v52, v52, v19
s_nop 1
v_mfma_f32_16x16x32_bf16 v[80:83], v[64:67], a[176:179], v[80:83]
s_add_u32 m0, s12, 73984
s_add_u32 s6, s13, 1310720
buffer_load_dwordx4 v2, s[52:55], s6 offen nt lds
s_waitcnt vmcnt(51)
v_perm_b32 v68, v34, v34, v20
v_perm_b32 v69, v34, v34, v21
v_perm_b32 v70, v34, v34, v22
v_perm_b32 v71, v34, v34, v23
s_nop 1
v_mfma_f32_16x16x32_bf16 v[76:79], v[68:71], a[180:183], v[76:79]
v_perm_b32 v72, v52, v52, v20
v_perm_b32 v73, v52, v52, v21
v_perm_b32 v74, v52, v52, v22
v_perm_b32 v75, v52, v52, v23
s_nop 1
v_mfma_f32_16x16x32_bf16 v[80:83], v[72:75], a[180:183], v[80:83]
s_add_u32 m0, s12, 75072
s_add_u32 s6, s13, 1311744
buffer_load_dwordx4 v2, s[52:55], s6 offen nt lds
s_waitcnt vmcnt(51)
v_perm_b32 v60, v35, v35, v16
v_perm_b32 v61, v35, v35, v17
v_perm_b32 v62, v35, v35, v18
v_perm_b32 v63, v35, v35, v19
s_nop 1
v_mfma_f32_16x16x32_bf16 v[76:79], v[60:63], a[184:187], v[76:79]
v_perm_b32 v64, v53, v53, v16
v_perm_b32 v65, v53, v53, v17
v_perm_b32 v66, v53, v53, v18
v_perm_b32 v67, v53, v53, v19
s_nop 1
v_mfma_f32_16x16x32_bf16 v[80:83], v[64:67], a[184:187], v[80:83]
s_add_u32 m0, s12, 76160
s_add_u32 s6, s13, 1312768
buffer_load_dwordx4 v2, s[52:55], s6 offen nt lds
s_waitcnt vmcnt(51)
v_perm_b32 v68, v35, v35, v20
v_perm_b32 v69, v35, v35, v21
v_perm_b32 v70, v35, v35, v22
v_perm_b32 v71, v35, v35, v23
s_nop 1
v_mfma_f32_16x16x32_bf16 v[76:79], v[68:71], a[188:191], v[76:79]
v_perm_b32 v72, v53, v53, v20
v_perm_b32 v73, v53, v53, v21
v_perm_b32 v74, v53, v53, v22
v_perm_b32 v75, v53, v53, v23
s_nop 1
v_mfma_f32_16x16x32_bf16 v[80:83], v[72:75], a[188:191], v[80:83]
s_add_u32 m0, s12, 77248
s_add_u32 s6, s13, 1313792
buffer_load_dwordx4 v2, s[52:55], s6 offen nt lds
s_waitcnt vmcnt(51)
v_perm_b32 v60, v36, v36, v16
v_perm_b32 v61, v36, v36, v17
v_perm_b32 v62, v36, v36, v18
v_perm_b32 v63, v36, v36, v19
s_nop 1
v_mfma_f32_16x16x32_bf16 v[76:79], v[60:63], a[192:195], v[76:79]
v_perm_b32 v64, v54, v54, v16
v_perm_b32 v65, v54, v54, v17
v_perm_b32 v66, v54, v54, v18
v_perm_b32 v67, v54, v54, v19
s_nop 1
v_mfma_f32_16x16x32_bf16 v[80:83], v[64:67], a[192:195], v[80:83]
s_add_u32 m0, s12, 78336
s_add_u32 s6, s13, 1572864
buffer_load_dwordx4 v10, s[52:55], s6 offen nt lds
s_waitcnt vmcnt(51)
v_perm_b32 v68, v36, v36, v20
v_perm_b32 v69, v36, v36, v21
v_perm_b32 v70, v36, v36, v22
v_perm_b32 v71, v36, v36, v23
s_nop 1
v_mfma_f32_16x16x32_bf16 v[76:79], v[68:71], a[196:199], v[76:79]
v_perm_b32 v72, v54, v54, v20
v_perm_b32 v73, v54, v54, v21
v_perm_b32 v74, v54, v54, v22
v_perm_b32 v75, v54, v54, v23
s_nop 1
v_mfma_f32_16x16x32_bf16 v[80:83], v[72:75], a[196:199], v[80:83]
s_add_u32 m0, s12, 79424
s_add_u32 s6, s13, 1573888
buffer_load_dwordx4 v10, s[52:55], s6 offen nt lds
s_waitcnt vmcnt(51)
v_perm_b32 v60, v37, v37, v16
v_perm_b32 v61, v37, v37, v17
v_perm_b32 v62, v37, v37, v18
v_perm_b32 v63, v37, v37, v19
s_nop 1
v_mfma_f32_16x16x32_bf16 v[76:79], v[60:63], a[200:203], v[76:79]
v_perm_b32 v64, v55, v55, v16
v_perm_b32 v65, v55, v55, v17
v_perm_b32 v66, v55, v55, v18
v_perm_b32 v67, v55, v55, v19
s_nop 1
v_mfma_f32_16x16x32_bf16 v[80:83], v[64:67], a[200:203], v[80:83]
s_add_u32 m0, s12, 80512
s_add_u32 s6, s13, 1574912
buffer_load_dwordx4 v10, s[52:55], s6 offen nt lds
s_waitcnt vmcnt(51)
v_perm_b32 v68, v37, v37, v20
v_perm_b32 v69, v37, v37, v21
v_perm_b32 v70, v37, v37, v22
v_perm_b32 v71, v37, v37, v23
s_nop 1
v_mfma_f32_16x16x32_bf16 v[76:79], v[68:71], a[204:207], v[76:79]
v_perm_b32 v72, v55, v55, v20
v_perm_b32 v73, v55, v55, v21
v_perm_b32 v74, v55, v55, v22
v_perm_b32 v75, v55, v55, v23
s_nop 1
v_mfma_f32_16x16x32_bf16 v[80:83], v[72:75], a[204:207], v[80:83]
s_add_u32 m0, s12, 81600
s_add_u32 s6, s13, 1575936
buffer_load_dwordx4 v10, s[52:55], s6 offen nt lds
s_waitcnt vmcnt(51)
v_perm_b32 v60, v38, v38, v16
v_perm_b32 v61, v38, v38, v17
v_perm_b32 v62, v38, v38, v18
v_perm_b32 v63, v38, v38, v19
s_nop 1
v_mfma_f32_16x16x32_bf16 v[76:79], v[60:63], a[208:211], v[76:79]
v_perm_b32 v64, v56, v56, v16
v_perm_b32 v65, v56, v56, v17
v_perm_b32 v66, v56, v56, v18
v_perm_b32 v67, v56, v56, v19
s_nop 1
v_mfma_f32_16x16x32_bf16 v[80:83], v[64:67], a[208:211], v[80:83]
buffer_load_dword v11, off, s[68:71], 0 offset:0 sc1
s_add_u32 m0, s12, 82688
s_add_u32 s6, s13, 1835008
buffer_load_dwordx4 v10, s[52:55], s6 offen nt lds
s_waitcnt vmcnt(52)
v_perm_b32 v68, v38, v38, v20
v_perm_b32 v69, v38, v38, v21
v_perm_b32 v70, v38, v38, v22
v_perm_b32 v71, v38, v38, v23
s_nop 1
v_mfma_f32_16x16x32_bf16 v[76:79], v[68:71], a[212:215], v[76:79]
v_perm_b32 v72, v56, v56, v20
v_perm_b32 v73, v56, v56, v21
v_perm_b32 v74, v56, v56, v22
v_perm_b32 v75, v56, v56, v23
s_nop 1
v_mfma_f32_16x16x32_bf16 v[80:83], v[72:75], a[212:215], v[80:83]
s_add_u32 m0, s12, 83776
s_add_u32 s6, s13, 1836032
buffer_load_dwordx4 v10, s[52:55], s6 offen nt lds
s_waitcnt vmcnt(52)
v_perm_b32 v60, v39, v39, v16
v_perm_b32 v61, v39, v39, v17
v_perm_b32 v62, v39, v39, v18
v_perm_b32 v63, v39, v39, v19
s_nop 1
v_mfma_f32_16x16x32_bf16 v[76:79], v[60:63], a[216:219], v[76:79]
v_perm_b32 v64, v57, v57, v16
v_perm_b32 v65, v57, v57, v17
v_perm_b32 v66, v57, v57, v18
v_perm_b32 v67, v57, v57, v19
s_nop 1
v_mfma_f32_16x16x32_bf16 v[80:83], v[64:67], a[216:219], v[80:83]
s_add_u32 m0, s12, 84864
s_add_u32 s6, s13, 1837056
buffer_load_dwordx4 v10, s[52:55], s6 offen nt lds
s_waitcnt vmcnt(52)
v_perm_b32 v68, v39, v39, v20
v_perm_b32 v69, v39, v39, v21
v_perm_b32 v70, v39, v39, v22
v_perm_b32 v71, v39, v39, v23
s_nop 1
v_mfma_f32_16x16x32_bf16 v[76:79], v[68:71], a[220:223], v[76:79]
v_perm_b32 v72, v57, v57, v20
v_perm_b32 v73, v57, v57, v21
v_perm_b32 v74, v57, v57, v22
v_perm_b32 v75, v57, v57, v23
s_nop 1
v_mfma_f32_16x16x32_bf16 v[80:83], v[72:75], a[220:223], v[80:83]
s_add_u32 m0, s12, 85952
s_add_u32 s6, s13, 1838080
buffer_load_dwordx4 v10, s[52:55], s6 offen nt lds
s_waitcnt vmcnt(52)
v_perm_b32 v60, v40, v40, v16
v_perm_b32 v61, v40, v40, v17
v_perm_b32 v62, v40, v40, v18
v_perm_b32 v63, v40, v40, v19
s_nop 1
v_mfma_f32_16x16x32_bf16 v[76:79], v[60:63], a[224:227], v[76:79]
v_perm_b32 v64, v58, v58, v16
v_perm_b32 v65, v58, v58, v17
v_perm_b32 v66, v58, v58, v18
v_perm_b32 v67, v58, v58, v19
s_nop 1
v_mfma_f32_16x16x32_bf16 v[80:83], v[64:67], a[224:227], v[80:83]
s_waitcnt vmcnt(51)
v_perm_b32 v68, v40, v40, v20
v_perm_b32 v69, v40, v40, v21
v_perm_b32 v70, v40, v40, v22
v_perm_b32 v71, v40, v40, v23
s_nop 1
v_mfma_f32_16x16x32_bf16 v[76:79], v[68:71], a[228:231], v[76:79]
v_perm_b32 v72, v58, v58, v20
v_perm_b32 v73, v58, v58, v21
v_perm_b32 v74, v58, v58, v22
v_perm_b32 v75, v58, v58, v23
s_nop 1
v_mfma_f32_16x16x32_bf16 v[80:83], v[72:75], a[228:231], v[80:83]
s_waitcnt vmcnt(50)
v_perm_b32 v60, v41, v41, v16
v_perm_b32 v61, v41, v41, v17
v_perm_b32 v62, v41, v41, v18
v_perm_b32 v63, v41, v41, v19
s_nop 1
v_mfma_f32_16x16x32_bf16 v[76:79], v[60:63], a[232:235], v[76:79]
v_perm_b32 v64, v59, v59, v16
v_perm_b32 v65, v59, v59, v17
v_perm_b32 v66, v59, v59, v18
v_perm_b32 v67, v59, v59, v19
s_nop 1
v_mfma_f32_16x16x32_bf16 v[80:83], v[64:67], a[232:235], v[80:83]
s_waitcnt vmcnt(49)
v_perm_b32 v68, v41, v41, v20
v_perm_b32 v69, v41, v41, v21
v_perm_b32 v70, v41, v41, v22
v_perm_b32 v71, v41, v41, v23
s_nop 1
v_mfma_f32_16x16x32_bf16 v[76:79], v[68:71], a[236:239], v[76:79]
v_perm_b32 v72, v59, v59, v20
v_perm_b32 v73, v59, v59, v21
v_perm_b32 v74, v59, v59, v22
v_perm_b32 v75, v59, v59, v23
s_nop 1
v_mfma_f32_16x16x32_bf16 v[80:83], v[72:75], a[236:239], v[80:83]
v_lshlrev_b32 v5, 5, v8
v_and_b32 v6, 1, v9
v_lshl_add_u32 v6, v6, 4, v5
v_lshrrev_b32 v7, 5, v1
v_lshl_add_u32 v6, v7, 9, v6
s_lshl_b32 s6, s3, 11
s_add_u32 s6, s6, 139264
v_add_u32 v6, s6, v6
ds_write_b128 v6, v[76:79]
ds_write_b128 v6, v[80:83] offset:1024
v_add_u32 v5, 139264, v5
s_waitcnt lgkmcnt(0)
s_barrier
ds_read_b128 v[188:191], v5 offset:0
ds_read_b128 v[192:195], v5 offset:16
ds_read_b128 v[196:199], v5 offset:2048
ds_read_b128 v[200:203], v5 offset:2064
ds_read_b128 v[204:207], v5 offset:4096
ds_read_b128 v[208:211], v5 offset:4112
ds_read_b128 v[212:215], v5 offset:6144
ds_read_b128 v[216:219], v5 offset:6160
s_waitcnt lgkmcnt(0)
v_add_f32 v188, v188, v196
v_add_f32 v204, v204, v212
v_add_f32 v189, v189, v197
v_add_f32 v205, v205, v213
v_add_f32 v190, v190, v198
v_add_f32 v206, v206, v214
v_add_f32 v191, v191, v199
v_add_f32 v207, v207, v215
v_add_f32 v192, v192, v200
v_add_f32 v208, v208, v216
v_add_f32 v193, v193, v201
v_add_f32 v209, v209, v217
v_add_f32 v194, v194, v202
v_add_f32 v210, v210, v218
v_add_f32 v195, v195, v203
v_add_f32 v211, v211, v219
v_add_f32 v188, v188, v204
v_add_f32 v189, v189, v205
v_add_f32 v190, v190, v206
v_add_f32 v191, v191, v207
v_add_f32 v192, v192, v208
v_add_f32 v193, v193, v209
v_add_f32 v194, v194, v210
v_add_f32 v195, v195, v211
v_cvt_pk_bf16_f32 v148, v188, v189
v_cvt_pk_bf16_f32 v149, v190, v191
v_cvt_pk_bf16_f32 v150, v192, v193
v_cvt_pk_bf16_f32 v151, v194, v195
ds_read_b128 v[188:191], v5 offset:512
ds_read_b128 v[192:195], v5 offset:528
ds_read_b128 v[196:199], v5 offset:2560
ds_read_b128 v[200:203], v5 offset:2576
ds_read_b128 v[204:207], v5 offset:4608
ds_read_b128 v[208:211], v5 offset:4624
ds_read_b128 v[212:215], v5 offset:6656
ds_read_b128 v[216:219], v5 offset:6672
s_waitcnt lgkmcnt(0)
v_add_f32 v188, v188, v196
v_add_f32 v204, v204, v212
v_add_f32 v189, v189, v197
v_add_f32 v205, v205, v213
v_add_f32 v190, v190, v198
v_add_f32 v206, v206, v214
v_add_f32 v191, v191, v199
v_add_f32 v207, v207, v215
v_add_f32 v192, v192, v200
v_add_f32 v208, v208, v216
v_add_f32 v193, v193, v201
v_add_f32 v209, v209, v217
v_add_f32 v194, v194, v202
v_add_f32 v210, v210, v218
v_add_f32 v195, v195, v203
v_add_f32 v211, v211, v219
v_add_f32 v188, v188, v204
v_add_f32 v189, v189, v205
v_add_f32 v190, v190, v206
v_add_f32 v191, v191, v207
v_add_f32 v192, v192, v208
v_add_f32 v193, v193, v209
v_add_f32 v194, v194, v210
v_add_f32 v195, v195, v211
v_cvt_pk_bf16_f32 v152, v188, v189
v_cvt_pk_bf16_f32 v153, v190, v191
v_cvt_pk_bf16_f32 v154, v192, v193
v_cvt_pk_bf16_f32 v155, v194, v195
ds_read_b128 v[188:191], v5 offset:1024
ds_read_b128 v[192:195], v5 offset:1040
ds_read_b128 v[196:199], v5 offset:3072
ds_read_b128 v[200:203], v5 offset:3088
ds_read_b128 v[204:207], v5 offset:5120
ds_read_b128 v[208:211], v5 offset:5136
ds_read_b128 v[212:215], v5 offset:7168
ds_read_b128 v[216:219], v5 offset:7184
s_waitcnt lgkmcnt(0)
v_add_f32 v188, v188, v196
v_add_f32 v204, v204, v212
v_add_f32 v189, v189, v197
v_add_f32 v205, v205, v213
v_add_f32 v190, v190, v198
v_add_f32 v206, v206, v214
v_add_f32 v191, v191, v199
v_add_f32 v207, v207, v215
v_add_f32 v192, v192, v200
v_add_f32 v208, v208, v216
v_add_f32 v193, v193, v201
v_add_f32 v209, v209, v217
v_add_f32 v194, v194, v202
v_add_f32 v210, v210, v218
v_add_f32 v195, v195, v203
v_add_f32 v211, v211, v219
v_add_f32 v188, v188, v204
v_add_f32 v189, v189, v205
v_add_f32 v190, v190, v206
v_add_f32 v191, v191, v207
v_add_f32 v192, v192, v208
v_add_f32 v193, v193, v209
v_add_f32 v194, v194, v210
v_add_f32 v195, v195, v211
v_cvt_pk_bf16_f32 v156, v188, v189
v_cvt_pk_bf16_f32 v157, v190, v191
v_cvt_pk_bf16_f32 v158, v192, v193
v_cvt_pk_bf16_f32 v159, v194, v195
ds_read_b128 v[188:191], v5 offset:1536
ds_read_b128 v[192:195], v5 offset:1552
ds_read_b128 v[196:199], v5 offset:3584
ds_read_b128 v[200:203], v5 offset:3600
ds_read_b128 v[204:207], v5 offset:5632
ds_read_b128 v[208:211], v5 offset:5648
ds_read_b128 v[212:215], v5 offset:7680
ds_read_b128 v[216:219], v5 offset:7696
s_waitcnt lgkmcnt(0)
v_add_f32 v188, v188, v196
v_add_f32 v204, v204, v212
v_add_f32 v189, v189, v197
v_add_f32 v205, v205, v213
v_add_f32 v190, v190, v198
v_add_f32 v206, v206, v214
v_add_f32 v191, v191, v199
v_add_f32 v207, v207, v215
v_add_f32 v192, v192, v200
v_add_f32 v208, v208, v216
v_add_f32 v193, v193, v201
v_add_f32 v209, v209, v217
v_add_f32 v194, v194, v202
v_add_f32 v210, v210, v218
v_add_f32 v195, v195, v203
v_add_f32 v211, v211, v219
v_add_f32 v188, v188, v204
v_add_f32 v189, v189, v205
v_add_f32 v190, v190, v206
v_add_f32 v191, v191, v207
v_add_f32 v192, v192, v208
v_add_f32 v193, v193, v209
v_add_f32 v194, v194, v210
v_add_f32 v195, v195, v211
v_cvt_pk_bf16_f32 v160, v188, v189
v_cvt_pk_bf16_f32 v161, v190, v191
v_cvt_pk_bf16_f32 v162, v192, v193
v_cvt_pk_bf16_f32 v163, v194, v195
s_waitcnt vmcnt(33)
v_dot2_f32_bf16 v164, v84, v148, 0
v_dot2_f32_bf16 v165, v84, v152, 0
v_dot2_f32_bf16 v166, v84, v156, 0
v_dot2_f32_bf16 v167, v84, v160, 0
v_dot2_f32_bf16 v164, v85, v149, v164
v_dot2_f32_bf16 v165, v85, v153, v165
v_dot2_f32_bf16 v166, v85, v157, v166
v_dot2_f32_bf16 v167, v85, v161, v167
v_dot2_f32_bf16 v164, v86, v150, v164
v_dot2_f32_bf16 v165, v86, v154, v165
v_dot2_f32_bf16 v166, v86, v158, v166
v_dot2_f32_bf16 v167, v86, v162, v167
v_dot2_f32_bf16 v164, v87, v151, v164
v_dot2_f32_bf16 v165, v87, v155, v165
v_dot2_f32_bf16 v166, v87, v159, v166
v_dot2_f32_bf16 v167, v87, v163, v167
v_add_f32_dpp v168, v164, v164 row_ror:8 row_mask:0xf bank_mask:0x3
v_add_f32_dpp v169, v165, v165 row_ror:8 row_mask:0xf bank_mask:0x3
v_add_f32_dpp v168, v166, v166 row_ror:8 row_mask:0xf bank_mask:0xc
v_add_f32_dpp v169, v167, v167 row_ror:8 row_mask:0xf bank_mask:0xc
s_nop 0
v_add_f32_dpp v172, v168, v168 row_half_mirror row_mask:0xf bank_mask:0x5
v_add_f32_dpp v172, v169, v169 row_half_mirror row_mask:0xf bank_mask:0xa
s_nop 1
v_add_f32_dpp v172, v172, v172 quad_perm:[1,0,3,2] row_mask:0xf bank_mask:0xf
s_nop 1
v_add_f32_dpp v172, v172, v172 quad_perm:[2,3,0,1] row_mask:0xf bank_mask:0xf
v_dot2_f32_bf16 v164, v88, v148, 0
v_dot2_f32_bf16 v165, v88, v152, 0
v_dot2_f32_bf16 v166, v88, v156, 0
v_dot2_f32_bf16 v167, v88, v160, 0
v_dot2_f32_bf16 v164, v89, v149, v164
v_dot2_f32_bf16 v165, v89, v153, v165
v_dot2_f32_bf16 v166, v89, v157, v166
v_dot2_f32_bf16 v167, v89, v161, v167
v_dot2_f32_bf16 v164, v90, v150, v164
v_dot2_f32_bf16 v165, v90, v154, v165
v_dot2_f32_bf16 v166, v90, v158, v166
v_dot2_f32_bf16 v167, v90, v162, v167
v_dot2_f32_bf16 v164, v91, v151, v164
v_dot2_f32_bf16 v165, v91, v155, v165
v_dot2_f32_bf16 v166, v91, v159, v166
v_dot2_f32_bf16 v167, v91, v163, v167
v_add_f32_dpp v168, v164, v164 row_ror:8 row_mask:0xf bank_mask:0x3
v_add_f32_dpp v169, v165, v165 row_ror:8 row_mask:0xf bank_mask:0x3
v_add_f32_dpp v168, v166, v166 row_ror:8 row_mask:0xf bank_mask:0xc
v_add_f32_dpp v169, v167, v167 row_ror:8 row_mask:0xf bank_mask:0xc
s_nop 0
v_add_f32_dpp v173, v168, v168 row_half_mirror row_mask:0xf bank_mask:0x5
v_add_f32_dpp v173, v169, v169 row_half_mirror row_mask:0xf bank_mask:0xa
s_nop 1
v_add_f32_dpp v173, v173, v173 quad_perm:[1,0,3,2] row_mask:0xf bank_mask:0xf
s_nop 1
v_add_f32_dpp v173, v173, v173 quad_perm:[2,3,0,1] row_mask:0xf bank_mask:0xf
v_dot2_f32_bf16 v164, v92, v148, 0
v_dot2_f32_bf16 v165, v92, v152, 0
v_dot2_f32_bf16 v166, v92, v156, 0
v_dot2_f32_bf16 v167, v92, v160, 0
v_dot2_f32_bf16 v164, v93, v149, v164
v_dot2_f32_bf16 v165, v93, v153, v165
v_dot2_f32_bf16 v166, v93, v157, v166
v_dot2_f32_bf16 v167, v93, v161, v167
v_dot2_f32_bf16 v164, v94, v150, v164
v_dot2_f32_bf16 v165, v94, v154, v165
v_dot2_f32_bf16 v166, v94, v158, v166
v_dot2_f32_bf16 v167, v94, v162, v167
v_dot2_f32_bf16 v164, v95, v151, v164
v_dot2_f32_bf16 v165, v95, v155, v165
v_dot2_f32_bf16 v166, v95, v159, v166
v_dot2_f32_bf16 v167, v95, v163, v167
v_add_f32_dpp v168, v164, v164 row_ror:8 row_mask:0xf bank_mask:0x3
v_add_f32_dpp v169, v165, v165 row_ror:8 row_mask:0xf bank_mask:0x3
v_add_f32_dpp v168, v166, v166 row_ror:8 row_mask:0xf bank_mask:0xc
v_add_f32_dpp v169, v167, v167 row_ror:8 row_mask:0xf bank_mask:0xc
s_nop 0
v_add_f32_dpp v174, v168, v168 row_half_mirror row_mask:0xf bank_mask:0x5
v_add_f32_dpp v174, v169, v169 row_half_mirror row_mask:0xf bank_mask:0xa
s_nop 1
v_add_f32_dpp v174, v174, v174 quad_perm:[1,0,3,2] row_mask:0xf bank_mask:0xf
s_nop 1
v_add_f32_dpp v174, v174, v174 quad_perm:[2,3,0,1] row_mask:0xf bank_mask:0xf
v_dot2_f32_bf16 v164, v96, v148, 0
v_dot2_f32_bf16 v165, v96, v152, 0
v_dot2_f32_bf16 v166, v96, v156, 0
v_dot2_f32_bf16 v167, v96, v160, 0
v_dot2_f32_bf16 v164, v97, v149, v164
v_dot2_f32_bf16 v165, v97, v153, v165
v_dot2_f32_bf16 v166, v97, v157, v166
v_dot2_f32_bf16 v167, v97, v161, v167
v_dot2_f32_bf16 v164, v98, v150, v164
v_dot2_f32_bf16 v165, v98, v154, v165
v_dot2_f32_bf16 v166, v98, v158, v166
v_dot2_f32_bf16 v167, v98, v162, v167
v_dot2_f32_bf16 v164, v99, v151, v164
v_dot2_f32_bf16 v165, v99, v155, v165
v_dot2_f32_bf16 v166, v99, v159, v166
v_dot2_f32_bf16 v167, v99, v163, v167
v_add_f32_dpp v168, v164, v164 row_ror:8 row_mask:0xf bank_mask:0x3
v_add_f32_dpp v169, v165, v165 row_ror:8 row_mask:0xf bank_mask:0x3
v_add_f32_dpp v168, v166, v166 row_ror:8 row_mask:0xf bank_mask:0xc
v_add_f32_dpp v169, v167, v167 row_ror:8 row_mask:0xf bank_mask:0xc
s_nop 0
v_add_f32_dpp v175, v168, v168 row_half_mirror row_mask:0xf bank_mask:0x5
v_add_f32_dpp v175, v169, v169 row_half_mirror row_mask:0xf bank_mask:0xa
s_nop 1
v_add_f32_dpp v175, v175, v175 quad_perm:[1,0,3,2] row_mask:0xf bank_mask:0xf
s_nop 1
v_add_f32_dpp v175, v175, v175 quad_perm:[2,3,0,1] row_mask:0xf bank_mask:0xf
v_dot2_f32_bf16 v164, v100, v148, 0
v_dot2_f32_bf16 v165, v100, v152, 0
v_dot2_f32_bf16 v166, v100, v156, 0
v_dot2_f32_bf16 v167, v100, v160, 0
v_dot2_f32_bf16 v164, v101, v149, v164
v_dot2_f32_bf16 v165, v101, v153, v165
v_dot2_f32_bf16 v166, v101, v157, v166
v_dot2_f32_bf16 v167, v101, v161, v167
v_dot2_f32_bf16 v164, v102, v150, v164
v_dot2_f32_bf16 v165, v102, v154, v165
v_dot2_f32_bf16 v166, v102, v158, v166
v_dot2_f32_bf16 v167, v102, v162, v167
v_dot2_f32_bf16 v164, v103, v151, v164
v_dot2_f32_bf16 v165, v103, v155, v165
v_dot2_f32_bf16 v166, v103, v159, v166
v_dot2_f32_bf16 v167, v103, v163, v167
v_add_f32_dpp v168, v164, v164 row_ror:8 row_mask:0xf bank_mask:0x3
v_add_f32_dpp v169, v165, v165 row_ror:8 row_mask:0xf bank_mask:0x3
v_add_f32_dpp v168, v166, v166 row_ror:8 row_mask:0xf bank_mask:0xc
v_add_f32_dpp v169, v167, v167 row_ror:8 row_mask:0xf bank_mask:0xc
s_nop 0
v_add_f32_dpp v176, v168, v168 row_half_mirror row_mask:0xf bank_mask:0x5
v_add_f32_dpp v176, v169, v169 row_half_mirror row_mask:0xf bank_mask:0xa
s_nop 1
v_add_f32_dpp v176, v176, v176 quad_perm:[1,0,3,2] row_mask:0xf bank_mask:0xf
s_nop 1
v_add_f32_dpp v176, v176, v176 quad_perm:[2,3,0,1] row_mask:0xf bank_mask:0xf
v_dot2_f32_bf16 v164, v104, v148, 0
v_dot2_f32_bf16 v165, v104, v152, 0
v_dot2_f32_bf16 v166, v104, v156, 0
v_dot2_f32_bf16 v167, v104, v160, 0
v_dot2_f32_bf16 v164, v105, v149, v164
v_dot2_f32_bf16 v165, v105, v153, v165
v_dot2_f32_bf16 v166, v105, v157, v166
v_dot2_f32_bf16 v167, v105, v161, v167
v_dot2_f32_bf16 v164, v106, v150, v164
v_dot2_f32_bf16 v165, v106, v154, v165
v_dot2_f32_bf16 v166, v106, v158, v166
v_dot2_f32_bf16 v167, v106, v162, v167
v_dot2_f32_bf16 v164, v107, v151, v164
v_dot2_f32_bf16 v165, v107, v155, v165
v_dot2_f32_bf16 v166, v107, v159, v166
v_dot2_f32_bf16 v167, v107, v163, v167
v_add_f32_dpp v168, v164, v164 row_ror:8 row_mask:0xf bank_mask:0x3
v_add_f32_dpp v169, v165, v165 row_ror:8 row_mask:0xf bank_mask:0x3
v_add_f32_dpp v168, v166, v166 row_ror:8 row_mask:0xf bank_mask:0xc
v_add_f32_dpp v169, v167, v167 row_ror:8 row_mask:0xf bank_mask:0xc
s_nop 0
v_add_f32_dpp v177, v168, v168 row_half_mirror row_mask:0xf bank_mask:0x5
v_add_f32_dpp v177, v169, v169 row_half_mirror row_mask:0xf bank_mask:0xa
s_nop 1
v_add_f32_dpp v177, v177, v177 quad_perm:[1,0,3,2] row_mask:0xf bank_mask:0xf
s_nop 1
v_add_f32_dpp v177, v177, v177 quad_perm:[2,3,0,1] row_mask:0xf bank_mask:0xf
v_dot2_f32_bf16 v164, v108, v148, 0
v_dot2_f32_bf16 v165, v108, v152, 0
v_dot2_f32_bf16 v166, v108, v156, 0
v_dot2_f32_bf16 v167, v108, v160, 0
v_dot2_f32_bf16 v164, v109, v149, v164
v_dot2_f32_bf16 v165, v109, v153, v165
v_dot2_f32_bf16 v166, v109, v157, v166
v_dot2_f32_bf16 v167, v109, v161, v167
v_dot2_f32_bf16 v164, v110, v150, v164
v_dot2_f32_bf16 v165, v110, v154, v165
v_dot2_f32_bf16 v166, v110, v158, v166
v_dot2_f32_bf16 v167, v110, v162, v167
v_dot2_f32_bf16 v164, v111, v151, v164
v_dot2_f32_bf16 v165, v111, v155, v165
v_dot2_f32_bf16 v166, v111, v159, v166
v_dot2_f32_bf16 v167, v111, v163, v167
v_add_f32_dpp v168, v164, v164 row_ror:8 row_mask:0xf bank_mask:0x3
v_add_f32_dpp v169, v165, v165 row_ror:8 row_mask:0xf bank_mask:0x3
v_add_f32_dpp v168, v166, v166 row_ror:8 row_mask:0xf bank_mask:0xc
v_add_f32_dpp v169, v167, v167 row_ror:8 row_mask:0xf bank_mask:0xc
s_nop 0
v_add_f32_dpp v178, v168, v168 row_half_mirror row_mask:0xf bank_mask:0x5
v_add_f32_dpp v178, v169, v169 row_half_mirror row_mask:0xf bank_mask:0xa
s_nop 1
v_add_f32_dpp v178, v178, v178 quad_perm:[1,0,3,2] row_mask:0xf bank_mask:0xf
s_nop 1
v_add_f32_dpp v178, v178, v178 quad_perm:[2,3,0,1] row_mask:0xf bank_mask:0xf
v_dot2_f32_bf16 v164, v112, v148, 0
v_dot2_f32_bf16 v165, v112, v152, 0
v_dot2_f32_bf16 v166, v112, v156, 0
v_dot2_f32_bf16 v167, v112, v160, 0
v_dot2_f32_bf16 v164, v113, v149, v164
v_dot2_f32_bf16 v165, v113, v153, v165
v_dot2_f32_bf16 v166, v113, v157, v166
v_dot2_f32_bf16 v167, v113, v161, v167
v_dot2_f32_bf16 v164, v114, v150, v164
v_dot2_f32_bf16 v165, v114, v154, v165
v_dot2_f32_bf16 v166, v114, v158, v166
v_dot2_f32_bf16 v167, v114, v162, v167
v_dot2_f32_bf16 v164, v115, v151, v164
v_dot2_f32_bf16 v165, v115, v155, v165
v_dot2_f32_bf16 v166, v115, v159, v166
v_dot2_f32_bf16 v167, v115, v163, v167
v_add_f32_dpp v168, v164, v164 row_ror:8 row_mask:0xf bank_mask:0x3
v_add_f32_dpp v169, v165, v165 row_ror:8 row_mask:0xf bank_mask:0x3
v_add_f32_dpp v168, v166, v166 row_ror:8 row_mask:0xf bank_mask:0xc
v_add_f32_dpp v169, v167, v167 row_ror:8 row_mask:0xf bank_mask:0xc
s_nop 0
v_add_f32_dpp v179, v168, v168 row_half_mirror row_mask:0xf bank_mask:0x5
v_add_f32_dpp v179, v169, v169 row_half_mirror row_mask:0xf bank_mask:0xa
s_nop 1
v_add_f32_dpp v179, v179, v179 quad_perm:[1,0,3,2] row_mask:0xf bank_mask:0xf
s_nop 1
v_add_f32_dpp v179, v179, v179 quad_perm:[2,3,0,1] row_mask:0xf bank_mask:0xf
v_dot2_f32_bf16 v164, v116, v148, 0
v_dot2_f32_bf16 v165, v116, v152, 0
v_dot2_f32_bf16 v166, v116, v156, 0
v_dot2_f32_bf16 v167, v116, v160, 0
v_dot2_f32_bf16 v164, v117, v149, v164
v_dot2_f32_bf16 v165, v117, v153, v165
v_dot2_f32_bf16 v166, v117, v157, v166
v_dot2_f32_bf16 v167, v117, v161, v167
v_dot2_f32_bf16 v164, v118, v150, v164
v_dot2_f32_bf16 v165, v118, v154, v165
v_dot2_f32_bf16 v166, v118, v158, v166
v_dot2_f32_bf16 v167, v118, v162, v167
v_dot2_f32_bf16 v164, v119, v151, v164
v_dot2_f32_bf16 v165, v119, v155, v165
v_dot2_f32_bf16 v166, v119, v159, v166
v_dot2_f32_bf16 v167, v119, v163, v167
v_add_f32_dpp v168, v164, v164 row_ror:8 row_mask:0xf bank_mask:0x3
v_add_f32_dpp v169, v165, v165 row_ror:8 row_mask:0xf bank_mask:0x3
v_add_f32_dpp v168, v166, v166 row_ror:8 row_mask:0xf bank_mask:0xc
v_add_f32_dpp v169, v167, v167 row_ror:8 row_mask:0xf bank_mask:0xc
s_nop 0
v_add_f32_dpp v180, v168, v168 row_half_mirror row_mask:0xf bank_mask:0x5
v_add_f32_dpp v180, v169, v169 row_half_mirror row_mask:0xf bank_mask:0xa
s_nop 1
v_add_f32_dpp v180, v180, v180 quad_perm:[1,0,3,2] row_mask:0xf bank_mask:0xf
s_nop 1
v_add_f32_dpp v180, v180, v180 quad_perm:[2,3,0,1] row_mask:0xf bank_mask:0xf
v_dot2_f32_bf16 v164, v120, v148, 0
v_dot2_f32_bf16 v165, v120, v152, 0
v_dot2_f32_bf16 v166, v120, v156, 0
v_dot2_f32_bf16 v167, v120, v160, 0
v_dot2_f32_bf16 v164, v121, v149, v164
v_dot2_f32_bf16 v165, v121, v153, v165
v_dot2_f32_bf16 v166, v121, v157, v166
v_dot2_f32_bf16 v167, v121, v161, v167
v_dot2_f32_bf16 v164, v122, v150, v164
v_dot2_f32_bf16 v165, v122, v154, v165
v_dot2_f32_bf16 v166, v122, v158, v166
v_dot2_f32_bf16 v167, v122, v162, v167
v_dot2_f32_bf16 v164, v123, v151, v164
v_dot2_f32_bf16 v165, v123, v155, v165
v_dot2_f32_bf16 v166, v123, v159, v166
v_dot2_f32_bf16 v167, v123, v163, v167
v_add_f32_dpp v168, v164, v164 row_ror:8 row_mask:0xf bank_mask:0x3
v_add_f32_dpp v169, v165, v165 row_ror:8 row_mask:0xf bank_mask:0x3
v_add_f32_dpp v168, v166, v166 row_ror:8 row_mask:0xf bank_mask:0xc
v_add_f32_dpp v169, v167, v167 row_ror:8 row_mask:0xf bank_mask:0xc
s_nop 0
v_add_f32_dpp v181, v168, v168 row_half_mirror row_mask:0xf bank_mask:0x5
v_add_f32_dpp v181, v169, v169 row_half_mirror row_mask:0xf bank_mask:0xa
s_nop 1
v_add_f32_dpp v181, v181, v181 quad_perm:[1,0,3,2] row_mask:0xf bank_mask:0xf
s_nop 1
v_add_f32_dpp v181, v181, v181 quad_perm:[2,3,0,1] row_mask:0xf bank_mask:0xf
v_dot2_f32_bf16 v164, v124, v148, 0
v_dot2_f32_bf16 v165, v124, v152, 0
v_dot2_f32_bf16 v166, v124, v156, 0
v_dot2_f32_bf16 v167, v124, v160, 0
v_dot2_f32_bf16 v164, v125, v149, v164
v_dot2_f32_bf16 v165, v125, v153, v165
v_dot2_f32_bf16 v166, v125, v157, v166
v_dot2_f32_bf16 v167, v125, v161, v167
v_dot2_f32_bf16 v164, v126, v150, v164
v_dot2_f32_bf16 v165, v126, v154, v165
v_dot2_f32_bf16 v166, v126, v158, v166
v_dot2_f32_bf16 v167, v126, v162, v167
v_dot2_f32_bf16 v164, v127, v151, v164
v_dot2_f32_bf16 v165, v127, v155, v165
v_dot2_f32_bf16 v166, v127, v159, v166
v_dot2_f32_bf16 v167, v127, v163, v167
v_add_f32_dpp v168, v164, v164 row_ror:8 row_mask:0xf bank_mask:0x3
v_add_f32_dpp v169, v165, v165 row_ror:8 row_mask:0xf bank_mask:0x3
v_add_f32_dpp v168, v166, v166 row_ror:8 row_mask:0xf bank_mask:0xc
v_add_f32_dpp v169, v167, v167 row_ror:8 row_mask:0xf bank_mask:0xc
s_nop 0
v_add_f32_dpp v182, v168, v168 row_half_mirror row_mask:0xf bank_mask:0x5
v_add_f32_dpp v182, v169, v169 row_half_mirror row_mask:0xf bank_mask:0xa
s_nop 1
v_add_f32_dpp v182, v182, v182 quad_perm:[1,0,3,2] row_mask:0xf bank_mask:0xf
s_nop 1
v_add_f32_dpp v182, v182, v182 quad_perm:[2,3,0,1] row_mask:0xf bank_mask:0xf
v_dot2_f32_bf16 v164, v128, v148, 0
v_dot2_f32_bf16 v165, v128, v152, 0
v_dot2_f32_bf16 v166, v128, v156, 0
v_dot2_f32_bf16 v167, v128, v160, 0
v_dot2_f32_bf16 v164, v129, v149, v164
v_dot2_f32_bf16 v165, v129, v153, v165
v_dot2_f32_bf16 v166, v129, v157, v166
v_dot2_f32_bf16 v167, v129, v161, v167
v_dot2_f32_bf16 v164, v130, v150, v164
v_dot2_f32_bf16 v165, v130, v154, v165
v_dot2_f32_bf16 v166, v130, v158, v166
v_dot2_f32_bf16 v167, v130, v162, v167
v_dot2_f32_bf16 v164, v131, v151, v164
v_dot2_f32_bf16 v165, v131, v155, v165
v_dot2_f32_bf16 v166, v131, v159, v166
v_dot2_f32_bf16 v167, v131, v163, v167
v_add_f32_dpp v168, v164, v164 row_ror:8 row_mask:0xf bank_mask:0x3
v_add_f32_dpp v169, v165, v165 row_ror:8 row_mask:0xf bank_mask:0x3
v_add_f32_dpp v168, v166, v166 row_ror:8 row_mask:0xf bank_mask:0xc
v_add_f32_dpp v169, v167, v167 row_ror:8 row_mask:0xf bank_mask:0xc
s_nop 0
v_add_f32_dpp v183, v168, v168 row_half_mirror row_mask:0xf bank_mask:0x5
v_add_f32_dpp v183, v169, v169 row_half_mirror row_mask:0xf bank_mask:0xa
s_nop 1
v_add_f32_dpp v183, v183, v183 quad_perm:[1,0,3,2] row_mask:0xf bank_mask:0xf
s_nop 1
v_add_f32_dpp v183, v183, v183 quad_perm:[2,3,0,1] row_mask:0xf bank_mask:0xf
v_dot2_f32_bf16 v164, v132, v148, 0
v_dot2_f32_bf16 v165, v132, v152, 0
v_dot2_f32_bf16 v166, v132, v156, 0
v_dot2_f32_bf16 v167, v132, v160, 0
v_dot2_f32_bf16 v164, v133, v149, v164
v_dot2_f32_bf16 v165, v133, v153, v165
v_dot2_f32_bf16 v166, v133, v157, v166
v_dot2_f32_bf16 v167, v133, v161, v167
v_dot2_f32_bf16 v164, v134, v150, v164
v_dot2_f32_bf16 v165, v134, v154, v165
v_dot2_f32_bf16 v166, v134, v158, v166
v_dot2_f32_bf16 v167, v134, v162, v167
v_dot2_f32_bf16 v164, v135, v151, v164
v_dot2_f32_bf16 v165, v135, v155, v165
v_dot2_f32_bf16 v166, v135, v159, v166
v_dot2_f32_bf16 v167, v135, v163, v167
v_add_f32_dpp v168, v164, v164 row_ror:8 row_mask:0xf bank_mask:0x3
v_add_f32_dpp v169, v165, v165 row_ror:8 row_mask:0xf bank_mask:0x3
v_add_f32_dpp v168, v166, v166 row_ror:8 row_mask:0xf bank_mask:0xc
v_add_f32_dpp v169, v167, v167 row_ror:8 row_mask:0xf bank_mask:0xc
s_nop 0
v_add_f32_dpp v184, v168, v168 row_half_mirror row_mask:0xf bank_mask:0x5
v_add_f32_dpp v184, v169, v169 row_half_mirror row_mask:0xf bank_mask:0xa
s_nop 1
v_add_f32_dpp v184, v184, v184 quad_perm:[1,0,3,2] row_mask:0xf bank_mask:0xf
s_nop 1
v_add_f32_dpp v184, v184, v184 quad_perm:[2,3,0,1] row_mask:0xf bank_mask:0xf
v_dot2_f32_bf16 v164, v136, v148, 0
v_dot2_f32_bf16 v165, v136, v152, 0
v_dot2_f32_bf16 v166, v136, v156, 0
v_dot2_f32_bf16 v167, v136, v160, 0
v_dot2_f32_bf16 v164, v137, v149, v164
v_dot2_f32_bf16 v165, v137, v153, v165
v_dot2_f32_bf16 v166, v137, v157, v166
v_dot2_f32_bf16 v167, v137, v161, v167
v_dot2_f32_bf16 v164, v138, v150, v164
v_dot2_f32_bf16 v165, v138, v154, v165
v_dot2_f32_bf16 v166, v138, v158, v166
v_dot2_f32_bf16 v167, v138, v162, v167
v_dot2_f32_bf16 v164, v139, v151, v164
v_dot2_f32_bf16 v165, v139, v155, v165
v_dot2_f32_bf16 v166, v139, v159, v166
v_dot2_f32_bf16 v167, v139, v163, v167
v_add_f32_dpp v168, v164, v164 row_ror:8 row_mask:0xf bank_mask:0x3
v_add_f32_dpp v169, v165, v165 row_ror:8 row_mask:0xf bank_mask:0x3
v_add_f32_dpp v168, v166, v166 row_ror:8 row_mask:0xf bank_mask:0xc
v_add_f32_dpp v169, v167, v167 row_ror:8 row_mask:0xf bank_mask:0xc
s_nop 0
v_add_f32_dpp v185, v168, v168 row_half_mirror row_mask:0xf bank_mask:0x5
v_add_f32_dpp v185, v169, v169 row_half_mirror row_mask:0xf bank_mask:0xa
s_nop 1
v_add_f32_dpp v185, v185, v185 quad_perm:[1,0,3,2] row_mask:0xf bank_mask:0xf
s_nop 1
v_add_f32_dpp v185, v185, v185 quad_perm:[2,3,0,1] row_mask:0xf bank_mask:0xf
v_dot2_f32_bf16 v164, v140, v148, 0
v_dot2_f32_bf16 v165, v140, v152, 0
v_dot2_f32_bf16 v166, v140, v156, 0
v_dot2_f32_bf16 v167, v140, v160, 0
v_dot2_f32_bf16 v164, v141, v149, v164
v_dot2_f32_bf16 v165, v141, v153, v165
v_dot2_f32_bf16 v166, v141, v157, v166
v_dot2_f32_bf16 v167, v141, v161, v167
v_dot2_f32_bf16 v164, v142, v150, v164
v_dot2_f32_bf16 v165, v142, v154, v165
v_dot2_f32_bf16 v166, v142, v158, v166
v_dot2_f32_bf16 v167, v142, v162, v167
v_dot2_f32_bf16 v164, v143, v151, v164
v_dot2_f32_bf16 v165, v143, v155, v165
v_dot2_f32_bf16 v166, v143, v159, v166
v_dot2_f32_bf16 v167, v143, v163, v167
v_add_f32_dpp v168, v164, v164 row_ror:8 row_mask:0xf bank_mask:0x3
v_add_f32_dpp v169, v165, v165 row_ror:8 row_mask:0xf bank_mask:0x3
v_add_f32_dpp v168, v166, v166 row_ror:8 row_mask:0xf bank_mask:0xc
v_add_f32_dpp v169, v167, v167 row_ror:8 row_mask:0xf bank_mask:0xc
s_nop 0
v_add_f32_dpp v186, v168, v168 row_half_mirror row_mask:0xf bank_mask:0x5
v_add_f32_dpp v186, v169, v169 row_half_mirror row_mask:0xf bank_mask:0xa
s_nop 1
v_add_f32_dpp v186, v186, v186 quad_perm:[1,0,3,2] row_mask:0xf bank_mask:0xf
s_nop 1
v_add_f32_dpp v186, v186, v186 quad_perm:[2,3,0,1] row_mask:0xf bank_mask:0xf
v_dot2_f32_bf16 v164, v144, v148, 0
v_dot2_f32_bf16 v165, v144, v152, 0
v_dot2_f32_bf16 v166, v144, v156, 0
v_dot2_f32_bf16 v167, v144, v160, 0
v_dot2_f32_bf16 v164, v145, v149, v164
v_dot2_f32_bf16 v165, v145, v153, v165
v_dot2_f32_bf16 v166, v145, v157, v166
v_dot2_f32_bf16 v167, v145, v161, v167
v_dot2_f32_bf16 v164, v146, v150, v164
v_dot2_f32_bf16 v165, v146, v154, v165
v_dot2_f32_bf16 v166, v146, v158, v166
v_dot2_f32_bf16 v167, v146, v162, v167
v_dot2_f32_bf16 v164, v147, v151, v164
v_dot2_f32_bf16 v165, v147, v155, v165
v_dot2_f32_bf16 v166, v147, v159, v166
v_dot2_f32_bf16 v167, v147, v163, v167
v_add_f32_dpp v168, v164, v164 row_ror:8 row_mask:0xf bank_mask:0x3
v_add_f32_dpp v169, v165, v165 row_ror:8 row_mask:0xf bank_mask:0x3
v_add_f32_dpp v168, v166, v166 row_ror:8 row_mask:0xf bank_mask:0xc
v_add_f32_dpp v169, v167, v167 row_ror:8 row_mask:0xf bank_mask:0xc
s_nop 0
v_add_f32_dpp v187, v168, v168 row_half_mirror row_mask:0xf bank_mask:0x5
v_add_f32_dpp v187, v169, v169 row_half_mirror row_mask:0xf bank_mask:0xa
s_nop 1
v_add_f32_dpp v187, v187, v187 quad_perm:[1,0,3,2] row_mask:0xf bank_mask:0xf
s_nop 1
v_add_f32_dpp v187, v187, v187 quad_perm:[2,3,0,1] row_mask:0xf bank_mask:0xf
v_cvt_pk_bf16_f32 v188, v172, v173
v_cvt_pk_bf16_f32 v189, v174, v175
v_cvt_pk_bf16_f32 v190, v176, v177
v_cvt_pk_bf16_f32 v191, v178, v179
v_cvt_pk_bf16_f32 v192, v180, v181
v_cvt_pk_bf16_f32 v193, v182, v183
v_cvt_pk_bf16_f32 v194, v184, v185
v_cvt_pk_bf16_f32 v195, v186, v187
v_min_u32 v188, -2, v188
v_min_u32 v189, -2, v189
v_min_u32 v190, -2, v190
v_min_u32 v191, -2, v191
v_min_u32 v192, -2, v192
v_min_u32 v193, -2, v193
v_min_u32 v194, -2, v194
v_min_u32 v195, -2, v195
v_bfe_u32 v5, v1, 2, 2
v_lshlrev_b32 v5, 15, v5
v_lshl_add_u32 v5, v9, 5, v5
s_lshl_b32 s6, s4, 10
s_lshl_b32 s7, s8, 9
s_add_u32 s6, s6, s7
s_lshl_b32 s7, s3, 7
s_add_u32 s6, s6, s7
s_add_u32 s6, s6, 0
s_mov_b32 exec_lo, 0x11111111
s_mov_b32 exec_hi, 0x11111111
buffer_store_dwordx4 v[188:191], v5, s[64:67], s6 offen sc1
buffer_store_dwordx4 v[192:195], v5, s[64:67], s6 offen offset:16 sc1
s_mov_b64 exec, -1
s_waitcnt vmcnt(6)
s_mov_b32 s7, 400000
L_ens_18:
v_readfirstlane_b32 s6, v11
s_cmp_ge_u32 s6, 128
s_cbranch_scc1 L_ensd_19
s_sleep 16
buffer_load_dword v11, off, s[68:71], 0 offset:0 sc1
s_waitcnt vmcnt(0)
s_sub_u32 s7, s7, 1
s_cmp_lg_u32 s7, 0
s_cbranch_scc1 L_ens_18
L_ensd_19:
s_lshl_b32 s14, s10, 15
s_lshl_b32 s6, s3, 12
s_add_u32 s14, s14, s6
s_add_u32 s14, s14, 0
s_add_u32 s15, s14, 16384
s_nop 1
buffer_load_dwordx4 v[84:87], v2, s[64:67], s14 offen offset:0 sc1
buffer_load_dwordx4 v[88:91], v2, s[64:67], s14 offen offset:1024 sc1
buffer_load_dwordx4 v[92:95], v2, s[64:67], s14 offen offset:2048 sc1
buffer_load_dwordx4 v[96:99], v2, s[64:67], s14 offen offset:3072 sc1
buffer_load_dwordx4 v[100:103], v2, s[64:67], s15 offen offset:0 sc1
buffer_load_dwordx4 v[104:107], v2, s[64:67], s15 offen offset:1024 sc1
buffer_load_dwordx4 v[108:111], v2, s[64:67], s15 offen offset:2048 sc1
buffer_load_dwordx4 v[112:115], v2, s[64:67], s15 offen offset:3072 sc1
s_add_u32 s6, s13, 2097152
buffer_load_dwordx4 a[128:131], v2, s[52:55], s6 offen nt
s_add_u32 s6, s13, 2098176
buffer_load_dwordx4 a[132:135], v2, s[52:55], s6 offen nt
s_add_u32 s6, s13, 2099200
buffer_load_dwordx4 a[136:139], v2, s[52:55], s6 offen nt
s_add_u32 s6, s13, 2100224
buffer_load_dwordx4 a[140:143], v2, s[52:55], s6 offen nt
s_add_u32 s6, s13, 2359296
buffer_load_dwordx4 a[144:147], v2, s[52:55], s6 offen nt
s_add_u32 s6, s13, 2360320
buffer_load_dwordx4 a[148:151], v2, s[52:55], s6 offen nt
s_add_u32 s6, s13, 2361344
buffer_load_dwordx4 a[152:155], v2, s[52:55], s6 offen nt
s_add_u32 s6, s13, 2362368
buffer_load_dwordx4 a[156:159], v2, s[52:55], s6 offen nt
s_add_u32 s6, s13, 2621440
buffer_load_dwordx4 a[160:163], v10, s[52:55], s6 offen nt
s_add_u32 s6, s13, 2622464
buffer_load_dwordx4 a[164:167], v10, s[52:55], s6 offen nt
s_add_u32 s6, s13, 2623488
buffer_load_dwordx4 a[168:171], v10, s[52:55], s6 offen nt
s_add_u32 s6, s13, 2624512
buffer_load_dwordx4 a[172:175], v10, s[52:55], s6 offen nt
s_add_u32 s6, s13, 2883584
buffer_load_dwordx4 a[176:179], v10, s[52:55], s6 offen nt
s_add_u32 s6, s13, 2884608
buffer_load_dwordx4 a[180:183], v10, s[52:55], s6 offen nt
s_add_u32 s6, s13, 2885632
buffer_load_dwordx4 a[184:187], v10, s[52:55], s6 offen nt
s_add_u32 s6, s13, 2886656
buffer_load_dwordx4 a[188:191], v10, s[52:55], s6 offen nt
s_add_u32 s6, s13, 3145728
buffer_load_dwordx4 a[192:195], v2, s[52:55], s6 offen nt
s_add_u32 s6, s13, 3146752
buffer_load_dwordx4 a[196:199], v2, s[52:55], s6 offen nt
s_add_u32 s6, s13, 3147776
buffer_load_dwordx4 a[200:203], v2, s[52:55], s6 offen nt
s_add_u32 s6, s13, 3148800
buffer_load_dwordx4 a[204:207], v2, s[52:55], s6 offen nt
s_add_u32 s6, s13, 3407872
buffer_load_dwordx4 a[208:211], v2, s[52:55], s6 offen nt
s_add_u32 s6, s13, 3408896
buffer_load_dwordx4 a[212:215], v2, s[52:55], s6 offen nt
s_add_u32 s6, s13, 3409920
buffer_load_dwordx4 a[216:219], v2, s[52:55], s6 offen nt
s_add_u32 s6, s13, 3410944
buffer_load_dwordx4 a[220:223], v2, s[52:55], s6 offen nt
s_add_u32 s6, s13, 3670016
buffer_load_dwordx4 a[224:227], v10, s[52:55], s6 offen nt
s_add_u32 s6, s13, 3671040
buffer_load_dwordx4 a[228:231], v10, s[52:55], s6 offen nt
s_add_u32 s6, s13, 3672064
buffer_load_dwordx4 a[232:235], v10, s[52:55], s6 offen nt
s_add_u32 s6, s13, 3673088
buffer_load_dwordx4 a[236:239], v10, s[52:55], s6 offen nt
s_add_u32 s6, s13, 3932160
buffer_load_dwordx4 a[240:243], v10, s[52:55], s6 offen nt
s_add_u32 s6, s13, 3933184
buffer_load_dwordx4 a[244:247], v10, s[52:55], s6 offen nt
s_add_u32 s6, s13, 3934208
buffer_load_dwordx4 a[248:251], v10, s[52:55], s6 offen nt
s_add_u32 s6, s13, 3935232
buffer_load_dwordx4 a[252:255], v10, s[52:55], s6 offen nt
s_lshl_b32 s6, s3, 4
v_add_u32 v5, s6, v8
v_mul_u32_u24 v5, 1088, v5
v_lshrrev_b32 v6, 3, v8
v_lshlrev_b32 v6, 1, v6
v_xor_b32 v6, v6, v9
v_lshl_add_u32 v194, v6, 4, v5
v_add_u32 v195, 69632, v194
v_lshrrev_b32 v5, 5, v1
v_lshlrev_b32 v5, 3, v5
v_bfe_u32 v6, v1, 2, 2
v_add_u32 v5, v5, v6
v_mul_u32_u24 v5, 1088, v5
v_lshrrev_b32 v6, 1, v9
v_xor_b32 v6, v6, v9
v_and_b32 v6, 1, v6
v_lshl_add_u32 v5, v6, 5, v5
v_and_b32 v6, 3, v1
v_lshl_add_u32 v5, v6, 3, v5
s_lshl_b32 s6, s3, 8
v_add_u32 v196, s6, v5
v_add_u32 v197, 69632, v196
v_lshlrev_b32 v199, 4, v8
v_add_u32 v199, 160256, v199
s_lshl_b32 s6, s3, 2
v_add_u32 v198, s6, v199
v_and_b32 v5, 31, v1
v_lshlrev_b32 v200, 4, v5
v_add_u32 v200, 160256, v200
v_lshlrev_b32 v202, 5, v5
v_lshrrev_b32 v6, 5, v1
v_lshl_add_u32 v202, v6, 4, v202
v_add_u32 v202, 156160, v202
v_lshlrev_b32 v201, 5, v8
v_lshl_add_u32 v201, v9, 3, v201
s_lshl_b32 s6, s3, 10
s_add_u32 s6, s6, 156160
v_add_u32 v201, s6, v201
v_mul_u32_u24 v203, 1056, v8
v_lshl_add_u32 v203, v9, 4, v203
v_add_u32 v203, 139264, v203
s_mul_i32 s6, s3, 4224
s_add_u32 s6, s6, 139264
v_add_u32 v204, s6, v2
v_add_u32 v206, s12, v2
v_add_u32 v207, 69632, v206
v_mov_b32 v185, 0x3e0293ee
v_mov_b32 v176, 0xff800000
v_mov_b32 v177, 0xff800000
v_mov_b32 v178, 0xff800000
v_mov_b32 v180, 0
v_mov_b32 v181, 0
s_waitcnt vmcnt(32)
s_mov_b32 s7, 400000
Q_chk:
v_max3_u32 v192, v84, v85, v86
v_max3_u32 v192, v192, v87, v88
v_max3_u32 v192, v192, v89, v90
v_max3_u32 v192, v192, v91, v92
v_max3_u32 v192, v192, v93, v94
v_max3_u32 v192, v192, v95, v96
v_max3_u32 v192, v192, v97, v98
v_max3_u32 v192, v192, v99, v100
v_max3_u32 v192, v192, v101, v102
v_max3_u32 v192, v192, v103, v104
v_max3_u32 v192, v192, v105, v106
v_max3_u32 v192, v192, v107, v108
v_max3_u32 v192, v192, v109, v110
v_max3_u32 v192, v192, v111, v112
v_max3_u32 v192, v192, v113, v114
v_max_u32 v192, v192, v115
v_cmp_eq_u32 vcc, -1, v192
s_cbranch_vccz Q_ok
s_sleep 16
buffer_load_dwordx4 v[84:87], v2, s[64:67], s14 offen offset:0 sc1
buffer_load_dwordx4 v[88:91], v2, s[64:67], s14 offen offset:1024 sc1
buffer_load_dwordx4 v[92:95], v2, s[64:67], s14 offen offset:2048 sc1
buffer_load_dwordx4 v[96:99], v2, s[64:67], s14 offen offset:3072 sc1
buffer_load_dwordx4 v[100:103], v2, s[64:67], s15 offen offset:0 sc1
buffer_load_dwordx4 v[104:107], v2, s[64:67], s15 offen offset:1024 sc1
buffer_load_dwordx4 v[108:111], v2, s[64:67], s15 offen offset:2048 sc1
buffer_load_dwordx4 v[112:115], v2, s[64:67], s15 offen offset:3072 sc1
s_waitcnt vmcnt(0)
s_sub_u32 s7, s7, 1
s_cmp_lg_u32 s7, 0
s_cbranch_scc1 Q_chk
Q_ok:
s_barrier
ds_write_b128 v204, v[84:87] offset:0
ds_write_b128 v204, v[88:91] offset:1056
ds_write_b128 v204, v[92:95] offset:2112
ds_write_b128 v204, v[96:99] offset:3168
s_waitcnt lgkmcnt(0)
s_barrier
ds_read_b128 a[0:3], v203 offset:0
ds_read_b128 a[4:7], v203 offset:64
ds_read_b128 a[8:11], v203 offset:128
ds_read_b128 a[12:15], v203 offset:192
ds_read_b128 a[16:19], v203 offset:256
ds_read_b128 a[20:23], v203 offset:320
ds_read_b128 a[24:27], v203 offset:384
ds_read_b128 a[28:31], v203 offset:448
ds_read_b128 a[32:35], v203 offset:512
ds_read_b128 a[36:39], v203 offset:576
ds_read_b128 a[40:43], v203 offset:640
ds_read_b128 a[44:47], v203 offset:704
ds_read_b128 a[48:51], v203 offset:768
ds_read_b128 a[52:55], v203 offset:832
ds_read_b128 a[56:59], v203 offset:896
ds_read_b128 a[60:63], v203 offset:960
s_waitcnt lgkmcnt(0)
s_barrier
ds_write_b128 v204, v[100:103] offset:0
ds_write_b128 v204, v[104:107] offset:1056
ds_write_b128 v204, v[108:111] offset:2112
ds_write_b128 v204, v[112:115] offset:3168
s_waitcnt lgkmcnt(0)
s_barrier
ds_read_b128 a[64:67], v203 offset:0
ds_read_b128 a[68:71], v203 offset:64
ds_read_b128 a[72:75], v203 offset:128
ds_read_b128 a[76:79], v203 offset:192
ds_read_b128 a[80:83], v203 offset:256
ds_read_b128 a[84:87], v203 offset:320
ds_read_b128 a[88:91], v203 offset:384
ds_read_b128 a[92:95], v203 offset:448
ds_read_b128 a[96:99], v203 offset:512
ds_read_b128 a[100:103], v203 offset:576
ds_read_b128 a[104:107], v203 offset:640
ds_read_b128 a[108:111], v203 offset:704
ds_read_b128 a[112:115], v203 offset:768
ds_read_b128 a[116:119], v203 offset:832
ds_read_b128 a[120:123], v203 offset:896
ds_read_b128 a[124:127], v203 offset:960
s_waitcnt lgkmcnt(0)
ds_read_b128 v[84:87], v194 offset:0
ds_read_b128 v[88:91], v194 offset:64
ds_read_b128 v[92:95], v194 offset:128
ds_read_b128 v[96:99], v194 offset:192
ds_read_b128 v[100:103], v194 offset:256
ds_read_b128 v[104:107], v194 offset:320
ds_read_b128 v[108:111], v194 offset:384
ds_read_b128 v[112:115], v194 offset:448
ds_read_b128 v[116:119], v194 offset:512
ds_read_b128 v[120:123], v194 offset:576
ds_read_b128 v[124:127], v194 offset:640
ds_read_b128 v[128:131], v194 offset:704
ds_read_b128 v[132:135], v194 offset:768
ds_read_b128 v[136:139], v194 offset:832
ds_read_b128 v[140:143], v194 offset:896
ds_read_b128 v[144:147], v194 offset:960
s_waitcnt lgkmcnt(15)
v_mfma_f32_16x16x32_bf16 v[76:79], v[84:87], a[0:3], 0
v_mfma_f32_16x16x32_bf16 v[80:83], v[84:87], a[64:67], 0
s_waitcnt lgkmcnt(14)
v_mfma_f32_16x16x32_bf16 v[76:79], v[88:91], a[4:7], v[76:79]
v_mfma_f32_16x16x32_bf16 v[80:83], v[88:91], a[68:71], v[80:83]
s_waitcnt lgkmcnt(13)
v_mfma_f32_16x16x32_bf16 v[76:79], v[92:95], a[8:11], v[76:79]
v_mfma_f32_16x16x32_bf16 v[80:83], v[92:95], a[72:75], v[80:83]
s_waitcnt lgkmcnt(12)
v_mfma_f32_16x16x32_bf16 v[76:79], v[96:99], a[12:15], v[76:79]
v_mfma_f32_16x16x32_bf16 v[80:83], v[96:99], a[76:79], v[80:83]
s_waitcnt lgkmcnt(11)
v_mfma_f32_16x16x32_bf16 v[76:79], v[100:103], a[16:19], v[76:79]
v_mfma_f32_16x16x32_bf16 v[80:83], v[100:103], a[80:83], v[80:83]
s_waitcnt lgkmcnt(10)
v_mfma_f32_16x16x32_bf16 v[76:79], v[104:107], a[20:23], v[76:79]
v_mfma_f32_16x16x32_bf16 v[80:83], v[104:107], a[84:87], v[80:83]
s_waitcnt lgkmcnt(9)
v_mfma_f32_16x16x32_bf16 v[76:79], v[108:111], a[24:27], v[76:79]
v_mfma_f32_16x16x32_bf16 v[80:83], v[108:111], a[88:91], v[80:83]
s_waitcnt lgkmcnt(8)
v_mfma_f32_16x16x32_bf16 v[76:79], v[112:115], a[28:31], v[76:79]
v_mfma_f32_16x16x32_bf16 v[80:83], v[112:115], a[92:95], v[80:83]
s_waitcnt lgkmcnt(7)
v_mfma_f32_16x16x32_bf16 v[76:79], v[116:119], a[32:35], v[76:79]
v_mfma_f32_16x16x32_bf16 v[80:83], v[116:119], a[96:99], v[80:83]
s_waitcnt lgkmcnt(6)
v_mfma_f32_16x16x32_bf16 v[76:79], v[120:123], a[36:39], v[76:79]
v_mfma_f32_16x16x32_bf16 v[80:83], v[120:123], a[100:103], v[80:83]
s_waitcnt lgkmcnt(5)
v_mfma_f32_16x16x32_bf16 v[76:79], v[124:127], a[40:43], v[76:79]
v_mfma_f32_16x16x32_bf16 v[80:83], v[124:127], a[104:107], v[80:83]
s_waitcnt lgkmcnt(4)
v_mfma_f32_16x16x32_bf16 v[76:79], v[128:131], a[44:47], v[76:79]
v_mfma_f32_16x16x32_bf16 v[80:83], v[128:131], a[108:111], v[80:83]
s_waitcnt lgkmcnt(3)
v_mfma_f32_16x16x32_bf16 v[76:79], v[132:135], a[48:51], v[76:79]
v_mfma_f32_16x16x32_bf16 v[80:83], v[132:135], a[112:115], v[80:83]
s_waitcnt lgkmcnt(2)
v_mfma_f32_16x16x32_bf16 v[76:79], v[136:139], a[52:55], v[76:79]
v_mfma_f32_16x16x32_bf16 v[80:83], v[136:139], a[116:119], v[80:83]
s_waitcnt lgkmcnt(1)
v_mfma_f32_16x16x32_bf16 v[76:79], v[140:143], a[56:59], v[76:79]
v_mfma_f32_16x16x32_bf16 v[80:83], v[140:143], a[120:123], v[80:83]
s_waitcnt lgkmcnt(0)
v_mfma_f32_16x16x32_bf16 v[76:79], v[144:147], a[60:63], v[76:79]
v_mfma_f32_16x16x32_bf16 v[80:83], v[144:147], a[124:127], v[80:83]
s_nop 6
v_max_f32 v190, v76, v77
v_max3_f32 v190, v190, v78, v79
v_mov_b32 v192, v190
s_nop 1
v_permlane16_swap_b32 v190, v192
v_max_f32 v190, v190, v192
v_mov_b32 v192, v190
s_nop 1
v_permlane32_swap_b32 v190, v192
v_max_f32 v190, v190, v192
ds_write_b32 v198, v190 offset:0
v_max_f32 v191, v80, v81
v_max3_f32 v191, v191, v82, v83
v_mov_b32 v192, v191
s_nop 1
v_permlane16_swap_b32 v191, v192
v_max_f32 v191, v191, v192
v_mov_b32 v192, v191
s_nop 1
v_permlane32_swap_b32 v191, v192
v_max_f32 v191, v191, v192
ds_write_b32 v198, v191 offset:256
s_waitcnt lgkmcnt(0)
s_barrier
ds_read_b128 v[164:167], v199
ds_read_b128 v[168:171], v199 offset:256
ds_read_b128 v[172:175], v200
s_waitcnt lgkmcnt(0)
v_max_f32 v164, v164, v165
v_max3_f32 v164, v164, v166, v167
v_mul_f32 v164, v164, v185
v_max_f32 v164, v164, v176
v_sub_f32 v182, v176, v164
v_exp_f32 v182, v182
v_mov_b32 v176, v164
v_max_f32 v168, v168, v169
v_max3_f32 v168, v168, v170, v171
v_mul_f32 v168, v168, v185
v_max_f32 v168, v168, v177
v_sub_f32 v183, v177, v168
v_exp_f32 v183, v183
v_mov_b32 v177, v168
v_max_f32 v172, v172, v173
v_max3_f32 v172, v172, v174, v175
v_mul_f32 v172, v172, v185
v_max_f32 v172, v172, v178
v_sub_f32 v184, v178, v172
v_exp_f32 v184, v184
v_mov_b32 v178, v172
v_fma_f32 v76, v76, v185, -v176
v_fma_f32 v77, v77, v185, -v176
v_fma_f32 v78, v78, v185, -v176
v_fma_f32 v79, v79, v185, -v176
v_exp_f32 v76, v76
v_exp_f32 v77, v77
v_exp_f32 v78, v78
v_exp_f32 v79, v79
v_mul_f32 v180, v180, v182
v_cvt_pk_bf16_f32 v186, v76, v77
v_cvt_pk_bf16_f32 v187, v78, v79
ds_write_b64 v201, v[186:187] offset:0
v_add_f32 v180, v180, v76
v_add_f32 v180, v180, v77
v_add_f32 v180, v180, v78
v_add_f32 v180, v180, v79
v_fma_f32 v80, v80, v185, -v177
v_fma_f32 v81, v81, v185, -v177
v_fma_f32 v82, v82, v185, -v177
v_fma_f32 v83, v83, v185, -v177
v_exp_f32 v80, v80
v_exp_f32 v81, v81
v_exp_f32 v82, v82
v_exp_f32 v83, v83
v_mul_f32 v181, v181, v183
v_cvt_pk_bf16_f32 v188, v80, v81
v_cvt_pk_bf16_f32 v189, v82, v83
ds_write_b64 v201, v[188:189] offset:512
v_add_f32 v181, v181, v80
v_add_f32 v181, v181, v81
v_add_f32 v181, v181, v82
v_add_f32 v181, v181, v83
s_waitcnt lgkmcnt(0)
s_barrier
ds_read_b128 v[148:151], v202 offset:0
ds_read_b128 v[152:155], v202 offset:1024
ds_read_b128 v[156:159], v202 offset:2048
ds_read_b128 v[160:163], v202 offset:3072
ds_read_b64_tr_b16 v[84:85], v196 offset:0
ds_read_b64_tr_b16 v[86:87], v196 offset:4352
ds_read_b64_tr_b16 v[88:89], v196 offset:64
ds_read_b64_tr_b16 v[90:91], v196 offset:4416
ds_read_b64_tr_b16 v[92:93], v196 offset:128
ds_read_b64_tr_b16 v[94:95], v196 offset:4480
ds_read_b64_tr_b16 v[96:97], v196 offset:192
ds_read_b64_tr_b16 v[98:99], v196 offset:4544
ds_read_b64_tr_b16 v[100:101], v196 offset:17408
ds_read_b64_tr_b16 v[102:103], v196 offset:21760
ds_read_b64_tr_b16 v[104:105], v196 offset:17472
ds_read_b64_tr_b16 v[106:107], v196 offset:21824
ds_read_b64_tr_b16 v[108:109], v196 offset:17536
ds_read_b64_tr_b16 v[110:111], v196 offset:21888
ds_read_b64_tr_b16 v[112:113], v196 offset:17600
ds_read_b64_tr_b16 v[114:115], v196 offset:21952
ds_read_b64_tr_b16 v[116:117], v196 offset:34816
ds_read_b64_tr_b16 v[118:119], v196 offset:39168
ds_read_b64_tr_b16 v[120:121], v196 offset:34880
ds_read_b64_tr_b16 v[122:123], v196 offset:39232
ds_read_b64_tr_b16 v[124:125], v196 offset:34944
ds_read_b64_tr_b16 v[126:127], v196 offset:39296
ds_read_b64_tr_b16 v[128:129], v196 offset:35008
ds_read_b64_tr_b16 v[130:131], v196 offset:39360
ds_read_b64_tr_b16 v[132:133], v196 offset:52224
ds_read_b64_tr_b16 v[134:135], v196 offset:56576
ds_read_b64_tr_b16 v[136:137], v196 offset:52288
ds_read_b64_tr_b16 v[138:139], v196 offset:56640
ds_read_b64_tr_b16 v[140:141], v196 offset:52352
ds_read_b64_tr_b16 v[142:143], v196 offset:56704
ds_read_b64_tr_b16 v[144:145], v196 offset:52416
ds_read_b64_tr_b16 v[146:147], v196 offset:56768
s_waitcnt lgkmcnt(15)
v_mfma_f32_32x32x16_bf16 v[12:27], v[84:87], v[148:151], 0
v_mfma_f32_32x32x16_bf16 v[28:43], v[88:91], v[148:151], 0
v_mfma_f32_32x32x16_bf16 v[44:59], v[92:95], v[148:151], 0
v_mfma_f32_32x32x16_bf16 v[60:75], v[96:99], v[148:151], 0
s_waitcnt lgkmcnt(15)
v_mfma_f32_32x32x16_bf16 v[12:27], v[100:103], v[152:155], v[12:27]
v_mfma_f32_32x32x16_bf16 v[28:43], v[104:107], v[152:155], v[28:43]
v_mfma_f32_32x32x16_bf16 v[44:59], v[108:111], v[152:155], v[44:59]
v_mfma_f32_32x32x16_bf16 v[60:75], v[112:115], v[152:155], v[60:75]
s_waitcnt lgkmcnt(8)
v_mfma_f32_32x32x16_bf16 v[12:27], v[116:119], v[156:159], v[12:27]
v_mfma_f32_32x32x16_bf16 v[28:43], v[120:123], v[156:159], v[28:43]
v_mfma_f32_32x32x16_bf16 v[44:59], v[124:127], v[156:159], v[44:59]
v_mfma_f32_32x32x16_bf16 v[60:75], v[128:131], v[156:159], v[60:75]
s_waitcnt lgkmcnt(0)
v_mfma_f32_32x32x16_bf16 v[12:27], v[132:135], v[160:163], v[12:27]
v_mfma_f32_32x32x16_bf16 v[28:43], v[136:139], v[160:163], v[28:43]
v_mfma_f32_32x32x16_bf16 v[44:59], v[140:143], v[160:163], v[44:59]
v_mfma_f32_32x32x16_bf16 v[60:75], v[144:147], v[160:163], v[60:75]
ds_read_b128 v[84:87], v195 offset:0
ds_read_b128 v[88:91], v195 offset:64
ds_read_b128 v[92:95], v195 offset:128
ds_read_b128 v[96:99], v195 offset:192
ds_read_b128 v[100:103], v195 offset:256
ds_read_b128 v[104:107], v195 offset:320
ds_read_b128 v[108:111], v195 offset:384
ds_read_b128 v[112:115], v195 offset:448
ds_read_b128 v[116:119], v195 offset:512
ds_read_b128 v[120:123], v195 offset:576
ds_read_b128 v[124:127], v195 offset:640
ds_read_b128 v[128:131], v195 offset:704
ds_read_b128 v[132:135], v195 offset:768
ds_read_b128 v[136:139], v195 offset:832
ds_read_b128 v[140:143], v195 offset:896
ds_read_b128 v[144:147], v195 offset:960
s_waitcnt lgkmcnt(15)
v_mfma_f32_16x16x32_bf16 v[76:79], v[84:87], a[0:3], 0
v_mfma_f32_16x16x32_bf16 v[80:83], v[84:87], a[64:67], 0
s_waitcnt lgkmcnt(14)
v_mfma_f32_16x16x32_bf16 v[76:79], v[88:91], a[4:7], v[76:79]
v_mfma_f32_16x16x32_bf16 v[80:83], v[88:91], a[68:71], v[80:83]
s_waitcnt lgkmcnt(13)
v_mfma_f32_16x16x32_bf16 v[76:79], v[92:95], a[8:11], v[76:79]
v_mfma_f32_16x16x32_bf16 v[80:83], v[92:95], a[72:75], v[80:83]
s_waitcnt lgkmcnt(12)
v_mfma_f32_16x16x32_bf16 v[76:79], v[96:99], a[12:15], v[76:79]
v_mfma_f32_16x16x32_bf16 v[80:83], v[96:99], a[76:79], v[80:83]
s_waitcnt lgkmcnt(11)
v_mfma_f32_16x16x32_bf16 v[76:79], v[100:103], a[16:19], v[76:79]
v_mfma_f32_16x16x32_bf16 v[80:83], v[100:103], a[80:83], v[80:83]
s_waitcnt lgkmcnt(10)
v_mfma_f32_16x16x32_bf16 v[76:79], v[104:107], a[20:23], v[76:79]
v_mfma_f32_16x16x32_bf16 v[80:83], v[104:107], a[84:87], v[80:83]
s_waitcnt lgkmcnt(9)
v_mfma_f32_16x16x32_bf16 v[76:79], v[108:111], a[24:27], v[76:79]
v_mfma_f32_16x16x32_bf16 v[80:83], v[108:111], a[88:91], v[80:83]
s_waitcnt lgkmcnt(8)
v_mfma_f32_16x16x32_bf16 v[76:79], v[112:115], a[28:31], v[76:79]
v_mfma_f32_16x16x32_bf16 v[80:83], v[112:115], a[92:95], v[80:83]
s_waitcnt lgkmcnt(7)
v_mfma_f32_16x16x32_bf16 v[76:79], v[116:119], a[32:35], v[76:79]
v_mfma_f32_16x16x32_bf16 v[80:83], v[116:119], a[96:99], v[80:83]
s_waitcnt lgkmcnt(6)
v_mfma_f32_16x16x32_bf16 v[76:79], v[120:123], a[36:39], v[76:79]
v_mfma_f32_16x16x32_bf16 v[80:83], v[120:123], a[100:103], v[80:83]
s_waitcnt lgkmcnt(5)
v_mfma_f32_16x16x32_bf16 v[76:79], v[124:127], a[40:43], v[76:79]
v_mfma_f32_16x16x32_bf16 v[80:83], v[124:127], a[104:107], v[80:83]
s_waitcnt lgkmcnt(4)
v_mfma_f32_16x16x32_bf16 v[76:79], v[128:131], a[44:47], v[76:79]
v_mfma_f32_16x16x32_bf16 v[80:83], v[128:131], a[108:111], v[80:83]
s_waitcnt lgkmcnt(3)
v_mfma_f32_16x16x32_bf16 v[76:79], v[132:135], a[48:51], v[76:79]
v_mfma_f32_16x16x32_bf16 v[80:83], v[132:135], a[112:115], v[80:83]
s_waitcnt lgkmcnt(2)
v_mfma_f32_16x16x32_bf16 v[76:79], v[136:139], a[52:55], v[76:79]
v_mfma_f32_16x16x32_bf16 v[80:83], v[136:139], a[116:119], v[80:83]
s_waitcnt lgkmcnt(1)
v_mfma_f32_16x16x32_bf16 v[76:79], v[140:143], a[56:59], v[76:79]
v_mfma_f32_16x16x32_bf16 v[80:83], v[140:143], a[120:123], v[80:83]
s_waitcnt lgkmcnt(0)
v_mfma_f32_16x16x32_bf16 v[76:79], v[144:147], a[60:63], v[76:79]
v_mfma_f32_16x16x32_bf16 v[80:83], v[144:147], a[124:127], v[80:83]
s_nop 6
v_max_f32 v190, v76, v77
v_max3_f32 v190, v190, v78, v79
v_mov_b32 v192, v190
s_nop 1
v_permlane16_swap_b32 v190, v192
v_max_f32 v190, v190, v192
v_mov_b32 v192, v190
s_nop 1
v_permlane32_swap_b32 v190, v192
v_max_f32 v190, v190, v192
ds_write_b32 v198, v190 offset:0
v_max_f32 v191, v80, v81
v_max3_f32 v191, v191, v82, v83
v_mov_b32 v192, v191
s_nop 1
v_permlane16_swap_b32 v191, v192
v_max_f32 v191, v191, v192
v_mov_b32 v192, v191
s_nop 1
v_permlane32_swap_b32 v191, v192
v_max_f32 v191, v191, v192
ds_write_b32 v198, v191 offset:256
s_waitcnt lgkmcnt(0)
s_barrier
ds_read_b128 v[164:167], v199
ds_read_b128 v[168:171], v199 offset:256
ds_read_b128 v[172:175], v200
s_waitcnt vmcnt(16)
ds_write_b128 v206, a[128:131] offset:0
ds_write_b128 v206, a[132:135] offset:1088
ds_write_b128 v206, a[136:139] offset:2176
ds_write_b128 v206, a[140:143] offset:3264
ds_write_b128 v206, a[144:147] offset:4352
ds_write_b128 v206, a[148:151] offset:5440
ds_write_b128 v206, a[152:155] offset:6528
ds_write_b128 v206, a[156:159] offset:7616
ds_write_b128 v206, a[160:163] offset:8704
ds_write_b128 v206, a[164:167] offset:9792
ds_write_b128 v206, a[168:171] offset:10880
ds_write_b128 v206, a[172:175] offset:11968
ds_write_b128 v206, a[176:179] offset:13056
ds_write_b128 v206, a[180:183] offset:14144
ds_write_b128 v206, a[184:187] offset:15232
ds_write_b128 v206, a[188:191] offset:16320
s_waitcnt lgkmcnt(15)
v_max_f32 v164, v164, v165
v_max3_f32 v164, v164, v166, v167
v_mul_f32 v164, v164, v185
v_max_f32 v164, v164, v176
v_sub_f32 v182, v176, v164
v_exp_f32 v182, v182
v_mov_b32 v176, v164
v_max_f32 v168, v168, v169
v_max3_f32 v168, v168, v170, v171
v_mul_f32 v168, v168, v185
v_max_f32 v168, v168, v177
v_sub_f32 v183, v177, v168
v_exp_f32 v183, v183
v_mov_b32 v177, v168
v_max_f32 v172, v172, v173
v_max3_f32 v172, v172, v174, v175
v_mul_f32 v172, v172, v185
v_max_f32 v172, v172, v178
v_sub_f32 v184, v178, v172
v_exp_f32 v184, v184
v_mov_b32 v178, v172
v_fma_f32 v76, v76, v185, -v176
v_fma_f32 v77, v77, v185, -v176
v_fma_f32 v78, v78, v185, -v176
v_fma_f32 v79, v79, v185, -v176
v_exp_f32 v76, v76
v_exp_f32 v77, v77
v_exp_f32 v78, v78
v_exp_f32 v79, v79
v_mul_f32 v180, v180, v182
v_cvt_pk_bf16_f32 v186, v76, v77
v_cvt_pk_bf16_f32 v187, v78, v79
ds_write_b64 v201, v[186:187] offset:0
v_add_f32 v180, v180, v76
v_add_f32 v180, v180, v77
v_add_f32 v180, v180, v78
v_add_f32 v180, v180, v79
v_fma_f32 v80, v80, v185, -v177
v_fma_f32 v81, v81, v185, -v177
v_fma_f32 v82, v82, v185, -v177
v_fma_f32 v83, v83, v185, -v177
v_exp_f32 v80, v80
v_exp_f32 v81, v81
v_exp_f32 v82, v82
v_exp_f32 v83, v83
v_mul_f32 v181, v181, v183
v_cvt_pk_bf16_f32 v188, v80, v81
v_cvt_pk_bf16_f32 v189, v82, v83
ds_write_b64 v201, v[188:189] offset:512
v_add_f32 v181, v181, v80
v_add_f32 v181, v181, v81
v_add_f32 v181, v181, v82
v_add_f32 v181, v181, v83
v_mul_f32 v12, v12, v184
v_mul_f32 v13, v13, v184
v_mul_f32 v14, v14, v184
v_mul_f32 v15, v15, v184
v_mul_f32 v16, v16, v184
v_mul_f32 v17, v17, v184
v_mul_f32 v18, v18, v184
v_mul_f32 v19, v19, v184
v_mul_f32 v20, v20, v184
v_mul_f32 v21, v21, v184
v_mul_f32 v22, v22, v184
v_mul_f32 v23, v23, v184
v_mul_f32 v24, v24, v184
v_mul_f32 v25, v25, v184
v_mul_f32 v26, v26, v184
v_mul_f32 v27, v27, v184
v_mul_f32 v28, v28, v184
v_mul_f32 v29, v29, v184
v_mul_f32 v30, v30, v184
v_mul_f32 v31, v31, v184
v_mul_f32 v32, v32, v184
v_mul_f32 v33, v33, v184
v_mul_f32 v34, v34, v184
v_mul_f32 v35, v35, v184
v_mul_f32 v36, v36, v184
v_mul_f32 v37, v37, v184
v_mul_f32 v38, v38, v184
v_mul_f32 v39, v39, v184
v_mul_f32 v40, v40, v184
v_mul_f32 v41, v41, v184
v_mul_f32 v42, v42, v184
v_mul_f32 v43, v43, v184
v_mul_f32 v44, v44, v184
v_mul_f32 v45, v45, v184
v_mul_f32 v46, v46, v184
v_mul_f32 v47, v47, v184
v_mul_f32 v48, v48, v184
v_mul_f32 v49, v49, v184
v_mul_f32 v50, v50, v184
v_mul_f32 v51, v51, v184
v_mul_f32 v52, v52, v184
v_mul_f32 v53, v53, v184
v_mul_f32 v54, v54, v184
v_mul_f32 v55, v55, v184
v_mul_f32 v56, v56, v184
v_mul_f32 v57, v57, v184
v_mul_f32 v58, v58, v184
v_mul_f32 v59, v59, v184
v_mul_f32 v60, v60, v184
v_mul_f32 v61, v61, v184
v_mul_f32 v62, v62, v184
v_mul_f32 v63, v63, v184
v_mul_f32 v64, v64, v184
v_mul_f32 v65, v65, v184
v_mul_f32 v66, v66, v184
v_mul_f32 v67, v67, v184
v_mul_f32 v68, v68, v184
v_mul_f32 v69, v69, v184
v_mul_f32 v70, v70, v184
v_mul_f32 v71, v71, v184
v_mul_f32 v72, v72, v184
v_mul_f32 v73, v73, v184
v_mul_f32 v74, v74, v184
v_mul_f32 v75, v75, v184
s_waitcnt lgkmcnt(0)
s_barrier
ds_read_b128 v[148:151], v202 offset:0
ds_read_b128 v[152:155], v202 offset:1024
ds_read_b128 v[156:159], v202 offset:2048
ds_read_b128 v[160:163], v202 offset:3072
ds_read_b64_tr_b16 v[84:85], v197 offset:0
ds_read_b64_tr_b16 v[86:87], v197 offset:4352
ds_read_b64_tr_b16 v[88:89], v197 offset:64
ds_read_b64_tr_b16 v[90:91], v197 offset:4416
ds_read_b64_tr_b16 v[92:93], v197 offset:128
ds_read_b64_tr_b16 v[94:95], v197 offset:4480
ds_read_b64_tr_b16 v[96:97], v197 offset:192
ds_read_b64_tr_b16 v[98:99], v197 offset:4544
ds_read_b64_tr_b16 v[100:101], v197 offset:17408
ds_read_b64_tr_b16 v[102:103], v197 offset:21760
ds_read_b64_tr_b16 v[104:105], v197 offset:17472
ds_read_b64_tr_b16 v[106:107], v197 offset:21824
ds_read_b64_tr_b16 v[108:109], v197 offset:17536
ds_read_b64_tr_b16 v[110:111], v197 offset:21888
ds_read_b64_tr_b16 v[112:113], v197 offset:17600
ds_read_b64_tr_b16 v[114:115], v197 offset:21952
ds_read_b64_tr_b16 v[116:117], v197 offset:34816
ds_read_b64_tr_b16 v[118:119], v197 offset:39168
ds_read_b64_tr_b16 v[120:121], v197 offset:34880
ds_read_b64_tr_b16 v[122:123], v197 offset:39232
ds_read_b64_tr_b16 v[124:125], v197 offset:34944
ds_read_b64_tr_b16 v[126:127], v197 offset:39296
ds_read_b64_tr_b16 v[128:129], v197 offset:35008
ds_read_b64_tr_b16 v[130:131], v197 offset:39360
ds_read_b64_tr_b16 v[132:133], v197 offset:52224
ds_read_b64_tr_b16 v[134:135], v197 offset:56576
ds_read_b64_tr_b16 v[136:137], v197 offset:52288
ds_read_b64_tr_b16 v[138:139], v197 offset:56640
ds_read_b64_tr_b16 v[140:141], v197 offset:52352
ds_read_b64_tr_b16 v[142:143], v197 offset:56704
ds_read_b64_tr_b16 v[144:145], v197 offset:52416
ds_read_b64_tr_b16 v[146:147], v197 offset:56768
s_waitcnt lgkmcnt(15)
v_mfma_f32_32x32x16_bf16 v[12:27], v[84:87], v[148:151], v[12:27]
v_mfma_f32_32x32x16_bf16 v[28:43], v[88:91], v[148:151], v[28:43]
v_mfma_f32_32x32x16_bf16 v[44:59], v[92:95], v[148:151], v[44:59]
v_mfma_f32_32x32x16_bf16 v[60:75], v[96:99], v[148:151], v[60:75]
s_waitcnt lgkmcnt(15)
v_mfma_f32_32x32x16_bf16 v[12:27], v[100:103], v[152:155], v[12:27]
v_mfma_f32_32x32x16_bf16 v[28:43], v[104:107], v[152:155], v[28:43]
v_mfma_f32_32x32x16_bf16 v[44:59], v[108:111], v[152:155], v[44:59]
v_mfma_f32_32x32x16_bf16 v[60:75], v[112:115], v[152:155], v[60:75]
s_waitcnt lgkmcnt(8)
v_mfma_f32_32x32x16_bf16 v[12:27], v[116:119], v[156:159], v[12:27]
v_mfma_f32_32x32x16_bf16 v[28:43], v[120:123], v[156:159], v[28:43]
v_mfma_f32_32x32x16_bf16 v[44:59], v[124:127], v[156:159], v[44:59]
v_mfma_f32_32x32x16_bf16 v[60:75], v[128:131], v[156:159], v[60:75]
s_waitcnt lgkmcnt(0)
v_mfma_f32_32x32x16_bf16 v[12:27], v[132:135], v[160:163], v[12:27]
v_mfma_f32_32x32x16_bf16 v[28:43], v[136:139], v[160:163], v[28:43]
v_mfma_f32_32x32x16_bf16 v[44:59], v[140:143], v[160:163], v[44:59]
v_mfma_f32_32x32x16_bf16 v[60:75], v[144:147], v[160:163], v[60:75]
ds_read_b128 v[84:87], v194 offset:0
ds_read_b128 v[88:91], v194 offset:64
ds_read_b128 v[92:95], v194 offset:128
ds_read_b128 v[96:99], v194 offset:192
ds_read_b128 v[100:103], v194 offset:256
ds_read_b128 v[104:107], v194 offset:320
ds_read_b128 v[108:111], v194 offset:384
ds_read_b128 v[112:115], v194 offset:448
ds_read_b128 v[116:119], v194 offset:512
ds_read_b128 v[120:123], v194 offset:576
ds_read_b128 v[124:127], v194 offset:640
ds_read_b128 v[128:131], v194 offset:704
ds_read_b128 v[132:135], v194 offset:768
ds_read_b128 v[136:139], v194 offset:832
ds_read_b128 v[140:143], v194 offset:896
ds_read_b128 v[144:147], v194 offset:960
s_waitcnt lgkmcnt(15)
v_mfma_f32_16x16x32_bf16 v[76:79], v[84:87], a[0:3], 0
v_mfma_f32_16x16x32_bf16 v[80:83], v[84:87], a[64:67], 0
s_waitcnt lgkmcnt(14)
v_mfma_f32_16x16x32_bf16 v[76:79], v[88:91], a[4:7], v[76:79]
v_mfma_f32_16x16x32_bf16 v[80:83], v[88:91], a[68:71], v[80:83]
s_waitcnt lgkmcnt(13)
v_mfma_f32_16x16x32_bf16 v[76:79], v[92:95], a[8:11], v[76:79]
v_mfma_f32_16x16x32_bf16 v[80:83], v[92:95], a[72:75], v[80:83]
s_waitcnt lgkmcnt(12)
v_mfma_f32_16x16x32_bf16 v[76:79], v[96:99], a[12:15], v[76:79]
v_mfma_f32_16x16x32_bf16 v[80:83], v[96:99], a[76:79], v[80:83]
s_waitcnt lgkmcnt(11)
v_mfma_f32_16x16x32_bf16 v[76:79], v[100:103], a[16:19], v[76:79]
v_mfma_f32_16x16x32_bf16 v[80:83], v[100:103], a[80:83], v[80:83]
s_waitcnt lgkmcnt(10)
v_mfma_f32_16x16x32_bf16 v[76:79], v[104:107], a[20:23], v[76:79]
v_mfma_f32_16x16x32_bf16 v[80:83], v[104:107], a[84:87], v[80:83]
s_waitcnt lgkmcnt(9)
v_mfma_f32_16x16x32_bf16 v[76:79], v[108:111], a[24:27], v[76:79]
v_mfma_f32_16x16x32_bf16 v[80:83], v[108:111], a[88:91], v[80:83]
s_waitcnt lgkmcnt(8)
v_mfma_f32_16x16x32_bf16 v[76:79], v[112:115], a[28:31], v[76:79]
v_mfma_f32_16x16x32_bf16 v[80:83], v[112:115], a[92:95], v[80:83]
s_waitcnt lgkmcnt(7)
v_mfma_f32_16x16x32_bf16 v[76:79], v[116:119], a[32:35], v[76:79]
v_mfma_f32_16x16x32_bf16 v[80:83], v[116:119], a[96:99], v[80:83]
s_waitcnt lgkmcnt(6)
v_mfma_f32_16x16x32_bf16 v[76:79], v[120:123], a[36:39], v[76:79]
v_mfma_f32_16x16x32_bf16 v[80:83], v[120:123], a[100:103], v[80:83]
s_waitcnt lgkmcnt(5)
v_mfma_f32_16x16x32_bf16 v[76:79], v[124:127], a[40:43], v[76:79]
v_mfma_f32_16x16x32_bf16 v[80:83], v[124:127], a[104:107], v[80:83]
s_waitcnt lgkmcnt(4)
v_mfma_f32_16x16x32_bf16 v[76:79], v[128:131], a[44:47], v[76:79]
v_mfma_f32_16x16x32_bf16 v[80:83], v[128:131], a[108:111], v[80:83]
s_waitcnt lgkmcnt(3)
v_mfma_f32_16x16x32_bf16 v[76:79], v[132:135], a[48:51], v[76:79]
v_mfma_f32_16x16x32_bf16 v[80:83], v[132:135], a[112:115], v[80:83]
s_waitcnt lgkmcnt(2)
v_mfma_f32_16x16x32_bf16 v[76:79], v[136:139], a[52:55], v[76:79]
v_mfma_f32_16x16x32_bf16 v[80:83], v[136:139], a[116:119], v[80:83]
s_waitcnt lgkmcnt(1)
v_mfma_f32_16x16x32_bf16 v[76:79], v[140:143], a[56:59], v[76:79]
v_mfma_f32_16x16x32_bf16 v[80:83], v[140:143], a[120:123], v[80:83]
s_waitcnt lgkmcnt(0)
v_mfma_f32_16x16x32_bf16 v[76:79], v[144:147], a[60:63], v[76:79]
v_mfma_f32_16x16x32_bf16 v[80:83], v[144:147], a[124:127], v[80:83]
s_nop 6
v_max_f32 v190, v76, v77
v_max3_f32 v190, v190, v78, v79
v_mov_b32 v192, v190
s_nop 1
v_permlane16_swap_b32 v190, v192
v_max_f32 v190, v190, v192
v_mov_b32 v192, v190
s_nop 1
v_permlane32_swap_b32 v190, v192
v_max_f32 v190, v190, v192
ds_write_b32 v198, v190 offset:0
v_max_f32 v191, v80, v81
v_max3_f32 v191, v191, v82, v83
v_mov_b32 v192, v191
s_nop 1
v_permlane16_swap_b32 v191, v192
v_max_f32 v191, v191, v192
v_mov_b32 v192, v191
s_nop 1
v_permlane32_swap_b32 v191, v192
v_max_f32 v191, v191, v192
ds_write_b32 v198, v191 offset:256
s_waitcnt lgkmcnt(0)
s_barrier
ds_read_b128 v[164:167], v199
ds_read_b128 v[168:171], v199 offset:256
ds_read_b128 v[172:175], v200
s_waitcnt vmcnt(0)
ds_write_b128 v207, a[192:195] offset:0
ds_write_b128 v207, a[196:199] offset:1088
ds_write_b128 v207, a[200:203] offset:2176
ds_write_b128 v207, a[204:207] offset:3264
ds_write_b128 v207, a[208:211] offset:4352
ds_write_b128 v207, a[212:215] offset:5440
ds_write_b128 v207, a[216:219] offset:6528
ds_write_b128 v207, a[220:223] offset:7616
ds_write_b128 v207, a[224:227] offset:8704
ds_write_b128 v207, a[228:231] offset:9792
ds_write_b128 v207, a[232:235] offset:10880
ds_write_b128 v207, a[236:239] offset:11968
ds_write_b128 v207, a[240:243] offset:13056
ds_write_b128 v207, a[244:247] offset:14144
ds_write_b128 v207, a[248:251] offset:15232
ds_write_b128 v207, a[252:255] offset:16320
s_waitcnt lgkmcnt(15)
v_max_f32 v164, v164, v165
v_max3_f32 v164, v164, v166, v167
v_mul_f32 v164, v164, v185
v_max_f32 v164, v164, v176
v_sub_f32 v182, v176, v164
v_exp_f32 v182, v182
v_mov_b32 v176, v164
v_max_f32 v168, v168, v169
v_max3_f32 v168, v168, v170, v171
v_mul_f32 v168, v168, v185
v_max_f32 v168, v168, v177
v_sub_f32 v183, v177, v168
v_exp_f32 v183, v183
v_mov_b32 v177, v168
v_max_f32 v172, v172, v173
v_max3_f32 v172, v172, v174, v175
v_mul_f32 v172, v172, v185
v_max_f32 v172, v172, v178
v_sub_f32 v184, v178, v172
v_exp_f32 v184, v184
v_mov_b32 v178, v172
v_fma_f32 v76, v76, v185, -v176
v_fma_f32 v77, v77, v185, -v176
v_fma_f32 v78, v78, v185, -v176
v_fma_f32 v79, v79, v185, -v176
v_exp_f32 v76, v76
v_exp_f32 v77, v77
v_exp_f32 v78, v78
v_exp_f32 v79, v79
v_mul_f32 v180, v180, v182
v_cvt_pk_bf16_f32 v186, v76, v77
v_cvt_pk_bf16_f32 v187, v78, v79
ds_write_b64 v201, v[186:187] offset:0
v_add_f32 v180, v180, v76
v_add_f32 v180, v180, v77
v_add_f32 v180, v180, v78
v_add_f32 v180, v180, v79
v_fma_f32 v80, v80, v185, -v177
v_fma_f32 v81, v81, v185, -v177
v_fma_f32 v82, v82, v185, -v177
v_fma_f32 v83, v83, v185, -v177
v_exp_f32 v80, v80
v_exp_f32 v81, v81
v_exp_f32 v82, v82
v_exp_f32 v83, v83
v_mul_f32 v181, v181, v183
v_cvt_pk_bf16_f32 v188, v80, v81
v_cvt_pk_bf16_f32 v189, v82, v83
ds_write_b64 v201, v[188:189] offset:512
v_add_f32 v181, v181, v80
v_add_f32 v181, v181, v81
v_add_f32 v181, v181, v82
v_add_f32 v181, v181, v83
v_mul_f32 v12, v12, v184
v_mul_f32 v13, v13, v184
v_mul_f32 v14, v14, v184
v_mul_f32 v15, v15, v184
v_mul_f32 v16, v16, v184
v_mul_f32 v17, v17, v184
v_mul_f32 v18, v18, v184
v_mul_f32 v19, v19, v184
v_mul_f32 v20, v20, v184
v_mul_f32 v21, v21, v184
v_mul_f32 v22, v22, v184
v_mul_f32 v23, v23, v184
v_mul_f32 v24, v24, v184
v_mul_f32 v25, v25, v184
v_mul_f32 v26, v26, v184
v_mul_f32 v27, v27, v184
v_mul_f32 v28, v28, v184
v_mul_f32 v29, v29, v184
v_mul_f32 v30, v30, v184
v_mul_f32 v31, v31, v184
v_mul_f32 v32, v32, v184
v_mul_f32 v33, v33, v184
v_mul_f32 v34, v34, v184
v_mul_f32 v35, v35, v184
v_mul_f32 v36, v36, v184
v_mul_f32 v37, v37, v184
v_mul_f32 v38, v38, v184
v_mul_f32 v39, v39, v184
v_mul_f32 v40, v40, v184
v_mul_f32 v41, v41, v184
v_mul_f32 v42, v42, v184
v_mul_f32 v43, v43, v184
v_mul_f32 v44, v44, v184
v_mul_f32 v45, v45, v184
v_mul_f32 v46, v46, v184
v_mul_f32 v47, v47, v184
v_mul_f32 v48, v48, v184
v_mul_f32 v49, v49, v184
v_mul_f32 v50, v50, v184
v_mul_f32 v51, v51, v184
v_mul_f32 v52, v52, v184
v_mul_f32 v53, v53, v184
v_mul_f32 v54, v54, v184
v_mul_f32 v55, v55, v184
v_mul_f32 v56, v56, v184
v_mul_f32 v57, v57, v184
v_mul_f32 v58, v58, v184
v_mul_f32 v59, v59, v184
v_mul_f32 v60, v60, v184
v_mul_f32 v61, v61, v184
v_mul_f32 v62, v62, v184
v_mul_f32 v63, v63, v184
v_mul_f32 v64, v64, v184
v_mul_f32 v65, v65, v184
v_mul_f32 v66, v66, v184
v_mul_f32 v67, v67, v184
v_mul_f32 v68, v68, v184
v_mul_f32 v69, v69, v184
v_mul_f32 v70, v70, v184
v_mul_f32 v71, v71, v184
v_mul_f32 v72, v72, v184
v_mul_f32 v73, v73, v184
v_mul_f32 v74, v74, v184
v_mul_f32 v75, v75, v184
s_waitcnt lgkmcnt(0)
s_barrier
ds_read_b128 v[148:151], v202 offset:0
ds_read_b128 v[152:155], v202 offset:1024
ds_read_b128 v[156:159], v202 offset:2048
ds_read_b128 v[160:163], v202 offset:3072
ds_read_b64_tr_b16 v[84:85], v196 offset:0
ds_read_b64_tr_b16 v[86:87], v196 offset:4352
ds_read_b64_tr_b16 v[88:89], v196 offset:64
ds_read_b64_tr_b16 v[90:91], v196 offset:4416
ds_read_b64_tr_b16 v[92:93], v196 offset:128
ds_read_b64_tr_b16 v[94:95], v196 offset:4480
ds_read_b64_tr_b16 v[96:97], v196 offset:192
ds_read_b64_tr_b16 v[98:99], v196 offset:4544
ds_read_b64_tr_b16 v[100:101], v196 offset:17408
ds_read_b64_tr_b16 v[102:103], v196 offset:21760
ds_read_b64_tr_b16 v[104:105], v196 offset:17472
ds_read_b64_tr_b16 v[106:107], v196 offset:21824
ds_read_b64_tr_b16 v[108:109], v196 offset:17536
ds_read_b64_tr_b16 v[110:111], v196 offset:21888
ds_read_b64_tr_b16 v[112:113], v196 offset:17600
ds_read_b64_tr_b16 v[114:115], v196 offset:21952
ds_read_b64_tr_b16 v[116:117], v196 offset:34816
ds_read_b64_tr_b16 v[118:119], v196 offset:39168
ds_read_b64_tr_b16 v[120:121], v196 offset:34880
ds_read_b64_tr_b16 v[122:123], v196 offset:39232
ds_read_b64_tr_b16 v[124:125], v196 offset:34944
ds_read_b64_tr_b16 v[126:127], v196 offset:39296
ds_read_b64_tr_b16 v[128:129], v196 offset:35008
ds_read_b64_tr_b16 v[130:131], v196 offset:39360
ds_read_b64_tr_b16 v[132:133], v196 offset:52224
ds_read_b64_tr_b16 v[134:135], v196 offset:56576
ds_read_b64_tr_b16 v[136:137], v196 offset:52288
ds_read_b64_tr_b16 v[138:139], v196 offset:56640
ds_read_b64_tr_b16 v[140:141], v196 offset:52352
ds_read_b64_tr_b16 v[142:143], v196 offset:56704
ds_read_b64_tr_b16 v[144:145], v196 offset:52416
ds_read_b64_tr_b16 v[146:147], v196 offset:56768
s_waitcnt lgkmcnt(15)
v_mfma_f32_32x32x16_bf16 v[12:27], v[84:87], v[148:151], v[12:27]
v_mfma_f32_32x32x16_bf16 v[28:43], v[88:91], v[148:151], v[28:43]
v_mfma_f32_32x32x16_bf16 v[44:59], v[92:95], v[148:151], v[44:59]
v_mfma_f32_32x32x16_bf16 v[60:75], v[96:99], v[148:151], v[60:75]
s_waitcnt lgkmcnt(15)
v_mfma_f32_32x32x16_bf16 v[12:27], v[100:103], v[152:155], v[12:27]
v_mfma_f32_32x32x16_bf16 v[28:43], v[104:107], v[152:155], v[28:43]
v_mfma_f32_32x32x16_bf16 v[44:59], v[108:111], v[152:155], v[44:59]
v_mfma_f32_32x32x16_bf16 v[60:75], v[112:115], v[152:155], v[60:75]
s_waitcnt lgkmcnt(8)
v_mfma_f32_32x32x16_bf16 v[12:27], v[116:119], v[156:159], v[12:27]
v_mfma_f32_32x32x16_bf16 v[28:43], v[120:123], v[156:159], v[28:43]
v_mfma_f32_32x32x16_bf16 v[44:59], v[124:127], v[156:159], v[44:59]
v_mfma_f32_32x32x16_bf16 v[60:75], v[128:131], v[156:159], v[60:75]
s_waitcnt lgkmcnt(0)
v_mfma_f32_32x32x16_bf16 v[12:27], v[132:135], v[160:163], v[12:27]
v_mfma_f32_32x32x16_bf16 v[28:43], v[136:139], v[160:163], v[28:43]
v_mfma_f32_32x32x16_bf16 v[44:59], v[140:143], v[160:163], v[44:59]
v_mfma_f32_32x32x16_bf16 v[60:75], v[144:147], v[160:163], v[60:75]
ds_read_b128 v[84:87], v195 offset:0
ds_read_b128 v[88:91], v195 offset:64
ds_read_b128 v[92:95], v195 offset:128
ds_read_b128 v[96:99], v195 offset:192
ds_read_b128 v[100:103], v195 offset:256
ds_read_b128 v[104:107], v195 offset:320
ds_read_b128 v[108:111], v195 offset:384
ds_read_b128 v[112:115], v195 offset:448
ds_read_b128 v[116:119], v195 offset:512
ds_read_b128 v[120:123], v195 offset:576
ds_read_b128 v[124:127], v195 offset:640
ds_read_b128 v[128:131], v195 offset:704
ds_read_b128 v[132:135], v195 offset:768
ds_read_b128 v[136:139], v195 offset:832
ds_read_b128 v[140:143], v195 offset:896
ds_read_b128 v[144:147], v195 offset:960
s_waitcnt lgkmcnt(15)
v_mfma_f32_16x16x32_bf16 v[76:79], v[84:87], a[0:3], 0
v_mfma_f32_16x16x32_bf16 v[80:83], v[84:87], a[64:67], 0
s_waitcnt lgkmcnt(14)
v_mfma_f32_16x16x32_bf16 v[76:79], v[88:91], a[4:7], v[76:79]
v_mfma_f32_16x16x32_bf16 v[80:83], v[88:91], a[68:71], v[80:83]
s_waitcnt lgkmcnt(13)
v_mfma_f32_16x16x32_bf16 v[76:79], v[92:95], a[8:11], v[76:79]
v_mfma_f32_16x16x32_bf16 v[80:83], v[92:95], a[72:75], v[80:83]
s_waitcnt lgkmcnt(12)
v_mfma_f32_16x16x32_bf16 v[76:79], v[96:99], a[12:15], v[76:79]
v_mfma_f32_16x16x32_bf16 v[80:83], v[96:99], a[76:79], v[80:83]
s_waitcnt lgkmcnt(11)
v_mfma_f32_16x16x32_bf16 v[76:79], v[100:103], a[16:19], v[76:79]
v_mfma_f32_16x16x32_bf16 v[80:83], v[100:103], a[80:83], v[80:83]
s_waitcnt lgkmcnt(10)
v_mfma_f32_16x16x32_bf16 v[76:79], v[104:107], a[20:23], v[76:79]
v_mfma_f32_16x16x32_bf16 v[80:83], v[104:107], a[84:87], v[80:83]
s_waitcnt lgkmcnt(9)
v_mfma_f32_16x16x32_bf16 v[76:79], v[108:111], a[24:27], v[76:79]
v_mfma_f32_16x16x32_bf16 v[80:83], v[108:111], a[88:91], v[80:83]
s_waitcnt lgkmcnt(8)
v_mfma_f32_16x16x32_bf16 v[76:79], v[112:115], a[28:31], v[76:79]
v_mfma_f32_16x16x32_bf16 v[80:83], v[112:115], a[92:95], v[80:83]
s_waitcnt lgkmcnt(7)
v_mfma_f32_16x16x32_bf16 v[76:79], v[116:119], a[32:35], v[76:79]
v_mfma_f32_16x16x32_bf16 v[80:83], v[116:119], a[96:99], v[80:83]
s_waitcnt lgkmcnt(6)
v_mfma_f32_16x16x32_bf16 v[76:79], v[120:123], a[36:39], v[76:79]
v_mfma_f32_16x16x32_bf16 v[80:83], v[120:123], a[100:103], v[80:83]
s_waitcnt lgkmcnt(5)
v_mfma_f32_16x16x32_bf16 v[76:79], v[124:127], a[40:43], v[76:79]
v_mfma_f32_16x16x32_bf16 v[80:83], v[124:127], a[104:107], v[80:83]
s_waitcnt lgkmcnt(4)
v_mfma_f32_16x16x32_bf16 v[76:79], v[128:131], a[44:47], v[76:79]
v_mfma_f32_16x16x32_bf16 v[80:83], v[128:131], a[108:111], v[80:83]
s_waitcnt lgkmcnt(3)
v_mfma_f32_16x16x32_bf16 v[76:79], v[132:135], a[48:51], v[76:79]
v_mfma_f32_16x16x32_bf16 v[80:83], v[132:135], a[112:115], v[80:83]
s_waitcnt lgkmcnt(2)
v_mfma_f32_16x16x32_bf16 v[76:79], v[136:139], a[52:55], v[76:79]
v_mfma_f32_16x16x32_bf16 v[80:83], v[136:139], a[116:119], v[80:83]
s_waitcnt lgkmcnt(1)
v_mfma_f32_16x16x32_bf16 v[76:79], v[140:143], a[56:59], v[76:79]
v_mfma_f32_16x16x32_bf16 v[80:83], v[140:143], a[120:123], v[80:83]
s_waitcnt lgkmcnt(0)
v_mfma_f32_16x16x32_bf16 v[76:79], v[144:147], a[60:63], v[76:79]
v_mfma_f32_16x16x32_bf16 v[80:83], v[144:147], a[124:127], v[80:83]
s_nop 6
v_max_f32 v190, v76, v77
v_max3_f32 v190, v190, v78, v79
v_mov_b32 v192, v190
s_nop 1
v_permlane16_swap_b32 v190, v192
v_max_f32 v190, v190, v192
v_mov_b32 v192, v190
s_nop 1
v_permlane32_swap_b32 v190, v192
v_max_f32 v190, v190, v192
ds_write_b32 v198, v190 offset:0
v_max_f32 v191, v80, v81
v_max3_f32 v191, v191, v82, v83
v_mov_b32 v192, v191
s_nop 1
v_permlane16_swap_b32 v191, v192
v_max_f32 v191, v191, v192
v_mov_b32 v192, v191
s_nop 1
v_permlane32_swap_b32 v191, v192
v_max_f32 v191, v191, v192
ds_write_b32 v198, v191 offset:256
s_waitcnt lgkmcnt(0)
s_barrier
ds_read_b128 v[164:167], v199
ds_read_b128 v[168:171], v199 offset:256
ds_read_b128 v[172:175], v200
s_waitcnt lgkmcnt(0)
v_max_f32 v164, v164, v165
v_max3_f32 v164, v164, v166, v167
v_mul_f32 v164, v164, v185
v_max_f32 v164, v164, v176
v_sub_f32 v182, v176, v164
v_exp_f32 v182, v182
v_mov_b32 v176, v164
v_max_f32 v168, v168, v169
v_max3_f32 v168, v168, v170, v171
v_mul_f32 v168, v168, v185
v_max_f32 v168, v168, v177
v_sub_f32 v183, v177, v168
v_exp_f32 v183, v183
v_mov_b32 v177, v168
v_max_f32 v172, v172, v173
v_max3_f32 v172, v172, v174, v175
v_mul_f32 v172, v172, v185
v_max_f32 v172, v172, v178
v_sub_f32 v184, v178, v172
v_exp_f32 v184, v184
v_mov_b32 v178, v172
v_fma_f32 v76, v76, v185, -v176
v_fma_f32 v77, v77, v185, -v176
v_fma_f32 v78, v78, v185, -v176
v_fma_f32 v79, v79, v185, -v176
v_exp_f32 v76, v76
v_exp_f32 v77, v77
v_exp_f32 v78, v78
v_exp_f32 v79, v79
v_mul_f32 v180, v180, v182
v_cvt_pk_bf16_f32 v186, v76, v77
v_cvt_pk_bf16_f32 v187, v78, v79
ds_write_b64 v201, v[186:187] offset:0
v_add_f32 v180, v180, v76
v_add_f32 v180, v180, v77
v_add_f32 v180, v180, v78
v_add_f32 v180, v180, v79
v_fma_f32 v80, v80, v185, -v177
v_fma_f32 v81, v81, v185, -v177
v_fma_f32 v82, v82, v185, -v177
v_fma_f32 v83, v83, v185, -v177
v_exp_f32 v80, v80
v_exp_f32 v81, v81
v_exp_f32 v82, v82
v_exp_f32 v83, v83
v_mul_f32 v181, v181, v183
v_cvt_pk_bf16_f32 v188, v80, v81
v_cvt_pk_bf16_f32 v189, v82, v83
ds_write_b64 v201, v[188:189] offset:512
v_add_f32 v181, v181, v80
v_add_f32 v181, v181, v81
v_add_f32 v181, v181, v82
v_add_f32 v181, v181, v83
v_mul_f32 v12, v12, v184
v_mul_f32 v13, v13, v184
v_mul_f32 v14, v14, v184
v_mul_f32 v15, v15, v184
v_mul_f32 v16, v16, v184
v_mul_f32 v17, v17, v184
v_mul_f32 v18, v18, v184
v_mul_f32 v19, v19, v184
v_mul_f32 v20, v20, v184
v_mul_f32 v21, v21, v184
v_mul_f32 v22, v22, v184
v_mul_f32 v23, v23, v184
v_mul_f32 v24, v24, v184
v_mul_f32 v25, v25, v184
v_mul_f32 v26, v26, v184
v_mul_f32 v27, v27, v184
v_mul_f32 v28, v28, v184
v_mul_f32 v29, v29, v184
v_mul_f32 v30, v30, v184
v_mul_f32 v31, v31, v184
v_mul_f32 v32, v32, v184
v_mul_f32 v33, v33, v184
v_mul_f32 v34, v34, v184
v_mul_f32 v35, v35, v184
v_mul_f32 v36, v36, v184
v_mul_f32 v37, v37, v184
v_mul_f32 v38, v38, v184
v_mul_f32 v39, v39, v184
v_mul_f32 v40, v40, v184
v_mul_f32 v41, v41, v184
v_mul_f32 v42, v42, v184
v_mul_f32 v43, v43, v184
v_mul_f32 v44, v44, v184
v_mul_f32 v45, v45, v184
v_mul_f32 v46, v46, v184
v_mul_f32 v47, v47, v184
v_mul_f32 v48, v48, v184
v_mul_f32 v49, v49, v184
v_mul_f32 v50, v50, v184
v_mul_f32 v51, v51, v184
v_mul_f32 v52, v52, v184
v_mul_f32 v53, v53, v184
v_mul_f32 v54, v54, v184
v_mul_f32 v55, v55, v184
v_mul_f32 v56, v56, v184
v_mul_f32 v57, v57, v184
v_mul_f32 v58, v58, v184
v_mul_f32 v59, v59, v184
v_mul_f32 v60, v60, v184
v_mul_f32 v61, v61, v184
v_mul_f32 v62, v62, v184
v_mul_f32 v63, v63, v184
v_mul_f32 v64, v64, v184
v_mul_f32 v65, v65, v184
v_mul_f32 v66, v66, v184
v_mul_f32 v67, v67, v184
v_mul_f32 v68, v68, v184
v_mul_f32 v69, v69, v184
v_mul_f32 v70, v70, v184
v_mul_f32 v71, v71, v184
v_mul_f32 v72, v72, v184
v_mul_f32 v73, v73, v184
v_mul_f32 v74, v74, v184
v_mul_f32 v75, v75, v184
s_waitcnt lgkmcnt(0)
s_barrier
ds_read_b128 v[148:151], v202 offset:0
ds_read_b128 v[152:155], v202 offset:1024
ds_read_b128 v[156:159], v202 offset:2048
ds_read_b128 v[160:163], v202 offset:3072
ds_read_b64_tr_b16 v[84:85], v197 offset:0
ds_read_b64_tr_b16 v[86:87], v197 offset:4352
ds_read_b64_tr_b16 v[88:89], v197 offset:64
ds_read_b64_tr_b16 v[90:91], v197 offset:4416
ds_read_b64_tr_b16 v[92:93], v197 offset:128
ds_read_b64_tr_b16 v[94:95], v197 offset:4480
ds_read_b64_tr_b16 v[96:97], v197 offset:192
ds_read_b64_tr_b16 v[98:99], v197 offset:4544
ds_read_b64_tr_b16 v[100:101], v197 offset:17408
ds_read_b64_tr_b16 v[102:103], v197 offset:21760
ds_read_b64_tr_b16 v[104:105], v197 offset:17472
ds_read_b64_tr_b16 v[106:107], v197 offset:21824
ds_read_b64_tr_b16 v[108:109], v197 offset:17536
ds_read_b64_tr_b16 v[110:111], v197 offset:21888
ds_read_b64_tr_b16 v[112:113], v197 offset:17600
ds_read_b64_tr_b16 v[114:115], v197 offset:21952
ds_read_b64_tr_b16 v[116:117], v197 offset:34816
ds_read_b64_tr_b16 v[118:119], v197 offset:39168
ds_read_b64_tr_b16 v[120:121], v197 offset:34880
ds_read_b64_tr_b16 v[122:123], v197 offset:39232
ds_read_b64_tr_b16 v[124:125], v197 offset:34944
ds_read_b64_tr_b16 v[126:127], v197 offset:39296
ds_read_b64_tr_b16 v[128:129], v197 offset:35008
ds_read_b64_tr_b16 v[130:131], v197 offset:39360
ds_read_b64_tr_b16 v[132:133], v197 offset:52224
ds_read_b64_tr_b16 v[134:135], v197 offset:56576
ds_read_b64_tr_b16 v[136:137], v197 offset:52288
ds_read_b64_tr_b16 v[138:139], v197 offset:56640
ds_read_b64_tr_b16 v[140:141], v197 offset:52352
ds_read_b64_tr_b16 v[142:143], v197 offset:56704
ds_read_b64_tr_b16 v[144:145], v197 offset:52416
ds_read_b64_tr_b16 v[146:147], v197 offset:56768
s_waitcnt lgkmcnt(15)
v_mfma_f32_32x32x16_bf16 v[12:27], v[84:87], v[148:151], v[12:27]
v_mfma_f32_32x32x16_bf16 v[28:43], v[88:91], v[148:151], v[28:43]
v_mfma_f32_32x32x16_bf16 v[44:59], v[92:95], v[148:151], v[44:59]
v_mfma_f32_32x32x16_bf16 v[60:75], v[96:99], v[148:151], v[60:75]
s_waitcnt lgkmcnt(15)
v_mfma_f32_32x32x16_bf16 v[12:27], v[100:103], v[152:155], v[12:27]
v_mfma_f32_32x32x16_bf16 v[28:43], v[104:107], v[152:155], v[28:43]
v_mfma_f32_32x32x16_bf16 v[44:59], v[108:111], v[152:155], v[44:59]
v_mfma_f32_32x32x16_bf16 v[60:75], v[112:115], v[152:155], v[60:75]
s_waitcnt lgkmcnt(8)
v_mfma_f32_32x32x16_bf16 v[12:27], v[116:119], v[156:159], v[12:27]
v_mfma_f32_32x32x16_bf16 v[28:43], v[120:123], v[156:159], v[28:43]
v_mfma_f32_32x32x16_bf16 v[44:59], v[124:127], v[156:159], v[44:59]
v_mfma_f32_32x32x16_bf16 v[60:75], v[128:131], v[156:159], v[60:75]
s_waitcnt lgkmcnt(0)
v_mfma_f32_32x32x16_bf16 v[12:27], v[132:135], v[160:163], v[12:27]
v_mfma_f32_32x32x16_bf16 v[28:43], v[136:139], v[160:163], v[28:43]
v_mfma_f32_32x32x16_bf16 v[44:59], v[140:143], v[160:163], v[44:59]
v_mfma_f32_32x32x16_bf16 v[60:75], v[144:147], v[160:163], v[60:75]
v_mov_b32 v192, v180
s_nop 1
v_permlane16_swap_b32 v180, v192
v_add_f32 v180, v180, v192
v_mov_b32 v192, v180
s_nop 1
v_permlane32_swap_b32 v180, v192
v_add_f32 v180, v180, v192
ds_write_b32 v198, v180 offset:512
v_mov_b32 v192, v181
s_nop 1
v_permlane16_swap_b32 v181, v192
v_add_f32 v181, v181, v192
v_mov_b32 v192, v181
s_nop 1
v_permlane32_swap_b32 v181, v192
v_add_f32 v181, v181, v192
ds_write_b32 v198, v181 offset:768
v_and_b32 v5, 31, v1
v_mul_u32_u24 v5, 1040, v5
v_lshrrev_b32 v6, 5, v1
v_lshl_add_u32 v5, v6, 3, v5
s_lshl_b32 s6, s3, 8
v_add_u32 v5, s6, v5
v_cvt_pk_bf16_f32 v84, v12, v13
v_cvt_pk_bf16_f32 v85, v14, v15
ds_write_b64 v5, v[84:85] offset:0
v_cvt_pk_bf16_f32 v86, v16, v17
v_cvt_pk_bf16_f32 v87, v18, v19
ds_write_b64 v5, v[86:87] offset:16
v_cvt_pk_bf16_f32 v88, v20, v21
v_cvt_pk_bf16_f32 v89, v22, v23
ds_write_b64 v5, v[88:89] offset:32
v_cvt_pk_bf16_f32 v90, v24, v25
v_cvt_pk_bf16_f32 v91, v26, v27
ds_write_b64 v5, v[90:91] offset:48
v_cvt_pk_bf16_f32 v92, v28, v29
v_cvt_pk_bf16_f32 v93, v30, v31
ds_write_b64 v5, v[92:93] offset:64
v_cvt_pk_bf16_f32 v94, v32, v33
v_cvt_pk_bf16_f32 v95, v34, v35
ds_write_b64 v5, v[94:95] offset:80
v_cvt_pk_bf16_f32 v96, v36, v37
v_cvt_pk_bf16_f32 v97, v38, v39
ds_write_b64 v5, v[96:97] offset:96
v_cvt_pk_bf16_f32 v98, v40, v41
v_cvt_pk_bf16_f32 v99, v42, v43
ds_write_b64 v5, v[98:99] offset:112
v_cvt_pk_bf16_f32 v100, v44, v45
v_cvt_pk_bf16_f32 v101, v46, v47
ds_write_b64 v5, v[100:101] offset:128
v_cvt_pk_bf16_f32 v102, v48, v49
v_cvt_pk_bf16_f32 v103, v50, v51
ds_write_b64 v5, v[102:103] offset:144
v_cvt_pk_bf16_f32 v104, v52, v53
v_cvt_pk_bf16_f32 v105, v54, v55
ds_write_b64 v5, v[104:105] offset:160
v_cvt_pk_bf16_f32 v106, v56, v57
v_cvt_pk_bf16_f32 v107, v58, v59
ds_write_b64 v5, v[106:107] offset:176
v_cvt_pk_bf16_f32 v108, v60, v61
v_cvt_pk_bf16_f32 v109, v62, v63
ds_write_b64 v5, v[108:109] offset:192
v_cvt_pk_bf16_f32 v110, v64, v65
v_cvt_pk_bf16_f32 v111, v66, v67
ds_write_b64 v5, v[110:111] offset:208
v_cvt_pk_bf16_f32 v112, v68, v69
v_cvt_pk_bf16_f32 v113, v70, v71
ds_write_b64 v5, v[112:113] offset:224
v_cvt_pk_bf16_f32 v114, v72, v73
v_cvt_pk_bf16_f32 v115, v74, v75
ds_write_b64 v5, v[114:115] offset:240
s_waitcnt lgkmcnt(0)
s_barrier
s_mul_i32 s6, s3, 8320
v_add_u32 v5, s6, v2
ds_read_b128 v[116:119], v5 offset:0
ds_read_b128 v[120:123], v5 offset:1040
ds_read_b128 v[124:127], v5 offset:2080
ds_read_b128 v[128:131], v5 offset:3120
ds_read_b128 v[132:135], v5 offset:4160
ds_read_b128 v[136:139], v5 offset:5200
ds_read_b128 v[140:143], v5 offset:6240
ds_read_b128 v[144:147], v5 offset:7280
ds_read_b128 v[164:167], v200 offset:512
s_lshl_b32 s7, s3, 19
s_lshl_b32 s6, s9, 10
s_add_u32 s7, s7, s6
s_add_u32 s7, s7, 1048576
s_waitcnt lgkmcnt(8)
s_add_u32 s6, s7, 0
buffer_store_dwordx4 v[116:119], v2, s[64:67], s6 offen sc1
s_waitcnt lgkmcnt(7)
s_add_u32 s6, s7, 65536
buffer_store_dwordx4 v[120:123], v2, s[64:67], s6 offen sc1
s_waitcnt lgkmcnt(6)
s_add_u32 s6, s7, 131072
buffer_store_dwordx4 v[124:127], v2, s[64:67], s6 offen sc1
s_waitcnt lgkmcnt(5)
s_add_u32 s6, s7, 196608
buffer_store_dwordx4 v[128:131], v2, s[64:67], s6 offen sc1
s_waitcnt lgkmcnt(4)
s_add_u32 s6, s7, 262144
buffer_store_dwordx4 v[132:135], v2, s[64:67], s6 offen sc1
s_waitcnt lgkmcnt(3)
s_add_u32 s6, s7, 327680
buffer_store_dwordx4 v[136:139], v2, s[64:67], s6 offen sc1
s_waitcnt lgkmcnt(2)
s_add_u32 s6, s7, 393216
buffer_store_dwordx4 v[140:143], v2, s[64:67], s6 offen sc1
s_waitcnt lgkmcnt(1)
s_add_u32 s6, s7, 458752
buffer_store_dwordx4 v[144:147], v2, s[64:67], s6 offen sc1
s_waitcnt lgkmcnt(0)
v_add_f32 v164, v164, v165
v_add_f32 v166, v166, v167
v_add_f32 v187, v164, v166
v_mov_b32 v186, v178
v_and_b32 v5, 31, v1
v_lshrrev_b32 v6, 5, v1
v_lshl_add_u32 v5, v5, 1, v6
v_lshlrev_b32 v5, 9, v5
s_lshl_b32 s6, s9, 3
s_add_u32 s6, s6, 262144
v_min_u32 v186, -2, v186
v_min_u32 v187, -2, v187
s_waitcnt vmcnt(0)
s_barrier
s_cmp_lg_u32 s3, 0
s_cbranch_scc1 L_nops_20
buffer_store_dwordx2 v[186:187], v5, s[64:67], s6 offen sc1
L_nops_20:
s_mul_i32 s6, s9, 73728
s_add_u32 s60, s36, s6
s_addc_u32 s61, s37, 0
s_mov_b32 s62, 73728
s_mov_b32 s63, 0x20000
s_lshl_b32 s6, s9, 7
s_sub_u32 s7, 4194304, s6
s_add_u32 s76, s34, s6
s_addc_u32 s77, s35, 0
s_mov_b32 s78, s7
s_mov_b32 s79, 0x20000
v_lshrrev_b32 v5, 3, v1
v_and_b32 v6, 7, v1
v_and_b32 v7, 2, v5
v_xor_b32 v6, v6, v7
v_lshlrev_b32 v5, 13, v5
v_lshl_add_u32 v152, v6, 4, v5
v_xor_b32 v6, 4, v6
v_lshl_add_u32 v153, v6, 4, v5
s_lshl_b32 s12, s3, 14
s_lshl_b32 s13, s3, 20
s_add_u32 m0, s12, 73728
s_add_u32 s6, s13, 0
buffer_load_dwordx4 v152, s[76:79], s6 offen nt lds
s_add_u32 m0, s12, 74752
s_add_u32 s6, s13, 65536
buffer_load_dwordx4 v153, s[76:79], s6 offen nt lds
s_add_u32 m0, s12, 75776
s_add_u32 s6, s13, 131072
buffer_load_dwordx4 v152, s[76:79], s6 offen nt lds
s_add_u32 m0, s12, 76800
s_add_u32 s6, s13, 196608
buffer_load_dwordx4 v153, s[76:79], s6 offen nt lds
s_add_u32 m0, s12, 77824
s_add_u32 s6, s13, 262144
buffer_load_dwordx4 v152, s[76:79], s6 offen nt lds
s_add_u32 m0, s12, 78848
s_add_u32 s6, s13, 327680
buffer_load_dwordx4 v153, s[76:79], s6 offen nt lds
s_add_u32 m0, s12, 79872
s_add_u32 s6, s13, 393216
buffer_load_dwordx4 v152, s[76:79], s6 offen nt lds
s_add_u32 m0, s12, 80896
s_add_u32 s6, s13, 458752
buffer_load_dwordx4 v153, s[76:79], s6 offen nt lds
s_add_u32 m0, s12, 81920
s_add_u32 s6, s13, 524288
buffer_load_dwordx4 v152, s[76:79], s6 offen nt lds
s_add_u32 m0, s12, 82944
s_add_u32 s6, s13, 589824
buffer_load_dwordx4 v153, s[76:79], s6 offen nt lds
s_add_u32 m0, s12, 83968
s_add_u32 s6, s13, 655360
buffer_load_dwordx4 v152, s[76:79], s6 offen nt lds
s_add_u32 m0, s12, 84992
s_add_u32 s6, s13, 720896
buffer_load_dwordx4 v153, s[76:79], s6 offen nt lds
s_add_u32 m0, s12, 86016
s_add_u32 s6, s13, 786432
buffer_load_dwordx4 v152, s[76:79], s6 offen nt lds
s_add_u32 m0, s12, 87040
s_add_u32 s6, s13, 851968
buffer_load_dwordx4 v153, s[76:79], s6 offen nt lds
s_add_u32 m0, s12, 88064
s_add_u32 s6, s13, 917504
buffer_load_dwordx4 v152, s[76:79], s6 offen nt lds
s_add_u32 m0, s12, 89088
s_add_u32 s6, s13, 983040
buffer_load_dwordx4 v153, s[76:79], s6 offen nt lds
s_mul_i32 s12, s3, 18432
s_add_u32 s6, s12, 0
s_mov_b32 m0, s6
s_nop 0
buffer_load_dwordx4 v2, s[60:63], s6 offen nt lds
s_add_u32 s6, s12, 1024
s_mov_b32 m0, s6
s_nop 0
buffer_load_dwordx4 v2, s[60:63], s6 offen nt lds
s_add_u32 s6, s12, 2048
s_mov_b32 m0, s6
s_nop 0
buffer_load_dwordx4 v2, s[60:63], s6 offen nt lds
s_add_u32 s6, s12, 3072
s_mov_b32 m0, s6
s_nop 0
buffer_load_dwordx4 v2, s[60:63], s6 offen nt lds
s_add_u32 s6, s12, 4096
s_mov_b32 m0, s6
s_nop 0
buffer_load_dwordx4 v2, s[60:63], s6 offen nt lds
s_add_u32 s6, s12, 5120
s_mov_b32 m0, s6
s_nop 0
buffer_load_dwordx4 v2, s[60:63], s6 offen nt lds
s_add_u32 s6, s12, 6144
s_mov_b32 m0, s6
s_nop 0
buffer_load_dwordx4 v2, s[60:63], s6 offen nt lds
s_add_u32 s6, s12, 7168
s_mov_b32 m0, s6
s_nop 0
buffer_load_dwordx4 v2, s[60:63], s6 offen nt lds
s_add_u32 s6, s12, 8192
s_mov_b32 m0, s6
s_nop 0
buffer_load_dwordx4 v2, s[60:63], s6 offen nt lds
s_add_u32 s6, s12, 9216
s_mov_b32 m0, s6
s_nop 0
buffer_load_dwordx4 v2, s[60:63], s6 offen nt lds
s_add_u32 s6, s12, 10240
s_mov_b32 m0, s6
s_nop 0
buffer_load_dwordx4 v2, s[60:63], s6 offen nt lds
s_add_u32 s6, s12, 11264
s_mov_b32 m0, s6
s_nop 0
buffer_load_dwordx4 v2, s[60:63], s6 offen nt lds
s_add_u32 s6, s12, 12288
s_mov_b32 m0, s6
s_nop 0
buffer_load_dwordx4 v2, s[60:63], s6 offen nt lds
s_add_u32 s6, s12, 13312
s_mov_b32 m0, s6
s_nop 0
buffer_load_dwordx4 v2, s[60:63], s6 offen nt lds
s_add_u32 s6, s12, 14336
s_mov_b32 m0, s6
s_nop 0
buffer_load_dwordx4 v2, s[60:63], s6 offen nt lds
s_add_u32 s6, s12, 15360
s_mov_b32 m0, s6
s_nop 0
buffer_load_dwordx4 v2, s[60:63], s6 offen nt lds
s_add_u32 s6, s12, 16384
s_mov_b32 m0, s6
s_nop 0
buffer_load_dwordx4 v2, s[60:63], s6 offen nt lds
s_add_u32 s6, s12, 17408
s_mov_b32 m0, s6
s_nop 0
buffer_load_dwordx4 v2, s[60:63], s6 offen nt lds
v_lshrrev_b32 v5, 4, v1
v_lshlrev_b32 v5, 3, v5
v_bfe_u32 v6, v1, 2, 2
v_add_u32 v5, v5, v6
v_mul_u32_u24 v5, 1152, v5
s_mul_i32 s6, s3, 288
v_add_u32 v5, s6, v5
v_and_b32 v6, 3, v1
v_lshl_add_u32 v158, v6, 5, v5
v_lshl_add_u32 v159, v6, 3, v5
v_add_u32 v159, 256, v159
v_bfe_u32 v5, v1, 2, 2
v_lshl_add_u32 v5, v9, 3, v5
v_lshlrev_b32 v5, 7, v5
v_and_b32 v6, 3, v1
v_lshl_add_u32 v5, v6, 3, v5
v_add_u32 v5, 73728, v5
v_bfe_u32 v6, v1, 3, 2
v_xor_b32 v7, 0, v6
v_lshl_add_u32 v154, v7, 5, v5
v_xor_b32 v7, 1, v6
v_lshl_add_u32 v155, v7, 5, v5
v_xor_b32 v7, 2, v6
v_lshl_add_u32 v156, v7, 5, v5
v_xor_b32 v7, 3, v6
v_lshl_add_u32 v157, v7, 5, v5
v_lshlrev_b32 v5, 10, v8
v_lshl_add_u32 v5, v9, 4, v5
v_lshlrev_b32 v6, 3, v8
s_lshl_b32 s6, s9, 9
s_lshl_b32 s7, s3, 7
s_add_u32 s6, s6, s7
s_add_u32 s6, s6, 262144
s_mov_b32 s7, 400000
P_poll:
buffer_load_dwordx2 v[148:149], v6, s[64:67], s6 offen sc1
s_waitcnt vmcnt(0)
v_max_u32 v150, v148, v149
v_cmp_eq_u32 vcc, -1, v150
s_cbranch_vccz P_ok
s_sleep 16
s_sub_u32 s7, s7, 1
s_cmp_lg_u32 s7, 0
s_cbranch_scc1 P_poll
P_ok:
s_lshl_b32 s6, s4, 16
s_lshl_b32 s7, s3, 14
s_add_u32 s6, s6, s7
s_add_u32 s6, s6, 1048576
buffer_load_dwordx4 v[12:15], v5, s[64:67], s6 offen offset:0 sc1
buffer_load_dwordx4 v[16:19], v5, s[64:67], s6 offen offset:64 sc1
buffer_load_dwordx4 v[20:23], v5, s[64:67], s6 offen offset:128 sc1
buffer_load_dwordx4 v[24:27], v5, s[64:67], s6 offen offset:192 sc1
buffer_load_dwordx4 v[28:31], v5, s[64:67], s6 offen offset:256 sc1
buffer_load_dwordx4 v[32:35], v5, s[64:67], s6 offen offset:320 sc1
buffer_load_dwordx4 v[36:39], v5, s[64:67], s6 offen offset:384 sc1
buffer_load_dwordx4 v[40:43], v5, s[64:67], s6 offen offset:448 sc1
buffer_load_dwordx4 v[44:47], v5, s[64:67], s6 offen offset:512 sc1
buffer_load_dwordx4 v[48:51], v5, s[64:67], s6 offen offset:576 sc1
buffer_load_dwordx4 v[52:55], v5, s[64:67], s6 offen offset:640 sc1
buffer_load_dwordx4 v[56:59], v5, s[64:67], s6 offen offset:704 sc1
buffer_load_dwordx4 v[60:63], v5, s[64:67], s6 offen offset:768 sc1
buffer_load_dwordx4 v[64:67], v5, s[64:67], s6 offen offset:832 sc1
buffer_load_dwordx4 v[68:71], v5, s[64:67], s6 offen offset:896 sc1
buffer_load_dwordx4 v[72:75], v5, s[64:67], s6 offen offset:960 sc1
s_barrier
ds_read_b64_tr_b16 a[96:97], v158 offset:0
ds_read_b64_tr_b16 a[98:99], v158 offset:4608
ds_read_b64_tr_b16 a[100:101], v158 offset:36864
ds_read_b64_tr_b16 a[102:103], v158 offset:41472
ds_read_b64_tr_b16 a[104:105], v158 offset:8
ds_read_b64_tr_b16 a[106:107], v158 offset:4616
ds_read_b64_tr_b16 a[108:109], v158 offset:36872
ds_read_b64_tr_b16 a[110:111], v158 offset:41480
ds_read_b64_tr_b16 a[112:113], v158 offset:16
ds_read_b64_tr_b16 a[114:115], v158 offset:4624
ds_read_b64_tr_b16 a[116:117], v158 offset:36880
ds_read_b64_tr_b16 a[118:119], v158 offset:41488
ds_read_b64_tr_b16 a[120:121], v158 offset:24
ds_read_b64_tr_b16 a[122:123], v158 offset:4632
ds_read_b64_tr_b16 a[124:125], v158 offset:36888
ds_read_b64_tr_b16 a[126:127], v158 offset:41496
ds_read_b64_tr_b16 a[128:129], v158 offset:128
ds_read_b64_tr_b16 a[130:131], v158 offset:4736
ds_read_b64_tr_b16 a[132:133], v158 offset:36992
ds_read_b64_tr_b16 a[134:135], v158 offset:41600
ds_read_b64_tr_b16 a[136:137], v158 offset:136
ds_read_b64_tr_b16 a[138:139], v158 offset:4744
ds_read_b64_tr_b16 a[140:141], v158 offset:37000
ds_read_b64_tr_b16 a[142:143], v158 offset:41608
ds_read_b64_tr_b16 a[144:145], v158 offset:144
ds_read_b64_tr_b16 a[146:147], v158 offset:4752
ds_read_b64_tr_b16 a[148:149], v158 offset:37008
ds_read_b64_tr_b16 a[150:151], v158 offset:41616
ds_read_b64_tr_b16 a[152:153], v158 offset:152
ds_read_b64_tr_b16 a[154:155], v158 offset:4760
ds_read_b64_tr_b16 a[156:157], v158 offset:37016
ds_read_b64_tr_b16 a[158:159], v158 offset:41624
ds_read_b64_tr_b16 a[160:161], v159 offset:0
ds_read_b64_tr_b16 a[162:163], v159 offset:4608
ds_read_b64_tr_b16 a[164:165], v159 offset:36864
ds_read_b64_tr_b16 a[166:167], v159 offset:41472
v_mov_b32 v150, v148
s_nop 1
v_max_f32_dpp v150, v150, v150 row_ror:8 row_mask:0xf bank_mask:0xf
s_nop 1
v_max_f32_dpp v150, v150, v150 row_ror:4 row_mask:0xf bank_mask:0xf
s_nop 1
v_max_f32_dpp v150, v150, v150 row_ror:2 row_mask:0xf bank_mask:0xf
s_nop 1
v_max_f32_dpp v150, v150, v150 row_ror:1 row_mask:0xf bank_mask:0xf
v_sub_f32 v148, v148, v150
v_exp_f32 v148, v148
s_nop 0
v_mul_f32 v151, v148, v149
s_nop 1
v_add_f32_dpp v151, v151, v151 row_ror:8 row_mask:0xf bank_mask:0xf
s_nop 1
v_add_f32_dpp v151, v151, v151 row_ror:4 row_mask:0xf bank_mask:0xf
s_nop 1
v_add_f32_dpp v151, v151, v151 row_ror:2 row_mask:0xf bank_mask:0xf
s_nop 1
v_add_f32_dpp v151, v151, v151 row_ror:1 row_mask:0xf bank_mask:0xf
v_rcp_f32 v151, v151
s_nop 0
v_mul_f32 v148, v148, v151
s_nop 1
v_mov_b32_dpp v144, v148 row_newbcast:0 row_mask:0x1 bank_mask:0xf
v_mov_b32_dpp v144, v148 row_newbcast:4 row_mask:0x2 bank_mask:0xf
v_mov_b32_dpp v144, v148 row_newbcast:8 row_mask:0x4 bank_mask:0xf
v_mov_b32_dpp v144, v148 row_newbcast:12 row_mask:0x8 bank_mask:0xf
v_mov_b32_dpp v145, v148 row_newbcast:1 row_mask:0x1 bank_mask:0xf
v_mov_b32_dpp v145, v148 row_newbcast:5 row_mask:0x2 bank_mask:0xf
v_mov_b32_dpp v145, v148 row_newbcast:9 row_mask:0x4 bank_mask:0xf
v_mov_b32_dpp v145, v148 row_newbcast:13 row_mask:0x8 bank_mask:0xf
v_mov_b32_dpp v146, v148 row_newbcast:2 row_mask:0x1 bank_mask:0xf
v_mov_b32_dpp v146, v148 row_newbcast:6 row_mask:0x2 bank_mask:0xf
v_mov_b32_dpp v146, v148 row_newbcast:10 row_mask:0x4 bank_mask:0xf
v_mov_b32_dpp v146, v148 row_newbcast:14 row_mask:0x8 bank_mask:0xf
v_mov_b32_dpp v147, v148 row_newbcast:3 row_mask:0x1 bank_mask:0xf
v_mov_b32_dpp v147, v148 row_newbcast:7 row_mask:0x2 bank_mask:0xf
v_mov_b32_dpp v147, v148 row_newbcast:11 row_mask:0x4 bank_mask:0xf
v_mov_b32_dpp v147, v148 row_newbcast:15 row_mask:0x8 bank_mask:0xf
s_waitcnt lgkmcnt(0)
ds_read_b64_tr_b16 v[76:77], v154 offset:0
ds_read_b64_tr_b16 v[78:79], v154 offset:512
ds_read_b64_tr_b16 v[80:81], v155 offset:0
ds_read_b64_tr_b16 v[82:83], v155 offset:512
ds_read_b64_tr_b16 v[84:85], v156 offset:0
ds_read_b64_tr_b16 v[86:87], v156 offset:512
ds_read_b64_tr_b16 v[88:89], v157 offset:0
ds_read_b64_tr_b16 v[90:91], v157 offset:512
ds_read_b64_tr_b16 v[92:93], v154 offset:4096
ds_read_b64_tr_b16 v[94:95], v154 offset:4608
ds_read_b64_tr_b16 v[96:97], v155 offset:4096
ds_read_b64_tr_b16 v[98:99], v155 offset:4608
ds_read_b64_tr_b16 v[100:101], v156 offset:4096
ds_read_b64_tr_b16 v[102:103], v156 offset:4608
ds_read_b64_tr_b16 v[104:105], v157 offset:4096
ds_read_b64_tr_b16 v[106:107], v157 offset:4608
s_waitcnt vmcnt(15)
s_waitcnt lgkmcnt(8)
v_mfma_f32_16x16x32_bf16 v[108:111], v[12:15], v[76:79], 0
v_mfma_f32_16x16x32_bf16 v[112:115], v[12:15], v[80:83], 0
v_mfma_f32_16x16x32_bf16 v[116:119], v[12:15], v[84:87], 0
v_mfma_f32_16x16x32_bf16 v[120:123], v[12:15], v[88:91], 0
ds_read_b64_tr_b16 v[76:77], v154 offset:8192
ds_read_b64_tr_b16 v[78:79], v154 offset:8704
ds_read_b64_tr_b16 v[80:81], v155 offset:8192
ds_read_b64_tr_b16 v[82:83], v155 offset:8704
ds_read_b64_tr_b16 v[84:85], v156 offset:8192
ds_read_b64_tr_b16 v[86:87], v156 offset:8704
ds_read_b64_tr_b16 v[88:89], v157 offset:8192
ds_read_b64_tr_b16 v[90:91], v157 offset:8704
s_waitcnt vmcnt(14)
s_waitcnt lgkmcnt(8)
v_mfma_f32_16x16x32_bf16 v[108:111], v[16:19], v[92:95], v[108:111]
v_mfma_f32_16x16x32_bf16 v[112:115], v[16:19], v[96:99], v[112:115]
v_mfma_f32_16x16x32_bf16 v[116:119], v[16:19], v[100:103], v[116:119]
v_mfma_f32_16x16x32_bf16 v[120:123], v[16:19], v[104:107], v[120:123]
ds_read_b64_tr_b16 v[92:93], v154 offset:12288
ds_read_b64_tr_b16 v[94:95], v154 offset:12800
ds_read_b64_tr_b16 v[96:97], v155 offset:12288
ds_read_b64_tr_b16 v[98:99], v155 offset:12800
ds_read_b64_tr_b16 v[100:101], v156 offset:12288
ds_read_b64_tr_b16 v[102:103], v156 offset:12800
ds_read_b64_tr_b16 v[104:105], v157 offset:12288
ds_read_b64_tr_b16 v[106:107], v157 offset:12800
s_waitcnt vmcnt(13)
s_waitcnt lgkmcnt(8)
v_mfma_f32_16x16x32_bf16 v[108:111], v[20:23], v[76:79], v[108:111]
v_mfma_f32_16x16x32_bf16 v[112:115], v[20:23], v[80:83], v[112:115]
v_mfma_f32_16x16x32_bf16 v[116:119], v[20:23], v[84:87], v[116:119]
v_mfma_f32_16x16x32_bf16 v[120:123], v[20:23], v[88:91], v[120:123]
ds_read_b64_tr_b16 v[76:77], v154 offset:16384
ds_read_b64_tr_b16 v[78:79], v154 offset:16896
ds_read_b64_tr_b16 v[80:81], v155 offset:16384
ds_read_b64_tr_b16 v[82:83], v155 offset:16896
ds_read_b64_tr_b16 v[84:85], v156 offset:16384
ds_read_b64_tr_b16 v[86:87], v156 offset:16896
ds_read_b64_tr_b16 v[88:89], v157 offset:16384
ds_read_b64_tr_b16 v[90:91], v157 offset:16896
s_waitcnt vmcnt(12)
s_waitcnt lgkmcnt(8)
v_mfma_f32_16x16x32_bf16 v[108:111], v[24:27], v[92:95], v[108:111]
v_mfma_f32_16x16x32_bf16 v[112:115], v[24:27], v[96:99], v[112:115]
v_mfma_f32_16x16x32_bf16 v[116:119], v[24:27], v[100:103], v[116:119]
v_mfma_f32_16x16x32_bf16 v[120:123], v[24:27], v[104:107], v[120:123]
ds_read_b64_tr_b16 v[92:93], v154 offset:20480
ds_read_b64_tr_b16 v[94:95], v154 offset:20992
ds_read_b64_tr_b16 v[96:97], v155 offset:20480
ds_read_b64_tr_b16 v[98:99], v155 offset:20992
ds_read_b64_tr_b16 v[100:101], v156 offset:20480
ds_read_b64_tr_b16 v[102:103], v156 offset:20992
ds_read_b64_tr_b16 v[104:105], v157 offset:20480
ds_read_b64_tr_b16 v[106:107], v157 offset:20992
s_waitcnt vmcnt(11)
s_waitcnt lgkmcnt(8)
v_mfma_f32_16x16x32_bf16 v[108:111], v[28:31], v[76:79], v[108:111]
v_mfma_f32_16x16x32_bf16 v[112:115], v[28:31], v[80:83], v[112:115]
v_mfma_f32_16x16x32_bf16 v[116:119], v[28:31], v[84:87], v[116:119]
v_mfma_f32_16x16x32_bf16 v[120:123], v[28:31], v[88:91], v[120:123]
ds_read_b64_tr_b16 v[76:77], v154 offset:24576
ds_read_b64_tr_b16 v[78:79], v154 offset:25088
ds_read_b64_tr_b16 v[80:81], v155 offset:24576
ds_read_b64_tr_b16 v[82:83], v155 offset:25088
ds_read_b64_tr_b16 v[84:85], v156 offset:24576
ds_read_b64_tr_b16 v[86:87], v156 offset:25088
ds_read_b64_tr_b16 v[88:89], v157 offset:24576
ds_read_b64_tr_b16 v[90:91], v157 offset:25088
s_waitcnt vmcnt(10)
s_waitcnt lgkmcnt(8)
v_mfma_f32_16x16x32_bf16 v[108:111], v[32:35], v[92:95], v[108:111]
v_mfma_f32_16x16x32_bf16 v[112:115], v[32:35], v[96:99], v[112:115]
v_mfma_f32_16x16x32_bf16 v[116:119], v[32:35], v[100:103], v[116:119]
v_mfma_f32_16x16x32_bf16 v[120:123], v[32:35], v[104:107], v[120:123]
ds_read_b64_tr_b16 v[92:93], v154 offset:28672
ds_read_b64_tr_b16 v[94:95], v154 offset:29184
ds_read_b64_tr_b16 v[96:97], v155 offset:28672
ds_read_b64_tr_b16 v[98:99], v155 offset:29184
ds_read_b64_tr_b16 v[100:101], v156 offset:28672
ds_read_b64_tr_b16 v[102:103], v156 offset:29184
ds_read_b64_tr_b16 v[104:105], v157 offset:28672
ds_read_b64_tr_b16 v[106:107], v157 offset:29184
s_waitcnt vmcnt(9)
s_waitcnt lgkmcnt(8)
v_mfma_f32_16x16x32_bf16 v[108:111], v[36:39], v[76:79], v[108:111]
v_mfma_f32_16x16x32_bf16 v[112:115], v[36:39], v[80:83], v[112:115]
v_mfma_f32_16x16x32_bf16 v[116:119], v[36:39], v[84:87], v[116:119]
v_mfma_f32_16x16x32_bf16 v[120:123], v[36:39], v[88:91], v[120:123]
ds_read_b64_tr_b16 v[76:77], v154 offset:32768
ds_read_b64_tr_b16 v[78:79], v154 offset:33280
ds_read_b64_tr_b16 v[80:81], v155 offset:32768
ds_read_b64_tr_b16 v[82:83], v155 offset:33280
ds_read_b64_tr_b16 v[84:85], v156 offset:32768
ds_read_b64_tr_b16 v[86:87], v156 offset:33280
ds_read_b64_tr_b16 v[88:89], v157 offset:32768
ds_read_b64_tr_b16 v[90:91], v157 offset:33280
s_waitcnt vmcnt(8)
s_waitcnt lgkmcnt(8)
v_mfma_f32_16x16x32_bf16 v[108:111], v[40:43], v[92:95], v[108:111]
v_mfma_f32_16x16x32_bf16 v[112:115], v[40:43], v[96:99], v[112:115]
v_mfma_f32_16x16x32_bf16 v[116:119], v[40:43], v[100:103], v[116:119]
v_mfma_f32_16x16x32_bf16 v[120:123], v[40:43], v[104:107], v[120:123]
ds_read_b64_tr_b16 v[92:93], v154 offset:36864
ds_read_b64_tr_b16 v[94:95], v154 offset:37376
ds_read_b64_tr_b16 v[96:97], v155 offset:36864
ds_read_b64_tr_b16 v[98:99], v155 offset:37376
ds_read_b64_tr_b16 v[100:101], v156 offset:36864
ds_read_b64_tr_b16 v[102:103], v156 offset:37376
ds_read_b64_tr_b16 v[104:105], v157 offset:36864
ds_read_b64_tr_b16 v[106:107], v157 offset:37376
s_waitcnt vmcnt(7)
s_waitcnt lgkmcnt(8)
v_mfma_f32_16x16x32_bf16 v[108:111], v[44:47], v[76:79], v[108:111]
v_mfma_f32_16x16x32_bf16 v[112:115], v[44:47], v[80:83], v[112:115]
v_mfma_f32_16x16x32_bf16 v[116:119], v[44:47], v[84:87], v[116:119]
v_mfma_f32_16x16x32_bf16 v[120:123], v[44:47], v[88:91], v[120:123]
ds_read_b64_tr_b16 v[76:77], v154 offset:40960
ds_read_b64_tr_b16 v[78:79], v154 offset:41472
ds_read_b64_tr_b16 v[80:81], v155 offset:40960
ds_read_b64_tr_b16 v[82:83], v155 offset:41472
ds_read_b64_tr_b16 v[84:85], v156 offset:40960
ds_read_b64_tr_b16 v[86:87], v156 offset:41472
ds_read_b64_tr_b16 v[88:89], v157 offset:40960
ds_read_b64_tr_b16 v[90:91], v157 offset:41472
s_waitcnt vmcnt(6)
s_waitcnt lgkmcnt(8)
v_mfma_f32_16x16x32_bf16 v[108:111], v[48:51], v[92:95], v[108:111]
v_mfma_f32_16x16x32_bf16 v[112:115], v[48:51], v[96:99], v[112:115]
v_mfma_f32_16x16x32_bf16 v[116:119], v[48:51], v[100:103], v[116:119]
v_mfma_f32_16x16x32_bf16 v[120:123], v[48:51], v[104:107], v[120:123]
ds_read_b64_tr_b16 v[92:93], v154 offset:45056
ds_read_b64_tr_b16 v[94:95], v154 offset:45568
ds_read_b64_tr_b16 v[96:97], v155 offset:45056
ds_read_b64_tr_b16 v[98:99], v155 offset:45568
ds_read_b64_tr_b16 v[100:101], v156 offset:45056
ds_read_b64_tr_b16 v[102:103], v156 offset:45568
ds_read_b64_tr_b16 v[104:105], v157 offset:45056
ds_read_b64_tr_b16 v[106:107], v157 offset:45568
s_waitcnt vmcnt(5)
s_waitcnt lgkmcnt(8)
v_mfma_f32_16x16x32_bf16 v[108:111], v[52:55], v[76:79], v[108:111]
v_mfma_f32_16x16x32_bf16 v[112:115], v[52:55], v[80:83], v[112:115]
v_mfma_f32_16x16x32_bf16 v[116:119], v[52:55], v[84:87], v[116:119]
v_mfma_f32_16x16x32_bf16 v[120:123], v[52:55], v[88:91], v[120:123]
ds_read_b64_tr_b16 v[76:77], v154 offset:49152
ds_read_b64_tr_b16 v[78:79], v154 offset:49664
ds_read_b64_tr_b16 v[80:81], v155 offset:49152
ds_read_b64_tr_b16 v[82:83], v155 offset:49664
ds_read_b64_tr_b16 v[84:85], v156 offset:49152
ds_read_b64_tr_b16 v[86:87], v156 offset:49664
ds_read_b64_tr_b16 v[88:89], v157 offset:49152
ds_read_b64_tr_b16 v[90:91], v157 offset:49664
s_waitcnt vmcnt(4)
s_waitcnt lgkmcnt(8)
v_mfma_f32_16x16x32_bf16 v[108:111], v[56:59], v[92:95], v[108:111]
v_mfma_f32_16x16x32_bf16 v[112:115], v[56:59], v[96:99], v[112:115]
v_mfma_f32_16x16x32_bf16 v[116:119], v[56:59], v[100:103], v[116:119]
v_mfma_f32_16x16x32_bf16 v[120:123], v[56:59], v[104:107], v[120:123]
ds_read_b64_tr_b16 v[92:93], v154 offset:53248
ds_read_b64_tr_b16 v[94:95], v154 offset:53760
ds_read_b64_tr_b16 v[96:97], v155 offset:53248
ds_read_b64_tr_b16 v[98:99], v155 offset:53760
ds_read_b64_tr_b16 v[100:101], v156 offset:53248
ds_read_b64_tr_b16 v[102:103], v156 offset:53760
ds_read_b64_tr_b16 v[104:105], v157 offset:53248
ds_read_b64_tr_b16 v[106:107], v157 offset:53760
s_waitcnt vmcnt(3)
s_waitcnt lgkmcnt(8)
v_mfma_f32_16x16x32_bf16 v[108:111], v[60:63], v[76:79], v[108:111]
v_mfma_f32_16x16x32_bf16 v[112:115], v[60:63], v[80:83], v[112:115]
v_mfma_f32_16x16x32_bf16 v[116:119], v[60:63], v[84:87], v[116:119]
v_mfma_f32_16x16x32_bf16 v[120:123], v[60:63], v[88:91], v[120:123]
ds_read_b64_tr_b16 v[76:77], v154 offset:57344
ds_read_b64_tr_b16 v[78:79], v154 offset:57856
ds_read_b64_tr_b16 v[80:81], v155 offset:57344
ds_read_b64_tr_b16 v[82:83], v155 offset:57856
ds_read_b64_tr_b16 v[84:85], v156 offset:57344
ds_read_b64_tr_b16 v[86:87], v156 offset:57856
ds_read_b64_tr_b16 v[88:89], v157 offset:57344
ds_read_b64_tr_b16 v[90:91], v157 offset:57856
s_waitcnt vmcnt(2)
s_waitcnt lgkmcnt(8)
v_mfma_f32_16x16x32_bf16 v[108:111], v[64:67], v[92:95], v[108:111]
v_mfma_f32_16x16x32_bf16 v[112:115], v[64:67], v[96:99], v[112:115]
v_mfma_f32_16x16x32_bf16 v[116:119], v[64:67], v[100:103], v[116:119]
v_mfma_f32_16x16x32_bf16 v[120:123], v[64:67], v[104:107], v[120:123]
ds_read_b64_tr_b16 v[92:93], v154 offset:61440
ds_read_b64_tr_b16 v[94:95], v154 offset:61952
ds_read_b64_tr_b16 v[96:97], v155 offset:61440
ds_read_b64_tr_b16 v[98:99], v155 offset:61952
ds_read_b64_tr_b16 v[100:101], v156 offset:61440
ds_read_b64_tr_b16 v[102:103], v156 offset:61952
ds_read_b64_tr_b16 v[104:105], v157 offset:61440
ds_read_b64_tr_b16 v[106:107], v157 offset:61952
s_waitcnt vmcnt(1)
s_waitcnt lgkmcnt(8)
v_mfma_f32_16x16x32_bf16 v[108:111], v[68:71], v[76:79], v[108:111]
v_mfma_f32_16x16x32_bf16 v[112:115], v[68:71], v[80:83], v[112:115]
v_mfma_f32_16x16x32_bf16 v[116:119], v[68:71], v[84:87], v[116:119]
v_mfma_f32_16x16x32_bf16 v[120:123], v[68:71], v[88:91], v[120:123]
s_waitcnt vmcnt(0)
s_waitcnt lgkmcnt(0)
v_mfma_f32_16x16x32_bf16 v[108:111], v[72:75], v[92:95], v[108:111]
v_mfma_f32_16x16x32_bf16 v[112:115], v[72:75], v[96:99], v[112:115]
v_mfma_f32_16x16x32_bf16 v[116:119], v[72:75], v[100:103], v[116:119]
v_mfma_f32_16x16x32_bf16 v[120:123], v[72:75], v[104:107], v[120:123]
v_lshlrev_b32 v5, 7, v9
v_lshl_add_u32 v5, v8, 1, v5
s_lshl_b32 s6, s3, 9
s_add_u32 s6, s6, 139264
v_add_u32 v5, s6, v5
v_mul_f32 v172, v144, v108
v_fma_f32 v172, v145, v109, v172
v_fma_f32 v172, v146, v110, v172
v_fma_f32 v172, v147, v111, v172
v_cvt_pk_bf16_f32 v172, v172, v172
ds_write_b16 v5, v172 offset:0
v_mul_f32 v173, v144, v112
v_fma_f32 v173, v145, v113, v173
v_fma_f32 v173, v146, v114, v173
v_fma_f32 v173, v147, v115, v173
v_cvt_pk_bf16_f32 v173, v173, v173
ds_write_b16 v5, v173 offset:32
v_mul_f32 v174, v144, v116
v_fma_f32 v174, v145, v117, v174
v_fma_f32 v174, v146, v118, v174
v_fma_f32 v174, v147, v119, v174
v_cvt_pk_bf16_f32 v174, v174, v174
ds_write_b16 v5, v174 offset:64
v_mul_f32 v175, v144, v120
v_fma_f32 v175, v145, v121, v175
v_fma_f32 v175, v146, v122, v175
v_fma_f32 v175, v147, v123, v175
v_cvt_pk_bf16_f32 v175, v175, v175
ds_write_b16 v5, v175 offset:96
v_lshlrev_b32 v6, 7, v8
v_lshl_add_u32 v6, v9, 4, v6
v_add_u32 v6, 139264, v6
v_mov_b32 v11, 141312
v_mov_b32 v7, 0
ds_write_b32 v11, v7
s_waitcnt lgkmcnt(0)
s_barrier
ds_read_b128 v[164:167], v6 offset:0
ds_read_b128 v[168:171], v6 offset:64
v_mul_u32_u24 v5, 147456, v9
v_and_b32 v6, 3, v1
v_bfe_u32 v7, v1, 2, 2
v_lshl_add_u32 v6, v6, 2, v7
v_lshl_add_u32 v6, v6, 2, v5
v_lshl_add_u32 v5, v8, 4, v5
s_mul_i32 s6, s9, 2304
s_mul_i32 s7, s3, 576
s_add_u32 s6, s6, s7
s_add_u32 s6, s6, 5242880
s_waitcnt lgkmcnt(0)
v_mfma_f32_16x16x32_bf16 v[108:111], v[164:167], a[96:99], 0
v_mfma_f32_16x16x32_bf16 v[108:111], v[168:171], a[100:103], v[108:111]
v_mfma_f32_16x16x32_bf16 v[112:115], v[164:167], a[104:107], 0
v_mfma_f32_16x16x32_bf16 v[112:115], v[168:171], a[108:111], v[112:115]
v_mfma_f32_16x16x32_bf16 v[116:119], v[164:167], a[112:115], 0
v_mfma_f32_16x16x32_bf16 v[116:119], v[168:171], a[116:119], v[116:119]
v_mfma_f32_16x16x32_bf16 v[120:123], v[164:167], a[120:123], 0
v_mfma_f32_16x16x32_bf16 v[120:123], v[168:171], a[124:127], v[120:123]
v_mfma_f32_16x16x32_bf16 v[124:127], v[164:167], a[128:131], 0
v_mfma_f32_16x16x32_bf16 v[124:127], v[168:171], a[132:135], v[124:127]
v_mfma_f32_16x16x32_bf16 v[128:131], v[164:167], a[136:139], 0
v_mfma_f32_16x16x32_bf16 v[128:131], v[168:171], a[140:143], v[128:131]
v_mfma_f32_16x16x32_bf16 v[132:135], v[164:167], a[144:147], 0
v_mfma_f32_16x16x32_bf16 v[132:135], v[168:171], a[148:151], v[132:135]
v_mfma_f32_16x16x32_bf16 v[136:139], v[164:167], a[152:155], 0
v_mfma_f32_16x16x32_bf16 v[136:139], v[168:171], a[156:159], v[136:139]
v_mfma_f32_16x16x32_bf16 v[140:143], v[164:167], a[160:163], 0
v_mfma_f32_16x16x32_bf16 v[140:143], v[168:171], a[164:167], v[140:143]
v_add_f32 v108, v108, v109
v_add_f32 v110, v110, v111
v_add_f32 v172, v108, v110
v_min_u32 v172, -2, v172
v_add_f32 v112, v112, v113
v_add_f32 v114, v114, v115
v_add_f32 v173, v112, v114
v_min_u32 v173, -2, v173
v_add_f32 v116, v116, v117
v_add_f32 v118, v118, v119
v_add_f32 v174, v116, v118
v_min_u32 v174, -2, v174
v_add_f32 v120, v120, v121
v_add_f32 v122, v122, v123
v_add_f32 v175, v120, v122
v_min_u32 v175, -2, v175
v_add_f32 v124, v124, v125
v_add_f32 v126, v126, v127
v_add_f32 v176, v124, v126
v_min_u32 v176, -2, v176
v_add_f32 v128, v128, v129
v_add_f32 v130, v130, v131
v_add_f32 v177, v128, v130
v_min_u32 v177, -2, v177
v_add_f32 v132, v132, v133
v_add_f32 v134, v134, v135
v_add_f32 v178, v132, v134
v_min_u32 v178, -2, v178
v_add_f32 v136, v136, v137
v_add_f32 v138, v138, v139
v_add_f32 v179, v136, v138
v_min_u32 v179, -2, v179
v_add_f32 v140, v140, v141
v_add_f32 v142, v142, v143
v_add_f32 v180, v140, v142
v_min_u32 v180, -2, v180
buffer_store_dwordx4 v[172:175], v5, s[64:67], s6 offen sc1
buffer_store_dwordx4 v[176:179], v5, s[64:67], s6 offen offset:256 sc1
buffer_store_dword v180, v6, s[64:67], s6 offen offset:512 sc1
s_cmp_eq_u32 s3, 3
s_cbranch_scc1 H_start
s_mov_b32 s14, s9
s_lshr_b32 s7, s3, 1
s_cmp_lg_u32 s3, 1
s_cbranch_scc1 L_w1_21
s_cmp_ge_u32 s9, 16
s_cbranch_scc1 B_end
s_lshr_b32 s7, s9, 3
s_and_b32 s14, s9, 7
s_add_u32 s14, s14, 64
L_w1_21:
s_mul_i32 s15, s14, 57
s_lshr_b32 s15, s15, 10
s_mul_i32 s6, s15, 18
s_sub_u32 s80, s14, s6
s_mul_i32 s81, s15, 147456
s_lshl_b32 s6, s80, 7
s_add_u32 s81, s81, s6
s_mul_i32 s6, s7, 1048576
s_add_u32 s81, s81, s6
s_add_u32 s81, s81, 4194304
s_mul_i32 s83, s15, 2304
s_lshl_b32 s6, s80, 6
s_add_u32 s83, s83, s6
s_mul_i32 s6, s7, 1152
s_add_u32 s83, s83, s6
v_lshrrev_b32 v5, 3, v1
v_and_b32 v6, 7, v1
v_mul_u32_u24 v44, 2304, v5
v_lshl_add_u32 v44, v6, 4, v44
v_bfe_u32 v5, v1, 2, 1
v_lshl_add_u32 v5, v5, 2, v9
v_and_b32 v6, 3, v1
v_lshl_add_u32 v5, v5, 2, v6
v_lshlrev_b32 v45, 1, v5
s_mov_b32 s82, 0
s_mov_b32 s7, 400000
R_pass:
s_bitcmp1_b32 s82, 0
s_cbranch_scc1 L_ld_22
s_add_u32 s6, s81, 0
buffer_load_dwordx4 v[12:15], v44, s[64:67], s6 offen sc1
L_ld_22:
s_bitcmp1_b32 s82, 1
s_cbranch_scc1 L_ld_23
s_add_u32 s6, s81, 18432
buffer_load_dwordx4 v[16:19], v44, s[64:67], s6 offen sc1
L_ld_23:
s_bitcmp1_b32 s82, 2
s_cbranch_scc1 L_ld_24
s_add_u32 s6, s81, 36864
buffer_load_dwordx4 v[20:23], v44, s[64:67], s6 offen sc1
L_ld_24:
s_bitcmp1_b32 s82, 3
s_cbranch_scc1 L_ld_25
s_add_u32 s6, s81, 55296
buffer_load_dwordx4 v[24:27], v44, s[64:67], s6 offen sc1
L_ld_25:
s_bitcmp1_b32 s82, 4
s_cbranch_scc1 L_ld_26
s_add_u32 s6, s81, 73728
buffer_load_dwordx4 v[28:31], v44, s[64:67], s6 offen sc1
L_ld_26:
s_bitcmp1_b32 s82, 5
s_cbranch_scc1 L_ld_27
s_add_u32 s6, s81, 92160
buffer_load_dwordx4 v[32:35], v44, s[64:67], s6 offen sc1
L_ld_27:
s_bitcmp1_b32 s82, 6
s_cbranch_scc1 L_ld_28
s_add_u32 s6, s81, 110592
buffer_load_dwordx4 v[36:39], v44, s[64:67], s6 offen sc1
L_ld_28:
s_bitcmp1_b32 s82, 7
s_cbranch_scc1 L_ld_29
s_add_u32 s6, s81, 129024
buffer_load_dwordx4 v[40:43], v44, s[64:67], s6 offen sc1
L_ld_29:
s_waitcnt vmcnt(0)
s_bitcmp1_b32 s82, 0
s_cbranch_scc1 L_ck_30
v_max3_u32 v46, v12, v13, v14
v_max_u32 v46, v46, v15
v_cmp_eq_u32 vcc, -1, v46
s_cbranch_vccnz L_ck_30
s_bitset1_b32 s82, 0
L_ck_30:
s_bitcmp1_b32 s82, 1
s_cbranch_scc1 L_ck_31
v_max3_u32 v46, v16, v17, v18
v_max_u32 v46, v46, v19
v_cmp_eq_u32 vcc, -1, v46
s_cbranch_vccnz L_ck_31
s_bitset1_b32 s82, 1
L_ck_31:
s_bitcmp1_b32 s82, 2
s_cbranch_scc1 L_ck_32
v_max3_u32 v46, v20, v21, v22
v_max_u32 v46, v46, v23
v_cmp_eq_u32 vcc, -1, v46
s_cbranch_vccnz L_ck_32
s_bitset1_b32 s82, 2
L_ck_32:
s_bitcmp1_b32 s82, 3
s_cbranch_scc1 L_ck_33
v_max3_u32 v46, v24, v25, v26
v_max_u32 v46, v46, v27
v_cmp_eq_u32 vcc, -1, v46
s_cbranch_vccnz L_ck_33
s_bitset1_b32 s82, 3
L_ck_33:
s_bitcmp1_b32 s82, 4
s_cbranch_scc1 L_ck_34
v_max3_u32 v46, v28, v29, v30
v_max_u32 v46, v46, v31
v_cmp_eq_u32 vcc, -1, v46
s_cbranch_vccnz L_ck_34
s_bitset1_b32 s82, 4
L_ck_34:
s_bitcmp1_b32 s82, 5
s_cbranch_scc1 L_ck_35
v_max3_u32 v46, v32, v33, v34
v_max_u32 v46, v46, v35
v_cmp_eq_u32 vcc, -1, v46
s_cbranch_vccnz L_ck_35
s_bitset1_b32 s82, 5
L_ck_35:
s_bitcmp1_b32 s82, 6
s_cbranch_scc1 L_ck_36
v_max3_u32 v46, v36, v37, v38
v_max_u32 v46, v46, v39
v_cmp_eq_u32 vcc, -1, v46
s_cbranch_vccnz L_ck_36
s_bitset1_b32 s82, 6
L_ck_36:
s_bitcmp1_b32 s82, 7
s_cbranch_scc1 L_ck_37
v_max3_u32 v46, v40, v41, v42
v_max_u32 v46, v46, v43
v_cmp_eq_u32 vcc, -1, v46
s_cbranch_vccnz L_ck_37
s_bitset1_b32 s82, 7
L_ck_37:
s_cmp_eq_u32 s82, 255
s_cbranch_scc1 R_done
s_sub_u32 s7, s7, 1
s_cmp_lg_u32 s7, 0
s_cbranch_scc1 R_pass
R_done:
v_pk_add_f32 v[12:13], v[12:13], v[28:29]
v_pk_add_f32 v[14:15], v[14:15], v[30:31]
v_pk_add_f32 v[16:17], v[16:17], v[32:33]
v_pk_add_f32 v[18:19], v[18:19], v[34:35]
v_pk_add_f32 v[20:21], v[20:21], v[36:37]
v_pk_add_f32 v[22:23], v[22:23], v[38:39]
v_pk_add_f32 v[24:25], v[24:25], v[40:41]
v_pk_add_f32 v[26:27], v[26:27], v[42:43]
v_pk_add_f32 v[12:13], v[12:13], v[20:21]
v_pk_add_f32 v[14:15], v[14:15], v[22:23]
v_pk_add_f32 v[16:17], v[16:17], v[24:25]
v_pk_add_f32 v[18:19], v[18:19], v[26:27]
v_pk_add_f32 v[12:13], v[12:13], v[16:17]
v_pk_add_f32 v[14:15], v[14:15], v[18:19]
s_nop 1
v_permlane32_swap_b32 v12, v14
v_permlane32_swap_b32 v13, v15
v_add_f32 v12, v12, v14
v_add_f32 v13, v13, v15
s_nop 1
v_permlane16_swap_b32 v12, v13
v_add_f32 v12, v12, v13
s_nop 1
v_add_f32_dpp v12, v12, v12 row_ror:8 row_mask:0xf bank_mask:0xf
v_cvt_pk_bf16_f32 v12, v12, v12
s_mov_b32 exec_lo, 0x00ff00ff
s_mov_b32 exec_hi, 0x00ff00ff
buffer_store_short v12, v45, s[72:75], s83 offen
s_mov_b64 exec, -1
s_cmp_lg_u32 s3, 0
s_cbranch_scc1 B_fin
ds_write_b32 v11, v11
s_waitcnt lgkmcnt(0)
B_fin:
B_end:
s_endpgm
H_start:
s_lshl_b32 s6, s8, 6
s_add_u32 s6, s6, s4
s_lshl_b32 s6, s6, 20
s_add_u32 s56, s20, s6
s_addc_u32 s57, s21, 0
s_mov_b32 s58, 34603008
s_mov_b32 s59, 0x20000
v_lshlrev_b32 v16, 7, v1
v_and_b32 v17, 4095, v16
v_add_u32 v16, 4096, v16
v_lshrrev_b32 v21, 5, v1
v_mul_u32_u24 v21, 20480, v21
v_add_u32 v17, v17, v21
s_and_b32 s6, s9, 56
v_and_b32 v19, 7, v1
v_add_u32 v19, s6, v19
v_mul_u32_u24 v19, 16, v19
v_add_u32 v19, 393216, v19
s_mov_b32 s16, 43
s_mov_b32 s17, 43
s_mov_b32 s18, 43
s_mov_b32 s31, 400000
buffer_load_dwordx3 v[12:14], v19, s[64:67], 0 offen sc1
s_waitcnt vmcnt(0)
H_loop:
v_med3_i32 v12, v12, -1, 31
v_med3_i32 v13, v13, -1, 31
v_med3_i32 v14, v14, -1, 31
v_add3_u32 v20, v12, v13, v14
v_readlane_b32 s20, v12, s9
v_readlane_b32 s21, v13, s9
v_readlane_b32 s22, v14, s9
v_add_u32_dpp v20, v20, v20 row_ror:8 row_mask:0xf bank_mask:0xf
s_nop 1
v_add_u32_dpp v20, v20, v20 row_ror:4 row_mask:0xf bank_mask:0xf
s_nop 1
v_add_u32_dpp v20, v20, v20 row_ror:2 row_mask:0xf bank_mask:0xf
s_nop 1
v_add_u32_dpp v20, v20, v20 row_ror:1 row_mask:0xf bank_mask:0xf
v_mov_b32 v21, v20
s_nop 1
v_permlane16_swap_b32 v20, v21
v_add_u32 v20, v20, v21
v_mov_b32 v21, v20
s_nop 1
v_permlane32_swap_b32 v20, v21
v_add_u32 v20, v20, v21
s_nop 0
v_readfirstlane_b32 s28, v20
buffer_load_dwordx3 v[12:14], v19, s[64:67], 0 offen sc1
s_mul_i32 s6, s20, 192
s_sub_i32 s24, s28, s6
s_mul_i32 s6, s16, 24
s_add_i32 s24, s24, s6
s_add_i32 s6, s16, -15
s_cmp_ge_i32 s6, s20
s_cselect_b32 s24, s24, -1048576
s_mul_i32 s6, s21, 192
s_sub_i32 s25, s28, s6
s_mul_i32 s6, s17, 24
s_add_i32 s25, s25, s6
s_add_i32 s6, s17, -15
s_cmp_ge_i32 s6, s21
s_cselect_b32 s25, s25, -1048576
s_mul_i32 s6, s22, 192
s_sub_i32 s26, s28, s6
s_mul_i32 s6, s18, 24
s_add_i32 s26, s26, s6
s_add_i32 s6, s18, -15
s_cmp_ge_i32 s6, s22
s_cselect_b32 s26, s26, -1048576
s_cmp_ge_i32 s24, s25
s_cselect_b32 s29, 0, 1
s_max_i32 s30, s24, s25
s_cmp_ge_i32 s30, s26
s_cselect_b32 s29, s29, 2
s_max_i32 s30, s30, s26
s_cmp_eq_i32 s30, -1048576
s_cbranch_scc1 H_end
s_sub_u32 s31, s31, 1
s_cmp_eq_u32 s31, 0
s_cbranch_scc1 H_end
s_cmp_lt_i32 s30, 1416
s_cbranch_scc1 H_idle
s_cmp_eq_u32 s29, 0
s_cselect_b32 s6, s16, s6
s_subb_u32 s16, s16, 0
s_cmp_eq_u32 s29, 1
s_cselect_b32 s6, s17, s6
s_subb_u32 s17, s17, 0
s_cmp_eq_u32 s29, 2
s_cselect_b32 s6, s18, s6
s_subb_u32 s18, s18, 0
s_mul_i32 s6, s6, 24576
s_sub_u32 s6, s6, 32768
s_cmp_eq_u32 s29, 2
s_cselect_b32 s7, 33554432, 0
s_add_u32 s6, s6, s7
s_cmp_eq_u32 s29, 1
s_cselect_b64 vcc, -1, 0
s_cselect_b32 s7, 25, 13
s_lshl_b32 s7, 1, s7
s_add_u32 s7, s7, s6
v_cndmask_b32 v18, v16, v17, vcc
buffer_load_dword v22, v18, s[56:59], s6 offen
buffer_load_dword v23, v18, s[56:59], s7 offen
s_waitcnt vmcnt(2)
s_branch H_loop
H_idle:
ds_read_b32 v21, v11
s_waitcnt vmcnt(0) lgkmcnt(0)
s_sleep 4
v_cmp_eq_u32 vcc, 0, v21
s_cbranch_vccnz H_loop
H_end:
s_branch B_end
.section .rodata,"a"
.p2align 6
.amdhsa_kernel concat_heads__mha_block_cached__compressed_kv_cla__decode_kernel
  .amdhsa_next_free_vgpr 512
  .amdhsa_next_free_sgpr 102
  .amdhsa_accum_offset 256
  .amdhsa_group_segment_fixed_size 0
  .amdhsa_kernarg_size 112
  .amdhsa_user_sgpr_count 2
  .amdhsa_user_sgpr_kernarg_segment_ptr 1
  .amdhsa_system_sgpr_workgroup_id_x 1
.end_amdhsa_kernel
```

```asm
; @launch grid=(256,1,1) block=(256,1,1) lds=163840
.amdgcn_target "amdgcn-amd-amdhsa--gfx950"
.text
.globl concat_heads__mha_block_cached__compressed_kv_cla__decode_kernel
.p2align 8
.type concat_heads__mha_block_cached__compressed_kv_cla__decode_kernel,@function
concat_heads__mha_block_cached__compressed_kv_cla__decode_kernel:
s_cmp_ge_u32 s2, 256
s_cbranch_scc1 L_exit
s_load_dwordx16 s[16:31], s[0:1], 0
s_load_dwordx8 s[32:39], s[0:1], 64
s_load_dwordx4 s[40:43], s[0:1], 96
v_lshrrev_b32 v1, 6, v0
s_nop 0
v_readfirstlane_b32 s3, v1
s_and_b32 s6, s2, 7
s_bfe_u32 s7, s2, 0x20003
s_lshl_b32 s4, s6, 2
s_add_u32 s4, s4, s7
s_lshr_b32 s5, s2, 5
s_cmp_lt_u32 s5, 2
s_cbranch_scc1 B_role
A_role:
s_sub_u32 s8, s5, 2
s_cmp_ge_u32 s8, 3
s_cselect_b32 s9, 1, 0
s_cselect_b32 s6, 3, 0
s_sub_u32 s8, s8, s6
s_lshl_b32 s11, s8, 2
s_add_u32 s11, s11, s3
s_cmp_ge_u32 s11, 6
s_cselect_b32 s83, 1, 0
s_cselect_b32 s6, -1, 1
s_add_u32 s11, s11, s6
s_cmp_ge_u32 s11, 6
s_cselect_b32 s6, 6, 0
s_sub_u32 s11, s11, s6
s_lshl_b32 s10, s9, 1
s_add_u32 s10, s10, s83
v_and_b32 v1, 63, v0
v_lshlrev_b32 v2, 4, v1
s_sub_u32 s14, s11, 8
s_lshl_b32 s14, s14, 12
s_mov_b32 s13, s14
s_add_u32 s13, s13, 24576
s_min_u32 s12, s13, 2146435072
s_lshl_b32 s82, s10, 5
s_add_u32 s82, s82, s4
s_lshl_b32 s6, s82, 20
s_waitcnt lgkmcnt(0)
s_add_u32 s52, s18, s6
s_addc_u32 s53, s19, 0
s_mov_b32 s54, 1048576
s_mov_b32 s55, 0x20000
s_add_u32 s56, s20, s6
s_addc_u32 s57, s21, 0
s_mov_b32 s58, 1048576
s_mov_b32 s59, 0x20000
s_mul_i32 s6, s9, 2304
s_mul_i32 s7, s3, 288
s_add_u32 s6, s6, s7
s_sub_u32 s7, 4608, s6
s_add_u32 s44, s16, s6
s_addc_u32 s45, s17, 0
s_mov_b32 s46, s7
s_mov_b32 s47, 0x20000
s_mul_i32 s6, s3, 1179648
s_lshl_b32 s7, s4, 8
s_add_u32 s6, s6, s7
s_sub_u32 s7, 4718592, s6
s_add_u32 s48, s22, s6
s_addc_u32 s49, s23, 0
s_mov_b32 s50, s7
s_mov_b32 s51, 0x20000
v_lshrrev_b32 v5, 4, v1
v_and_b32 v6, 15, v1
v_mul_u32_u24 v3, 294912, v5
v_lshl_add_u32 v3, v6, 4, v3
v_mul_u32_u24 v4, 72, v5
v_lshrrev_b32 v6, 3, v6
v_mul_u32_u24 v6, 1152, v6
v_add_u32 v4, v4, v6
v_mov_b32 v7, 7168
s_lshr_b32 s6, s2, 3
s_sub_u32 s6, s6, 8
s_lshl_b32 s6, s6, 2
s_add_u32 s6, s6, s3
s_mul_i32 s6, s6, 49152
s_and_b32 s7, s2, 7
s_lshl_b32 s7, s7, 10
s_add_u32 s6, s6, s7
s_mov_b32 s60, s22
s_mov_b32 s61, s23
s_mov_b32 s62, 4718592
s_mov_b32 s63, 0x20000
v_min_u32 v35, 47, v1
v_lshrrev_b32 v36, 3, v35
v_lshlrev_b32 v35, 7, v35
v_mad_u32_u24 v36, v36, v7, v35
buffer_load_dword v120, v36, s[60:63], s6 offen
buffer_load_dwordx4 v[40:43], v4, s[44:47], 0 offen offset:0
buffer_load_dwordx4 v[44:47], v4, s[44:47], 0 offen offset:16
buffer_load_dwordx4 v[48:51], v4, s[44:47], 0 offen offset:32
buffer_load_dwordx4 v[52:55], v4, s[44:47], 0 offen offset:48
buffer_load_dwordx2 v[56:57], v4, s[44:47], 0 offen offset:64
s_waitcnt vmcnt(54)
buffer_load_dwordx4 v[136:139], v2, s[52:55], s12 offen offset:0 nt
buffer_load_dwordx4 v[140:143], v2, s[52:55], s12 offen offset:1024 nt
buffer_load_dwordx4 v[144:147], v2, s[52:55], s12 offen offset:2048 nt
buffer_load_dwordx4 v[148:151], v2, s[52:55], s12 offen offset:3072 nt
s_add_u32 s13, s13, 24576
s_min_u32 s12, s13, 2146435072
s_waitcnt vmcnt(54)
buffer_load_dwordx4 v[152:155], v2, s[52:55], s12 offen offset:0 nt
buffer_load_dwordx4 v[156:159], v2, s[52:55], s12 offen offset:1024 nt
buffer_load_dwordx4 v[160:163], v2, s[52:55], s12 offen offset:2048 nt
buffer_load_dwordx4 v[164:167], v2, s[52:55], s12 offen offset:3072 nt
s_add_u32 s13, s13, 24576
s_min_u32 s12, s13, 2146435072
s_cmp_lg_u32 s8, 0
s_cbranch_scc1 L_nowq_1
s_waitcnt vmcnt(20)
s_mov_b32 s6, 0
buffer_load_dwordx4 a[96:99], v3, s[48:51], s6 offen
s_mov_b32 s6, 8192
buffer_load_dwordx4 a[100:103], v3, s[48:51], s6 offen
s_mov_b32 s6, 16384
buffer_load_dwordx4 a[104:107], v3, s[48:51], s6 offen
s_mov_b32 s6, 24576
buffer_load_dwordx4 a[108:111], v3, s[48:51], s6 offen
s_mov_b32 s6, 32768
buffer_load_dwordx4 a[112:115], v3, s[48:51], s6 offen
s_mov_b32 s6, 40960
buffer_load_dwordx4 a[116:119], v3, s[48:51], s6 offen
s_mov_b32 s6, 49152
buffer_load_dwordx4 a[120:123], v3, s[48:51], s6 offen
s_mov_b32 s6, 57344
buffer_load_dwordx4 a[124:127], v3, s[48:51], s6 offen
s_mov_b32 s6, 65536
buffer_load_dwordx4 a[128:131], v3, s[48:51], s6 offen
s_mov_b32 s6, 73728
buffer_load_dwordx4 a[132:135], v3, s[48:51], s6 offen
s_mov_b32 s6, 81920
buffer_load_dwordx4 a[136:139], v3, s[48:51], s6 offen
s_mov_b32 s6, 90112
buffer_load_dwordx4 a[140:143], v3, s[48:51], s6 offen
s_mov_b32 s6, 98304
buffer_load_dwordx4 a[144:147], v3, s[48:51], s6 offen
s_mov_b32 s6, 106496
buffer_load_dwordx4 a[148:151], v3, s[48:51], s6 offen
s_mov_b32 s6, 114688
buffer_load_dwordx4 a[152:155], v3, s[48:51], s6 offen
s_mov_b32 s6, 122880
buffer_load_dwordx4 a[156:159], v3, s[48:51], s6 offen
s_mov_b32 s6, 131072
buffer_load_dwordx4 a[160:163], v3, s[48:51], s6 offen
s_mov_b32 s6, 139264
buffer_load_dwordx4 a[164:167], v3, s[48:51], s6 offen
s_mov_b32 s6, 147456
buffer_load_dwordx4 a[168:171], v3, s[48:51], s6 offen
s_mov_b32 s6, 155648
buffer_load_dwordx4 a[172:175], v3, s[48:51], s6 offen
s_mov_b32 s6, 163840
buffer_load_dwordx4 a[176:179], v3, s[48:51], s6 offen
s_mov_b32 s6, 172032
buffer_load_dwordx4 a[180:183], v3, s[48:51], s6 offen
s_mov_b32 s6, 180224
buffer_load_dwordx4 a[184:187], v3, s[48:51], s6 offen
s_mov_b32 s6, 188416
buffer_load_dwordx4 a[188:191], v3, s[48:51], s6 offen
s_mov_b32 s6, 196608
buffer_load_dwordx4 a[192:195], v3, s[48:51], s6 offen
s_mov_b32 s6, 204800
buffer_load_dwordx4 a[196:199], v3, s[48:51], s6 offen
s_mov_b32 s6, 212992
buffer_load_dwordx4 a[200:203], v3, s[48:51], s6 offen
s_mov_b32 s6, 221184
buffer_load_dwordx4 a[204:207], v3, s[48:51], s6 offen
s_mov_b32 s6, 229376
buffer_load_dwordx4 a[208:211], v3, s[48:51], s6 offen
s_mov_b32 s6, 237568
buffer_load_dwordx4 a[212:215], v3, s[48:51], s6 offen
s_mov_b32 s6, 245760
buffer_load_dwordx4 a[216:219], v3, s[48:51], s6 offen
s_mov_b32 s6, 253952
buffer_load_dwordx4 a[220:223], v3, s[48:51], s6 offen
s_mov_b32 s6, 262144
buffer_load_dwordx4 a[224:227], v3, s[48:51], s6 offen
s_mov_b32 s6, 270336
buffer_load_dwordx4 a[228:231], v3, s[48:51], s6 offen
s_mov_b32 s6, 278528
buffer_load_dwordx4 a[232:235], v3, s[48:51], s6 offen
s_mov_b32 s6, 286720
buffer_load_dwordx4 a[236:239], v3, s[48:51], s6 offen
L_nowq_1:
s_waitcnt vmcnt(54)
buffer_load_dwordx4 v[168:171], v2, s[52:55], s12 offen offset:0 nt
buffer_load_dwordx4 v[172:175], v2, s[52:55], s12 offen offset:1024 nt
buffer_load_dwordx4 v[176:179], v2, s[52:55], s12 offen offset:2048 nt
buffer_load_dwordx4 v[180:183], v2, s[52:55], s12 offen offset:3072 nt
s_add_u32 s13, s13, 24576
s_min_u32 s12, s13, 2146435072
s_waitcnt vmcnt(54)
buffer_load_dwordx4 v[184:187], v2, s[52:55], s12 offen offset:0 nt
buffer_load_dwordx4 v[188:191], v2, s[52:55], s12 offen offset:1024 nt
buffer_load_dwordx4 v[192:195], v2, s[52:55], s12 offen offset:2048 nt
buffer_load_dwordx4 v[196:199], v2, s[52:55], s12 offen offset:3072 nt
s_add_u32 s13, s13, 24576
s_min_u32 s12, s13, 2146435072
s_waitcnt vmcnt(54)
buffer_load_dwordx4 v[200:203], v2, s[52:55], s12 offen offset:0 nt
buffer_load_dwordx4 v[204:207], v2, s[52:55], s12 offen offset:1024 nt
buffer_load_dwordx4 v[208:211], v2, s[52:55], s12 offen offset:2048 nt
buffer_load_dwordx4 v[212:215], v2, s[52:55], s12 offen offset:3072 nt
s_add_u32 s13, s13, 24576
s_min_u32 s12, s13, 2146435072
s_cmp_lg_u32 s8, 1
s_cbranch_scc1 L_nowq_2
s_waitcnt vmcnt(20)
s_mov_b32 s6, 0
buffer_load_dwordx4 a[96:99], v3, s[48:51], s6 offen
s_mov_b32 s6, 8192
buffer_load_dwordx4 a[100:103], v3, s[48:51], s6 offen
s_mov_b32 s6, 16384
buffer_load_dwordx4 a[104:107], v3, s[48:51], s6 offen
s_mov_b32 s6, 24576
buffer_load_dwordx4 a[108:111], v3, s[48:51], s6 offen
s_mov_b32 s6, 32768
buffer_load_dwordx4 a[112:115], v3, s[48:51], s6 offen
s_mov_b32 s6, 40960
buffer_load_dwordx4 a[116:119], v3, s[48:51], s6 offen
s_mov_b32 s6, 49152
buffer_load_dwordx4 a[120:123], v3, s[48:51], s6 offen
s_mov_b32 s6, 57344
buffer_load_dwordx4 a[124:127], v3, s[48:51], s6 offen
s_mov_b32 s6, 65536
buffer_load_dwordx4 a[128:131], v3, s[48:51], s6 offen
s_mov_b32 s6, 73728
buffer_load_dwordx4 a[132:135], v3, s[48:51], s6 offen
s_mov_b32 s6, 81920
buffer_load_dwordx4 a[136:139], v3, s[48:51], s6 offen
s_mov_b32 s6, 90112
buffer_load_dwordx4 a[140:143], v3, s[48:51], s6 offen
s_mov_b32 s6, 98304
buffer_load_dwordx4 a[144:147], v3, s[48:51], s6 offen
s_mov_b32 s6, 106496
buffer_load_dwordx4 a[148:151], v3, s[48:51], s6 offen
s_mov_b32 s6, 114688
buffer_load_dwordx4 a[152:155], v3, s[48:51], s6 offen
s_mov_b32 s6, 122880
buffer_load_dwordx4 a[156:159], v3, s[48:51], s6 offen
s_mov_b32 s6, 131072
buffer_load_dwordx4 a[160:163], v3, s[48:51], s6 offen
s_mov_b32 s6, 139264
buffer_load_dwordx4 a[164:167], v3, s[48:51], s6 offen
s_mov_b32 s6, 147456
buffer_load_dwordx4 a[168:171], v3, s[48:51], s6 offen
s_mov_b32 s6, 155648
buffer_load_dwordx4 a[172:175], v3, s[48:51], s6 offen
s_mov_b32 s6, 163840
buffer_load_dwordx4 a[176:179], v3, s[48:51], s6 offen
s_mov_b32 s6, 172032
buffer_load_dwordx4 a[180:183], v3, s[48:51], s6 offen
s_mov_b32 s6, 180224
buffer_load_dwordx4 a[184:187], v3, s[48:51], s6 offen
s_mov_b32 s6, 188416
buffer_load_dwordx4 a[188:191], v3, s[48:51], s6 offen
s_mov_b32 s6, 196608
buffer_load_dwordx4 a[192:195], v3, s[48:51], s6 offen
s_mov_b32 s6, 204800
buffer_load_dwordx4 a[196:199], v3, s[48:51], s6 offen
s_mov_b32 s6, 212992
buffer_load_dwordx4 a[200:203], v3, s[48:51], s6 offen
s_mov_b32 s6, 221184
buffer_load_dwordx4 a[204:207], v3, s[48:51], s6 offen
s_mov_b32 s6, 229376
buffer_load_dwordx4 a[208:211], v3, s[48:51], s6 offen
s_mov_b32 s6, 237568
buffer_load_dwordx4 a[212:215], v3, s[48:51], s6 offen
s_mov_b32 s6, 245760
buffer_load_dwordx4 a[216:219], v3, s[48:51], s6 offen
s_mov_b32 s6, 253952
buffer_load_dwordx4 a[220:223], v3, s[48:51], s6 offen
s_mov_b32 s6, 262144
buffer_load_dwordx4 a[224:227], v3, s[48:51], s6 offen
s_mov_b32 s6, 270336
buffer_load_dwordx4 a[228:231], v3, s[48:51], s6 offen
s_mov_b32 s6, 278528
buffer_load_dwordx4 a[232:235], v3, s[48:51], s6 offen
s_mov_b32 s6, 286720
buffer_load_dwordx4 a[236:239], v3, s[48:51], s6 offen
L_nowq_2:
s_waitcnt vmcnt(54)
buffer_load_dwordx4 v[216:219], v2, s[52:55], s12 offen offset:0 nt
buffer_load_dwordx4 v[220:223], v2, s[52:55], s12 offen offset:1024 nt
buffer_load_dwordx4 v[224:227], v2, s[52:55], s12 offen offset:2048 nt
buffer_load_dwordx4 v[228:231], v2, s[52:55], s12 offen offset:3072 nt
s_add_u32 s13, s13, 24576
s_min_u32 s12, s13, 2146435072
s_waitcnt vmcnt(54)
buffer_load_dwordx4 v[232:235], v2, s[52:55], s12 offen offset:0 nt
buffer_load_dwordx4 v[236:239], v2, s[52:55], s12 offen offset:1024 nt
buffer_load_dwordx4 v[240:243], v2, s[52:55], s12 offen offset:2048 nt
buffer_load_dwordx4 v[244:247], v2, s[52:55], s12 offen offset:3072 nt
s_add_u32 s13, s13, 24576
s_min_u32 s12, s13, 2146435072
s_waitcnt vmcnt(54)
s_add_u32 s34, s14, 24576
s_min_u32 s34, s34, 2146435072
buffer_load_dwordx4 a[0:3], v2, s[56:59], s34 offen offset:0 nt
buffer_load_dwordx4 a[4:7], v2, s[56:59], s34 offen offset:1024 nt
buffer_load_dwordx4 a[8:11], v2, s[56:59], s34 offen offset:2048 nt
buffer_load_dwordx4 a[12:15], v2, s[56:59], s34 offen offset:3072 nt
s_cmp_lg_u32 s8, 2
s_cbranch_scc1 L_nowq_3
s_waitcnt vmcnt(20)
s_mov_b32 s6, 0
buffer_load_dwordx4 a[96:99], v3, s[48:51], s6 offen
s_mov_b32 s6, 8192
buffer_load_dwordx4 a[100:103], v3, s[48:51], s6 offen
s_mov_b32 s6, 16384
buffer_load_dwordx4 a[104:107], v3, s[48:51], s6 offen
s_mov_b32 s6, 24576
buffer_load_dwordx4 a[108:111], v3, s[48:51], s6 offen
s_mov_b32 s6, 32768
buffer_load_dwordx4 a[112:115], v3, s[48:51], s6 offen
s_mov_b32 s6, 40960
buffer_load_dwordx4 a[116:119], v3, s[48:51], s6 offen
s_mov_b32 s6, 49152
buffer_load_dwordx4 a[120:123], v3, s[48:51], s6 offen
s_mov_b32 s6, 57344
buffer_load_dwordx4 a[124:127], v3, s[48:51], s6 offen
s_mov_b32 s6, 65536
buffer_load_dwordx4 a[128:131], v3, s[48:51], s6 offen
s_mov_b32 s6, 73728
buffer_load_dwordx4 a[132:135], v3, s[48:51], s6 offen
s_mov_b32 s6, 81920
buffer_load_dwordx4 a[136:139], v3, s[48:51], s6 offen
s_mov_b32 s6, 90112
buffer_load_dwordx4 a[140:143], v3, s[48:51], s6 offen
s_mov_b32 s6, 98304
buffer_load_dwordx4 a[144:147], v3, s[48:51], s6 offen
s_mov_b32 s6, 106496
buffer_load_dwordx4 a[148:151], v3, s[48:51], s6 offen
s_mov_b32 s6, 114688
buffer_load_dwordx4 a[152:155], v3, s[48:51], s6 offen
s_mov_b32 s6, 122880
buffer_load_dwordx4 a[156:159], v3, s[48:51], s6 offen
s_mov_b32 s6, 131072
buffer_load_dwordx4 a[160:163], v3, s[48:51], s6 offen
s_mov_b32 s6, 139264
buffer_load_dwordx4 a[164:167], v3, s[48:51], s6 offen
s_mov_b32 s6, 147456
buffer_load_dwordx4 a[168:171], v3, s[48:51], s6 offen
s_mov_b32 s6, 155648
buffer_load_dwordx4 a[172:175], v3, s[48:51], s6 offen
s_mov_b32 s6, 163840
buffer_load_dwordx4 a[176:179], v3, s[48:51], s6 offen
s_mov_b32 s6, 172032
buffer_load_dwordx4 a[180:183], v3, s[48:51], s6 offen
s_mov_b32 s6, 180224
buffer_load_dwordx4 a[184:187], v3, s[48:51], s6 offen
s_mov_b32 s6, 188416
buffer_load_dwordx4 a[188:191], v3, s[48:51], s6 offen
s_mov_b32 s6, 196608
buffer_load_dwordx4 a[192:195], v3, s[48:51], s6 offen
s_mov_b32 s6, 204800
buffer_load_dwordx4 a[196:199], v3, s[48:51], s6 offen
s_mov_b32 s6, 212992
buffer_load_dwordx4 a[200:203], v3, s[48:51], s6 offen
s_mov_b32 s6, 221184
buffer_load_dwordx4 a[204:207], v3, s[48:51], s6 offen
s_mov_b32 s6, 229376
buffer_load_dwordx4 a[208:211], v3, s[48:51], s6 offen
s_mov_b32 s6, 237568
buffer_load_dwordx4 a[212:215], v3, s[48:51], s6 offen
s_mov_b32 s6, 245760
buffer_load_dwordx4 a[216:219], v3, s[48:51], s6 offen
s_mov_b32 s6, 253952
buffer_load_dwordx4 a[220:223], v3, s[48:51], s6 offen
s_mov_b32 s6, 262144
buffer_load_dwordx4 a[224:227], v3, s[48:51], s6 offen
s_mov_b32 s6, 270336
buffer_load_dwordx4 a[228:231], v3, s[48:51], s6 offen
s_mov_b32 s6, 278528
buffer_load_dwordx4 a[232:235], v3, s[48:51], s6 offen
s_mov_b32 s6, 286720
buffer_load_dwordx4 a[236:239], v3, s[48:51], s6 offen
L_nowq_3:
s_mov_b32 s64, s42
s_mov_b32 s65, s43
s_mov_b32 s66, 6291456
s_mov_b32 s67, 0x20000
s_mov_b32 s68, s40
s_mov_b32 s69, s41
s_mov_b32 s70, 256
s_mov_b32 s71, 0x20000
s_mul_i32 s6, s4, 147456
s_add_u32 s60, s24, s6
s_addc_u32 s61, s25, 0
s_mov_b32 s62, 147456
s_mov_b32 s63, 0x20000
v_and_b32 v5, 1, v1
v_lshlrev_b32 v5, 4, v5
v_mov_b32 v6, 0xffff
v_lshlrev_b32 v5, v5, v6
v_bfe_u32 v6, v1, 1, 2
v_cmp_eq_u32 vcc, 0, v6
s_nop 1
v_cndmask_b32 v8, 0, v5, vcc
v_cmp_eq_u32 vcc, 1, v6
s_nop 1
v_cndmask_b32 v9, 0, v5, vcc
v_cmp_eq_u32 vcc, 2, v6
s_nop 1
v_cndmask_b32 v10, 0, v5, vcc
v_cmp_eq_u32 vcc, 3, v6
s_nop 1
v_cndmask_b32 v11, 0, v5, vcc
v_mov_b32 v5, 0x0c0c0c0c
s_mov_b32 s6, 0x01000100
s_mov_b32 s7, 0x03020302
v_bfi_b32 v12, v8, s6, v5
v_bfi_b32 v13, v9, s6, v5
v_bfi_b32 v14, v10, s6, v5
v_bfi_b32 v15, v11, s6, v5
v_bfi_b32 v16, v8, s7, v5
v_bfi_b32 v17, v9, s7, v5
v_bfi_b32 v18, v10, s7, v5
v_bfi_b32 v19, v11, s7, v5
v_mov_b32 v7, 0x3e0293ee
v_mov_b32 v86, 0xff800000
v_lshrrev_b32 v5, 4, v1
v_lshlrev_b32 v5, 3, v5
v_bfe_u32 v6, v1, 2, 2
v_add_u32 v5, v5, v6
v_mul_u32_u24 v5, 1152, v5
s_mul_i32 s6, s3, 288
v_add_u32 v5, s6, v5
v_and_b32 v6, 3, v1
v_lshl_add_u32 v88, v6, 5, v5
v_lshl_add_u32 v89, v6, 3, v5
v_add_u32 v89, 256, v89
v_add_u32 v90, 73728, v88
v_add_u32 v91, 73728, v89
s_lshl_b32 s82, s82, 6
s_add_u32 s82, s82, 327680
s_mov_b64 s[72:73], 0
s_cmp_ge_u32 s11, 2
s_cselect_b32 s74, 0x22222222, 0
s_mov_b32 s75, s74
s_mov_b32 s76, 0x44444444
s_mov_b32 s77, s76
s_mov_b32 s78, 0x88888888
s_mov_b32 s79, s78
v_bfe_u32 v5, v1, 4, 1
s_lshl_b32 s6, s9, 7
s_lshl_b32 s7, s4, 1
s_add_u32 s6, s6, s7
s_add_u32 s6, s6, s8
v_mul_u32_u24 v6, 63, v5
v_add_u32 v6, s6, v6
v_mul_u32_u24 v92, 2304, v6
v_add_u32 v92, 4194304, v92
v_sub_u32 v6, s8, v5
v_cmp_lt_u32 vcc, 1, v6
v_mov_b32 v6, 2146435072
s_nop 0
v_cndmask_b32 v92, v92, v6, vcc
s_mul_i32 s6, s3, 576
v_add_u32 v92, s6, v92
v_and_b32 v35, 3, v1
v_bfe_u32 v36, v1, 2, 2
v_lshl_add_u32 v35, v35, 2, v36
v_lshl_add_u32 v93, v35, 2, v92
v_and_b32 v35, 15, v1
v_lshrrev_b32 v36, 5, v1
v_lshl_add_u32 v35, v36, 4, v35
v_lshl_add_u32 v92, v35, 4, v92
s_lshl_b32 s6, s8, 2
s_add_u32 s6, s6, 0
s_cmp_ge_u32 s6, 6
s_cselect_b32 s6, 1, 0
v_cmp_eq_u32 vcc, s6, v5
s_nop 1
v_cndmask_b32 v106, 0, 1.0, vcc
s_lshl_b32 s6, s8, 2
s_add_u32 s6, s6, 1
s_cmp_ge_u32 s6, 6
s_cselect_b32 s6, 1, 0
v_cmp_eq_u32 vcc, s6, v5
s_nop 1
v_cndmask_b32 v107, 0, 1.0, vcc
s_lshl_b32 s6, s8, 2
s_add_u32 s6, s6, 2
s_cmp_ge_u32 s6, 6
s_cselect_b32 s6, 1, 0
v_cmp_eq_u32 vcc, s6, v5
s_nop 1
v_cndmask_b32 v108, 0, 1.0, vcc
s_lshl_b32 s6, s8, 2
s_add_u32 s6, s6, 3
s_cmp_ge_u32 s6, 6
s_cselect_b32 s6, 1, 0
v_cmp_eq_u32 vcc, s6, v5
s_nop 1
v_cndmask_b32 v109, 0, 1.0, vcc
v_cmp_gt_u32 vcc, 32, v1
s_nop 1
v_cndmask_b32 v98, 0, v106, vcc
v_cndmask_b32 v102, v106, 0, vcc
v_cndmask_b32 v99, 0, v107, vcc
v_cndmask_b32 v103, v107, 0, vcc
v_cndmask_b32 v100, 0, v108, vcc
v_cndmask_b32 v104, v108, 0, vcc
v_cndmask_b32 v101, 0, v109, vcc
v_cndmask_b32 v105, v109, 0, vcc
v_and_b32 v35, 15, v1
v_lshlrev_b32 v35, 4, v35
v_lshl_add_u32 v94, v5, 3, v35
s_lshl_b32 s6, s3, 8
s_add_u32 s6, s6, 151552
v_add_u32 v94, s6, v94
v_and_b32 v35, 3, v1
v_lshlrev_b32 v35, 8, v35
v_lshrrev_b32 v36, 4, v1
v_lshl_add_u32 v95, v36, 4, v35
v_add_u32 v95, 151552, v95
s_mul_i32 s15, s3, 36864
s_mov_b32 s80, 0x0
s_mov_b32 s81, 0
s_lshl_b32 s6, s4, 1
s_add_u32 s6, s6, s9
s_mul_i32 s6, s6, 4
s_add_u32 s6, s6, s8
s_lshl_b32 s6, s6, 2
s_add_u32 s6, s6, 393216
v_mov_b32 v118, 2146435072
v_mov_b32 v117, s6
v_cmp_eq_u32 vcc, 0, v0
s_nop 1
v_cndmask_b32 v118, v118, v117, vcc
v_mov_b32 v117, 3
v_and_b32 v35, 15, v1
v_lshlrev_b32 v35, 5, v35
v_lshl_add_u32 v36, v5, 4, v35
v_lshrrev_b32 v6, 5, v1
v_lshl_add_u32 v36, v6, 9, v36
s_lshl_b32 s6, s3, 10
s_add_u32 s6, s6, 147456
v_add_u32 v36, s6, v36
s_lshl_b32 s6, s83, 9
s_add_u32 s6, s6, 147456
v_add_u32 v35, s6, v35
s_waitcnt vmcnt(35)
v_perm_b32 v60, v40, v40, v12
v_perm_b32 v61, v40, v40, v13
v_perm_b32 v62, v40, v40, v14
v_perm_b32 v63, v40, v40, v15
s_nop 1
v_mfma_f32_16x16x32_bf16 v[20:23], v[60:63], a[96:99], 0
s_add_u32 s34, s14, 49152
s_min_u32 s34, s34, 2146435072
buffer_load_dwordx4 a[16:19], v2, s[56:59], s34 offen offset:0 nt
s_waitcnt vmcnt(35)
v_perm_b32 v64, v40, v40, v16
v_perm_b32 v65, v40, v40, v17
v_perm_b32 v66, v40, v40, v18
v_perm_b32 v67, v40, v40, v19
s_nop 1
v_mfma_f32_16x16x32_bf16 v[20:23], v[64:67], a[100:103], v[20:23]
buffer_load_dwordx4 a[20:23], v2, s[56:59], s34 offen offset:1024 nt
s_waitcnt vmcnt(35)
v_perm_b32 v68, v41, v41, v12
v_perm_b32 v69, v41, v41, v13
v_perm_b32 v70, v41, v41, v14
v_perm_b32 v71, v41, v41, v15
s_nop 1
v_mfma_f32_16x16x32_bf16 v[20:23], v[68:71], a[104:107], v[20:23]
buffer_load_dwordx4 a[24:27], v2, s[56:59], s34 offen offset:2048 nt
s_waitcnt vmcnt(35)
v_perm_b32 v72, v41, v41, v16
v_perm_b32 v73, v41, v41, v17
v_perm_b32 v74, v41, v41, v18
v_perm_b32 v75, v41, v41, v19
s_nop 1
v_mfma_f32_16x16x32_bf16 v[20:23], v[72:75], a[108:111], v[20:23]
buffer_load_dwordx4 a[28:31], v2, s[56:59], s34 offen offset:3072 nt
s_waitcnt vmcnt(35)
v_perm_b32 v60, v42, v42, v12
v_perm_b32 v61, v42, v42, v13
v_perm_b32 v62, v42, v42, v14
v_perm_b32 v63, v42, v42, v15
s_nop 1
v_mfma_f32_16x16x32_bf16 v[20:23], v[60:63], a[112:115], v[20:23]
s_add_u32 s34, s14, 73728
s_min_u32 s34, s34, 2146435072
buffer_load_dwordx4 a[32:35], v2, s[56:59], s34 offen offset:0 nt
s_waitcnt vmcnt(35)
v_perm_b32 v64, v42, v42, v16
v_perm_b32 v65, v42, v42, v17
v_perm_b32 v66, v42, v42, v18
v_perm_b32 v67, v42, v42, v19
s_nop 1
v_mfma_f32_16x16x32_bf16 v[20:23], v[64:67], a[116:119], v[20:23]
buffer_load_dwordx4 a[36:39], v2, s[56:59], s34 offen offset:1024 nt
s_waitcnt vmcnt(35)
v_perm_b32 v68, v43, v43, v12
v_perm_b32 v69, v43, v43, v13
v_perm_b32 v70, v43, v43, v14
v_perm_b32 v71, v43, v43, v15
s_nop 1
v_mfma_f32_16x16x32_bf16 v[20:23], v[68:71], a[120:123], v[20:23]
buffer_load_dwordx4 a[40:43], v2, s[56:59], s34 offen offset:2048 nt
s_waitcnt vmcnt(35)
v_perm_b32 v72, v43, v43, v16
v_perm_b32 v73, v43, v43, v17
v_perm_b32 v74, v43, v43, v18
v_perm_b32 v75, v43, v43, v19
s_nop 1
v_mfma_f32_16x16x32_bf16 v[20:23], v[72:75], a[124:127], v[20:23]
buffer_load_dwordx4 a[44:47], v2, s[56:59], s34 offen offset:3072 nt
s_waitcnt vmcnt(35)
v_perm_b32 v60, v44, v44, v12
v_perm_b32 v61, v44, v44, v13
v_perm_b32 v62, v44, v44, v14
v_perm_b32 v63, v44, v44, v15
s_nop 1
v_mfma_f32_16x16x32_bf16 v[20:23], v[60:63], a[128:131], v[20:23]
s_add_u32 s34, s14, 98304
s_min_u32 s34, s34, 2146435072
buffer_load_dwordx4 a[48:51], v2, s[56:59], s34 offen offset:0 nt
s_waitcnt vmcnt(35)
v_perm_b32 v64, v44, v44, v16
v_perm_b32 v65, v44, v44, v17
v_perm_b32 v66, v44, v44, v18
v_perm_b32 v67, v44, v44, v19
s_nop 1
v_mfma_f32_16x16x32_bf16 v[20:23], v[64:67], a[132:135], v[20:23]
buffer_load_dwordx4 a[52:55], v2, s[56:59], s34 offen offset:1024 nt
s_waitcnt vmcnt(35)
v_perm_b32 v68, v45, v45, v12
v_perm_b32 v69, v45, v45, v13
v_perm_b32 v70, v45, v45, v14
v_perm_b32 v71, v45, v45, v15
s_nop 1
v_mfma_f32_16x16x32_bf16 v[20:23], v[68:71], a[136:139], v[20:23]
buffer_load_dwordx4 a[56:59], v2, s[56:59], s34 offen offset:2048 nt
s_waitcnt vmcnt(35)
v_perm_b32 v72, v45, v45, v16
v_perm_b32 v73, v45, v45, v17
v_perm_b32 v74, v45, v45, v18
v_perm_b32 v75, v45, v45, v19
s_nop 1
v_mfma_f32_16x16x32_bf16 v[20:23], v[72:75], a[140:143], v[20:23]
buffer_load_dwordx4 a[60:63], v2, s[56:59], s34 offen offset:3072 nt
s_waitcnt vmcnt(35)
v_perm_b32 v60, v46, v46, v12
v_perm_b32 v61, v46, v46, v13
v_perm_b32 v62, v46, v46, v14
v_perm_b32 v63, v46, v46, v15
s_nop 1
v_mfma_f32_16x16x32_bf16 v[20:23], v[60:63], a[144:147], v[20:23]
s_add_u32 s34, s14, 122880
s_min_u32 s34, s34, 2146435072
buffer_load_dwordx4 a[64:67], v2, s[56:59], s34 offen offset:0 nt
s_waitcnt vmcnt(35)
v_perm_b32 v64, v46, v46, v16
v_perm_b32 v65, v46, v46, v17
v_perm_b32 v66, v46, v46, v18
v_perm_b32 v67, v46, v46, v19
s_nop 1
v_mfma_f32_16x16x32_bf16 v[20:23], v[64:67], a[148:151], v[20:23]
buffer_load_dwordx4 a[68:71], v2, s[56:59], s34 offen offset:1024 nt
s_waitcnt vmcnt(35)
v_perm_b32 v68, v47, v47, v12
v_perm_b32 v69, v47, v47, v13
v_perm_b32 v70, v47, v47, v14
v_perm_b32 v71, v47, v47, v15
s_nop 1
v_mfma_f32_16x16x32_bf16 v[20:23], v[68:71], a[152:155], v[20:23]
buffer_load_dwordx4 a[72:75], v2, s[56:59], s34 offen offset:2048 nt
s_waitcnt vmcnt(35)
v_perm_b32 v72, v47, v47, v16
v_perm_b32 v73, v47, v47, v17
v_perm_b32 v74, v47, v47, v18
v_perm_b32 v75, v47, v47, v19
s_nop 1
v_mfma_f32_16x16x32_bf16 v[20:23], v[72:75], a[156:159], v[20:23]
buffer_load_dwordx4 a[76:79], v2, s[56:59], s34 offen offset:3072 nt
s_waitcnt vmcnt(35)
v_perm_b32 v60, v48, v48, v12
v_perm_b32 v61, v48, v48, v13
v_perm_b32 v62, v48, v48, v14
v_perm_b32 v63, v48, v48, v15
s_nop 1
v_mfma_f32_16x16x32_bf16 v[20:23], v[60:63], a[160:163], v[20:23]
s_add_u32 s34, s14, 147456
s_min_u32 s34, s34, 2146435072
buffer_load_dwordx4 a[80:83], v2, s[56:59], s34 offen offset:0 nt
s_waitcnt vmcnt(35)
v_perm_b32 v64, v48, v48, v16
v_perm_b32 v65, v48, v48, v17
v_perm_b32 v66, v48, v48, v18
v_perm_b32 v67, v48, v48, v19
s_nop 1
v_mfma_f32_16x16x32_bf16 v[20:23], v[64:67], a[164:167], v[20:23]
buffer_load_dwordx4 a[84:87], v2, s[56:59], s34 offen offset:1024 nt
s_waitcnt vmcnt(35)
v_perm_b32 v68, v49, v49, v12
v_perm_b32 v69, v49, v49, v13
v_perm_b32 v70, v49, v49, v14
v_perm_b32 v71, v49, v49, v15
s_nop 1
v_mfma_f32_16x16x32_bf16 v[20:23], v[68:71], a[168:171], v[20:23]
buffer_load_dwordx4 a[88:91], v2, s[56:59], s34 offen offset:2048 nt
s_waitcnt vmcnt(35)
v_perm_b32 v72, v49, v49, v16
v_perm_b32 v73, v49, v49, v17
v_perm_b32 v74, v49, v49, v18
v_perm_b32 v75, v49, v49, v19
s_nop 1
v_mfma_f32_16x16x32_bf16 v[20:23], v[72:75], a[172:175], v[20:23]
buffer_load_dwordx4 a[92:95], v2, s[56:59], s34 offen offset:3072 nt
s_waitcnt vmcnt(35)
v_perm_b32 v60, v50, v50, v12
v_perm_b32 v61, v50, v50, v13
v_perm_b32 v62, v50, v50, v14
v_perm_b32 v63, v50, v50, v15
s_nop 1
v_mfma_f32_16x16x32_bf16 v[20:23], v[60:63], a[176:179], v[20:23]
s_add_u32 s34, s14, 172032
s_min_u32 s34, s34, 2146435072
buffer_load_dwordx4 a[240:243], v2, s[56:59], s34 offen offset:0 nt
s_waitcnt vmcnt(35)
v_perm_b32 v64, v50, v50, v16
v_perm_b32 v65, v50, v50, v17
v_perm_b32 v66, v50, v50, v18
v_perm_b32 v67, v50, v50, v19
s_nop 1
v_mfma_f32_16x16x32_bf16 v[20:23], v[64:67], a[180:183], v[20:23]
buffer_load_dwordx4 a[244:247], v2, s[56:59], s34 offen offset:1024 nt
s_waitcnt vmcnt(35)
v_perm_b32 v68, v51, v51, v12
v_perm_b32 v69, v51, v51, v13
v_perm_b32 v70, v51, v51, v14
v_perm_b32 v71, v51, v51, v15
s_nop 1
v_mfma_f32_16x16x32_bf16 v[20:23], v[68:71], a[184:187], v[20:23]
buffer_load_dwordx4 a[248:251], v2, s[56:59], s34 offen offset:2048 nt
s_waitcnt vmcnt(35)
v_perm_b32 v72, v51, v51, v16
v_perm_b32 v73, v51, v51, v17
v_perm_b32 v74, v51, v51, v18
v_perm_b32 v75, v51, v51, v19
s_nop 1
v_mfma_f32_16x16x32_bf16 v[20:23], v[72:75], a[188:191], v[20:23]
buffer_load_dwordx4 a[252:255], v2, s[56:59], s34 offen offset:3072 nt
s_waitcnt vmcnt(35)
v_perm_b32 v60, v52, v52, v12
v_perm_b32 v61, v52, v52, v13
v_perm_b32 v62, v52, v52, v14
v_perm_b32 v63, v52, v52, v15
s_nop 1
v_mfma_f32_16x16x32_bf16 v[20:23], v[60:63], a[192:195], v[20:23]
s_waitcnt vmcnt(34)
v_perm_b32 v64, v52, v52, v16
v_perm_b32 v65, v52, v52, v17
v_perm_b32 v66, v52, v52, v18
v_perm_b32 v67, v52, v52, v19
s_nop 1
v_mfma_f32_16x16x32_bf16 v[20:23], v[64:67], a[196:199], v[20:23]
s_waitcnt vmcnt(33)
v_perm_b32 v68, v53, v53, v12
v_perm_b32 v69, v53, v53, v13
v_perm_b32 v70, v53, v53, v14
v_perm_b32 v71, v53, v53, v15
s_nop 1
v_mfma_f32_16x16x32_bf16 v[20:23], v[68:71], a[200:203], v[20:23]
s_waitcnt vmcnt(32)
v_perm_b32 v72, v53, v53, v16
v_perm_b32 v73, v53, v53, v17
v_perm_b32 v74, v53, v53, v18
v_perm_b32 v75, v53, v53, v19
s_nop 1
v_mfma_f32_16x16x32_bf16 v[20:23], v[72:75], a[204:207], v[20:23]
s_waitcnt vmcnt(31)
v_perm_b32 v60, v54, v54, v12
v_perm_b32 v61, v54, v54, v13
v_perm_b32 v62, v54, v54, v14
v_perm_b32 v63, v54, v54, v15
s_nop 1
v_mfma_f32_16x16x32_bf16 v[20:23], v[60:63], a[208:211], v[20:23]
s_waitcnt vmcnt(30)
v_perm_b32 v64, v54, v54, v16
v_perm_b32 v65, v54, v54, v17
v_perm_b32 v66, v54, v54, v18
v_perm_b32 v67, v54, v54, v19
s_nop 1
v_mfma_f32_16x16x32_bf16 v[20:23], v[64:67], a[212:215], v[20:23]
s_waitcnt vmcnt(29)
v_perm_b32 v68, v55, v55, v12
v_perm_b32 v69, v55, v55, v13
v_perm_b32 v70, v55, v55, v14
v_perm_b32 v71, v55, v55, v15
s_nop 1
v_mfma_f32_16x16x32_bf16 v[20:23], v[68:71], a[216:219], v[20:23]
s_waitcnt vmcnt(28)
v_perm_b32 v72, v55, v55, v16
v_perm_b32 v73, v55, v55, v17
v_perm_b32 v74, v55, v55, v18
v_perm_b32 v75, v55, v55, v19
s_nop 1
v_mfma_f32_16x16x32_bf16 v[20:23], v[72:75], a[220:223], v[20:23]
s_waitcnt vmcnt(27)
v_perm_b32 v60, v56, v56, v12
v_perm_b32 v61, v56, v56, v13
v_perm_b32 v62, v56, v56, v14
v_perm_b32 v63, v56, v56, v15
s_nop 1
v_mfma_f32_16x16x32_bf16 v[20:23], v[60:63], a[224:227], v[20:23]
s_waitcnt vmcnt(26)
v_perm_b32 v64, v56, v56, v16
v_perm_b32 v65, v56, v56, v17
v_perm_b32 v66, v56, v56, v18
v_perm_b32 v67, v56, v56, v19
s_nop 1
v_mfma_f32_16x16x32_bf16 v[20:23], v[64:67], a[228:231], v[20:23]
s_waitcnt vmcnt(25)
v_perm_b32 v68, v57, v57, v12
v_perm_b32 v69, v57, v57, v13
v_perm_b32 v70, v57, v57, v14
v_perm_b32 v71, v57, v57, v15
s_nop 1
v_mfma_f32_16x16x32_bf16 v[20:23], v[68:71], a[232:235], v[20:23]
s_waitcnt vmcnt(24)
v_perm_b32 v72, v57, v57, v16
v_perm_b32 v73, v57, v57, v17
v_perm_b32 v74, v57, v57, v18
v_perm_b32 v75, v57, v57, v19
s_nop 1
v_mfma_f32_16x16x32_bf16 v[20:23], v[72:75], a[236:239], v[20:23]
s_nop 7
ds_write_b128 v36, v[20:23]
s_waitcnt lgkmcnt(0)
s_barrier
ds_read_b128 v[40:43], v35 offset:0
ds_read_b128 v[44:47], v35 offset:16
ds_read_b128 v[48:51], v35 offset:1024
ds_read_b128 v[52:55], v35 offset:1040
ds_read_b128 v[56:59], v35 offset:2048
ds_read_b128 v[60:63], v35 offset:2064
ds_read_b128 v[64:67], v35 offset:3072
ds_read_b128 v[68:71], v35 offset:3088
v_mov_b32 v20, 0
v_mov_b32 v21, 0
v_mov_b32 v22, 0
v_mov_b32 v23, 0
s_waitcnt lgkmcnt(0)
v_add_f32 v40, v40, v48
v_add_f32 v56, v56, v64
v_add_f32 v41, v41, v49
v_add_f32 v57, v57, v65
v_add_f32 v42, v42, v50
v_add_f32 v58, v58, v66
v_add_f32 v43, v43, v51
v_add_f32 v59, v59, v67
v_add_f32 v44, v44, v52
v_add_f32 v60, v60, v68
v_add_f32 v45, v45, v53
v_add_f32 v61, v61, v69
v_add_f32 v46, v46, v54
v_add_f32 v62, v62, v70
v_add_f32 v47, v47, v55
v_add_f32 v63, v63, v71
v_add_f32 v40, v40, v56
v_add_f32 v41, v41, v57
v_add_f32 v42, v42, v58
v_add_f32 v43, v43, v59
v_add_f32 v44, v44, v60
v_add_f32 v45, v45, v61
v_add_f32 v46, v46, v62
v_add_f32 v47, v47, v63
v_cvt_pk_bf16_f32 v24, v40, v41
v_cvt_pk_bf16_f32 v25, v42, v43
v_cvt_pk_bf16_f32 v26, v44, v45
v_cvt_pk_bf16_f32 v27, v46, v47
s_mov_b32 s80, 783
s_add_u32 s14, s14, 196608
K_loop:
s_cmp_lg_u32 s81, 8
s_cbranch_scc1 L_c0_4
buffer_load_dword v96, off, s[68:71], 0 offset:0 sc1
L_c0_4:
s_waitcnt vmcnt(28)
v_dot2_f32_bf16 v28, v120, v24, 0
v_dot2_f32_bf16 v29, v124, v24, 0
v_dot2_f32_bf16 v30, v128, v24, 0
v_dot2_f32_bf16 v31, v132, v24, 0
v_dot2_f32_bf16 v28, v121, v25, v28
v_dot2_f32_bf16 v29, v125, v25, v29
v_dot2_f32_bf16 v30, v129, v25, v30
v_dot2_f32_bf16 v31, v133, v25, v31
v_dot2_f32_bf16 v28, v122, v26, v28
v_dot2_f32_bf16 v29, v126, v26, v29
v_dot2_f32_bf16 v30, v130, v26, v30
v_dot2_f32_bf16 v31, v134, v26, v31
v_dot2_f32_bf16 v28, v123, v27, v28
v_dot2_f32_bf16 v29, v127, v27, v29
v_dot2_f32_bf16 v30, v131, v27, v30
v_dot2_f32_bf16 v31, v135, v27, v31
buffer_load_dwordx4 v[120:123], v2, s[52:55], s12 offen offset:0 nt
buffer_load_dwordx4 v[124:127], v2, s[52:55], s12 offen offset:1024 nt
buffer_load_dwordx4 v[128:131], v2, s[52:55], s12 offen offset:2048 nt
buffer_load_dwordx4 v[132:135], v2, s[52:55], s12 offen offset:3072 nt
s_add_u32 s13, s13, 24576
s_min_u32 s12, s13, 2146435072
s_bitcmp0_b32 s80, s81
s_cbranch_scc1 L_nodma_5
s_mov_b32 m0, s15
s_nop 0
buffer_load_dwordx4 v2, s[60:63], s15 offen offset:0  lds
buffer_load_dwordx4 v2, s[60:63], s15 offen offset:1024  lds
s_add_u32 s15, s15, 2048
L_nodma_5:
v_add_f32_dpp v32, v28, v28 row_ror:8 row_mask:0xf bank_mask:0x3
v_add_f32_dpp v33, v29, v29 row_ror:8 row_mask:0xf bank_mask:0x3
v_add_f32_dpp v32, v30, v30 row_ror:8 row_mask:0xf bank_mask:0xc
v_add_f32_dpp v33, v31, v31 row_ror:8 row_mask:0xf bank_mask:0xc
s_nop 0
v_add_f32_dpp v34, v32, v32 row_half_mirror row_mask:0xf bank_mask:0x5
v_add_f32_dpp v34, v33, v33 row_half_mirror row_mask:0xf bank_mask:0xa
s_nop 1
v_add_f32_dpp v34, v34, v34 quad_perm:[1,0,3,2] row_mask:0xf bank_mask:0xf
s_nop 1
v_add_f32_dpp v34, v34, v34 quad_perm:[2,3,0,1] row_mask:0xf bank_mask:0xf
v_cndmask_b32 v86, v86, v34, s[72:73]
s_waitcnt vmcnt(28)
v_dot2_f32_bf16 v28, v136, v24, 0
v_dot2_f32_bf16 v29, v140, v24, 0
v_dot2_f32_bf16 v30, v144, v24, 0
v_dot2_f32_bf16 v31, v148, v24, 0
v_dot2_f32_bf16 v28, v137, v25, v28
v_dot2_f32_bf16 v29, v141, v25, v29
v_dot2_f32_bf16 v30, v145, v25, v30
v_dot2_f32_bf16 v31, v149, v25, v31
v_dot2_f32_bf16 v28, v138, v26, v28
v_dot2_f32_bf16 v29, v142, v26, v29
v_dot2_f32_bf16 v30, v146, v26, v30
v_dot2_f32_bf16 v31, v150, v26, v31
v_dot2_f32_bf16 v28, v139, v27, v28
v_dot2_f32_bf16 v29, v143, v27, v29
v_dot2_f32_bf16 v30, v147, v27, v30
v_dot2_f32_bf16 v31, v151, v27, v31
buffer_load_dwordx4 v[136:139], v2, s[52:55], s12 offen offset:0 nt
buffer_load_dwordx4 v[140:143], v2, s[52:55], s12 offen offset:1024 nt
buffer_load_dwordx4 v[144:147], v2, s[52:55], s12 offen offset:2048 nt
buffer_load_dwordx4 v[148:151], v2, s[52:55], s12 offen offset:3072 nt
s_add_u32 s13, s13, 24576
s_min_u32 s12, s13, 2146435072
s_bitcmp0_b32 s80, s81
s_cbranch_scc1 L_nodma_6
s_mov_b32 m0, s15
s_nop 0
buffer_load_dwordx4 v2, s[60:63], s15 offen offset:0  lds
buffer_load_dwordx4 v2, s[60:63], s15 offen offset:1024  lds
s_add_u32 s15, s15, 2048
L_nodma_6:
v_add_f32_dpp v32, v28, v28 row_ror:8 row_mask:0xf bank_mask:0x3
v_add_f32_dpp v33, v29, v29 row_ror:8 row_mask:0xf bank_mask:0x3
v_add_f32_dpp v32, v30, v30 row_ror:8 row_mask:0xf bank_mask:0xc
v_add_f32_dpp v33, v31, v31 row_ror:8 row_mask:0xf bank_mask:0xc
s_nop 0
v_add_f32_dpp v34, v32, v32 row_half_mirror row_mask:0xf bank_mask:0x5
v_add_f32_dpp v34, v33, v33 row_half_mirror row_mask:0xf bank_mask:0xa
s_nop 1
v_add_f32_dpp v34, v34, v34 quad_perm:[1,0,3,2] row_mask:0xf bank_mask:0xf
s_nop 1
v_add_f32_dpp v34, v34, v34 quad_perm:[2,3,0,1] row_mask:0xf bank_mask:0xf
v_cndmask_b32 v86, v86, v34, s[74:75]
s_waitcnt vmcnt(28)
v_dot2_f32_bf16 v28, v152, v24, 0
v_dot2_f32_bf16 v29, v156, v24, 0
v_dot2_f32_bf16 v30, v160, v24, 0
v_dot2_f32_bf16 v31, v164, v24, 0
v_dot2_f32_bf16 v28, v153, v25, v28
v_dot2_f32_bf16 v29, v157, v25, v29
v_dot2_f32_bf16 v30, v161, v25, v30
v_dot2_f32_bf16 v31, v165, v25, v31
v_dot2_f32_bf16 v28, v154, v26, v28
v_dot2_f32_bf16 v29, v158, v26, v29
v_dot2_f32_bf16 v30, v162, v26, v30
v_dot2_f32_bf16 v31, v166, v26, v31
v_dot2_f32_bf16 v28, v155, v27, v28
v_dot2_f32_bf16 v29, v159, v27, v29
v_dot2_f32_bf16 v30, v163, v27, v30
v_dot2_f32_bf16 v31, v167, v27, v31
buffer_load_dwordx4 v[152:155], v2, s[52:55], s12 offen offset:0 nt
buffer_load_dwordx4 v[156:159], v2, s[52:55], s12 offen offset:1024 nt
buffer_load_dwordx4 v[160:163], v2, s[52:55], s12 offen offset:2048 nt
buffer_load_dwordx4 v[164:167], v2, s[52:55], s12 offen offset:3072 nt
s_add_u32 s13, s13, 24576
s_min_u32 s12, s13, 2146435072
s_bitcmp0_b32 s80, s81
s_cbranch_scc1 L_nodma_7
s_mov_b32 m0, s15
s_nop 0
buffer_load_dwordx4 v2, s[60:63], s15 offen offset:0  lds
buffer_load_dwordx4 v2, s[60:63], s15 offen offset:1024  lds
s_add_u32 s15, s15, 2048
L_nodma_7:
v_add_f32_dpp v32, v28, v28 row_ror:8 row_mask:0xf bank_mask:0x3
v_add_f32_dpp v33, v29, v29 row_ror:8 row_mask:0xf bank_mask:0x3
v_add_f32_dpp v32, v30, v30 row_ror:8 row_mask:0xf bank_mask:0xc
v_add_f32_dpp v33, v31, v31 row_ror:8 row_mask:0xf bank_mask:0xc
s_nop 0
v_add_f32_dpp v34, v32, v32 row_half_mirror row_mask:0xf bank_mask:0x5
v_add_f32_dpp v34, v33, v33 row_half_mirror row_mask:0xf bank_mask:0xa
s_nop 1
v_add_f32_dpp v34, v34, v34 quad_perm:[1,0,3,2] row_mask:0xf bank_mask:0xf
s_nop 1
v_add_f32_dpp v34, v34, v34 quad_perm:[2,3,0,1] row_mask:0xf bank_mask:0xf
v_cndmask_b32 v86, v86, v34, s[76:77]
s_waitcnt vmcnt(28)
v_dot2_f32_bf16 v28, v168, v24, 0
v_dot2_f32_bf16 v29, v172, v24, 0
v_dot2_f32_bf16 v30, v176, v24, 0
v_dot2_f32_bf16 v31, v180, v24, 0
v_dot2_f32_bf16 v28, v169, v25, v28
v_dot2_f32_bf16 v29, v173, v25, v29
v_dot2_f32_bf16 v30, v177, v25, v30
v_dot2_f32_bf16 v31, v181, v25, v31
v_dot2_f32_bf16 v28, v170, v26, v28
v_dot2_f32_bf16 v29, v174, v26, v29
v_dot2_f32_bf16 v30, v178, v26, v30
v_dot2_f32_bf16 v31, v182, v26, v31
v_dot2_f32_bf16 v28, v171, v27, v28
v_dot2_f32_bf16 v29, v175, v27, v29
v_dot2_f32_bf16 v30, v179, v27, v30
v_dot2_f32_bf16 v31, v183, v27, v31
buffer_load_dwordx4 v[168:171], v2, s[52:55], s12 offen offset:0 nt
buffer_load_dwordx4 v[172:175], v2, s[52:55], s12 offen offset:1024 nt
buffer_load_dwordx4 v[176:179], v2, s[52:55], s12 offen offset:2048 nt
buffer_load_dwordx4 v[180:183], v2, s[52:55], s12 offen offset:3072 nt
s_add_u32 s13, s13, 24576
s_min_u32 s12, s13, 2146435072
v_add_f32_dpp v32, v28, v28 row_ror:8 row_mask:0xf bank_mask:0x3
v_add_f32_dpp v33, v29, v29 row_ror:8 row_mask:0xf bank_mask:0x3
v_add_f32_dpp v32, v30, v30 row_ror:8 row_mask:0xf bank_mask:0xc
v_add_f32_dpp v33, v31, v31 row_ror:8 row_mask:0xf bank_mask:0xc
s_nop 0
v_add_f32_dpp v34, v32, v32 row_half_mirror row_mask:0xf bank_mask:0x5
v_add_f32_dpp v34, v33, v33 row_half_mirror row_mask:0xf bank_mask:0xa
s_nop 1
v_add_f32_dpp v34, v34, v34 quad_perm:[1,0,3,2] row_mask:0xf bank_mask:0xf
s_nop 1
v_add_f32_dpp v34, v34, v34 quad_perm:[2,3,0,1] row_mask:0xf bank_mask:0xf
v_cndmask_b32 v86, v86, v34, s[78:79]
s_add_u32 s81, s81, 1
s_cmp_eq_u32 s81, 11
s_cbranch_scc1 A_mid
v_mov_b32 v76, v77
v_mov_b32 v77, v78
v_mov_b32 v78, v79
v_mov_b32 v79, v80
v_mov_b32 v80, v81
v_mov_b32 v81, v82
v_mov_b32 v82, v83
v_mov_b32 v83, v84
v_mov_b32 v84, v85
v_mov_b32 v85, v86
s_lshr_b64 s[72:73], s[76:77], 2
s_lshr_b64 s[74:75], s[76:77], 1
s_cmp_eq_u32 s81, 9
s_cselect_b32 s52, s56, s52
s_cselect_b32 s53, s57, s53
s_cselect_b32 s13, s14, s13
s_min_u32 s12, s13, 2146435072
s_waitcnt vmcnt(28)
v_dot2_f32_bf16 v28, v184, v24, 0
v_dot2_f32_bf16 v29, v188, v24, 0
v_dot2_f32_bf16 v30, v192, v24, 0
v_dot2_f32_bf16 v31, v196, v24, 0
v_dot2_f32_bf16 v28, v185, v25, v28
v_dot2_f32_bf16 v29, v189, v25, v29
v_dot2_f32_bf16 v30, v193, v25, v30
v_dot2_f32_bf16 v31, v197, v25, v31
v_dot2_f32_bf16 v28, v186, v26, v28
v_dot2_f32_bf16 v29, v190, v26, v29
v_dot2_f32_bf16 v30, v194, v26, v30
v_dot2_f32_bf16 v31, v198, v26, v31
v_dot2_f32_bf16 v28, v187, v27, v28
v_dot2_f32_bf16 v29, v191, v27, v29
v_dot2_f32_bf16 v30, v195, v27, v30
v_dot2_f32_bf16 v31, v199, v27, v31
buffer_load_dwordx4 v[184:187], v2, s[52:55], s12 offen offset:0 nt
buffer_load_dwordx4 v[188:191], v2, s[52:55], s12 offen offset:1024 nt
buffer_load_dwordx4 v[192:195], v2, s[52:55], s12 offen offset:2048 nt
buffer_load_dwordx4 v[196:199], v2, s[52:55], s12 offen offset:3072 nt
s_add_u32 s13, s13, 24576
s_min_u32 s12, s13, 2146435072
s_bitcmp0_b32 s80, s81
s_cbranch_scc1 L_nodma_8
s_mov_b32 m0, s15
s_nop 0
buffer_load_dwordx4 v2, s[60:63], s15 offen offset:0  lds
buffer_load_dwordx4 v2, s[60:63], s15 offen offset:1024  lds
s_add_u32 s15, s15, 2048
L_nodma_8:
v_add_f32_dpp v32, v28, v28 row_ror:8 row_mask:0xf bank_mask:0x3
v_add_f32_dpp v33, v29, v29 row_ror:8 row_mask:0xf bank_mask:0x3
v_add_f32_dpp v32, v30, v30 row_ror:8 row_mask:0xf bank_mask:0xc
v_add_f32_dpp v33, v31, v31 row_ror:8 row_mask:0xf bank_mask:0xc
s_nop 0
v_add_f32_dpp v34, v32, v32 row_half_mirror row_mask:0xf bank_mask:0x5
v_add_f32_dpp v34, v33, v33 row_half_mirror row_mask:0xf bank_mask:0xa
s_nop 1
v_add_f32_dpp v34, v34, v34 quad_perm:[1,0,3,2] row_mask:0xf bank_mask:0xf
s_nop 1
v_add_f32_dpp v34, v34, v34 quad_perm:[2,3,0,1] row_mask:0xf bank_mask:0xf
v_cndmask_b32 v86, v86, v34, s[72:73]
s_waitcnt vmcnt(28)
v_dot2_f32_bf16 v28, v200, v24, 0
v_dot2_f32_bf16 v29, v204, v24, 0
v_dot2_f32_bf16 v30, v208, v24, 0
v_dot2_f32_bf16 v31, v212, v24, 0
v_dot2_f32_bf16 v28, v201, v25, v28
v_dot2_f32_bf16 v29, v205, v25, v29
v_dot2_f32_bf16 v30, v209, v25, v30
v_dot2_f32_bf16 v31, v213, v25, v31
v_dot2_f32_bf16 v28, v202, v26, v28
v_dot2_f32_bf16 v29, v206, v26, v29
v_dot2_f32_bf16 v30, v210, v26, v30
v_dot2_f32_bf16 v31, v214, v26, v31
v_dot2_f32_bf16 v28, v203, v27, v28
v_dot2_f32_bf16 v29, v207, v27, v29
v_dot2_f32_bf16 v30, v211, v27, v30
v_dot2_f32_bf16 v31, v215, v27, v31
buffer_load_dwordx4 v[200:203], v2, s[52:55], s12 offen offset:0 nt
buffer_load_dwordx4 v[204:207], v2, s[52:55], s12 offen offset:1024 nt
buffer_load_dwordx4 v[208:211], v2, s[52:55], s12 offen offset:2048 nt
buffer_load_dwordx4 v[212:215], v2, s[52:55], s12 offen offset:3072 nt
s_add_u32 s13, s13, 24576
s_min_u32 s12, s13, 2146435072
s_bitcmp0_b32 s80, s81
s_cbranch_scc1 L_nodma_9
s_mov_b32 m0, s15
s_nop 0
buffer_load_dwordx4 v2, s[60:63], s15 offen offset:0  lds
buffer_load_dwordx4 v2, s[60:63], s15 offen offset:1024  lds
s_add_u32 s15, s15, 2048
L_nodma_9:
v_add_f32_dpp v32, v28, v28 row_ror:8 row_mask:0xf bank_mask:0x3
v_add_f32_dpp v33, v29, v29 row_ror:8 row_mask:0xf bank_mask:0x3
v_add_f32_dpp v32, v30, v30 row_ror:8 row_mask:0xf bank_mask:0xc
v_add_f32_dpp v33, v31, v31 row_ror:8 row_mask:0xf bank_mask:0xc
s_nop 0
v_add_f32_dpp v34, v32, v32 row_half_mirror row_mask:0xf bank_mask:0x5
v_add_f32_dpp v34, v33, v33 row_half_mirror row_mask:0xf bank_mask:0xa
s_nop 1
v_add_f32_dpp v34, v34, v34 quad_perm:[1,0,3,2] row_mask:0xf bank_mask:0xf
s_nop 1
v_add_f32_dpp v34, v34, v34 quad_perm:[2,3,0,1] row_mask:0xf bank_mask:0xf
v_cndmask_b32 v86, v86, v34, s[74:75]
s_waitcnt vmcnt(28)
v_dot2_f32_bf16 v28, v216, v24, 0
v_dot2_f32_bf16 v29, v220, v24, 0
v_dot2_f32_bf16 v30, v224, v24, 0
v_dot2_f32_bf16 v31, v228, v24, 0
v_dot2_f32_bf16 v28, v217, v25, v28
v_dot2_f32_bf16 v29, v221, v25, v29
v_dot2_f32_bf16 v30, v225, v25, v30
v_dot2_f32_bf16 v31, v229, v25, v31
v_dot2_f32_bf16 v28, v218, v26, v28
v_dot2_f32_bf16 v29, v222, v26, v29
v_dot2_f32_bf16 v30, v226, v26, v30
v_dot2_f32_bf16 v31, v230, v26, v31
v_dot2_f32_bf16 v28, v219, v27, v28
v_dot2_f32_bf16 v29, v223, v27, v29
v_dot2_f32_bf16 v30, v227, v27, v30
v_dot2_f32_bf16 v31, v231, v27, v31
buffer_load_dwordx4 v[216:219], v2, s[52:55], s12 offen offset:0 nt
buffer_load_dwordx4 v[220:223], v2, s[52:55], s12 offen offset:1024 nt
buffer_load_dwordx4 v[224:227], v2, s[52:55], s12 offen offset:2048 nt
buffer_load_dwordx4 v[228:231], v2, s[52:55], s12 offen offset:3072 nt
s_add_u32 s13, s13, 24576
s_min_u32 s12, s13, 2146435072
s_bitcmp0_b32 s80, s81
s_cbranch_scc1 L_nodma_10
s_mov_b32 m0, s15
s_nop 0
buffer_load_dwordx4 v2, s[60:63], s15 offen offset:0  lds
buffer_load_dwordx4 v2, s[60:63], s15 offen offset:1024  lds
s_add_u32 s15, s15, 2048
L_nodma_10:
v_add_f32_dpp v32, v28, v28 row_ror:8 row_mask:0xf bank_mask:0x3
v_add_f32_dpp v33, v29, v29 row_ror:8 row_mask:0xf bank_mask:0x3
v_add_f32_dpp v32, v30, v30 row_ror:8 row_mask:0xf bank_mask:0xc
v_add_f32_dpp v33, v31, v31 row_ror:8 row_mask:0xf bank_mask:0xc
s_nop 0
v_add_f32_dpp v34, v32, v32 row_half_mirror row_mask:0xf bank_mask:0x5
v_add_f32_dpp v34, v33, v33 row_half_mirror row_mask:0xf bank_mask:0xa
s_nop 1
v_add_f32_dpp v34, v34, v34 quad_perm:[1,0,3,2] row_mask:0xf bank_mask:0xf
s_nop 1
v_add_f32_dpp v34, v34, v34 quad_perm:[2,3,0,1] row_mask:0xf bank_mask:0xf
v_cndmask_b32 v86, v86, v34, s[76:77]
s_waitcnt vmcnt(28)
v_dot2_f32_bf16 v28, v232, v24, 0
v_dot2_f32_bf16 v29, v236, v24, 0
v_dot2_f32_bf16 v30, v240, v24, 0
v_dot2_f32_bf16 v31, v244, v24, 0
v_dot2_f32_bf16 v28, v233, v25, v28
v_dot2_f32_bf16 v29, v237, v25, v29
v_dot2_f32_bf16 v30, v241, v25, v30
v_dot2_f32_bf16 v31, v245, v25, v31
v_dot2_f32_bf16 v28, v234, v26, v28
v_dot2_f32_bf16 v29, v238, v26, v29
v_dot2_f32_bf16 v30, v242, v26, v30
v_dot2_f32_bf16 v31, v246, v26, v31
v_dot2_f32_bf16 v28, v235, v27, v28
v_dot2_f32_bf16 v29, v239, v27, v29
v_dot2_f32_bf16 v30, v243, v27, v30
v_dot2_f32_bf16 v31, v247, v27, v31
buffer_load_dwordx4 v[232:235], v2, s[52:55], s12 offen offset:0 nt
buffer_load_dwordx4 v[236:239], v2, s[52:55], s12 offen offset:1024 nt
buffer_load_dwordx4 v[240:243], v2, s[52:55], s12 offen offset:2048 nt
buffer_load_dwordx4 v[244:247], v2, s[52:55], s12 offen offset:3072 nt
s_add_u32 s13, s13, 24576
s_min_u32 s12, s13, 2146435072
v_add_f32_dpp v32, v28, v28 row_ror:8 row_mask:0xf bank_mask:0x3
v_add_f32_dpp v33, v29, v29 row_ror:8 row_mask:0xf bank_mask:0x3
v_add_f32_dpp v32, v30, v30 row_ror:8 row_mask:0xf bank_mask:0xc
v_add_f32_dpp v33, v31, v31 row_ror:8 row_mask:0xf bank_mask:0xc
s_nop 0
v_add_f32_dpp v34, v32, v32 row_half_mirror row_mask:0xf bank_mask:0x5
v_add_f32_dpp v34, v33, v33 row_half_mirror row_mask:0xf bank_mask:0xa
s_nop 1
v_add_f32_dpp v34, v34, v34 quad_perm:[1,0,3,2] row_mask:0xf bank_mask:0xf
s_nop 1
v_add_f32_dpp v34, v34, v34 quad_perm:[2,3,0,1] row_mask:0xf bank_mask:0xf
v_cndmask_b32 v86, v86, v34, s[78:79]
s_add_u32 s81, s81, 1
v_mov_b32 v76, v77
v_mov_b32 v77, v78
v_mov_b32 v78, v79
v_mov_b32 v79, v80
v_mov_b32 v80, v81
v_mov_b32 v81, v82
v_mov_b32 v82, v83
v_mov_b32 v83, v84
v_mov_b32 v84, v85
v_mov_b32 v85, v86
s_branch K_loop
A_mid:
v_max3_f32 v35, v76, v77, v78
v_max3_f32 v35, v35, v79, v80
v_max3_f32 v35, v35, v81, v82
v_max3_f32 v35, v35, v83, v84
v_max3_f32 v35, v35, v85, v86
s_nop 1
v_max_f32_dpp v35, v35, v35 row_ror:8 row_mask:0xf bank_mask:0xf
s_nop 1
v_max_f32_dpp v35, v35, v35 row_ror:4 row_mask:0xf bank_mask:0xf
s_nop 1
v_max_f32_dpp v35, v35, v35 row_ror:2 row_mask:0xf bank_mask:0xf
s_nop 1
v_max_f32_dpp v35, v35, v35 row_ror:1 row_mask:0xf bank_mask:0xf
v_mov_b32 v36, v35
s_nop 1
v_permlane16_swap_b32 v35, v36
v_max_f32 v35, v35, v36
v_mov_b32 v36, v35
s_nop 1
v_permlane32_swap_b32 v35, v36
v_max_f32 v35, v35, v36
v_mul_f32 v32, v35, v7
v_fma_f32 v76, v76, v7, -v32
v_fma_f32 v77, v77, v7, -v32
v_fma_f32 v78, v78, v7, -v32
v_fma_f32 v79, v79, v7, -v32
v_fma_f32 v80, v80, v7, -v32
v_fma_f32 v81, v81, v7, -v32
v_fma_f32 v82, v82, v7, -v32
v_fma_f32 v83, v83, v7, -v32
v_fma_f32 v84, v84, v7, -v32
v_fma_f32 v85, v85, v7, -v32
v_fma_f32 v86, v86, v7, -v32
v_exp_f32 v76, v76
v_exp_f32 v77, v77
v_exp_f32 v78, v78
v_exp_f32 v79, v79
v_exp_f32 v80, v80
v_exp_f32 v81, v81
v_exp_f32 v82, v82
v_exp_f32 v83, v83
v_exp_f32 v84, v84
v_exp_f32 v85, v85
v_exp_f32 v86, v86
v_add_f32 v35, v76, v77
v_add_f32 v35, v35, v78
v_add_f32 v35, v35, v79
v_add_f32 v35, v35, v80
v_add_f32 v35, v35, v81
v_add_f32 v35, v35, v82
v_add_f32 v35, v35, v83
v_add_f32 v35, v35, v84
v_add_f32 v35, v35, v85
v_add_f32 v35, v35, v86
v_cvt_pk_bf16_f32 v76, v76, v76
v_cvt_pk_bf16_f32 v77, v77, v77
v_cvt_pk_bf16_f32 v78, v78, v78
v_cvt_pk_bf16_f32 v79, v79, v79
v_cvt_pk_bf16_f32 v80, v80, v80
v_cvt_pk_bf16_f32 v81, v81, v81
v_cvt_pk_bf16_f32 v82, v82, v82
v_cvt_pk_bf16_f32 v83, v83, v83
v_cvt_pk_bf16_f32 v84, v84, v84
v_cvt_pk_bf16_f32 v85, v85, v85
v_cvt_pk_bf16_f32 v86, v86, v86
v_add_f32_dpp v35, v35, v35 row_ror:8 row_mask:0xf bank_mask:0xf
s_nop 1
v_add_f32_dpp v35, v35, v35 row_ror:4 row_mask:0xf bank_mask:0xf
s_nop 1
v_add_f32_dpp v35, v35, v35 row_ror:2 row_mask:0xf bank_mask:0xf
s_nop 1
v_add_f32_dpp v35, v35, v35 row_ror:1 row_mask:0xf bank_mask:0xf
v_mov_b32 v36, v35
s_nop 1
v_permlane16_swap_b32 v35, v36
v_add_f32 v35, v35, v36
v_mov_b32 v36, v35
s_nop 1
v_permlane32_swap_b32 v35, v36
v_add_f32 v35, v35, v36
v_min_u32 v32, -2, v32
v_min_u32 v33, -2, v35
s_mov_b32 s7, 400000
L_ens_11:
v_readfirstlane_b32 s6, v96
s_cmp_ge_u32 s6, 128
s_cbranch_scc1 L_ensd_12
s_sleep 16
buffer_load_dword v96, off, s[68:71], 0 offset:0 sc1
s_waitcnt vmcnt(0)
s_sub_u32 s7, s7, 1
s_cmp_lg_u32 s7, 0
s_cbranch_scc1 L_ens_11
L_ensd_12:
s_lshl_b32 s6, s11, 3
s_add_u32 s6, s6, s82
s_mov_b64 exec, 1
buffer_store_dwordx2 v[32:33], off, s[64:67], s6 sc1
s_mov_b64 exec, -1
v_and_b32_dpp v60, v78, v8 row_newbcast:0 row_mask:0xf bank_mask:0xf
v_and_b32_dpp v61, v78, v9 row_newbcast:0 row_mask:0xf bank_mask:0xf
v_and_b32_dpp v62, v78, v10 row_newbcast:0 row_mask:0xf bank_mask:0xf
v_and_b32_dpp v63, v78, v11 row_newbcast:0 row_mask:0xf bank_mask:0xf
v_and_b32_dpp v64, v78, v8 row_newbcast:4 row_mask:0xf bank_mask:0xf
v_and_b32_dpp v65, v78, v9 row_newbcast:4 row_mask:0xf bank_mask:0xf
v_and_b32_dpp v66, v78, v10 row_newbcast:4 row_mask:0xf bank_mask:0xf
v_and_b32_dpp v67, v78, v11 row_newbcast:4 row_mask:0xf bank_mask:0xf
v_and_b32_dpp v68, v78, v8 row_newbcast:8 row_mask:0xf bank_mask:0xf
v_and_b32_dpp v69, v78, v9 row_newbcast:8 row_mask:0xf bank_mask:0xf
v_and_b32_dpp v70, v78, v10 row_newbcast:8 row_mask:0xf bank_mask:0xf
v_and_b32_dpp v71, v78, v11 row_newbcast:8 row_mask:0xf bank_mask:0xf
v_and_b32_dpp v72, v78, v8 row_newbcast:12 row_mask:0xf bank_mask:0xf
v_and_b32_dpp v73, v78, v9 row_newbcast:12 row_mask:0xf bank_mask:0xf
v_and_b32_dpp v74, v78, v10 row_newbcast:12 row_mask:0xf bank_mask:0xf
v_and_b32_dpp v75, v78, v11 row_newbcast:12 row_mask:0xf bank_mask:0xf
s_waitcnt vmcnt(29)
v_mfma_f32_16x16x32_bf16 v[20:23], v[60:63], v[184:187], v[20:23]
v_mfma_f32_16x16x32_bf16 v[20:23], v[64:67], v[188:191], v[20:23]
v_mfma_f32_16x16x32_bf16 v[20:23], v[68:71], v[192:195], v[20:23]
v_mfma_f32_16x16x32_bf16 v[20:23], v[72:75], v[196:199], v[20:23]
v_add_u32 v117, 1, v117
buffer_store_dword v117, v118, s[64:67], 0 offen
buffer_load_dwordx4 v[184:187], v2, s[52:55], s12 offen offset:0 nt
buffer_load_dwordx4 v[188:191], v2, s[52:55], s12 offen offset:1024 nt
buffer_load_dwordx4 v[192:195], v2, s[52:55], s12 offen offset:2048 nt
buffer_load_dwordx4 v[196:199], v2, s[52:55], s12 offen offset:3072 nt
s_add_u32 s13, s13, 24576
s_min_u32 s12, s13, 2146435072
v_and_b32_dpp v60, v78, v8 row_newbcast:1 row_mask:0xf bank_mask:0xf
v_and_b32_dpp v61, v78, v9 row_newbcast:1 row_mask:0xf bank_mask:0xf
v_and_b32_dpp v62, v78, v10 row_newbcast:1 row_mask:0xf bank_mask:0xf
v_and_b32_dpp v63, v78, v11 row_newbcast:1 row_mask:0xf bank_mask:0xf
v_and_b32_dpp v64, v78, v8 row_newbcast:5 row_mask:0xf bank_mask:0xf
v_and_b32_dpp v65, v78, v9 row_newbcast:5 row_mask:0xf bank_mask:0xf
v_and_b32_dpp v66, v78, v10 row_newbcast:5 row_mask:0xf bank_mask:0xf
v_and_b32_dpp v67, v78, v11 row_newbcast:5 row_mask:0xf bank_mask:0xf
v_and_b32_dpp v68, v78, v8 row_newbcast:9 row_mask:0xf bank_mask:0xf
v_and_b32_dpp v69, v78, v9 row_newbcast:9 row_mask:0xf bank_mask:0xf
v_and_b32_dpp v70, v78, v10 row_newbcast:9 row_mask:0xf bank_mask:0xf
v_and_b32_dpp v71, v78, v11 row_newbcast:9 row_mask:0xf bank_mask:0xf
v_and_b32_dpp v72, v78, v8 row_newbcast:13 row_mask:0xf bank_mask:0xf
v_and_b32_dpp v73, v78, v9 row_newbcast:13 row_mask:0xf bank_mask:0xf
v_and_b32_dpp v74, v78, v10 row_newbcast:13 row_mask:0xf bank_mask:0xf
v_and_b32_dpp v75, v78, v11 row_newbcast:13 row_mask:0xf bank_mask:0xf
s_waitcnt vmcnt(30)
v_mfma_f32_16x16x32_bf16 v[20:23], v[60:63], v[200:203], v[20:23]
v_mfma_f32_16x16x32_bf16 v[20:23], v[64:67], v[204:207], v[20:23]
v_mfma_f32_16x16x32_bf16 v[20:23], v[68:71], v[208:211], v[20:23]
v_mfma_f32_16x16x32_bf16 v[20:23], v[72:75], v[212:215], v[20:23]
v_add_u32 v117, 1, v117
buffer_store_dword v117, v118, s[64:67], 0 offen
buffer_load_dwordx4 v[200:203], v2, s[52:55], s12 offen offset:0 nt
buffer_load_dwordx4 v[204:207], v2, s[52:55], s12 offen offset:1024 nt
buffer_load_dwordx4 v[208:211], v2, s[52:55], s12 offen offset:2048 nt
buffer_load_dwordx4 v[212:215], v2, s[52:55], s12 offen offset:3072 nt
s_add_u32 s13, s13, 24576
s_min_u32 s12, s13, 2146435072
v_and_b32_dpp v60, v76, v8 row_newbcast:1 row_mask:0xf bank_mask:0xf
v_and_b32_dpp v61, v76, v9 row_newbcast:1 row_mask:0xf bank_mask:0xf
v_and_b32_dpp v62, v76, v10 row_newbcast:1 row_mask:0xf bank_mask:0xf
v_and_b32_dpp v63, v76, v11 row_newbcast:1 row_mask:0xf bank_mask:0xf
v_and_b32_dpp v64, v76, v8 row_newbcast:5 row_mask:0xf bank_mask:0xf
v_and_b32_dpp v65, v76, v9 row_newbcast:5 row_mask:0xf bank_mask:0xf
v_and_b32_dpp v66, v76, v10 row_newbcast:5 row_mask:0xf bank_mask:0xf
v_and_b32_dpp v67, v76, v11 row_newbcast:5 row_mask:0xf bank_mask:0xf
v_and_b32_dpp v68, v76, v8 row_newbcast:9 row_mask:0xf bank_mask:0xf
v_and_b32_dpp v69, v76, v9 row_newbcast:9 row_mask:0xf bank_mask:0xf
v_and_b32_dpp v70, v76, v10 row_newbcast:9 row_mask:0xf bank_mask:0xf
v_and_b32_dpp v71, v76, v11 row_newbcast:9 row_mask:0xf bank_mask:0xf
v_and_b32_dpp v72, v76, v8 row_newbcast:13 row_mask:0xf bank_mask:0xf
v_and_b32_dpp v73, v76, v9 row_newbcast:13 row_mask:0xf bank_mask:0xf
v_and_b32_dpp v74, v76, v10 row_newbcast:13 row_mask:0xf bank_mask:0xf
v_and_b32_dpp v75, v76, v11 row_newbcast:13 row_mask:0xf bank_mask:0xf
v_mfma_f32_16x16x32_bf16 v[20:23], v[60:63], a[0:3], v[20:23]
v_mfma_f32_16x16x32_bf16 v[20:23], v[64:67], a[4:7], v[20:23]
v_mfma_f32_16x16x32_bf16 v[20:23], v[68:71], a[8:11], v[20:23]
v_mfma_f32_16x16x32_bf16 v[20:23], v[72:75], a[12:15], v[20:23]
s_nop 3
v_and_b32_dpp v60, v78, v8 row_newbcast:2 row_mask:0xf bank_mask:0xf
v_and_b32_dpp v61, v78, v9 row_newbcast:2 row_mask:0xf bank_mask:0xf
v_and_b32_dpp v62, v78, v10 row_newbcast:2 row_mask:0xf bank_mask:0xf
v_and_b32_dpp v63, v78, v11 row_newbcast:2 row_mask:0xf bank_mask:0xf
v_and_b32_dpp v64, v78, v8 row_newbcast:6 row_mask:0xf bank_mask:0xf
v_and_b32_dpp v65, v78, v9 row_newbcast:6 row_mask:0xf bank_mask:0xf
v_and_b32_dpp v66, v78, v10 row_newbcast:6 row_mask:0xf bank_mask:0xf
v_and_b32_dpp v67, v78, v11 row_newbcast:6 row_mask:0xf bank_mask:0xf
v_and_b32_dpp v68, v78, v8 row_newbcast:10 row_mask:0xf bank_mask:0xf
v_and_b32_dpp v69, v78, v9 row_newbcast:10 row_mask:0xf bank_mask:0xf
v_and_b32_dpp v70, v78, v10 row_newbcast:10 row_mask:0xf bank_mask:0xf
v_and_b32_dpp v71, v78, v11 row_newbcast:10 row_mask:0xf bank_mask:0xf
v_and_b32_dpp v72, v78, v8 row_newbcast:14 row_mask:0xf bank_mask:0xf
v_and_b32_dpp v73, v78, v9 row_newbcast:14 row_mask:0xf bank_mask:0xf
v_and_b32_dpp v74, v78, v10 row_newbcast:14 row_mask:0xf bank_mask:0xf
v_and_b32_dpp v75, v78, v11 row_newbcast:14 row_mask:0xf bank_mask:0xf
s_waitcnt vmcnt(31)
v_mfma_f32_16x16x32_bf16 v[20:23], v[60:63], v[216:219], v[20:23]
v_mfma_f32_16x16x32_bf16 v[20:23], v[64:67], v[220:223], v[20:23]
v_mfma_f32_16x16x32_bf16 v[20:23], v[68:71], v[224:227], v[20:23]
v_mfma_f32_16x16x32_bf16 v[20:23], v[72:75], v[228:231], v[20:23]
v_add_u32 v117, 1, v117
buffer_store_dword v117, v118, s[64:67], 0 offen
buffer_load_dwordx4 v[216:219], v2, s[52:55], s12 offen offset:0 nt
buffer_load_dwordx4 v[220:223], v2, s[52:55], s12 offen offset:1024 nt
buffer_load_dwordx4 v[224:227], v2, s[52:55], s12 offen offset:2048 nt
buffer_load_dwordx4 v[228:231], v2, s[52:55], s12 offen offset:3072 nt
s_add_u32 s13, s13, 24576
s_min_u32 s12, s13, 2146435072
v_and_b32_dpp v60, v78, v8 row_newbcast:3 row_mask:0xf bank_mask:0xf
v_and_b32_dpp v61, v78, v9 row_newbcast:3 row_mask:0xf bank_mask:0xf
v_and_b32_dpp v62, v78, v10 row_newbcast:3 row_mask:0xf bank_mask:0xf
v_and_b32_dpp v63, v78, v11 row_newbcast:3 row_mask:0xf bank_mask:0xf
v_and_b32_dpp v64, v78, v8 row_newbcast:7 row_mask:0xf bank_mask:0xf
v_and_b32_dpp v65, v78, v9 row_newbcast:7 row_mask:0xf bank_mask:0xf
v_and_b32_dpp v66, v78, v10 row_newbcast:7 row_mask:0xf bank_mask:0xf
v_and_b32_dpp v67, v78, v11 row_newbcast:7 row_mask:0xf bank_mask:0xf
v_and_b32_dpp v68, v78, v8 row_newbcast:11 row_mask:0xf bank_mask:0xf
v_and_b32_dpp v69, v78, v9 row_newbcast:11 row_mask:0xf bank_mask:0xf
v_and_b32_dpp v70, v78, v10 row_newbcast:11 row_mask:0xf bank_mask:0xf
v_and_b32_dpp v71, v78, v11 row_newbcast:11 row_mask:0xf bank_mask:0xf
v_and_b32_dpp v72, v78, v8 row_newbcast:15 row_mask:0xf bank_mask:0xf
v_and_b32_dpp v73, v78, v9 row_newbcast:15 row_mask:0xf bank_mask:0xf
v_and_b32_dpp v74, v78, v10 row_newbcast:15 row_mask:0xf bank_mask:0xf
v_and_b32_dpp v75, v78, v11 row_newbcast:15 row_mask:0xf bank_mask:0xf
s_waitcnt vmcnt(32)
v_mfma_f32_16x16x32_bf16 v[20:23], v[60:63], v[232:235], v[20:23]
v_mfma_f32_16x16x32_bf16 v[20:23], v[64:67], v[236:239], v[20:23]
v_mfma_f32_16x16x32_bf16 v[20:23], v[68:71], v[240:243], v[20:23]
v_mfma_f32_16x16x32_bf16 v[20:23], v[72:75], v[244:247], v[20:23]
v_add_u32 v117, 1, v117
buffer_store_dword v117, v118, s[64:67], 0 offen
buffer_load_dwordx4 v[232:235], v2, s[52:55], s12 offen offset:0 nt
buffer_load_dwordx4 v[236:239], v2, s[52:55], s12 offen offset:1024 nt
buffer_load_dwordx4 v[240:243], v2, s[52:55], s12 offen offset:2048 nt
buffer_load_dwordx4 v[244:247], v2, s[52:55], s12 offen offset:3072 nt
s_add_u32 s13, s13, 24576
s_min_u32 s12, s13, 2146435072
s_barrier
ds_read_b64_tr_b16 a[96:97], v88 offset:0
ds_read_b64_tr_b16 a[98:99], v88 offset:4608
ds_read_b64_tr_b16 a[100:101], v88 offset:36864
ds_read_b64_tr_b16 a[102:103], v88 offset:41472
v_and_b32_dpp v60, v79, v8 row_newbcast:0 row_mask:0xf bank_mask:0xf
v_and_b32_dpp v61, v79, v9 row_newbcast:0 row_mask:0xf bank_mask:0xf
v_and_b32_dpp v62, v79, v10 row_newbcast:0 row_mask:0xf bank_mask:0xf
v_and_b32_dpp v63, v79, v11 row_newbcast:0 row_mask:0xf bank_mask:0xf
v_and_b32_dpp v64, v79, v8 row_newbcast:4 row_mask:0xf bank_mask:0xf
v_and_b32_dpp v65, v79, v9 row_newbcast:4 row_mask:0xf bank_mask:0xf
v_and_b32_dpp v66, v79, v10 row_newbcast:4 row_mask:0xf bank_mask:0xf
v_and_b32_dpp v67, v79, v11 row_newbcast:4 row_mask:0xf bank_mask:0xf
v_and_b32_dpp v68, v79, v8 row_newbcast:8 row_mask:0xf bank_mask:0xf
v_and_b32_dpp v69, v79, v9 row_newbcast:8 row_mask:0xf bank_mask:0xf
v_and_b32_dpp v70, v79, v10 row_newbcast:8 row_mask:0xf bank_mask:0xf
v_and_b32_dpp v71, v79, v11 row_newbcast:8 row_mask:0xf bank_mask:0xf
v_and_b32_dpp v72, v79, v8 row_newbcast:12 row_mask:0xf bank_mask:0xf
v_and_b32_dpp v73, v79, v9 row_newbcast:12 row_mask:0xf bank_mask:0xf
v_and_b32_dpp v74, v79, v10 row_newbcast:12 row_mask:0xf bank_mask:0xf
v_and_b32_dpp v75, v79, v11 row_newbcast:12 row_mask:0xf bank_mask:0xf
s_waitcnt vmcnt(33)
v_mfma_f32_16x16x32_bf16 v[20:23], v[60:63], v[120:123], v[20:23]
v_mfma_f32_16x16x32_bf16 v[20:23], v[64:67], v[124:127], v[20:23]
v_mfma_f32_16x16x32_bf16 v[20:23], v[68:71], v[128:131], v[20:23]
v_mfma_f32_16x16x32_bf16 v[20:23], v[72:75], v[132:135], v[20:23]
v_add_u32 v117, 1, v117
buffer_store_dword v117, v118, s[64:67], 0 offen
buffer_load_dwordx4 v[120:123], v2, s[52:55], s12 offen offset:0 nt
buffer_load_dwordx4 v[124:127], v2, s[52:55], s12 offen offset:1024 nt
buffer_load_dwordx4 v[128:131], v2, s[52:55], s12 offen offset:2048 nt
buffer_load_dwordx4 v[132:135], v2, s[52:55], s12 offen offset:3072 nt
s_add_u32 s13, s13, 24576
s_min_u32 s12, s13, 2146435072
ds_read_b64_tr_b16 a[104:105], v90 offset:0
ds_read_b64_tr_b16 a[106:107], v90 offset:4608
ds_read_b64_tr_b16 a[108:109], v90 offset:36864
ds_read_b64_tr_b16 a[110:111], v90 offset:41472
v_and_b32_dpp v60, v79, v8 row_newbcast:1 row_mask:0xf bank_mask:0xf
v_and_b32_dpp v61, v79, v9 row_newbcast:1 row_mask:0xf bank_mask:0xf
v_and_b32_dpp v62, v79, v10 row_newbcast:1 row_mask:0xf bank_mask:0xf
v_and_b32_dpp v63, v79, v11 row_newbcast:1 row_mask:0xf bank_mask:0xf
v_and_b32_dpp v64, v79, v8 row_newbcast:5 row_mask:0xf bank_mask:0xf
v_and_b32_dpp v65, v79, v9 row_newbcast:5 row_mask:0xf bank_mask:0xf
v_and_b32_dpp v66, v79, v10 row_newbcast:5 row_mask:0xf bank_mask:0xf
v_and_b32_dpp v67, v79, v11 row_newbcast:5 row_mask:0xf bank_mask:0xf
v_and_b32_dpp v68, v79, v8 row_newbcast:9 row_mask:0xf bank_mask:0xf
v_and_b32_dpp v69, v79, v9 row_newbcast:9 row_mask:0xf bank_mask:0xf
v_and_b32_dpp v70, v79, v10 row_newbcast:9 row_mask:0xf bank_mask:0xf
v_and_b32_dpp v71, v79, v11 row_newbcast:9 row_mask:0xf bank_mask:0xf
v_and_b32_dpp v72, v79, v8 row_newbcast:13 row_mask:0xf bank_mask:0xf
v_and_b32_dpp v73, v79, v9 row_newbcast:13 row_mask:0xf bank_mask:0xf
v_and_b32_dpp v74, v79, v10 row_newbcast:13 row_mask:0xf bank_mask:0xf
v_and_b32_dpp v75, v79, v11 row_newbcast:13 row_mask:0xf bank_mask:0xf
s_waitcnt vmcnt(34)
v_mfma_f32_16x16x32_bf16 v[20:23], v[60:63], v[136:139], v[20:23]
v_mfma_f32_16x16x32_bf16 v[20:23], v[64:67], v[140:143], v[20:23]
v_mfma_f32_16x16x32_bf16 v[20:23], v[68:71], v[144:147], v[20:23]
v_mfma_f32_16x16x32_bf16 v[20:23], v[72:75], v[148:151], v[20:23]
v_add_u32 v117, 1, v117
buffer_store_dword v117, v118, s[64:67], 0 offen
buffer_load_dwordx4 v[136:139], v2, s[52:55], s12 offen offset:0 nt
buffer_load_dwordx4 v[140:143], v2, s[52:55], s12 offen offset:1024 nt
buffer_load_dwordx4 v[144:147], v2, s[52:55], s12 offen offset:2048 nt
buffer_load_dwordx4 v[148:151], v2, s[52:55], s12 offen offset:3072 nt
s_add_u32 s13, s13, 24576
s_min_u32 s12, s13, 2146435072
ds_read_b64_tr_b16 a[112:113], v88 offset:8
ds_read_b64_tr_b16 a[114:115], v88 offset:4616
ds_read_b64_tr_b16 a[116:117], v88 offset:36872
ds_read_b64_tr_b16 a[118:119], v88 offset:41480
v_and_b32_dpp v60, v76, v8 row_newbcast:2 row_mask:0xf bank_mask:0xf
v_and_b32_dpp v61, v76, v9 row_newbcast:2 row_mask:0xf bank_mask:0xf
v_and_b32_dpp v62, v76, v10 row_newbcast:2 row_mask:0xf bank_mask:0xf
v_and_b32_dpp v63, v76, v11 row_newbcast:2 row_mask:0xf bank_mask:0xf
v_and_b32_dpp v64, v76, v8 row_newbcast:6 row_mask:0xf bank_mask:0xf
v_and_b32_dpp v65, v76, v9 row_newbcast:6 row_mask:0xf bank_mask:0xf
v_and_b32_dpp v66, v76, v10 row_newbcast:6 row_mask:0xf bank_mask:0xf
v_and_b32_dpp v67, v76, v11 row_newbcast:6 row_mask:0xf bank_mask:0xf
v_and_b32_dpp v68, v76, v8 row_newbcast:10 row_mask:0xf bank_mask:0xf
v_and_b32_dpp v69, v76, v9 row_newbcast:10 row_mask:0xf bank_mask:0xf
v_and_b32_dpp v70, v76, v10 row_newbcast:10 row_mask:0xf bank_mask:0xf
v_and_b32_dpp v71, v76, v11 row_newbcast:10 row_mask:0xf bank_mask:0xf
v_and_b32_dpp v72, v76, v8 row_newbcast:14 row_mask:0xf bank_mask:0xf
v_and_b32_dpp v73, v76, v9 row_newbcast:14 row_mask:0xf bank_mask:0xf
v_and_b32_dpp v74, v76, v10 row_newbcast:14 row_mask:0xf bank_mask:0xf
v_and_b32_dpp v75, v76, v11 row_newbcast:14 row_mask:0xf bank_mask:0xf
v_mfma_f32_16x16x32_bf16 v[20:23], v[60:63], a[16:19], v[20:23]
v_mfma_f32_16x16x32_bf16 v[20:23], v[64:67], a[20:23], v[20:23]
v_mfma_f32_16x16x32_bf16 v[20:23], v[68:71], a[24:27], v[20:23]
v_mfma_f32_16x16x32_bf16 v[20:23], v[72:75], a[28:31], v[20:23]
s_nop 3
v_and_b32_dpp v60, v79, v8 row_newbcast:2 row_mask:0xf bank_mask:0xf
v_and_b32_dpp v61, v79, v9 row_newbcast:2 row_mask:0xf bank_mask:0xf
v_and_b32_dpp v62, v79, v10 row_newbcast:2 row_mask:0xf bank_mask:0xf
v_and_b32_dpp v63, v79, v11 row_newbcast:2 row_mask:0xf bank_mask:0xf
v_and_b32_dpp v64, v79, v8 row_newbcast:6 row_mask:0xf bank_mask:0xf
v_and_b32_dpp v65, v79, v9 row_newbcast:6 row_mask:0xf bank_mask:0xf
v_and_b32_dpp v66, v79, v10 row_newbcast:6 row_mask:0xf bank_mask:0xf
v_and_b32_dpp v67, v79, v11 row_newbcast:6 row_mask:0xf bank_mask:0xf
v_and_b32_dpp v68, v79, v8 row_newbcast:10 row_mask:0xf bank_mask:0xf
v_and_b32_dpp v69, v79, v9 row_newbcast:10 row_mask:0xf bank_mask:0xf
v_and_b32_dpp v70, v79, v10 row_newbcast:10 row_mask:0xf bank_mask:0xf
v_and_b32_dpp v71, v79, v11 row_newbcast:10 row_mask:0xf bank_mask:0xf
v_and_b32_dpp v72, v79, v8 row_newbcast:14 row_mask:0xf bank_mask:0xf
v_and_b32_dpp v73, v79, v9 row_newbcast:14 row_mask:0xf bank_mask:0xf
v_and_b32_dpp v74, v79, v10 row_newbcast:14 row_mask:0xf bank_mask:0xf
v_and_b32_dpp v75, v79, v11 row_newbcast:14 row_mask:0xf bank_mask:0xf
s_waitcnt vmcnt(35)
v_mfma_f32_16x16x32_bf16 v[20:23], v[60:63], v[152:155], v[20:23]
v_mfma_f32_16x16x32_bf16 v[20:23], v[64:67], v[156:159], v[20:23]
v_mfma_f32_16x16x32_bf16 v[20:23], v[68:71], v[160:163], v[20:23]
v_mfma_f32_16x16x32_bf16 v[20:23], v[72:75], v[164:167], v[20:23]
v_add_u32 v117, 1, v117
buffer_store_dword v117, v118, s[64:67], 0 offen
buffer_load_dwordx4 v[152:155], v2, s[52:55], s12 offen offset:0 nt
buffer_load_dwordx4 v[156:159], v2, s[52:55], s12 offen offset:1024 nt
buffer_load_dwordx4 v[160:163], v2, s[52:55], s12 offen offset:2048 nt
buffer_load_dwordx4 v[164:167], v2, s[52:55], s12 offen offset:3072 nt
s_add_u32 s13, s13, 24576
s_min_u32 s12, s13, 2146435072
ds_read_b64_tr_b16 a[120:121], v90 offset:8
ds_read_b64_tr_b16 a[122:123], v90 offset:4616
ds_read_b64_tr_b16 a[124:125], v90 offset:36872
ds_read_b64_tr_b16 a[126:127], v90 offset:41480
v_and_b32_dpp v60, v79, v8 row_newbcast:3 row_mask:0xf bank_mask:0xf
v_and_b32_dpp v61, v79, v9 row_newbcast:3 row_mask:0xf bank_mask:0xf
v_and_b32_dpp v62, v79, v10 row_newbcast:3 row_mask:0xf bank_mask:0xf
v_and_b32_dpp v63, v79, v11 row_newbcast:3 row_mask:0xf bank_mask:0xf
v_and_b32_dpp v64, v79, v8 row_newbcast:7 row_mask:0xf bank_mask:0xf
v_and_b32_dpp v65, v79, v9 row_newbcast:7 row_mask:0xf bank_mask:0xf
v_and_b32_dpp v66, v79, v10 row_newbcast:7 row_mask:0xf bank_mask:0xf
v_and_b32_dpp v67, v79, v11 row_newbcast:7 row_mask:0xf bank_mask:0xf
v_and_b32_dpp v68, v79, v8 row_newbcast:11 row_mask:0xf bank_mask:0xf
v_and_b32_dpp v69, v79, v9 row_newbcast:11 row_mask:0xf bank_mask:0xf
v_and_b32_dpp v70, v79, v10 row_newbcast:11 row_mask:0xf bank_mask:0xf
v_and_b32_dpp v71, v79, v11 row_newbcast:11 row_mask:0xf bank_mask:0xf
v_and_b32_dpp v72, v79, v8 row_newbcast:15 row_mask:0xf bank_mask:0xf
v_and_b32_dpp v73, v79, v9 row_newbcast:15 row_mask:0xf bank_mask:0xf
v_and_b32_dpp v74, v79, v10 row_newbcast:15 row_mask:0xf bank_mask:0xf
v_and_b32_dpp v75, v79, v11 row_newbcast:15 row_mask:0xf bank_mask:0xf
s_waitcnt vmcnt(36)
v_mfma_f32_16x16x32_bf16 v[20:23], v[60:63], v[168:171], v[20:23]
v_mfma_f32_16x16x32_bf16 v[20:23], v[64:67], v[172:175], v[20:23]
v_mfma_f32_16x16x32_bf16 v[20:23], v[68:71], v[176:179], v[20:23]
v_mfma_f32_16x16x32_bf16 v[20:23], v[72:75], v[180:183], v[20:23]
v_add_u32 v117, 1, v117
buffer_store_dword v117, v118, s[64:67], 0 offen
buffer_load_dwordx4 v[168:171], v2, s[52:55], s12 offen offset:0 nt
buffer_load_dwordx4 v[172:175], v2, s[52:55], s12 offen offset:1024 nt
buffer_load_dwordx4 v[176:179], v2, s[52:55], s12 offen offset:2048 nt
buffer_load_dwordx4 v[180:183], v2, s[52:55], s12 offen offset:3072 nt
s_add_u32 s13, s13, 24576
s_min_u32 s12, s13, 2146435072
ds_read_b64_tr_b16 a[128:129], v88 offset:16
ds_read_b64_tr_b16 a[130:131], v88 offset:4624
ds_read_b64_tr_b16 a[132:133], v88 offset:36880
ds_read_b64_tr_b16 a[134:135], v88 offset:41488
v_and_b32_dpp v60, v80, v8 row_newbcast:0 row_mask:0xf bank_mask:0xf
v_and_b32_dpp v61, v80, v9 row_newbcast:0 row_mask:0xf bank_mask:0xf
v_and_b32_dpp v62, v80, v10 row_newbcast:0 row_mask:0xf bank_mask:0xf
v_and_b32_dpp v63, v80, v11 row_newbcast:0 row_mask:0xf bank_mask:0xf
v_and_b32_dpp v64, v80, v8 row_newbcast:4 row_mask:0xf bank_mask:0xf
v_and_b32_dpp v65, v80, v9 row_newbcast:4 row_mask:0xf bank_mask:0xf
v_and_b32_dpp v66, v80, v10 row_newbcast:4 row_mask:0xf bank_mask:0xf
v_and_b32_dpp v67, v80, v11 row_newbcast:4 row_mask:0xf bank_mask:0xf
v_and_b32_dpp v68, v80, v8 row_newbcast:8 row_mask:0xf bank_mask:0xf
v_and_b32_dpp v69, v80, v9 row_newbcast:8 row_mask:0xf bank_mask:0xf
v_and_b32_dpp v70, v80, v10 row_newbcast:8 row_mask:0xf bank_mask:0xf
v_and_b32_dpp v71, v80, v11 row_newbcast:8 row_mask:0xf bank_mask:0xf
v_and_b32_dpp v72, v80, v8 row_newbcast:12 row_mask:0xf bank_mask:0xf
v_and_b32_dpp v73, v80, v9 row_newbcast:12 row_mask:0xf bank_mask:0xf
v_and_b32_dpp v74, v80, v10 row_newbcast:12 row_mask:0xf bank_mask:0xf
v_and_b32_dpp v75, v80, v11 row_newbcast:12 row_mask:0xf bank_mask:0xf
s_waitcnt vmcnt(35)
v_mfma_f32_16x16x32_bf16 v[20:23], v[60:63], v[184:187], v[20:23]
v_mfma_f32_16x16x32_bf16 v[20:23], v[64:67], v[188:191], v[20:23]
v_mfma_f32_16x16x32_bf16 v[20:23], v[68:71], v[192:195], v[20:23]
v_mfma_f32_16x16x32_bf16 v[20:23], v[72:75], v[196:199], v[20:23]
v_add_u32 v117, 1, v117
buffer_store_dword v117, v118, s[64:67], 0 offen
buffer_load_dwordx4 v[184:187], v2, s[52:55], s12 offen offset:0 nt
buffer_load_dwordx4 v[188:191], v2, s[52:55], s12 offen offset:1024 nt
buffer_load_dwordx4 v[192:195], v2, s[52:55], s12 offen offset:2048 nt
buffer_load_dwordx4 v[196:199], v2, s[52:55], s12 offen offset:3072 nt
s_add_u32 s13, s13, 24576
s_min_u32 s12, s13, 2146435072
ds_read_b64_tr_b16 a[136:137], v90 offset:16
ds_read_b64_tr_b16 a[138:139], v90 offset:4624
ds_read_b64_tr_b16 a[140:141], v90 offset:36880
ds_read_b64_tr_b16 a[142:143], v90 offset:41488
v_and_b32_dpp v60, v80, v8 row_newbcast:1 row_mask:0xf bank_mask:0xf
v_and_b32_dpp v61, v80, v9 row_newbcast:1 row_mask:0xf bank_mask:0xf
v_and_b32_dpp v62, v80, v10 row_newbcast:1 row_mask:0xf bank_mask:0xf
v_and_b32_dpp v63, v80, v11 row_newbcast:1 row_mask:0xf bank_mask:0xf
v_and_b32_dpp v64, v80, v8 row_newbcast:5 row_mask:0xf bank_mask:0xf
v_and_b32_dpp v65, v80, v9 row_newbcast:5 row_mask:0xf bank_mask:0xf
v_and_b32_dpp v66, v80, v10 row_newbcast:5 row_mask:0xf bank_mask:0xf
v_and_b32_dpp v67, v80, v11 row_newbcast:5 row_mask:0xf bank_mask:0xf
v_and_b32_dpp v68, v80, v8 row_newbcast:9 row_mask:0xf bank_mask:0xf
v_and_b32_dpp v69, v80, v9 row_newbcast:9 row_mask:0xf bank_mask:0xf
v_and_b32_dpp v70, v80, v10 row_newbcast:9 row_mask:0xf bank_mask:0xf
v_and_b32_dpp v71, v80, v11 row_newbcast:9 row_mask:0xf bank_mask:0xf
v_and_b32_dpp v72, v80, v8 row_newbcast:13 row_mask:0xf bank_mask:0xf
v_and_b32_dpp v73, v80, v9 row_newbcast:13 row_mask:0xf bank_mask:0xf
v_and_b32_dpp v74, v80, v10 row_newbcast:13 row_mask:0xf bank_mask:0xf
v_and_b32_dpp v75, v80, v11 row_newbcast:13 row_mask:0xf bank_mask:0xf
s_waitcnt vmcnt(35)
v_mfma_f32_16x16x32_bf16 v[20:23], v[60:63], v[200:203], v[20:23]
v_mfma_f32_16x16x32_bf16 v[20:23], v[64:67], v[204:207], v[20:23]
v_mfma_f32_16x16x32_bf16 v[20:23], v[68:71], v[208:211], v[20:23]
v_mfma_f32_16x16x32_bf16 v[20:23], v[72:75], v[212:215], v[20:23]
v_add_u32 v117, 1, v117
buffer_store_dword v117, v118, s[64:67], 0 offen
buffer_load_dwordx4 v[200:203], v2, s[52:55], s12 offen offset:0 nt
buffer_load_dwordx4 v[204:207], v2, s[52:55], s12 offen offset:1024 nt
buffer_load_dwordx4 v[208:211], v2, s[52:55], s12 offen offset:2048 nt
buffer_load_dwordx4 v[212:215], v2, s[52:55], s12 offen offset:3072 nt
s_add_u32 s13, s13, 24576
s_min_u32 s12, s13, 2146435072
ds_read_b64_tr_b16 a[144:145], v88 offset:24
ds_read_b64_tr_b16 a[146:147], v88 offset:4632
ds_read_b64_tr_b16 a[148:149], v88 offset:36888
ds_read_b64_tr_b16 a[150:151], v88 offset:41496
v_and_b32_dpp v60, v76, v8 row_newbcast:3 row_mask:0xf bank_mask:0xf
v_and_b32_dpp v61, v76, v9 row_newbcast:3 row_mask:0xf bank_mask:0xf
v_and_b32_dpp v62, v76, v10 row_newbcast:3 row_mask:0xf bank_mask:0xf
v_and_b32_dpp v63, v76, v11 row_newbcast:3 row_mask:0xf bank_mask:0xf
v_and_b32_dpp v64, v76, v8 row_newbcast:7 row_mask:0xf bank_mask:0xf
v_and_b32_dpp v65, v76, v9 row_newbcast:7 row_mask:0xf bank_mask:0xf
v_and_b32_dpp v66, v76, v10 row_newbcast:7 row_mask:0xf bank_mask:0xf
v_and_b32_dpp v67, v76, v11 row_newbcast:7 row_mask:0xf bank_mask:0xf
v_and_b32_dpp v68, v76, v8 row_newbcast:11 row_mask:0xf bank_mask:0xf
v_and_b32_dpp v69, v76, v9 row_newbcast:11 row_mask:0xf bank_mask:0xf
v_and_b32_dpp v70, v76, v10 row_newbcast:11 row_mask:0xf bank_mask:0xf
v_and_b32_dpp v71, v76, v11 row_newbcast:11 row_mask:0xf bank_mask:0xf
v_and_b32_dpp v72, v76, v8 row_newbcast:15 row_mask:0xf bank_mask:0xf
v_and_b32_dpp v73, v76, v9 row_newbcast:15 row_mask:0xf bank_mask:0xf
v_and_b32_dpp v74, v76, v10 row_newbcast:15 row_mask:0xf bank_mask:0xf
v_and_b32_dpp v75, v76, v11 row_newbcast:15 row_mask:0xf bank_mask:0xf
v_mfma_f32_16x16x32_bf16 v[20:23], v[60:63], a[32:35], v[20:23]
v_mfma_f32_16x16x32_bf16 v[20:23], v[64:67], a[36:39], v[20:23]
v_mfma_f32_16x16x32_bf16 v[20:23], v[68:71], a[40:43], v[20:23]
v_mfma_f32_16x16x32_bf16 v[20:23], v[72:75], a[44:47], v[20:23]
s_nop 3
v_and_b32_dpp v60, v80, v8 row_newbcast:2 row_mask:0xf bank_mask:0xf
v_and_b32_dpp v61, v80, v9 row_newbcast:2 row_mask:0xf bank_mask:0xf
v_and_b32_dpp v62, v80, v10 row_newbcast:2 row_mask:0xf bank_mask:0xf
v_and_b32_dpp v63, v80, v11 row_newbcast:2 row_mask:0xf bank_mask:0xf
v_and_b32_dpp v64, v80, v8 row_newbcast:6 row_mask:0xf bank_mask:0xf
v_and_b32_dpp v65, v80, v9 row_newbcast:6 row_mask:0xf bank_mask:0xf
v_and_b32_dpp v66, v80, v10 row_newbcast:6 row_mask:0xf bank_mask:0xf
v_and_b32_dpp v67, v80, v11 row_newbcast:6 row_mask:0xf bank_mask:0xf
v_and_b32_dpp v68, v80, v8 row_newbcast:10 row_mask:0xf bank_mask:0xf
v_and_b32_dpp v69, v80, v9 row_newbcast:10 row_mask:0xf bank_mask:0xf
v_and_b32_dpp v70, v80, v10 row_newbcast:10 row_mask:0xf bank_mask:0xf
v_and_b32_dpp v71, v80, v11 row_newbcast:10 row_mask:0xf bank_mask:0xf
v_and_b32_dpp v72, v80, v8 row_newbcast:14 row_mask:0xf bank_mask:0xf
v_and_b32_dpp v73, v80, v9 row_newbcast:14 row_mask:0xf bank_mask:0xf
v_and_b32_dpp v74, v80, v10 row_newbcast:14 row_mask:0xf bank_mask:0xf
v_and_b32_dpp v75, v80, v11 row_newbcast:14 row_mask:0xf bank_mask:0xf
s_waitcnt vmcnt(35)
v_mfma_f32_16x16x32_bf16 v[20:23], v[60:63], v[216:219], v[20:23]
v_mfma_f32_16x16x32_bf16 v[20:23], v[64:67], v[220:223], v[20:23]
v_mfma_f32_16x16x32_bf16 v[20:23], v[68:71], v[224:227], v[20:23]
v_mfma_f32_16x16x32_bf16 v[20:23], v[72:75], v[228:231], v[20:23]
v_add_u32 v117, 1, v117
buffer_store_dword v117, v118, s[64:67], 0 offen
buffer_load_dwordx4 v[216:219], v2, s[52:55], s12 offen offset:0 nt
buffer_load_dwordx4 v[220:223], v2, s[52:55], s12 offen offset:1024 nt
buffer_load_dwordx4 v[224:227], v2, s[52:55], s12 offen offset:2048 nt
buffer_load_dwordx4 v[228:231], v2, s[52:55], s12 offen offset:3072 nt
s_add_u32 s13, s13, 24576
s_min_u32 s12, s13, 2146435072
ds_read_b64_tr_b16 a[152:153], v90 offset:24
ds_read_b64_tr_b16 a[154:155], v90 offset:4632
ds_read_b64_tr_b16 a[156:157], v90 offset:36888
ds_read_b64_tr_b16 a[158:159], v90 offset:41496
v_and_b32_dpp v60, v80, v8 row_newbcast:3 row_mask:0xf bank_mask:0xf
v_and_b32_dpp v61, v80, v9 row_newbcast:3 row_mask:0xf bank_mask:0xf
v_and_b32_dpp v62, v80, v10 row_newbcast:3 row_mask:0xf bank_mask:0xf
v_and_b32_dpp v63, v80, v11 row_newbcast:3 row_mask:0xf bank_mask:0xf
v_and_b32_dpp v64, v80, v8 row_newbcast:7 row_mask:0xf bank_mask:0xf
v_and_b32_dpp v65, v80, v9 row_newbcast:7 row_mask:0xf bank_mask:0xf
v_and_b32_dpp v66, v80, v10 row_newbcast:7 row_mask:0xf bank_mask:0xf
v_and_b32_dpp v67, v80, v11 row_newbcast:7 row_mask:0xf bank_mask:0xf
v_and_b32_dpp v68, v80, v8 row_newbcast:11 row_mask:0xf bank_mask:0xf
v_and_b32_dpp v69, v80, v9 row_newbcast:11 row_mask:0xf bank_mask:0xf
v_and_b32_dpp v70, v80, v10 row_newbcast:11 row_mask:0xf bank_mask:0xf
v_and_b32_dpp v71, v80, v11 row_newbcast:11 row_mask:0xf bank_mask:0xf
v_and_b32_dpp v72, v80, v8 row_newbcast:15 row_mask:0xf bank_mask:0xf
v_and_b32_dpp v73, v80, v9 row_newbcast:15 row_mask:0xf bank_mask:0xf
v_and_b32_dpp v74, v80, v10 row_newbcast:15 row_mask:0xf bank_mask:0xf
v_and_b32_dpp v75, v80, v11 row_newbcast:15 row_mask:0xf bank_mask:0xf
s_waitcnt vmcnt(35)
v_mfma_f32_16x16x32_bf16 v[20:23], v[60:63], v[232:235], v[20:23]
v_mfma_f32_16x16x32_bf16 v[20:23], v[64:67], v[236:239], v[20:23]
v_mfma_f32_16x16x32_bf16 v[20:23], v[68:71], v[240:243], v[20:23]
v_mfma_f32_16x16x32_bf16 v[20:23], v[72:75], v[244:247], v[20:23]
v_add_u32 v117, 1, v117
buffer_store_dword v117, v118, s[64:67], 0 offen
buffer_load_dwordx4 v[232:235], v2, s[52:55], s12 offen offset:0 nt
buffer_load_dwordx4 v[236:239], v2, s[52:55], s12 offen offset:1024 nt
buffer_load_dwordx4 v[240:243], v2, s[52:55], s12 offen offset:2048 nt
buffer_load_dwordx4 v[244:247], v2, s[52:55], s12 offen offset:3072 nt
s_add_u32 s13, s13, 24576
s_min_u32 s12, s13, 2146435072
ds_read_b64_tr_b16 a[160:161], v88 offset:128
ds_read_b64_tr_b16 a[162:163], v88 offset:4736
ds_read_b64_tr_b16 a[164:165], v88 offset:36992
ds_read_b64_tr_b16 a[166:167], v88 offset:41600
v_and_b32_dpp v60, v81, v8 row_newbcast:0 row_mask:0xf bank_mask:0xf
v_and_b32_dpp v61, v81, v9 row_newbcast:0 row_mask:0xf bank_mask:0xf
v_and_b32_dpp v62, v81, v10 row_newbcast:0 row_mask:0xf bank_mask:0xf
v_and_b32_dpp v63, v81, v11 row_newbcast:0 row_mask:0xf bank_mask:0xf
v_and_b32_dpp v64, v81, v8 row_newbcast:4 row_mask:0xf bank_mask:0xf
v_and_b32_dpp v65, v81, v9 row_newbcast:4 row_mask:0xf bank_mask:0xf
v_and_b32_dpp v66, v81, v10 row_newbcast:4 row_mask:0xf bank_mask:0xf
v_and_b32_dpp v67, v81, v11 row_newbcast:4 row_mask:0xf bank_mask:0xf
v_and_b32_dpp v68, v81, v8 row_newbcast:8 row_mask:0xf bank_mask:0xf
v_and_b32_dpp v69, v81, v9 row_newbcast:8 row_mask:0xf bank_mask:0xf
v_and_b32_dpp v70, v81, v10 row_newbcast:8 row_mask:0xf bank_mask:0xf
v_and_b32_dpp v71, v81, v11 row_newbcast:8 row_mask:0xf bank_mask:0xf
v_and_b32_dpp v72, v81, v8 row_newbcast:12 row_mask:0xf bank_mask:0xf
v_and_b32_dpp v73, v81, v9 row_newbcast:12 row_mask:0xf bank_mask:0xf
v_and_b32_dpp v74, v81, v10 row_newbcast:12 row_mask:0xf bank_mask:0xf
v_and_b32_dpp v75, v81, v11 row_newbcast:12 row_mask:0xf bank_mask:0xf
s_waitcnt vmcnt(35)
v_mfma_f32_16x16x32_bf16 v[20:23], v[60:63], v[120:123], v[20:23]
v_mfma_f32_16x16x32_bf16 v[20:23], v[64:67], v[124:127], v[20:23]
v_mfma_f32_16x16x32_bf16 v[20:23], v[68:71], v[128:131], v[20:23]
v_mfma_f32_16x16x32_bf16 v[20:23], v[72:75], v[132:135], v[20:23]
v_add_u32 v117, 1, v117
buffer_store_dword v117, v118, s[64:67], 0 offen
buffer_load_dwordx4 v[120:123], v2, s[52:55], s12 offen offset:0 nt
buffer_load_dwordx4 v[124:127], v2, s[52:55], s12 offen offset:1024 nt
buffer_load_dwordx4 v[128:131], v2, s[52:55], s12 offen offset:2048 nt
buffer_load_dwordx4 v[132:135], v2, s[52:55], s12 offen offset:3072 nt
s_add_u32 s13, s13, 24576
s_min_u32 s12, s13, 2146435072
ds_read_b64_tr_b16 a[168:169], v90 offset:128
ds_read_b64_tr_b16 a[170:171], v90 offset:4736
ds_read_b64_tr_b16 a[172:173], v90 offset:36992
ds_read_b64_tr_b16 a[174:175], v90 offset:41600
v_and_b32_dpp v60, v81, v8 row_newbcast:1 row_mask:0xf bank_mask:0xf
v_and_b32_dpp v61, v81, v9 row_newbcast:1 row_mask:0xf bank_mask:0xf
v_and_b32_dpp v62, v81, v10 row_newbcast:1 row_mask:0xf bank_mask:0xf
v_and_b32_dpp v63, v81, v11 row_newbcast:1 row_mask:0xf bank_mask:0xf
v_and_b32_dpp v64, v81, v8 row_newbcast:5 row_mask:0xf bank_mask:0xf
v_and_b32_dpp v65, v81, v9 row_newbcast:5 row_mask:0xf bank_mask:0xf
v_and_b32_dpp v66, v81, v10 row_newbcast:5 row_mask:0xf bank_mask:0xf
v_and_b32_dpp v67, v81, v11 row_newbcast:5 row_mask:0xf bank_mask:0xf
v_and_b32_dpp v68, v81, v8 row_newbcast:9 row_mask:0xf bank_mask:0xf
v_and_b32_dpp v69, v81, v9 row_newbcast:9 row_mask:0xf bank_mask:0xf
v_and_b32_dpp v70, v81, v10 row_newbcast:9 row_mask:0xf bank_mask:0xf
v_and_b32_dpp v71, v81, v11 row_newbcast:9 row_mask:0xf bank_mask:0xf
v_and_b32_dpp v72, v81, v8 row_newbcast:13 row_mask:0xf bank_mask:0xf
v_and_b32_dpp v73, v81, v9 row_newbcast:13 row_mask:0xf bank_mask:0xf
v_and_b32_dpp v74, v81, v10 row_newbcast:13 row_mask:0xf bank_mask:0xf
v_and_b32_dpp v75, v81, v11 row_newbcast:13 row_mask:0xf bank_mask:0xf
s_waitcnt vmcnt(35)
v_mfma_f32_16x16x32_bf16 v[20:23], v[60:63], v[136:139], v[20:23]
v_mfma_f32_16x16x32_bf16 v[20:23], v[64:67], v[140:143], v[20:23]
v_mfma_f32_16x16x32_bf16 v[20:23], v[68:71], v[144:147], v[20:23]
v_mfma_f32_16x16x32_bf16 v[20:23], v[72:75], v[148:151], v[20:23]
v_add_u32 v117, 1, v117
buffer_store_dword v117, v118, s[64:67], 0 offen
buffer_load_dwordx4 v[136:139], v2, s[52:55], s12 offen offset:0 nt
buffer_load_dwordx4 v[140:143], v2, s[52:55], s12 offen offset:1024 nt
buffer_load_dwordx4 v[144:147], v2, s[52:55], s12 offen offset:2048 nt
buffer_load_dwordx4 v[148:151], v2, s[52:55], s12 offen offset:3072 nt
s_add_u32 s13, s13, 24576
s_min_u32 s12, s13, 2146435072
ds_read_b64_tr_b16 a[176:177], v88 offset:136
ds_read_b64_tr_b16 a[178:179], v88 offset:4744
ds_read_b64_tr_b16 a[180:181], v88 offset:37000
ds_read_b64_tr_b16 a[182:183], v88 offset:41608
v_and_b32_dpp v60, v77, v8 row_newbcast:0 row_mask:0xf bank_mask:0xf
v_and_b32_dpp v61, v77, v9 row_newbcast:0 row_mask:0xf bank_mask:0xf
v_and_b32_dpp v62, v77, v10 row_newbcast:0 row_mask:0xf bank_mask:0xf
v_and_b32_dpp v63, v77, v11 row_newbcast:0 row_mask:0xf bank_mask:0xf
v_and_b32_dpp v64, v77, v8 row_newbcast:4 row_mask:0xf bank_mask:0xf
v_and_b32_dpp v65, v77, v9 row_newbcast:4 row_mask:0xf bank_mask:0xf
v_and_b32_dpp v66, v77, v10 row_newbcast:4 row_mask:0xf bank_mask:0xf
v_and_b32_dpp v67, v77, v11 row_newbcast:4 row_mask:0xf bank_mask:0xf
v_and_b32_dpp v68, v77, v8 row_newbcast:8 row_mask:0xf bank_mask:0xf
v_and_b32_dpp v69, v77, v9 row_newbcast:8 row_mask:0xf bank_mask:0xf
v_and_b32_dpp v70, v77, v10 row_newbcast:8 row_mask:0xf bank_mask:0xf
v_and_b32_dpp v71, v77, v11 row_newbcast:8 row_mask:0xf bank_mask:0xf
v_and_b32_dpp v72, v77, v8 row_newbcast:12 row_mask:0xf bank_mask:0xf
v_and_b32_dpp v73, v77, v9 row_newbcast:12 row_mask:0xf bank_mask:0xf
v_and_b32_dpp v74, v77, v10 row_newbcast:12 row_mask:0xf bank_mask:0xf
v_and_b32_dpp v75, v77, v11 row_newbcast:12 row_mask:0xf bank_mask:0xf
v_mfma_f32_16x16x32_bf16 v[20:23], v[60:63], a[48:51], v[20:23]
v_mfma_f32_16x16x32_bf16 v[20:23], v[64:67], a[52:55], v[20:23]
v_mfma_f32_16x16x32_bf16 v[20:23], v[68:71], a[56:59], v[20:23]
v_mfma_f32_16x16x32_bf16 v[20:23], v[72:75], a[60:63], v[20:23]
s_nop 3
v_and_b32_dpp v60, v81, v8 row_newbcast:2 row_mask:0xf bank_mask:0xf
v_and_b32_dpp v61, v81, v9 row_newbcast:2 row_mask:0xf bank_mask:0xf
v_and_b32_dpp v62, v81, v10 row_newbcast:2 row_mask:0xf bank_mask:0xf
v_and_b32_dpp v63, v81, v11 row_newbcast:2 row_mask:0xf bank_mask:0xf
v_and_b32_dpp v64, v81, v8 row_newbcast:6 row_mask:0xf bank_mask:0xf
v_and_b32_dpp v65, v81, v9 row_newbcast:6 row_mask:0xf bank_mask:0xf
v_and_b32_dpp v66, v81, v10 row_newbcast:6 row_mask:0xf bank_mask:0xf
v_and_b32_dpp v67, v81, v11 row_newbcast:6 row_mask:0xf bank_mask:0xf
v_and_b32_dpp v68, v81, v8 row_newbcast:10 row_mask:0xf bank_mask:0xf
v_and_b32_dpp v69, v81, v9 row_newbcast:10 row_mask:0xf bank_mask:0xf
v_and_b32_dpp v70, v81, v10 row_newbcast:10 row_mask:0xf bank_mask:0xf
v_and_b32_dpp v71, v81, v11 row_newbcast:10 row_mask:0xf bank_mask:0xf
v_and_b32_dpp v72, v81, v8 row_newbcast:14 row_mask:0xf bank_mask:0xf
v_and_b32_dpp v73, v81, v9 row_newbcast:14 row_mask:0xf bank_mask:0xf
v_and_b32_dpp v74, v81, v10 row_newbcast:14 row_mask:0xf bank_mask:0xf
v_and_b32_dpp v75, v81, v11 row_newbcast:14 row_mask:0xf bank_mask:0xf
s_waitcnt vmcnt(35)
v_mfma_f32_16x16x32_bf16 v[20:23], v[60:63], v[152:155], v[20:23]
v_mfma_f32_16x16x32_bf16 v[20:23], v[64:67], v[156:159], v[20:23]
v_mfma_f32_16x16x32_bf16 v[20:23], v[68:71], v[160:163], v[20:23]
v_mfma_f32_16x16x32_bf16 v[20:23], v[72:75], v[164:167], v[20:23]
v_add_u32 v117, 1, v117
buffer_store_dword v117, v118, s[64:67], 0 offen
buffer_load_dwordx4 v[152:155], v2, s[52:55], s12 offen offset:0 nt
buffer_load_dwordx4 v[156:159], v2, s[52:55], s12 offen offset:1024 nt
buffer_load_dwordx4 v[160:163], v2, s[52:55], s12 offen offset:2048 nt
buffer_load_dwordx4 v[164:167], v2, s[52:55], s12 offen offset:3072 nt
s_add_u32 s13, s13, 24576
s_min_u32 s12, s13, 2146435072
ds_read_b64_tr_b16 a[184:185], v90 offset:136
ds_read_b64_tr_b16 a[186:187], v90 offset:4744
ds_read_b64_tr_b16 a[188:189], v90 offset:37000
ds_read_b64_tr_b16 a[190:191], v90 offset:41608
v_and_b32_dpp v60, v81, v8 row_newbcast:3 row_mask:0xf bank_mask:0xf
v_and_b32_dpp v61, v81, v9 row_newbcast:3 row_mask:0xf bank_mask:0xf
v_and_b32_dpp v62, v81, v10 row_newbcast:3 row_mask:0xf bank_mask:0xf
v_and_b32_dpp v63, v81, v11 row_newbcast:3 row_mask:0xf bank_mask:0xf
v_and_b32_dpp v64, v81, v8 row_newbcast:7 row_mask:0xf bank_mask:0xf
v_and_b32_dpp v65, v81, v9 row_newbcast:7 row_mask:0xf bank_mask:0xf
v_and_b32_dpp v66, v81, v10 row_newbcast:7 row_mask:0xf bank_mask:0xf
v_and_b32_dpp v67, v81, v11 row_newbcast:7 row_mask:0xf bank_mask:0xf
v_and_b32_dpp v68, v81, v8 row_newbcast:11 row_mask:0xf bank_mask:0xf
v_and_b32_dpp v69, v81, v9 row_newbcast:11 row_mask:0xf bank_mask:0xf
v_and_b32_dpp v70, v81, v10 row_newbcast:11 row_mask:0xf bank_mask:0xf
v_and_b32_dpp v71, v81, v11 row_newbcast:11 row_mask:0xf bank_mask:0xf
v_and_b32_dpp v72, v81, v8 row_newbcast:15 row_mask:0xf bank_mask:0xf
v_and_b32_dpp v73, v81, v9 row_newbcast:15 row_mask:0xf bank_mask:0xf
v_and_b32_dpp v74, v81, v10 row_newbcast:15 row_mask:0xf bank_mask:0xf
v_and_b32_dpp v75, v81, v11 row_newbcast:15 row_mask:0xf bank_mask:0xf
s_waitcnt vmcnt(35)
v_mfma_f32_16x16x32_bf16 v[20:23], v[60:63], v[168:171], v[20:23]
v_mfma_f32_16x16x32_bf16 v[20:23], v[64:67], v[172:175], v[20:23]
v_mfma_f32_16x16x32_bf16 v[20:23], v[68:71], v[176:179], v[20:23]
v_mfma_f32_16x16x32_bf16 v[20:23], v[72:75], v[180:183], v[20:23]
v_add_u32 v117, 1, v117
buffer_store_dword v117, v118, s[64:67], 0 offen
buffer_load_dwordx4 v[168:171], v2, s[52:55], s12 offen offset:0 nt
buffer_load_dwordx4 v[172:175], v2, s[52:55], s12 offen offset:1024 nt
buffer_load_dwordx4 v[176:179], v2, s[52:55], s12 offen offset:2048 nt
buffer_load_dwordx4 v[180:183], v2, s[52:55], s12 offen offset:3072 nt
s_add_u32 s13, s13, 24576
s_min_u32 s12, s13, 2146435072
ds_read_b64_tr_b16 a[192:193], v88 offset:144
ds_read_b64_tr_b16 a[194:195], v88 offset:4752
ds_read_b64_tr_b16 a[196:197], v88 offset:37008
ds_read_b64_tr_b16 a[198:199], v88 offset:41616
v_and_b32_dpp v60, v82, v8 row_newbcast:0 row_mask:0xf bank_mask:0xf
v_and_b32_dpp v61, v82, v9 row_newbcast:0 row_mask:0xf bank_mask:0xf
v_and_b32_dpp v62, v82, v10 row_newbcast:0 row_mask:0xf bank_mask:0xf
v_and_b32_dpp v63, v82, v11 row_newbcast:0 row_mask:0xf bank_mask:0xf
v_and_b32_dpp v64, v82, v8 row_newbcast:4 row_mask:0xf bank_mask:0xf
v_and_b32_dpp v65, v82, v9 row_newbcast:4 row_mask:0xf bank_mask:0xf
v_and_b32_dpp v66, v82, v10 row_newbcast:4 row_mask:0xf bank_mask:0xf
v_and_b32_dpp v67, v82, v11 row_newbcast:4 row_mask:0xf bank_mask:0xf
v_and_b32_dpp v68, v82, v8 row_newbcast:8 row_mask:0xf bank_mask:0xf
v_and_b32_dpp v69, v82, v9 row_newbcast:8 row_mask:0xf bank_mask:0xf
v_and_b32_dpp v70, v82, v10 row_newbcast:8 row_mask:0xf bank_mask:0xf
v_and_b32_dpp v71, v82, v11 row_newbcast:8 row_mask:0xf bank_mask:0xf
v_and_b32_dpp v72, v82, v8 row_newbcast:12 row_mask:0xf bank_mask:0xf
v_and_b32_dpp v73, v82, v9 row_newbcast:12 row_mask:0xf bank_mask:0xf
v_and_b32_dpp v74, v82, v10 row_newbcast:12 row_mask:0xf bank_mask:0xf
v_and_b32_dpp v75, v82, v11 row_newbcast:12 row_mask:0xf bank_mask:0xf
s_waitcnt vmcnt(35)
v_mfma_f32_16x16x32_bf16 v[20:23], v[60:63], v[184:187], v[20:23]
v_mfma_f32_16x16x32_bf16 v[20:23], v[64:67], v[188:191], v[20:23]
v_mfma_f32_16x16x32_bf16 v[20:23], v[68:71], v[192:195], v[20:23]
v_mfma_f32_16x16x32_bf16 v[20:23], v[72:75], v[196:199], v[20:23]
v_add_u32 v117, 1, v117
buffer_store_dword v117, v118, s[64:67], 0 offen
buffer_load_dwordx4 v[184:187], v2, s[52:55], s12 offen offset:0 nt
buffer_load_dwordx4 v[188:191], v2, s[52:55], s12 offen offset:1024 nt
buffer_load_dwordx4 v[192:195], v2, s[52:55], s12 offen offset:2048 nt
buffer_load_dwordx4 v[196:199], v2, s[52:55], s12 offen offset:3072 nt
s_add_u32 s13, s13, 24576
s_min_u32 s12, s13, 2146435072
ds_read_b64_tr_b16 a[200:201], v90 offset:144
ds_read_b64_tr_b16 a[202:203], v90 offset:4752
ds_read_b64_tr_b16 a[204:205], v90 offset:37008
ds_read_b64_tr_b16 a[206:207], v90 offset:41616
v_and_b32_dpp v60, v82, v8 row_newbcast:1 row_mask:0xf bank_mask:0xf
v_and_b32_dpp v61, v82, v9 row_newbcast:1 row_mask:0xf bank_mask:0xf
v_and_b32_dpp v62, v82, v10 row_newbcast:1 row_mask:0xf bank_mask:0xf
v_and_b32_dpp v63, v82, v11 row_newbcast:1 row_mask:0xf bank_mask:0xf
v_and_b32_dpp v64, v82, v8 row_newbcast:5 row_mask:0xf bank_mask:0xf
v_and_b32_dpp v65, v82, v9 row_newbcast:5 row_mask:0xf bank_mask:0xf
v_and_b32_dpp v66, v82, v10 row_newbcast:5 row_mask:0xf bank_mask:0xf
v_and_b32_dpp v67, v82, v11 row_newbcast:5 row_mask:0xf bank_mask:0xf
v_and_b32_dpp v68, v82, v8 row_newbcast:9 row_mask:0xf bank_mask:0xf
v_and_b32_dpp v69, v82, v9 row_newbcast:9 row_mask:0xf bank_mask:0xf
v_and_b32_dpp v70, v82, v10 row_newbcast:9 row_mask:0xf bank_mask:0xf
v_and_b32_dpp v71, v82, v11 row_newbcast:9 row_mask:0xf bank_mask:0xf
v_and_b32_dpp v72, v82, v8 row_newbcast:13 row_mask:0xf bank_mask:0xf
v_and_b32_dpp v73, v82, v9 row_newbcast:13 row_mask:0xf bank_mask:0xf
v_and_b32_dpp v74, v82, v10 row_newbcast:13 row_mask:0xf bank_mask:0xf
v_and_b32_dpp v75, v82, v11 row_newbcast:13 row_mask:0xf bank_mask:0xf
s_waitcnt vmcnt(35)
v_mfma_f32_16x16x32_bf16 v[20:23], v[60:63], v[200:203], v[20:23]
v_mfma_f32_16x16x32_bf16 v[20:23], v[64:67], v[204:207], v[20:23]
v_mfma_f32_16x16x32_bf16 v[20:23], v[68:71], v[208:211], v[20:23]
v_mfma_f32_16x16x32_bf16 v[20:23], v[72:75], v[212:215], v[20:23]
v_add_u32 v117, 1, v117
buffer_store_dword v117, v118, s[64:67], 0 offen
buffer_load_dwordx4 v[200:203], v2, s[52:55], s12 offen offset:0 nt
buffer_load_dwordx4 v[204:207], v2, s[52:55], s12 offen offset:1024 nt
buffer_load_dwordx4 v[208:211], v2, s[52:55], s12 offen offset:2048 nt
buffer_load_dwordx4 v[212:215], v2, s[52:55], s12 offen offset:3072 nt
s_add_u32 s13, s13, 24576
s_min_u32 s12, s13, 2146435072
ds_read_b64_tr_b16 a[208:209], v88 offset:152
ds_read_b64_tr_b16 a[210:211], v88 offset:4760
ds_read_b64_tr_b16 a[212:213], v88 offset:37016
ds_read_b64_tr_b16 a[214:215], v88 offset:41624
v_and_b32_dpp v60, v77, v8 row_newbcast:1 row_mask:0xf bank_mask:0xf
v_and_b32_dpp v61, v77, v9 row_newbcast:1 row_mask:0xf bank_mask:0xf
v_and_b32_dpp v62, v77, v10 row_newbcast:1 row_mask:0xf bank_mask:0xf
v_and_b32_dpp v63, v77, v11 row_newbcast:1 row_mask:0xf bank_mask:0xf
v_and_b32_dpp v64, v77, v8 row_newbcast:5 row_mask:0xf bank_mask:0xf
v_and_b32_dpp v65, v77, v9 row_newbcast:5 row_mask:0xf bank_mask:0xf
v_and_b32_dpp v66, v77, v10 row_newbcast:5 row_mask:0xf bank_mask:0xf
v_and_b32_dpp v67, v77, v11 row_newbcast:5 row_mask:0xf bank_mask:0xf
v_and_b32_dpp v68, v77, v8 row_newbcast:9 row_mask:0xf bank_mask:0xf
v_and_b32_dpp v69, v77, v9 row_newbcast:9 row_mask:0xf bank_mask:0xf
v_and_b32_dpp v70, v77, v10 row_newbcast:9 row_mask:0xf bank_mask:0xf
v_and_b32_dpp v71, v77, v11 row_newbcast:9 row_mask:0xf bank_mask:0xf
v_and_b32_dpp v72, v77, v8 row_newbcast:13 row_mask:0xf bank_mask:0xf
v_and_b32_dpp v73, v77, v9 row_newbcast:13 row_mask:0xf bank_mask:0xf
v_and_b32_dpp v74, v77, v10 row_newbcast:13 row_mask:0xf bank_mask:0xf
v_and_b32_dpp v75, v77, v11 row_newbcast:13 row_mask:0xf bank_mask:0xf
v_mfma_f32_16x16x32_bf16 v[20:23], v[60:63], a[64:67], v[20:23]
v_mfma_f32_16x16x32_bf16 v[20:23], v[64:67], a[68:71], v[20:23]
v_mfma_f32_16x16x32_bf16 v[20:23], v[68:71], a[72:75], v[20:23]
v_mfma_f32_16x16x32_bf16 v[20:23], v[72:75], a[76:79], v[20:23]
s_nop 3
v_and_b32_dpp v60, v82, v8 row_newbcast:2 row_mask:0xf bank_mask:0xf
v_and_b32_dpp v61, v82, v9 row_newbcast:2 row_mask:0xf bank_mask:0xf
v_and_b32_dpp v62, v82, v10 row_newbcast:2 row_mask:0xf bank_mask:0xf
v_and_b32_dpp v63, v82, v11 row_newbcast:2 row_mask:0xf bank_mask:0xf
v_and_b32_dpp v64, v82, v8 row_newbcast:6 row_mask:0xf bank_mask:0xf
v_and_b32_dpp v65, v82, v9 row_newbcast:6 row_mask:0xf bank_mask:0xf
v_and_b32_dpp v66, v82, v10 row_newbcast:6 row_mask:0xf bank_mask:0xf
v_and_b32_dpp v67, v82, v11 row_newbcast:6 row_mask:0xf bank_mask:0xf
v_and_b32_dpp v68, v82, v8 row_newbcast:10 row_mask:0xf bank_mask:0xf
v_and_b32_dpp v69, v82, v9 row_newbcast:10 row_mask:0xf bank_mask:0xf
v_and_b32_dpp v70, v82, v10 row_newbcast:10 row_mask:0xf bank_mask:0xf
v_and_b32_dpp v71, v82, v11 row_newbcast:10 row_mask:0xf bank_mask:0xf
v_and_b32_dpp v72, v82, v8 row_newbcast:14 row_mask:0xf bank_mask:0xf
v_and_b32_dpp v73, v82, v9 row_newbcast:14 row_mask:0xf bank_mask:0xf
v_and_b32_dpp v74, v82, v10 row_newbcast:14 row_mask:0xf bank_mask:0xf
v_and_b32_dpp v75, v82, v11 row_newbcast:14 row_mask:0xf bank_mask:0xf
s_waitcnt vmcnt(35)
v_mfma_f32_16x16x32_bf16 v[20:23], v[60:63], v[216:219], v[20:23]
v_mfma_f32_16x16x32_bf16 v[20:23], v[64:67], v[220:223], v[20:23]
v_mfma_f32_16x16x32_bf16 v[20:23], v[68:71], v[224:227], v[20:23]
v_mfma_f32_16x16x32_bf16 v[20:23], v[72:75], v[228:231], v[20:23]
v_add_u32 v117, 1, v117
buffer_store_dword v117, v118, s[64:67], 0 offen
buffer_load_dwordx4 v[216:219], v2, s[52:55], s12 offen offset:0 nt
buffer_load_dwordx4 v[220:223], v2, s[52:55], s12 offen offset:1024 nt
buffer_load_dwordx4 v[224:227], v2, s[52:55], s12 offen offset:2048 nt
buffer_load_dwordx4 v[228:231], v2, s[52:55], s12 offen offset:3072 nt
s_add_u32 s13, s13, 24576
s_min_u32 s12, s13, 2146435072
ds_read_b64_tr_b16 a[216:217], v90 offset:152
ds_read_b64_tr_b16 a[218:219], v90 offset:4760
ds_read_b64_tr_b16 a[220:221], v90 offset:37016
ds_read_b64_tr_b16 a[222:223], v90 offset:41624
v_and_b32_dpp v60, v82, v8 row_newbcast:3 row_mask:0xf bank_mask:0xf
v_and_b32_dpp v61, v82, v9 row_newbcast:3 row_mask:0xf bank_mask:0xf
v_and_b32_dpp v62, v82, v10 row_newbcast:3 row_mask:0xf bank_mask:0xf
v_and_b32_dpp v63, v82, v11 row_newbcast:3 row_mask:0xf bank_mask:0xf
v_and_b32_dpp v64, v82, v8 row_newbcast:7 row_mask:0xf bank_mask:0xf
v_and_b32_dpp v65, v82, v9 row_newbcast:7 row_mask:0xf bank_mask:0xf
v_and_b32_dpp v66, v82, v10 row_newbcast:7 row_mask:0xf bank_mask:0xf
v_and_b32_dpp v67, v82, v11 row_newbcast:7 row_mask:0xf bank_mask:0xf
v_and_b32_dpp v68, v82, v8 row_newbcast:11 row_mask:0xf bank_mask:0xf
v_and_b32_dpp v69, v82, v9 row_newbcast:11 row_mask:0xf bank_mask:0xf
v_and_b32_dpp v70, v82, v10 row_newbcast:11 row_mask:0xf bank_mask:0xf
v_and_b32_dpp v71, v82, v11 row_newbcast:11 row_mask:0xf bank_mask:0xf
v_and_b32_dpp v72, v82, v8 row_newbcast:15 row_mask:0xf bank_mask:0xf
v_and_b32_dpp v73, v82, v9 row_newbcast:15 row_mask:0xf bank_mask:0xf
v_and_b32_dpp v74, v82, v10 row_newbcast:15 row_mask:0xf bank_mask:0xf
v_and_b32_dpp v75, v82, v11 row_newbcast:15 row_mask:0xf bank_mask:0xf
s_waitcnt vmcnt(35)
v_mfma_f32_16x16x32_bf16 v[20:23], v[60:63], v[232:235], v[20:23]
v_mfma_f32_16x16x32_bf16 v[20:23], v[64:67], v[236:239], v[20:23]
v_mfma_f32_16x16x32_bf16 v[20:23], v[68:71], v[240:243], v[20:23]
v_mfma_f32_16x16x32_bf16 v[20:23], v[72:75], v[244:247], v[20:23]
v_add_u32 v117, 1, v117
buffer_store_dword v117, v118, s[64:67], 0 offen
buffer_load_dwordx4 v[232:235], v2, s[52:55], s12 offen offset:0 nt
buffer_load_dwordx4 v[236:239], v2, s[52:55], s12 offen offset:1024 nt
buffer_load_dwordx4 v[240:243], v2, s[52:55], s12 offen offset:2048 nt
buffer_load_dwordx4 v[244:247], v2, s[52:55], s12 offen offset:3072 nt
s_add_u32 s13, s13, 24576
s_min_u32 s12, s13, 2146435072
ds_read_b64_tr_b16 a[224:225], v89 offset:0
ds_read_b64_tr_b16 a[226:227], v89 offset:4608
ds_read_b64_tr_b16 a[228:229], v89 offset:36864
ds_read_b64_tr_b16 a[230:231], v89 offset:41472
buffer_load_dwordx4 v[40:43], off, s[64:67], s82 offset:0 sc1
buffer_load_dwordx4 v[44:47], off, s[64:67], s82 offset:16 sc1
buffer_load_dwordx4 v[48:51], off, s[64:67], s82 offset:32 sc1
v_and_b32_dpp v60, v83, v8 row_newbcast:0 row_mask:0xf bank_mask:0xf
v_and_b32_dpp v61, v83, v9 row_newbcast:0 row_mask:0xf bank_mask:0xf
v_and_b32_dpp v62, v83, v10 row_newbcast:0 row_mask:0xf bank_mask:0xf
v_and_b32_dpp v63, v83, v11 row_newbcast:0 row_mask:0xf bank_mask:0xf
v_and_b32_dpp v64, v83, v8 row_newbcast:4 row_mask:0xf bank_mask:0xf
v_and_b32_dpp v65, v83, v9 row_newbcast:4 row_mask:0xf bank_mask:0xf
v_and_b32_dpp v66, v83, v10 row_newbcast:4 row_mask:0xf bank_mask:0xf
v_and_b32_dpp v67, v83, v11 row_newbcast:4 row_mask:0xf bank_mask:0xf
v_and_b32_dpp v68, v83, v8 row_newbcast:8 row_mask:0xf bank_mask:0xf
v_and_b32_dpp v69, v83, v9 row_newbcast:8 row_mask:0xf bank_mask:0xf
v_and_b32_dpp v70, v83, v10 row_newbcast:8 row_mask:0xf bank_mask:0xf
v_and_b32_dpp v71, v83, v11 row_newbcast:8 row_mask:0xf bank_mask:0xf
v_and_b32_dpp v72, v83, v8 row_newbcast:12 row_mask:0xf bank_mask:0xf
v_and_b32_dpp v73, v83, v9 row_newbcast:12 row_mask:0xf bank_mask:0xf
v_and_b32_dpp v74, v83, v10 row_newbcast:12 row_mask:0xf bank_mask:0xf
v_and_b32_dpp v75, v83, v11 row_newbcast:12 row_mask:0xf bank_mask:0xf
s_waitcnt vmcnt(38)
v_mfma_f32_16x16x32_bf16 v[20:23], v[60:63], v[120:123], v[20:23]
v_mfma_f32_16x16x32_bf16 v[20:23], v[64:67], v[124:127], v[20:23]
v_mfma_f32_16x16x32_bf16 v[20:23], v[68:71], v[128:131], v[20:23]
v_mfma_f32_16x16x32_bf16 v[20:23], v[72:75], v[132:135], v[20:23]
v_add_u32 v117, 1, v117
buffer_store_dword v117, v118, s[64:67], 0 offen
buffer_load_dwordx4 v[120:123], v2, s[52:55], s12 offen offset:0 nt
buffer_load_dwordx4 v[124:127], v2, s[52:55], s12 offen offset:1024 nt
buffer_load_dwordx4 v[128:131], v2, s[52:55], s12 offen offset:2048 nt
buffer_load_dwordx4 v[132:135], v2, s[52:55], s12 offen offset:3072 nt
s_add_u32 s13, s13, 24576
s_min_u32 s12, s13, 2146435072
ds_read_b64_tr_b16 a[232:233], v91 offset:0
ds_read_b64_tr_b16 a[234:235], v91 offset:4608
ds_read_b64_tr_b16 a[236:237], v91 offset:36864
ds_read_b64_tr_b16 a[238:239], v91 offset:41472
v_and_b32_dpp v60, v83, v8 row_newbcast:1 row_mask:0xf bank_mask:0xf
v_and_b32_dpp v61, v83, v9 row_newbcast:1 row_mask:0xf bank_mask:0xf
v_and_b32_dpp v62, v83, v10 row_newbcast:1 row_mask:0xf bank_mask:0xf
v_and_b32_dpp v63, v83, v11 row_newbcast:1 row_mask:0xf bank_mask:0xf
v_and_b32_dpp v64, v83, v8 row_newbcast:5 row_mask:0xf bank_mask:0xf
v_and_b32_dpp v65, v83, v9 row_newbcast:5 row_mask:0xf bank_mask:0xf
v_and_b32_dpp v66, v83, v10 row_newbcast:5 row_mask:0xf bank_mask:0xf
v_and_b32_dpp v67, v83, v11 row_newbcast:5 row_mask:0xf bank_mask:0xf
v_and_b32_dpp v68, v83, v8 row_newbcast:9 row_mask:0xf bank_mask:0xf
v_and_b32_dpp v69, v83, v9 row_newbcast:9 row_mask:0xf bank_mask:0xf
v_and_b32_dpp v70, v83, v10 row_newbcast:9 row_mask:0xf bank_mask:0xf
v_and_b32_dpp v71, v83, v11 row_newbcast:9 row_mask:0xf bank_mask:0xf
v_and_b32_dpp v72, v83, v8 row_newbcast:13 row_mask:0xf bank_mask:0xf
v_and_b32_dpp v73, v83, v9 row_newbcast:13 row_mask:0xf bank_mask:0xf
v_and_b32_dpp v74, v83, v10 row_newbcast:13 row_mask:0xf bank_mask:0xf
v_and_b32_dpp v75, v83, v11 row_newbcast:13 row_mask:0xf bank_mask:0xf
s_waitcnt vmcnt(38)
v_mfma_f32_16x16x32_bf16 v[20:23], v[60:63], v[136:139], v[20:23]
v_mfma_f32_16x16x32_bf16 v[20:23], v[64:67], v[140:143], v[20:23]
v_mfma_f32_16x16x32_bf16 v[20:23], v[68:71], v[144:147], v[20:23]
v_mfma_f32_16x16x32_bf16 v[20:23], v[72:75], v[148:151], v[20:23]
s_nop 3
v_and_b32_dpp v60, v83, v8 row_newbcast:2 row_mask:0xf bank_mask:0xf
v_and_b32_dpp v61, v83, v9 row_newbcast:2 row_mask:0xf bank_mask:0xf
v_and_b32_dpp v62, v83, v10 row_newbcast:2 row_mask:0xf bank_mask:0xf
v_and_b32_dpp v63, v83, v11 row_newbcast:2 row_mask:0xf bank_mask:0xf
v_and_b32_dpp v64, v83, v8 row_newbcast:6 row_mask:0xf bank_mask:0xf
v_and_b32_dpp v65, v83, v9 row_newbcast:6 row_mask:0xf bank_mask:0xf
v_and_b32_dpp v66, v83, v10 row_newbcast:6 row_mask:0xf bank_mask:0xf
v_and_b32_dpp v67, v83, v11 row_newbcast:6 row_mask:0xf bank_mask:0xf
v_and_b32_dpp v68, v83, v8 row_newbcast:10 row_mask:0xf bank_mask:0xf
v_and_b32_dpp v69, v83, v9 row_newbcast:10 row_mask:0xf bank_mask:0xf
v_and_b32_dpp v70, v83, v10 row_newbcast:10 row_mask:0xf bank_mask:0xf
v_and_b32_dpp v71, v83, v11 row_newbcast:10 row_mask:0xf bank_mask:0xf
v_and_b32_dpp v72, v83, v8 row_newbcast:14 row_mask:0xf bank_mask:0xf
v_and_b32_dpp v73, v83, v9 row_newbcast:14 row_mask:0xf bank_mask:0xf
v_and_b32_dpp v74, v83, v10 row_newbcast:14 row_mask:0xf bank_mask:0xf
v_and_b32_dpp v75, v83, v11 row_newbcast:14 row_mask:0xf bank_mask:0xf
s_waitcnt vmcnt(33)
v_mfma_f32_16x16x32_bf16 v[20:23], v[60:63], v[152:155], v[20:23]
v_mfma_f32_16x16x32_bf16 v[20:23], v[64:67], v[156:159], v[20:23]
v_mfma_f32_16x16x32_bf16 v[20:23], v[68:71], v[160:163], v[20:23]
v_mfma_f32_16x16x32_bf16 v[20:23], v[72:75], v[164:167], v[20:23]
v_add_u32 v117, 1, v117
buffer_store_dword v117, v118, s[64:67], 0 offen
buffer_load_dwordx4 v[136:139], v2, s[52:55], s12 offen offset:0 nt
buffer_load_dwordx4 v[140:143], v2, s[52:55], s12 offen offset:1024 nt
buffer_load_dwordx4 v[144:147], v2, s[52:55], s12 offen offset:2048 nt
buffer_load_dwordx4 v[148:151], v2, s[52:55], s12 offen offset:3072 nt
s_add_u32 s13, s13, 24576
s_min_u32 s12, s13, 2146435072
v_and_b32_dpp v60, v77, v8 row_newbcast:2 row_mask:0xf bank_mask:0xf
v_and_b32_dpp v61, v77, v9 row_newbcast:2 row_mask:0xf bank_mask:0xf
v_and_b32_dpp v62, v77, v10 row_newbcast:2 row_mask:0xf bank_mask:0xf
v_and_b32_dpp v63, v77, v11 row_newbcast:2 row_mask:0xf bank_mask:0xf
v_and_b32_dpp v64, v77, v8 row_newbcast:6 row_mask:0xf bank_mask:0xf
v_and_b32_dpp v65, v77, v9 row_newbcast:6 row_mask:0xf bank_mask:0xf
v_and_b32_dpp v66, v77, v10 row_newbcast:6 row_mask:0xf bank_mask:0xf
v_and_b32_dpp v67, v77, v11 row_newbcast:6 row_mask:0xf bank_mask:0xf
v_and_b32_dpp v68, v77, v8 row_newbcast:10 row_mask:0xf bank_mask:0xf
v_and_b32_dpp v69, v77, v9 row_newbcast:10 row_mask:0xf bank_mask:0xf
v_and_b32_dpp v70, v77, v10 row_newbcast:10 row_mask:0xf bank_mask:0xf
v_and_b32_dpp v71, v77, v11 row_newbcast:10 row_mask:0xf bank_mask:0xf
v_and_b32_dpp v72, v77, v8 row_newbcast:14 row_mask:0xf bank_mask:0xf
v_and_b32_dpp v73, v77, v9 row_newbcast:14 row_mask:0xf bank_mask:0xf
v_and_b32_dpp v74, v77, v10 row_newbcast:14 row_mask:0xf bank_mask:0xf
v_and_b32_dpp v75, v77, v11 row_newbcast:14 row_mask:0xf bank_mask:0xf
v_mfma_f32_16x16x32_bf16 v[20:23], v[60:63], a[80:83], v[20:23]
v_mfma_f32_16x16x32_bf16 v[20:23], v[64:67], a[84:87], v[20:23]
v_mfma_f32_16x16x32_bf16 v[20:23], v[68:71], a[88:91], v[20:23]
v_mfma_f32_16x16x32_bf16 v[20:23], v[72:75], a[92:95], v[20:23]
s_nop 3
v_and_b32_dpp v60, v83, v8 row_newbcast:3 row_mask:0xf bank_mask:0xf
v_and_b32_dpp v61, v83, v9 row_newbcast:3 row_mask:0xf bank_mask:0xf
v_and_b32_dpp v62, v83, v10 row_newbcast:3 row_mask:0xf bank_mask:0xf
v_and_b32_dpp v63, v83, v11 row_newbcast:3 row_mask:0xf bank_mask:0xf
v_and_b32_dpp v64, v83, v8 row_newbcast:7 row_mask:0xf bank_mask:0xf
v_and_b32_dpp v65, v83, v9 row_newbcast:7 row_mask:0xf bank_mask:0xf
v_and_b32_dpp v66, v83, v10 row_newbcast:7 row_mask:0xf bank_mask:0xf
v_and_b32_dpp v67, v83, v11 row_newbcast:7 row_mask:0xf bank_mask:0xf
v_and_b32_dpp v68, v83, v8 row_newbcast:11 row_mask:0xf bank_mask:0xf
v_and_b32_dpp v69, v83, v9 row_newbcast:11 row_mask:0xf bank_mask:0xf
v_and_b32_dpp v70, v83, v10 row_newbcast:11 row_mask:0xf bank_mask:0xf
v_and_b32_dpp v71, v83, v11 row_newbcast:11 row_mask:0xf bank_mask:0xf
v_and_b32_dpp v72, v83, v8 row_newbcast:15 row_mask:0xf bank_mask:0xf
v_and_b32_dpp v73, v83, v9 row_newbcast:15 row_mask:0xf bank_mask:0xf
v_and_b32_dpp v74, v83, v10 row_newbcast:15 row_mask:0xf bank_mask:0xf
v_and_b32_dpp v75, v83, v11 row_newbcast:15 row_mask:0xf bank_mask:0xf
s_waitcnt vmcnt(33)
v_mfma_f32_16x16x32_bf16 v[20:23], v[60:63], v[168:171], v[20:23]
v_mfma_f32_16x16x32_bf16 v[20:23], v[64:67], v[172:175], v[20:23]
v_mfma_f32_16x16x32_bf16 v[20:23], v[68:71], v[176:179], v[20:23]
v_mfma_f32_16x16x32_bf16 v[20:23], v[72:75], v[180:183], v[20:23]
s_nop 3
v_and_b32_dpp v60, v84, v8 row_newbcast:0 row_mask:0xf bank_mask:0xf
v_and_b32_dpp v61, v84, v9 row_newbcast:0 row_mask:0xf bank_mask:0xf
v_and_b32_dpp v62, v84, v10 row_newbcast:0 row_mask:0xf bank_mask:0xf
v_and_b32_dpp v63, v84, v11 row_newbcast:0 row_mask:0xf bank_mask:0xf
v_and_b32_dpp v64, v84, v8 row_newbcast:4 row_mask:0xf bank_mask:0xf
v_and_b32_dpp v65, v84, v9 row_newbcast:4 row_mask:0xf bank_mask:0xf
v_and_b32_dpp v66, v84, v10 row_newbcast:4 row_mask:0xf bank_mask:0xf
v_and_b32_dpp v67, v84, v11 row_newbcast:4 row_mask:0xf bank_mask:0xf
v_and_b32_dpp v68, v84, v8 row_newbcast:8 row_mask:0xf bank_mask:0xf
v_and_b32_dpp v69, v84, v9 row_newbcast:8 row_mask:0xf bank_mask:0xf
v_and_b32_dpp v70, v84, v10 row_newbcast:8 row_mask:0xf bank_mask:0xf
v_and_b32_dpp v71, v84, v11 row_newbcast:8 row_mask:0xf bank_mask:0xf
v_and_b32_dpp v72, v84, v8 row_newbcast:12 row_mask:0xf bank_mask:0xf
v_and_b32_dpp v73, v84, v9 row_newbcast:12 row_mask:0xf bank_mask:0xf
v_and_b32_dpp v74, v84, v10 row_newbcast:12 row_mask:0xf bank_mask:0xf
v_and_b32_dpp v75, v84, v11 row_newbcast:12 row_mask:0xf bank_mask:0xf
s_waitcnt vmcnt(28)
v_mfma_f32_16x16x32_bf16 v[20:23], v[60:63], v[184:187], v[20:23]
v_mfma_f32_16x16x32_bf16 v[20:23], v[64:67], v[188:191], v[20:23]
v_mfma_f32_16x16x32_bf16 v[20:23], v[68:71], v[192:195], v[20:23]
v_mfma_f32_16x16x32_bf16 v[20:23], v[72:75], v[196:199], v[20:23]
v_add_u32 v117, 1, v117
buffer_store_dword v117, v118, s[64:67], 0 offen
buffer_load_dwordx4 v[152:155], v2, s[52:55], s12 offen offset:0 nt
buffer_load_dwordx4 v[156:159], v2, s[52:55], s12 offen offset:1024 nt
buffer_load_dwordx4 v[160:163], v2, s[52:55], s12 offen offset:2048 nt
buffer_load_dwordx4 v[164:167], v2, s[52:55], s12 offen offset:3072 nt
s_add_u32 s13, s13, 24576
s_min_u32 s12, s13, 2146435072
v_and_b32_dpp v60, v84, v8 row_newbcast:1 row_mask:0xf bank_mask:0xf
v_and_b32_dpp v61, v84, v9 row_newbcast:1 row_mask:0xf bank_mask:0xf
v_and_b32_dpp v62, v84, v10 row_newbcast:1 row_mask:0xf bank_mask:0xf
v_and_b32_dpp v63, v84, v11 row_newbcast:1 row_mask:0xf bank_mask:0xf
v_and_b32_dpp v64, v84, v8 row_newbcast:5 row_mask:0xf bank_mask:0xf
v_and_b32_dpp v65, v84, v9 row_newbcast:5 row_mask:0xf bank_mask:0xf
v_and_b32_dpp v66, v84, v10 row_newbcast:5 row_mask:0xf bank_mask:0xf
v_and_b32_dpp v67, v84, v11 row_newbcast:5 row_mask:0xf bank_mask:0xf
v_and_b32_dpp v68, v84, v8 row_newbcast:9 row_mask:0xf bank_mask:0xf
v_and_b32_dpp v69, v84, v9 row_newbcast:9 row_mask:0xf bank_mask:0xf
v_and_b32_dpp v70, v84, v10 row_newbcast:9 row_mask:0xf bank_mask:0xf
v_and_b32_dpp v71, v84, v11 row_newbcast:9 row_mask:0xf bank_mask:0xf
v_and_b32_dpp v72, v84, v8 row_newbcast:13 row_mask:0xf bank_mask:0xf
v_and_b32_dpp v73, v84, v9 row_newbcast:13 row_mask:0xf bank_mask:0xf
v_and_b32_dpp v74, v84, v10 row_newbcast:13 row_mask:0xf bank_mask:0xf
v_and_b32_dpp v75, v84, v11 row_newbcast:13 row_mask:0xf bank_mask:0xf
s_waitcnt vmcnt(28)
v_mfma_f32_16x16x32_bf16 v[20:23], v[60:63], v[200:203], v[20:23]
v_mfma_f32_16x16x32_bf16 v[20:23], v[64:67], v[204:207], v[20:23]
v_mfma_f32_16x16x32_bf16 v[20:23], v[68:71], v[208:211], v[20:23]
v_mfma_f32_16x16x32_bf16 v[20:23], v[72:75], v[212:215], v[20:23]
s_nop 3
v_and_b32_dpp v60, v84, v8 row_newbcast:2 row_mask:0xf bank_mask:0xf
v_and_b32_dpp v61, v84, v9 row_newbcast:2 row_mask:0xf bank_mask:0xf
v_and_b32_dpp v62, v84, v10 row_newbcast:2 row_mask:0xf bank_mask:0xf
v_and_b32_dpp v63, v84, v11 row_newbcast:2 row_mask:0xf bank_mask:0xf
v_and_b32_dpp v64, v84, v8 row_newbcast:6 row_mask:0xf bank_mask:0xf
v_and_b32_dpp v65, v84, v9 row_newbcast:6 row_mask:0xf bank_mask:0xf
v_and_b32_dpp v66, v84, v10 row_newbcast:6 row_mask:0xf bank_mask:0xf
v_and_b32_dpp v67, v84, v11 row_newbcast:6 row_mask:0xf bank_mask:0xf
v_and_b32_dpp v68, v84, v8 row_newbcast:10 row_mask:0xf bank_mask:0xf
v_and_b32_dpp v69, v84, v9 row_newbcast:10 row_mask:0xf bank_mask:0xf
v_and_b32_dpp v70, v84, v10 row_newbcast:10 row_mask:0xf bank_mask:0xf
v_and_b32_dpp v71, v84, v11 row_newbcast:10 row_mask:0xf bank_mask:0xf
v_and_b32_dpp v72, v84, v8 row_newbcast:14 row_mask:0xf bank_mask:0xf
v_and_b32_dpp v73, v84, v9 row_newbcast:14 row_mask:0xf bank_mask:0xf
v_and_b32_dpp v74, v84, v10 row_newbcast:14 row_mask:0xf bank_mask:0xf
v_and_b32_dpp v75, v84, v11 row_newbcast:14 row_mask:0xf bank_mask:0xf
s_waitcnt vmcnt(23)
v_mfma_f32_16x16x32_bf16 v[20:23], v[60:63], v[216:219], v[20:23]
v_mfma_f32_16x16x32_bf16 v[20:23], v[64:67], v[220:223], v[20:23]
v_mfma_f32_16x16x32_bf16 v[20:23], v[68:71], v[224:227], v[20:23]
v_mfma_f32_16x16x32_bf16 v[20:23], v[72:75], v[228:231], v[20:23]
v_add_u32 v117, 1, v117
buffer_store_dword v117, v118, s[64:67], 0 offen
buffer_load_dwordx4 v[168:171], v2, s[52:55], s12 offen offset:0 nt
buffer_load_dwordx4 v[172:175], v2, s[52:55], s12 offen offset:1024 nt
buffer_load_dwordx4 v[176:179], v2, s[52:55], s12 offen offset:2048 nt
buffer_load_dwordx4 v[180:183], v2, s[52:55], s12 offen offset:3072 nt
s_add_u32 s13, s13, 24576
s_min_u32 s12, s13, 2146435072
v_and_b32_dpp v60, v84, v8 row_newbcast:3 row_mask:0xf bank_mask:0xf
v_and_b32_dpp v61, v84, v9 row_newbcast:3 row_mask:0xf bank_mask:0xf
v_and_b32_dpp v62, v84, v10 row_newbcast:3 row_mask:0xf bank_mask:0xf
v_and_b32_dpp v63, v84, v11 row_newbcast:3 row_mask:0xf bank_mask:0xf
v_and_b32_dpp v64, v84, v8 row_newbcast:7 row_mask:0xf bank_mask:0xf
v_and_b32_dpp v65, v84, v9 row_newbcast:7 row_mask:0xf bank_mask:0xf
v_and_b32_dpp v66, v84, v10 row_newbcast:7 row_mask:0xf bank_mask:0xf
v_and_b32_dpp v67, v84, v11 row_newbcast:7 row_mask:0xf bank_mask:0xf
v_and_b32_dpp v68, v84, v8 row_newbcast:11 row_mask:0xf bank_mask:0xf
v_and_b32_dpp v69, v84, v9 row_newbcast:11 row_mask:0xf bank_mask:0xf
v_and_b32_dpp v70, v84, v10 row_newbcast:11 row_mask:0xf bank_mask:0xf
v_and_b32_dpp v71, v84, v11 row_newbcast:11 row_mask:0xf bank_mask:0xf
v_and_b32_dpp v72, v84, v8 row_newbcast:15 row_mask:0xf bank_mask:0xf
v_and_b32_dpp v73, v84, v9 row_newbcast:15 row_mask:0xf bank_mask:0xf
v_and_b32_dpp v74, v84, v10 row_newbcast:15 row_mask:0xf bank_mask:0xf
v_and_b32_dpp v75, v84, v11 row_newbcast:15 row_mask:0xf bank_mask:0xf
s_waitcnt vmcnt(23)
v_mfma_f32_16x16x32_bf16 v[20:23], v[60:63], v[232:235], v[20:23]
v_mfma_f32_16x16x32_bf16 v[20:23], v[64:67], v[236:239], v[20:23]
v_mfma_f32_16x16x32_bf16 v[20:23], v[68:71], v[240:243], v[20:23]
v_mfma_f32_16x16x32_bf16 v[20:23], v[72:75], v[244:247], v[20:23]
s_nop 3
v_and_b32_dpp v60, v85, v8 row_newbcast:0 row_mask:0xf bank_mask:0xf
v_and_b32_dpp v61, v85, v9 row_newbcast:0 row_mask:0xf bank_mask:0xf
v_and_b32_dpp v62, v85, v10 row_newbcast:0 row_mask:0xf bank_mask:0xf
v_and_b32_dpp v63, v85, v11 row_newbcast:0 row_mask:0xf bank_mask:0xf
v_and_b32_dpp v64, v85, v8 row_newbcast:4 row_mask:0xf bank_mask:0xf
v_and_b32_dpp v65, v85, v9 row_newbcast:4 row_mask:0xf bank_mask:0xf
v_and_b32_dpp v66, v85, v10 row_newbcast:4 row_mask:0xf bank_mask:0xf
v_and_b32_dpp v67, v85, v11 row_newbcast:4 row_mask:0xf bank_mask:0xf
v_and_b32_dpp v68, v85, v8 row_newbcast:8 row_mask:0xf bank_mask:0xf
v_and_b32_dpp v69, v85, v9 row_newbcast:8 row_mask:0xf bank_mask:0xf
v_and_b32_dpp v70, v85, v10 row_newbcast:8 row_mask:0xf bank_mask:0xf
v_and_b32_dpp v71, v85, v11 row_newbcast:8 row_mask:0xf bank_mask:0xf
v_and_b32_dpp v72, v85, v8 row_newbcast:12 row_mask:0xf bank_mask:0xf
v_and_b32_dpp v73, v85, v9 row_newbcast:12 row_mask:0xf bank_mask:0xf
v_and_b32_dpp v74, v85, v10 row_newbcast:12 row_mask:0xf bank_mask:0xf
v_and_b32_dpp v75, v85, v11 row_newbcast:12 row_mask:0xf bank_mask:0xf
s_waitcnt vmcnt(15)
v_mfma_f32_16x16x32_bf16 v[20:23], v[60:63], v[120:123], v[20:23]
v_mfma_f32_16x16x32_bf16 v[20:23], v[64:67], v[124:127], v[20:23]
v_mfma_f32_16x16x32_bf16 v[20:23], v[68:71], v[128:131], v[20:23]
v_mfma_f32_16x16x32_bf16 v[20:23], v[72:75], v[132:135], v[20:23]
v_add_u32 v117, 1, v117
buffer_store_dword v117, v118, s[64:67], 0 offen
buffer_load_dwordx4 v[184:187], v2, s[52:55], s12 offen offset:0 nt
buffer_load_dwordx4 v[188:191], v2, s[52:55], s12 offen offset:1024 nt
buffer_load_dwordx4 v[192:195], v2, s[52:55], s12 offen offset:2048 nt
buffer_load_dwordx4 v[196:199], v2, s[52:55], s12 offen offset:3072 nt
s_add_u32 s13, s13, 24576
s_min_u32 s12, s13, 2146435072
s_mov_b32 s7, 400000
A_ev2_chk:
v_max3_u32 v35, v40, v41, v42
v_max3_u32 v35, v35, v43, v44
v_max3_u32 v35, v35, v45, v46
v_max3_u32 v35, v35, v47, v48
v_max3_u32 v35, v35, v49, v50
v_max_u32 v35, v35, v51
v_cmp_eq_u32 vcc, -1, v35
s_cbranch_vccz A_ev2_ok
buffer_load_dwordx4 v[40:43], off, s[64:67], s82 offset:0 sc1
buffer_load_dwordx4 v[44:47], off, s[64:67], s82 offset:16 sc1
buffer_load_dwordx4 v[48:51], off, s[64:67], s82 offset:32 sc1
s_waitcnt vmcnt(0)
s_sub_u32 s7, s7, 1
s_cmp_lg_u32 s7, 0
s_cbranch_scc1 A_ev2_chk
A_ev2_ok:
v_max3_f32 v35, v40, v42, v44
v_max3_f32 v36, v46, v48, v50
v_max_f32 v35, v35, v36
v_sub_f32 v40, v40, v35
v_sub_f32 v42, v42, v35
v_sub_f32 v44, v44, v35
v_sub_f32 v46, v46, v35
v_sub_f32 v48, v48, v35
v_sub_f32 v50, v50, v35
v_sub_f32 v37, v32, v35
v_exp_f32 v40, v40
v_exp_f32 v42, v42
v_exp_f32 v44, v44
v_exp_f32 v46, v46
v_exp_f32 v48, v48
v_exp_f32 v50, v50
v_exp_f32 v37, v37
v_mul_f32 v35, v40, v41
v_fma_f32 v35, v42, v43, v35
v_fma_f32 v35, v44, v45, v35
v_fma_f32 v35, v46, v47, v35
v_fma_f32 v35, v48, v49, v35
v_fma_f32 v35, v50, v51, v35
v_rcp_f32 v35, v35
s_nop 0
v_mul_f32 v37, v37, v35
v_and_b32_dpp v60, v85, v8 row_newbcast:1 row_mask:0xf bank_mask:0xf
v_and_b32_dpp v61, v85, v9 row_newbcast:1 row_mask:0xf bank_mask:0xf
v_and_b32_dpp v62, v85, v10 row_newbcast:1 row_mask:0xf bank_mask:0xf
v_and_b32_dpp v63, v85, v11 row_newbcast:1 row_mask:0xf bank_mask:0xf
v_and_b32_dpp v64, v85, v8 row_newbcast:5 row_mask:0xf bank_mask:0xf
v_and_b32_dpp v65, v85, v9 row_newbcast:5 row_mask:0xf bank_mask:0xf
v_and_b32_dpp v66, v85, v10 row_newbcast:5 row_mask:0xf bank_mask:0xf
v_and_b32_dpp v67, v85, v11 row_newbcast:5 row_mask:0xf bank_mask:0xf
v_and_b32_dpp v68, v85, v8 row_newbcast:9 row_mask:0xf bank_mask:0xf
v_and_b32_dpp v69, v85, v9 row_newbcast:9 row_mask:0xf bank_mask:0xf
v_and_b32_dpp v70, v85, v10 row_newbcast:9 row_mask:0xf bank_mask:0xf
v_and_b32_dpp v71, v85, v11 row_newbcast:9 row_mask:0xf bank_mask:0xf
v_and_b32_dpp v72, v85, v8 row_newbcast:13 row_mask:0xf bank_mask:0xf
v_and_b32_dpp v73, v85, v9 row_newbcast:13 row_mask:0xf bank_mask:0xf
v_and_b32_dpp v74, v85, v10 row_newbcast:13 row_mask:0xf bank_mask:0xf
v_and_b32_dpp v75, v85, v11 row_newbcast:13 row_mask:0xf bank_mask:0xf
s_waitcnt vmcnt(15)
v_mfma_f32_16x16x32_bf16 v[20:23], v[60:63], v[136:139], v[20:23]
v_mfma_f32_16x16x32_bf16 v[20:23], v[64:67], v[140:143], v[20:23]
v_mfma_f32_16x16x32_bf16 v[20:23], v[68:71], v[144:147], v[20:23]
v_mfma_f32_16x16x32_bf16 v[20:23], v[72:75], v[148:151], v[20:23]
v_add_u32 v117, 1, v117
buffer_store_dword v117, v118, s[64:67], 0 offen
buffer_load_dwordx4 v[200:203], v2, s[52:55], s12 offen offset:0 nt
buffer_load_dwordx4 v[204:207], v2, s[52:55], s12 offen offset:1024 nt
buffer_load_dwordx4 v[208:211], v2, s[52:55], s12 offen offset:2048 nt
buffer_load_dwordx4 v[212:215], v2, s[52:55], s12 offen offset:3072 nt
s_add_u32 s13, s13, 24576
s_min_u32 s12, s13, 2146435072
v_and_b32_dpp v60, v77, v8 row_newbcast:3 row_mask:0xf bank_mask:0xf
v_and_b32_dpp v61, v77, v9 row_newbcast:3 row_mask:0xf bank_mask:0xf
v_and_b32_dpp v62, v77, v10 row_newbcast:3 row_mask:0xf bank_mask:0xf
v_and_b32_dpp v63, v77, v11 row_newbcast:3 row_mask:0xf bank_mask:0xf
v_and_b32_dpp v64, v77, v8 row_newbcast:7 row_mask:0xf bank_mask:0xf
v_and_b32_dpp v65, v77, v9 row_newbcast:7 row_mask:0xf bank_mask:0xf
v_and_b32_dpp v66, v77, v10 row_newbcast:7 row_mask:0xf bank_mask:0xf
v_and_b32_dpp v67, v77, v11 row_newbcast:7 row_mask:0xf bank_mask:0xf
v_and_b32_dpp v68, v77, v8 row_newbcast:11 row_mask:0xf bank_mask:0xf
v_and_b32_dpp v69, v77, v9 row_newbcast:11 row_mask:0xf bank_mask:0xf
v_and_b32_dpp v70, v77, v10 row_newbcast:11 row_mask:0xf bank_mask:0xf
v_and_b32_dpp v71, v77, v11 row_newbcast:11 row_mask:0xf bank_mask:0xf
v_and_b32_dpp v72, v77, v8 row_newbcast:15 row_mask:0xf bank_mask:0xf
v_and_b32_dpp v73, v77, v9 row_newbcast:15 row_mask:0xf bank_mask:0xf
v_and_b32_dpp v74, v77, v10 row_newbcast:15 row_mask:0xf bank_mask:0xf
v_and_b32_dpp v75, v77, v11 row_newbcast:15 row_mask:0xf bank_mask:0xf
v_mfma_f32_16x16x32_bf16 v[20:23], v[60:63], a[240:243], v[20:23]
v_mfma_f32_16x16x32_bf16 v[20:23], v[64:67], a[244:247], v[20:23]
v_mfma_f32_16x16x32_bf16 v[20:23], v[68:71], a[248:251], v[20:23]
v_mfma_f32_16x16x32_bf16 v[20:23], v[72:75], a[252:255], v[20:23]
s_nop 3
v_and_b32_dpp v60, v85, v8 row_newbcast:2 row_mask:0xf bank_mask:0xf
v_and_b32_dpp v61, v85, v9 row_newbcast:2 row_mask:0xf bank_mask:0xf
v_and_b32_dpp v62, v85, v10 row_newbcast:2 row_mask:0xf bank_mask:0xf
v_and_b32_dpp v63, v85, v11 row_newbcast:2 row_mask:0xf bank_mask:0xf
v_and_b32_dpp v64, v85, v8 row_newbcast:6 row_mask:0xf bank_mask:0xf
v_and_b32_dpp v65, v85, v9 row_newbcast:6 row_mask:0xf bank_mask:0xf
v_and_b32_dpp v66, v85, v10 row_newbcast:6 row_mask:0xf bank_mask:0xf
v_and_b32_dpp v67, v85, v11 row_newbcast:6 row_mask:0xf bank_mask:0xf
v_and_b32_dpp v68, v85, v8 row_newbcast:10 row_mask:0xf bank_mask:0xf
v_and_b32_dpp v69, v85, v9 row_newbcast:10 row_mask:0xf bank_mask:0xf
v_and_b32_dpp v70, v85, v10 row_newbcast:10 row_mask:0xf bank_mask:0xf
v_and_b32_dpp v71, v85, v11 row_newbcast:10 row_mask:0xf bank_mask:0xf
v_and_b32_dpp v72, v85, v8 row_newbcast:14 row_mask:0xf bank_mask:0xf
v_and_b32_dpp v73, v85, v9 row_newbcast:14 row_mask:0xf bank_mask:0xf
v_and_b32_dpp v74, v85, v10 row_newbcast:14 row_mask:0xf bank_mask:0xf
v_and_b32_dpp v75, v85, v11 row_newbcast:14 row_mask:0xf bank_mask:0xf
s_waitcnt vmcnt(15)
v_mfma_f32_16x16x32_bf16 v[20:23], v[60:63], v[152:155], v[20:23]
v_mfma_f32_16x16x32_bf16 v[20:23], v[64:67], v[156:159], v[20:23]
v_mfma_f32_16x16x32_bf16 v[20:23], v[68:71], v[160:163], v[20:23]
v_mfma_f32_16x16x32_bf16 v[20:23], v[72:75], v[164:167], v[20:23]
v_add_u32 v117, 1, v117
buffer_store_dword v117, v118, s[64:67], 0 offen
buffer_load_dwordx4 v[216:219], v2, s[52:55], s12 offen offset:0 nt
buffer_load_dwordx4 v[220:223], v2, s[52:55], s12 offen offset:1024 nt
buffer_load_dwordx4 v[224:227], v2, s[52:55], s12 offen offset:2048 nt
buffer_load_dwordx4 v[228:231], v2, s[52:55], s12 offen offset:3072 nt
s_add_u32 s13, s13, 24576
s_min_u32 s12, s13, 2146435072
v_and_b32_dpp v60, v85, v8 row_newbcast:3 row_mask:0xf bank_mask:0xf
v_and_b32_dpp v61, v85, v9 row_newbcast:3 row_mask:0xf bank_mask:0xf
v_and_b32_dpp v62, v85, v10 row_newbcast:3 row_mask:0xf bank_mask:0xf
v_and_b32_dpp v63, v85, v11 row_newbcast:3 row_mask:0xf bank_mask:0xf
v_and_b32_dpp v64, v85, v8 row_newbcast:7 row_mask:0xf bank_mask:0xf
v_and_b32_dpp v65, v85, v9 row_newbcast:7 row_mask:0xf bank_mask:0xf
v_and_b32_dpp v66, v85, v10 row_newbcast:7 row_mask:0xf bank_mask:0xf
v_and_b32_dpp v67, v85, v11 row_newbcast:7 row_mask:0xf bank_mask:0xf
v_and_b32_dpp v68, v85, v8 row_newbcast:11 row_mask:0xf bank_mask:0xf
v_and_b32_dpp v69, v85, v9 row_newbcast:11 row_mask:0xf bank_mask:0xf
v_and_b32_dpp v70, v85, v10 row_newbcast:11 row_mask:0xf bank_mask:0xf
v_and_b32_dpp v71, v85, v11 row_newbcast:11 row_mask:0xf bank_mask:0xf
v_and_b32_dpp v72, v85, v8 row_newbcast:15 row_mask:0xf bank_mask:0xf
v_and_b32_dpp v73, v85, v9 row_newbcast:15 row_mask:0xf bank_mask:0xf
v_and_b32_dpp v74, v85, v10 row_newbcast:15 row_mask:0xf bank_mask:0xf
v_and_b32_dpp v75, v85, v11 row_newbcast:15 row_mask:0xf bank_mask:0xf
s_waitcnt vmcnt(15)
v_mfma_f32_16x16x32_bf16 v[20:23], v[60:63], v[168:171], v[20:23]
v_mfma_f32_16x16x32_bf16 v[20:23], v[64:67], v[172:175], v[20:23]
v_mfma_f32_16x16x32_bf16 v[20:23], v[68:71], v[176:179], v[20:23]
v_mfma_f32_16x16x32_bf16 v[20:23], v[72:75], v[180:183], v[20:23]
v_add_u32 v117, 1, v117
buffer_store_dword v117, v118, s[64:67], 0 offen
buffer_load_dwordx4 v[232:235], v2, s[52:55], s12 offen offset:0 nt
buffer_load_dwordx4 v[236:239], v2, s[52:55], s12 offen offset:1024 nt
buffer_load_dwordx4 v[240:243], v2, s[52:55], s12 offen offset:2048 nt
buffer_load_dwordx4 v[244:247], v2, s[52:55], s12 offen offset:3072 nt
s_add_u32 s13, s13, 24576
s_min_u32 s12, s13, 2146435072
v_and_b32_dpp v60, v86, v8 row_newbcast:0 row_mask:0xf bank_mask:0xf
v_and_b32_dpp v61, v86, v9 row_newbcast:0 row_mask:0xf bank_mask:0xf
v_and_b32_dpp v62, v86, v10 row_newbcast:0 row_mask:0xf bank_mask:0xf
v_and_b32_dpp v63, v86, v11 row_newbcast:0 row_mask:0xf bank_mask:0xf
v_and_b32_dpp v64, v86, v8 row_newbcast:4 row_mask:0xf bank_mask:0xf
v_and_b32_dpp v65, v86, v9 row_newbcast:4 row_mask:0xf bank_mask:0xf
v_and_b32_dpp v66, v86, v10 row_newbcast:4 row_mask:0xf bank_mask:0xf
v_and_b32_dpp v67, v86, v11 row_newbcast:4 row_mask:0xf bank_mask:0xf
v_and_b32_dpp v68, v86, v8 row_newbcast:8 row_mask:0xf bank_mask:0xf
v_and_b32_dpp v69, v86, v9 row_newbcast:8 row_mask:0xf bank_mask:0xf
v_and_b32_dpp v70, v86, v10 row_newbcast:8 row_mask:0xf bank_mask:0xf
v_and_b32_dpp v71, v86, v11 row_newbcast:8 row_mask:0xf bank_mask:0xf
v_and_b32_dpp v72, v86, v8 row_newbcast:12 row_mask:0xf bank_mask:0xf
v_and_b32_dpp v73, v86, v9 row_newbcast:12 row_mask:0xf bank_mask:0xf
v_and_b32_dpp v74, v86, v10 row_newbcast:12 row_mask:0xf bank_mask:0xf
v_and_b32_dpp v75, v86, v11 row_newbcast:12 row_mask:0xf bank_mask:0xf
s_waitcnt vmcnt(15)
v_mfma_f32_16x16x32_bf16 v[20:23], v[60:63], v[184:187], v[20:23]
v_mfma_f32_16x16x32_bf16 v[20:23], v[64:67], v[188:191], v[20:23]
v_mfma_f32_16x16x32_bf16 v[20:23], v[68:71], v[192:195], v[20:23]
v_mfma_f32_16x16x32_bf16 v[20:23], v[72:75], v[196:199], v[20:23]
s_nop 3
v_and_b32_dpp v60, v86, v8 row_newbcast:1 row_mask:0xf bank_mask:0xf
v_and_b32_dpp v61, v86, v9 row_newbcast:1 row_mask:0xf bank_mask:0xf
v_and_b32_dpp v62, v86, v10 row_newbcast:1 row_mask:0xf bank_mask:0xf
v_and_b32_dpp v63, v86, v11 row_newbcast:1 row_mask:0xf bank_mask:0xf
v_and_b32_dpp v64, v86, v8 row_newbcast:5 row_mask:0xf bank_mask:0xf
v_and_b32_dpp v65, v86, v9 row_newbcast:5 row_mask:0xf bank_mask:0xf
v_and_b32_dpp v66, v86, v10 row_newbcast:5 row_mask:0xf bank_mask:0xf
v_and_b32_dpp v67, v86, v11 row_newbcast:5 row_mask:0xf bank_mask:0xf
v_and_b32_dpp v68, v86, v8 row_newbcast:9 row_mask:0xf bank_mask:0xf
v_and_b32_dpp v69, v86, v9 row_newbcast:9 row_mask:0xf bank_mask:0xf
v_and_b32_dpp v70, v86, v10 row_newbcast:9 row_mask:0xf bank_mask:0xf
v_and_b32_dpp v71, v86, v11 row_newbcast:9 row_mask:0xf bank_mask:0xf
v_and_b32_dpp v72, v86, v8 row_newbcast:13 row_mask:0xf bank_mask:0xf
v_and_b32_dpp v73, v86, v9 row_newbcast:13 row_mask:0xf bank_mask:0xf
v_and_b32_dpp v74, v86, v10 row_newbcast:13 row_mask:0xf bank_mask:0xf
v_and_b32_dpp v75, v86, v11 row_newbcast:13 row_mask:0xf bank_mask:0xf
s_waitcnt vmcnt(10)
v_mfma_f32_16x16x32_bf16 v[20:23], v[60:63], v[200:203], v[20:23]
v_mfma_f32_16x16x32_bf16 v[20:23], v[64:67], v[204:207], v[20:23]
v_mfma_f32_16x16x32_bf16 v[20:23], v[68:71], v[208:211], v[20:23]
v_mfma_f32_16x16x32_bf16 v[20:23], v[72:75], v[212:215], v[20:23]
s_nop 3
v_and_b32_dpp v60, v86, v8 row_newbcast:2 row_mask:0xf bank_mask:0xf
v_and_b32_dpp v61, v86, v9 row_newbcast:2 row_mask:0xf bank_mask:0xf
v_and_b32_dpp v62, v86, v10 row_newbcast:2 row_mask:0xf bank_mask:0xf
v_and_b32_dpp v63, v86, v11 row_newbcast:2 row_mask:0xf bank_mask:0xf
v_and_b32_dpp v64, v86, v8 row_newbcast:6 row_mask:0xf bank_mask:0xf
v_and_b32_dpp v65, v86, v9 row_newbcast:6 row_mask:0xf bank_mask:0xf
v_and_b32_dpp v66, v86, v10 row_newbcast:6 row_mask:0xf bank_mask:0xf
v_and_b32_dpp v67, v86, v11 row_newbcast:6 row_mask:0xf bank_mask:0xf
v_and_b32_dpp v68, v86, v8 row_newbcast:10 row_mask:0xf bank_mask:0xf
v_and_b32_dpp v69, v86, v9 row_newbcast:10 row_mask:0xf bank_mask:0xf
v_and_b32_dpp v70, v86, v10 row_newbcast:10 row_mask:0xf bank_mask:0xf
v_and_b32_dpp v71, v86, v11 row_newbcast:10 row_mask:0xf bank_mask:0xf
v_and_b32_dpp v72, v86, v8 row_newbcast:14 row_mask:0xf bank_mask:0xf
v_and_b32_dpp v73, v86, v9 row_newbcast:14 row_mask:0xf bank_mask:0xf
v_and_b32_dpp v74, v86, v10 row_newbcast:14 row_mask:0xf bank_mask:0xf
v_and_b32_dpp v75, v86, v11 row_newbcast:14 row_mask:0xf bank_mask:0xf
v_and_b32_dpp v184, v86, v8 row_newbcast:3 row_mask:0xf bank_mask:0xf
v_and_b32_dpp v185, v86, v9 row_newbcast:3 row_mask:0xf bank_mask:0xf
v_and_b32_dpp v186, v86, v10 row_newbcast:3 row_mask:0xf bank_mask:0xf
v_and_b32_dpp v187, v86, v11 row_newbcast:3 row_mask:0xf bank_mask:0xf
v_and_b32_dpp v188, v86, v8 row_newbcast:7 row_mask:0xf bank_mask:0xf
v_and_b32_dpp v189, v86, v9 row_newbcast:7 row_mask:0xf bank_mask:0xf
v_and_b32_dpp v190, v86, v10 row_newbcast:7 row_mask:0xf bank_mask:0xf
v_and_b32_dpp v191, v86, v11 row_newbcast:7 row_mask:0xf bank_mask:0xf
v_and_b32_dpp v192, v86, v8 row_newbcast:11 row_mask:0xf bank_mask:0xf
v_and_b32_dpp v193, v86, v9 row_newbcast:11 row_mask:0xf bank_mask:0xf
v_and_b32_dpp v194, v86, v10 row_newbcast:11 row_mask:0xf bank_mask:0xf
v_and_b32_dpp v195, v86, v11 row_newbcast:11 row_mask:0xf bank_mask:0xf
v_and_b32_dpp v196, v86, v8 row_newbcast:15 row_mask:0xf bank_mask:0xf
v_and_b32_dpp v197, v86, v9 row_newbcast:15 row_mask:0xf bank_mask:0xf
v_and_b32_dpp v198, v86, v10 row_newbcast:15 row_mask:0xf bank_mask:0xf
v_and_b32_dpp v199, v86, v11 row_newbcast:15 row_mask:0xf bank_mask:0xf
s_waitcnt vmcnt(5)
v_mfma_f32_16x16x32_bf16 v[20:23], v[60:63], v[216:219], v[20:23]
v_mfma_f32_16x16x32_bf16 v[20:23], v[64:67], v[220:223], v[20:23]
v_mfma_f32_16x16x32_bf16 v[20:23], v[68:71], v[224:227], v[20:23]
v_mfma_f32_16x16x32_bf16 v[20:23], v[72:75], v[228:231], v[20:23]
s_waitcnt vmcnt(3)
v_mfma_f32_16x16x32_bf16 v[20:23], v[184:187], v[232:235], v[20:23]
s_waitcnt vmcnt(2)
v_mfma_f32_16x16x32_bf16 v[20:23], v[188:191], v[236:239], v[20:23]
s_waitcnt vmcnt(1)
v_mfma_f32_16x16x32_bf16 v[20:23], v[192:195], v[240:243], v[20:23]
s_waitcnt vmcnt(0)
v_mfma_f32_16x16x32_bf16 v[20:23], v[196:199], v[244:247], v[20:23]
A_tail:
s_nop 7
v_mul_f32 v20, v20, v37
v_mul_f32 v21, v21, v37
v_mul_f32 v22, v22, v37
v_mul_f32 v23, v23, v37
v_cvt_pk_bf16_f32 v28, v20, v21
v_cvt_pk_bf16_f32 v29, v22, v23
ds_write_b64 v94, v[28:29]
s_waitcnt lgkmcnt(0)
s_barrier
ds_read_b128 a[0:3], v95 offset:0
ds_read_b128 a[4:7], v95 offset:64
ds_read_b128 a[8:11], v95 offset:128
ds_read_b128 a[12:15], v95 offset:192
s_waitcnt lgkmcnt(0)
v_mfma_f32_16x16x32_bf16 v[72:75], a[0:3], a[224:227], 0
v_mfma_f32_16x16x32_bf16 v[72:75], a[4:7], a[228:231], v[72:75]
v_mfma_f32_16x16x32_bf16 v[72:75], a[8:11], a[232:235], v[72:75]
v_mfma_f32_16x16x32_bf16 v[72:75], a[12:15], a[236:239], v[72:75]
v_mfma_f32_16x16x32_bf16 v[40:43], a[0:3], a[96:99], 0
v_mfma_f32_16x16x32_bf16 v[40:43], a[4:7], a[100:103], v[40:43]
v_mfma_f32_16x16x32_bf16 v[40:43], a[8:11], a[104:107], v[40:43]
v_mfma_f32_16x16x32_bf16 v[40:43], a[12:15], a[108:111], v[40:43]
v_mfma_f32_16x16x32_bf16 v[44:47], a[0:3], a[112:115], 0
v_mfma_f32_16x16x32_bf16 v[44:47], a[4:7], a[116:119], v[44:47]
v_mfma_f32_16x16x32_bf16 v[44:47], a[8:11], a[120:123], v[44:47]
v_mfma_f32_16x16x32_bf16 v[44:47], a[12:15], a[124:127], v[44:47]
v_mul_f32 v114, v106, v72
v_fma_f32 v114, v107, v73, v114
v_fma_f32 v114, v108, v74, v114
v_fma_f32 v114, v109, v75, v114
v_mfma_f32_16x16x32_bf16 v[48:51], a[0:3], a[128:131], 0
v_mfma_f32_16x16x32_bf16 v[48:51], a[4:7], a[132:135], v[48:51]
v_mfma_f32_16x16x32_bf16 v[48:51], a[8:11], a[136:139], v[48:51]
v_mfma_f32_16x16x32_bf16 v[48:51], a[12:15], a[140:143], v[48:51]
v_min_u32 v114, -2, v114
s_mov_b64 exec, 0xffffffff
buffer_store_dword v114, v93, s[64:67], 0 offen offset:512 sc1
s_mov_b64 exec, -1
v_mul_f32 v110, v98, v40
v_fma_f32 v110, v99, v41, v110
v_fma_f32 v110, v100, v42, v110
v_fma_f32 v110, v101, v43, v110
v_mfma_f32_16x16x32_bf16 v[52:55], a[0:3], a[144:147], 0
v_mfma_f32_16x16x32_bf16 v[52:55], a[4:7], a[148:151], v[52:55]
v_mfma_f32_16x16x32_bf16 v[52:55], a[8:11], a[152:155], v[52:55]
v_mfma_f32_16x16x32_bf16 v[52:55], a[12:15], a[156:159], v[52:55]
v_mul_f32 v111, v98, v44
v_fma_f32 v111, v99, v45, v111
v_fma_f32 v111, v100, v46, v111
v_fma_f32 v111, v101, v47, v111
v_mfma_f32_16x16x32_bf16 v[56:59], a[0:3], a[160:163], 0
v_mfma_f32_16x16x32_bf16 v[56:59], a[4:7], a[164:167], v[56:59]
v_mfma_f32_16x16x32_bf16 v[56:59], a[8:11], a[168:171], v[56:59]
v_mfma_f32_16x16x32_bf16 v[56:59], a[12:15], a[172:175], v[56:59]
v_mul_f32 v112, v98, v48
v_fma_f32 v112, v99, v49, v112
v_fma_f32 v112, v100, v50, v112
v_fma_f32 v112, v101, v51, v112
v_mfma_f32_16x16x32_bf16 v[60:63], a[0:3], a[176:179], 0
v_mfma_f32_16x16x32_bf16 v[60:63], a[4:7], a[180:183], v[60:63]
v_mfma_f32_16x16x32_bf16 v[60:63], a[8:11], a[184:187], v[60:63]
v_mfma_f32_16x16x32_bf16 v[60:63], a[12:15], a[188:191], v[60:63]
v_mul_f32 v113, v98, v52
v_fma_f32 v113, v99, v53, v113
v_fma_f32 v113, v100, v54, v113
v_fma_f32 v113, v101, v55, v113
v_mfma_f32_16x16x32_bf16 v[64:67], a[0:3], a[192:195], 0
v_mfma_f32_16x16x32_bf16 v[64:67], a[4:7], a[196:199], v[64:67]
v_mfma_f32_16x16x32_bf16 v[64:67], a[8:11], a[200:203], v[64:67]
v_mfma_f32_16x16x32_bf16 v[64:67], a[12:15], a[204:207], v[64:67]
v_fma_f32 v110, v102, v56, v110
v_fma_f32 v110, v103, v57, v110
v_fma_f32 v110, v104, v58, v110
v_fma_f32 v110, v105, v59, v110
v_mfma_f32_16x16x32_bf16 v[68:71], a[0:3], a[208:211], 0
v_mfma_f32_16x16x32_bf16 v[68:71], a[4:7], a[212:215], v[68:71]
v_mfma_f32_16x16x32_bf16 v[68:71], a[8:11], a[216:219], v[68:71]
v_mfma_f32_16x16x32_bf16 v[68:71], a[12:15], a[220:223], v[68:71]
v_fma_f32 v111, v102, v60, v111
v_fma_f32 v111, v103, v61, v111
v_fma_f32 v111, v104, v62, v111
v_fma_f32 v111, v105, v63, v111
v_fma_f32 v112, v102, v64, v112
v_fma_f32 v112, v103, v65, v112
v_fma_f32 v112, v104, v66, v112
v_fma_f32 v112, v105, v67, v112
v_min_u32 v110, -2, v110
v_min_u32 v111, -2, v111
v_min_u32 v112, -2, v112
v_fma_f32 v113, v102, v68, v113
v_fma_f32 v113, v103, v69, v113
v_fma_f32 v113, v104, v70, v113
v_fma_f32 v113, v105, v71, v113
v_min_u32 v113, -2, v113
buffer_store_dwordx4 v[110:113], v92, s[64:67], 0 offen sc1
s_endpgm
L_exit:
s_endpgm
B_role:
s_mov_b32 s8, s5
s_lshl_b32 s9, s4, 1
s_add_u32 s9, s9, s8
s_lshr_b32 s10, s9, 4
s_and_b32 s11, s9, 15
v_and_b32 v1, 63, v0
v_lshlrev_b32 v2, 4, v1
v_lshrrev_b32 v9, 4, v1
v_and_b32 v8, 15, v1
s_waitcnt lgkmcnt(0)
s_mul_i32 s6, s3, 288
s_sub_u32 s7, 4608, s6
s_add_u32 s44, s26, s6
s_addc_u32 s45, s27, 0
s_mov_b32 s46, s7
s_mov_b32 s47, 0x20000
s_mul_i32 s6, s3, 1179648
s_lshl_b32 s7, s4, 8
s_add_u32 s6, s6, s7
s_sub_u32 s7, 4718592, s6
s_add_u32 s48, s30, s6
s_addc_u32 s49, s31, 0
s_mov_b32 s50, s7
s_mov_b32 s51, 0x20000
s_lshl_b32 s6, s8, 2
s_add_u32 s6, s6, s3
s_lshl_b32 s6, s6, 19
s_lshl_b32 s7, s4, 8
s_add_u32 s6, s6, s7
s_sub_u32 s7, 4194304, s6
s_add_u32 s76, s32, s6
s_addc_u32 s77, s33, 0
s_mov_b32 s78, s7
s_mov_b32 s79, 0x20000
s_lshl_b32 s6, s10, 22
s_add_u32 s52, s28, s6
s_addc_u32 s53, s29, 0
s_mov_b32 s54, 4194304
s_mov_b32 s55, 0x20000
v_mul_u32_u24 v3, 294912, v9
v_lshl_add_u32 v3, v8, 4, v3
v_mul_u32_u24 v4, 72, v9
v_lshrrev_b32 v6, 3, v8
v_mul_u32_u24 v6, 1152, v6
v_add_u32 v4, v4, v6
v_lshlrev_b32 v220, 17, v9
v_lshl_add_u32 v220, v8, 4, v220
v_xor_b32 v10, 32, v2
s_mov_b32 s64, s42
s_mov_b32 s65, s43
s_mov_b32 s66, 6291456
s_mov_b32 s67, 0x20000
buffer_load_dwordx4 v[24:27], v4, s[44:47], 0 offen offset:0
buffer_load_dwordx4 v[28:31], v4, s[44:47], 0 offen offset:16
buffer_load_dwordx4 v[32:35], v4, s[44:47], 0 offen offset:32
buffer_load_dwordx4 v[36:39], v4, s[44:47], 0 offen offset:48
buffer_load_dwordx2 v[40:41], v4, s[44:47], 0 offen offset:64
buffer_load_dwordx4 v[42:45], v4, s[44:47], 0 offen offset:2304
buffer_load_dwordx4 v[46:49], v4, s[44:47], 0 offen offset:2320
buffer_load_dwordx4 v[50:53], v4, s[44:47], 0 offen offset:2336
buffer_load_dwordx4 v[54:57], v4, s[44:47], 0 offen offset:2352
buffer_load_dwordx2 v[58:59], v4, s[44:47], 0 offen offset:2368
s_cmp_ge_u32 s3, 2
s_cbranch_scc1 L_noclr_13
v_mov_b32 v188, -1
v_mov_b32 v189, -1
v_mov_b32 v190, -1
v_mov_b32 v191, -1
s_cmp_eq_u32 s3, 1
s_cbranch_scc1 L_clr1_14
v_lshrrev_b32 v5, 5, v1
v_lshlrev_b32 v5, 15, v5
v_and_b32 v6, 31, v1
v_lshl_add_u32 v5, v6, 4, v5
s_lshl_b32 s6, s9, 9
s_add_u32 s7, s6, 65536
s_add_u32 s6, s6, 0
buffer_store_dwordx4 v[188:191], v5, s[64:67], s6 offen sc1
buffer_store_dwordx4 v[188:191], v5, s[64:67], s7 offen sc1
s_add_u32 s6, s6, 262144
s_mov_b64 exec, 0xffffffff
buffer_store_dwordx4 v[188:191], v2, s[64:67], s6 offen sc1
s_lshl_b32 s6, s9, 7
s_add_u32 s6, s6, 327680
s_mov_b64 exec, 0xff
buffer_store_dwordx4 v[188:191], v2, s[64:67], s6 offen sc1
s_mul_i32 s6, s9, 16
s_add_u32 s6, s6, 393216
s_mov_b32 exec_lo, 1
s_mov_b32 exec_hi, 0
buffer_store_dwordx4 v[188:191], v5, s[64:67], s6 offen sc1
s_mov_b64 exec, -1
L_clr1_14:
s_mul_i32 s6, s9, 9216
s_mul_i32 s7, s3, 1048576
s_add_u32 s6, s6, s7
s_add_u32 s6, s6, 4194304
buffer_store_dwordx4 v[188:191], v2, s[64:67], s6 offen offset:0 sc1
buffer_store_dwordx4 v[188:191], v2, s[64:67], s6 offen offset:1024 sc1
buffer_store_dwordx4 v[188:191], v2, s[64:67], s6 offen offset:2048 sc1
buffer_store_dwordx4 v[188:191], v2, s[64:67], s6 offen offset:3072 sc1
s_add_u32 s6, s6, 4096
buffer_store_dwordx4 v[188:191], v2, s[64:67], s6 offen offset:0 sc1
buffer_store_dwordx4 v[188:191], v2, s[64:67], s6 offen offset:1024 sc1
buffer_store_dwordx4 v[188:191], v2, s[64:67], s6 offen offset:2048 sc1
buffer_store_dwordx4 v[188:191], v2, s[64:67], s6 offen offset:3072 sc1
s_add_u32 s6, s6, 4096
buffer_store_dwordx4 v[188:191], v2, s[64:67], s6 offen offset:0 sc1
L_noclr_13:
s_mov_b32 s6, 0
buffer_load_dwordx4 a[96:99], v3, s[48:51], s6 offen
s_mov_b32 s6, 8192
buffer_load_dwordx4 a[100:103], v3, s[48:51], s6 offen
s_mov_b32 s6, 16384
buffer_load_dwordx4 a[104:107], v3, s[48:51], s6 offen
s_mov_b32 s6, 24576
buffer_load_dwordx4 a[108:111], v3, s[48:51], s6 offen
s_mov_b32 s6, 32768
buffer_load_dwordx4 a[112:115], v3, s[48:51], s6 offen
s_mov_b32 s6, 40960
buffer_load_dwordx4 a[116:119], v3, s[48:51], s6 offen
s_mov_b32 s6, 49152
buffer_load_dwordx4 a[120:123], v3, s[48:51], s6 offen
s_mov_b32 s6, 57344
buffer_load_dwordx4 a[124:127], v3, s[48:51], s6 offen
s_mov_b32 s6, 65536
buffer_load_dwordx4 a[128:131], v3, s[48:51], s6 offen
s_mov_b32 s6, 73728
buffer_load_dwordx4 a[132:135], v3, s[48:51], s6 offen
s_mov_b32 s6, 81920
buffer_load_dwordx4 a[136:139], v3, s[48:51], s6 offen
s_mov_b32 s6, 90112
buffer_load_dwordx4 a[140:143], v3, s[48:51], s6 offen
s_mov_b32 s6, 98304
buffer_load_dwordx4 a[144:147], v3, s[48:51], s6 offen
s_mov_b32 s6, 106496
buffer_load_dwordx4 a[148:151], v3, s[48:51], s6 offen
s_mov_b32 s6, 114688
buffer_load_dwordx4 a[152:155], v3, s[48:51], s6 offen
s_mov_b32 s6, 122880
buffer_load_dwordx4 a[156:159], v3, s[48:51], s6 offen
s_mov_b32 s6, 131072
buffer_load_dwordx4 a[160:163], v3, s[48:51], s6 offen
s_mov_b32 s6, 139264
buffer_load_dwordx4 a[164:167], v3, s[48:51], s6 offen
s_mov_b32 s6, 147456
buffer_load_dwordx4 a[168:171], v3, s[48:51], s6 offen
s_mov_b32 s6, 155648
buffer_load_dwordx4 a[172:175], v3, s[48:51], s6 offen
s_mov_b32 s6, 163840
buffer_load_dwordx4 a[176:179], v3, s[48:51], s6 offen
s_mov_b32 s6, 172032
buffer_load_dwordx4 a[180:183], v3, s[48:51], s6 offen
s_mov_b32 s6, 180224
buffer_load_dwordx4 a[184:187], v3, s[48:51], s6 offen
s_mov_b32 s6, 188416
buffer_load_dwordx4 a[188:191], v3, s[48:51], s6 offen
s_mov_b32 s6, 196608
buffer_load_dwordx4 a[192:195], v3, s[48:51], s6 offen
s_mov_b32 s6, 204800
buffer_load_dwordx4 a[196:199], v3, s[48:51], s6 offen
s_mov_b32 s6, 212992
buffer_load_dwordx4 a[200:203], v3, s[48:51], s6 offen
s_mov_b32 s6, 221184
buffer_load_dwordx4 a[204:207], v3, s[48:51], s6 offen
s_mov_b32 s6, 229376
buffer_load_dwordx4 a[208:211], v3, s[48:51], s6 offen
s_mov_b32 s6, 237568
buffer_load_dwordx4 a[212:215], v3, s[48:51], s6 offen
s_mov_b32 s6, 245760
buffer_load_dwordx4 a[216:219], v3, s[48:51], s6 offen
s_mov_b32 s6, 253952
buffer_load_dwordx4 a[220:223], v3, s[48:51], s6 offen
s_mov_b32 s6, 262144
buffer_load_dwordx4 a[224:227], v3, s[48:51], s6 offen
s_mov_b32 s6, 270336
buffer_load_dwordx4 a[228:231], v3, s[48:51], s6 offen
s_mov_b32 s6, 278528
buffer_load_dwordx4 a[232:235], v3, s[48:51], s6 offen
s_mov_b32 s6, 286720
buffer_load_dwordx4 a[236:239], v3, s[48:51], s6 offen
s_mov_b32 s6, 0
buffer_load_dwordx4 v[84:87], v220, s[76:79], s6 offen nt
s_mov_b32 s6, 8192
buffer_load_dwordx4 v[88:91], v220, s[76:79], s6 offen nt
s_mov_b32 s6, 16384
buffer_load_dwordx4 v[92:95], v220, s[76:79], s6 offen nt
s_mov_b32 s68, s40
s_mov_b32 s69, s41
s_mov_b32 s70, 256
s_mov_b32 s71, 0x20000
s_mov_b32 s72, s38
s_mov_b32 s73, s39
s_mov_b32 s74, 9216
s_mov_b32 s75, 0x20000
v_and_b32 v5, 1, v1
v_lshlrev_b32 v5, 4, v5
v_mov_b32 v6, 0xffff
v_lshlrev_b32 v5, v5, v6
v_bfe_u32 v6, v1, 1, 2
v_cmp_eq_u32 vcc, 0, v6
s_nop 1
v_cndmask_b32 v12, 0, v5, vcc
v_cmp_eq_u32 vcc, 1, v6
s_nop 1
v_cndmask_b32 v13, 0, v5, vcc
v_cmp_eq_u32 vcc, 2, v6
s_nop 1
v_cndmask_b32 v14, 0, v5, vcc
v_cmp_eq_u32 vcc, 3, v6
s_nop 1
v_cndmask_b32 v15, 0, v5, vcc
v_mov_b32 v5, 0x0c0c0c0c
s_mov_b32 s6, 0x01000100
s_mov_b32 s7, 0x03020302
v_bfi_b32 v16, v12, s6, v5
v_bfi_b32 v17, v13, s6, v5
v_bfi_b32 v18, v14, s6, v5
v_bfi_b32 v19, v15, s6, v5
v_bfi_b32 v20, v12, s7, v5
v_bfi_b32 v21, v13, s7, v5
v_bfi_b32 v22, v14, s7, v5
v_bfi_b32 v23, v15, s7, v5
s_mul_i32 s12, s3, 17408
s_lshl_b32 s13, s3, 14
s_lshl_b32 s6, s11, 16
s_add_u32 s13, s13, s6
s_lshr_b32 s13, s13, 2
s_waitcnt vmcnt(38)
s_cmp_ge_u32 s3, 2
s_cbranch_scc1 L_sig0_15
v_mov_b32 v7, 1
s_mov_b64 exec, 1
buffer_atomic_add v7, off, s[68:71], 0 offset:0
s_mov_b64 exec, -1
L_sig0_15:
s_mov_b32 s6, 24576
buffer_load_dwordx4 v[96:99], v220, s[76:79], s6 offen nt
s_mov_b32 s6, 32768
buffer_load_dwordx4 v[100:103], v220, s[76:79], s6 offen nt
s_mov_b32 s6, 40960
buffer_load_dwordx4 v[104:107], v220, s[76:79], s6 offen nt
s_mov_b32 s6, 49152
buffer_load_dwordx4 v[108:111], v220, s[76:79], s6 offen nt
s_mov_b32 s6, 57344
buffer_load_dwordx4 v[112:115], v220, s[76:79], s6 offen nt
s_mov_b32 s6, 65536
buffer_load_dwordx4 v[116:119], v220, s[76:79], s6 offen nt
s_mov_b32 s6, 73728
buffer_load_dwordx4 v[120:123], v220, s[76:79], s6 offen nt
s_mov_b32 s6, 81920
buffer_load_dwordx4 v[124:127], v220, s[76:79], s6 offen nt
s_mov_b32 s6, 90112
buffer_load_dwordx4 v[128:131], v220, s[76:79], s6 offen nt
s_mov_b32 s6, 98304
buffer_load_dwordx4 v[132:135], v220, s[76:79], s6 offen nt
s_mov_b32 s6, 106496
buffer_load_dwordx4 v[136:139], v220, s[76:79], s6 offen nt
s_mov_b32 s6, 114688
buffer_load_dwordx4 v[140:143], v220, s[76:79], s6 offen nt
s_mov_b32 s6, 122880
buffer_load_dwordx4 v[144:147], v220, s[76:79], s6 offen nt
v_perm_b32 v60, v24, v24, v16
v_perm_b32 v61, v24, v24, v17
v_perm_b32 v62, v24, v24, v18
v_perm_b32 v63, v24, v24, v19
s_nop 1
v_mfma_f32_16x16x32_bf16 v[76:79], v[60:63], a[96:99], 0
v_perm_b32 v64, v42, v42, v16
v_perm_b32 v65, v42, v42, v17
v_perm_b32 v66, v42, v42, v18
v_perm_b32 v67, v42, v42, v19
s_nop 1
v_mfma_f32_16x16x32_bf16 v[80:83], v[64:67], a[96:99], 0
s_add_u32 m0, s12, 0
s_add_u32 s6, s13, 0
buffer_load_dwordx4 v2, s[52:55], s6 offen nt lds
s_waitcnt vmcnt(51)
v_perm_b32 v68, v24, v24, v20
v_perm_b32 v69, v24, v24, v21
v_perm_b32 v70, v24, v24, v22
v_perm_b32 v71, v24, v24, v23
s_nop 1
v_mfma_f32_16x16x32_bf16 v[76:79], v[68:71], a[100:103], v[76:79]
v_perm_b32 v72, v42, v42, v20
v_perm_b32 v73, v42, v42, v21
v_perm_b32 v74, v42, v42, v22
v_perm_b32 v75, v42, v42, v23
s_nop 1
v_mfma_f32_16x16x32_bf16 v[80:83], v[72:75], a[100:103], v[80:83]
s_add_u32 m0, s12, 1088
s_add_u32 s6, s13, 1024
buffer_load_dwordx4 v2, s[52:55], s6 offen nt lds
s_waitcnt vmcnt(51)
v_perm_b32 v60, v25, v25, v16
v_perm_b32 v61, v25, v25, v17
v_perm_b32 v62, v25, v25, v18
v_perm_b32 v63, v25, v25, v19
s_nop 1
v_mfma_f32_16x16x32_bf16 v[76:79], v[60:63], a[104:107], v[76:79]
v_perm_b32 v64, v43, v43, v16
v_perm_b32 v65, v43, v43, v17
v_perm_b32 v66, v43, v43, v18
v_perm_b32 v67, v43, v43, v19
s_nop 1
v_mfma_f32_16x16x32_bf16 v[80:83], v[64:67], a[104:107], v[80:83]
s_add_u32 m0, s12, 2176
s_add_u32 s6, s13, 2048
buffer_load_dwordx4 v2, s[52:55], s6 offen nt lds
s_waitcnt vmcnt(51)
v_perm_b32 v68, v25, v25, v20
v_perm_b32 v69, v25, v25, v21
v_perm_b32 v70, v25, v25, v22
v_perm_b32 v71, v25, v25, v23
s_nop 1
v_mfma_f32_16x16x32_bf16 v[76:79], v[68:71], a[108:111], v[76:79]
v_perm_b32 v72, v43, v43, v20
v_perm_b32 v73, v43, v43, v21
v_perm_b32 v74, v43, v43, v22
v_perm_b32 v75, v43, v43, v23
s_nop 1
v_mfma_f32_16x16x32_bf16 v[80:83], v[72:75], a[108:111], v[80:83]
s_add_u32 m0, s12, 3264
s_add_u32 s6, s13, 3072
buffer_load_dwordx4 v2, s[52:55], s6 offen nt lds
s_waitcnt vmcnt(51)
v_perm_b32 v60, v26, v26, v16
v_perm_b32 v61, v26, v26, v17
v_perm_b32 v62, v26, v26, v18
v_perm_b32 v63, v26, v26, v19
s_nop 1
v_mfma_f32_16x16x32_bf16 v[76:79], v[60:63], a[112:115], v[76:79]
v_perm_b32 v64, v44, v44, v16
v_perm_b32 v65, v44, v44, v17
v_perm_b32 v66, v44, v44, v18
v_perm_b32 v67, v44, v44, v19
s_nop 1
v_mfma_f32_16x16x32_bf16 v[80:83], v[64:67], a[112:115], v[80:83]
s_add_u32 m0, s12, 4352
s_add_u32 s6, s13, 262144
buffer_load_dwordx4 v2, s[52:55], s6 offen nt lds
s_waitcnt vmcnt(51)
v_perm_b32 v68, v26, v26, v20
v_perm_b32 v69, v26, v26, v21
v_perm_b32 v70, v26, v26, v22
v_perm_b32 v71, v26, v26, v23
s_nop 1
v_mfma_f32_16x16x32_bf16 v[76:79], v[68:71], a[116:119], v[76:79]
v_perm_b32 v72, v44, v44, v20
v_perm_b32 v73, v44, v44, v21
v_perm_b32 v74, v44, v44, v22
v_perm_b32 v75, v44, v44, v23
s_nop 1
v_mfma_f32_16x16x32_bf16 v[80:83], v[72:75], a[116:119], v[80:83]
s_add_u32 m0, s12, 5440
s_add_u32 s6, s13, 263168
buffer_load_dwordx4 v2, s[52:55], s6 offen nt lds
s_waitcnt vmcnt(51)
v_perm_b32 v60, v27, v27, v16
v_perm_b32 v61, v27, v27, v17
v_perm_b32 v62, v27, v27, v18
v_perm_b32 v63, v27, v27, v19
s_nop 1
v_mfma_f32_16x16x32_bf16 v[76:79], v[60:63], a[120:123], v[76:79]
v_perm_b32 v64, v45, v45, v16
v_perm_b32 v65, v45, v45, v17
v_perm_b32 v66, v45, v45, v18
v_perm_b32 v67, v45, v45, v19
s_nop 1
v_mfma_f32_16x16x32_bf16 v[80:83], v[64:67], a[120:123], v[80:83]
s_add_u32 m0, s12, 6528
s_add_u32 s6, s13, 264192
buffer_load_dwordx4 v2, s[52:55], s6 offen nt lds
s_waitcnt vmcnt(51)
v_perm_b32 v68, v27, v27, v20
v_perm_b32 v69, v27, v27, v21
v_perm_b32 v70, v27, v27, v22
v_perm_b32 v71, v27, v27, v23
s_nop 1
v_mfma_f32_16x16x32_bf16 v[76:79], v[68:71], a[124:127], v[76:79]
v_perm_b32 v72, v45, v45, v20
v_perm_b32 v73, v45, v45, v21
v_perm_b32 v74, v45, v45, v22
v_perm_b32 v75, v45, v45, v23
s_nop 1
v_mfma_f32_16x16x32_bf16 v[80:83], v[72:75], a[124:127], v[80:83]
s_add_u32 m0, s12, 7616
s_add_u32 s6, s13, 265216
buffer_load_dwordx4 v2, s[52:55], s6 offen nt lds
s_waitcnt vmcnt(51)
v_perm_b32 v60, v28, v28, v16
v_perm_b32 v61, v28, v28, v17
v_perm_b32 v62, v28, v28, v18
v_perm_b32 v63, v28, v28, v19
s_nop 1
v_mfma_f32_16x16x32_bf16 v[76:79], v[60:63], a[128:131], v[76:79]
v_perm_b32 v64, v46, v46, v16
v_perm_b32 v65, v46, v46, v17
v_perm_b32 v66, v46, v46, v18
v_perm_b32 v67, v46, v46, v19
s_nop 1
v_mfma_f32_16x16x32_bf16 v[80:83], v[64:67], a[128:131], v[80:83]
s_add_u32 m0, s12, 8704
s_add_u32 s6, s13, 524288
buffer_load_dwordx4 v10, s[52:55], s6 offen nt lds
s_waitcnt vmcnt(51)
v_perm_b32 v68, v28, v28, v20
v_perm_b32 v69, v28, v28, v21
v_perm_b32 v70, v28, v28, v22
v_perm_b32 v71, v28, v28, v23
s_nop 1
v_mfma_f32_16x16x32_bf16 v[76:79], v[68:71], a[132:135], v[76:79]
v_perm_b32 v72, v46, v46, v20
v_perm_b32 v73, v46, v46, v21
v_perm_b32 v74, v46, v46, v22
v_perm_b32 v75, v46, v46, v23
s_nop 1
v_mfma_f32_16x16x32_bf16 v[80:83], v[72:75], a[132:135], v[80:83]
s_add_u32 m0, s12, 9792
s_add_u32 s6, s13, 525312
buffer_load_dwordx4 v10, s[52:55], s6 offen nt lds
s_waitcnt vmcnt(51)
v_perm_b32 v60, v29, v29, v16
v_perm_b32 v61, v29, v29, v17
v_perm_b32 v62, v29, v29, v18
v_perm_b32 v63, v29, v29, v19
s_nop 1
v_mfma_f32_16x16x32_bf16 v[76:79], v[60:63], a[136:139], v[76:79]
v_perm_b32 v64, v47, v47, v16
v_perm_b32 v65, v47, v47, v17
v_perm_b32 v66, v47, v47, v18
v_perm_b32 v67, v47, v47, v19
s_nop 1
v_mfma_f32_16x16x32_bf16 v[80:83], v[64:67], a[136:139], v[80:83]
s_add_u32 m0, s12, 10880
s_add_u32 s6, s13, 526336
buffer_load_dwordx4 v10, s[52:55], s6 offen nt lds
s_waitcnt vmcnt(51)
v_perm_b32 v68, v29, v29, v20
v_perm_b32 v69, v29, v29, v21
v_perm_b32 v70, v29, v29, v22
v_perm_b32 v71, v29, v29, v23
s_nop 1
v_mfma_f32_16x16x32_bf16 v[76:79], v[68:71], a[140:143], v[76:79]
v_perm_b32 v72, v47, v47, v20
v_perm_b32 v73, v47, v47, v21
v_perm_b32 v74, v47, v47, v22
v_perm_b32 v75, v47, v47, v23
s_nop 1
v_mfma_f32_16x16x32_bf16 v[80:83], v[72:75], a[140:143], v[80:83]
s_add_u32 m0, s12, 11968
s_add_u32 s6, s13, 527360
buffer_load_dwordx4 v10, s[52:55], s6 offen nt lds
s_waitcnt vmcnt(51)
v_perm_b32 v60, v30, v30, v16
v_perm_b32 v61, v30, v30, v17
v_perm_b32 v62, v30, v30, v18
v_perm_b32 v63, v30, v30, v19
s_nop 1
v_mfma_f32_16x16x32_bf16 v[76:79], v[60:63], a[144:147], v[76:79]
v_perm_b32 v64, v48, v48, v16
v_perm_b32 v65, v48, v48, v17
v_perm_b32 v66, v48, v48, v18
v_perm_b32 v67, v48, v48, v19
s_nop 1
v_mfma_f32_16x16x32_bf16 v[80:83], v[64:67], a[144:147], v[80:83]
s_add_u32 m0, s12, 13056
s_add_u32 s6, s13, 786432
buffer_load_dwordx4 v10, s[52:55], s6 offen nt lds
s_waitcnt vmcnt(51)
v_perm_b32 v68, v30, v30, v20
v_perm_b32 v69, v30, v30, v21
v_perm_b32 v70, v30, v30, v22
v_perm_b32 v71, v30, v30, v23
s_nop 1
v_mfma_f32_16x16x32_bf16 v[76:79], v[68:71], a[148:151], v[76:79]
v_perm_b32 v72, v48, v48, v20
v_perm_b32 v73, v48, v48, v21
v_perm_b32 v74, v48, v48, v22
v_perm_b32 v75, v48, v48, v23
s_nop 1
v_mfma_f32_16x16x32_bf16 v[80:83], v[72:75], a[148:151], v[80:83]
s_add_u32 m0, s12, 14144
s_add_u32 s6, s13, 787456
buffer_load_dwordx4 v10, s[52:55], s6 offen nt lds
s_waitcnt vmcnt(51)
v_perm_b32 v60, v31, v31, v16
v_perm_b32 v61, v31, v31, v17
v_perm_b32 v62, v31, v31, v18
v_perm_b32 v63, v31, v31, v19
s_nop 1
v_mfma_f32_16x16x32_bf16 v[76:79], v[60:63], a[152:155], v[76:79]
v_perm_b32 v64, v49, v49, v16
v_perm_b32 v65, v49, v49, v17
v_perm_b32 v66, v49, v49, v18
v_perm_b32 v67, v49, v49, v19
s_nop 1
v_mfma_f32_16x16x32_bf16 v[80:83], v[64:67], a[152:155], v[80:83]
s_add_u32 m0, s12, 15232
s_add_u32 s6, s13, 788480
buffer_load_dwordx4 v10, s[52:55], s6 offen nt lds
s_waitcnt vmcnt(51)
v_perm_b32 v68, v31, v31, v20
v_perm_b32 v69, v31, v31, v21
v_perm_b32 v70, v31, v31, v22
v_perm_b32 v71, v31, v31, v23
s_nop 1
v_mfma_f32_16x16x32_bf16 v[76:79], v[68:71], a[156:159], v[76:79]
v_perm_b32 v72, v49, v49, v20
v_perm_b32 v73, v49, v49, v21
v_perm_b32 v74, v49, v49, v22
v_perm_b32 v75, v49, v49, v23
s_nop 1
v_mfma_f32_16x16x32_bf16 v[80:83], v[72:75], a[156:159], v[80:83]
s_add_u32 m0, s12, 16320
s_add_u32 s6, s13, 789504
buffer_load_dwordx4 v10, s[52:55], s6 offen nt lds
s_waitcnt vmcnt(51)
v_perm_b32 v60, v32, v32, v16
v_perm_b32 v61, v32, v32, v17
v_perm_b32 v62, v32, v32, v18
v_perm_b32 v63, v32, v32, v19
s_nop 1
v_mfma_f32_16x16x32_bf16 v[76:79], v[60:63], a[160:163], v[76:79]
v_perm_b32 v64, v50, v50, v16
v_perm_b32 v65, v50, v50, v17
v_perm_b32 v66, v50, v50, v18
v_perm_b32 v67, v50, v50, v19
s_nop 1
v_mfma_f32_16x16x32_bf16 v[80:83], v[64:67], a[160:163], v[80:83]
s_add_u32 m0, s12, 69632
s_add_u32 s6, s13, 1048576
buffer_load_dwordx4 v2, s[52:55], s6 offen nt lds
s_waitcnt vmcnt(51)
v_perm_b32 v68, v32, v32, v20
v_perm_b32 v69, v32, v32, v21
v_perm_b32 v70, v32, v32, v22
v_perm_b32 v71, v32, v32, v23
s_nop 1
v_mfma_f32_16x16x32_bf16 v[76:79], v[68:71], a[164:167], v[76:79]
v_perm_b32 v72, v50, v50, v20
v_perm_b32 v73, v50, v50, v21
v_perm_b32 v74, v50, v50, v22
v_perm_b32 v75, v50, v50, v23
s_nop 1
v_mfma_f32_16x16x32_bf16 v[80:83], v[72:75], a[164:167], v[80:83]
s_add_u32 m0, s12, 70720
s_add_u32 s6, s13, 1049600
buffer_load_dwordx4 v2, s[52:55], s6 offen nt lds
s_waitcnt vmcnt(51)
v_perm_b32 v60, v33, v33, v16
v_perm_b32 v61, v33, v33, v17
v_perm_b32 v62, v33, v33, v18
v_perm_b32 v63, v33, v33, v19
s_nop 1
v_mfma_f32_16x16x32_bf16 v[76:79], v[60:63], a[168:171], v[76:79]
v_perm_b32 v64, v51, v51, v16
v_perm_b32 v65, v51, v51, v17
v_perm_b32 v66, v51, v51, v18
v_perm_b32 v67, v51, v51, v19
s_nop 1
v_mfma_f32_16x16x32_bf16 v[80:83], v[64:67], a[168:171], v[80:83]
s_add_u32 m0, s12, 71808
s_add_u32 s6, s13, 1050624
buffer_load_dwordx4 v2, s[52:55], s6 offen nt lds
s_waitcnt vmcnt(51)
v_perm_b32 v68, v33, v33, v20
v_perm_b32 v69, v33, v33, v21
v_perm_b32 v70, v33, v33, v22
v_perm_b32 v71, v33, v33, v23
s_nop 1
v_mfma_f32_16x16x32_bf16 v[76:79], v[68:71], a[172:175], v[76:79]
v_perm_b32 v72, v51, v51, v20
v_perm_b32 v73, v51, v51, v21
v_perm_b32 v74, v51, v51, v22
v_perm_b32 v75, v51, v51, v23
s_nop 1
v_mfma_f32_16x16x32_bf16 v[80:83], v[72:75], a[172:175], v[80:83]
s_add_u32 m0, s12, 72896
s_add_u32 s6, s13, 1051648
buffer_load_dwordx4 v2, s[52:55], s6 offen nt lds
s_waitcnt vmcnt(51)
v_perm_b32 v60, v34, v34, v16
v_perm_b32 v61, v34, v34, v17
v_perm_b32 v62, v34, v34, v18
v_perm_b32 v63, v34, v34, v19
s_nop 1
v_mfma_f32_16x16x32_bf16 v[76:79], v[60:63], a[176:179], v[76:79]
v_perm_b32 v64, v52, v52, v16
v_perm_b32 v65, v52, v52, v17
v_perm_b32 v66, v52, v52, v18
v_perm_b32 v67, v52, v52, v19
s_nop 1
v_mfma_f32_16x16x32_bf16 v[80:83], v[64:67], a[176:179], v[80:83]
s_add_u32 m0, s12, 73984
s_add_u32 s6, s13, 1310720
buffer_load_dwordx4 v2, s[52:55], s6 offen nt lds
s_waitcnt vmcnt(51)
v_perm_b32 v68, v34, v34, v20
v_perm_b32 v69, v34, v34, v21
v_perm_b32 v70, v34, v34, v22
v_perm_b32 v71, v34, v34, v23
s_nop 1
v_mfma_f32_16x16x32_bf16 v[76:79], v[68:71], a[180:183], v[76:79]
v_perm_b32 v72, v52, v52, v20
v_perm_b32 v73, v52, v52, v21
v_perm_b32 v74, v52, v52, v22
v_perm_b32 v75, v52, v52, v23
s_nop 1
v_mfma_f32_16x16x32_bf16 v[80:83], v[72:75], a[180:183], v[80:83]
s_add_u32 m0, s12, 75072
s_add_u32 s6, s13, 1311744
buffer_load_dwordx4 v2, s[52:55], s6 offen nt lds
s_waitcnt vmcnt(51)
v_perm_b32 v60, v35, v35, v16
v_perm_b32 v61, v35, v35, v17
v_perm_b32 v62, v35, v35, v18
v_perm_b32 v63, v35, v35, v19
s_nop 1
v_mfma_f32_16x16x32_bf16 v[76:79], v[60:63], a[184:187], v[76:79]
v_perm_b32 v64, v53, v53, v16
v_perm_b32 v65, v53, v53, v17
v_perm_b32 v66, v53, v53, v18
v_perm_b32 v67, v53, v53, v19
s_nop 1
v_mfma_f32_16x16x32_bf16 v[80:83], v[64:67], a[184:187], v[80:83]
s_add_u32 m0, s12, 76160
s_add_u32 s6, s13, 1312768
buffer_load_dwordx4 v2, s[52:55], s6 offen nt lds
s_waitcnt vmcnt(51)
v_perm_b32 v68, v35, v35, v20
v_perm_b32 v69, v35, v35, v21
v_perm_b32 v70, v35, v35, v22
v_perm_b32 v71, v35, v35, v23
s_nop 1
v_mfma_f32_16x16x32_bf16 v[76:79], v[68:71], a[188:191], v[76:79]
v_perm_b32 v72, v53, v53, v20
v_perm_b32 v73, v53, v53, v21
v_perm_b32 v74, v53, v53, v22
v_perm_b32 v75, v53, v53, v23
s_nop 1
v_mfma_f32_16x16x32_bf16 v[80:83], v[72:75], a[188:191], v[80:83]
s_add_u32 m0, s12, 77248
s_add_u32 s6, s13, 1313792
buffer_load_dwordx4 v2, s[52:55], s6 offen nt lds
s_waitcnt vmcnt(51)
v_perm_b32 v60, v36, v36, v16
v_perm_b32 v61, v36, v36, v17
v_perm_b32 v62, v36, v36, v18
v_perm_b32 v63, v36, v36, v19
s_nop 1
v_mfma_f32_16x16x32_bf16 v[76:79], v[60:63], a[192:195], v[76:79]
v_perm_b32 v64, v54, v54, v16
v_perm_b32 v65, v54, v54, v17
v_perm_b32 v66, v54, v54, v18
v_perm_b32 v67, v54, v54, v19
s_nop 1
v_mfma_f32_16x16x32_bf16 v[80:83], v[64:67], a[192:195], v[80:83]
s_add_u32 m0, s12, 78336
s_add_u32 s6, s13, 1572864
buffer_load_dwordx4 v10, s[52:55], s6 offen nt lds
s_waitcnt vmcnt(51)
v_perm_b32 v68, v36, v36, v20
v_perm_b32 v69, v36, v36, v21
v_perm_b32 v70, v36, v36, v22
v_perm_b32 v71, v36, v36, v23
s_nop 1
v_mfma_f32_16x16x32_bf16 v[76:79], v[68:71], a[196:199], v[76:79]
v_perm_b32 v72, v54, v54, v20
v_perm_b32 v73, v54, v54, v21
v_perm_b32 v74, v54, v54, v22
v_perm_b32 v75, v54, v54, v23
s_nop 1
v_mfma_f32_16x16x32_bf16 v[80:83], v[72:75], a[196:199], v[80:83]
s_add_u32 m0, s12, 79424
s_add_u32 s6, s13, 1573888
buffer_load_dwordx4 v10, s[52:55], s6 offen nt lds
s_waitcnt vmcnt(51)
v_perm_b32 v60, v37, v37, v16
v_perm_b32 v61, v37, v37, v17
v_perm_b32 v62, v37, v37, v18
v_perm_b32 v63, v37, v37, v19
s_nop 1
v_mfma_f32_16x16x32_bf16 v[76:79], v[60:63], a[200:203], v[76:79]
v_perm_b32 v64, v55, v55, v16
v_perm_b32 v65, v55, v55, v17
v_perm_b32 v66, v55, v55, v18
v_perm_b32 v67, v55, v55, v19
s_nop 1
v_mfma_f32_16x16x32_bf16 v[80:83], v[64:67], a[200:203], v[80:83]
s_add_u32 m0, s12, 80512
s_add_u32 s6, s13, 1574912
buffer_load_dwordx4 v10, s[52:55], s6 offen nt lds
s_waitcnt vmcnt(51)
v_perm_b32 v68, v37, v37, v20
v_perm_b32 v69, v37, v37, v21
v_perm_b32 v70, v37, v37, v22
v_perm_b32 v71, v37, v37, v23
s_nop 1
v_mfma_f32_16x16x32_bf16 v[76:79], v[68:71], a[204:207], v[76:79]
v_perm_b32 v72, v55, v55, v20
v_perm_b32 v73, v55, v55, v21
v_perm_b32 v74, v55, v55, v22
v_perm_b32 v75, v55, v55, v23
s_nop 1
v_mfma_f32_16x16x32_bf16 v[80:83], v[72:75], a[204:207], v[80:83]
s_add_u32 m0, s12, 81600
s_add_u32 s6, s13, 1575936
buffer_load_dwordx4 v10, s[52:55], s6 offen nt lds
s_waitcnt vmcnt(51)
v_perm_b32 v60, v38, v38, v16
v_perm_b32 v61, v38, v38, v17
v_perm_b32 v62, v38, v38, v18
v_perm_b32 v63, v38, v38, v19
s_nop 1
v_mfma_f32_16x16x32_bf16 v[76:79], v[60:63], a[208:211], v[76:79]
v_perm_b32 v64, v56, v56, v16
v_perm_b32 v65, v56, v56, v17
v_perm_b32 v66, v56, v56, v18
v_perm_b32 v67, v56, v56, v19
s_nop 1
v_mfma_f32_16x16x32_bf16 v[80:83], v[64:67], a[208:211], v[80:83]
buffer_load_dword v11, off, s[68:71], 0 offset:0 sc1
s_add_u32 m0, s12, 82688
s_add_u32 s6, s13, 1835008
buffer_load_dwordx4 v10, s[52:55], s6 offen nt lds
s_waitcnt vmcnt(52)
v_perm_b32 v68, v38, v38, v20
v_perm_b32 v69, v38, v38, v21
v_perm_b32 v70, v38, v38, v22
v_perm_b32 v71, v38, v38, v23
s_nop 1
v_mfma_f32_16x16x32_bf16 v[76:79], v[68:71], a[212:215], v[76:79]
v_perm_b32 v72, v56, v56, v20
v_perm_b32 v73, v56, v56, v21
v_perm_b32 v74, v56, v56, v22
v_perm_b32 v75, v56, v56, v23
s_nop 1
v_mfma_f32_16x16x32_bf16 v[80:83], v[72:75], a[212:215], v[80:83]
s_add_u32 m0, s12, 83776
s_add_u32 s6, s13, 1836032
buffer_load_dwordx4 v10, s[52:55], s6 offen nt lds
s_waitcnt vmcnt(52)
v_perm_b32 v60, v39, v39, v16
v_perm_b32 v61, v39, v39, v17
v_perm_b32 v62, v39, v39, v18
v_perm_b32 v63, v39, v39, v19
s_nop 1
v_mfma_f32_16x16x32_bf16 v[76:79], v[60:63], a[216:219], v[76:79]
v_perm_b32 v64, v57, v57, v16
v_perm_b32 v65, v57, v57, v17
v_perm_b32 v66, v57, v57, v18
v_perm_b32 v67, v57, v57, v19
s_nop 1
v_mfma_f32_16x16x32_bf16 v[80:83], v[64:67], a[216:219], v[80:83]
s_add_u32 m0, s12, 84864
s_add_u32 s6, s13, 1837056
buffer_load_dwordx4 v10, s[52:55], s6 offen nt lds
s_waitcnt vmcnt(52)
v_perm_b32 v68, v39, v39, v20
v_perm_b32 v69, v39, v39, v21
v_perm_b32 v70, v39, v39, v22
v_perm_b32 v71, v39, v39, v23
s_nop 1
v_mfma_f32_16x16x32_bf16 v[76:79], v[68:71], a[220:223], v[76:79]
v_perm_b32 v72, v57, v57, v20
v_perm_b32 v73, v57, v57, v21
v_perm_b32 v74, v57, v57, v22
v_perm_b32 v75, v57, v57, v23
s_nop 1
v_mfma_f32_16x16x32_bf16 v[80:83], v[72:75], a[220:223], v[80:83]
s_add_u32 m0, s12, 85952
s_add_u32 s6, s13, 1838080
buffer_load_dwordx4 v10, s[52:55], s6 offen nt lds
s_waitcnt vmcnt(52)
v_perm_b32 v60, v40, v40, v16
v_perm_b32 v61, v40, v40, v17
v_perm_b32 v62, v40, v40, v18
v_perm_b32 v63, v40, v40, v19
s_nop 1
v_mfma_f32_16x16x32_bf16 v[76:79], v[60:63], a[224:227], v[76:79]
v_perm_b32 v64, v58, v58, v16
v_perm_b32 v65, v58, v58, v17
v_perm_b32 v66, v58, v58, v18
v_perm_b32 v67, v58, v58, v19
s_nop 1
v_mfma_f32_16x16x32_bf16 v[80:83], v[64:67], a[224:227], v[80:83]
s_waitcnt vmcnt(51)
v_perm_b32 v68, v40, v40, v20
v_perm_b32 v69, v40, v40, v21
v_perm_b32 v70, v40, v40, v22
v_perm_b32 v71, v40, v40, v23
s_nop 1
v_mfma_f32_16x16x32_bf16 v[76:79], v[68:71], a[228:231], v[76:79]
v_perm_b32 v72, v58, v58, v20
v_perm_b32 v73, v58, v58, v21
v_perm_b32 v74, v58, v58, v22
v_perm_b32 v75, v58, v58, v23
s_nop 1
v_mfma_f32_16x16x32_bf16 v[80:83], v[72:75], a[228:231], v[80:83]
s_waitcnt vmcnt(50)
v_perm_b32 v60, v41, v41, v16
v_perm_b32 v61, v41, v41, v17
v_perm_b32 v62, v41, v41, v18
v_perm_b32 v63, v41, v41, v19
s_nop 1
v_mfma_f32_16x16x32_bf16 v[76:79], v[60:63], a[232:235], v[76:79]
v_perm_b32 v64, v59, v59, v16
v_perm_b32 v65, v59, v59, v17
v_perm_b32 v66, v59, v59, v18
v_perm_b32 v67, v59, v59, v19
s_nop 1
v_mfma_f32_16x16x32_bf16 v[80:83], v[64:67], a[232:235], v[80:83]
s_waitcnt vmcnt(49)
v_perm_b32 v68, v41, v41, v20
v_perm_b32 v69, v41, v41, v21
v_perm_b32 v70, v41, v41, v22
v_perm_b32 v71, v41, v41, v23
s_nop 1
v_mfma_f32_16x16x32_bf16 v[76:79], v[68:71], a[236:239], v[76:79]
v_perm_b32 v72, v59, v59, v20
v_perm_b32 v73, v59, v59, v21
v_perm_b32 v74, v59, v59, v22
v_perm_b32 v75, v59, v59, v23
s_nop 1
v_mfma_f32_16x16x32_bf16 v[80:83], v[72:75], a[236:239], v[80:83]
v_lshlrev_b32 v5, 5, v8
v_and_b32 v6, 1, v9
v_lshl_add_u32 v6, v6, 4, v5
v_lshrrev_b32 v7, 5, v1
v_lshl_add_u32 v6, v7, 9, v6
s_lshl_b32 s6, s3, 11
s_add_u32 s6, s6, 139264
v_add_u32 v6, s6, v6
ds_write_b128 v6, v[76:79]
ds_write_b128 v6, v[80:83] offset:1024
v_add_u32 v5, 139264, v5
s_waitcnt lgkmcnt(0)
s_barrier
ds_read_b128 v[188:191], v5 offset:0
ds_read_b128 v[192:195], v5 offset:16
ds_read_b128 v[196:199], v5 offset:2048
ds_read_b128 v[200:203], v5 offset:2064
ds_read_b128 v[204:207], v5 offset:4096
ds_read_b128 v[208:211], v5 offset:4112
ds_read_b128 v[212:215], v5 offset:6144
ds_read_b128 v[216:219], v5 offset:6160
s_waitcnt lgkmcnt(0)
v_add_f32 v188, v188, v196
v_add_f32 v204, v204, v212
v_add_f32 v189, v189, v197
v_add_f32 v205, v205, v213
v_add_f32 v190, v190, v198
v_add_f32 v206, v206, v214
v_add_f32 v191, v191, v199
v_add_f32 v207, v207, v215
v_add_f32 v192, v192, v200
v_add_f32 v208, v208, v216
v_add_f32 v193, v193, v201
v_add_f32 v209, v209, v217
v_add_f32 v194, v194, v202
v_add_f32 v210, v210, v218
v_add_f32 v195, v195, v203
v_add_f32 v211, v211, v219
v_add_f32 v188, v188, v204
v_add_f32 v189, v189, v205
v_add_f32 v190, v190, v206
v_add_f32 v191, v191, v207
v_add_f32 v192, v192, v208
v_add_f32 v193, v193, v209
v_add_f32 v194, v194, v210
v_add_f32 v195, v195, v211
v_cvt_pk_bf16_f32 v148, v188, v189
v_cvt_pk_bf16_f32 v149, v190, v191
v_cvt_pk_bf16_f32 v150, v192, v193
v_cvt_pk_bf16_f32 v151, v194, v195
ds_read_b128 v[188:191], v5 offset:512
ds_read_b128 v[192:195], v5 offset:528
ds_read_b128 v[196:199], v5 offset:2560
ds_read_b128 v[200:203], v5 offset:2576
ds_read_b128 v[204:207], v5 offset:4608
ds_read_b128 v[208:211], v5 offset:4624
ds_read_b128 v[212:215], v5 offset:6656
ds_read_b128 v[216:219], v5 offset:6672
s_waitcnt lgkmcnt(0)
v_add_f32 v188, v188, v196
v_add_f32 v204, v204, v212
v_add_f32 v189, v189, v197
v_add_f32 v205, v205, v213
v_add_f32 v190, v190, v198
v_add_f32 v206, v206, v214
v_add_f32 v191, v191, v199
v_add_f32 v207, v207, v215
v_add_f32 v192, v192, v200
v_add_f32 v208, v208, v216
v_add_f32 v193, v193, v201
v_add_f32 v209, v209, v217
v_add_f32 v194, v194, v202
v_add_f32 v210, v210, v218
v_add_f32 v195, v195, v203
v_add_f32 v211, v211, v219
v_add_f32 v188, v188, v204
v_add_f32 v189, v189, v205
v_add_f32 v190, v190, v206
v_add_f32 v191, v191, v207
v_add_f32 v192, v192, v208
v_add_f32 v193, v193, v209
v_add_f32 v194, v194, v210
v_add_f32 v195, v195, v211
v_cvt_pk_bf16_f32 v152, v188, v189
v_cvt_pk_bf16_f32 v153, v190, v191
v_cvt_pk_bf16_f32 v154, v192, v193
v_cvt_pk_bf16_f32 v155, v194, v195
ds_read_b128 v[188:191], v5 offset:1024
ds_read_b128 v[192:195], v5 offset:1040
ds_read_b128 v[196:199], v5 offset:3072
ds_read_b128 v[200:203], v5 offset:3088
ds_read_b128 v[204:207], v5 offset:5120
ds_read_b128 v[208:211], v5 offset:5136
ds_read_b128 v[212:215], v5 offset:7168
ds_read_b128 v[216:219], v5 offset:7184
s_waitcnt lgkmcnt(0)
v_add_f32 v188, v188, v196
v_add_f32 v204, v204, v212
v_add_f32 v189, v189, v197
v_add_f32 v205, v205, v213
v_add_f32 v190, v190, v198
v_add_f32 v206, v206, v214
v_add_f32 v191, v191, v199
v_add_f32 v207, v207, v215
v_add_f32 v192, v192, v200
v_add_f32 v208, v208, v216
v_add_f32 v193, v193, v201
v_add_f32 v209, v209, v217
v_add_f32 v194, v194, v202
v_add_f32 v210, v210, v218
v_add_f32 v195, v195, v203
v_add_f32 v211, v211, v219
v_add_f32 v188, v188, v204
v_add_f32 v189, v189, v205
v_add_f32 v190, v190, v206
v_add_f32 v191, v191, v207
v_add_f32 v192, v192, v208
v_add_f32 v193, v193, v209
v_add_f32 v194, v194, v210
v_add_f32 v195, v195, v211
v_cvt_pk_bf16_f32 v156, v188, v189
v_cvt_pk_bf16_f32 v157, v190, v191
v_cvt_pk_bf16_f32 v158, v192, v193
v_cvt_pk_bf16_f32 v159, v194, v195
ds_read_b128 v[188:191], v5 offset:1536
ds_read_b128 v[192:195], v5 offset:1552
ds_read_b128 v[196:199], v5 offset:3584
ds_read_b128 v[200:203], v5 offset:3600
ds_read_b128 v[204:207], v5 offset:5632
ds_read_b128 v[208:211], v5 offset:5648
ds_read_b128 v[212:215], v5 offset:7680
ds_read_b128 v[216:219], v5 offset:7696
s_waitcnt lgkmcnt(0)
v_add_f32 v188, v188, v196
v_add_f32 v204, v204, v212
v_add_f32 v189, v189, v197
v_add_f32 v205, v205, v213
v_add_f32 v190, v190, v198
v_add_f32 v206, v206, v214
v_add_f32 v191, v191, v199
v_add_f32 v207, v207, v215
v_add_f32 v192, v192, v200
v_add_f32 v208, v208, v216
v_add_f32 v193, v193, v201
v_add_f32 v209, v209, v217
v_add_f32 v194, v194, v202
v_add_f32 v210, v210, v218
v_add_f32 v195, v195, v203
v_add_f32 v211, v211, v219
v_add_f32 v188, v188, v204
v_add_f32 v189, v189, v205
v_add_f32 v190, v190, v206
v_add_f32 v191, v191, v207
v_add_f32 v192, v192, v208
v_add_f32 v193, v193, v209
v_add_f32 v194, v194, v210
v_add_f32 v195, v195, v211
v_cvt_pk_bf16_f32 v160, v188, v189
v_cvt_pk_bf16_f32 v161, v190, v191
v_cvt_pk_bf16_f32 v162, v192, v193
v_cvt_pk_bf16_f32 v163, v194, v195
s_waitcnt vmcnt(33)
v_dot2_f32_bf16 v164, v84, v148, 0
v_dot2_f32_bf16 v165, v84, v152, 0
v_dot2_f32_bf16 v166, v84, v156, 0
v_dot2_f32_bf16 v167, v84, v160, 0
v_dot2_f32_bf16 v164, v85, v149, v164
v_dot2_f32_bf16 v165, v85, v153, v165
v_dot2_f32_bf16 v166, v85, v157, v166
v_dot2_f32_bf16 v167, v85, v161, v167
v_dot2_f32_bf16 v164, v86, v150, v164
v_dot2_f32_bf16 v165, v86, v154, v165
v_dot2_f32_bf16 v166, v86, v158, v166
v_dot2_f32_bf16 v167, v86, v162, v167
v_dot2_f32_bf16 v164, v87, v151, v164
v_dot2_f32_bf16 v165, v87, v155, v165
v_dot2_f32_bf16 v166, v87, v159, v166
v_dot2_f32_bf16 v167, v87, v163, v167
v_add_f32_dpp v168, v164, v164 row_ror:8 row_mask:0xf bank_mask:0x3
v_add_f32_dpp v169, v165, v165 row_ror:8 row_mask:0xf bank_mask:0x3
v_add_f32_dpp v168, v166, v166 row_ror:8 row_mask:0xf bank_mask:0xc
v_add_f32_dpp v169, v167, v167 row_ror:8 row_mask:0xf bank_mask:0xc
s_nop 0
v_add_f32_dpp v172, v168, v168 row_half_mirror row_mask:0xf bank_mask:0x5
v_add_f32_dpp v172, v169, v169 row_half_mirror row_mask:0xf bank_mask:0xa
s_nop 1
v_add_f32_dpp v172, v172, v172 quad_perm:[1,0,3,2] row_mask:0xf bank_mask:0xf
s_nop 1
v_add_f32_dpp v172, v172, v172 quad_perm:[2,3,0,1] row_mask:0xf bank_mask:0xf
v_dot2_f32_bf16 v164, v88, v148, 0
v_dot2_f32_bf16 v165, v88, v152, 0
v_dot2_f32_bf16 v166, v88, v156, 0
v_dot2_f32_bf16 v167, v88, v160, 0
v_dot2_f32_bf16 v164, v89, v149, v164
v_dot2_f32_bf16 v165, v89, v153, v165
v_dot2_f32_bf16 v166, v89, v157, v166
v_dot2_f32_bf16 v167, v89, v161, v167
v_dot2_f32_bf16 v164, v90, v150, v164
v_dot2_f32_bf16 v165, v90, v154, v165
v_dot2_f32_bf16 v166, v90, v158, v166
v_dot2_f32_bf16 v167, v90, v162, v167
v_dot2_f32_bf16 v164, v91, v151, v164
v_dot2_f32_bf16 v165, v91, v155, v165
v_dot2_f32_bf16 v166, v91, v159, v166
v_dot2_f32_bf16 v167, v91, v163, v167
v_add_f32_dpp v168, v164, v164 row_ror:8 row_mask:0xf bank_mask:0x3
v_add_f32_dpp v169, v165, v165 row_ror:8 row_mask:0xf bank_mask:0x3
v_add_f32_dpp v168, v166, v166 row_ror:8 row_mask:0xf bank_mask:0xc
v_add_f32_dpp v169, v167, v167 row_ror:8 row_mask:0xf bank_mask:0xc
s_nop 0
v_add_f32_dpp v173, v168, v168 row_half_mirror row_mask:0xf bank_mask:0x5
v_add_f32_dpp v173, v169, v169 row_half_mirror row_mask:0xf bank_mask:0xa
s_nop 1
v_add_f32_dpp v173, v173, v173 quad_perm:[1,0,3,2] row_mask:0xf bank_mask:0xf
s_nop 1
v_add_f32_dpp v173, v173, v173 quad_perm:[2,3,0,1] row_mask:0xf bank_mask:0xf
v_dot2_f32_bf16 v164, v92, v148, 0
v_dot2_f32_bf16 v165, v92, v152, 0
v_dot2_f32_bf16 v166, v92, v156, 0
v_dot2_f32_bf16 v167, v92, v160, 0
v_dot2_f32_bf16 v164, v93, v149, v164
v_dot2_f32_bf16 v165, v93, v153, v165
v_dot2_f32_bf16 v166, v93, v157, v166
v_dot2_f32_bf16 v167, v93, v161, v167
v_dot2_f32_bf16 v164, v94, v150, v164
v_dot2_f32_bf16 v165, v94, v154, v165
v_dot2_f32_bf16 v166, v94, v158, v166
v_dot2_f32_bf16 v167, v94, v162, v167
v_dot2_f32_bf16 v164, v95, v151, v164
v_dot2_f32_bf16 v165, v95, v155, v165
v_dot2_f32_bf16 v166, v95, v159, v166
v_dot2_f32_bf16 v167, v95, v163, v167
v_add_f32_dpp v168, v164, v164 row_ror:8 row_mask:0xf bank_mask:0x3
v_add_f32_dpp v169, v165, v165 row_ror:8 row_mask:0xf bank_mask:0x3
v_add_f32_dpp v168, v166, v166 row_ror:8 row_mask:0xf bank_mask:0xc
v_add_f32_dpp v169, v167, v167 row_ror:8 row_mask:0xf bank_mask:0xc
s_nop 0
v_add_f32_dpp v174, v168, v168 row_half_mirror row_mask:0xf bank_mask:0x5
v_add_f32_dpp v174, v169, v169 row_half_mirror row_mask:0xf bank_mask:0xa
s_nop 1
v_add_f32_dpp v174, v174, v174 quad_perm:[1,0,3,2] row_mask:0xf bank_mask:0xf
s_nop 1
v_add_f32_dpp v174, v174, v174 quad_perm:[2,3,0,1] row_mask:0xf bank_mask:0xf
v_dot2_f32_bf16 v164, v96, v148, 0
v_dot2_f32_bf16 v165, v96, v152, 0
v_dot2_f32_bf16 v166, v96, v156, 0
v_dot2_f32_bf16 v167, v96, v160, 0
v_dot2_f32_bf16 v164, v97, v149, v164
v_dot2_f32_bf16 v165, v97, v153, v165
v_dot2_f32_bf16 v166, v97, v157, v166
v_dot2_f32_bf16 v167, v97, v161, v167
v_dot2_f32_bf16 v164, v98, v150, v164
v_dot2_f32_bf16 v165, v98, v154, v165
v_dot2_f32_bf16 v166, v98, v158, v166
v_dot2_f32_bf16 v167, v98, v162, v167
v_dot2_f32_bf16 v164, v99, v151, v164
v_dot2_f32_bf16 v165, v99, v155, v165
v_dot2_f32_bf16 v166, v99, v159, v166
v_dot2_f32_bf16 v167, v99, v163, v167
v_add_f32_dpp v168, v164, v164 row_ror:8 row_mask:0xf bank_mask:0x3
v_add_f32_dpp v169, v165, v165 row_ror:8 row_mask:0xf bank_mask:0x3
v_add_f32_dpp v168, v166, v166 row_ror:8 row_mask:0xf bank_mask:0xc
v_add_f32_dpp v169, v167, v167 row_ror:8 row_mask:0xf bank_mask:0xc
s_nop 0
v_add_f32_dpp v175, v168, v168 row_half_mirror row_mask:0xf bank_mask:0x5
v_add_f32_dpp v175, v169, v169 row_half_mirror row_mask:0xf bank_mask:0xa
s_nop 1
v_add_f32_dpp v175, v175, v175 quad_perm:[1,0,3,2] row_mask:0xf bank_mask:0xf
s_nop 1
v_add_f32_dpp v175, v175, v175 quad_perm:[2,3,0,1] row_mask:0xf bank_mask:0xf
v_dot2_f32_bf16 v164, v100, v148, 0
v_dot2_f32_bf16 v165, v100, v152, 0
v_dot2_f32_bf16 v166, v100, v156, 0
v_dot2_f32_bf16 v167, v100, v160, 0
v_dot2_f32_bf16 v164, v101, v149, v164
v_dot2_f32_bf16 v165, v101, v153, v165
v_dot2_f32_bf16 v166, v101, v157, v166
v_dot2_f32_bf16 v167, v101, v161, v167
v_dot2_f32_bf16 v164, v102, v150, v164
v_dot2_f32_bf16 v165, v102, v154, v165
v_dot2_f32_bf16 v166, v102, v158, v166
v_dot2_f32_bf16 v167, v102, v162, v167
v_dot2_f32_bf16 v164, v103, v151, v164
v_dot2_f32_bf16 v165, v103, v155, v165
v_dot2_f32_bf16 v166, v103, v159, v166
v_dot2_f32_bf16 v167, v103, v163, v167
v_add_f32_dpp v168, v164, v164 row_ror:8 row_mask:0xf bank_mask:0x3
v_add_f32_dpp v169, v165, v165 row_ror:8 row_mask:0xf bank_mask:0x3
v_add_f32_dpp v168, v166, v166 row_ror:8 row_mask:0xf bank_mask:0xc
v_add_f32_dpp v169, v167, v167 row_ror:8 row_mask:0xf bank_mask:0xc
s_nop 0
v_add_f32_dpp v176, v168, v168 row_half_mirror row_mask:0xf bank_mask:0x5
v_add_f32_dpp v176, v169, v169 row_half_mirror row_mask:0xf bank_mask:0xa
s_nop 1
v_add_f32_dpp v176, v176, v176 quad_perm:[1,0,3,2] row_mask:0xf bank_mask:0xf
s_nop 1
v_add_f32_dpp v176, v176, v176 quad_perm:[2,3,0,1] row_mask:0xf bank_mask:0xf
v_dot2_f32_bf16 v164, v104, v148, 0
v_dot2_f32_bf16 v165, v104, v152, 0
v_dot2_f32_bf16 v166, v104, v156, 0
v_dot2_f32_bf16 v167, v104, v160, 0
v_dot2_f32_bf16 v164, v105, v149, v164
v_dot2_f32_bf16 v165, v105, v153, v165
v_dot2_f32_bf16 v166, v105, v157, v166
v_dot2_f32_bf16 v167, v105, v161, v167
v_dot2_f32_bf16 v164, v106, v150, v164
v_dot2_f32_bf16 v165, v106, v154, v165
v_dot2_f32_bf16 v166, v106, v158, v166
v_dot2_f32_bf16 v167, v106, v162, v167
v_dot2_f32_bf16 v164, v107, v151, v164
v_dot2_f32_bf16 v165, v107, v155, v165
v_dot2_f32_bf16 v166, v107, v159, v166
v_dot2_f32_bf16 v167, v107, v163, v167
v_add_f32_dpp v168, v164, v164 row_ror:8 row_mask:0xf bank_mask:0x3
v_add_f32_dpp v169, v165, v165 row_ror:8 row_mask:0xf bank_mask:0x3
v_add_f32_dpp v168, v166, v166 row_ror:8 row_mask:0xf bank_mask:0xc
v_add_f32_dpp v169, v167, v167 row_ror:8 row_mask:0xf bank_mask:0xc
s_nop 0
v_add_f32_dpp v177, v168, v168 row_half_mirror row_mask:0xf bank_mask:0x5
v_add_f32_dpp v177, v169, v169 row_half_mirror row_mask:0xf bank_mask:0xa
s_nop 1
v_add_f32_dpp v177, v177, v177 quad_perm:[1,0,3,2] row_mask:0xf bank_mask:0xf
s_nop 1
v_add_f32_dpp v177, v177, v177 quad_perm:[2,3,0,1] row_mask:0xf bank_mask:0xf
v_dot2_f32_bf16 v164, v108, v148, 0
v_dot2_f32_bf16 v165, v108, v152, 0
v_dot2_f32_bf16 v166, v108, v156, 0
v_dot2_f32_bf16 v167, v108, v160, 0
v_dot2_f32_bf16 v164, v109, v149, v164
v_dot2_f32_bf16 v165, v109, v153, v165
v_dot2_f32_bf16 v166, v109, v157, v166
v_dot2_f32_bf16 v167, v109, v161, v167
v_dot2_f32_bf16 v164, v110, v150, v164
v_dot2_f32_bf16 v165, v110, v154, v165
v_dot2_f32_bf16 v166, v110, v158, v166
v_dot2_f32_bf16 v167, v110, v162, v167
v_dot2_f32_bf16 v164, v111, v151, v164
v_dot2_f32_bf16 v165, v111, v155, v165
v_dot2_f32_bf16 v166, v111, v159, v166
v_dot2_f32_bf16 v167, v111, v163, v167
v_add_f32_dpp v168, v164, v164 row_ror:8 row_mask:0xf bank_mask:0x3
v_add_f32_dpp v169, v165, v165 row_ror:8 row_mask:0xf bank_mask:0x3
v_add_f32_dpp v168, v166, v166 row_ror:8 row_mask:0xf bank_mask:0xc
v_add_f32_dpp v169, v167, v167 row_ror:8 row_mask:0xf bank_mask:0xc
s_nop 0
v_add_f32_dpp v178, v168, v168 row_half_mirror row_mask:0xf bank_mask:0x5
v_add_f32_dpp v178, v169, v169 row_half_mirror row_mask:0xf bank_mask:0xa
s_nop 1
v_add_f32_dpp v178, v178, v178 quad_perm:[1,0,3,2] row_mask:0xf bank_mask:0xf
s_nop 1
v_add_f32_dpp v178, v178, v178 quad_perm:[2,3,0,1] row_mask:0xf bank_mask:0xf
v_dot2_f32_bf16 v164, v112, v148, 0
v_dot2_f32_bf16 v165, v112, v152, 0
v_dot2_f32_bf16 v166, v112, v156, 0
v_dot2_f32_bf16 v167, v112, v160, 0
v_dot2_f32_bf16 v164, v113, v149, v164
v_dot2_f32_bf16 v165, v113, v153, v165
v_dot2_f32_bf16 v166, v113, v157, v166
v_dot2_f32_bf16 v167, v113, v161, v167
v_dot2_f32_bf16 v164, v114, v150, v164
v_dot2_f32_bf16 v165, v114, v154, v165
v_dot2_f32_bf16 v166, v114, v158, v166
v_dot2_f32_bf16 v167, v114, v162, v167
v_dot2_f32_bf16 v164, v115, v151, v164
v_dot2_f32_bf16 v165, v115, v155, v165
v_dot2_f32_bf16 v166, v115, v159, v166
v_dot2_f32_bf16 v167, v115, v163, v167
v_add_f32_dpp v168, v164, v164 row_ror:8 row_mask:0xf bank_mask:0x3
v_add_f32_dpp v169, v165, v165 row_ror:8 row_mask:0xf bank_mask:0x3
v_add_f32_dpp v168, v166, v166 row_ror:8 row_mask:0xf bank_mask:0xc
v_add_f32_dpp v169, v167, v167 row_ror:8 row_mask:0xf bank_mask:0xc
s_nop 0
v_add_f32_dpp v179, v168, v168 row_half_mirror row_mask:0xf bank_mask:0x5
v_add_f32_dpp v179, v169, v169 row_half_mirror row_mask:0xf bank_mask:0xa
s_nop 1
v_add_f32_dpp v179, v179, v179 quad_perm:[1,0,3,2] row_mask:0xf bank_mask:0xf
s_nop 1
v_add_f32_dpp v179, v179, v179 quad_perm:[2,3,0,1] row_mask:0xf bank_mask:0xf
v_dot2_f32_bf16 v164, v116, v148, 0
v_dot2_f32_bf16 v165, v116, v152, 0
v_dot2_f32_bf16 v166, v116, v156, 0
v_dot2_f32_bf16 v167, v116, v160, 0
v_dot2_f32_bf16 v164, v117, v149, v164
v_dot2_f32_bf16 v165, v117, v153, v165
v_dot2_f32_bf16 v166, v117, v157, v166
v_dot2_f32_bf16 v167, v117, v161, v167
v_dot2_f32_bf16 v164, v118, v150, v164
v_dot2_f32_bf16 v165, v118, v154, v165
v_dot2_f32_bf16 v166, v118, v158, v166
v_dot2_f32_bf16 v167, v118, v162, v167
v_dot2_f32_bf16 v164, v119, v151, v164
v_dot2_f32_bf16 v165, v119, v155, v165
v_dot2_f32_bf16 v166, v119, v159, v166
v_dot2_f32_bf16 v167, v119, v163, v167
v_add_f32_dpp v168, v164, v164 row_ror:8 row_mask:0xf bank_mask:0x3
v_add_f32_dpp v169, v165, v165 row_ror:8 row_mask:0xf bank_mask:0x3
v_add_f32_dpp v168, v166, v166 row_ror:8 row_mask:0xf bank_mask:0xc
v_add_f32_dpp v169, v167, v167 row_ror:8 row_mask:0xf bank_mask:0xc
s_nop 0
v_add_f32_dpp v180, v168, v168 row_half_mirror row_mask:0xf bank_mask:0x5
v_add_f32_dpp v180, v169, v169 row_half_mirror row_mask:0xf bank_mask:0xa
s_nop 1
v_add_f32_dpp v180, v180, v180 quad_perm:[1,0,3,2] row_mask:0xf bank_mask:0xf
s_nop 1
v_add_f32_dpp v180, v180, v180 quad_perm:[2,3,0,1] row_mask:0xf bank_mask:0xf
v_dot2_f32_bf16 v164, v120, v148, 0
v_dot2_f32_bf16 v165, v120, v152, 0
v_dot2_f32_bf16 v166, v120, v156, 0
v_dot2_f32_bf16 v167, v120, v160, 0
v_dot2_f32_bf16 v164, v121, v149, v164
v_dot2_f32_bf16 v165, v121, v153, v165
v_dot2_f32_bf16 v166, v121, v157, v166
v_dot2_f32_bf16 v167, v121, v161, v167
v_dot2_f32_bf16 v164, v122, v150, v164
v_dot2_f32_bf16 v165, v122, v154, v165
v_dot2_f32_bf16 v166, v122, v158, v166
v_dot2_f32_bf16 v167, v122, v162, v167
v_dot2_f32_bf16 v164, v123, v151, v164
v_dot2_f32_bf16 v165, v123, v155, v165
v_dot2_f32_bf16 v166, v123, v159, v166
v_dot2_f32_bf16 v167, v123, v163, v167
v_add_f32_dpp v168, v164, v164 row_ror:8 row_mask:0xf bank_mask:0x3
v_add_f32_dpp v169, v165, v165 row_ror:8 row_mask:0xf bank_mask:0x3
v_add_f32_dpp v168, v166, v166 row_ror:8 row_mask:0xf bank_mask:0xc
v_add_f32_dpp v169, v167, v167 row_ror:8 row_mask:0xf bank_mask:0xc
s_nop 0
v_add_f32_dpp v181, v168, v168 row_half_mirror row_mask:0xf bank_mask:0x5
v_add_f32_dpp v181, v169, v169 row_half_mirror row_mask:0xf bank_mask:0xa
s_nop 1
v_add_f32_dpp v181, v181, v181 quad_perm:[1,0,3,2] row_mask:0xf bank_mask:0xf
s_nop 1
v_add_f32_dpp v181, v181, v181 quad_perm:[2,3,0,1] row_mask:0xf bank_mask:0xf
v_dot2_f32_bf16 v164, v124, v148, 0
v_dot2_f32_bf16 v165, v124, v152, 0
v_dot2_f32_bf16 v166, v124, v156, 0
v_dot2_f32_bf16 v167, v124, v160, 0
v_dot2_f32_bf16 v164, v125, v149, v164
v_dot2_f32_bf16 v165, v125, v153, v165
v_dot2_f32_bf16 v166, v125, v157, v166
v_dot2_f32_bf16 v167, v125, v161, v167
v_dot2_f32_bf16 v164, v126, v150, v164
v_dot2_f32_bf16 v165, v126, v154, v165
v_dot2_f32_bf16 v166, v126, v158, v166
v_dot2_f32_bf16 v167, v126, v162, v167
v_dot2_f32_bf16 v164, v127, v151, v164
v_dot2_f32_bf16 v165, v127, v155, v165
v_dot2_f32_bf16 v166, v127, v159, v166
v_dot2_f32_bf16 v167, v127, v163, v167
v_add_f32_dpp v168, v164, v164 row_ror:8 row_mask:0xf bank_mask:0x3
v_add_f32_dpp v169, v165, v165 row_ror:8 row_mask:0xf bank_mask:0x3
v_add_f32_dpp v168, v166, v166 row_ror:8 row_mask:0xf bank_mask:0xc
v_add_f32_dpp v169, v167, v167 row_ror:8 row_mask:0xf bank_mask:0xc
s_nop 0
v_add_f32_dpp v182, v168, v168 row_half_mirror row_mask:0xf bank_mask:0x5
v_add_f32_dpp v182, v169, v169 row_half_mirror row_mask:0xf bank_mask:0xa
s_nop 1
v_add_f32_dpp v182, v182, v182 quad_perm:[1,0,3,2] row_mask:0xf bank_mask:0xf
s_nop 1
v_add_f32_dpp v182, v182, v182 quad_perm:[2,3,0,1] row_mask:0xf bank_mask:0xf
v_dot2_f32_bf16 v164, v128, v148, 0
v_dot2_f32_bf16 v165, v128, v152, 0
v_dot2_f32_bf16 v166, v128, v156, 0
v_dot2_f32_bf16 v167, v128, v160, 0
v_dot2_f32_bf16 v164, v129, v149, v164
v_dot2_f32_bf16 v165, v129, v153, v165
v_dot2_f32_bf16 v166, v129, v157, v166
v_dot2_f32_bf16 v167, v129, v161, v167
v_dot2_f32_bf16 v164, v130, v150, v164
v_dot2_f32_bf16 v165, v130, v154, v165
v_dot2_f32_bf16 v166, v130, v158, v166
v_dot2_f32_bf16 v167, v130, v162, v167
v_dot2_f32_bf16 v164, v131, v151, v164
v_dot2_f32_bf16 v165, v131, v155, v165
v_dot2_f32_bf16 v166, v131, v159, v166
v_dot2_f32_bf16 v167, v131, v163, v167
v_add_f32_dpp v168, v164, v164 row_ror:8 row_mask:0xf bank_mask:0x3
v_add_f32_dpp v169, v165, v165 row_ror:8 row_mask:0xf bank_mask:0x3
v_add_f32_dpp v168, v166, v166 row_ror:8 row_mask:0xf bank_mask:0xc
v_add_f32_dpp v169, v167, v167 row_ror:8 row_mask:0xf bank_mask:0xc
s_nop 0
v_add_f32_dpp v183, v168, v168 row_half_mirror row_mask:0xf bank_mask:0x5
v_add_f32_dpp v183, v169, v169 row_half_mirror row_mask:0xf bank_mask:0xa
s_nop 1
v_add_f32_dpp v183, v183, v183 quad_perm:[1,0,3,2] row_mask:0xf bank_mask:0xf
s_nop 1
v_add_f32_dpp v183, v183, v183 quad_perm:[2,3,0,1] row_mask:0xf bank_mask:0xf
v_dot2_f32_bf16 v164, v132, v148, 0
v_dot2_f32_bf16 v165, v132, v152, 0
v_dot2_f32_bf16 v166, v132, v156, 0
v_dot2_f32_bf16 v167, v132, v160, 0
v_dot2_f32_bf16 v164, v133, v149, v164
v_dot2_f32_bf16 v165, v133, v153, v165
v_dot2_f32_bf16 v166, v133, v157, v166
v_dot2_f32_bf16 v167, v133, v161, v167
v_dot2_f32_bf16 v164, v134, v150, v164
v_dot2_f32_bf16 v165, v134, v154, v165
v_dot2_f32_bf16 v166, v134, v158, v166
v_dot2_f32_bf16 v167, v134, v162, v167
v_dot2_f32_bf16 v164, v135, v151, v164
v_dot2_f32_bf16 v165, v135, v155, v165
v_dot2_f32_bf16 v166, v135, v159, v166
v_dot2_f32_bf16 v167, v135, v163, v167
v_add_f32_dpp v168, v164, v164 row_ror:8 row_mask:0xf bank_mask:0x3
v_add_f32_dpp v169, v165, v165 row_ror:8 row_mask:0xf bank_mask:0x3
v_add_f32_dpp v168, v166, v166 row_ror:8 row_mask:0xf bank_mask:0xc
v_add_f32_dpp v169, v167, v167 row_ror:8 row_mask:0xf bank_mask:0xc
s_nop 0
v_add_f32_dpp v184, v168, v168 row_half_mirror row_mask:0xf bank_mask:0x5
v_add_f32_dpp v184, v169, v169 row_half_mirror row_mask:0xf bank_mask:0xa
s_nop 1
v_add_f32_dpp v184, v184, v184 quad_perm:[1,0,3,2] row_mask:0xf bank_mask:0xf
s_nop 1
v_add_f32_dpp v184, v184, v184 quad_perm:[2,3,0,1] row_mask:0xf bank_mask:0xf
v_dot2_f32_bf16 v164, v136, v148, 0
v_dot2_f32_bf16 v165, v136, v152, 0
v_dot2_f32_bf16 v166, v136, v156, 0
v_dot2_f32_bf16 v167, v136, v160, 0
v_dot2_f32_bf16 v164, v137, v149, v164
v_dot2_f32_bf16 v165, v137, v153, v165
v_dot2_f32_bf16 v166, v137, v157, v166
v_dot2_f32_bf16 v167, v137, v161, v167
v_dot2_f32_bf16 v164, v138, v150, v164
v_dot2_f32_bf16 v165, v138, v154, v165
v_dot2_f32_bf16 v166, v138, v158, v166
v_dot2_f32_bf16 v167, v138, v162, v167
v_dot2_f32_bf16 v164, v139, v151, v164
v_dot2_f32_bf16 v165, v139, v155, v165
v_dot2_f32_bf16 v166, v139, v159, v166
v_dot2_f32_bf16 v167, v139, v163, v167
v_add_f32_dpp v168, v164, v164 row_ror:8 row_mask:0xf bank_mask:0x3
v_add_f32_dpp v169, v165, v165 row_ror:8 row_mask:0xf bank_mask:0x3
v_add_f32_dpp v168, v166, v166 row_ror:8 row_mask:0xf bank_mask:0xc
v_add_f32_dpp v169, v167, v167 row_ror:8 row_mask:0xf bank_mask:0xc
s_nop 0
v_add_f32_dpp v185, v168, v168 row_half_mirror row_mask:0xf bank_mask:0x5
v_add_f32_dpp v185, v169, v169 row_half_mirror row_mask:0xf bank_mask:0xa
s_nop 1
v_add_f32_dpp v185, v185, v185 quad_perm:[1,0,3,2] row_mask:0xf bank_mask:0xf
s_nop 1
v_add_f32_dpp v185, v185, v185 quad_perm:[2,3,0,1] row_mask:0xf bank_mask:0xf
v_dot2_f32_bf16 v164, v140, v148, 0
v_dot2_f32_bf16 v165, v140, v152, 0
v_dot2_f32_bf16 v166, v140, v156, 0
v_dot2_f32_bf16 v167, v140, v160, 0
v_dot2_f32_bf16 v164, v141, v149, v164
v_dot2_f32_bf16 v165, v141, v153, v165
v_dot2_f32_bf16 v166, v141, v157, v166
v_dot2_f32_bf16 v167, v141, v161, v167
v_dot2_f32_bf16 v164, v142, v150, v164
v_dot2_f32_bf16 v165, v142, v154, v165
v_dot2_f32_bf16 v166, v142, v158, v166
v_dot2_f32_bf16 v167, v142, v162, v167
v_dot2_f32_bf16 v164, v143, v151, v164
v_dot2_f32_bf16 v165, v143, v155, v165
v_dot2_f32_bf16 v166, v143, v159, v166
v_dot2_f32_bf16 v167, v143, v163, v167
v_add_f32_dpp v168, v164, v164 row_ror:8 row_mask:0xf bank_mask:0x3
v_add_f32_dpp v169, v165, v165 row_ror:8 row_mask:0xf bank_mask:0x3
v_add_f32_dpp v168, v166, v166 row_ror:8 row_mask:0xf bank_mask:0xc
v_add_f32_dpp v169, v167, v167 row_ror:8 row_mask:0xf bank_mask:0xc
s_nop 0
v_add_f32_dpp v186, v168, v168 row_half_mirror row_mask:0xf bank_mask:0x5
v_add_f32_dpp v186, v169, v169 row_half_mirror row_mask:0xf bank_mask:0xa
s_nop 1
v_add_f32_dpp v186, v186, v186 quad_perm:[1,0,3,2] row_mask:0xf bank_mask:0xf
s_nop 1
v_add_f32_dpp v186, v186, v186 quad_perm:[2,3,0,1] row_mask:0xf bank_mask:0xf
v_dot2_f32_bf16 v164, v144, v148, 0
v_dot2_f32_bf16 v165, v144, v152, 0
v_dot2_f32_bf16 v166, v144, v156, 0
v_dot2_f32_bf16 v167, v144, v160, 0
v_dot2_f32_bf16 v164, v145, v149, v164
v_dot2_f32_bf16 v165, v145, v153, v165
v_dot2_f32_bf16 v166, v145, v157, v166
v_dot2_f32_bf16 v167, v145, v161, v167
v_dot2_f32_bf16 v164, v146, v150, v164
v_dot2_f32_bf16 v165, v146, v154, v165
v_dot2_f32_bf16 v166, v146, v158, v166
v_dot2_f32_bf16 v167, v146, v162, v167
v_dot2_f32_bf16 v164, v147, v151, v164
v_dot2_f32_bf16 v165, v147, v155, v165
v_dot2_f32_bf16 v166, v147, v159, v166
v_dot2_f32_bf16 v167, v147, v163, v167
v_add_f32_dpp v168, v164, v164 row_ror:8 row_mask:0xf bank_mask:0x3
v_add_f32_dpp v169, v165, v165 row_ror:8 row_mask:0xf bank_mask:0x3
v_add_f32_dpp v168, v166, v166 row_ror:8 row_mask:0xf bank_mask:0xc
v_add_f32_dpp v169, v167, v167 row_ror:8 row_mask:0xf bank_mask:0xc
s_nop 0
v_add_f32_dpp v187, v168, v168 row_half_mirror row_mask:0xf bank_mask:0x5
v_add_f32_dpp v187, v169, v169 row_half_mirror row_mask:0xf bank_mask:0xa
s_nop 1
v_add_f32_dpp v187, v187, v187 quad_perm:[1,0,3,2] row_mask:0xf bank_mask:0xf
s_nop 1
v_add_f32_dpp v187, v187, v187 quad_perm:[2,3,0,1] row_mask:0xf bank_mask:0xf
v_cvt_pk_bf16_f32 v188, v172, v173
v_cvt_pk_bf16_f32 v189, v174, v175
v_cvt_pk_bf16_f32 v190, v176, v177
v_cvt_pk_bf16_f32 v191, v178, v179
v_cvt_pk_bf16_f32 v192, v180, v181
v_cvt_pk_bf16_f32 v193, v182, v183
v_cvt_pk_bf16_f32 v194, v184, v185
v_cvt_pk_bf16_f32 v195, v186, v187
v_min_u32 v188, -2, v188
v_min_u32 v189, -2, v189
v_min_u32 v190, -2, v190
v_min_u32 v191, -2, v191
v_min_u32 v192, -2, v192
v_min_u32 v193, -2, v193
v_min_u32 v194, -2, v194
v_min_u32 v195, -2, v195
v_bfe_u32 v5, v1, 2, 2
v_lshlrev_b32 v5, 15, v5
v_lshl_add_u32 v5, v9, 5, v5
s_lshl_b32 s6, s4, 10
s_lshl_b32 s7, s8, 9
s_add_u32 s6, s6, s7
s_lshl_b32 s7, s3, 7
s_add_u32 s6, s6, s7
s_add_u32 s6, s6, 0
v_and_b32 v6, 1, v1
v_lshl_add_u32 v5, v6, 4, v5
v_cmp_eq_u32 vcc, 1, v6
s_nop 1
v_cndmask_b32 v188, v188, v192, vcc
v_cndmask_b32 v189, v189, v193, vcc
v_cndmask_b32 v190, v190, v194, vcc
v_cndmask_b32 v191, v191, v195, vcc
s_mov_b32 exec_lo, 0x33333333
s_mov_b32 exec_hi, 0x33333333
buffer_store_dwordx4 v[188:191], v5, s[64:67], s6 offen sc1
s_mov_b64 exec, -1
s_waitcnt vmcnt(5)
s_mov_b32 s7, 400000
L_ens_16:
v_readfirstlane_b32 s6, v11
s_cmp_ge_u32 s6, 128
s_cbranch_scc1 L_ensd_17
s_sleep 16
buffer_load_dword v11, off, s[68:71], 0 offset:0 sc1
s_waitcnt vmcnt(0)
s_sub_u32 s7, s7, 1
s_cmp_lg_u32 s7, 0
s_cbranch_scc1 L_ens_16
L_ensd_17:
s_lshl_b32 s14, s10, 15
s_lshl_b32 s6, s3, 12
s_add_u32 s14, s14, s6
s_add_u32 s14, s14, 0
s_add_u32 s15, s14, 16384
s_nop 1
buffer_load_dwordx4 v[84:87], v2, s[64:67], s14 offen offset:0 sc1
buffer_load_dwordx4 v[88:91], v2, s[64:67], s14 offen offset:1024 sc1
buffer_load_dwordx4 v[92:95], v2, s[64:67], s14 offen offset:2048 sc1
buffer_load_dwordx4 v[96:99], v2, s[64:67], s14 offen offset:3072 sc1
buffer_load_dwordx4 v[100:103], v2, s[64:67], s15 offen offset:0 sc1
buffer_load_dwordx4 v[104:107], v2, s[64:67], s15 offen offset:1024 sc1
buffer_load_dwordx4 v[108:111], v2, s[64:67], s15 offen offset:2048 sc1
buffer_load_dwordx4 v[112:115], v2, s[64:67], s15 offen offset:3072 sc1
s_add_u32 s6, s13, 2097152
buffer_load_dwordx4 a[128:131], v2, s[52:55], s6 offen nt
s_add_u32 s6, s13, 2098176
buffer_load_dwordx4 a[132:135], v2, s[52:55], s6 offen nt
s_add_u32 s6, s13, 2099200
buffer_load_dwordx4 a[136:139], v2, s[52:55], s6 offen nt
s_add_u32 s6, s13, 2100224
buffer_load_dwordx4 a[140:143], v2, s[52:55], s6 offen nt
s_add_u32 s6, s13, 2359296
buffer_load_dwordx4 a[144:147], v2, s[52:55], s6 offen nt
s_add_u32 s6, s13, 2360320
buffer_load_dwordx4 a[148:151], v2, s[52:55], s6 offen nt
s_add_u32 s6, s13, 2361344
buffer_load_dwordx4 a[152:155], v2, s[52:55], s6 offen nt
s_add_u32 s6, s13, 2362368
buffer_load_dwordx4 a[156:159], v2, s[52:55], s6 offen nt
s_add_u32 s6, s13, 2621440
buffer_load_dwordx4 a[160:163], v10, s[52:55], s6 offen nt
s_add_u32 s6, s13, 2622464
buffer_load_dwordx4 a[164:167], v10, s[52:55], s6 offen nt
s_add_u32 s6, s13, 2623488
buffer_load_dwordx4 a[168:171], v10, s[52:55], s6 offen nt
s_add_u32 s6, s13, 2624512
buffer_load_dwordx4 a[172:175], v10, s[52:55], s6 offen nt
s_add_u32 s6, s13, 2883584
buffer_load_dwordx4 a[176:179], v10, s[52:55], s6 offen nt
s_add_u32 s6, s13, 2884608
buffer_load_dwordx4 a[180:183], v10, s[52:55], s6 offen nt
s_add_u32 s6, s13, 2885632
buffer_load_dwordx4 a[184:187], v10, s[52:55], s6 offen nt
s_add_u32 s6, s13, 2886656
buffer_load_dwordx4 a[188:191], v10, s[52:55], s6 offen nt
s_add_u32 s6, s13, 3145728
buffer_load_dwordx4 a[192:195], v2, s[52:55], s6 offen nt
s_add_u32 s6, s13, 3146752
buffer_load_dwordx4 a[196:199], v2, s[52:55], s6 offen nt
s_add_u32 s6, s13, 3147776
buffer_load_dwordx4 a[200:203], v2, s[52:55], s6 offen nt
s_add_u32 s6, s13, 3148800
buffer_load_dwordx4 a[204:207], v2, s[52:55], s6 offen nt
s_add_u32 s6, s13, 3407872
buffer_load_dwordx4 a[208:211], v2, s[52:55], s6 offen nt
s_add_u32 s6, s13, 3408896
buffer_load_dwordx4 a[212:215], v2, s[52:55], s6 offen nt
s_add_u32 s6, s13, 3409920
buffer_load_dwordx4 a[216:219], v2, s[52:55], s6 offen nt
s_add_u32 s6, s13, 3410944
buffer_load_dwordx4 a[220:223], v2, s[52:55], s6 offen nt
s_add_u32 s6, s13, 3670016
buffer_load_dwordx4 a[224:227], v10, s[52:55], s6 offen nt
s_add_u32 s6, s13, 3671040
buffer_load_dwordx4 a[228:231], v10, s[52:55], s6 offen nt
s_add_u32 s6, s13, 3672064
buffer_load_dwordx4 a[232:235], v10, s[52:55], s6 offen nt
s_add_u32 s6, s13, 3673088
buffer_load_dwordx4 a[236:239], v10, s[52:55], s6 offen nt
s_add_u32 s6, s13, 3932160
buffer_load_dwordx4 a[240:243], v10, s[52:55], s6 offen nt
s_add_u32 s6, s13, 3933184
buffer_load_dwordx4 a[244:247], v10, s[52:55], s6 offen nt
s_add_u32 s6, s13, 3934208
buffer_load_dwordx4 a[248:251], v10, s[52:55], s6 offen nt
s_add_u32 s6, s13, 3935232
buffer_load_dwordx4 a[252:255], v10, s[52:55], s6 offen nt
s_lshl_b32 s6, s3, 4
v_add_u32 v5, s6, v8
v_mul_u32_u24 v5, 1088, v5
v_lshrrev_b32 v6, 3, v8
v_lshlrev_b32 v6, 1, v6
v_xor_b32 v6, v6, v9
v_lshl_add_u32 v194, v6, 4, v5
v_add_u32 v195, 69632, v194
v_lshrrev_b32 v5, 5, v1
v_lshlrev_b32 v5, 3, v5
v_bfe_u32 v6, v1, 2, 2
v_add_u32 v5, v5, v6
v_mul_u32_u24 v5, 1088, v5
v_lshrrev_b32 v6, 1, v9
v_xor_b32 v6, v6, v9
v_and_b32 v6, 1, v6
v_lshl_add_u32 v5, v6, 5, v5
v_and_b32 v6, 3, v1
v_lshl_add_u32 v5, v6, 3, v5
s_lshl_b32 s6, s3, 8
v_add_u32 v196, s6, v5
v_add_u32 v197, 69632, v196
v_lshlrev_b32 v199, 4, v8
v_add_u32 v199, 160256, v199
s_lshl_b32 s6, s3, 2
v_add_u32 v198, s6, v199
v_and_b32 v5, 31, v1
v_lshlrev_b32 v200, 4, v5
v_add_u32 v200, 160256, v200
v_lshlrev_b32 v202, 5, v5
v_lshrrev_b32 v6, 5, v1
v_lshl_add_u32 v202, v6, 4, v202
v_add_u32 v202, 156160, v202
v_lshlrev_b32 v201, 5, v8
v_lshl_add_u32 v201, v9, 3, v201
s_lshl_b32 s6, s3, 10
s_add_u32 s6, s6, 156160
v_add_u32 v201, s6, v201
v_mul_u32_u24 v203, 1056, v8
v_lshl_add_u32 v203, v9, 4, v203
v_add_u32 v203, 139264, v203
s_mul_i32 s6, s3, 4224
s_add_u32 s6, s6, 139264
v_add_u32 v204, s6, v2
v_add_u32 v206, s12, v2
v_add_u32 v207, 69632, v206
v_mov_b32 v185, 0x3e0293ee
v_mov_b32 v176, 0xff800000
v_mov_b32 v177, 0xff800000
v_mov_b32 v178, 0xff800000
v_mov_b32 v180, 0
v_mov_b32 v181, 0
s_waitcnt vmcnt(32)
s_mov_b32 s7, 400000
Q_chk:
v_max3_u32 v192, v84, v85, v86
v_max3_u32 v192, v192, v87, v88
v_max3_u32 v192, v192, v89, v90
v_max3_u32 v192, v192, v91, v92
v_max3_u32 v192, v192, v93, v94
v_max3_u32 v192, v192, v95, v96
v_max3_u32 v192, v192, v97, v98
v_max3_u32 v192, v192, v99, v100
v_max3_u32 v192, v192, v101, v102
v_max3_u32 v192, v192, v103, v104
v_max3_u32 v192, v192, v105, v106
v_max3_u32 v192, v192, v107, v108
v_max3_u32 v192, v192, v109, v110
v_max3_u32 v192, v192, v111, v112
v_max3_u32 v192, v192, v113, v114
v_max_u32 v192, v192, v115
v_cmp_eq_u32 vcc, -1, v192
s_cbranch_vccz Q_ok
s_sleep 16
buffer_load_dwordx4 v[84:87], v2, s[64:67], s14 offen offset:0 sc1
buffer_load_dwordx4 v[88:91], v2, s[64:67], s14 offen offset:1024 sc1
buffer_load_dwordx4 v[92:95], v2, s[64:67], s14 offen offset:2048 sc1
buffer_load_dwordx4 v[96:99], v2, s[64:67], s14 offen offset:3072 sc1
buffer_load_dwordx4 v[100:103], v2, s[64:67], s15 offen offset:0 sc1
buffer_load_dwordx4 v[104:107], v2, s[64:67], s15 offen offset:1024 sc1
buffer_load_dwordx4 v[108:111], v2, s[64:67], s15 offen offset:2048 sc1
buffer_load_dwordx4 v[112:115], v2, s[64:67], s15 offen offset:3072 sc1
s_waitcnt vmcnt(0)
s_sub_u32 s7, s7, 1
s_cmp_lg_u32 s7, 0
s_cbranch_scc1 Q_chk
Q_ok:
s_barrier
ds_write_b128 v204, v[84:87] offset:0
ds_write_b128 v204, v[88:91] offset:1056
ds_write_b128 v204, v[92:95] offset:2112
ds_write_b128 v204, v[96:99] offset:3168
s_waitcnt lgkmcnt(0)
s_barrier
ds_read_b128 a[0:3], v203 offset:0
ds_read_b128 a[4:7], v203 offset:64
ds_read_b128 a[8:11], v203 offset:128
ds_read_b128 a[12:15], v203 offset:192
ds_read_b128 a[16:19], v203 offset:256
ds_read_b128 a[20:23], v203 offset:320
ds_read_b128 a[24:27], v203 offset:384
ds_read_b128 a[28:31], v203 offset:448
ds_read_b128 a[32:35], v203 offset:512
ds_read_b128 a[36:39], v203 offset:576
ds_read_b128 a[40:43], v203 offset:640
ds_read_b128 a[44:47], v203 offset:704
ds_read_b128 a[48:51], v203 offset:768
ds_read_b128 a[52:55], v203 offset:832
ds_read_b128 a[56:59], v203 offset:896
ds_read_b128 a[60:63], v203 offset:960
s_waitcnt lgkmcnt(0)
s_barrier
ds_write_b128 v204, v[100:103] offset:0
ds_write_b128 v204, v[104:107] offset:1056
ds_write_b128 v204, v[108:111] offset:2112
ds_write_b128 v204, v[112:115] offset:3168
s_waitcnt lgkmcnt(0)
s_barrier
ds_read_b128 a[64:67], v203 offset:0
ds_read_b128 a[68:71], v203 offset:64
ds_read_b128 a[72:75], v203 offset:128
ds_read_b128 a[76:79], v203 offset:192
ds_read_b128 a[80:83], v203 offset:256
ds_read_b128 a[84:87], v203 offset:320
ds_read_b128 a[88:91], v203 offset:384
ds_read_b128 a[92:95], v203 offset:448
ds_read_b128 a[96:99], v203 offset:512
ds_read_b128 a[100:103], v203 offset:576
ds_read_b128 a[104:107], v203 offset:640
ds_read_b128 a[108:111], v203 offset:704
ds_read_b128 a[112:115], v203 offset:768
ds_read_b128 a[116:119], v203 offset:832
ds_read_b128 a[120:123], v203 offset:896
ds_read_b128 a[124:127], v203 offset:960
s_waitcnt lgkmcnt(0)
ds_read_b128 v[84:87], v194 offset:0
ds_read_b128 v[88:91], v194 offset:64
ds_read_b128 v[92:95], v194 offset:128
ds_read_b128 v[96:99], v194 offset:192
ds_read_b128 v[100:103], v194 offset:256
ds_read_b128 v[104:107], v194 offset:320
ds_read_b128 v[108:111], v194 offset:384
ds_read_b128 v[112:115], v194 offset:448
ds_read_b128 v[116:119], v194 offset:512
ds_read_b128 v[120:123], v194 offset:576
ds_read_b128 v[124:127], v194 offset:640
ds_read_b128 v[128:131], v194 offset:704
ds_read_b128 v[132:135], v194 offset:768
ds_read_b128 v[136:139], v194 offset:832
ds_read_b128 v[140:143], v194 offset:896
ds_read_b128 v[144:147], v194 offset:960
s_waitcnt lgkmcnt(15)
v_mfma_f32_16x16x32_bf16 v[76:79], v[84:87], a[0:3], 0
v_mfma_f32_16x16x32_bf16 v[80:83], v[84:87], a[64:67], 0
s_waitcnt lgkmcnt(14)
v_mfma_f32_16x16x32_bf16 v[76:79], v[88:91], a[4:7], v[76:79]
v_mfma_f32_16x16x32_bf16 v[80:83], v[88:91], a[68:71], v[80:83]
s_waitcnt lgkmcnt(13)
v_mfma_f32_16x16x32_bf16 v[76:79], v[92:95], a[8:11], v[76:79]
v_mfma_f32_16x16x32_bf16 v[80:83], v[92:95], a[72:75], v[80:83]
s_waitcnt lgkmcnt(12)
v_mfma_f32_16x16x32_bf16 v[76:79], v[96:99], a[12:15], v[76:79]
v_mfma_f32_16x16x32_bf16 v[80:83], v[96:99], a[76:79], v[80:83]
s_waitcnt lgkmcnt(11)
v_mfma_f32_16x16x32_bf16 v[76:79], v[100:103], a[16:19], v[76:79]
v_mfma_f32_16x16x32_bf16 v[80:83], v[100:103], a[80:83], v[80:83]
s_waitcnt lgkmcnt(10)
v_mfma_f32_16x16x32_bf16 v[76:79], v[104:107], a[20:23], v[76:79]
v_mfma_f32_16x16x32_bf16 v[80:83], v[104:107], a[84:87], v[80:83]
s_waitcnt lgkmcnt(9)
v_mfma_f32_16x16x32_bf16 v[76:79], v[108:111], a[24:27], v[76:79]
v_mfma_f32_16x16x32_bf16 v[80:83], v[108:111], a[88:91], v[80:83]
s_waitcnt lgkmcnt(8)
v_mfma_f32_16x16x32_bf16 v[76:79], v[112:115], a[28:31], v[76:79]
v_mfma_f32_16x16x32_bf16 v[80:83], v[112:115], a[92:95], v[80:83]
s_waitcnt lgkmcnt(7)
v_mfma_f32_16x16x32_bf16 v[76:79], v[116:119], a[32:35], v[76:79]
v_mfma_f32_16x16x32_bf16 v[80:83], v[116:119], a[96:99], v[80:83]
s_waitcnt lgkmcnt(6)
v_mfma_f32_16x16x32_bf16 v[76:79], v[120:123], a[36:39], v[76:79]
v_mfma_f32_16x16x32_bf16 v[80:83], v[120:123], a[100:103], v[80:83]
s_waitcnt lgkmcnt(5)
v_mfma_f32_16x16x32_bf16 v[76:79], v[124:127], a[40:43], v[76:79]
v_mfma_f32_16x16x32_bf16 v[80:83], v[124:127], a[104:107], v[80:83]
s_waitcnt lgkmcnt(4)
v_mfma_f32_16x16x32_bf16 v[76:79], v[128:131], a[44:47], v[76:79]
v_mfma_f32_16x16x32_bf16 v[80:83], v[128:131], a[108:111], v[80:83]
s_waitcnt lgkmcnt(3)
v_mfma_f32_16x16x32_bf16 v[76:79], v[132:135], a[48:51], v[76:79]
v_mfma_f32_16x16x32_bf16 v[80:83], v[132:135], a[112:115], v[80:83]
s_waitcnt lgkmcnt(2)
v_mfma_f32_16x16x32_bf16 v[76:79], v[136:139], a[52:55], v[76:79]
v_mfma_f32_16x16x32_bf16 v[80:83], v[136:139], a[116:119], v[80:83]
s_waitcnt lgkmcnt(1)
v_mfma_f32_16x16x32_bf16 v[76:79], v[140:143], a[56:59], v[76:79]
v_mfma_f32_16x16x32_bf16 v[80:83], v[140:143], a[120:123], v[80:83]
s_waitcnt lgkmcnt(0)
v_mfma_f32_16x16x32_bf16 v[76:79], v[144:147], a[60:63], v[76:79]
v_mfma_f32_16x16x32_bf16 v[80:83], v[144:147], a[124:127], v[80:83]
s_nop 6
v_max_f32 v190, v76, v77
v_max3_f32 v190, v190, v78, v79
v_mov_b32 v192, v190
s_nop 1
v_permlane16_swap_b32 v190, v192
v_max_f32 v190, v190, v192
v_mov_b32 v192, v190
s_nop 1
v_permlane32_swap_b32 v190, v192
v_max_f32 v190, v190, v192
ds_write_b32 v198, v190 offset:0
v_max_f32 v191, v80, v81
v_max3_f32 v191, v191, v82, v83
v_mov_b32 v192, v191
s_nop 1
v_permlane16_swap_b32 v191, v192
v_max_f32 v191, v191, v192
v_mov_b32 v192, v191
s_nop 1
v_permlane32_swap_b32 v191, v192
v_max_f32 v191, v191, v192
ds_write_b32 v198, v191 offset:256
s_waitcnt lgkmcnt(0)
s_barrier
ds_read_b128 v[164:167], v199
ds_read_b128 v[168:171], v199 offset:256
ds_read_b128 v[172:175], v200
s_waitcnt lgkmcnt(0)
v_max_f32 v164, v164, v165
v_max3_f32 v164, v164, v166, v167
v_mul_f32 v164, v164, v185
v_max_f32 v164, v164, v176
v_sub_f32 v182, v176, v164
v_exp_f32 v182, v182
v_mov_b32 v176, v164
v_max_f32 v168, v168, v169
v_max3_f32 v168, v168, v170, v171
v_mul_f32 v168, v168, v185
v_max_f32 v168, v168, v177
v_sub_f32 v183, v177, v168
v_exp_f32 v183, v183
v_mov_b32 v177, v168
v_max_f32 v172, v172, v173
v_max3_f32 v172, v172, v174, v175
v_mul_f32 v172, v172, v185
v_max_f32 v172, v172, v178
v_sub_f32 v184, v178, v172
v_exp_f32 v184, v184
v_mov_b32 v178, v172
v_fma_f32 v76, v76, v185, -v176
v_fma_f32 v77, v77, v185, -v176
v_fma_f32 v78, v78, v185, -v176
v_fma_f32 v79, v79, v185, -v176
v_exp_f32 v76, v76
v_exp_f32 v77, v77
v_exp_f32 v78, v78
v_exp_f32 v79, v79
v_mul_f32 v180, v180, v182
v_cvt_pk_bf16_f32 v186, v76, v77
v_cvt_pk_bf16_f32 v187, v78, v79
ds_write_b64 v201, v[186:187] offset:0
v_add_f32 v180, v180, v76
v_add_f32 v180, v180, v77
v_add_f32 v180, v180, v78
v_add_f32 v180, v180, v79
v_fma_f32 v80, v80, v185, -v177
v_fma_f32 v81, v81, v185, -v177
v_fma_f32 v82, v82, v185, -v177
v_fma_f32 v83, v83, v185, -v177
v_exp_f32 v80, v80
v_exp_f32 v81, v81
v_exp_f32 v82, v82
v_exp_f32 v83, v83
v_mul_f32 v181, v181, v183
v_cvt_pk_bf16_f32 v188, v80, v81
v_cvt_pk_bf16_f32 v189, v82, v83
ds_write_b64 v201, v[188:189] offset:512
v_add_f32 v181, v181, v80
v_add_f32 v181, v181, v81
v_add_f32 v181, v181, v82
v_add_f32 v181, v181, v83
s_waitcnt lgkmcnt(0)
s_barrier
ds_read_b128 v[148:151], v202 offset:0
ds_read_b128 v[152:155], v202 offset:1024
ds_read_b128 v[156:159], v202 offset:2048
ds_read_b128 v[160:163], v202 offset:3072
ds_read_b64_tr_b16 v[84:85], v196 offset:0
ds_read_b64_tr_b16 v[86:87], v196 offset:4352
ds_read_b64_tr_b16 v[88:89], v196 offset:64
ds_read_b64_tr_b16 v[90:91], v196 offset:4416
ds_read_b64_tr_b16 v[92:93], v196 offset:128
ds_read_b64_tr_b16 v[94:95], v196 offset:4480
ds_read_b64_tr_b16 v[96:97], v196 offset:192
ds_read_b64_tr_b16 v[98:99], v196 offset:4544
ds_read_b64_tr_b16 v[100:101], v196 offset:17408
ds_read_b64_tr_b16 v[102:103], v196 offset:21760
ds_read_b64_tr_b16 v[104:105], v196 offset:17472
ds_read_b64_tr_b16 v[106:107], v196 offset:21824
ds_read_b64_tr_b16 v[108:109], v196 offset:17536
ds_read_b64_tr_b16 v[110:111], v196 offset:21888
ds_read_b64_tr_b16 v[112:113], v196 offset:17600
ds_read_b64_tr_b16 v[114:115], v196 offset:21952
ds_read_b64_tr_b16 v[116:117], v196 offset:34816
ds_read_b64_tr_b16 v[118:119], v196 offset:39168
ds_read_b64_tr_b16 v[120:121], v196 offset:34880
ds_read_b64_tr_b16 v[122:123], v196 offset:39232
ds_read_b64_tr_b16 v[124:125], v196 offset:34944
ds_read_b64_tr_b16 v[126:127], v196 offset:39296
ds_read_b64_tr_b16 v[128:129], v196 offset:35008
ds_read_b64_tr_b16 v[130:131], v196 offset:39360
ds_read_b64_tr_b16 v[132:133], v196 offset:52224
ds_read_b64_tr_b16 v[134:135], v196 offset:56576
ds_read_b64_tr_b16 v[136:137], v196 offset:52288
ds_read_b64_tr_b16 v[138:139], v196 offset:56640
ds_read_b64_tr_b16 v[140:141], v196 offset:52352
ds_read_b64_tr_b16 v[142:143], v196 offset:56704
ds_read_b64_tr_b16 v[144:145], v196 offset:52416
ds_read_b64_tr_b16 v[146:147], v196 offset:56768
s_waitcnt lgkmcnt(15)
v_mfma_f32_32x32x16_bf16 v[12:27], v[84:87], v[148:151], 0
v_mfma_f32_32x32x16_bf16 v[28:43], v[88:91], v[148:151], 0
v_mfma_f32_32x32x16_bf16 v[44:59], v[92:95], v[148:151], 0
v_mfma_f32_32x32x16_bf16 v[60:75], v[96:99], v[148:151], 0
s_waitcnt lgkmcnt(15)
v_mfma_f32_32x32x16_bf16 v[12:27], v[100:103], v[152:155], v[12:27]
v_mfma_f32_32x32x16_bf16 v[28:43], v[104:107], v[152:155], v[28:43]
v_mfma_f32_32x32x16_bf16 v[44:59], v[108:111], v[152:155], v[44:59]
v_mfma_f32_32x32x16_bf16 v[60:75], v[112:115], v[152:155], v[60:75]
s_waitcnt lgkmcnt(8)
v_mfma_f32_32x32x16_bf16 v[12:27], v[116:119], v[156:159], v[12:27]
v_mfma_f32_32x32x16_bf16 v[28:43], v[120:123], v[156:159], v[28:43]
v_mfma_f32_32x32x16_bf16 v[44:59], v[124:127], v[156:159], v[44:59]
v_mfma_f32_32x32x16_bf16 v[60:75], v[128:131], v[156:159], v[60:75]
s_waitcnt lgkmcnt(0)
v_mfma_f32_32x32x16_bf16 v[12:27], v[132:135], v[160:163], v[12:27]
v_mfma_f32_32x32x16_bf16 v[28:43], v[136:139], v[160:163], v[28:43]
v_mfma_f32_32x32x16_bf16 v[44:59], v[140:143], v[160:163], v[44:59]
v_mfma_f32_32x32x16_bf16 v[60:75], v[144:147], v[160:163], v[60:75]
ds_read_b128 v[84:87], v195 offset:0
ds_read_b128 v[88:91], v195 offset:64
ds_read_b128 v[92:95], v195 offset:128
ds_read_b128 v[96:99], v195 offset:192
ds_read_b128 v[100:103], v195 offset:256
ds_read_b128 v[104:107], v195 offset:320
ds_read_b128 v[108:111], v195 offset:384
ds_read_b128 v[112:115], v195 offset:448
ds_read_b128 v[116:119], v195 offset:512
ds_read_b128 v[120:123], v195 offset:576
ds_read_b128 v[124:127], v195 offset:640
ds_read_b128 v[128:131], v195 offset:704
ds_read_b128 v[132:135], v195 offset:768
ds_read_b128 v[136:139], v195 offset:832
ds_read_b128 v[140:143], v195 offset:896
ds_read_b128 v[144:147], v195 offset:960
s_waitcnt lgkmcnt(15)
v_mfma_f32_16x16x32_bf16 v[76:79], v[84:87], a[0:3], 0
v_mfma_f32_16x16x32_bf16 v[80:83], v[84:87], a[64:67], 0
s_waitcnt lgkmcnt(14)
v_mfma_f32_16x16x32_bf16 v[76:79], v[88:91], a[4:7], v[76:79]
v_mfma_f32_16x16x32_bf16 v[80:83], v[88:91], a[68:71], v[80:83]
s_waitcnt lgkmcnt(13)
v_mfma_f32_16x16x32_bf16 v[76:79], v[92:95], a[8:11], v[76:79]
v_mfma_f32_16x16x32_bf16 v[80:83], v[92:95], a[72:75], v[80:83]
s_waitcnt lgkmcnt(12)
v_mfma_f32_16x16x32_bf16 v[76:79], v[96:99], a[12:15], v[76:79]
v_mfma_f32_16x16x32_bf16 v[80:83], v[96:99], a[76:79], v[80:83]
s_waitcnt lgkmcnt(11)
v_mfma_f32_16x16x32_bf16 v[76:79], v[100:103], a[16:19], v[76:79]
v_mfma_f32_16x16x32_bf16 v[80:83], v[100:103], a[80:83], v[80:83]
s_waitcnt lgkmcnt(10)
v_mfma_f32_16x16x32_bf16 v[76:79], v[104:107], a[20:23], v[76:79]
v_mfma_f32_16x16x32_bf16 v[80:83], v[104:107], a[84:87], v[80:83]
s_waitcnt lgkmcnt(9)
v_mfma_f32_16x16x32_bf16 v[76:79], v[108:111], a[24:27], v[76:79]
v_mfma_f32_16x16x32_bf16 v[80:83], v[108:111], a[88:91], v[80:83]
s_waitcnt lgkmcnt(8)
v_mfma_f32_16x16x32_bf16 v[76:79], v[112:115], a[28:31], v[76:79]
v_mfma_f32_16x16x32_bf16 v[80:83], v[112:115], a[92:95], v[80:83]
s_waitcnt lgkmcnt(7)
v_mfma_f32_16x16x32_bf16 v[76:79], v[116:119], a[32:35], v[76:79]
v_mfma_f32_16x16x32_bf16 v[80:83], v[116:119], a[96:99], v[80:83]
s_waitcnt lgkmcnt(6)
v_mfma_f32_16x16x32_bf16 v[76:79], v[120:123], a[36:39], v[76:79]
v_mfma_f32_16x16x32_bf16 v[80:83], v[120:123], a[100:103], v[80:83]
s_waitcnt lgkmcnt(5)
v_mfma_f32_16x16x32_bf16 v[76:79], v[124:127], a[40:43], v[76:79]
v_mfma_f32_16x16x32_bf16 v[80:83], v[124:127], a[104:107], v[80:83]
s_waitcnt lgkmcnt(4)
v_mfma_f32_16x16x32_bf16 v[76:79], v[128:131], a[44:47], v[76:79]
v_mfma_f32_16x16x32_bf16 v[80:83], v[128:131], a[108:111], v[80:83]
s_waitcnt lgkmcnt(3)
v_mfma_f32_16x16x32_bf16 v[76:79], v[132:135], a[48:51], v[76:79]
v_mfma_f32_16x16x32_bf16 v[80:83], v[132:135], a[112:115], v[80:83]
s_waitcnt lgkmcnt(2)
v_mfma_f32_16x16x32_bf16 v[76:79], v[136:139], a[52:55], v[76:79]
v_mfma_f32_16x16x32_bf16 v[80:83], v[136:139], a[116:119], v[80:83]
s_waitcnt lgkmcnt(1)
v_mfma_f32_16x16x32_bf16 v[76:79], v[140:143], a[56:59], v[76:79]
v_mfma_f32_16x16x32_bf16 v[80:83], v[140:143], a[120:123], v[80:83]
s_waitcnt lgkmcnt(0)
v_mfma_f32_16x16x32_bf16 v[76:79], v[144:147], a[60:63], v[76:79]
v_mfma_f32_16x16x32_bf16 v[80:83], v[144:147], a[124:127], v[80:83]
s_nop 6
v_max_f32 v190, v76, v77
v_max3_f32 v190, v190, v78, v79
v_mov_b32 v192, v190
s_nop 1
v_permlane16_swap_b32 v190, v192
v_max_f32 v190, v190, v192
v_mov_b32 v192, v190
s_nop 1
v_permlane32_swap_b32 v190, v192
v_max_f32 v190, v190, v192
ds_write_b32 v198, v190 offset:0
v_max_f32 v191, v80, v81
v_max3_f32 v191, v191, v82, v83
v_mov_b32 v192, v191
s_nop 1
v_permlane16_swap_b32 v191, v192
v_max_f32 v191, v191, v192
v_mov_b32 v192, v191
s_nop 1
v_permlane32_swap_b32 v191, v192
v_max_f32 v191, v191, v192
ds_write_b32 v198, v191 offset:256
s_waitcnt lgkmcnt(0)
s_barrier
ds_read_b128 v[164:167], v199
ds_read_b128 v[168:171], v199 offset:256
ds_read_b128 v[172:175], v200
s_waitcnt vmcnt(16)
ds_write_b128 v206, a[128:131] offset:0
ds_write_b128 v206, a[132:135] offset:1088
ds_write_b128 v206, a[136:139] offset:2176
ds_write_b128 v206, a[140:143] offset:3264
ds_write_b128 v206, a[144:147] offset:4352
ds_write_b128 v206, a[148:151] offset:5440
ds_write_b128 v206, a[152:155] offset:6528
ds_write_b128 v206, a[156:159] offset:7616
ds_write_b128 v206, a[160:163] offset:8704
ds_write_b128 v206, a[164:167] offset:9792
ds_write_b128 v206, a[168:171] offset:10880
ds_write_b128 v206, a[172:175] offset:11968
ds_write_b128 v206, a[176:179] offset:13056
ds_write_b128 v206, a[180:183] offset:14144
ds_write_b128 v206, a[184:187] offset:15232
ds_write_b128 v206, a[188:191] offset:16320
s_waitcnt lgkmcnt(15)
v_max_f32 v164, v164, v165
v_max3_f32 v164, v164, v166, v167
v_mul_f32 v164, v164, v185
v_max_f32 v164, v164, v176
v_sub_f32 v182, v176, v164
v_exp_f32 v182, v182
v_mov_b32 v176, v164
v_max_f32 v168, v168, v169
v_max3_f32 v168, v168, v170, v171
v_mul_f32 v168, v168, v185
v_max_f32 v168, v168, v177
v_sub_f32 v183, v177, v168
v_exp_f32 v183, v183
v_mov_b32 v177, v168
v_max_f32 v172, v172, v173
v_max3_f32 v172, v172, v174, v175
v_mul_f32 v172, v172, v185
v_max_f32 v172, v172, v178
v_sub_f32 v184, v178, v172
v_exp_f32 v184, v184
v_mov_b32 v178, v172
v_fma_f32 v76, v76, v185, -v176
v_fma_f32 v77, v77, v185, -v176
v_fma_f32 v78, v78, v185, -v176
v_fma_f32 v79, v79, v185, -v176
v_exp_f32 v76, v76
v_exp_f32 v77, v77
v_exp_f32 v78, v78
v_exp_f32 v79, v79
v_mul_f32 v180, v180, v182
v_cvt_pk_bf16_f32 v186, v76, v77
v_cvt_pk_bf16_f32 v187, v78, v79
ds_write_b64 v201, v[186:187] offset:0
v_add_f32 v180, v180, v76
v_add_f32 v180, v180, v77
v_add_f32 v180, v180, v78
v_add_f32 v180, v180, v79
v_fma_f32 v80, v80, v185, -v177
v_fma_f32 v81, v81, v185, -v177
v_fma_f32 v82, v82, v185, -v177
v_fma_f32 v83, v83, v185, -v177
v_exp_f32 v80, v80
v_exp_f32 v81, v81
v_exp_f32 v82, v82
v_exp_f32 v83, v83
v_mul_f32 v181, v181, v183
v_cvt_pk_bf16_f32 v188, v80, v81
v_cvt_pk_bf16_f32 v189, v82, v83
ds_write_b64 v201, v[188:189] offset:512
v_add_f32 v181, v181, v80
v_add_f32 v181, v181, v81
v_add_f32 v181, v181, v82
v_add_f32 v181, v181, v83
v_mul_f32 v12, v12, v184
v_mul_f32 v13, v13, v184
v_mul_f32 v14, v14, v184
v_mul_f32 v15, v15, v184
v_mul_f32 v16, v16, v184
v_mul_f32 v17, v17, v184
v_mul_f32 v18, v18, v184
v_mul_f32 v19, v19, v184
v_mul_f32 v20, v20, v184
v_mul_f32 v21, v21, v184
v_mul_f32 v22, v22, v184
v_mul_f32 v23, v23, v184
v_mul_f32 v24, v24, v184
v_mul_f32 v25, v25, v184
v_mul_f32 v26, v26, v184
v_mul_f32 v27, v27, v184
v_mul_f32 v28, v28, v184
v_mul_f32 v29, v29, v184
v_mul_f32 v30, v30, v184
v_mul_f32 v31, v31, v184
v_mul_f32 v32, v32, v184
v_mul_f32 v33, v33, v184
v_mul_f32 v34, v34, v184
v_mul_f32 v35, v35, v184
v_mul_f32 v36, v36, v184
v_mul_f32 v37, v37, v184
v_mul_f32 v38, v38, v184
v_mul_f32 v39, v39, v184
v_mul_f32 v40, v40, v184
v_mul_f32 v41, v41, v184
v_mul_f32 v42, v42, v184
v_mul_f32 v43, v43, v184
v_mul_f32 v44, v44, v184
v_mul_f32 v45, v45, v184
v_mul_f32 v46, v46, v184
v_mul_f32 v47, v47, v184
v_mul_f32 v48, v48, v184
v_mul_f32 v49, v49, v184
v_mul_f32 v50, v50, v184
v_mul_f32 v51, v51, v184
v_mul_f32 v52, v52, v184
v_mul_f32 v53, v53, v184
v_mul_f32 v54, v54, v184
v_mul_f32 v55, v55, v184
v_mul_f32 v56, v56, v184
v_mul_f32 v57, v57, v184
v_mul_f32 v58, v58, v184
v_mul_f32 v59, v59, v184
v_mul_f32 v60, v60, v184
v_mul_f32 v61, v61, v184
v_mul_f32 v62, v62, v184
v_mul_f32 v63, v63, v184
v_mul_f32 v64, v64, v184
v_mul_f32 v65, v65, v184
v_mul_f32 v66, v66, v184
v_mul_f32 v67, v67, v184
v_mul_f32 v68, v68, v184
v_mul_f32 v69, v69, v184
v_mul_f32 v70, v70, v184
v_mul_f32 v71, v71, v184
v_mul_f32 v72, v72, v184
v_mul_f32 v73, v73, v184
v_mul_f32 v74, v74, v184
v_mul_f32 v75, v75, v184
s_waitcnt lgkmcnt(0)
s_barrier
ds_read_b128 v[148:151], v202 offset:0
ds_read_b128 v[152:155], v202 offset:1024
ds_read_b128 v[156:159], v202 offset:2048
ds_read_b128 v[160:163], v202 offset:3072
ds_read_b64_tr_b16 v[84:85], v197 offset:0
ds_read_b64_tr_b16 v[86:87], v197 offset:4352
ds_read_b64_tr_b16 v[88:89], v197 offset:64
ds_read_b64_tr_b16 v[90:91], v197 offset:4416
ds_read_b64_tr_b16 v[92:93], v197 offset:128
ds_read_b64_tr_b16 v[94:95], v197 offset:4480
ds_read_b64_tr_b16 v[96:97], v197 offset:192
ds_read_b64_tr_b16 v[98:99], v197 offset:4544
ds_read_b64_tr_b16 v[100:101], v197 offset:17408
ds_read_b64_tr_b16 v[102:103], v197 offset:21760
ds_read_b64_tr_b16 v[104:105], v197 offset:17472
ds_read_b64_tr_b16 v[106:107], v197 offset:21824
ds_read_b64_tr_b16 v[108:109], v197 offset:17536
ds_read_b64_tr_b16 v[110:111], v197 offset:21888
ds_read_b64_tr_b16 v[112:113], v197 offset:17600
ds_read_b64_tr_b16 v[114:115], v197 offset:21952
ds_read_b64_tr_b16 v[116:117], v197 offset:34816
ds_read_b64_tr_b16 v[118:119], v197 offset:39168
ds_read_b64_tr_b16 v[120:121], v197 offset:34880
ds_read_b64_tr_b16 v[122:123], v197 offset:39232
ds_read_b64_tr_b16 v[124:125], v197 offset:34944
ds_read_b64_tr_b16 v[126:127], v197 offset:39296
ds_read_b64_tr_b16 v[128:129], v197 offset:35008
ds_read_b64_tr_b16 v[130:131], v197 offset:39360
ds_read_b64_tr_b16 v[132:133], v197 offset:52224
ds_read_b64_tr_b16 v[134:135], v197 offset:56576
ds_read_b64_tr_b16 v[136:137], v197 offset:52288
ds_read_b64_tr_b16 v[138:139], v197 offset:56640
ds_read_b64_tr_b16 v[140:141], v197 offset:52352
ds_read_b64_tr_b16 v[142:143], v197 offset:56704
ds_read_b64_tr_b16 v[144:145], v197 offset:52416
ds_read_b64_tr_b16 v[146:147], v197 offset:56768
s_waitcnt lgkmcnt(15)
v_mfma_f32_32x32x16_bf16 v[12:27], v[84:87], v[148:151], v[12:27]
v_mfma_f32_32x32x16_bf16 v[28:43], v[88:91], v[148:151], v[28:43]
v_mfma_f32_32x32x16_bf16 v[44:59], v[92:95], v[148:151], v[44:59]
v_mfma_f32_32x32x16_bf16 v[60:75], v[96:99], v[148:151], v[60:75]
s_waitcnt lgkmcnt(15)
v_mfma_f32_32x32x16_bf16 v[12:27], v[100:103], v[152:155], v[12:27]
v_mfma_f32_32x32x16_bf16 v[28:43], v[104:107], v[152:155], v[28:43]
v_mfma_f32_32x32x16_bf16 v[44:59], v[108:111], v[152:155], v[44:59]
v_mfma_f32_32x32x16_bf16 v[60:75], v[112:115], v[152:155], v[60:75]
s_waitcnt lgkmcnt(8)
v_mfma_f32_32x32x16_bf16 v[12:27], v[116:119], v[156:159], v[12:27]
v_mfma_f32_32x32x16_bf16 v[28:43], v[120:123], v[156:159], v[28:43]
v_mfma_f32_32x32x16_bf16 v[44:59], v[124:127], v[156:159], v[44:59]
v_mfma_f32_32x32x16_bf16 v[60:75], v[128:131], v[156:159], v[60:75]
s_waitcnt lgkmcnt(0)
v_mfma_f32_32x32x16_bf16 v[12:27], v[132:135], v[160:163], v[12:27]
v_mfma_f32_32x32x16_bf16 v[28:43], v[136:139], v[160:163], v[28:43]
v_mfma_f32_32x32x16_bf16 v[44:59], v[140:143], v[160:163], v[44:59]
v_mfma_f32_32x32x16_bf16 v[60:75], v[144:147], v[160:163], v[60:75]
ds_read_b128 v[84:87], v194 offset:0
ds_read_b128 v[88:91], v194 offset:64
ds_read_b128 v[92:95], v194 offset:128
ds_read_b128 v[96:99], v194 offset:192
ds_read_b128 v[100:103], v194 offset:256
ds_read_b128 v[104:107], v194 offset:320
ds_read_b128 v[108:111], v194 offset:384
ds_read_b128 v[112:115], v194 offset:448
ds_read_b128 v[116:119], v194 offset:512
ds_read_b128 v[120:123], v194 offset:576
ds_read_b128 v[124:127], v194 offset:640
ds_read_b128 v[128:131], v194 offset:704
ds_read_b128 v[132:135], v194 offset:768
ds_read_b128 v[136:139], v194 offset:832
ds_read_b128 v[140:143], v194 offset:896
ds_read_b128 v[144:147], v194 offset:960
s_waitcnt lgkmcnt(15)
v_mfma_f32_16x16x32_bf16 v[76:79], v[84:87], a[0:3], 0
v_mfma_f32_16x16x32_bf16 v[80:83], v[84:87], a[64:67], 0
s_waitcnt lgkmcnt(14)
v_mfma_f32_16x16x32_bf16 v[76:79], v[88:91], a[4:7], v[76:79]
v_mfma_f32_16x16x32_bf16 v[80:83], v[88:91], a[68:71], v[80:83]
s_waitcnt lgkmcnt(13)
v_mfma_f32_16x16x32_bf16 v[76:79], v[92:95], a[8:11], v[76:79]
v_mfma_f32_16x16x32_bf16 v[80:83], v[92:95], a[72:75], v[80:83]
s_waitcnt lgkmcnt(12)
v_mfma_f32_16x16x32_bf16 v[76:79], v[96:99], a[12:15], v[76:79]
v_mfma_f32_16x16x32_bf16 v[80:83], v[96:99], a[76:79], v[80:83]
s_waitcnt lgkmcnt(11)
v_mfma_f32_16x16x32_bf16 v[76:79], v[100:103], a[16:19], v[76:79]
v_mfma_f32_16x16x32_bf16 v[80:83], v[100:103], a[80:83], v[80:83]
s_waitcnt lgkmcnt(10)
v_mfma_f32_16x16x32_bf16 v[76:79], v[104:107], a[20:23], v[76:79]
v_mfma_f32_16x16x32_bf16 v[80:83], v[104:107], a[84:87], v[80:83]
s_waitcnt lgkmcnt(9)
v_mfma_f32_16x16x32_bf16 v[76:79], v[108:111], a[24:27], v[76:79]
v_mfma_f32_16x16x32_bf16 v[80:83], v[108:111], a[88:91], v[80:83]
s_waitcnt lgkmcnt(8)
v_mfma_f32_16x16x32_bf16 v[76:79], v[112:115], a[28:31], v[76:79]
v_mfma_f32_16x16x32_bf16 v[80:83], v[112:115], a[92:95], v[80:83]
s_waitcnt lgkmcnt(7)
v_mfma_f32_16x16x32_bf16 v[76:79], v[116:119], a[32:35], v[76:79]
v_mfma_f32_16x16x32_bf16 v[80:83], v[116:119], a[96:99], v[80:83]
s_waitcnt lgkmcnt(6)
v_mfma_f32_16x16x32_bf16 v[76:79], v[120:123], a[36:39], v[76:79]
v_mfma_f32_16x16x32_bf16 v[80:83], v[120:123], a[100:103], v[80:83]
s_waitcnt lgkmcnt(5)
v_mfma_f32_16x16x32_bf16 v[76:79], v[124:127], a[40:43], v[76:79]
v_mfma_f32_16x16x32_bf16 v[80:83], v[124:127], a[104:107], v[80:83]
s_waitcnt lgkmcnt(4)
v_mfma_f32_16x16x32_bf16 v[76:79], v[128:131], a[44:47], v[76:79]
v_mfma_f32_16x16x32_bf16 v[80:83], v[128:131], a[108:111], v[80:83]
s_waitcnt lgkmcnt(3)
v_mfma_f32_16x16x32_bf16 v[76:79], v[132:135], a[48:51], v[76:79]
v_mfma_f32_16x16x32_bf16 v[80:83], v[132:135], a[112:115], v[80:83]
s_waitcnt lgkmcnt(2)
v_mfma_f32_16x16x32_bf16 v[76:79], v[136:139], a[52:55], v[76:79]
v_mfma_f32_16x16x32_bf16 v[80:83], v[136:139], a[116:119], v[80:83]
s_waitcnt lgkmcnt(1)
v_mfma_f32_16x16x32_bf16 v[76:79], v[140:143], a[56:59], v[76:79]
v_mfma_f32_16x16x32_bf16 v[80:83], v[140:143], a[120:123], v[80:83]
s_waitcnt lgkmcnt(0)
v_mfma_f32_16x16x32_bf16 v[76:79], v[144:147], a[60:63], v[76:79]
v_mfma_f32_16x16x32_bf16 v[80:83], v[144:147], a[124:127], v[80:83]
s_nop 6
v_max_f32 v190, v76, v77
v_max3_f32 v190, v190, v78, v79
v_mov_b32 v192, v190
s_nop 1
v_permlane16_swap_b32 v190, v192
v_max_f32 v190, v190, v192
v_mov_b32 v192, v190
s_nop 1
v_permlane32_swap_b32 v190, v192
v_max_f32 v190, v190, v192
ds_write_b32 v198, v190 offset:0
v_max_f32 v191, v80, v81
v_max3_f32 v191, v191, v82, v83
v_mov_b32 v192, v191
s_nop 1
v_permlane16_swap_b32 v191, v192
v_max_f32 v191, v191, v192
v_mov_b32 v192, v191
s_nop 1
v_permlane32_swap_b32 v191, v192
v_max_f32 v191, v191, v192
ds_write_b32 v198, v191 offset:256
s_waitcnt lgkmcnt(0)
s_barrier
ds_read_b128 v[164:167], v199
ds_read_b128 v[168:171], v199 offset:256
ds_read_b128 v[172:175], v200
s_waitcnt vmcnt(0)
ds_write_b128 v207, a[192:195] offset:0
ds_write_b128 v207, a[196:199] offset:1088
ds_write_b128 v207, a[200:203] offset:2176
ds_write_b128 v207, a[204:207] offset:3264
ds_write_b128 v207, a[208:211] offset:4352
ds_write_b128 v207, a[212:215] offset:5440
ds_write_b128 v207, a[216:219] offset:6528
ds_write_b128 v207, a[220:223] offset:7616
ds_write_b128 v207, a[224:227] offset:8704
ds_write_b128 v207, a[228:231] offset:9792
ds_write_b128 v207, a[232:235] offset:10880
ds_write_b128 v207, a[236:239] offset:11968
ds_write_b128 v207, a[240:243] offset:13056
ds_write_b128 v207, a[244:247] offset:14144
ds_write_b128 v207, a[248:251] offset:15232
ds_write_b128 v207, a[252:255] offset:16320
s_waitcnt lgkmcnt(15)
v_max_f32 v164, v164, v165
v_max3_f32 v164, v164, v166, v167
v_mul_f32 v164, v164, v185
v_max_f32 v164, v164, v176
v_sub_f32 v182, v176, v164
v_exp_f32 v182, v182
v_mov_b32 v176, v164
v_max_f32 v168, v168, v169
v_max3_f32 v168, v168, v170, v171
v_mul_f32 v168, v168, v185
v_max_f32 v168, v168, v177
v_sub_f32 v183, v177, v168
v_exp_f32 v183, v183
v_mov_b32 v177, v168
v_max_f32 v172, v172, v173
v_max3_f32 v172, v172, v174, v175
v_mul_f32 v172, v172, v185
v_max_f32 v172, v172, v178
v_sub_f32 v184, v178, v172
v_exp_f32 v184, v184
v_mov_b32 v178, v172
v_fma_f32 v76, v76, v185, -v176
v_fma_f32 v77, v77, v185, -v176
v_fma_f32 v78, v78, v185, -v176
v_fma_f32 v79, v79, v185, -v176
v_exp_f32 v76, v76
v_exp_f32 v77, v77
v_exp_f32 v78, v78
v_exp_f32 v79, v79
v_mul_f32 v180, v180, v182
v_cvt_pk_bf16_f32 v186, v76, v77
v_cvt_pk_bf16_f32 v187, v78, v79
ds_write_b64 v201, v[186:187] offset:0
v_add_f32 v180, v180, v76
v_add_f32 v180, v180, v77
v_add_f32 v180, v180, v78
v_add_f32 v180, v180, v79
v_fma_f32 v80, v80, v185, -v177
v_fma_f32 v81, v81, v185, -v177
v_fma_f32 v82, v82, v185, -v177
v_fma_f32 v83, v83, v185, -v177
v_exp_f32 v80, v80
v_exp_f32 v81, v81
v_exp_f32 v82, v82
v_exp_f32 v83, v83
v_mul_f32 v181, v181, v183
v_cvt_pk_bf16_f32 v188, v80, v81
v_cvt_pk_bf16_f32 v189, v82, v83
ds_write_b64 v201, v[188:189] offset:512
v_add_f32 v181, v181, v80
v_add_f32 v181, v181, v81
v_add_f32 v181, v181, v82
v_add_f32 v181, v181, v83
v_mul_f32 v12, v12, v184
v_mul_f32 v13, v13, v184
v_mul_f32 v14, v14, v184
v_mul_f32 v15, v15, v184
v_mul_f32 v16, v16, v184
v_mul_f32 v17, v17, v184
v_mul_f32 v18, v18, v184
v_mul_f32 v19, v19, v184
v_mul_f32 v20, v20, v184
v_mul_f32 v21, v21, v184
v_mul_f32 v22, v22, v184
v_mul_f32 v23, v23, v184
v_mul_f32 v24, v24, v184
v_mul_f32 v25, v25, v184
v_mul_f32 v26, v26, v184
v_mul_f32 v27, v27, v184
v_mul_f32 v28, v28, v184
v_mul_f32 v29, v29, v184
v_mul_f32 v30, v30, v184
v_mul_f32 v31, v31, v184
v_mul_f32 v32, v32, v184
v_mul_f32 v33, v33, v184
v_mul_f32 v34, v34, v184
v_mul_f32 v35, v35, v184
v_mul_f32 v36, v36, v184
v_mul_f32 v37, v37, v184
v_mul_f32 v38, v38, v184
v_mul_f32 v39, v39, v184
v_mul_f32 v40, v40, v184
v_mul_f32 v41, v41, v184
v_mul_f32 v42, v42, v184
v_mul_f32 v43, v43, v184
v_mul_f32 v44, v44, v184
v_mul_f32 v45, v45, v184
v_mul_f32 v46, v46, v184
v_mul_f32 v47, v47, v184
v_mul_f32 v48, v48, v184
v_mul_f32 v49, v49, v184
v_mul_f32 v50, v50, v184
v_mul_f32 v51, v51, v184
v_mul_f32 v52, v52, v184
v_mul_f32 v53, v53, v184
v_mul_f32 v54, v54, v184
v_mul_f32 v55, v55, v184
v_mul_f32 v56, v56, v184
v_mul_f32 v57, v57, v184
v_mul_f32 v58, v58, v184
v_mul_f32 v59, v59, v184
v_mul_f32 v60, v60, v184
v_mul_f32 v61, v61, v184
v_mul_f32 v62, v62, v184
v_mul_f32 v63, v63, v184
v_mul_f32 v64, v64, v184
v_mul_f32 v65, v65, v184
v_mul_f32 v66, v66, v184
v_mul_f32 v67, v67, v184
v_mul_f32 v68, v68, v184
v_mul_f32 v69, v69, v184
v_mul_f32 v70, v70, v184
v_mul_f32 v71, v71, v184
v_mul_f32 v72, v72, v184
v_mul_f32 v73, v73, v184
v_mul_f32 v74, v74, v184
v_mul_f32 v75, v75, v184
s_waitcnt lgkmcnt(0)
s_barrier
ds_read_b128 v[148:151], v202 offset:0
ds_read_b128 v[152:155], v202 offset:1024
ds_read_b128 v[156:159], v202 offset:2048
ds_read_b128 v[160:163], v202 offset:3072
ds_read_b64_tr_b16 v[84:85], v196 offset:0
ds_read_b64_tr_b16 v[86:87], v196 offset:4352
ds_read_b64_tr_b16 v[88:89], v196 offset:64
ds_read_b64_tr_b16 v[90:91], v196 offset:4416
ds_read_b64_tr_b16 v[92:93], v196 offset:128
ds_read_b64_tr_b16 v[94:95], v196 offset:4480
ds_read_b64_tr_b16 v[96:97], v196 offset:192
ds_read_b64_tr_b16 v[98:99], v196 offset:4544
ds_read_b64_tr_b16 v[100:101], v196 offset:17408
ds_read_b64_tr_b16 v[102:103], v196 offset:21760
ds_read_b64_tr_b16 v[104:105], v196 offset:17472
ds_read_b64_tr_b16 v[106:107], v196 offset:21824
ds_read_b64_tr_b16 v[108:109], v196 offset:17536
ds_read_b64_tr_b16 v[110:111], v196 offset:21888
ds_read_b64_tr_b16 v[112:113], v196 offset:17600
ds_read_b64_tr_b16 v[114:115], v196 offset:21952
ds_read_b64_tr_b16 v[116:117], v196 offset:34816
ds_read_b64_tr_b16 v[118:119], v196 offset:39168
ds_read_b64_tr_b16 v[120:121], v196 offset:34880
ds_read_b64_tr_b16 v[122:123], v196 offset:39232
ds_read_b64_tr_b16 v[124:125], v196 offset:34944
ds_read_b64_tr_b16 v[126:127], v196 offset:39296
ds_read_b64_tr_b16 v[128:129], v196 offset:35008
ds_read_b64_tr_b16 v[130:131], v196 offset:39360
ds_read_b64_tr_b16 v[132:133], v196 offset:52224
ds_read_b64_tr_b16 v[134:135], v196 offset:56576
ds_read_b64_tr_b16 v[136:137], v196 offset:52288
ds_read_b64_tr_b16 v[138:139], v196 offset:56640
ds_read_b64_tr_b16 v[140:141], v196 offset:52352
ds_read_b64_tr_b16 v[142:143], v196 offset:56704
ds_read_b64_tr_b16 v[144:145], v196 offset:52416
ds_read_b64_tr_b16 v[146:147], v196 offset:56768
s_waitcnt lgkmcnt(15)
v_mfma_f32_32x32x16_bf16 v[12:27], v[84:87], v[148:151], v[12:27]
v_mfma_f32_32x32x16_bf16 v[28:43], v[88:91], v[148:151], v[28:43]
v_mfma_f32_32x32x16_bf16 v[44:59], v[92:95], v[148:151], v[44:59]
v_mfma_f32_32x32x16_bf16 v[60:75], v[96:99], v[148:151], v[60:75]
s_waitcnt lgkmcnt(15)
v_mfma_f32_32x32x16_bf16 v[12:27], v[100:103], v[152:155], v[12:27]
v_mfma_f32_32x32x16_bf16 v[28:43], v[104:107], v[152:155], v[28:43]
v_mfma_f32_32x32x16_bf16 v[44:59], v[108:111], v[152:155], v[44:59]
v_mfma_f32_32x32x16_bf16 v[60:75], v[112:115], v[152:155], v[60:75]
s_waitcnt lgkmcnt(8)
v_mfma_f32_32x32x16_bf16 v[12:27], v[116:119], v[156:159], v[12:27]
v_mfma_f32_32x32x16_bf16 v[28:43], v[120:123], v[156:159], v[28:43]
v_mfma_f32_32x32x16_bf16 v[44:59], v[124:127], v[156:159], v[44:59]
v_mfma_f32_32x32x16_bf16 v[60:75], v[128:131], v[156:159], v[60:75]
s_waitcnt lgkmcnt(0)
v_mfma_f32_32x32x16_bf16 v[12:27], v[132:135], v[160:163], v[12:27]
v_mfma_f32_32x32x16_bf16 v[28:43], v[136:139], v[160:163], v[28:43]
v_mfma_f32_32x32x16_bf16 v[44:59], v[140:143], v[160:163], v[44:59]
v_mfma_f32_32x32x16_bf16 v[60:75], v[144:147], v[160:163], v[60:75]
ds_read_b128 v[84:87], v195 offset:0
ds_read_b128 v[88:91], v195 offset:64
ds_read_b128 v[92:95], v195 offset:128
ds_read_b128 v[96:99], v195 offset:192
ds_read_b128 v[100:103], v195 offset:256
ds_read_b128 v[104:107], v195 offset:320
ds_read_b128 v[108:111], v195 offset:384
ds_read_b128 v[112:115], v195 offset:448
ds_read_b128 v[116:119], v195 offset:512
ds_read_b128 v[120:123], v195 offset:576
ds_read_b128 v[124:127], v195 offset:640
ds_read_b128 v[128:131], v195 offset:704
ds_read_b128 v[132:135], v195 offset:768
ds_read_b128 v[136:139], v195 offset:832
ds_read_b128 v[140:143], v195 offset:896
ds_read_b128 v[144:147], v195 offset:960
s_waitcnt lgkmcnt(15)
v_mfma_f32_16x16x32_bf16 v[76:79], v[84:87], a[0:3], 0
v_mfma_f32_16x16x32_bf16 v[80:83], v[84:87], a[64:67], 0
s_waitcnt lgkmcnt(14)
v_mfma_f32_16x16x32_bf16 v[76:79], v[88:91], a[4:7], v[76:79]
v_mfma_f32_16x16x32_bf16 v[80:83], v[88:91], a[68:71], v[80:83]
s_waitcnt lgkmcnt(13)
v_mfma_f32_16x16x32_bf16 v[76:79], v[92:95], a[8:11], v[76:79]
v_mfma_f32_16x16x32_bf16 v[80:83], v[92:95], a[72:75], v[80:83]
s_waitcnt lgkmcnt(12)
v_mfma_f32_16x16x32_bf16 v[76:79], v[96:99], a[12:15], v[76:79]
v_mfma_f32_16x16x32_bf16 v[80:83], v[96:99], a[76:79], v[80:83]
s_waitcnt lgkmcnt(11)
v_mfma_f32_16x16x32_bf16 v[76:79], v[100:103], a[16:19], v[76:79]
v_mfma_f32_16x16x32_bf16 v[80:83], v[100:103], a[80:83], v[80:83]
s_waitcnt lgkmcnt(10)
v_mfma_f32_16x16x32_bf16 v[76:79], v[104:107], a[20:23], v[76:79]
v_mfma_f32_16x16x32_bf16 v[80:83], v[104:107], a[84:87], v[80:83]
s_waitcnt lgkmcnt(9)
v_mfma_f32_16x16x32_bf16 v[76:79], v[108:111], a[24:27], v[76:79]
v_mfma_f32_16x16x32_bf16 v[80:83], v[108:111], a[88:91], v[80:83]
s_waitcnt lgkmcnt(8)
v_mfma_f32_16x16x32_bf16 v[76:79], v[112:115], a[28:31], v[76:79]
v_mfma_f32_16x16x32_bf16 v[80:83], v[112:115], a[92:95], v[80:83]
s_waitcnt lgkmcnt(7)
v_mfma_f32_16x16x32_bf16 v[76:79], v[116:119], a[32:35], v[76:79]
v_mfma_f32_16x16x32_bf16 v[80:83], v[116:119], a[96:99], v[80:83]
s_waitcnt lgkmcnt(6)
v_mfma_f32_16x16x32_bf16 v[76:79], v[120:123], a[36:39], v[76:79]
v_mfma_f32_16x16x32_bf16 v[80:83], v[120:123], a[100:103], v[80:83]
s_waitcnt lgkmcnt(5)
v_mfma_f32_16x16x32_bf16 v[76:79], v[124:127], a[40:43], v[76:79]
v_mfma_f32_16x16x32_bf16 v[80:83], v[124:127], a[104:107], v[80:83]
s_waitcnt lgkmcnt(4)
v_mfma_f32_16x16x32_bf16 v[76:79], v[128:131], a[44:47], v[76:79]
v_mfma_f32_16x16x32_bf16 v[80:83], v[128:131], a[108:111], v[80:83]
s_waitcnt lgkmcnt(3)
v_mfma_f32_16x16x32_bf16 v[76:79], v[132:135], a[48:51], v[76:79]
v_mfma_f32_16x16x32_bf16 v[80:83], v[132:135], a[112:115], v[80:83]
s_waitcnt lgkmcnt(2)
v_mfma_f32_16x16x32_bf16 v[76:79], v[136:139], a[52:55], v[76:79]
v_mfma_f32_16x16x32_bf16 v[80:83], v[136:139], a[116:119], v[80:83]
s_waitcnt lgkmcnt(1)
v_mfma_f32_16x16x32_bf16 v[76:79], v[140:143], a[56:59], v[76:79]
v_mfma_f32_16x16x32_bf16 v[80:83], v[140:143], a[120:123], v[80:83]
s_waitcnt lgkmcnt(0)
v_mfma_f32_16x16x32_bf16 v[76:79], v[144:147], a[60:63], v[76:79]
v_mfma_f32_16x16x32_bf16 v[80:83], v[144:147], a[124:127], v[80:83]
s_nop 6
v_max_f32 v190, v76, v77
v_max3_f32 v190, v190, v78, v79
v_mov_b32 v192, v190
s_nop 1
v_permlane16_swap_b32 v190, v192
v_max_f32 v190, v190, v192
v_mov_b32 v192, v190
s_nop 1
v_permlane32_swap_b32 v190, v192
v_max_f32 v190, v190, v192
ds_write_b32 v198, v190 offset:0
v_max_f32 v191, v80, v81
v_max3_f32 v191, v191, v82, v83
v_mov_b32 v192, v191
s_nop 1
v_permlane16_swap_b32 v191, v192
v_max_f32 v191, v191, v192
v_mov_b32 v192, v191
s_nop 1
v_permlane32_swap_b32 v191, v192
v_max_f32 v191, v191, v192
ds_write_b32 v198, v191 offset:256
s_waitcnt lgkmcnt(0)
s_barrier
ds_read_b128 v[164:167], v199
ds_read_b128 v[168:171], v199 offset:256
ds_read_b128 v[172:175], v200
s_waitcnt lgkmcnt(0)
v_max_f32 v164, v164, v165
v_max3_f32 v164, v164, v166, v167
v_mul_f32 v164, v164, v185
v_max_f32 v164, v164, v176
v_sub_f32 v182, v176, v164
v_exp_f32 v182, v182
v_mov_b32 v176, v164
v_max_f32 v168, v168, v169
v_max3_f32 v168, v168, v170, v171
v_mul_f32 v168, v168, v185
v_max_f32 v168, v168, v177
v_sub_f32 v183, v177, v168
v_exp_f32 v183, v183
v_mov_b32 v177, v168
v_max_f32 v172, v172, v173
v_max3_f32 v172, v172, v174, v175
v_mul_f32 v172, v172, v185
v_max_f32 v172, v172, v178
v_sub_f32 v184, v178, v172
v_exp_f32 v184, v184
v_mov_b32 v178, v172
v_fma_f32 v76, v76, v185, -v176
v_fma_f32 v77, v77, v185, -v176
v_fma_f32 v78, v78, v185, -v176
v_fma_f32 v79, v79, v185, -v176
v_exp_f32 v76, v76
v_exp_f32 v77, v77
v_exp_f32 v78, v78
v_exp_f32 v79, v79
v_mul_f32 v180, v180, v182
v_cvt_pk_bf16_f32 v186, v76, v77
v_cvt_pk_bf16_f32 v187, v78, v79
ds_write_b64 v201, v[186:187] offset:0
v_add_f32 v180, v180, v76
v_add_f32 v180, v180, v77
v_add_f32 v180, v180, v78
v_add_f32 v180, v180, v79
v_fma_f32 v80, v80, v185, -v177
v_fma_f32 v81, v81, v185, -v177
v_fma_f32 v82, v82, v185, -v177
v_fma_f32 v83, v83, v185, -v177
v_exp_f32 v80, v80
v_exp_f32 v81, v81
v_exp_f32 v82, v82
v_exp_f32 v83, v83
v_mul_f32 v181, v181, v183
v_cvt_pk_bf16_f32 v188, v80, v81
v_cvt_pk_bf16_f32 v189, v82, v83
ds_write_b64 v201, v[188:189] offset:512
v_add_f32 v181, v181, v80
v_add_f32 v181, v181, v81
v_add_f32 v181, v181, v82
v_add_f32 v181, v181, v83
v_mul_f32 v12, v12, v184
v_mul_f32 v13, v13, v184
v_mul_f32 v14, v14, v184
v_mul_f32 v15, v15, v184
v_mul_f32 v16, v16, v184
v_mul_f32 v17, v17, v184
v_mul_f32 v18, v18, v184
v_mul_f32 v19, v19, v184
v_mul_f32 v20, v20, v184
v_mul_f32 v21, v21, v184
v_mul_f32 v22, v22, v184
v_mul_f32 v23, v23, v184
v_mul_f32 v24, v24, v184
v_mul_f32 v25, v25, v184
v_mul_f32 v26, v26, v184
v_mul_f32 v27, v27, v184
v_mul_f32 v28, v28, v184
v_mul_f32 v29, v29, v184
v_mul_f32 v30, v30, v184
v_mul_f32 v31, v31, v184
v_mul_f32 v32, v32, v184
v_mul_f32 v33, v33, v184
v_mul_f32 v34, v34, v184
v_mul_f32 v35, v35, v184
v_mul_f32 v36, v36, v184
v_mul_f32 v37, v37, v184
v_mul_f32 v38, v38, v184
v_mul_f32 v39, v39, v184
v_mul_f32 v40, v40, v184
v_mul_f32 v41, v41, v184
v_mul_f32 v42, v42, v184
v_mul_f32 v43, v43, v184
v_mul_f32 v44, v44, v184
v_mul_f32 v45, v45, v184
v_mul_f32 v46, v46, v184
v_mul_f32 v47, v47, v184
v_mul_f32 v48, v48, v184
v_mul_f32 v49, v49, v184
v_mul_f32 v50, v50, v184
v_mul_f32 v51, v51, v184
v_mul_f32 v52, v52, v184
v_mul_f32 v53, v53, v184
v_mul_f32 v54, v54, v184
v_mul_f32 v55, v55, v184
v_mul_f32 v56, v56, v184
v_mul_f32 v57, v57, v184
v_mul_f32 v58, v58, v184
v_mul_f32 v59, v59, v184
v_mul_f32 v60, v60, v184
v_mul_f32 v61, v61, v184
v_mul_f32 v62, v62, v184
v_mul_f32 v63, v63, v184
v_mul_f32 v64, v64, v184
v_mul_f32 v65, v65, v184
v_mul_f32 v66, v66, v184
v_mul_f32 v67, v67, v184
v_mul_f32 v68, v68, v184
v_mul_f32 v69, v69, v184
v_mul_f32 v70, v70, v184
v_mul_f32 v71, v71, v184
v_mul_f32 v72, v72, v184
v_mul_f32 v73, v73, v184
v_mul_f32 v74, v74, v184
v_mul_f32 v75, v75, v184
s_waitcnt lgkmcnt(0)
s_barrier
ds_read_b128 v[148:151], v202 offset:0
ds_read_b128 v[152:155], v202 offset:1024
ds_read_b128 v[156:159], v202 offset:2048
ds_read_b128 v[160:163], v202 offset:3072
ds_read_b64_tr_b16 v[84:85], v197 offset:0
ds_read_b64_tr_b16 v[86:87], v197 offset:4352
ds_read_b64_tr_b16 v[88:89], v197 offset:64
ds_read_b64_tr_b16 v[90:91], v197 offset:4416
ds_read_b64_tr_b16 v[92:93], v197 offset:128
ds_read_b64_tr_b16 v[94:95], v197 offset:4480
ds_read_b64_tr_b16 v[96:97], v197 offset:192
ds_read_b64_tr_b16 v[98:99], v197 offset:4544
ds_read_b64_tr_b16 v[100:101], v197 offset:17408
ds_read_b64_tr_b16 v[102:103], v197 offset:21760
ds_read_b64_tr_b16 v[104:105], v197 offset:17472
ds_read_b64_tr_b16 v[106:107], v197 offset:21824
ds_read_b64_tr_b16 v[108:109], v197 offset:17536
ds_read_b64_tr_b16 v[110:111], v197 offset:21888
ds_read_b64_tr_b16 v[112:113], v197 offset:17600
ds_read_b64_tr_b16 v[114:115], v197 offset:21952
ds_read_b64_tr_b16 v[116:117], v197 offset:34816
ds_read_b64_tr_b16 v[118:119], v197 offset:39168
ds_read_b64_tr_b16 v[120:121], v197 offset:34880
ds_read_b64_tr_b16 v[122:123], v197 offset:39232
ds_read_b64_tr_b16 v[124:125], v197 offset:34944
ds_read_b64_tr_b16 v[126:127], v197 offset:39296
ds_read_b64_tr_b16 v[128:129], v197 offset:35008
ds_read_b64_tr_b16 v[130:131], v197 offset:39360
ds_read_b64_tr_b16 v[132:133], v197 offset:52224
ds_read_b64_tr_b16 v[134:135], v197 offset:56576
ds_read_b64_tr_b16 v[136:137], v197 offset:52288
ds_read_b64_tr_b16 v[138:139], v197 offset:56640
ds_read_b64_tr_b16 v[140:141], v197 offset:52352
ds_read_b64_tr_b16 v[142:143], v197 offset:56704
ds_read_b64_tr_b16 v[144:145], v197 offset:52416
ds_read_b64_tr_b16 v[146:147], v197 offset:56768
s_waitcnt lgkmcnt(15)
v_mfma_f32_32x32x16_bf16 v[12:27], v[84:87], v[148:151], v[12:27]
v_mfma_f32_32x32x16_bf16 v[28:43], v[88:91], v[148:151], v[28:43]
v_mfma_f32_32x32x16_bf16 v[44:59], v[92:95], v[148:151], v[44:59]
v_mfma_f32_32x32x16_bf16 v[60:75], v[96:99], v[148:151], v[60:75]
s_waitcnt lgkmcnt(15)
v_mfma_f32_32x32x16_bf16 v[12:27], v[100:103], v[152:155], v[12:27]
v_mfma_f32_32x32x16_bf16 v[28:43], v[104:107], v[152:155], v[28:43]
v_mfma_f32_32x32x16_bf16 v[44:59], v[108:111], v[152:155], v[44:59]
v_mfma_f32_32x32x16_bf16 v[60:75], v[112:115], v[152:155], v[60:75]
s_waitcnt lgkmcnt(8)
v_mfma_f32_32x32x16_bf16 v[12:27], v[116:119], v[156:159], v[12:27]
v_mfma_f32_32x32x16_bf16 v[28:43], v[120:123], v[156:159], v[28:43]
v_mfma_f32_32x32x16_bf16 v[44:59], v[124:127], v[156:159], v[44:59]
v_mfma_f32_32x32x16_bf16 v[60:75], v[128:131], v[156:159], v[60:75]
s_waitcnt lgkmcnt(0)
v_mfma_f32_32x32x16_bf16 v[12:27], v[132:135], v[160:163], v[12:27]
v_mfma_f32_32x32x16_bf16 v[28:43], v[136:139], v[160:163], v[28:43]
v_mfma_f32_32x32x16_bf16 v[44:59], v[140:143], v[160:163], v[44:59]
v_mfma_f32_32x32x16_bf16 v[60:75], v[144:147], v[160:163], v[60:75]
v_mov_b32 v192, v180
s_nop 1
v_permlane16_swap_b32 v180, v192
v_add_f32 v180, v180, v192
v_mov_b32 v192, v180
s_nop 1
v_permlane32_swap_b32 v180, v192
v_add_f32 v180, v180, v192
ds_write_b32 v198, v180 offset:512
v_mov_b32 v192, v181
s_nop 1
v_permlane16_swap_b32 v181, v192
v_add_f32 v181, v181, v192
v_mov_b32 v192, v181
s_nop 1
v_permlane32_swap_b32 v181, v192
v_add_f32 v181, v181, v192
ds_write_b32 v198, v181 offset:768
v_and_b32 v5, 31, v1
v_mul_u32_u24 v5, 1040, v5
v_lshrrev_b32 v6, 5, v1
v_lshl_add_u32 v5, v6, 3, v5
s_lshl_b32 s6, s3, 8
v_add_u32 v5, s6, v5
v_cvt_pk_bf16_f32 v84, v12, v13
v_cvt_pk_bf16_f32 v85, v14, v15
ds_write_b64 v5, v[84:85] offset:0
v_cvt_pk_bf16_f32 v86, v16, v17
v_cvt_pk_bf16_f32 v87, v18, v19
ds_write_b64 v5, v[86:87] offset:16
v_cvt_pk_bf16_f32 v88, v20, v21
v_cvt_pk_bf16_f32 v89, v22, v23
ds_write_b64 v5, v[88:89] offset:32
v_cvt_pk_bf16_f32 v90, v24, v25
v_cvt_pk_bf16_f32 v91, v26, v27
ds_write_b64 v5, v[90:91] offset:48
v_cvt_pk_bf16_f32 v92, v28, v29
v_cvt_pk_bf16_f32 v93, v30, v31
ds_write_b64 v5, v[92:93] offset:64
v_cvt_pk_bf16_f32 v94, v32, v33
v_cvt_pk_bf16_f32 v95, v34, v35
ds_write_b64 v5, v[94:95] offset:80
v_cvt_pk_bf16_f32 v96, v36, v37
v_cvt_pk_bf16_f32 v97, v38, v39
ds_write_b64 v5, v[96:97] offset:96
v_cvt_pk_bf16_f32 v98, v40, v41
v_cvt_pk_bf16_f32 v99, v42, v43
ds_write_b64 v5, v[98:99] offset:112
v_cvt_pk_bf16_f32 v100, v44, v45
v_cvt_pk_bf16_f32 v101, v46, v47
ds_write_b64 v5, v[100:101] offset:128
v_cvt_pk_bf16_f32 v102, v48, v49
v_cvt_pk_bf16_f32 v103, v50, v51
ds_write_b64 v5, v[102:103] offset:144
v_cvt_pk_bf16_f32 v104, v52, v53
v_cvt_pk_bf16_f32 v105, v54, v55
ds_write_b64 v5, v[104:105] offset:160
v_cvt_pk_bf16_f32 v106, v56, v57
v_cvt_pk_bf16_f32 v107, v58, v59
ds_write_b64 v5, v[106:107] offset:176
v_cvt_pk_bf16_f32 v108, v60, v61
v_cvt_pk_bf16_f32 v109, v62, v63
ds_write_b64 v5, v[108:109] offset:192
v_cvt_pk_bf16_f32 v110, v64, v65
v_cvt_pk_bf16_f32 v111, v66, v67
ds_write_b64 v5, v[110:111] offset:208
v_cvt_pk_bf16_f32 v112, v68, v69
v_cvt_pk_bf16_f32 v113, v70, v71
ds_write_b64 v5, v[112:113] offset:224
v_cvt_pk_bf16_f32 v114, v72, v73
v_cvt_pk_bf16_f32 v115, v74, v75
ds_write_b64 v5, v[114:115] offset:240
s_waitcnt lgkmcnt(0)
s_barrier
s_mul_i32 s6, s3, 8320
v_add_u32 v5, s6, v2
ds_read_b128 v[116:119], v5 offset:0
ds_read_b128 v[120:123], v5 offset:1040
ds_read_b128 v[124:127], v5 offset:2080
ds_read_b128 v[128:131], v5 offset:3120
ds_read_b128 v[132:135], v5 offset:4160
ds_read_b128 v[136:139], v5 offset:5200
ds_read_b128 v[140:143], v5 offset:6240
ds_read_b128 v[144:147], v5 offset:7280
ds_read_b128 v[164:167], v200 offset:512
s_lshl_b32 s7, s3, 19
s_lshl_b32 s6, s9, 10
s_add_u32 s7, s7, s6
s_add_u32 s7, s7, 1048576
s_waitcnt lgkmcnt(8)
s_add_u32 s6, s7, 0
buffer_store_dwordx4 v[116:119], v2, s[64:67], s6 offen sc1
s_waitcnt lgkmcnt(7)
s_add_u32 s6, s7, 65536
buffer_store_dwordx4 v[120:123], v2, s[64:67], s6 offen sc1
s_waitcnt lgkmcnt(6)
s_add_u32 s6, s7, 131072
buffer_store_dwordx4 v[124:127], v2, s[64:67], s6 offen sc1
s_waitcnt lgkmcnt(5)
s_add_u32 s6, s7, 196608
buffer_store_dwordx4 v[128:131], v2, s[64:67], s6 offen sc1
s_waitcnt lgkmcnt(4)
s_add_u32 s6, s7, 262144
buffer_store_dwordx4 v[132:135], v2, s[64:67], s6 offen sc1
s_waitcnt lgkmcnt(3)
s_add_u32 s6, s7, 327680
buffer_store_dwordx4 v[136:139], v2, s[64:67], s6 offen sc1
s_waitcnt lgkmcnt(2)
s_add_u32 s6, s7, 393216
buffer_store_dwordx4 v[140:143], v2, s[64:67], s6 offen sc1
s_waitcnt lgkmcnt(1)
s_add_u32 s6, s7, 458752
buffer_store_dwordx4 v[144:147], v2, s[64:67], s6 offen sc1
s_waitcnt lgkmcnt(0)
v_add_f32 v164, v164, v165
v_add_f32 v166, v166, v167
v_add_f32 v187, v164, v166
v_mov_b32 v186, v178
v_and_b32 v5, 31, v1
v_lshrrev_b32 v6, 5, v1
v_lshl_add_u32 v5, v5, 1, v6
v_lshlrev_b32 v5, 9, v5
s_lshl_b32 s6, s9, 3
s_add_u32 s6, s6, 262144
v_min_u32 v186, -2, v186
v_min_u32 v187, -2, v187
s_waitcnt vmcnt(0)
s_barrier
s_cmp_lg_u32 s3, 0
s_cbranch_scc1 L_nops_18
s_mov_b64 exec, 0xffffffff
buffer_store_dwordx2 v[186:187], v5, s[64:67], s6 offen sc1
s_mov_b64 exec, -1
L_nops_18:
s_mul_i32 s6, s9, 73728
s_add_u32 s60, s36, s6
s_addc_u32 s61, s37, 0
s_mov_b32 s62, 73728
s_mov_b32 s63, 0x20000
s_lshl_b32 s6, s9, 7
s_sub_u32 s7, 4194304, s6
s_add_u32 s76, s34, s6
s_addc_u32 s77, s35, 0
s_mov_b32 s78, s7
s_mov_b32 s79, 0x20000
v_lshrrev_b32 v5, 3, v1
v_and_b32 v6, 7, v1
v_and_b32 v7, 2, v5
v_xor_b32 v6, v6, v7
v_lshlrev_b32 v5, 13, v5
v_lshl_add_u32 v152, v6, 4, v5
v_xor_b32 v6, 4, v6
v_lshl_add_u32 v153, v6, 4, v5
s_lshl_b32 s12, s3, 14
s_lshl_b32 s13, s3, 20
s_add_u32 m0, s12, 73728
s_add_u32 s6, s13, 0
buffer_load_dwordx4 v152, s[76:79], s6 offen nt lds
s_add_u32 m0, s12, 74752
s_add_u32 s6, s13, 65536
buffer_load_dwordx4 v153, s[76:79], s6 offen nt lds
s_add_u32 m0, s12, 75776
s_add_u32 s6, s13, 131072
buffer_load_dwordx4 v152, s[76:79], s6 offen nt lds
s_add_u32 m0, s12, 76800
s_add_u32 s6, s13, 196608
buffer_load_dwordx4 v153, s[76:79], s6 offen nt lds
s_add_u32 m0, s12, 77824
s_add_u32 s6, s13, 262144
buffer_load_dwordx4 v152, s[76:79], s6 offen nt lds
s_add_u32 m0, s12, 78848
s_add_u32 s6, s13, 327680
buffer_load_dwordx4 v153, s[76:79], s6 offen nt lds
s_add_u32 m0, s12, 79872
s_add_u32 s6, s13, 393216
buffer_load_dwordx4 v152, s[76:79], s6 offen nt lds
s_add_u32 m0, s12, 80896
s_add_u32 s6, s13, 458752
buffer_load_dwordx4 v153, s[76:79], s6 offen nt lds
s_add_u32 m0, s12, 81920
s_add_u32 s6, s13, 524288
buffer_load_dwordx4 v152, s[76:79], s6 offen nt lds
s_add_u32 m0, s12, 82944
s_add_u32 s6, s13, 589824
buffer_load_dwordx4 v153, s[76:79], s6 offen nt lds
s_add_u32 m0, s12, 83968
s_add_u32 s6, s13, 655360
buffer_load_dwordx4 v152, s[76:79], s6 offen nt lds
s_add_u32 m0, s12, 84992
s_add_u32 s6, s13, 720896
buffer_load_dwordx4 v153, s[76:79], s6 offen nt lds
s_add_u32 m0, s12, 86016
s_add_u32 s6, s13, 786432
buffer_load_dwordx4 v152, s[76:79], s6 offen nt lds
s_add_u32 m0, s12, 87040
s_add_u32 s6, s13, 851968
buffer_load_dwordx4 v153, s[76:79], s6 offen nt lds
s_add_u32 m0, s12, 88064
s_add_u32 s6, s13, 917504
buffer_load_dwordx4 v152, s[76:79], s6 offen nt lds
s_add_u32 m0, s12, 89088
s_add_u32 s6, s13, 983040
buffer_load_dwordx4 v153, s[76:79], s6 offen nt lds
s_mul_i32 s12, s3, 18432
s_add_u32 s6, s12, 0
s_mov_b32 m0, s6
s_nop 0
buffer_load_dwordx4 v2, s[60:63], s6 offen nt lds
s_add_u32 s6, s12, 1024
s_mov_b32 m0, s6
s_nop 0
buffer_load_dwordx4 v2, s[60:63], s6 offen nt lds
s_add_u32 s6, s12, 2048
s_mov_b32 m0, s6
s_nop 0
buffer_load_dwordx4 v2, s[60:63], s6 offen nt lds
s_add_u32 s6, s12, 3072
s_mov_b32 m0, s6
s_nop 0
buffer_load_dwordx4 v2, s[60:63], s6 offen nt lds
s_add_u32 s6, s12, 4096
s_mov_b32 m0, s6
s_nop 0
buffer_load_dwordx4 v2, s[60:63], s6 offen nt lds
s_add_u32 s6, s12, 5120
s_mov_b32 m0, s6
s_nop 0
buffer_load_dwordx4 v2, s[60:63], s6 offen nt lds
s_add_u32 s6, s12, 6144
s_mov_b32 m0, s6
s_nop 0
buffer_load_dwordx4 v2, s[60:63], s6 offen nt lds
s_add_u32 s6, s12, 7168
s_mov_b32 m0, s6
s_nop 0
buffer_load_dwordx4 v2, s[60:63], s6 offen nt lds
s_add_u32 s6, s12, 8192
s_mov_b32 m0, s6
s_nop 0
buffer_load_dwordx4 v2, s[60:63], s6 offen nt lds
s_add_u32 s6, s12, 9216
s_mov_b32 m0, s6
s_nop 0
buffer_load_dwordx4 v2, s[60:63], s6 offen nt lds
s_add_u32 s6, s12, 10240
s_mov_b32 m0, s6
s_nop 0
buffer_load_dwordx4 v2, s[60:63], s6 offen nt lds
s_add_u32 s6, s12, 11264
s_mov_b32 m0, s6
s_nop 0
buffer_load_dwordx4 v2, s[60:63], s6 offen nt lds
s_add_u32 s6, s12, 12288
s_mov_b32 m0, s6
s_nop 0
buffer_load_dwordx4 v2, s[60:63], s6 offen nt lds
s_add_u32 s6, s12, 13312
s_mov_b32 m0, s6
s_nop 0
buffer_load_dwordx4 v2, s[60:63], s6 offen nt lds
s_add_u32 s6, s12, 14336
s_mov_b32 m0, s6
s_nop 0
buffer_load_dwordx4 v2, s[60:63], s6 offen nt lds
s_add_u32 s6, s12, 15360
s_mov_b32 m0, s6
s_nop 0
buffer_load_dwordx4 v2, s[60:63], s6 offen nt lds
s_add_u32 s6, s12, 16384
s_mov_b32 m0, s6
s_nop 0
buffer_load_dwordx4 v2, s[60:63], s6 offen nt lds
s_add_u32 s6, s12, 17408
s_mov_b32 m0, s6
s_nop 0
buffer_load_dwordx4 v2, s[60:63], s6 offen nt lds
v_lshrrev_b32 v5, 4, v1
v_lshlrev_b32 v5, 3, v5
v_bfe_u32 v6, v1, 2, 2
v_add_u32 v5, v5, v6
v_mul_u32_u24 v5, 1152, v5
s_mul_i32 s6, s3, 288
v_add_u32 v5, s6, v5
v_and_b32 v6, 3, v1
v_lshl_add_u32 v158, v6, 5, v5
v_lshl_add_u32 v159, v6, 3, v5
v_add_u32 v159, 256, v159
v_bfe_u32 v5, v1, 2, 2
v_lshl_add_u32 v5, v9, 3, v5
v_lshlrev_b32 v5, 7, v5
v_and_b32 v6, 3, v1
v_lshl_add_u32 v5, v6, 3, v5
v_add_u32 v5, 73728, v5
v_bfe_u32 v6, v1, 3, 2
v_xor_b32 v7, 0, v6
v_lshl_add_u32 v154, v7, 5, v5
v_xor_b32 v7, 1, v6
v_lshl_add_u32 v155, v7, 5, v5
v_xor_b32 v7, 2, v6
v_lshl_add_u32 v156, v7, 5, v5
v_xor_b32 v7, 3, v6
v_lshl_add_u32 v157, v7, 5, v5
v_lshlrev_b32 v5, 10, v8
v_lshl_add_u32 v5, v9, 4, v5
v_lshlrev_b32 v6, 3, v8
s_lshl_b32 s6, s4, 10
s_lshl_b32 s7, s3, 7
s_add_u32 s6, s6, s7
s_add_u32 s6, s6, 262144
s_mov_b32 s7, 400000
P_poll:
buffer_load_dwordx2 v[148:149], v6, s[64:67], s6 offen sc1
s_waitcnt vmcnt(0)
v_max_u32 v150, v148, v149
v_cmp_eq_u32 vcc, -1, v150
s_cbranch_vccz P_ok
s_sleep 16
s_sub_u32 s7, s7, 1
s_cmp_lg_u32 s7, 0
s_cbranch_scc1 P_poll
P_ok:
s_lshl_b32 s6, s4, 16
s_lshl_b32 s7, s3, 14
s_add_u32 s6, s6, s7
s_add_u32 s6, s6, 1048576
buffer_load_dwordx4 v[12:15], v5, s[64:67], s6 offen offset:0 sc1
buffer_load_dwordx4 v[16:19], v5, s[64:67], s6 offen offset:64 sc1
buffer_load_dwordx4 v[20:23], v5, s[64:67], s6 offen offset:128 sc1
buffer_load_dwordx4 v[24:27], v5, s[64:67], s6 offen offset:192 sc1
buffer_load_dwordx4 v[28:31], v5, s[64:67], s6 offen offset:256 sc1
buffer_load_dwordx4 v[32:35], v5, s[64:67], s6 offen offset:320 sc1
buffer_load_dwordx4 v[36:39], v5, s[64:67], s6 offen offset:384 sc1
buffer_load_dwordx4 v[40:43], v5, s[64:67], s6 offen offset:448 sc1
buffer_load_dwordx4 v[44:47], v5, s[64:67], s6 offen offset:512 sc1
buffer_load_dwordx4 v[48:51], v5, s[64:67], s6 offen offset:576 sc1
buffer_load_dwordx4 v[52:55], v5, s[64:67], s6 offen offset:640 sc1
buffer_load_dwordx4 v[56:59], v5, s[64:67], s6 offen offset:704 sc1
buffer_load_dwordx4 v[60:63], v5, s[64:67], s6 offen offset:768 sc1
buffer_load_dwordx4 v[64:67], v5, s[64:67], s6 offen offset:832 sc1
buffer_load_dwordx4 v[68:71], v5, s[64:67], s6 offen offset:896 sc1
buffer_load_dwordx4 v[72:75], v5, s[64:67], s6 offen offset:960 sc1
s_barrier
ds_read_b64_tr_b16 a[96:97], v158 offset:0
ds_read_b64_tr_b16 a[98:99], v158 offset:4608
ds_read_b64_tr_b16 a[100:101], v158 offset:36864
ds_read_b64_tr_b16 a[102:103], v158 offset:41472
ds_read_b64_tr_b16 a[104:105], v158 offset:8
ds_read_b64_tr_b16 a[106:107], v158 offset:4616
ds_read_b64_tr_b16 a[108:109], v158 offset:36872
ds_read_b64_tr_b16 a[110:111], v158 offset:41480
ds_read_b64_tr_b16 a[112:113], v158 offset:16
ds_read_b64_tr_b16 a[114:115], v158 offset:4624
ds_read_b64_tr_b16 a[116:117], v158 offset:36880
ds_read_b64_tr_b16 a[118:119], v158 offset:41488
ds_read_b64_tr_b16 a[120:121], v158 offset:24
ds_read_b64_tr_b16 a[122:123], v158 offset:4632
ds_read_b64_tr_b16 a[124:125], v158 offset:36888
ds_read_b64_tr_b16 a[126:127], v158 offset:41496
ds_read_b64_tr_b16 a[128:129], v158 offset:128
ds_read_b64_tr_b16 a[130:131], v158 offset:4736
ds_read_b64_tr_b16 a[132:133], v158 offset:36992
ds_read_b64_tr_b16 a[134:135], v158 offset:41600
ds_read_b64_tr_b16 a[136:137], v158 offset:136
ds_read_b64_tr_b16 a[138:139], v158 offset:4744
ds_read_b64_tr_b16 a[140:141], v158 offset:37000
ds_read_b64_tr_b16 a[142:143], v158 offset:41608
ds_read_b64_tr_b16 a[144:145], v158 offset:144
ds_read_b64_tr_b16 a[146:147], v158 offset:4752
ds_read_b64_tr_b16 a[148:149], v158 offset:37008
ds_read_b64_tr_b16 a[150:151], v158 offset:41616
ds_read_b64_tr_b16 a[152:153], v158 offset:152
ds_read_b64_tr_b16 a[154:155], v158 offset:4760
ds_read_b64_tr_b16 a[156:157], v158 offset:37016
ds_read_b64_tr_b16 a[158:159], v158 offset:41624
ds_read_b64_tr_b16 a[160:161], v159 offset:0
ds_read_b64_tr_b16 a[162:163], v159 offset:4608
ds_read_b64_tr_b16 a[164:165], v159 offset:36864
ds_read_b64_tr_b16 a[166:167], v159 offset:41472
v_mov_b32 v150, v148
s_nop 1
v_max_f32_dpp v150, v150, v150 row_ror:8 row_mask:0xf bank_mask:0xf
s_nop 1
v_max_f32_dpp v150, v150, v150 row_ror:4 row_mask:0xf bank_mask:0xf
s_nop 1
v_max_f32_dpp v150, v150, v150 row_ror:2 row_mask:0xf bank_mask:0xf
s_nop 1
v_max_f32_dpp v150, v150, v150 row_ror:1 row_mask:0xf bank_mask:0xf
v_sub_f32 v148, v148, v150
v_exp_f32 v148, v148
s_nop 0
v_mul_f32 v151, v148, v149
s_nop 1
v_add_f32_dpp v151, v151, v151 row_ror:8 row_mask:0xf bank_mask:0xf
s_nop 1
v_add_f32_dpp v151, v151, v151 row_ror:4 row_mask:0xf bank_mask:0xf
s_nop 1
v_add_f32_dpp v151, v151, v151 row_ror:2 row_mask:0xf bank_mask:0xf
s_nop 1
v_add_f32_dpp v151, v151, v151 row_ror:1 row_mask:0xf bank_mask:0xf
v_rcp_f32 v151, v151
s_nop 0
v_mul_f32 v148, v148, v151
s_nop 1
v_mov_b32_dpp v144, v148 row_newbcast:0 row_mask:0x1 bank_mask:0xf
v_mov_b32_dpp v144, v148 row_newbcast:4 row_mask:0x2 bank_mask:0xf
v_mov_b32_dpp v144, v148 row_newbcast:8 row_mask:0x4 bank_mask:0xf
v_mov_b32_dpp v144, v148 row_newbcast:12 row_mask:0x8 bank_mask:0xf
v_mov_b32_dpp v145, v148 row_newbcast:1 row_mask:0x1 bank_mask:0xf
v_mov_b32_dpp v145, v148 row_newbcast:5 row_mask:0x2 bank_mask:0xf
v_mov_b32_dpp v145, v148 row_newbcast:9 row_mask:0x4 bank_mask:0xf
v_mov_b32_dpp v145, v148 row_newbcast:13 row_mask:0x8 bank_mask:0xf
v_mov_b32_dpp v146, v148 row_newbcast:2 row_mask:0x1 bank_mask:0xf
v_mov_b32_dpp v146, v148 row_newbcast:6 row_mask:0x2 bank_mask:0xf
v_mov_b32_dpp v146, v148 row_newbcast:10 row_mask:0x4 bank_mask:0xf
v_mov_b32_dpp v146, v148 row_newbcast:14 row_mask:0x8 bank_mask:0xf
v_mov_b32_dpp v147, v148 row_newbcast:3 row_mask:0x1 bank_mask:0xf
v_mov_b32_dpp v147, v148 row_newbcast:7 row_mask:0x2 bank_mask:0xf
v_mov_b32_dpp v147, v148 row_newbcast:11 row_mask:0x4 bank_mask:0xf
v_mov_b32_dpp v147, v148 row_newbcast:15 row_mask:0x8 bank_mask:0xf
s_waitcnt lgkmcnt(0)
ds_read_b64_tr_b16 v[76:77], v154 offset:0
ds_read_b64_tr_b16 v[78:79], v154 offset:512
ds_read_b64_tr_b16 v[80:81], v155 offset:0
ds_read_b64_tr_b16 v[82:83], v155 offset:512
ds_read_b64_tr_b16 v[84:85], v156 offset:0
ds_read_b64_tr_b16 v[86:87], v156 offset:512
ds_read_b64_tr_b16 v[88:89], v157 offset:0
ds_read_b64_tr_b16 v[90:91], v157 offset:512
ds_read_b64_tr_b16 v[92:93], v154 offset:4096
ds_read_b64_tr_b16 v[94:95], v154 offset:4608
ds_read_b64_tr_b16 v[96:97], v155 offset:4096
ds_read_b64_tr_b16 v[98:99], v155 offset:4608
ds_read_b64_tr_b16 v[100:101], v156 offset:4096
ds_read_b64_tr_b16 v[102:103], v156 offset:4608
ds_read_b64_tr_b16 v[104:105], v157 offset:4096
ds_read_b64_tr_b16 v[106:107], v157 offset:4608
s_waitcnt vmcnt(15)
s_waitcnt lgkmcnt(8)
v_mfma_f32_16x16x32_bf16 v[108:111], v[12:15], v[76:79], 0
v_mfma_f32_16x16x32_bf16 v[112:115], v[12:15], v[80:83], 0
v_mfma_f32_16x16x32_bf16 v[116:119], v[12:15], v[84:87], 0
v_mfma_f32_16x16x32_bf16 v[120:123], v[12:15], v[88:91], 0
ds_read_b64_tr_b16 v[76:77], v154 offset:8192
ds_read_b64_tr_b16 v[78:79], v154 offset:8704
ds_read_b64_tr_b16 v[80:81], v155 offset:8192
ds_read_b64_tr_b16 v[82:83], v155 offset:8704
ds_read_b64_tr_b16 v[84:85], v156 offset:8192
ds_read_b64_tr_b16 v[86:87], v156 offset:8704
ds_read_b64_tr_b16 v[88:89], v157 offset:8192
ds_read_b64_tr_b16 v[90:91], v157 offset:8704
s_waitcnt vmcnt(14)
s_waitcnt lgkmcnt(8)
v_mfma_f32_16x16x32_bf16 v[108:111], v[16:19], v[92:95], v[108:111]
v_mfma_f32_16x16x32_bf16 v[112:115], v[16:19], v[96:99], v[112:115]
v_mfma_f32_16x16x32_bf16 v[116:119], v[16:19], v[100:103], v[116:119]
v_mfma_f32_16x16x32_bf16 v[120:123], v[16:19], v[104:107], v[120:123]
ds_read_b64_tr_b16 v[92:93], v154 offset:12288
ds_read_b64_tr_b16 v[94:95], v154 offset:12800
ds_read_b64_tr_b16 v[96:97], v155 offset:12288
ds_read_b64_tr_b16 v[98:99], v155 offset:12800
ds_read_b64_tr_b16 v[100:101], v156 offset:12288
ds_read_b64_tr_b16 v[102:103], v156 offset:12800
ds_read_b64_tr_b16 v[104:105], v157 offset:12288
ds_read_b64_tr_b16 v[106:107], v157 offset:12800
s_waitcnt vmcnt(13)
s_waitcnt lgkmcnt(8)
v_mfma_f32_16x16x32_bf16 v[108:111], v[20:23], v[76:79], v[108:111]
v_mfma_f32_16x16x32_bf16 v[112:115], v[20:23], v[80:83], v[112:115]
v_mfma_f32_16x16x32_bf16 v[116:119], v[20:23], v[84:87], v[116:119]
v_mfma_f32_16x16x32_bf16 v[120:123], v[20:23], v[88:91], v[120:123]
ds_read_b64_tr_b16 v[76:77], v154 offset:16384
ds_read_b64_tr_b16 v[78:79], v154 offset:16896
ds_read_b64_tr_b16 v[80:81], v155 offset:16384
ds_read_b64_tr_b16 v[82:83], v155 offset:16896
ds_read_b64_tr_b16 v[84:85], v156 offset:16384
ds_read_b64_tr_b16 v[86:87], v156 offset:16896
ds_read_b64_tr_b16 v[88:89], v157 offset:16384
ds_read_b64_tr_b16 v[90:91], v157 offset:16896
s_waitcnt vmcnt(12)
s_waitcnt lgkmcnt(8)
v_mfma_f32_16x16x32_bf16 v[108:111], v[24:27], v[92:95], v[108:111]
v_mfma_f32_16x16x32_bf16 v[112:115], v[24:27], v[96:99], v[112:115]
v_mfma_f32_16x16x32_bf16 v[116:119], v[24:27], v[100:103], v[116:119]
v_mfma_f32_16x16x32_bf16 v[120:123], v[24:27], v[104:107], v[120:123]
ds_read_b64_tr_b16 v[92:93], v154 offset:20480
ds_read_b64_tr_b16 v[94:95], v154 offset:20992
ds_read_b64_tr_b16 v[96:97], v155 offset:20480
ds_read_b64_tr_b16 v[98:99], v155 offset:20992
ds_read_b64_tr_b16 v[100:101], v156 offset:20480
ds_read_b64_tr_b16 v[102:103], v156 offset:20992
ds_read_b64_tr_b16 v[104:105], v157 offset:20480
ds_read_b64_tr_b16 v[106:107], v157 offset:20992
s_waitcnt vmcnt(11)
s_waitcnt lgkmcnt(8)
v_mfma_f32_16x16x32_bf16 v[108:111], v[28:31], v[76:79], v[108:111]
v_mfma_f32_16x16x32_bf16 v[112:115], v[28:31], v[80:83], v[112:115]
v_mfma_f32_16x16x32_bf16 v[116:119], v[28:31], v[84:87], v[116:119]
v_mfma_f32_16x16x32_bf16 v[120:123], v[28:31], v[88:91], v[120:123]
ds_read_b64_tr_b16 v[76:77], v154 offset:24576
ds_read_b64_tr_b16 v[78:79], v154 offset:25088
ds_read_b64_tr_b16 v[80:81], v155 offset:24576
ds_read_b64_tr_b16 v[82:83], v155 offset:25088
ds_read_b64_tr_b16 v[84:85], v156 offset:24576
ds_read_b64_tr_b16 v[86:87], v156 offset:25088
ds_read_b64_tr_b16 v[88:89], v157 offset:24576
ds_read_b64_tr_b16 v[90:91], v157 offset:25088
s_waitcnt vmcnt(10)
s_waitcnt lgkmcnt(8)
v_mfma_f32_16x16x32_bf16 v[108:111], v[32:35], v[92:95], v[108:111]
v_mfma_f32_16x16x32_bf16 v[112:115], v[32:35], v[96:99], v[112:115]
v_mfma_f32_16x16x32_bf16 v[116:119], v[32:35], v[100:103], v[116:119]
v_mfma_f32_16x16x32_bf16 v[120:123], v[32:35], v[104:107], v[120:123]
ds_read_b64_tr_b16 v[92:93], v154 offset:28672
ds_read_b64_tr_b16 v[94:95], v154 offset:29184
ds_read_b64_tr_b16 v[96:97], v155 offset:28672
ds_read_b64_tr_b16 v[98:99], v155 offset:29184
ds_read_b64_tr_b16 v[100:101], v156 offset:28672
ds_read_b64_tr_b16 v[102:103], v156 offset:29184
ds_read_b64_tr_b16 v[104:105], v157 offset:28672
ds_read_b64_tr_b16 v[106:107], v157 offset:29184
s_waitcnt vmcnt(9)
s_waitcnt lgkmcnt(8)
v_mfma_f32_16x16x32_bf16 v[108:111], v[36:39], v[76:79], v[108:111]
v_mfma_f32_16x16x32_bf16 v[112:115], v[36:39], v[80:83], v[112:115]
v_mfma_f32_16x16x32_bf16 v[116:119], v[36:39], v[84:87], v[116:119]
v_mfma_f32_16x16x32_bf16 v[120:123], v[36:39], v[88:91], v[120:123]
ds_read_b64_tr_b16 v[76:77], v154 offset:32768
ds_read_b64_tr_b16 v[78:79], v154 offset:33280
ds_read_b64_tr_b16 v[80:81], v155 offset:32768
ds_read_b64_tr_b16 v[82:83], v155 offset:33280
ds_read_b64_tr_b16 v[84:85], v156 offset:32768
ds_read_b64_tr_b16 v[86:87], v156 offset:33280
ds_read_b64_tr_b16 v[88:89], v157 offset:32768
ds_read_b64_tr_b16 v[90:91], v157 offset:33280
s_waitcnt vmcnt(8)
s_waitcnt lgkmcnt(8)
v_mfma_f32_16x16x32_bf16 v[108:111], v[40:43], v[92:95], v[108:111]
v_mfma_f32_16x16x32_bf16 v[112:115], v[40:43], v[96:99], v[112:115]
v_mfma_f32_16x16x32_bf16 v[116:119], v[40:43], v[100:103], v[116:119]
v_mfma_f32_16x16x32_bf16 v[120:123], v[40:43], v[104:107], v[120:123]
ds_read_b64_tr_b16 v[92:93], v154 offset:36864
ds_read_b64_tr_b16 v[94:95], v154 offset:37376
ds_read_b64_tr_b16 v[96:97], v155 offset:36864
ds_read_b64_tr_b16 v[98:99], v155 offset:37376
ds_read_b64_tr_b16 v[100:101], v156 offset:36864
ds_read_b64_tr_b16 v[102:103], v156 offset:37376
ds_read_b64_tr_b16 v[104:105], v157 offset:36864
ds_read_b64_tr_b16 v[106:107], v157 offset:37376
s_waitcnt vmcnt(7)
s_waitcnt lgkmcnt(8)
v_mfma_f32_16x16x32_bf16 v[108:111], v[44:47], v[76:79], v[108:111]
v_mfma_f32_16x16x32_bf16 v[112:115], v[44:47], v[80:83], v[112:115]
v_mfma_f32_16x16x32_bf16 v[116:119], v[44:47], v[84:87], v[116:119]
v_mfma_f32_16x16x32_bf16 v[120:123], v[44:47], v[88:91], v[120:123]
ds_read_b64_tr_b16 v[76:77], v154 offset:40960
ds_read_b64_tr_b16 v[78:79], v154 offset:41472
ds_read_b64_tr_b16 v[80:81], v155 offset:40960
ds_read_b64_tr_b16 v[82:83], v155 offset:41472
ds_read_b64_tr_b16 v[84:85], v156 offset:40960
ds_read_b64_tr_b16 v[86:87], v156 offset:41472
ds_read_b64_tr_b16 v[88:89], v157 offset:40960
ds_read_b64_tr_b16 v[90:91], v157 offset:41472
s_waitcnt vmcnt(6)
s_waitcnt lgkmcnt(8)
v_mfma_f32_16x16x32_bf16 v[108:111], v[48:51], v[92:95], v[108:111]
v_mfma_f32_16x16x32_bf16 v[112:115], v[48:51], v[96:99], v[112:115]
v_mfma_f32_16x16x32_bf16 v[116:119], v[48:51], v[100:103], v[116:119]
v_mfma_f32_16x16x32_bf16 v[120:123], v[48:51], v[104:107], v[120:123]
ds_read_b64_tr_b16 v[92:93], v154 offset:45056
ds_read_b64_tr_b16 v[94:95], v154 offset:45568
ds_read_b64_tr_b16 v[96:97], v155 offset:45056
ds_read_b64_tr_b16 v[98:99], v155 offset:45568
ds_read_b64_tr_b16 v[100:101], v156 offset:45056
ds_read_b64_tr_b16 v[102:103], v156 offset:45568
ds_read_b64_tr_b16 v[104:105], v157 offset:45056
ds_read_b64_tr_b16 v[106:107], v157 offset:45568
s_waitcnt vmcnt(5)
s_waitcnt lgkmcnt(8)
v_mfma_f32_16x16x32_bf16 v[108:111], v[52:55], v[76:79], v[108:111]
v_mfma_f32_16x16x32_bf16 v[112:115], v[52:55], v[80:83], v[112:115]
v_mfma_f32_16x16x32_bf16 v[116:119], v[52:55], v[84:87], v[116:119]
v_mfma_f32_16x16x32_bf16 v[120:123], v[52:55], v[88:91], v[120:123]
ds_read_b64_tr_b16 v[76:77], v154 offset:49152
ds_read_b64_tr_b16 v[78:79], v154 offset:49664
ds_read_b64_tr_b16 v[80:81], v155 offset:49152
ds_read_b64_tr_b16 v[82:83], v155 offset:49664
ds_read_b64_tr_b16 v[84:85], v156 offset:49152
ds_read_b64_tr_b16 v[86:87], v156 offset:49664
ds_read_b64_tr_b16 v[88:89], v157 offset:49152
ds_read_b64_tr_b16 v[90:91], v157 offset:49664
s_waitcnt vmcnt(4)
s_waitcnt lgkmcnt(8)
v_mfma_f32_16x16x32_bf16 v[108:111], v[56:59], v[92:95], v[108:111]
v_mfma_f32_16x16x32_bf16 v[112:115], v[56:59], v[96:99], v[112:115]
v_mfma_f32_16x16x32_bf16 v[116:119], v[56:59], v[100:103], v[116:119]
v_mfma_f32_16x16x32_bf16 v[120:123], v[56:59], v[104:107], v[120:123]
ds_read_b64_tr_b16 v[92:93], v154 offset:53248
ds_read_b64_tr_b16 v[94:95], v154 offset:53760
ds_read_b64_tr_b16 v[96:97], v155 offset:53248
ds_read_b64_tr_b16 v[98:99], v155 offset:53760
ds_read_b64_tr_b16 v[100:101], v156 offset:53248
ds_read_b64_tr_b16 v[102:103], v156 offset:53760
ds_read_b64_tr_b16 v[104:105], v157 offset:53248
ds_read_b64_tr_b16 v[106:107], v157 offset:53760
s_waitcnt vmcnt(3)
s_waitcnt lgkmcnt(8)
v_mfma_f32_16x16x32_bf16 v[108:111], v[60:63], v[76:79], v[108:111]
v_mfma_f32_16x16x32_bf16 v[112:115], v[60:63], v[80:83], v[112:115]
v_mfma_f32_16x16x32_bf16 v[116:119], v[60:63], v[84:87], v[116:119]
v_mfma_f32_16x16x32_bf16 v[120:123], v[60:63], v[88:91], v[120:123]
ds_read_b64_tr_b16 v[76:77], v154 offset:57344
ds_read_b64_tr_b16 v[78:79], v154 offset:57856
ds_read_b64_tr_b16 v[80:81], v155 offset:57344
ds_read_b64_tr_b16 v[82:83], v155 offset:57856
ds_read_b64_tr_b16 v[84:85], v156 offset:57344
ds_read_b64_tr_b16 v[86:87], v156 offset:57856
ds_read_b64_tr_b16 v[88:89], v157 offset:57344
ds_read_b64_tr_b16 v[90:91], v157 offset:57856
s_waitcnt vmcnt(2)
s_waitcnt lgkmcnt(8)
v_mfma_f32_16x16x32_bf16 v[108:111], v[64:67], v[92:95], v[108:111]
v_mfma_f32_16x16x32_bf16 v[112:115], v[64:67], v[96:99], v[112:115]
v_mfma_f32_16x16x32_bf16 v[116:119], v[64:67], v[100:103], v[116:119]
v_mfma_f32_16x16x32_bf16 v[120:123], v[64:67], v[104:107], v[120:123]
ds_read_b64_tr_b16 v[92:93], v154 offset:61440
ds_read_b64_tr_b16 v[94:95], v154 offset:61952
ds_read_b64_tr_b16 v[96:97], v155 offset:61440
ds_read_b64_tr_b16 v[98:99], v155 offset:61952
ds_read_b64_tr_b16 v[100:101], v156 offset:61440
ds_read_b64_tr_b16 v[102:103], v156 offset:61952
ds_read_b64_tr_b16 v[104:105], v157 offset:61440
ds_read_b64_tr_b16 v[106:107], v157 offset:61952
s_waitcnt vmcnt(1)
s_waitcnt lgkmcnt(8)
v_mfma_f32_16x16x32_bf16 v[108:111], v[68:71], v[76:79], v[108:111]
v_mfma_f32_16x16x32_bf16 v[112:115], v[68:71], v[80:83], v[112:115]
v_mfma_f32_16x16x32_bf16 v[116:119], v[68:71], v[84:87], v[116:119]
v_mfma_f32_16x16x32_bf16 v[120:123], v[68:71], v[88:91], v[120:123]
s_waitcnt vmcnt(0)
s_waitcnt lgkmcnt(0)
v_mfma_f32_16x16x32_bf16 v[108:111], v[72:75], v[92:95], v[108:111]
v_mfma_f32_16x16x32_bf16 v[112:115], v[72:75], v[96:99], v[112:115]
v_mfma_f32_16x16x32_bf16 v[116:119], v[72:75], v[100:103], v[116:119]
v_mfma_f32_16x16x32_bf16 v[120:123], v[72:75], v[104:107], v[120:123]
v_lshlrev_b32 v5, 7, v9
v_lshl_add_u32 v5, v8, 1, v5
s_lshl_b32 s6, s3, 9
s_add_u32 s6, s6, 139264
v_add_u32 v5, s6, v5
v_mul_f32 v172, v144, v108
v_fma_f32 v172, v145, v109, v172
v_fma_f32 v172, v146, v110, v172
v_fma_f32 v172, v147, v111, v172
v_cvt_pk_bf16_f32 v172, v172, v172
ds_write_b16 v5, v172 offset:0
v_mul_f32 v173, v144, v112
v_fma_f32 v173, v145, v113, v173
v_fma_f32 v173, v146, v114, v173
v_fma_f32 v173, v147, v115, v173
v_cvt_pk_bf16_f32 v173, v173, v173
ds_write_b16 v5, v173 offset:32
v_mul_f32 v174, v144, v116
v_fma_f32 v174, v145, v117, v174
v_fma_f32 v174, v146, v118, v174
v_fma_f32 v174, v147, v119, v174
v_cvt_pk_bf16_f32 v174, v174, v174
ds_write_b16 v5, v174 offset:64
v_mul_f32 v175, v144, v120
v_fma_f32 v175, v145, v121, v175
v_fma_f32 v175, v146, v122, v175
v_fma_f32 v175, v147, v123, v175
v_cvt_pk_bf16_f32 v175, v175, v175
ds_write_b16 v5, v175 offset:96
v_lshlrev_b32 v6, 7, v8
v_lshl_add_u32 v6, v9, 4, v6
v_add_u32 v6, 139264, v6
v_mov_b32 v11, 141312
v_mov_b32 v7, 0
ds_write_b32 v11, v7
s_waitcnt lgkmcnt(0)
s_barrier
ds_read_b128 v[164:167], v6 offset:0
ds_read_b128 v[168:171], v6 offset:64
v_mul_u32_u24 v5, 147456, v9
v_and_b32 v6, 3, v1
v_bfe_u32 v7, v1, 2, 2
v_lshl_add_u32 v6, v6, 2, v7
v_lshl_add_u32 v6, v6, 2, v5
v_lshl_add_u32 v5, v8, 4, v5
s_mul_i32 s6, s9, 2304
s_mul_i32 s7, s3, 576
s_add_u32 s6, s6, s7
s_add_u32 s6, s6, 5242880
s_waitcnt lgkmcnt(0)
v_mfma_f32_16x16x32_bf16 v[108:111], v[164:167], a[96:99], 0
v_mfma_f32_16x16x32_bf16 v[108:111], v[168:171], a[100:103], v[108:111]
v_mfma_f32_16x16x32_bf16 v[112:115], v[164:167], a[104:107], 0
v_mfma_f32_16x16x32_bf16 v[112:115], v[168:171], a[108:111], v[112:115]
v_mfma_f32_16x16x32_bf16 v[116:119], v[164:167], a[112:115], 0
v_mfma_f32_16x16x32_bf16 v[116:119], v[168:171], a[116:119], v[116:119]
v_mfma_f32_16x16x32_bf16 v[120:123], v[164:167], a[120:123], 0
v_mfma_f32_16x16x32_bf16 v[120:123], v[168:171], a[124:127], v[120:123]
v_mfma_f32_16x16x32_bf16 v[124:127], v[164:167], a[128:131], 0
v_mfma_f32_16x16x32_bf16 v[124:127], v[168:171], a[132:135], v[124:127]
v_mfma_f32_16x16x32_bf16 v[128:131], v[164:167], a[136:139], 0
v_mfma_f32_16x16x32_bf16 v[128:131], v[168:171], a[140:143], v[128:131]
v_mfma_f32_16x16x32_bf16 v[132:135], v[164:167], a[144:147], 0
v_mfma_f32_16x16x32_bf16 v[132:135], v[168:171], a[148:151], v[132:135]
v_mfma_f32_16x16x32_bf16 v[136:139], v[164:167], a[152:155], 0
v_mfma_f32_16x16x32_bf16 v[136:139], v[168:171], a[156:159], v[136:139]
v_mfma_f32_16x16x32_bf16 v[140:143], v[164:167], a[160:163], 0
v_mfma_f32_16x16x32_bf16 v[140:143], v[168:171], a[164:167], v[140:143]
v_add_f32 v108, v108, v109
v_add_f32 v110, v110, v111
v_add_f32 v172, v108, v110
v_min_u32 v172, -2, v172
v_add_f32 v112, v112, v113
v_add_f32 v114, v114, v115
v_add_f32 v173, v112, v114
v_min_u32 v173, -2, v173
v_add_f32 v116, v116, v117
v_add_f32 v118, v118, v119
v_add_f32 v174, v116, v118
v_min_u32 v174, -2, v174
v_add_f32 v120, v120, v121
v_add_f32 v122, v122, v123
v_add_f32 v175, v120, v122
v_min_u32 v175, -2, v175
v_add_f32 v124, v124, v125
v_add_f32 v126, v126, v127
v_add_f32 v176, v124, v126
v_min_u32 v176, -2, v176
v_add_f32 v128, v128, v129
v_add_f32 v130, v130, v131
v_add_f32 v177, v128, v130
v_min_u32 v177, -2, v177
v_add_f32 v132, v132, v133
v_add_f32 v134, v134, v135
v_add_f32 v178, v132, v134
v_min_u32 v178, -2, v178
v_add_f32 v136, v136, v137
v_add_f32 v138, v138, v139
v_add_f32 v179, v136, v138
v_min_u32 v179, -2, v179
v_add_f32 v140, v140, v141
v_add_f32 v142, v142, v143
v_add_f32 v180, v140, v142
v_min_u32 v180, -2, v180
buffer_store_dwordx4 v[172:175], v5, s[64:67], s6 offen sc1
buffer_store_dwordx4 v[176:179], v5, s[64:67], s6 offen offset:256 sc1
buffer_store_dword v180, v6, s[64:67], s6 offen offset:512 sc1
s_cmp_eq_u32 s3, 3
s_cbranch_scc1 H_start
s_mov_b32 s14, s9
s_lshr_b32 s7, s3, 1
s_cmp_lg_u32 s3, 1
s_cbranch_scc1 L_w1_19
s_and_b32 s7, s9, 7
s_cmp_ge_u32 s7, 2
s_cbranch_scc1 B_end
s_lshr_b32 s14, s9, 3
s_add_u32 s14, s14, 64
L_w1_19:
s_mul_i32 s15, s14, 57
s_lshr_b32 s15, s15, 10
s_mul_i32 s6, s15, 18
s_sub_u32 s80, s14, s6
s_mul_i32 s81, s15, 147456
s_lshl_b32 s6, s80, 7
s_add_u32 s81, s81, s6
s_mul_i32 s6, s7, 1048576
s_add_u32 s81, s81, s6
s_add_u32 s81, s81, 4194304
s_mul_i32 s83, s15, 2304
s_lshl_b32 s6, s80, 6
s_add_u32 s83, s83, s6
s_mul_i32 s6, s7, 1152
s_add_u32 s83, s83, s6
v_lshrrev_b32 v5, 3, v1
v_and_b32 v6, 7, v1
v_mul_u32_u24 v44, 2304, v5
v_lshl_add_u32 v44, v6, 4, v44
v_bfe_u32 v5, v1, 2, 1
v_lshl_add_u32 v5, v5, 2, v9
v_and_b32 v6, 3, v1
v_lshl_add_u32 v5, v5, 2, v6
v_lshlrev_b32 v45, 1, v5
s_mov_b32 s82, 0
s_mov_b32 s7, 400000
R_pass:
s_bitcmp1_b32 s82, 0
s_cbranch_scc1 L_ld_20
s_add_u32 s6, s81, 0
buffer_load_dwordx4 v[12:15], v44, s[64:67], s6 offen sc1
L_ld_20:
s_bitcmp1_b32 s82, 1
s_cbranch_scc1 L_ld_21
s_add_u32 s6, s81, 18432
buffer_load_dwordx4 v[16:19], v44, s[64:67], s6 offen sc1
L_ld_21:
s_bitcmp1_b32 s82, 2
s_cbranch_scc1 L_ld_22
s_add_u32 s6, s81, 36864
buffer_load_dwordx4 v[20:23], v44, s[64:67], s6 offen sc1
L_ld_22:
s_bitcmp1_b32 s82, 3
s_cbranch_scc1 L_ld_23
s_add_u32 s6, s81, 55296
buffer_load_dwordx4 v[24:27], v44, s[64:67], s6 offen sc1
L_ld_23:
s_bitcmp1_b32 s82, 4
s_cbranch_scc1 L_ld_24
s_add_u32 s6, s81, 73728
buffer_load_dwordx4 v[28:31], v44, s[64:67], s6 offen sc1
L_ld_24:
s_bitcmp1_b32 s82, 5
s_cbranch_scc1 L_ld_25
s_add_u32 s6, s81, 92160
buffer_load_dwordx4 v[32:35], v44, s[64:67], s6 offen sc1
L_ld_25:
s_bitcmp1_b32 s82, 6
s_cbranch_scc1 L_ld_26
s_add_u32 s6, s81, 110592
buffer_load_dwordx4 v[36:39], v44, s[64:67], s6 offen sc1
L_ld_26:
s_bitcmp1_b32 s82, 7
s_cbranch_scc1 L_ld_27
s_add_u32 s6, s81, 129024
buffer_load_dwordx4 v[40:43], v44, s[64:67], s6 offen sc1
L_ld_27:
s_waitcnt vmcnt(0)
s_bitcmp1_b32 s82, 0
s_cbranch_scc1 L_ck_28
v_max3_u32 v46, v12, v13, v14
v_max_u32 v46, v46, v15
v_cmp_eq_u32 vcc, -1, v46
s_cbranch_vccnz L_ck_28
s_bitset1_b32 s82, 0
L_ck_28:
s_bitcmp1_b32 s82, 1
s_cbranch_scc1 L_ck_29
v_max3_u32 v46, v16, v17, v18
v_max_u32 v46, v46, v19
v_cmp_eq_u32 vcc, -1, v46
s_cbranch_vccnz L_ck_29
s_bitset1_b32 s82, 1
L_ck_29:
s_bitcmp1_b32 s82, 2
s_cbranch_scc1 L_ck_30
v_max3_u32 v46, v20, v21, v22
v_max_u32 v46, v46, v23
v_cmp_eq_u32 vcc, -1, v46
s_cbranch_vccnz L_ck_30
s_bitset1_b32 s82, 2
L_ck_30:
s_bitcmp1_b32 s82, 3
s_cbranch_scc1 L_ck_31
v_max3_u32 v46, v24, v25, v26
v_max_u32 v46, v46, v27
v_cmp_eq_u32 vcc, -1, v46
s_cbranch_vccnz L_ck_31
s_bitset1_b32 s82, 3
L_ck_31:
s_bitcmp1_b32 s82, 4
s_cbranch_scc1 L_ck_32
v_max3_u32 v46, v28, v29, v30
v_max_u32 v46, v46, v31
v_cmp_eq_u32 vcc, -1, v46
s_cbranch_vccnz L_ck_32
s_bitset1_b32 s82, 4
L_ck_32:
s_bitcmp1_b32 s82, 5
s_cbranch_scc1 L_ck_33
v_max3_u32 v46, v32, v33, v34
v_max_u32 v46, v46, v35
v_cmp_eq_u32 vcc, -1, v46
s_cbranch_vccnz L_ck_33
s_bitset1_b32 s82, 5
L_ck_33:
s_bitcmp1_b32 s82, 6
s_cbranch_scc1 L_ck_34
v_max3_u32 v46, v36, v37, v38
v_max_u32 v46, v46, v39
v_cmp_eq_u32 vcc, -1, v46
s_cbranch_vccnz L_ck_34
s_bitset1_b32 s82, 6
L_ck_34:
s_bitcmp1_b32 s82, 7
s_cbranch_scc1 L_ck_35
v_max3_u32 v46, v40, v41, v42
v_max_u32 v46, v46, v43
v_cmp_eq_u32 vcc, -1, v46
s_cbranch_vccnz L_ck_35
s_bitset1_b32 s82, 7
L_ck_35:
s_cmp_eq_u32 s82, 255
s_cbranch_scc1 R_done
s_sub_u32 s7, s7, 1
s_cmp_lg_u32 s7, 0
s_cbranch_scc1 R_pass
R_done:
v_pk_add_f32 v[12:13], v[12:13], v[28:29]
v_pk_add_f32 v[14:15], v[14:15], v[30:31]
v_pk_add_f32 v[16:17], v[16:17], v[32:33]
v_pk_add_f32 v[18:19], v[18:19], v[34:35]
v_pk_add_f32 v[20:21], v[20:21], v[36:37]
v_pk_add_f32 v[22:23], v[22:23], v[38:39]
v_pk_add_f32 v[24:25], v[24:25], v[40:41]
v_pk_add_f32 v[26:27], v[26:27], v[42:43]
v_pk_add_f32 v[12:13], v[12:13], v[20:21]
v_pk_add_f32 v[14:15], v[14:15], v[22:23]
v_pk_add_f32 v[16:17], v[16:17], v[24:25]
v_pk_add_f32 v[18:19], v[18:19], v[26:27]
v_pk_add_f32 v[12:13], v[12:13], v[16:17]
v_pk_add_f32 v[14:15], v[14:15], v[18:19]
s_nop 1
v_permlane32_swap_b32 v12, v14
v_permlane32_swap_b32 v13, v15
v_add_f32 v12, v12, v14
v_add_f32 v13, v13, v15
s_nop 1
v_permlane16_swap_b32 v12, v13
v_add_f32 v12, v12, v13
s_nop 1
v_add_f32_dpp v12, v12, v12 row_ror:8 row_mask:0xf bank_mask:0xf
v_cvt_pk_bf16_f32 v12, v12, v12
s_mov_b32 exec_lo, 0x00ff00ff
s_mov_b32 exec_hi, 0x00ff00ff
buffer_store_short v12, v45, s[72:75], s83 offen
s_mov_b64 exec, -1
s_cmp_lg_u32 s3, 0
s_cbranch_scc1 B_fin
ds_write_b32 v11, v11
s_waitcnt lgkmcnt(0)
B_fin:
B_end:
s_endpgm
H_start:
s_lshl_b32 s6, s8, 6
s_add_u32 s6, s6, s4
s_lshl_b32 s6, s6, 20
s_add_u32 s56, s20, s6
s_addc_u32 s57, s21, 0
s_mov_b32 s58, 34603008
s_mov_b32 s59, 0x20000
v_lshlrev_b32 v16, 7, v1
v_and_b32 v17, 4095, v16
v_add_u32 v16, 4096, v16
v_lshrrev_b32 v21, 5, v1
v_mul_u32_u24 v21, 20480, v21
v_add_u32 v17, v17, v21
s_and_b32 s6, s9, 56
v_and_b32 v19, 7, v1
v_add_u32 v19, s6, v19
v_mul_u32_u24 v19, 16, v19
v_add_u32 v19, 393216, v19
s_mov_b32 s16, 43
s_mov_b32 s17, 43
s_mov_b32 s18, 43
s_mov_b32 s31, 400000
buffer_load_dwordx3 v[12:14], v19, s[64:67], 0 offen sc1
s_waitcnt vmcnt(0)
H_loop:
v_med3_i32 v12, v12, -1, 31
v_med3_i32 v13, v13, -1, 31
v_med3_i32 v14, v14, -1, 31
v_add3_u32 v20, v12, v13, v14
s_nop 1
v_add_u32_dpp v20, v20, v20 row_ror:4 row_mask:0xf bank_mask:0xf
s_nop 1
v_add_u32_dpp v20, v20, v20 row_ror:2 row_mask:0xf bank_mask:0xf
s_nop 1
v_add_u32_dpp v20, v20, v20 row_ror:1 row_mask:0xf bank_mask:0xf
v_lshlrev_b32 v20, 3, v20
s_nop 0
v_readfirstlane_b32 s28, v20
v_readlane_b32 s20, v12, s9
v_readlane_b32 s21, v13, s9
v_readlane_b32 s22, v14, s9
buffer_load_dwordx3 v[12:14], v19, s[64:67], 0 offen sc1
s_mul_i32 s6, s20, 192
s_sub_i32 s24, s28, s6
s_mul_i32 s6, s16, 24
s_add_i32 s24, s24, s6
s_add_i32 s6, s16, -15
s_cmp_ge_i32 s6, s20
s_cselect_b32 s24, s24, -1048576
s_mul_i32 s6, s21, 192
s_sub_i32 s25, s28, s6
s_mul_i32 s6, s17, 24
s_add_i32 s25, s25, s6
s_add_i32 s6, s17, -15
s_cmp_ge_i32 s6, s21
s_cselect_b32 s25, s25, -1048576
s_mul_i32 s6, s22, 192
s_sub_i32 s26, s28, s6
s_mul_i32 s6, s18, 24
s_add_i32 s26, s26, s6
s_add_i32 s6, s18, -15
s_cmp_ge_i32 s6, s22
s_cselect_b32 s26, s26, -1048576
s_cmp_ge_i32 s24, s25
s_cselect_b32 s29, 0, 1
s_max_i32 s30, s24, s25
s_cmp_ge_i32 s30, s26
s_cselect_b32 s29, s29, 2
s_max_i32 s30, s30, s26
s_cmp_eq_i32 s30, -1048576
s_cbranch_scc1 H_end
s_sub_u32 s31, s31, 1
s_cmp_eq_u32 s31, 0
s_cbranch_scc1 H_end
s_cmp_lt_i32 s30, 1416
s_cbranch_scc1 H_idle
s_cmp_eq_u32 s29, 0
s_cselect_b32 s6, s16, s6
s_subb_u32 s16, s16, 0
s_cmp_eq_u32 s29, 1
s_cselect_b32 s6, s17, s6
s_subb_u32 s17, s17, 0
s_cmp_eq_u32 s29, 2
s_cselect_b32 s6, s18, s6
s_subb_u32 s18, s18, 0
s_mul_i32 s6, s6, 24576
s_sub_u32 s6, s6, 32768
s_cmp_eq_u32 s29, 2
s_cselect_b32 s7, 33554432, 0
s_add_u32 s6, s6, s7
s_cmp_eq_u32 s29, 1
s_cselect_b64 vcc, -1, 0
s_cselect_b32 s7, 25, 13
s_lshl_b32 s7, 1, s7
s_add_u32 s7, s7, s6
v_cndmask_b32 v18, v16, v17, vcc
buffer_load_dword v22, v18, s[56:59], s6 offen
buffer_load_dword v23, v18, s[56:59], s7 offen
s_waitcnt vmcnt(2)
s_branch H_loop
H_idle:
ds_read_b32 v21, v11
s_waitcnt vmcnt(0) lgkmcnt(0)
s_sleep 4
v_cmp_eq_u32 vcc, 0, v21
s_cbranch_vccnz H_loop
H_end:
s_branch B_end
.section .rodata,"a"
.p2align 6
.amdhsa_kernel concat_heads__mha_block_cached__compressed_kv_cla__decode_kernel
  .amdhsa_next_free_vgpr 512
  .amdhsa_next_free_sgpr 102
  .amdhsa_accum_offset 256
  .amdhsa_group_segment_fixed_size 0
  .amdhsa_kernarg_size 112
  .amdhsa_user_sgpr_count 2
  .amdhsa_user_sgpr_kernarg_segment_ptr 1
  .amdhsa_system_sgpr_workgroup_id_x 1
.end_amdhsa_kernel
```

```asm
; @launch grid=(256,1,1) block=(256,1,1) lds=163840
.amdgcn_target "amdgcn-amd-amdhsa--gfx950"
.text
.globl concat_heads__mha_block_cached__compressed_kv_cla__decode_kernel
.p2align 8
.type concat_heads__mha_block_cached__compressed_kv_cla__decode_kernel,@function
concat_heads__mha_block_cached__compressed_kv_cla__decode_kernel:
s_cmp_ge_u32 s2, 256
s_cbranch_scc1 L_exit
s_load_dwordx16 s[16:31], s[0:1], 0
s_load_dwordx8 s[32:39], s[0:1], 64
s_load_dwordx4 s[40:43], s[0:1], 96
v_lshrrev_b32 v1, 6, v0
s_nop 0
v_readfirstlane_b32 s3, v1
s_and_b32 s6, s2, 7
s_bfe_u32 s7, s2, 0x20003
s_lshl_b32 s4, s6, 2
s_add_u32 s4, s4, s7
s_lshr_b32 s5, s2, 5
s_cmp_lt_u32 s5, 2
s_cbranch_scc1 B_role
A_role:
s_sub_u32 s8, s5, 2
s_cmp_ge_u32 s8, 3
s_cselect_b32 s9, 1, 0
s_cselect_b32 s6, 3, 0
s_sub_u32 s8, s8, s6
s_lshl_b32 s11, s8, 2
s_add_u32 s11, s11, s3
s_cmp_ge_u32 s11, 6
s_cselect_b32 s83, 1, 0
s_cselect_b32 s6, -1, 1
s_add_u32 s11, s11, s6
s_cmp_ge_u32 s11, 6
s_cselect_b32 s6, 6, 0
s_sub_u32 s11, s11, s6
s_lshl_b32 s10, s9, 1
s_add_u32 s10, s10, s83
v_and_b32 v1, 63, v0
v_lshlrev_b32 v2, 4, v1
s_sub_u32 s14, s11, 8
s_lshl_b32 s14, s14, 12
s_mov_b32 s13, s14
s_add_u32 s13, s13, 24576
s_min_u32 s12, s13, 2146435072
s_lshl_b32 s82, s10, 5
s_add_u32 s82, s82, s4
s_lshl_b32 s6, s82, 20
s_waitcnt lgkmcnt(0)
s_add_u32 s52, s18, s6
s_addc_u32 s53, s19, 0
s_mov_b32 s54, 1048576
s_mov_b32 s55, 0x20000
s_add_u32 s56, s20, s6
s_addc_u32 s57, s21, 0
s_mov_b32 s58, 1048576
s_mov_b32 s59, 0x20000
s_mul_i32 s6, s9, 2304
s_mul_i32 s7, s3, 288
s_add_u32 s6, s6, s7
s_sub_u32 s7, 4608, s6
s_add_u32 s44, s16, s6
s_addc_u32 s45, s17, 0
s_mov_b32 s46, s7
s_mov_b32 s47, 0x20000
s_mul_i32 s6, s3, 1179648
s_lshl_b32 s7, s4, 8
s_add_u32 s6, s6, s7
s_sub_u32 s7, 4718592, s6
s_add_u32 s48, s22, s6
s_addc_u32 s49, s23, 0
s_mov_b32 s50, s7
s_mov_b32 s51, 0x20000
v_lshrrev_b32 v5, 4, v1
v_and_b32 v6, 15, v1
v_mul_u32_u24 v3, 294912, v5
v_lshl_add_u32 v3, v6, 4, v3
v_mul_u32_u24 v4, 72, v5
v_lshrrev_b32 v6, 3, v6
v_mul_u32_u24 v6, 1152, v6
v_add_u32 v4, v4, v6
v_mov_b32 v7, 7168
s_lshr_b32 s6, s2, 3
s_sub_u32 s6, s6, 8
s_lshl_b32 s6, s6, 2
s_add_u32 s6, s6, s3
s_mul_i32 s6, s6, 49152
s_and_b32 s7, s2, 7
s_lshl_b32 s7, s7, 10
s_add_u32 s6, s6, s7
s_mov_b32 s60, s22
s_mov_b32 s61, s23
s_mov_b32 s62, 4718592
s_mov_b32 s63, 0x20000
v_min_u32 v35, 47, v1
v_lshrrev_b32 v36, 3, v35
v_lshlrev_b32 v35, 7, v35
v_mad_u32_u24 v36, v36, v7, v35
buffer_load_dword v120, v36, s[60:63], s6 offen
buffer_load_dwordx4 v[40:43], v4, s[44:47], 0 offen offset:0
buffer_load_dwordx4 v[44:47], v4, s[44:47], 0 offen offset:16
buffer_load_dwordx4 v[48:51], v4, s[44:47], 0 offen offset:32
buffer_load_dwordx4 v[52:55], v4, s[44:47], 0 offen offset:48
buffer_load_dwordx2 v[56:57], v4, s[44:47], 0 offen offset:64
s_waitcnt vmcnt(54)
buffer_load_dwordx4 v[136:139], v2, s[52:55], s12 offen offset:0 nt
buffer_load_dwordx4 v[140:143], v2, s[52:55], s12 offen offset:1024 nt
buffer_load_dwordx4 v[144:147], v2, s[52:55], s12 offen offset:2048 nt
buffer_load_dwordx4 v[148:151], v2, s[52:55], s12 offen offset:3072 nt
s_add_u32 s13, s13, 24576
s_min_u32 s12, s13, 2146435072
s_waitcnt vmcnt(54)
buffer_load_dwordx4 v[152:155], v2, s[52:55], s12 offen offset:0 nt
buffer_load_dwordx4 v[156:159], v2, s[52:55], s12 offen offset:1024 nt
buffer_load_dwordx4 v[160:163], v2, s[52:55], s12 offen offset:2048 nt
buffer_load_dwordx4 v[164:167], v2, s[52:55], s12 offen offset:3072 nt
s_add_u32 s13, s13, 24576
s_min_u32 s12, s13, 2146435072
s_cmp_lg_u32 s8, 0
s_cbranch_scc1 L_nowq_1
s_waitcnt vmcnt(20)
s_mov_b32 s6, 0
buffer_load_dwordx4 a[96:99], v3, s[48:51], s6 offen
s_mov_b32 s6, 8192
buffer_load_dwordx4 a[100:103], v3, s[48:51], s6 offen
s_mov_b32 s6, 16384
buffer_load_dwordx4 a[104:107], v3, s[48:51], s6 offen
s_mov_b32 s6, 24576
buffer_load_dwordx4 a[108:111], v3, s[48:51], s6 offen
s_mov_b32 s6, 32768
buffer_load_dwordx4 a[112:115], v3, s[48:51], s6 offen
s_mov_b32 s6, 40960
buffer_load_dwordx4 a[116:119], v3, s[48:51], s6 offen
s_mov_b32 s6, 49152
buffer_load_dwordx4 a[120:123], v3, s[48:51], s6 offen
s_mov_b32 s6, 57344
buffer_load_dwordx4 a[124:127], v3, s[48:51], s6 offen
s_mov_b32 s6, 65536
buffer_load_dwordx4 a[128:131], v3, s[48:51], s6 offen
s_mov_b32 s6, 73728
buffer_load_dwordx4 a[132:135], v3, s[48:51], s6 offen
s_mov_b32 s6, 81920
buffer_load_dwordx4 a[136:139], v3, s[48:51], s6 offen
s_mov_b32 s6, 90112
buffer_load_dwordx4 a[140:143], v3, s[48:51], s6 offen
s_mov_b32 s6, 98304
buffer_load_dwordx4 a[144:147], v3, s[48:51], s6 offen
s_mov_b32 s6, 106496
buffer_load_dwordx4 a[148:151], v3, s[48:51], s6 offen
s_mov_b32 s6, 114688
buffer_load_dwordx4 a[152:155], v3, s[48:51], s6 offen
s_mov_b32 s6, 122880
buffer_load_dwordx4 a[156:159], v3, s[48:51], s6 offen
s_mov_b32 s6, 131072
buffer_load_dwordx4 a[160:163], v3, s[48:51], s6 offen
s_mov_b32 s6, 139264
buffer_load_dwordx4 a[164:167], v3, s[48:51], s6 offen
s_mov_b32 s6, 147456
buffer_load_dwordx4 a[168:171], v3, s[48:51], s6 offen
s_mov_b32 s6, 155648
buffer_load_dwordx4 a[172:175], v3, s[48:51], s6 offen
s_mov_b32 s6, 163840
buffer_load_dwordx4 a[176:179], v3, s[48:51], s6 offen
s_mov_b32 s6, 172032
buffer_load_dwordx4 a[180:183], v3, s[48:51], s6 offen
s_mov_b32 s6, 180224
buffer_load_dwordx4 a[184:187], v3, s[48:51], s6 offen
s_mov_b32 s6, 188416
buffer_load_dwordx4 a[188:191], v3, s[48:51], s6 offen
s_mov_b32 s6, 196608
buffer_load_dwordx4 a[192:195], v3, s[48:51], s6 offen
s_mov_b32 s6, 204800
buffer_load_dwordx4 a[196:199], v3, s[48:51], s6 offen
s_mov_b32 s6, 212992
buffer_load_dwordx4 a[200:203], v3, s[48:51], s6 offen
s_mov_b32 s6, 221184
buffer_load_dwordx4 a[204:207], v3, s[48:51], s6 offen
s_mov_b32 s6, 229376
buffer_load_dwordx4 a[208:211], v3, s[48:51], s6 offen
s_mov_b32 s6, 237568
buffer_load_dwordx4 a[212:215], v3, s[48:51], s6 offen
s_mov_b32 s6, 245760
buffer_load_dwordx4 a[216:219], v3, s[48:51], s6 offen
s_mov_b32 s6, 253952
buffer_load_dwordx4 a[220:223], v3, s[48:51], s6 offen
s_mov_b32 s6, 262144
buffer_load_dwordx4 a[224:227], v3, s[48:51], s6 offen
s_mov_b32 s6, 270336
buffer_load_dwordx4 a[228:231], v3, s[48:51], s6 offen
s_mov_b32 s6, 278528
buffer_load_dwordx4 a[232:235], v3, s[48:51], s6 offen
s_mov_b32 s6, 286720
buffer_load_dwordx4 a[236:239], v3, s[48:51], s6 offen
L_nowq_1:
s_waitcnt vmcnt(54)
buffer_load_dwordx4 v[168:171], v2, s[52:55], s12 offen offset:0 nt
buffer_load_dwordx4 v[172:175], v2, s[52:55], s12 offen offset:1024 nt
buffer_load_dwordx4 v[176:179], v2, s[52:55], s12 offen offset:2048 nt
buffer_load_dwordx4 v[180:183], v2, s[52:55], s12 offen offset:3072 nt
s_add_u32 s13, s13, 24576
s_min_u32 s12, s13, 2146435072
s_waitcnt vmcnt(54)
buffer_load_dwordx4 v[184:187], v2, s[52:55], s12 offen offset:0 nt
buffer_load_dwordx4 v[188:191], v2, s[52:55], s12 offen offset:1024 nt
buffer_load_dwordx4 v[192:195], v2, s[52:55], s12 offen offset:2048 nt
buffer_load_dwordx4 v[196:199], v2, s[52:55], s12 offen offset:3072 nt
s_add_u32 s13, s13, 24576
s_min_u32 s12, s13, 2146435072
s_waitcnt vmcnt(54)
buffer_load_dwordx4 v[200:203], v2, s[52:55], s12 offen offset:0 nt
buffer_load_dwordx4 v[204:207], v2, s[52:55], s12 offen offset:1024 nt
buffer_load_dwordx4 v[208:211], v2, s[52:55], s12 offen offset:2048 nt
buffer_load_dwordx4 v[212:215], v2, s[52:55], s12 offen offset:3072 nt
s_add_u32 s13, s13, 24576
s_min_u32 s12, s13, 2146435072
s_cmp_lg_u32 s8, 1
s_cbranch_scc1 L_nowq_2
s_waitcnt vmcnt(20)
s_mov_b32 s6, 0
buffer_load_dwordx4 a[96:99], v3, s[48:51], s6 offen
s_mov_b32 s6, 8192
buffer_load_dwordx4 a[100:103], v3, s[48:51], s6 offen
s_mov_b32 s6, 16384
buffer_load_dwordx4 a[104:107], v3, s[48:51], s6 offen
s_mov_b32 s6, 24576
buffer_load_dwordx4 a[108:111], v3, s[48:51], s6 offen
s_mov_b32 s6, 32768
buffer_load_dwordx4 a[112:115], v3, s[48:51], s6 offen
s_mov_b32 s6, 40960
buffer_load_dwordx4 a[116:119], v3, s[48:51], s6 offen
s_mov_b32 s6, 49152
buffer_load_dwordx4 a[120:123], v3, s[48:51], s6 offen
s_mov_b32 s6, 57344
buffer_load_dwordx4 a[124:127], v3, s[48:51], s6 offen
s_mov_b32 s6, 65536
buffer_load_dwordx4 a[128:131], v3, s[48:51], s6 offen
s_mov_b32 s6, 73728
buffer_load_dwordx4 a[132:135], v3, s[48:51], s6 offen
s_mov_b32 s6, 81920
buffer_load_dwordx4 a[136:139], v3, s[48:51], s6 offen
s_mov_b32 s6, 90112
buffer_load_dwordx4 a[140:143], v3, s[48:51], s6 offen
s_mov_b32 s6, 98304
buffer_load_dwordx4 a[144:147], v3, s[48:51], s6 offen
s_mov_b32 s6, 106496
buffer_load_dwordx4 a[148:151], v3, s[48:51], s6 offen
s_mov_b32 s6, 114688
buffer_load_dwordx4 a[152:155], v3, s[48:51], s6 offen
s_mov_b32 s6, 122880
buffer_load_dwordx4 a[156:159], v3, s[48:51], s6 offen
s_mov_b32 s6, 131072
buffer_load_dwordx4 a[160:163], v3, s[48:51], s6 offen
s_mov_b32 s6, 139264
buffer_load_dwordx4 a[164:167], v3, s[48:51], s6 offen
s_mov_b32 s6, 147456
buffer_load_dwordx4 a[168:171], v3, s[48:51], s6 offen
s_mov_b32 s6, 155648
buffer_load_dwordx4 a[172:175], v3, s[48:51], s6 offen
s_mov_b32 s6, 163840
buffer_load_dwordx4 a[176:179], v3, s[48:51], s6 offen
s_mov_b32 s6, 172032
buffer_load_dwordx4 a[180:183], v3, s[48:51], s6 offen
s_mov_b32 s6, 180224
buffer_load_dwordx4 a[184:187], v3, s[48:51], s6 offen
s_mov_b32 s6, 188416
buffer_load_dwordx4 a[188:191], v3, s[48:51], s6 offen
s_mov_b32 s6, 196608
buffer_load_dwordx4 a[192:195], v3, s[48:51], s6 offen
s_mov_b32 s6, 204800
buffer_load_dwordx4 a[196:199], v3, s[48:51], s6 offen
s_mov_b32 s6, 212992
buffer_load_dwordx4 a[200:203], v3, s[48:51], s6 offen
s_mov_b32 s6, 221184
buffer_load_dwordx4 a[204:207], v3, s[48:51], s6 offen
s_mov_b32 s6, 229376
buffer_load_dwordx4 a[208:211], v3, s[48:51], s6 offen
s_mov_b32 s6, 237568
buffer_load_dwordx4 a[212:215], v3, s[48:51], s6 offen
s_mov_b32 s6, 245760
buffer_load_dwordx4 a[216:219], v3, s[48:51], s6 offen
s_mov_b32 s6, 253952
buffer_load_dwordx4 a[220:223], v3, s[48:51], s6 offen
s_mov_b32 s6, 262144
buffer_load_dwordx4 a[224:227], v3, s[48:51], s6 offen
s_mov_b32 s6, 270336
buffer_load_dwordx4 a[228:231], v3, s[48:51], s6 offen
s_mov_b32 s6, 278528
buffer_load_dwordx4 a[232:235], v3, s[48:51], s6 offen
s_mov_b32 s6, 286720
buffer_load_dwordx4 a[236:239], v3, s[48:51], s6 offen
L_nowq_2:
s_waitcnt vmcnt(54)
buffer_load_dwordx4 v[216:219], v2, s[52:55], s12 offen offset:0 nt
buffer_load_dwordx4 v[220:223], v2, s[52:55], s12 offen offset:1024 nt
buffer_load_dwordx4 v[224:227], v2, s[52:55], s12 offen offset:2048 nt
buffer_load_dwordx4 v[228:231], v2, s[52:55], s12 offen offset:3072 nt
s_add_u32 s13, s13, 24576
s_min_u32 s12, s13, 2146435072
s_waitcnt vmcnt(54)
buffer_load_dwordx4 v[232:235], v2, s[52:55], s12 offen offset:0 nt
buffer_load_dwordx4 v[236:239], v2, s[52:55], s12 offen offset:1024 nt
buffer_load_dwordx4 v[240:243], v2, s[52:55], s12 offen offset:2048 nt
buffer_load_dwordx4 v[244:247], v2, s[52:55], s12 offen offset:3072 nt
s_add_u32 s13, s13, 24576
s_min_u32 s12, s13, 2146435072
s_waitcnt vmcnt(54)
s_add_u32 s34, s14, 24576
s_min_u32 s34, s34, 2146435072
buffer_load_dwordx4 a[0:3], v2, s[56:59], s34 offen offset:0 nt
buffer_load_dwordx4 a[4:7], v2, s[56:59], s34 offen offset:1024 nt
buffer_load_dwordx4 a[8:11], v2, s[56:59], s34 offen offset:2048 nt
buffer_load_dwordx4 a[12:15], v2, s[56:59], s34 offen offset:3072 nt
s_cmp_lg_u32 s8, 2
s_cbranch_scc1 L_nowq_3
s_waitcnt vmcnt(20)
s_mov_b32 s6, 0
buffer_load_dwordx4 a[96:99], v3, s[48:51], s6 offen
s_mov_b32 s6, 8192
buffer_load_dwordx4 a[100:103], v3, s[48:51], s6 offen
s_mov_b32 s6, 16384
buffer_load_dwordx4 a[104:107], v3, s[48:51], s6 offen
s_mov_b32 s6, 24576
buffer_load_dwordx4 a[108:111], v3, s[48:51], s6 offen
s_mov_b32 s6, 32768
buffer_load_dwordx4 a[112:115], v3, s[48:51], s6 offen
s_mov_b32 s6, 40960
buffer_load_dwordx4 a[116:119], v3, s[48:51], s6 offen
s_mov_b32 s6, 49152
buffer_load_dwordx4 a[120:123], v3, s[48:51], s6 offen
s_mov_b32 s6, 57344
buffer_load_dwordx4 a[124:127], v3, s[48:51], s6 offen
s_mov_b32 s6, 65536
buffer_load_dwordx4 a[128:131], v3, s[48:51], s6 offen
s_mov_b32 s6, 73728
buffer_load_dwordx4 a[132:135], v3, s[48:51], s6 offen
s_mov_b32 s6, 81920
buffer_load_dwordx4 a[136:139], v3, s[48:51], s6 offen
s_mov_b32 s6, 90112
buffer_load_dwordx4 a[140:143], v3, s[48:51], s6 offen
s_mov_b32 s6, 98304
buffer_load_dwordx4 a[144:147], v3, s[48:51], s6 offen
s_mov_b32 s6, 106496
buffer_load_dwordx4 a[148:151], v3, s[48:51], s6 offen
s_mov_b32 s6, 114688
buffer_load_dwordx4 a[152:155], v3, s[48:51], s6 offen
s_mov_b32 s6, 122880
buffer_load_dwordx4 a[156:159], v3, s[48:51], s6 offen
s_mov_b32 s6, 131072
buffer_load_dwordx4 a[160:163], v3, s[48:51], s6 offen
s_mov_b32 s6, 139264
buffer_load_dwordx4 a[164:167], v3, s[48:51], s6 offen
s_mov_b32 s6, 147456
buffer_load_dwordx4 a[168:171], v3, s[48:51], s6 offen
s_mov_b32 s6, 155648
buffer_load_dwordx4 a[172:175], v3, s[48:51], s6 offen
s_mov_b32 s6, 163840
buffer_load_dwordx4 a[176:179], v3, s[48:51], s6 offen
s_mov_b32 s6, 172032
buffer_load_dwordx4 a[180:183], v3, s[48:51], s6 offen
s_mov_b32 s6, 180224
buffer_load_dwordx4 a[184:187], v3, s[48:51], s6 offen
s_mov_b32 s6, 188416
buffer_load_dwordx4 a[188:191], v3, s[48:51], s6 offen
s_mov_b32 s6, 196608
buffer_load_dwordx4 a[192:195], v3, s[48:51], s6 offen
s_mov_b32 s6, 204800
buffer_load_dwordx4 a[196:199], v3, s[48:51], s6 offen
s_mov_b32 s6, 212992
buffer_load_dwordx4 a[200:203], v3, s[48:51], s6 offen
s_mov_b32 s6, 221184
buffer_load_dwordx4 a[204:207], v3, s[48:51], s6 offen
s_mov_b32 s6, 229376
buffer_load_dwordx4 a[208:211], v3, s[48:51], s6 offen
s_mov_b32 s6, 237568
buffer_load_dwordx4 a[212:215], v3, s[48:51], s6 offen
s_mov_b32 s6, 245760
buffer_load_dwordx4 a[216:219], v3, s[48:51], s6 offen
s_mov_b32 s6, 253952
buffer_load_dwordx4 a[220:223], v3, s[48:51], s6 offen
s_mov_b32 s6, 262144
buffer_load_dwordx4 a[224:227], v3, s[48:51], s6 offen
s_mov_b32 s6, 270336
buffer_load_dwordx4 a[228:231], v3, s[48:51], s6 offen
s_mov_b32 s6, 278528
buffer_load_dwordx4 a[232:235], v3, s[48:51], s6 offen
s_mov_b32 s6, 286720
buffer_load_dwordx4 a[236:239], v3, s[48:51], s6 offen
L_nowq_3:
s_mov_b32 s64, s42
s_mov_b32 s65, s43
s_mov_b32 s66, 6291456
s_mov_b32 s67, 0x20000
s_mov_b32 s68, s40
s_mov_b32 s69, s41
s_mov_b32 s70, 256
s_mov_b32 s71, 0x20000
s_mul_i32 s6, s4, 147456
s_add_u32 s60, s24, s6
s_addc_u32 s61, s25, 0
s_mov_b32 s62, 147456
s_mov_b32 s63, 0x20000
v_and_b32 v5, 1, v1
v_lshlrev_b32 v5, 4, v5
v_mov_b32 v6, 0xffff
v_lshlrev_b32 v5, v5, v6
v_bfe_u32 v6, v1, 1, 2
v_cmp_eq_u32 vcc, 0, v6
s_nop 1
v_cndmask_b32 v8, 0, v5, vcc
v_cmp_eq_u32 vcc, 1, v6
s_nop 1
v_cndmask_b32 v9, 0, v5, vcc
v_cmp_eq_u32 vcc, 2, v6
s_nop 1
v_cndmask_b32 v10, 0, v5, vcc
v_cmp_eq_u32 vcc, 3, v6
s_nop 1
v_cndmask_b32 v11, 0, v5, vcc
v_mov_b32 v5, 0x0c0c0c0c
s_mov_b32 s6, 0x01000100
s_mov_b32 s7, 0x03020302
v_bfi_b32 v12, v8, s6, v5
v_bfi_b32 v13, v9, s6, v5
v_bfi_b32 v14, v10, s6, v5
v_bfi_b32 v15, v11, s6, v5
v_bfi_b32 v16, v8, s7, v5
v_bfi_b32 v17, v9, s7, v5
v_bfi_b32 v18, v10, s7, v5
v_bfi_b32 v19, v11, s7, v5
v_mov_b32 v7, 0x3e0293ee
v_mov_b32 v86, 0xff800000
v_lshrrev_b32 v5, 4, v1
v_lshlrev_b32 v5, 3, v5
v_bfe_u32 v6, v1, 2, 2
v_add_u32 v5, v5, v6
v_mul_u32_u24 v5, 1152, v5
s_mul_i32 s6, s3, 288
v_add_u32 v5, s6, v5
v_and_b32 v6, 3, v1
v_lshl_add_u32 v88, v6, 5, v5
v_lshl_add_u32 v89, v6, 3, v5
v_add_u32 v89, 256, v89
v_add_u32 v90, 73728, v88
v_add_u32 v91, 73728, v89
s_lshl_b32 s82, s82, 6
s_add_u32 s82, s82, 327680
s_mov_b64 s[72:73], 0
s_cmp_ge_u32 s11, 2
s_cselect_b32 s74, 0x22222222, 0
s_mov_b32 s75, s74
s_mov_b32 s76, 0x44444444
s_mov_b32 s77, s76
s_mov_b32 s78, 0x88888888
s_mov_b32 s79, s78
v_bfe_u32 v5, v1, 4, 1
s_lshl_b32 s6, s9, 7
s_lshl_b32 s7, s4, 1
s_add_u32 s6, s6, s7
s_add_u32 s6, s6, s8
v_mul_u32_u24 v6, 63, v5
v_add_u32 v6, s6, v6
v_mul_u32_u24 v92, 2304, v6
v_add_u32 v92, 4194304, v92
v_sub_u32 v6, s8, v5
v_cmp_lt_u32 vcc, 1, v6
v_mov_b32 v6, 2146435072
s_nop 0
v_cndmask_b32 v92, v92, v6, vcc
s_mul_i32 s6, s3, 576
v_add_u32 v92, s6, v92
v_and_b32 v35, 3, v1
v_bfe_u32 v36, v1, 2, 2
v_lshl_add_u32 v35, v35, 2, v36
v_lshl_add_u32 v93, v35, 2, v92
v_and_b32 v35, 15, v1
v_lshrrev_b32 v36, 5, v1
v_lshl_add_u32 v35, v36, 4, v35
v_lshl_add_u32 v92, v35, 4, v92
s_lshl_b32 s6, s8, 2
s_add_u32 s6, s6, 0
s_cmp_ge_u32 s6, 6
s_cselect_b32 s6, 1, 0
v_cmp_eq_u32 vcc, s6, v5
s_nop 1
v_cndmask_b32 v106, 0, 1.0, vcc
s_lshl_b32 s6, s8, 2
s_add_u32 s6, s6, 1
s_cmp_ge_u32 s6, 6
s_cselect_b32 s6, 1, 0
v_cmp_eq_u32 vcc, s6, v5
s_nop 1
v_cndmask_b32 v107, 0, 1.0, vcc
s_lshl_b32 s6, s8, 2
s_add_u32 s6, s6, 2
s_cmp_ge_u32 s6, 6
s_cselect_b32 s6, 1, 0
v_cmp_eq_u32 vcc, s6, v5
s_nop 1
v_cndmask_b32 v108, 0, 1.0, vcc
s_lshl_b32 s6, s8, 2
s_add_u32 s6, s6, 3
s_cmp_ge_u32 s6, 6
s_cselect_b32 s6, 1, 0
v_cmp_eq_u32 vcc, s6, v5
s_nop 1
v_cndmask_b32 v109, 0, 1.0, vcc
v_cmp_gt_u32 vcc, 32, v1
s_nop 1
v_cndmask_b32 v98, 0, v106, vcc
v_cndmask_b32 v102, v106, 0, vcc
v_cndmask_b32 v99, 0, v107, vcc
v_cndmask_b32 v103, v107, 0, vcc
v_cndmask_b32 v100, 0, v108, vcc
v_cndmask_b32 v104, v108, 0, vcc
v_cndmask_b32 v101, 0, v109, vcc
v_cndmask_b32 v105, v109, 0, vcc
v_and_b32 v35, 15, v1
v_lshlrev_b32 v35, 4, v35
v_lshl_add_u32 v94, v5, 3, v35
s_lshl_b32 s6, s3, 8
s_add_u32 s6, s6, 151552
v_add_u32 v94, s6, v94
v_and_b32 v35, 3, v1
v_lshlrev_b32 v35, 8, v35
v_lshrrev_b32 v36, 4, v1
v_lshl_add_u32 v95, v36, 4, v35
v_add_u32 v95, 151552, v95
s_mul_i32 s15, s3, 36864
s_mov_b32 s80, 0x0
s_mov_b32 s81, 0
s_lshl_b32 s6, s4, 1
s_add_u32 s6, s6, s9
s_mul_i32 s6, s6, 4
s_add_u32 s6, s6, s8
s_lshl_b32 s6, s6, 2
s_add_u32 s6, s6, 393216
v_mov_b32 v118, 2146435072
v_mov_b32 v117, s6
v_cmp_eq_u32 vcc, 0, v0
s_nop 1
v_cndmask_b32 v118, v118, v117, vcc
v_mov_b32 v117, 3
v_and_b32 v35, 15, v1
v_lshlrev_b32 v35, 5, v35
v_lshl_add_u32 v36, v5, 4, v35
v_lshrrev_b32 v6, 5, v1
v_lshl_add_u32 v36, v6, 9, v36
s_lshl_b32 s6, s3, 10
s_add_u32 s6, s6, 147456
v_add_u32 v36, s6, v36
s_lshl_b32 s6, s83, 9
s_add_u32 s6, s6, 147456
v_add_u32 v35, s6, v35
s_waitcnt vmcnt(35)
v_perm_b32 v60, v40, v40, v12
v_perm_b32 v61, v40, v40, v13
v_perm_b32 v62, v40, v40, v14
v_perm_b32 v63, v40, v40, v15
s_nop 1
v_mfma_f32_16x16x32_bf16 v[20:23], v[60:63], a[96:99], 0
s_add_u32 s34, s14, 49152
s_min_u32 s34, s34, 2146435072
buffer_load_dwordx4 a[16:19], v2, s[56:59], s34 offen offset:0 nt
s_waitcnt vmcnt(35)
v_perm_b32 v64, v40, v40, v16
v_perm_b32 v65, v40, v40, v17
v_perm_b32 v66, v40, v40, v18
v_perm_b32 v67, v40, v40, v19
s_nop 1
v_mfma_f32_16x16x32_bf16 v[20:23], v[64:67], a[100:103], v[20:23]
buffer_load_dwordx4 a[20:23], v2, s[56:59], s34 offen offset:1024 nt
s_waitcnt vmcnt(35)
v_perm_b32 v68, v41, v41, v12
v_perm_b32 v69, v41, v41, v13
v_perm_b32 v70, v41, v41, v14
v_perm_b32 v71, v41, v41, v15
s_nop 1
v_mfma_f32_16x16x32_bf16 v[20:23], v[68:71], a[104:107], v[20:23]
buffer_load_dwordx4 a[24:27], v2, s[56:59], s34 offen offset:2048 nt
s_waitcnt vmcnt(35)
v_perm_b32 v72, v41, v41, v16
v_perm_b32 v73, v41, v41, v17
v_perm_b32 v74, v41, v41, v18
v_perm_b32 v75, v41, v41, v19
s_nop 1
v_mfma_f32_16x16x32_bf16 v[20:23], v[72:75], a[108:111], v[20:23]
buffer_load_dwordx4 a[28:31], v2, s[56:59], s34 offen offset:3072 nt
s_waitcnt vmcnt(35)
v_perm_b32 v60, v42, v42, v12
v_perm_b32 v61, v42, v42, v13
v_perm_b32 v62, v42, v42, v14
v_perm_b32 v63, v42, v42, v15
s_nop 1
v_mfma_f32_16x16x32_bf16 v[20:23], v[60:63], a[112:115], v[20:23]
s_add_u32 s34, s14, 73728
s_min_u32 s34, s34, 2146435072
buffer_load_dwordx4 a[32:35], v2, s[56:59], s34 offen offset:0 nt
s_waitcnt vmcnt(35)
v_perm_b32 v64, v42, v42, v16
v_perm_b32 v65, v42, v42, v17
v_perm_b32 v66, v42, v42, v18
v_perm_b32 v67, v42, v42, v19
s_nop 1
v_mfma_f32_16x16x32_bf16 v[20:23], v[64:67], a[116:119], v[20:23]
buffer_load_dwordx4 a[36:39], v2, s[56:59], s34 offen offset:1024 nt
s_waitcnt vmcnt(35)
v_perm_b32 v68, v43, v43, v12
v_perm_b32 v69, v43, v43, v13
v_perm_b32 v70, v43, v43, v14
v_perm_b32 v71, v43, v43, v15
s_nop 1
v_mfma_f32_16x16x32_bf16 v[20:23], v[68:71], a[120:123], v[20:23]
buffer_load_dwordx4 a[40:43], v2, s[56:59], s34 offen offset:2048 nt
s_waitcnt vmcnt(35)
v_perm_b32 v72, v43, v43, v16
v_perm_b32 v73, v43, v43, v17
v_perm_b32 v74, v43, v43, v18
v_perm_b32 v75, v43, v43, v19
s_nop 1
v_mfma_f32_16x16x32_bf16 v[20:23], v[72:75], a[124:127], v[20:23]
buffer_load_dwordx4 a[44:47], v2, s[56:59], s34 offen offset:3072 nt
s_waitcnt vmcnt(35)
v_perm_b32 v60, v44, v44, v12
v_perm_b32 v61, v44, v44, v13
v_perm_b32 v62, v44, v44, v14
v_perm_b32 v63, v44, v44, v15
s_nop 1
v_mfma_f32_16x16x32_bf16 v[20:23], v[60:63], a[128:131], v[20:23]
s_add_u32 s34, s14, 98304
s_min_u32 s34, s34, 2146435072
buffer_load_dwordx4 a[48:51], v2, s[56:59], s34 offen offset:0 nt
s_waitcnt vmcnt(35)
v_perm_b32 v64, v44, v44, v16
v_perm_b32 v65, v44, v44, v17
v_perm_b32 v66, v44, v44, v18
v_perm_b32 v67, v44, v44, v19
s_nop 1
v_mfma_f32_16x16x32_bf16 v[20:23], v[64:67], a[132:135], v[20:23]
buffer_load_dwordx4 a[52:55], v2, s[56:59], s34 offen offset:1024 nt
s_waitcnt vmcnt(35)
v_perm_b32 v68, v45, v45, v12
v_perm_b32 v69, v45, v45, v13
v_perm_b32 v70, v45, v45, v14
v_perm_b32 v71, v45, v45, v15
s_nop 1
v_mfma_f32_16x16x32_bf16 v[20:23], v[68:71], a[136:139], v[20:23]
buffer_load_dwordx4 a[56:59], v2, s[56:59], s34 offen offset:2048 nt
s_waitcnt vmcnt(35)
v_perm_b32 v72, v45, v45, v16
v_perm_b32 v73, v45, v45, v17
v_perm_b32 v74, v45, v45, v18
v_perm_b32 v75, v45, v45, v19
s_nop 1
v_mfma_f32_16x16x32_bf16 v[20:23], v[72:75], a[140:143], v[20:23]
buffer_load_dwordx4 a[60:63], v2, s[56:59], s34 offen offset:3072 nt
s_waitcnt vmcnt(35)
v_perm_b32 v60, v46, v46, v12
v_perm_b32 v61, v46, v46, v13
v_perm_b32 v62, v46, v46, v14
v_perm_b32 v63, v46, v46, v15
s_nop 1
v_mfma_f32_16x16x32_bf16 v[20:23], v[60:63], a[144:147], v[20:23]
s_add_u32 s34, s14, 122880
s_min_u32 s34, s34, 2146435072
buffer_load_dwordx4 a[64:67], v2, s[56:59], s34 offen offset:0 nt
s_waitcnt vmcnt(35)
v_perm_b32 v64, v46, v46, v16
v_perm_b32 v65, v46, v46, v17
v_perm_b32 v66, v46, v46, v18
v_perm_b32 v67, v46, v46, v19
s_nop 1
v_mfma_f32_16x16x32_bf16 v[20:23], v[64:67], a[148:151], v[20:23]
buffer_load_dwordx4 a[68:71], v2, s[56:59], s34 offen offset:1024 nt
s_waitcnt vmcnt(35)
v_perm_b32 v68, v47, v47, v12
v_perm_b32 v69, v47, v47, v13
v_perm_b32 v70, v47, v47, v14
v_perm_b32 v71, v47, v47, v15
s_nop 1
v_mfma_f32_16x16x32_bf16 v[20:23], v[68:71], a[152:155], v[20:23]
buffer_load_dwordx4 a[72:75], v2, s[56:59], s34 offen offset:2048 nt
s_waitcnt vmcnt(35)
v_perm_b32 v72, v47, v47, v16
v_perm_b32 v73, v47, v47, v17
v_perm_b32 v74, v47, v47, v18
v_perm_b32 v75, v47, v47, v19
s_nop 1
v_mfma_f32_16x16x32_bf16 v[20:23], v[72:75], a[156:159], v[20:23]
buffer_load_dwordx4 a[76:79], v2, s[56:59], s34 offen offset:3072 nt
s_waitcnt vmcnt(35)
v_perm_b32 v60, v48, v48, v12
v_perm_b32 v61, v48, v48, v13
v_perm_b32 v62, v48, v48, v14
v_perm_b32 v63, v48, v48, v15
s_nop 1
v_mfma_f32_16x16x32_bf16 v[20:23], v[60:63], a[160:163], v[20:23]
s_add_u32 s34, s14, 147456
s_min_u32 s34, s34, 2146435072
buffer_load_dwordx4 a[80:83], v2, s[56:59], s34 offen offset:0 nt
s_waitcnt vmcnt(35)
v_perm_b32 v64, v48, v48, v16
v_perm_b32 v65, v48, v48, v17
v_perm_b32 v66, v48, v48, v18
v_perm_b32 v67, v48, v48, v19
s_nop 1
v_mfma_f32_16x16x32_bf16 v[20:23], v[64:67], a[164:167], v[20:23]
buffer_load_dwordx4 a[84:87], v2, s[56:59], s34 offen offset:1024 nt
s_waitcnt vmcnt(35)
v_perm_b32 v68, v49, v49, v12
v_perm_b32 v69, v49, v49, v13
v_perm_b32 v70, v49, v49, v14
v_perm_b32 v71, v49, v49, v15
s_nop 1
v_mfma_f32_16x16x32_bf16 v[20:23], v[68:71], a[168:171], v[20:23]
buffer_load_dwordx4 a[88:91], v2, s[56:59], s34 offen offset:2048 nt
s_waitcnt vmcnt(35)
v_perm_b32 v72, v49, v49, v16
v_perm_b32 v73, v49, v49, v17
v_perm_b32 v74, v49, v49, v18
v_perm_b32 v75, v49, v49, v19
s_nop 1
v_mfma_f32_16x16x32_bf16 v[20:23], v[72:75], a[172:175], v[20:23]
buffer_load_dwordx4 a[92:95], v2, s[56:59], s34 offen offset:3072 nt
s_waitcnt vmcnt(35)
v_perm_b32 v60, v50, v50, v12
v_perm_b32 v61, v50, v50, v13
v_perm_b32 v62, v50, v50, v14
v_perm_b32 v63, v50, v50, v15
s_nop 1
v_mfma_f32_16x16x32_bf16 v[20:23], v[60:63], a[176:179], v[20:23]
s_add_u32 s34, s14, 172032
s_min_u32 s34, s34, 2146435072
buffer_load_dwordx4 a[240:243], v2, s[56:59], s34 offen offset:0 nt
s_waitcnt vmcnt(35)
v_perm_b32 v64, v50, v50, v16
v_perm_b32 v65, v50, v50, v17
v_perm_b32 v66, v50, v50, v18
v_perm_b32 v67, v50, v50, v19
s_nop 1
v_mfma_f32_16x16x32_bf16 v[20:23], v[64:67], a[180:183], v[20:23]
buffer_load_dwordx4 a[244:247], v2, s[56:59], s34 offen offset:1024 nt
s_waitcnt vmcnt(35)
v_perm_b32 v68, v51, v51, v12
v_perm_b32 v69, v51, v51, v13
v_perm_b32 v70, v51, v51, v14
v_perm_b32 v71, v51, v51, v15
s_nop 1
v_mfma_f32_16x16x32_bf16 v[20:23], v[68:71], a[184:187], v[20:23]
buffer_load_dwordx4 a[248:251], v2, s[56:59], s34 offen offset:2048 nt
s_waitcnt vmcnt(35)
v_perm_b32 v72, v51, v51, v16
v_perm_b32 v73, v51, v51, v17
v_perm_b32 v74, v51, v51, v18
v_perm_b32 v75, v51, v51, v19
s_nop 1
v_mfma_f32_16x16x32_bf16 v[20:23], v[72:75], a[188:191], v[20:23]
buffer_load_dwordx4 a[252:255], v2, s[56:59], s34 offen offset:3072 nt
s_waitcnt vmcnt(35)
v_perm_b32 v60, v52, v52, v12
v_perm_b32 v61, v52, v52, v13
v_perm_b32 v62, v52, v52, v14
v_perm_b32 v63, v52, v52, v15
s_nop 1
v_mfma_f32_16x16x32_bf16 v[20:23], v[60:63], a[192:195], v[20:23]
s_waitcnt vmcnt(34)
v_perm_b32 v64, v52, v52, v16
v_perm_b32 v65, v52, v52, v17
v_perm_b32 v66, v52, v52, v18
v_perm_b32 v67, v52, v52, v19
s_nop 1
v_mfma_f32_16x16x32_bf16 v[20:23], v[64:67], a[196:199], v[20:23]
s_waitcnt vmcnt(33)
v_perm_b32 v68, v53, v53, v12
v_perm_b32 v69, v53, v53, v13
v_perm_b32 v70, v53, v53, v14
v_perm_b32 v71, v53, v53, v15
s_nop 1
v_mfma_f32_16x16x32_bf16 v[20:23], v[68:71], a[200:203], v[20:23]
s_waitcnt vmcnt(32)
v_perm_b32 v72, v53, v53, v16
v_perm_b32 v73, v53, v53, v17
v_perm_b32 v74, v53, v53, v18
v_perm_b32 v75, v53, v53, v19
s_nop 1
v_mfma_f32_16x16x32_bf16 v[20:23], v[72:75], a[204:207], v[20:23]
s_waitcnt vmcnt(31)
v_perm_b32 v60, v54, v54, v12
v_perm_b32 v61, v54, v54, v13
v_perm_b32 v62, v54, v54, v14
v_perm_b32 v63, v54, v54, v15
s_nop 1
v_mfma_f32_16x16x32_bf16 v[20:23], v[60:63], a[208:211], v[20:23]
s_waitcnt vmcnt(30)
v_perm_b32 v64, v54, v54, v16
v_perm_b32 v65, v54, v54, v17
v_perm_b32 v66, v54, v54, v18
v_perm_b32 v67, v54, v54, v19
s_nop 1
v_mfma_f32_16x16x32_bf16 v[20:23], v[64:67], a[212:215], v[20:23]
s_waitcnt vmcnt(29)
v_perm_b32 v68, v55, v55, v12
v_perm_b32 v69, v55, v55, v13
v_perm_b32 v70, v55, v55, v14
v_perm_b32 v71, v55, v55, v15
s_nop 1
v_mfma_f32_16x16x32_bf16 v[20:23], v[68:71], a[216:219], v[20:23]
s_waitcnt vmcnt(28)
v_perm_b32 v72, v55, v55, v16
v_perm_b32 v73, v55, v55, v17
v_perm_b32 v74, v55, v55, v18
v_perm_b32 v75, v55, v55, v19
s_nop 1
v_mfma_f32_16x16x32_bf16 v[20:23], v[72:75], a[220:223], v[20:23]
s_waitcnt vmcnt(27)
v_perm_b32 v60, v56, v56, v12
v_perm_b32 v61, v56, v56, v13
v_perm_b32 v62, v56, v56, v14
v_perm_b32 v63, v56, v56, v15
s_nop 1
v_mfma_f32_16x16x32_bf16 v[20:23], v[60:63], a[224:227], v[20:23]
s_waitcnt vmcnt(26)
v_perm_b32 v64, v56, v56, v16
v_perm_b32 v65, v56, v56, v17
v_perm_b32 v66, v56, v56, v18
v_perm_b32 v67, v56, v56, v19
s_nop 1
v_mfma_f32_16x16x32_bf16 v[20:23], v[64:67], a[228:231], v[20:23]
s_waitcnt vmcnt(25)
v_perm_b32 v68, v57, v57, v12
v_perm_b32 v69, v57, v57, v13
v_perm_b32 v70, v57, v57, v14
v_perm_b32 v71, v57, v57, v15
s_nop 1
v_mfma_f32_16x16x32_bf16 v[20:23], v[68:71], a[232:235], v[20:23]
s_waitcnt vmcnt(24)
v_perm_b32 v72, v57, v57, v16
v_perm_b32 v73, v57, v57, v17
v_perm_b32 v74, v57, v57, v18
v_perm_b32 v75, v57, v57, v19
s_nop 1
v_mfma_f32_16x16x32_bf16 v[20:23], v[72:75], a[236:239], v[20:23]
s_nop 7
ds_write_b128 v36, v[20:23]
s_waitcnt lgkmcnt(0)
s_barrier
ds_read_b128 v[40:43], v35 offset:0
ds_read_b128 v[44:47], v35 offset:16
ds_read_b128 v[48:51], v35 offset:1024
ds_read_b128 v[52:55], v35 offset:1040
ds_read_b128 v[56:59], v35 offset:2048
ds_read_b128 v[60:63], v35 offset:2064
ds_read_b128 v[64:67], v35 offset:3072
ds_read_b128 v[68:71], v35 offset:3088
v_mov_b32 v20, 0
v_mov_b32 v21, 0
v_mov_b32 v22, 0
v_mov_b32 v23, 0
s_waitcnt lgkmcnt(0)
v_add_f32 v40, v40, v48
v_add_f32 v56, v56, v64
v_add_f32 v41, v41, v49
v_add_f32 v57, v57, v65
v_add_f32 v42, v42, v50
v_add_f32 v58, v58, v66
v_add_f32 v43, v43, v51
v_add_f32 v59, v59, v67
v_add_f32 v44, v44, v52
v_add_f32 v60, v60, v68
v_add_f32 v45, v45, v53
v_add_f32 v61, v61, v69
v_add_f32 v46, v46, v54
v_add_f32 v62, v62, v70
v_add_f32 v47, v47, v55
v_add_f32 v63, v63, v71
v_add_f32 v40, v40, v56
v_add_f32 v41, v41, v57
v_add_f32 v42, v42, v58
v_add_f32 v43, v43, v59
v_add_f32 v44, v44, v60
v_add_f32 v45, v45, v61
v_add_f32 v46, v46, v62
v_add_f32 v47, v47, v63
v_cvt_pk_bf16_f32 v24, v40, v41
v_cvt_pk_bf16_f32 v25, v42, v43
v_cvt_pk_bf16_f32 v26, v44, v45
v_cvt_pk_bf16_f32 v27, v46, v47
s_add_u32 s14, s14, 196608
K_loop:
s_cmp_lg_u32 s81, 8
s_cbranch_scc1 L_c0_4
buffer_load_dword v96, off, s[68:71], 0 offset:0 sc1
L_c0_4:
s_waitcnt vmcnt(28)
v_dot2_f32_bf16 v28, v120, v24, 0
v_dot2_f32_bf16 v29, v124, v24, 0
v_dot2_f32_bf16 v30, v128, v24, 0
v_dot2_f32_bf16 v31, v132, v24, 0
v_dot2_f32_bf16 v28, v121, v25, v28
v_dot2_f32_bf16 v29, v125, v25, v29
v_dot2_f32_bf16 v30, v129, v25, v30
v_dot2_f32_bf16 v31, v133, v25, v31
v_dot2_f32_bf16 v28, v122, v26, v28
v_dot2_f32_bf16 v29, v126, v26, v29
v_dot2_f32_bf16 v30, v130, v26, v30
v_dot2_f32_bf16 v31, v134, v26, v31
v_dot2_f32_bf16 v28, v123, v27, v28
v_dot2_f32_bf16 v29, v127, v27, v29
v_dot2_f32_bf16 v30, v131, v27, v30
v_dot2_f32_bf16 v31, v135, v27, v31
buffer_load_dwordx4 v[120:123], v2, s[52:55], s12 offen offset:0 nt
buffer_load_dwordx4 v[124:127], v2, s[52:55], s12 offen offset:1024 nt
buffer_load_dwordx4 v[128:131], v2, s[52:55], s12 offen offset:2048 nt
buffer_load_dwordx4 v[132:135], v2, s[52:55], s12 offen offset:3072 nt
s_add_u32 s13, s13, 24576
s_min_u32 s12, s13, 2146435072
s_cmp_ge_u32 s80, 36
s_cbranch_scc1 L_nodma_5
s_mov_b32 m0, s15
s_nop 0
buffer_load_dwordx4 v2, s[60:63], s15 offen  lds
s_add_u32 s15, s15, 1024
L_nodma_5:
s_add_u32 s80, s80, 1
v_add_f32_dpp v32, v28, v28 row_ror:8 row_mask:0xf bank_mask:0x3
v_add_f32_dpp v33, v29, v29 row_ror:8 row_mask:0xf bank_mask:0x3
v_add_f32_dpp v32, v30, v30 row_ror:8 row_mask:0xf bank_mask:0xc
v_add_f32_dpp v33, v31, v31 row_ror:8 row_mask:0xf bank_mask:0xc
s_nop 0
v_add_f32_dpp v34, v32, v32 row_half_mirror row_mask:0xf bank_mask:0x5
v_add_f32_dpp v34, v33, v33 row_half_mirror row_mask:0xf bank_mask:0xa
s_nop 1
v_add_f32_dpp v34, v34, v34 quad_perm:[1,0,3,2] row_mask:0xf bank_mask:0xf
s_nop 1
v_add_f32_dpp v34, v34, v34 quad_perm:[2,3,0,1] row_mask:0xf bank_mask:0xf
v_cndmask_b32 v86, v86, v34, s[72:73]
s_waitcnt vmcnt(28)
v_dot2_f32_bf16 v28, v136, v24, 0
v_dot2_f32_bf16 v29, v140, v24, 0
v_dot2_f32_bf16 v30, v144, v24, 0
v_dot2_f32_bf16 v31, v148, v24, 0
v_dot2_f32_bf16 v28, v137, v25, v28
v_dot2_f32_bf16 v29, v141, v25, v29
v_dot2_f32_bf16 v30, v145, v25, v30
v_dot2_f32_bf16 v31, v149, v25, v31
v_dot2_f32_bf16 v28, v138, v26, v28
v_dot2_f32_bf16 v29, v142, v26, v29
v_dot2_f32_bf16 v30, v146, v26, v30
v_dot2_f32_bf16 v31, v150, v26, v31
v_dot2_f32_bf16 v28, v139, v27, v28
v_dot2_f32_bf16 v29, v143, v27, v29
v_dot2_f32_bf16 v30, v147, v27, v30
v_dot2_f32_bf16 v31, v151, v27, v31
buffer_load_dwordx4 v[136:139], v2, s[52:55], s12 offen offset:0 nt
buffer_load_dwordx4 v[140:143], v2, s[52:55], s12 offen offset:1024 nt
buffer_load_dwordx4 v[144:147], v2, s[52:55], s12 offen offset:2048 nt
buffer_load_dwordx4 v[148:151], v2, s[52:55], s12 offen offset:3072 nt
s_add_u32 s13, s13, 24576
s_min_u32 s12, s13, 2146435072
s_cmp_ge_u32 s80, 36
s_cbranch_scc1 L_nodma_6
s_mov_b32 m0, s15
s_nop 0
buffer_load_dwordx4 v2, s[60:63], s15 offen  lds
s_add_u32 s15, s15, 1024
L_nodma_6:
s_add_u32 s80, s80, 1
v_add_f32_dpp v32, v28, v28 row_ror:8 row_mask:0xf bank_mask:0x3
v_add_f32_dpp v33, v29, v29 row_ror:8 row_mask:0xf bank_mask:0x3
v_add_f32_dpp v32, v30, v30 row_ror:8 row_mask:0xf bank_mask:0xc
v_add_f32_dpp v33, v31, v31 row_ror:8 row_mask:0xf bank_mask:0xc
s_nop 0
v_add_f32_dpp v34, v32, v32 row_half_mirror row_mask:0xf bank_mask:0x5
v_add_f32_dpp v34, v33, v33 row_half_mirror row_mask:0xf bank_mask:0xa
s_nop 1
v_add_f32_dpp v34, v34, v34 quad_perm:[1,0,3,2] row_mask:0xf bank_mask:0xf
s_nop 1
v_add_f32_dpp v34, v34, v34 quad_perm:[2,3,0,1] row_mask:0xf bank_mask:0xf
v_cndmask_b32 v86, v86, v34, s[74:75]
s_waitcnt vmcnt(28)
v_dot2_f32_bf16 v28, v152, v24, 0
v_dot2_f32_bf16 v29, v156, v24, 0
v_dot2_f32_bf16 v30, v160, v24, 0
v_dot2_f32_bf16 v31, v164, v24, 0
v_dot2_f32_bf16 v28, v153, v25, v28
v_dot2_f32_bf16 v29, v157, v25, v29
v_dot2_f32_bf16 v30, v161, v25, v30
v_dot2_f32_bf16 v31, v165, v25, v31
v_dot2_f32_bf16 v28, v154, v26, v28
v_dot2_f32_bf16 v29, v158, v26, v29
v_dot2_f32_bf16 v30, v162, v26, v30
v_dot2_f32_bf16 v31, v166, v26, v31
v_dot2_f32_bf16 v28, v155, v27, v28
v_dot2_f32_bf16 v29, v159, v27, v29
v_dot2_f32_bf16 v30, v163, v27, v30
v_dot2_f32_bf16 v31, v167, v27, v31
buffer_load_dwordx4 v[152:155], v2, s[52:55], s12 offen offset:0 nt
buffer_load_dwordx4 v[156:159], v2, s[52:55], s12 offen offset:1024 nt
buffer_load_dwordx4 v[160:163], v2, s[52:55], s12 offen offset:2048 nt
buffer_load_dwordx4 v[164:167], v2, s[52:55], s12 offen offset:3072 nt
s_add_u32 s13, s13, 24576
s_min_u32 s12, s13, 2146435072
s_cmp_ge_u32 s80, 36
s_cbranch_scc1 L_nodma_7
s_mov_b32 m0, s15
s_nop 0
buffer_load_dwordx4 v2, s[60:63], s15 offen  lds
s_add_u32 s15, s15, 1024
L_nodma_7:
s_add_u32 s80, s80, 1
v_add_f32_dpp v32, v28, v28 row_ror:8 row_mask:0xf bank_mask:0x3
v_add_f32_dpp v33, v29, v29 row_ror:8 row_mask:0xf bank_mask:0x3
v_add_f32_dpp v32, v30, v30 row_ror:8 row_mask:0xf bank_mask:0xc
v_add_f32_dpp v33, v31, v31 row_ror:8 row_mask:0xf bank_mask:0xc
s_nop 0
v_add_f32_dpp v34, v32, v32 row_half_mirror row_mask:0xf bank_mask:0x5
v_add_f32_dpp v34, v33, v33 row_half_mirror row_mask:0xf bank_mask:0xa
s_nop 1
v_add_f32_dpp v34, v34, v34 quad_perm:[1,0,3,2] row_mask:0xf bank_mask:0xf
s_nop 1
v_add_f32_dpp v34, v34, v34 quad_perm:[2,3,0,1] row_mask:0xf bank_mask:0xf
v_cndmask_b32 v86, v86, v34, s[76:77]
s_waitcnt vmcnt(28)
v_dot2_f32_bf16 v28, v168, v24, 0
v_dot2_f32_bf16 v29, v172, v24, 0
v_dot2_f32_bf16 v30, v176, v24, 0
v_dot2_f32_bf16 v31, v180, v24, 0
v_dot2_f32_bf16 v28, v169, v25, v28
v_dot2_f32_bf16 v29, v173, v25, v29
v_dot2_f32_bf16 v30, v177, v25, v30
v_dot2_f32_bf16 v31, v181, v25, v31
v_dot2_f32_bf16 v28, v170, v26, v28
v_dot2_f32_bf16 v29, v174, v26, v29
v_dot2_f32_bf16 v30, v178, v26, v30
v_dot2_f32_bf16 v31, v182, v26, v31
v_dot2_f32_bf16 v28, v171, v27, v28
v_dot2_f32_bf16 v29, v175, v27, v29
v_dot2_f32_bf16 v30, v179, v27, v30
v_dot2_f32_bf16 v31, v183, v27, v31
buffer_load_dwordx4 v[168:171], v2, s[52:55], s12 offen offset:0 nt
buffer_load_dwordx4 v[172:175], v2, s[52:55], s12 offen offset:1024 nt
buffer_load_dwordx4 v[176:179], v2, s[52:55], s12 offen offset:2048 nt
buffer_load_dwordx4 v[180:183], v2, s[52:55], s12 offen offset:3072 nt
s_add_u32 s13, s13, 24576
s_min_u32 s12, s13, 2146435072
s_cmp_ge_u32 s80, 36
s_cbranch_scc1 L_nodma_8
s_mov_b32 m0, s15
s_nop 0
buffer_load_dwordx4 v2, s[60:63], s15 offen  lds
s_add_u32 s15, s15, 1024
L_nodma_8:
s_add_u32 s80, s80, 1
v_add_f32_dpp v32, v28, v28 row_ror:8 row_mask:0xf bank_mask:0x3
v_add_f32_dpp v33, v29, v29 row_ror:8 row_mask:0xf bank_mask:0x3
v_add_f32_dpp v32, v30, v30 row_ror:8 row_mask:0xf bank_mask:0xc
v_add_f32_dpp v33, v31, v31 row_ror:8 row_mask:0xf bank_mask:0xc
s_nop 0
v_add_f32_dpp v34, v32, v32 row_half_mirror row_mask:0xf bank_mask:0x5
v_add_f32_dpp v34, v33, v33 row_half_mirror row_mask:0xf bank_mask:0xa
s_nop 1
v_add_f32_dpp v34, v34, v34 quad_perm:[1,0,3,2] row_mask:0xf bank_mask:0xf
s_nop 1
v_add_f32_dpp v34, v34, v34 quad_perm:[2,3,0,1] row_mask:0xf bank_mask:0xf
v_cndmask_b32 v86, v86, v34, s[78:79]
s_add_u32 s81, s81, 1
s_cmp_eq_u32 s81, 11
s_cbranch_scc1 A_mid
v_mov_b32 v76, v77
v_mov_b32 v77, v78
v_mov_b32 v78, v79
v_mov_b32 v79, v80
v_mov_b32 v80, v81
v_mov_b32 v81, v82
v_mov_b32 v82, v83
v_mov_b32 v83, v84
v_mov_b32 v84, v85
v_mov_b32 v85, v86
s_lshr_b64 s[72:73], s[76:77], 2
s_lshr_b64 s[74:75], s[76:77], 1
s_cmp_eq_u32 s81, 9
s_cselect_b32 s52, s56, s52
s_cselect_b32 s53, s57, s53
s_cselect_b32 s13, s14, s13
s_min_u32 s12, s13, 2146435072
s_waitcnt vmcnt(28)
v_dot2_f32_bf16 v28, v184, v24, 0
v_dot2_f32_bf16 v29, v188, v24, 0
v_dot2_f32_bf16 v30, v192, v24, 0
v_dot2_f32_bf16 v31, v196, v24, 0
v_dot2_f32_bf16 v28, v185, v25, v28
v_dot2_f32_bf16 v29, v189, v25, v29
v_dot2_f32_bf16 v30, v193, v25, v30
v_dot2_f32_bf16 v31, v197, v25, v31
v_dot2_f32_bf16 v28, v186, v26, v28
v_dot2_f32_bf16 v29, v190, v26, v29
v_dot2_f32_bf16 v30, v194, v26, v30
v_dot2_f32_bf16 v31, v198, v26, v31
v_dot2_f32_bf16 v28, v187, v27, v28
v_dot2_f32_bf16 v29, v191, v27, v29
v_dot2_f32_bf16 v30, v195, v27, v30
v_dot2_f32_bf16 v31, v199, v27, v31
buffer_load_dwordx4 v[184:187], v2, s[52:55], s12 offen offset:0 nt
buffer_load_dwordx4 v[188:191], v2, s[52:55], s12 offen offset:1024 nt
buffer_load_dwordx4 v[192:195], v2, s[52:55], s12 offen offset:2048 nt
buffer_load_dwordx4 v[196:199], v2, s[52:55], s12 offen offset:3072 nt
s_add_u32 s13, s13, 24576
s_min_u32 s12, s13, 2146435072
s_cmp_ge_u32 s80, 36
s_cbranch_scc1 L_nodma_9
s_mov_b32 m0, s15
s_nop 0
buffer_load_dwordx4 v2, s[60:63], s15 offen  lds
s_add_u32 s15, s15, 1024
L_nodma_9:
s_add_u32 s80, s80, 1
v_add_f32_dpp v32, v28, v28 row_ror:8 row_mask:0xf bank_mask:0x3
v_add_f32_dpp v33, v29, v29 row_ror:8 row_mask:0xf bank_mask:0x3
v_add_f32_dpp v32, v30, v30 row_ror:8 row_mask:0xf bank_mask:0xc
v_add_f32_dpp v33, v31, v31 row_ror:8 row_mask:0xf bank_mask:0xc
s_nop 0
v_add_f32_dpp v34, v32, v32 row_half_mirror row_mask:0xf bank_mask:0x5
v_add_f32_dpp v34, v33, v33 row_half_mirror row_mask:0xf bank_mask:0xa
s_nop 1
v_add_f32_dpp v34, v34, v34 quad_perm:[1,0,3,2] row_mask:0xf bank_mask:0xf
s_nop 1
v_add_f32_dpp v34, v34, v34 quad_perm:[2,3,0,1] row_mask:0xf bank_mask:0xf
v_cndmask_b32 v86, v86, v34, s[72:73]
s_waitcnt vmcnt(28)
v_dot2_f32_bf16 v28, v200, v24, 0
v_dot2_f32_bf16 v29, v204, v24, 0
v_dot2_f32_bf16 v30, v208, v24, 0
v_dot2_f32_bf16 v31, v212, v24, 0
v_dot2_f32_bf16 v28, v201, v25, v28
v_dot2_f32_bf16 v29, v205, v25, v29
v_dot2_f32_bf16 v30, v209, v25, v30
v_dot2_f32_bf16 v31, v213, v25, v31
v_dot2_f32_bf16 v28, v202, v26, v28
v_dot2_f32_bf16 v29, v206, v26, v29
v_dot2_f32_bf16 v30, v210, v26, v30
v_dot2_f32_bf16 v31, v214, v26, v31
v_dot2_f32_bf16 v28, v203, v27, v28
v_dot2_f32_bf16 v29, v207, v27, v29
v_dot2_f32_bf16 v30, v211, v27, v30
v_dot2_f32_bf16 v31, v215, v27, v31
buffer_load_dwordx4 v[200:203], v2, s[52:55], s12 offen offset:0 nt
buffer_load_dwordx4 v[204:207], v2, s[52:55], s12 offen offset:1024 nt
buffer_load_dwordx4 v[208:211], v2, s[52:55], s12 offen offset:2048 nt
buffer_load_dwordx4 v[212:215], v2, s[52:55], s12 offen offset:3072 nt
s_add_u32 s13, s13, 24576
s_min_u32 s12, s13, 2146435072
s_cmp_ge_u32 s80, 36
s_cbranch_scc1 L_nodma_10
s_mov_b32 m0, s15
s_nop 0
buffer_load_dwordx4 v2, s[60:63], s15 offen  lds
s_add_u32 s15, s15, 1024
L_nodma_10:
s_add_u32 s80, s80, 1
v_add_f32_dpp v32, v28, v28 row_ror:8 row_mask:0xf bank_mask:0x3
v_add_f32_dpp v33, v29, v29 row_ror:8 row_mask:0xf bank_mask:0x3
v_add_f32_dpp v32, v30, v30 row_ror:8 row_mask:0xf bank_mask:0xc
v_add_f32_dpp v33, v31, v31 row_ror:8 row_mask:0xf bank_mask:0xc
s_nop 0
v_add_f32_dpp v34, v32, v32 row_half_mirror row_mask:0xf bank_mask:0x5
v_add_f32_dpp v34, v33, v33 row_half_mirror row_mask:0xf bank_mask:0xa
s_nop 1
v_add_f32_dpp v34, v34, v34 quad_perm:[1,0,3,2] row_mask:0xf bank_mask:0xf
s_nop 1
v_add_f32_dpp v34, v34, v34 quad_perm:[2,3,0,1] row_mask:0xf bank_mask:0xf
v_cndmask_b32 v86, v86, v34, s[74:75]
s_waitcnt vmcnt(28)
v_dot2_f32_bf16 v28, v216, v24, 0
v_dot2_f32_bf16 v29, v220, v24, 0
v_dot2_f32_bf16 v30, v224, v24, 0
v_dot2_f32_bf16 v31, v228, v24, 0
v_dot2_f32_bf16 v28, v217, v25, v28
v_dot2_f32_bf16 v29, v221, v25, v29
v_dot2_f32_bf16 v30, v225, v25, v30
v_dot2_f32_bf16 v31, v229, v25, v31
v_dot2_f32_bf16 v28, v218, v26, v28
v_dot2_f32_bf16 v29, v222, v26, v29
v_dot2_f32_bf16 v30, v226, v26, v30
v_dot2_f32_bf16 v31, v230, v26, v31
v_dot2_f32_bf16 v28, v219, v27, v28
v_dot2_f32_bf16 v29, v223, v27, v29
v_dot2_f32_bf16 v30, v227, v27, v30
v_dot2_f32_bf16 v31, v231, v27, v31
buffer_load_dwordx4 v[216:219], v2, s[52:55], s12 offen offset:0 nt
buffer_load_dwordx4 v[220:223], v2, s[52:55], s12 offen offset:1024 nt
buffer_load_dwordx4 v[224:227], v2, s[52:55], s12 offen offset:2048 nt
buffer_load_dwordx4 v[228:231], v2, s[52:55], s12 offen offset:3072 nt
s_add_u32 s13, s13, 24576
s_min_u32 s12, s13, 2146435072
s_cmp_ge_u32 s80, 36
s_cbranch_scc1 L_nodma_11
s_mov_b32 m0, s15
s_nop 0
buffer_load_dwordx4 v2, s[60:63], s15 offen  lds
s_add_u32 s15, s15, 1024
L_nodma_11:
s_add_u32 s80, s80, 1
v_add_f32_dpp v32, v28, v28 row_ror:8 row_mask:0xf bank_mask:0x3
v_add_f32_dpp v33, v29, v29 row_ror:8 row_mask:0xf bank_mask:0x3
v_add_f32_dpp v32, v30, v30 row_ror:8 row_mask:0xf bank_mask:0xc
v_add_f32_dpp v33, v31, v31 row_ror:8 row_mask:0xf bank_mask:0xc
s_nop 0
v_add_f32_dpp v34, v32, v32 row_half_mirror row_mask:0xf bank_mask:0x5
v_add_f32_dpp v34, v33, v33 row_half_mirror row_mask:0xf bank_mask:0xa
s_nop 1
v_add_f32_dpp v34, v34, v34 quad_perm:[1,0,3,2] row_mask:0xf bank_mask:0xf
s_nop 1
v_add_f32_dpp v34, v34, v34 quad_perm:[2,3,0,1] row_mask:0xf bank_mask:0xf
v_cndmask_b32 v86, v86, v34, s[76:77]
s_waitcnt vmcnt(28)
v_dot2_f32_bf16 v28, v232, v24, 0
v_dot2_f32_bf16 v29, v236, v24, 0
v_dot2_f32_bf16 v30, v240, v24, 0
v_dot2_f32_bf16 v31, v244, v24, 0
v_dot2_f32_bf16 v28, v233, v25, v28
v_dot2_f32_bf16 v29, v237, v25, v29
v_dot2_f32_bf16 v30, v241, v25, v30
v_dot2_f32_bf16 v31, v245, v25, v31
v_dot2_f32_bf16 v28, v234, v26, v28
v_dot2_f32_bf16 v29, v238, v26, v29
v_dot2_f32_bf16 v30, v242, v26, v30
v_dot2_f32_bf16 v31, v246, v26, v31
v_dot2_f32_bf16 v28, v235, v27, v28
v_dot2_f32_bf16 v29, v239, v27, v29
v_dot2_f32_bf16 v30, v243, v27, v30
v_dot2_f32_bf16 v31, v247, v27, v31
buffer_load_dwordx4 v[232:235], v2, s[52:55], s12 offen offset:0 nt
buffer_load_dwordx4 v[236:239], v2, s[52:55], s12 offen offset:1024 nt
buffer_load_dwordx4 v[240:243], v2, s[52:55], s12 offen offset:2048 nt
buffer_load_dwordx4 v[244:247], v2, s[52:55], s12 offen offset:3072 nt
s_add_u32 s13, s13, 24576
s_min_u32 s12, s13, 2146435072
s_cmp_ge_u32 s80, 36
s_cbranch_scc1 L_nodma_12
s_mov_b32 m0, s15
s_nop 0
buffer_load_dwordx4 v2, s[60:63], s15 offen  lds
s_add_u32 s15, s15, 1024
L_nodma_12:
s_add_u32 s80, s80, 1
v_add_f32_dpp v32, v28, v28 row_ror:8 row_mask:0xf bank_mask:0x3
v_add_f32_dpp v33, v29, v29 row_ror:8 row_mask:0xf bank_mask:0x3
v_add_f32_dpp v32, v30, v30 row_ror:8 row_mask:0xf bank_mask:0xc
v_add_f32_dpp v33, v31, v31 row_ror:8 row_mask:0xf bank_mask:0xc
s_nop 0
v_add_f32_dpp v34, v32, v32 row_half_mirror row_mask:0xf bank_mask:0x5
v_add_f32_dpp v34, v33, v33 row_half_mirror row_mask:0xf bank_mask:0xa
s_nop 1
v_add_f32_dpp v34, v34, v34 quad_perm:[1,0,3,2] row_mask:0xf bank_mask:0xf
s_nop 1
v_add_f32_dpp v34, v34, v34 quad_perm:[2,3,0,1] row_mask:0xf bank_mask:0xf
v_cndmask_b32 v86, v86, v34, s[78:79]
s_add_u32 s81, s81, 1
v_mov_b32 v76, v77
v_mov_b32 v77, v78
v_mov_b32 v78, v79
v_mov_b32 v79, v80
v_mov_b32 v80, v81
v_mov_b32 v81, v82
v_mov_b32 v82, v83
v_mov_b32 v83, v84
v_mov_b32 v84, v85
v_mov_b32 v85, v86
s_branch K_loop
A_mid:
v_max3_f32 v35, v76, v77, v78
v_max3_f32 v35, v35, v79, v80
v_max3_f32 v35, v35, v81, v82
v_max3_f32 v35, v35, v83, v84
v_max3_f32 v35, v35, v85, v86
s_nop 1
v_max_f32_dpp v35, v35, v35 row_ror:8 row_mask:0xf bank_mask:0xf
s_nop 1
v_max_f32_dpp v35, v35, v35 row_ror:4 row_mask:0xf bank_mask:0xf
s_nop 1
v_max_f32_dpp v35, v35, v35 row_ror:2 row_mask:0xf bank_mask:0xf
s_nop 1
v_max_f32_dpp v35, v35, v35 row_ror:1 row_mask:0xf bank_mask:0xf
v_mov_b32 v36, v35
s_nop 1
v_permlane16_swap_b32 v35, v36
v_max_f32 v35, v35, v36
v_mov_b32 v36, v35
s_nop 1
v_permlane32_swap_b32 v35, v36
v_max_f32 v35, v35, v36
v_mul_f32 v32, v35, v7
v_fma_f32 v76, v76, v7, -v32
v_fma_f32 v77, v77, v7, -v32
v_fma_f32 v78, v78, v7, -v32
v_fma_f32 v79, v79, v7, -v32
v_fma_f32 v80, v80, v7, -v32
v_fma_f32 v81, v81, v7, -v32
v_fma_f32 v82, v82, v7, -v32
v_fma_f32 v83, v83, v7, -v32
v_fma_f32 v84, v84, v7, -v32
v_fma_f32 v85, v85, v7, -v32
v_fma_f32 v86, v86, v7, -v32
v_exp_f32 v76, v76
v_exp_f32 v77, v77
v_exp_f32 v78, v78
v_exp_f32 v79, v79
v_exp_f32 v80, v80
v_exp_f32 v81, v81
v_exp_f32 v82, v82
v_exp_f32 v83, v83
v_exp_f32 v84, v84
v_exp_f32 v85, v85
v_exp_f32 v86, v86
v_add_f32 v35, v76, v77
v_add_f32 v35, v35, v78
v_add_f32 v35, v35, v79
v_add_f32 v35, v35, v80
v_add_f32 v35, v35, v81
v_add_f32 v35, v35, v82
v_add_f32 v35, v35, v83
v_add_f32 v35, v35, v84
v_add_f32 v35, v35, v85
v_add_f32 v35, v35, v86
v_cvt_pk_bf16_f32 v76, v76, v76
v_cvt_pk_bf16_f32 v77, v77, v77
v_cvt_pk_bf16_f32 v78, v78, v78
v_cvt_pk_bf16_f32 v79, v79, v79
v_cvt_pk_bf16_f32 v80, v80, v80
v_cvt_pk_bf16_f32 v81, v81, v81
v_cvt_pk_bf16_f32 v82, v82, v82
v_cvt_pk_bf16_f32 v83, v83, v83
v_cvt_pk_bf16_f32 v84, v84, v84
v_cvt_pk_bf16_f32 v85, v85, v85
v_cvt_pk_bf16_f32 v86, v86, v86
v_add_f32_dpp v35, v35, v35 row_ror:8 row_mask:0xf bank_mask:0xf
s_nop 1
v_add_f32_dpp v35, v35, v35 row_ror:4 row_mask:0xf bank_mask:0xf
s_nop 1
v_add_f32_dpp v35, v35, v35 row_ror:2 row_mask:0xf bank_mask:0xf
s_nop 1
v_add_f32_dpp v35, v35, v35 row_ror:1 row_mask:0xf bank_mask:0xf
v_mov_b32 v36, v35
s_nop 1
v_permlane16_swap_b32 v35, v36
v_add_f32 v35, v35, v36
v_mov_b32 v36, v35
s_nop 1
v_permlane32_swap_b32 v35, v36
v_add_f32 v35, v35, v36
v_min_u32 v32, -2, v32
v_min_u32 v33, -2, v35
s_mov_b32 s7, 400000
L_ens_13:
v_readfirstlane_b32 s6, v96
s_cmp_ge_u32 s6, 128
s_cbranch_scc1 L_ensd_14
s_sleep 16
buffer_load_dword v96, off, s[68:71], 0 offset:0 sc1
s_waitcnt vmcnt(0)
s_sub_u32 s7, s7, 1
s_cmp_lg_u32 s7, 0
s_cbranch_scc1 L_ens_13
L_ensd_14:
s_lshl_b32 s6, s11, 3
s_add_u32 s6, s6, s82
s_mov_b64 exec, 1
buffer_store_dwordx2 v[32:33], off, s[64:67], s6 sc1
s_mov_b64 exec, -1
v_and_b32_dpp v60, v78, v8 row_newbcast:0 row_mask:0xf bank_mask:0xf
v_and_b32_dpp v61, v78, v9 row_newbcast:0 row_mask:0xf bank_mask:0xf
v_and_b32_dpp v62, v78, v10 row_newbcast:0 row_mask:0xf bank_mask:0xf
v_and_b32_dpp v63, v78, v11 row_newbcast:0 row_mask:0xf bank_mask:0xf
v_and_b32_dpp v64, v78, v8 row_newbcast:4 row_mask:0xf bank_mask:0xf
v_and_b32_dpp v65, v78, v9 row_newbcast:4 row_mask:0xf bank_mask:0xf
v_and_b32_dpp v66, v78, v10 row_newbcast:4 row_mask:0xf bank_mask:0xf
v_and_b32_dpp v67, v78, v11 row_newbcast:4 row_mask:0xf bank_mask:0xf
v_and_b32_dpp v68, v78, v8 row_newbcast:8 row_mask:0xf bank_mask:0xf
v_and_b32_dpp v69, v78, v9 row_newbcast:8 row_mask:0xf bank_mask:0xf
v_and_b32_dpp v70, v78, v10 row_newbcast:8 row_mask:0xf bank_mask:0xf
v_and_b32_dpp v71, v78, v11 row_newbcast:8 row_mask:0xf bank_mask:0xf
v_and_b32_dpp v72, v78, v8 row_newbcast:12 row_mask:0xf bank_mask:0xf
v_and_b32_dpp v73, v78, v9 row_newbcast:12 row_mask:0xf bank_mask:0xf
v_and_b32_dpp v74, v78, v10 row_newbcast:12 row_mask:0xf bank_mask:0xf
v_and_b32_dpp v75, v78, v11 row_newbcast:12 row_mask:0xf bank_mask:0xf
s_waitcnt vmcnt(29)
v_mfma_f32_16x16x32_bf16 v[20:23], v[60:63], v[184:187], v[20:23]
v_mfma_f32_16x16x32_bf16 v[20:23], v[64:67], v[188:191], v[20:23]
v_mfma_f32_16x16x32_bf16 v[20:23], v[68:71], v[192:195], v[20:23]
v_mfma_f32_16x16x32_bf16 v[20:23], v[72:75], v[196:199], v[20:23]
v_add_u32 v117, 1, v117
buffer_store_dword v117, v118, s[64:67], 0 offen
buffer_load_dwordx4 v[184:187], v2, s[52:55], s12 offen offset:0 nt
buffer_load_dwordx4 v[188:191], v2, s[52:55], s12 offen offset:1024 nt
buffer_load_dwordx4 v[192:195], v2, s[52:55], s12 offen offset:2048 nt
buffer_load_dwordx4 v[196:199], v2, s[52:55], s12 offen offset:3072 nt
s_add_u32 s13, s13, 24576
s_min_u32 s12, s13, 2146435072
v_and_b32_dpp v60, v78, v8 row_newbcast:1 row_mask:0xf bank_mask:0xf
v_and_b32_dpp v61, v78, v9 row_newbcast:1 row_mask:0xf bank_mask:0xf
v_and_b32_dpp v62, v78, v10 row_newbcast:1 row_mask:0xf bank_mask:0xf
v_and_b32_dpp v63, v78, v11 row_newbcast:1 row_mask:0xf bank_mask:0xf
v_and_b32_dpp v64, v78, v8 row_newbcast:5 row_mask:0xf bank_mask:0xf
v_and_b32_dpp v65, v78, v9 row_newbcast:5 row_mask:0xf bank_mask:0xf
v_and_b32_dpp v66, v78, v10 row_newbcast:5 row_mask:0xf bank_mask:0xf
v_and_b32_dpp v67, v78, v11 row_newbcast:5 row_mask:0xf bank_mask:0xf
v_and_b32_dpp v68, v78, v8 row_newbcast:9 row_mask:0xf bank_mask:0xf
v_and_b32_dpp v69, v78, v9 row_newbcast:9 row_mask:0xf bank_mask:0xf
v_and_b32_dpp v70, v78, v10 row_newbcast:9 row_mask:0xf bank_mask:0xf
v_and_b32_dpp v71, v78, v11 row_newbcast:9 row_mask:0xf bank_mask:0xf
v_and_b32_dpp v72, v78, v8 row_newbcast:13 row_mask:0xf bank_mask:0xf
v_and_b32_dpp v73, v78, v9 row_newbcast:13 row_mask:0xf bank_mask:0xf
v_and_b32_dpp v74, v78, v10 row_newbcast:13 row_mask:0xf bank_mask:0xf
v_and_b32_dpp v75, v78, v11 row_newbcast:13 row_mask:0xf bank_mask:0xf
s_waitcnt vmcnt(30)
v_mfma_f32_16x16x32_bf16 v[20:23], v[60:63], v[200:203], v[20:23]
v_mfma_f32_16x16x32_bf16 v[20:23], v[64:67], v[204:207], v[20:23]
v_mfma_f32_16x16x32_bf16 v[20:23], v[68:71], v[208:211], v[20:23]
v_mfma_f32_16x16x32_bf16 v[20:23], v[72:75], v[212:215], v[20:23]
v_add_u32 v117, 1, v117
buffer_store_dword v117, v118, s[64:67], 0 offen
buffer_load_dwordx4 v[200:203], v2, s[52:55], s12 offen offset:0 nt
buffer_load_dwordx4 v[204:207], v2, s[52:55], s12 offen offset:1024 nt
buffer_load_dwordx4 v[208:211], v2, s[52:55], s12 offen offset:2048 nt
buffer_load_dwordx4 v[212:215], v2, s[52:55], s12 offen offset:3072 nt
s_add_u32 s13, s13, 24576
s_min_u32 s12, s13, 2146435072
v_and_b32_dpp v60, v76, v8 row_newbcast:1 row_mask:0xf bank_mask:0xf
v_and_b32_dpp v61, v76, v9 row_newbcast:1 row_mask:0xf bank_mask:0xf
v_and_b32_dpp v62, v76, v10 row_newbcast:1 row_mask:0xf bank_mask:0xf
v_and_b32_dpp v63, v76, v11 row_newbcast:1 row_mask:0xf bank_mask:0xf
v_and_b32_dpp v64, v76, v8 row_newbcast:5 row_mask:0xf bank_mask:0xf
v_and_b32_dpp v65, v76, v9 row_newbcast:5 row_mask:0xf bank_mask:0xf
v_and_b32_dpp v66, v76, v10 row_newbcast:5 row_mask:0xf bank_mask:0xf
v_and_b32_dpp v67, v76, v11 row_newbcast:5 row_mask:0xf bank_mask:0xf
v_and_b32_dpp v68, v76, v8 row_newbcast:9 row_mask:0xf bank_mask:0xf
v_and_b32_dpp v69, v76, v9 row_newbcast:9 row_mask:0xf bank_mask:0xf
v_and_b32_dpp v70, v76, v10 row_newbcast:9 row_mask:0xf bank_mask:0xf
v_and_b32_dpp v71, v76, v11 row_newbcast:9 row_mask:0xf bank_mask:0xf
v_and_b32_dpp v72, v76, v8 row_newbcast:13 row_mask:0xf bank_mask:0xf
v_and_b32_dpp v73, v76, v9 row_newbcast:13 row_mask:0xf bank_mask:0xf
v_and_b32_dpp v74, v76, v10 row_newbcast:13 row_mask:0xf bank_mask:0xf
v_and_b32_dpp v75, v76, v11 row_newbcast:13 row_mask:0xf bank_mask:0xf
v_mfma_f32_16x16x32_bf16 v[20:23], v[60:63], a[0:3], v[20:23]
v_mfma_f32_16x16x32_bf16 v[20:23], v[64:67], a[4:7], v[20:23]
v_mfma_f32_16x16x32_bf16 v[20:23], v[68:71], a[8:11], v[20:23]
v_mfma_f32_16x16x32_bf16 v[20:23], v[72:75], a[12:15], v[20:23]
s_nop 3
v_and_b32_dpp v60, v78, v8 row_newbcast:2 row_mask:0xf bank_mask:0xf
v_and_b32_dpp v61, v78, v9 row_newbcast:2 row_mask:0xf bank_mask:0xf
v_and_b32_dpp v62, v78, v10 row_newbcast:2 row_mask:0xf bank_mask:0xf
v_and_b32_dpp v63, v78, v11 row_newbcast:2 row_mask:0xf bank_mask:0xf
v_and_b32_dpp v64, v78, v8 row_newbcast:6 row_mask:0xf bank_mask:0xf
v_and_b32_dpp v65, v78, v9 row_newbcast:6 row_mask:0xf bank_mask:0xf
v_and_b32_dpp v66, v78, v10 row_newbcast:6 row_mask:0xf bank_mask:0xf
v_and_b32_dpp v67, v78, v11 row_newbcast:6 row_mask:0xf bank_mask:0xf
v_and_b32_dpp v68, v78, v8 row_newbcast:10 row_mask:0xf bank_mask:0xf
v_and_b32_dpp v69, v78, v9 row_newbcast:10 row_mask:0xf bank_mask:0xf
v_and_b32_dpp v70, v78, v10 row_newbcast:10 row_mask:0xf bank_mask:0xf
v_and_b32_dpp v71, v78, v11 row_newbcast:10 row_mask:0xf bank_mask:0xf
v_and_b32_dpp v72, v78, v8 row_newbcast:14 row_mask:0xf bank_mask:0xf
v_and_b32_dpp v73, v78, v9 row_newbcast:14 row_mask:0xf bank_mask:0xf
v_and_b32_dpp v74, v78, v10 row_newbcast:14 row_mask:0xf bank_mask:0xf
v_and_b32_dpp v75, v78, v11 row_newbcast:14 row_mask:0xf bank_mask:0xf
s_waitcnt vmcnt(31)
v_mfma_f32_16x16x32_bf16 v[20:23], v[60:63], v[216:219], v[20:23]
v_mfma_f32_16x16x32_bf16 v[20:23], v[64:67], v[220:223], v[20:23]
v_mfma_f32_16x16x32_bf16 v[20:23], v[68:71], v[224:227], v[20:23]
v_mfma_f32_16x16x32_bf16 v[20:23], v[72:75], v[228:231], v[20:23]
v_add_u32 v117, 1, v117
buffer_store_dword v117, v118, s[64:67], 0 offen
buffer_load_dwordx4 v[216:219], v2, s[52:55], s12 offen offset:0 nt
buffer_load_dwordx4 v[220:223], v2, s[52:55], s12 offen offset:1024 nt
buffer_load_dwordx4 v[224:227], v2, s[52:55], s12 offen offset:2048 nt
buffer_load_dwordx4 v[228:231], v2, s[52:55], s12 offen offset:3072 nt
s_add_u32 s13, s13, 24576
s_min_u32 s12, s13, 2146435072
v_and_b32_dpp v60, v78, v8 row_newbcast:3 row_mask:0xf bank_mask:0xf
v_and_b32_dpp v61, v78, v9 row_newbcast:3 row_mask:0xf bank_mask:0xf
v_and_b32_dpp v62, v78, v10 row_newbcast:3 row_mask:0xf bank_mask:0xf
v_and_b32_dpp v63, v78, v11 row_newbcast:3 row_mask:0xf bank_mask:0xf
v_and_b32_dpp v64, v78, v8 row_newbcast:7 row_mask:0xf bank_mask:0xf
v_and_b32_dpp v65, v78, v9 row_newbcast:7 row_mask:0xf bank_mask:0xf
v_and_b32_dpp v66, v78, v10 row_newbcast:7 row_mask:0xf bank_mask:0xf
v_and_b32_dpp v67, v78, v11 row_newbcast:7 row_mask:0xf bank_mask:0xf
v_and_b32_dpp v68, v78, v8 row_newbcast:11 row_mask:0xf bank_mask:0xf
v_and_b32_dpp v69, v78, v9 row_newbcast:11 row_mask:0xf bank_mask:0xf
v_and_b32_dpp v70, v78, v10 row_newbcast:11 row_mask:0xf bank_mask:0xf
v_and_b32_dpp v71, v78, v11 row_newbcast:11 row_mask:0xf bank_mask:0xf
v_and_b32_dpp v72, v78, v8 row_newbcast:15 row_mask:0xf bank_mask:0xf
v_and_b32_dpp v73, v78, v9 row_newbcast:15 row_mask:0xf bank_mask:0xf
v_and_b32_dpp v74, v78, v10 row_newbcast:15 row_mask:0xf bank_mask:0xf
v_and_b32_dpp v75, v78, v11 row_newbcast:15 row_mask:0xf bank_mask:0xf
s_waitcnt vmcnt(32)
v_mfma_f32_16x16x32_bf16 v[20:23], v[60:63], v[232:235], v[20:23]
v_mfma_f32_16x16x32_bf16 v[20:23], v[64:67], v[236:239], v[20:23]
v_mfma_f32_16x16x32_bf16 v[20:23], v[68:71], v[240:243], v[20:23]
v_mfma_f32_16x16x32_bf16 v[20:23], v[72:75], v[244:247], v[20:23]
v_add_u32 v117, 1, v117
buffer_store_dword v117, v118, s[64:67], 0 offen
buffer_load_dwordx4 v[232:235], v2, s[52:55], s12 offen offset:0 nt
buffer_load_dwordx4 v[236:239], v2, s[52:55], s12 offen offset:1024 nt
buffer_load_dwordx4 v[240:243], v2, s[52:55], s12 offen offset:2048 nt
buffer_load_dwordx4 v[244:247], v2, s[52:55], s12 offen offset:3072 nt
s_add_u32 s13, s13, 24576
s_min_u32 s12, s13, 2146435072
s_barrier
ds_read_b64_tr_b16 a[96:97], v88 offset:0
ds_read_b64_tr_b16 a[98:99], v88 offset:4608
ds_read_b64_tr_b16 a[100:101], v88 offset:36864
ds_read_b64_tr_b16 a[102:103], v88 offset:41472
v_and_b32_dpp v60, v79, v8 row_newbcast:0 row_mask:0xf bank_mask:0xf
v_and_b32_dpp v61, v79, v9 row_newbcast:0 row_mask:0xf bank_mask:0xf
v_and_b32_dpp v62, v79, v10 row_newbcast:0 row_mask:0xf bank_mask:0xf
v_and_b32_dpp v63, v79, v11 row_newbcast:0 row_mask:0xf bank_mask:0xf
v_and_b32_dpp v64, v79, v8 row_newbcast:4 row_mask:0xf bank_mask:0xf
v_and_b32_dpp v65, v79, v9 row_newbcast:4 row_mask:0xf bank_mask:0xf
v_and_b32_dpp v66, v79, v10 row_newbcast:4 row_mask:0xf bank_mask:0xf
v_and_b32_dpp v67, v79, v11 row_newbcast:4 row_mask:0xf bank_mask:0xf
v_and_b32_dpp v68, v79, v8 row_newbcast:8 row_mask:0xf bank_mask:0xf
v_and_b32_dpp v69, v79, v9 row_newbcast:8 row_mask:0xf bank_mask:0xf
v_and_b32_dpp v70, v79, v10 row_newbcast:8 row_mask:0xf bank_mask:0xf
v_and_b32_dpp v71, v79, v11 row_newbcast:8 row_mask:0xf bank_mask:0xf
v_and_b32_dpp v72, v79, v8 row_newbcast:12 row_mask:0xf bank_mask:0xf
v_and_b32_dpp v73, v79, v9 row_newbcast:12 row_mask:0xf bank_mask:0xf
v_and_b32_dpp v74, v79, v10 row_newbcast:12 row_mask:0xf bank_mask:0xf
v_and_b32_dpp v75, v79, v11 row_newbcast:12 row_mask:0xf bank_mask:0xf
s_waitcnt vmcnt(33)
v_mfma_f32_16x16x32_bf16 v[20:23], v[60:63], v[120:123], v[20:23]
v_mfma_f32_16x16x32_bf16 v[20:23], v[64:67], v[124:127], v[20:23]
v_mfma_f32_16x16x32_bf16 v[20:23], v[68:71], v[128:131], v[20:23]
v_mfma_f32_16x16x32_bf16 v[20:23], v[72:75], v[132:135], v[20:23]
v_add_u32 v117, 1, v117
buffer_store_dword v117, v118, s[64:67], 0 offen
buffer_load_dwordx4 v[120:123], v2, s[52:55], s12 offen offset:0 nt
buffer_load_dwordx4 v[124:127], v2, s[52:55], s12 offen offset:1024 nt
buffer_load_dwordx4 v[128:131], v2, s[52:55], s12 offen offset:2048 nt
buffer_load_dwordx4 v[132:135], v2, s[52:55], s12 offen offset:3072 nt
s_add_u32 s13, s13, 24576
s_min_u32 s12, s13, 2146435072
ds_read_b64_tr_b16 a[104:105], v90 offset:0
ds_read_b64_tr_b16 a[106:107], v90 offset:4608
ds_read_b64_tr_b16 a[108:109], v90 offset:36864
ds_read_b64_tr_b16 a[110:111], v90 offset:41472
v_and_b32_dpp v60, v79, v8 row_newbcast:1 row_mask:0xf bank_mask:0xf
v_and_b32_dpp v61, v79, v9 row_newbcast:1 row_mask:0xf bank_mask:0xf
v_and_b32_dpp v62, v79, v10 row_newbcast:1 row_mask:0xf bank_mask:0xf
v_and_b32_dpp v63, v79, v11 row_newbcast:1 row_mask:0xf bank_mask:0xf
v_and_b32_dpp v64, v79, v8 row_newbcast:5 row_mask:0xf bank_mask:0xf
v_and_b32_dpp v65, v79, v9 row_newbcast:5 row_mask:0xf bank_mask:0xf
v_and_b32_dpp v66, v79, v10 row_newbcast:5 row_mask:0xf bank_mask:0xf
v_and_b32_dpp v67, v79, v11 row_newbcast:5 row_mask:0xf bank_mask:0xf
v_and_b32_dpp v68, v79, v8 row_newbcast:9 row_mask:0xf bank_mask:0xf
v_and_b32_dpp v69, v79, v9 row_newbcast:9 row_mask:0xf bank_mask:0xf
v_and_b32_dpp v70, v79, v10 row_newbcast:9 row_mask:0xf bank_mask:0xf
v_and_b32_dpp v71, v79, v11 row_newbcast:9 row_mask:0xf bank_mask:0xf
v_and_b32_dpp v72, v79, v8 row_newbcast:13 row_mask:0xf bank_mask:0xf
v_and_b32_dpp v73, v79, v9 row_newbcast:13 row_mask:0xf bank_mask:0xf
v_and_b32_dpp v74, v79, v10 row_newbcast:13 row_mask:0xf bank_mask:0xf
v_and_b32_dpp v75, v79, v11 row_newbcast:13 row_mask:0xf bank_mask:0xf
s_waitcnt vmcnt(34)
v_mfma_f32_16x16x32_bf16 v[20:23], v[60:63], v[136:139], v[20:23]
v_mfma_f32_16x16x32_bf16 v[20:23], v[64:67], v[140:143], v[20:23]
v_mfma_f32_16x16x32_bf16 v[20:23], v[68:71], v[144:147], v[20:23]
v_mfma_f32_16x16x32_bf16 v[20:23], v[72:75], v[148:151], v[20:23]
v_add_u32 v117, 1, v117
buffer_store_dword v117, v118, s[64:67], 0 offen
buffer_load_dwordx4 v[136:139], v2, s[52:55], s12 offen offset:0 nt
buffer_load_dwordx4 v[140:143], v2, s[52:55], s12 offen offset:1024 nt
buffer_load_dwordx4 v[144:147], v2, s[52:55], s12 offen offset:2048 nt
buffer_load_dwordx4 v[148:151], v2, s[52:55], s12 offen offset:3072 nt
s_add_u32 s13, s13, 24576
s_min_u32 s12, s13, 2146435072
ds_read_b64_tr_b16 a[112:113], v88 offset:8
ds_read_b64_tr_b16 a[114:115], v88 offset:4616
ds_read_b64_tr_b16 a[116:117], v88 offset:36872
ds_read_b64_tr_b16 a[118:119], v88 offset:41480
v_and_b32_dpp v60, v76, v8 row_newbcast:2 row_mask:0xf bank_mask:0xf
v_and_b32_dpp v61, v76, v9 row_newbcast:2 row_mask:0xf bank_mask:0xf
v_and_b32_dpp v62, v76, v10 row_newbcast:2 row_mask:0xf bank_mask:0xf
v_and_b32_dpp v63, v76, v11 row_newbcast:2 row_mask:0xf bank_mask:0xf
v_and_b32_dpp v64, v76, v8 row_newbcast:6 row_mask:0xf bank_mask:0xf
v_and_b32_dpp v65, v76, v9 row_newbcast:6 row_mask:0xf bank_mask:0xf
v_and_b32_dpp v66, v76, v10 row_newbcast:6 row_mask:0xf bank_mask:0xf
v_and_b32_dpp v67, v76, v11 row_newbcast:6 row_mask:0xf bank_mask:0xf
v_and_b32_dpp v68, v76, v8 row_newbcast:10 row_mask:0xf bank_mask:0xf
v_and_b32_dpp v69, v76, v9 row_newbcast:10 row_mask:0xf bank_mask:0xf
v_and_b32_dpp v70, v76, v10 row_newbcast:10 row_mask:0xf bank_mask:0xf
v_and_b32_dpp v71, v76, v11 row_newbcast:10 row_mask:0xf bank_mask:0xf
v_and_b32_dpp v72, v76, v8 row_newbcast:14 row_mask:0xf bank_mask:0xf
v_and_b32_dpp v73, v76, v9 row_newbcast:14 row_mask:0xf bank_mask:0xf
v_and_b32_dpp v74, v76, v10 row_newbcast:14 row_mask:0xf bank_mask:0xf
v_and_b32_dpp v75, v76, v11 row_newbcast:14 row_mask:0xf bank_mask:0xf
v_mfma_f32_16x16x32_bf16 v[20:23], v[60:63], a[16:19], v[20:23]
v_mfma_f32_16x16x32_bf16 v[20:23], v[64:67], a[20:23], v[20:23]
v_mfma_f32_16x16x32_bf16 v[20:23], v[68:71], a[24:27], v[20:23]
v_mfma_f32_16x16x32_bf16 v[20:23], v[72:75], a[28:31], v[20:23]
s_nop 3
v_and_b32_dpp v60, v79, v8 row_newbcast:2 row_mask:0xf bank_mask:0xf
v_and_b32_dpp v61, v79, v9 row_newbcast:2 row_mask:0xf bank_mask:0xf
v_and_b32_dpp v62, v79, v10 row_newbcast:2 row_mask:0xf bank_mask:0xf
v_and_b32_dpp v63, v79, v11 row_newbcast:2 row_mask:0xf bank_mask:0xf
v_and_b32_dpp v64, v79, v8 row_newbcast:6 row_mask:0xf bank_mask:0xf
v_and_b32_dpp v65, v79, v9 row_newbcast:6 row_mask:0xf bank_mask:0xf
v_and_b32_dpp v66, v79, v10 row_newbcast:6 row_mask:0xf bank_mask:0xf
v_and_b32_dpp v67, v79, v11 row_newbcast:6 row_mask:0xf bank_mask:0xf
v_and_b32_dpp v68, v79, v8 row_newbcast:10 row_mask:0xf bank_mask:0xf
v_and_b32_dpp v69, v79, v9 row_newbcast:10 row_mask:0xf bank_mask:0xf
v_and_b32_dpp v70, v79, v10 row_newbcast:10 row_mask:0xf bank_mask:0xf
v_and_b32_dpp v71, v79, v11 row_newbcast:10 row_mask:0xf bank_mask:0xf
v_and_b32_dpp v72, v79, v8 row_newbcast:14 row_mask:0xf bank_mask:0xf
v_and_b32_dpp v73, v79, v9 row_newbcast:14 row_mask:0xf bank_mask:0xf
v_and_b32_dpp v74, v79, v10 row_newbcast:14 row_mask:0xf bank_mask:0xf
v_and_b32_dpp v75, v79, v11 row_newbcast:14 row_mask:0xf bank_mask:0xf
s_waitcnt vmcnt(35)
v_mfma_f32_16x16x32_bf16 v[20:23], v[60:63], v[152:155], v[20:23]
v_mfma_f32_16x16x32_bf16 v[20:23], v[64:67], v[156:159], v[20:23]
v_mfma_f32_16x16x32_bf16 v[20:23], v[68:71], v[160:163], v[20:23]
v_mfma_f32_16x16x32_bf16 v[20:23], v[72:75], v[164:167], v[20:23]
v_add_u32 v117, 1, v117
buffer_store_dword v117, v118, s[64:67], 0 offen
buffer_load_dwordx4 v[152:155], v2, s[52:55], s12 offen offset:0 nt
buffer_load_dwordx4 v[156:159], v2, s[52:55], s12 offen offset:1024 nt
buffer_load_dwordx4 v[160:163], v2, s[52:55], s12 offen offset:2048 nt
buffer_load_dwordx4 v[164:167], v2, s[52:55], s12 offen offset:3072 nt
s_add_u32 s13, s13, 24576
s_min_u32 s12, s13, 2146435072
ds_read_b64_tr_b16 a[120:121], v90 offset:8
ds_read_b64_tr_b16 a[122:123], v90 offset:4616
ds_read_b64_tr_b16 a[124:125], v90 offset:36872
ds_read_b64_tr_b16 a[126:127], v90 offset:41480
v_and_b32_dpp v60, v79, v8 row_newbcast:3 row_mask:0xf bank_mask:0xf
v_and_b32_dpp v61, v79, v9 row_newbcast:3 row_mask:0xf bank_mask:0xf
v_and_b32_dpp v62, v79, v10 row_newbcast:3 row_mask:0xf bank_mask:0xf
v_and_b32_dpp v63, v79, v11 row_newbcast:3 row_mask:0xf bank_mask:0xf
v_and_b32_dpp v64, v79, v8 row_newbcast:7 row_mask:0xf bank_mask:0xf
v_and_b32_dpp v65, v79, v9 row_newbcast:7 row_mask:0xf bank_mask:0xf
v_and_b32_dpp v66, v79, v10 row_newbcast:7 row_mask:0xf bank_mask:0xf
v_and_b32_dpp v67, v79, v11 row_newbcast:7 row_mask:0xf bank_mask:0xf
v_and_b32_dpp v68, v79, v8 row_newbcast:11 row_mask:0xf bank_mask:0xf
v_and_b32_dpp v69, v79, v9 row_newbcast:11 row_mask:0xf bank_mask:0xf
v_and_b32_dpp v70, v79, v10 row_newbcast:11 row_mask:0xf bank_mask:0xf
v_and_b32_dpp v71, v79, v11 row_newbcast:11 row_mask:0xf bank_mask:0xf
v_and_b32_dpp v72, v79, v8 row_newbcast:15 row_mask:0xf bank_mask:0xf
v_and_b32_dpp v73, v79, v9 row_newbcast:15 row_mask:0xf bank_mask:0xf
v_and_b32_dpp v74, v79, v10 row_newbcast:15 row_mask:0xf bank_mask:0xf
v_and_b32_dpp v75, v79, v11 row_newbcast:15 row_mask:0xf bank_mask:0xf
s_waitcnt vmcnt(36)
v_mfma_f32_16x16x32_bf16 v[20:23], v[60:63], v[168:171], v[20:23]
v_mfma_f32_16x16x32_bf16 v[20:23], v[64:67], v[172:175], v[20:23]
v_mfma_f32_16x16x32_bf16 v[20:23], v[68:71], v[176:179], v[20:23]
v_mfma_f32_16x16x32_bf16 v[20:23], v[72:75], v[180:183], v[20:23]
v_add_u32 v117, 1, v117
buffer_store_dword v117, v118, s[64:67], 0 offen
buffer_load_dwordx4 v[168:171], v2, s[52:55], s12 offen offset:0 nt
buffer_load_dwordx4 v[172:175], v2, s[52:55], s12 offen offset:1024 nt
buffer_load_dwordx4 v[176:179], v2, s[52:55], s12 offen offset:2048 nt
buffer_load_dwordx4 v[180:183], v2, s[52:55], s12 offen offset:3072 nt
s_add_u32 s13, s13, 24576
s_min_u32 s12, s13, 2146435072
ds_read_b64_tr_b16 a[128:129], v88 offset:16
ds_read_b64_tr_b16 a[130:131], v88 offset:4624
ds_read_b64_tr_b16 a[132:133], v88 offset:36880
ds_read_b64_tr_b16 a[134:135], v88 offset:41488
v_and_b32_dpp v60, v80, v8 row_newbcast:0 row_mask:0xf bank_mask:0xf
v_and_b32_dpp v61, v80, v9 row_newbcast:0 row_mask:0xf bank_mask:0xf
v_and_b32_dpp v62, v80, v10 row_newbcast:0 row_mask:0xf bank_mask:0xf
v_and_b32_dpp v63, v80, v11 row_newbcast:0 row_mask:0xf bank_mask:0xf
v_and_b32_dpp v64, v80, v8 row_newbcast:4 row_mask:0xf bank_mask:0xf
v_and_b32_dpp v65, v80, v9 row_newbcast:4 row_mask:0xf bank_mask:0xf
v_and_b32_dpp v66, v80, v10 row_newbcast:4 row_mask:0xf bank_mask:0xf
v_and_b32_dpp v67, v80, v11 row_newbcast:4 row_mask:0xf bank_mask:0xf
v_and_b32_dpp v68, v80, v8 row_newbcast:8 row_mask:0xf bank_mask:0xf
v_and_b32_dpp v69, v80, v9 row_newbcast:8 row_mask:0xf bank_mask:0xf
v_and_b32_dpp v70, v80, v10 row_newbcast:8 row_mask:0xf bank_mask:0xf
v_and_b32_dpp v71, v80, v11 row_newbcast:8 row_mask:0xf bank_mask:0xf
v_and_b32_dpp v72, v80, v8 row_newbcast:12 row_mask:0xf bank_mask:0xf
v_and_b32_dpp v73, v80, v9 row_newbcast:12 row_mask:0xf bank_mask:0xf
v_and_b32_dpp v74, v80, v10 row_newbcast:12 row_mask:0xf bank_mask:0xf
v_and_b32_dpp v75, v80, v11 row_newbcast:12 row_mask:0xf bank_mask:0xf
s_waitcnt vmcnt(35)
v_mfma_f32_16x16x32_bf16 v[20:23], v[60:63], v[184:187], v[20:23]
v_mfma_f32_16x16x32_bf16 v[20:23], v[64:67], v[188:191], v[20:23]
v_mfma_f32_16x16x32_bf16 v[20:23], v[68:71], v[192:195], v[20:23]
v_mfma_f32_16x16x32_bf16 v[20:23], v[72:75], v[196:199], v[20:23]
v_add_u32 v117, 1, v117
buffer_store_dword v117, v118, s[64:67], 0 offen
buffer_load_dwordx4 v[184:187], v2, s[52:55], s12 offen offset:0 nt
buffer_load_dwordx4 v[188:191], v2, s[52:55], s12 offen offset:1024 nt
buffer_load_dwordx4 v[192:195], v2, s[52:55], s12 offen offset:2048 nt
buffer_load_dwordx4 v[196:199], v2, s[52:55], s12 offen offset:3072 nt
s_add_u32 s13, s13, 24576
s_min_u32 s12, s13, 2146435072
ds_read_b64_tr_b16 a[136:137], v90 offset:16
ds_read_b64_tr_b16 a[138:139], v90 offset:4624
ds_read_b64_tr_b16 a[140:141], v90 offset:36880
ds_read_b64_tr_b16 a[142:143], v90 offset:41488
v_and_b32_dpp v60, v80, v8 row_newbcast:1 row_mask:0xf bank_mask:0xf
v_and_b32_dpp v61, v80, v9 row_newbcast:1 row_mask:0xf bank_mask:0xf
v_and_b32_dpp v62, v80, v10 row_newbcast:1 row_mask:0xf bank_mask:0xf
v_and_b32_dpp v63, v80, v11 row_newbcast:1 row_mask:0xf bank_mask:0xf
v_and_b32_dpp v64, v80, v8 row_newbcast:5 row_mask:0xf bank_mask:0xf
v_and_b32_dpp v65, v80, v9 row_newbcast:5 row_mask:0xf bank_mask:0xf
v_and_b32_dpp v66, v80, v10 row_newbcast:5 row_mask:0xf bank_mask:0xf
v_and_b32_dpp v67, v80, v11 row_newbcast:5 row_mask:0xf bank_mask:0xf
v_and_b32_dpp v68, v80, v8 row_newbcast:9 row_mask:0xf bank_mask:0xf
v_and_b32_dpp v69, v80, v9 row_newbcast:9 row_mask:0xf bank_mask:0xf
v_and_b32_dpp v70, v80, v10 row_newbcast:9 row_mask:0xf bank_mask:0xf
v_and_b32_dpp v71, v80, v11 row_newbcast:9 row_mask:0xf bank_mask:0xf
v_and_b32_dpp v72, v80, v8 row_newbcast:13 row_mask:0xf bank_mask:0xf
v_and_b32_dpp v73, v80, v9 row_newbcast:13 row_mask:0xf bank_mask:0xf
v_and_b32_dpp v74, v80, v10 row_newbcast:13 row_mask:0xf bank_mask:0xf
v_and_b32_dpp v75, v80, v11 row_newbcast:13 row_mask:0xf bank_mask:0xf
s_waitcnt vmcnt(35)
v_mfma_f32_16x16x32_bf16 v[20:23], v[60:63], v[200:203], v[20:23]
v_mfma_f32_16x16x32_bf16 v[20:23], v[64:67], v[204:207], v[20:23]
v_mfma_f32_16x16x32_bf16 v[20:23], v[68:71], v[208:211], v[20:23]
v_mfma_f32_16x16x32_bf16 v[20:23], v[72:75], v[212:215], v[20:23]
v_add_u32 v117, 1, v117
buffer_store_dword v117, v118, s[64:67], 0 offen
buffer_load_dwordx4 v[200:203], v2, s[52:55], s12 offen offset:0 nt
buffer_load_dwordx4 v[204:207], v2, s[52:55], s12 offen offset:1024 nt
buffer_load_dwordx4 v[208:211], v2, s[52:55], s12 offen offset:2048 nt
buffer_load_dwordx4 v[212:215], v2, s[52:55], s12 offen offset:3072 nt
s_add_u32 s13, s13, 24576
s_min_u32 s12, s13, 2146435072
ds_read_b64_tr_b16 a[144:145], v88 offset:24
ds_read_b64_tr_b16 a[146:147], v88 offset:4632
ds_read_b64_tr_b16 a[148:149], v88 offset:36888
ds_read_b64_tr_b16 a[150:151], v88 offset:41496
v_and_b32_dpp v60, v76, v8 row_newbcast:3 row_mask:0xf bank_mask:0xf
v_and_b32_dpp v61, v76, v9 row_newbcast:3 row_mask:0xf bank_mask:0xf
v_and_b32_dpp v62, v76, v10 row_newbcast:3 row_mask:0xf bank_mask:0xf
v_and_b32_dpp v63, v76, v11 row_newbcast:3 row_mask:0xf bank_mask:0xf
v_and_b32_dpp v64, v76, v8 row_newbcast:7 row_mask:0xf bank_mask:0xf
v_and_b32_dpp v65, v76, v9 row_newbcast:7 row_mask:0xf bank_mask:0xf
v_and_b32_dpp v66, v76, v10 row_newbcast:7 row_mask:0xf bank_mask:0xf
v_and_b32_dpp v67, v76, v11 row_newbcast:7 row_mask:0xf bank_mask:0xf
v_and_b32_dpp v68, v76, v8 row_newbcast:11 row_mask:0xf bank_mask:0xf
v_and_b32_dpp v69, v76, v9 row_newbcast:11 row_mask:0xf bank_mask:0xf
v_and_b32_dpp v70, v76, v10 row_newbcast:11 row_mask:0xf bank_mask:0xf
v_and_b32_dpp v71, v76, v11 row_newbcast:11 row_mask:0xf bank_mask:0xf
v_and_b32_dpp v72, v76, v8 row_newbcast:15 row_mask:0xf bank_mask:0xf
v_and_b32_dpp v73, v76, v9 row_newbcast:15 row_mask:0xf bank_mask:0xf
v_and_b32_dpp v74, v76, v10 row_newbcast:15 row_mask:0xf bank_mask:0xf
v_and_b32_dpp v75, v76, v11 row_newbcast:15 row_mask:0xf bank_mask:0xf
v_mfma_f32_16x16x32_bf16 v[20:23], v[60:63], a[32:35], v[20:23]
v_mfma_f32_16x16x32_bf16 v[20:23], v[64:67], a[36:39], v[20:23]
v_mfma_f32_16x16x32_bf16 v[20:23], v[68:71], a[40:43], v[20:23]
v_mfma_f32_16x16x32_bf16 v[20:23], v[72:75], a[44:47], v[20:23]
s_nop 3
v_and_b32_dpp v60, v80, v8 row_newbcast:2 row_mask:0xf bank_mask:0xf
v_and_b32_dpp v61, v80, v9 row_newbcast:2 row_mask:0xf bank_mask:0xf
v_and_b32_dpp v62, v80, v10 row_newbcast:2 row_mask:0xf bank_mask:0xf
v_and_b32_dpp v63, v80, v11 row_newbcast:2 row_mask:0xf bank_mask:0xf
v_and_b32_dpp v64, v80, v8 row_newbcast:6 row_mask:0xf bank_mask:0xf
v_and_b32_dpp v65, v80, v9 row_newbcast:6 row_mask:0xf bank_mask:0xf
v_and_b32_dpp v66, v80, v10 row_newbcast:6 row_mask:0xf bank_mask:0xf
v_and_b32_dpp v67, v80, v11 row_newbcast:6 row_mask:0xf bank_mask:0xf
v_and_b32_dpp v68, v80, v8 row_newbcast:10 row_mask:0xf bank_mask:0xf
v_and_b32_dpp v69, v80, v9 row_newbcast:10 row_mask:0xf bank_mask:0xf
v_and_b32_dpp v70, v80, v10 row_newbcast:10 row_mask:0xf bank_mask:0xf
v_and_b32_dpp v71, v80, v11 row_newbcast:10 row_mask:0xf bank_mask:0xf
v_and_b32_dpp v72, v80, v8 row_newbcast:14 row_mask:0xf bank_mask:0xf
v_and_b32_dpp v73, v80, v9 row_newbcast:14 row_mask:0xf bank_mask:0xf
v_and_b32_dpp v74, v80, v10 row_newbcast:14 row_mask:0xf bank_mask:0xf
v_and_b32_dpp v75, v80, v11 row_newbcast:14 row_mask:0xf bank_mask:0xf
s_waitcnt vmcnt(35)
v_mfma_f32_16x16x32_bf16 v[20:23], v[60:63], v[216:219], v[20:23]
v_mfma_f32_16x16x32_bf16 v[20:23], v[64:67], v[220:223], v[20:23]
v_mfma_f32_16x16x32_bf16 v[20:23], v[68:71], v[224:227], v[20:23]
v_mfma_f32_16x16x32_bf16 v[20:23], v[72:75], v[228:231], v[20:23]
v_add_u32 v117, 1, v117
buffer_store_dword v117, v118, s[64:67], 0 offen
buffer_load_dwordx4 v[216:219], v2, s[52:55], s12 offen offset:0 nt
buffer_load_dwordx4 v[220:223], v2, s[52:55], s12 offen offset:1024 nt
buffer_load_dwordx4 v[224:227], v2, s[52:55], s12 offen offset:2048 nt
buffer_load_dwordx4 v[228:231], v2, s[52:55], s12 offen offset:3072 nt
s_add_u32 s13, s13, 24576
s_min_u32 s12, s13, 2146435072
ds_read_b64_tr_b16 a[152:153], v90 offset:24
ds_read_b64_tr_b16 a[154:155], v90 offset:4632
ds_read_b64_tr_b16 a[156:157], v90 offset:36888
ds_read_b64_tr_b16 a[158:159], v90 offset:41496
v_and_b32_dpp v60, v80, v8 row_newbcast:3 row_mask:0xf bank_mask:0xf
v_and_b32_dpp v61, v80, v9 row_newbcast:3 row_mask:0xf bank_mask:0xf
v_and_b32_dpp v62, v80, v10 row_newbcast:3 row_mask:0xf bank_mask:0xf
v_and_b32_dpp v63, v80, v11 row_newbcast:3 row_mask:0xf bank_mask:0xf
v_and_b32_dpp v64, v80, v8 row_newbcast:7 row_mask:0xf bank_mask:0xf
v_and_b32_dpp v65, v80, v9 row_newbcast:7 row_mask:0xf bank_mask:0xf
v_and_b32_dpp v66, v80, v10 row_newbcast:7 row_mask:0xf bank_mask:0xf
v_and_b32_dpp v67, v80, v11 row_newbcast:7 row_mask:0xf bank_mask:0xf
v_and_b32_dpp v68, v80, v8 row_newbcast:11 row_mask:0xf bank_mask:0xf
v_and_b32_dpp v69, v80, v9 row_newbcast:11 row_mask:0xf bank_mask:0xf
v_and_b32_dpp v70, v80, v10 row_newbcast:11 row_mask:0xf bank_mask:0xf
v_and_b32_dpp v71, v80, v11 row_newbcast:11 row_mask:0xf bank_mask:0xf
v_and_b32_dpp v72, v80, v8 row_newbcast:15 row_mask:0xf bank_mask:0xf
v_and_b32_dpp v73, v80, v9 row_newbcast:15 row_mask:0xf bank_mask:0xf
v_and_b32_dpp v74, v80, v10 row_newbcast:15 row_mask:0xf bank_mask:0xf
v_and_b32_dpp v75, v80, v11 row_newbcast:15 row_mask:0xf bank_mask:0xf
s_waitcnt vmcnt(35)
v_mfma_f32_16x16x32_bf16 v[20:23], v[60:63], v[232:235], v[20:23]
v_mfma_f32_16x16x32_bf16 v[20:23], v[64:67], v[236:239], v[20:23]
v_mfma_f32_16x16x32_bf16 v[20:23], v[68:71], v[240:243], v[20:23]
v_mfma_f32_16x16x32_bf16 v[20:23], v[72:75], v[244:247], v[20:23]
v_add_u32 v117, 1, v117
buffer_store_dword v117, v118, s[64:67], 0 offen
buffer_load_dwordx4 v[232:235], v2, s[52:55], s12 offen offset:0 nt
buffer_load_dwordx4 v[236:239], v2, s[52:55], s12 offen offset:1024 nt
buffer_load_dwordx4 v[240:243], v2, s[52:55], s12 offen offset:2048 nt
buffer_load_dwordx4 v[244:247], v2, s[52:55], s12 offen offset:3072 nt
s_add_u32 s13, s13, 24576
s_min_u32 s12, s13, 2146435072
ds_read_b64_tr_b16 a[160:161], v88 offset:128
ds_read_b64_tr_b16 a[162:163], v88 offset:4736
ds_read_b64_tr_b16 a[164:165], v88 offset:36992
ds_read_b64_tr_b16 a[166:167], v88 offset:41600
v_and_b32_dpp v60, v81, v8 row_newbcast:0 row_mask:0xf bank_mask:0xf
v_and_b32_dpp v61, v81, v9 row_newbcast:0 row_mask:0xf bank_mask:0xf
v_and_b32_dpp v62, v81, v10 row_newbcast:0 row_mask:0xf bank_mask:0xf
v_and_b32_dpp v63, v81, v11 row_newbcast:0 row_mask:0xf bank_mask:0xf
v_and_b32_dpp v64, v81, v8 row_newbcast:4 row_mask:0xf bank_mask:0xf
v_and_b32_dpp v65, v81, v9 row_newbcast:4 row_mask:0xf bank_mask:0xf
v_and_b32_dpp v66, v81, v10 row_newbcast:4 row_mask:0xf bank_mask:0xf
v_and_b32_dpp v67, v81, v11 row_newbcast:4 row_mask:0xf bank_mask:0xf
v_and_b32_dpp v68, v81, v8 row_newbcast:8 row_mask:0xf bank_mask:0xf
v_and_b32_dpp v69, v81, v9 row_newbcast:8 row_mask:0xf bank_mask:0xf
v_and_b32_dpp v70, v81, v10 row_newbcast:8 row_mask:0xf bank_mask:0xf
v_and_b32_dpp v71, v81, v11 row_newbcast:8 row_mask:0xf bank_mask:0xf
v_and_b32_dpp v72, v81, v8 row_newbcast:12 row_mask:0xf bank_mask:0xf
v_and_b32_dpp v73, v81, v9 row_newbcast:12 row_mask:0xf bank_mask:0xf
v_and_b32_dpp v74, v81, v10 row_newbcast:12 row_mask:0xf bank_mask:0xf
v_and_b32_dpp v75, v81, v11 row_newbcast:12 row_mask:0xf bank_mask:0xf
s_waitcnt vmcnt(35)
v_mfma_f32_16x16x32_bf16 v[20:23], v[60:63], v[120:123], v[20:23]
v_mfma_f32_16x16x32_bf16 v[20:23], v[64:67], v[124:127], v[20:23]
v_mfma_f32_16x16x32_bf16 v[20:23], v[68:71], v[128:131], v[20:23]
v_mfma_f32_16x16x32_bf16 v[20:23], v[72:75], v[132:135], v[20:23]
v_add_u32 v117, 1, v117
buffer_store_dword v117, v118, s[64:67], 0 offen
buffer_load_dwordx4 v[120:123], v2, s[52:55], s12 offen offset:0 nt
buffer_load_dwordx4 v[124:127], v2, s[52:55], s12 offen offset:1024 nt
buffer_load_dwordx4 v[128:131], v2, s[52:55], s12 offen offset:2048 nt
buffer_load_dwordx4 v[132:135], v2, s[52:55], s12 offen offset:3072 nt
s_add_u32 s13, s13, 24576
s_min_u32 s12, s13, 2146435072
ds_read_b64_tr_b16 a[168:169], v90 offset:128
ds_read_b64_tr_b16 a[170:171], v90 offset:4736
ds_read_b64_tr_b16 a[172:173], v90 offset:36992
ds_read_b64_tr_b16 a[174:175], v90 offset:41600
v_and_b32_dpp v60, v81, v8 row_newbcast:1 row_mask:0xf bank_mask:0xf
v_and_b32_dpp v61, v81, v9 row_newbcast:1 row_mask:0xf bank_mask:0xf
v_and_b32_dpp v62, v81, v10 row_newbcast:1 row_mask:0xf bank_mask:0xf
v_and_b32_dpp v63, v81, v11 row_newbcast:1 row_mask:0xf bank_mask:0xf
v_and_b32_dpp v64, v81, v8 row_newbcast:5 row_mask:0xf bank_mask:0xf
v_and_b32_dpp v65, v81, v9 row_newbcast:5 row_mask:0xf bank_mask:0xf
v_and_b32_dpp v66, v81, v10 row_newbcast:5 row_mask:0xf bank_mask:0xf
v_and_b32_dpp v67, v81, v11 row_newbcast:5 row_mask:0xf bank_mask:0xf
v_and_b32_dpp v68, v81, v8 row_newbcast:9 row_mask:0xf bank_mask:0xf
v_and_b32_dpp v69, v81, v9 row_newbcast:9 row_mask:0xf bank_mask:0xf
v_and_b32_dpp v70, v81, v10 row_newbcast:9 row_mask:0xf bank_mask:0xf
v_and_b32_dpp v71, v81, v11 row_newbcast:9 row_mask:0xf bank_mask:0xf
v_and_b32_dpp v72, v81, v8 row_newbcast:13 row_mask:0xf bank_mask:0xf
v_and_b32_dpp v73, v81, v9 row_newbcast:13 row_mask:0xf bank_mask:0xf
v_and_b32_dpp v74, v81, v10 row_newbcast:13 row_mask:0xf bank_mask:0xf
v_and_b32_dpp v75, v81, v11 row_newbcast:13 row_mask:0xf bank_mask:0xf
s_waitcnt vmcnt(35)
v_mfma_f32_16x16x32_bf16 v[20:23], v[60:63], v[136:139], v[20:23]
v_mfma_f32_16x16x32_bf16 v[20:23], v[64:67], v[140:143], v[20:23]
v_mfma_f32_16x16x32_bf16 v[20:23], v[68:71], v[144:147], v[20:23]
v_mfma_f32_16x16x32_bf16 v[20:23], v[72:75], v[148:151], v[20:23]
v_add_u32 v117, 1, v117
buffer_store_dword v117, v118, s[64:67], 0 offen
buffer_load_dwordx4 v[136:139], v2, s[52:55], s12 offen offset:0 nt
buffer_load_dwordx4 v[140:143], v2, s[52:55], s12 offen offset:1024 nt
buffer_load_dwordx4 v[144:147], v2, s[52:55], s12 offen offset:2048 nt
buffer_load_dwordx4 v[148:151], v2, s[52:55], s12 offen offset:3072 nt
s_add_u32 s13, s13, 24576
s_min_u32 s12, s13, 2146435072
ds_read_b64_tr_b16 a[176:177], v88 offset:136
ds_read_b64_tr_b16 a[178:179], v88 offset:4744
ds_read_b64_tr_b16 a[180:181], v88 offset:37000
ds_read_b64_tr_b16 a[182:183], v88 offset:41608
v_and_b32_dpp v60, v77, v8 row_newbcast:0 row_mask:0xf bank_mask:0xf
v_and_b32_dpp v61, v77, v9 row_newbcast:0 row_mask:0xf bank_mask:0xf
v_and_b32_dpp v62, v77, v10 row_newbcast:0 row_mask:0xf bank_mask:0xf
v_and_b32_dpp v63, v77, v11 row_newbcast:0 row_mask:0xf bank_mask:0xf
v_and_b32_dpp v64, v77, v8 row_newbcast:4 row_mask:0xf bank_mask:0xf
v_and_b32_dpp v65, v77, v9 row_newbcast:4 row_mask:0xf bank_mask:0xf
v_and_b32_dpp v66, v77, v10 row_newbcast:4 row_mask:0xf bank_mask:0xf
v_and_b32_dpp v67, v77, v11 row_newbcast:4 row_mask:0xf bank_mask:0xf
v_and_b32_dpp v68, v77, v8 row_newbcast:8 row_mask:0xf bank_mask:0xf
v_and_b32_dpp v69, v77, v9 row_newbcast:8 row_mask:0xf bank_mask:0xf
v_and_b32_dpp v70, v77, v10 row_newbcast:8 row_mask:0xf bank_mask:0xf
v_and_b32_dpp v71, v77, v11 row_newbcast:8 row_mask:0xf bank_mask:0xf
v_and_b32_dpp v72, v77, v8 row_newbcast:12 row_mask:0xf bank_mask:0xf
v_and_b32_dpp v73, v77, v9 row_newbcast:12 row_mask:0xf bank_mask:0xf
v_and_b32_dpp v74, v77, v10 row_newbcast:12 row_mask:0xf bank_mask:0xf
v_and_b32_dpp v75, v77, v11 row_newbcast:12 row_mask:0xf bank_mask:0xf
v_mfma_f32_16x16x32_bf16 v[20:23], v[60:63], a[48:51], v[20:23]
v_mfma_f32_16x16x32_bf16 v[20:23], v[64:67], a[52:55], v[20:23]
v_mfma_f32_16x16x32_bf16 v[20:23], v[68:71], a[56:59], v[20:23]
v_mfma_f32_16x16x32_bf16 v[20:23], v[72:75], a[60:63], v[20:23]
s_nop 3
v_and_b32_dpp v60, v81, v8 row_newbcast:2 row_mask:0xf bank_mask:0xf
v_and_b32_dpp v61, v81, v9 row_newbcast:2 row_mask:0xf bank_mask:0xf
v_and_b32_dpp v62, v81, v10 row_newbcast:2 row_mask:0xf bank_mask:0xf
v_and_b32_dpp v63, v81, v11 row_newbcast:2 row_mask:0xf bank_mask:0xf
v_and_b32_dpp v64, v81, v8 row_newbcast:6 row_mask:0xf bank_mask:0xf
v_and_b32_dpp v65, v81, v9 row_newbcast:6 row_mask:0xf bank_mask:0xf
v_and_b32_dpp v66, v81, v10 row_newbcast:6 row_mask:0xf bank_mask:0xf
v_and_b32_dpp v67, v81, v11 row_newbcast:6 row_mask:0xf bank_mask:0xf
v_and_b32_dpp v68, v81, v8 row_newbcast:10 row_mask:0xf bank_mask:0xf
v_and_b32_dpp v69, v81, v9 row_newbcast:10 row_mask:0xf bank_mask:0xf
v_and_b32_dpp v70, v81, v10 row_newbcast:10 row_mask:0xf bank_mask:0xf
v_and_b32_dpp v71, v81, v11 row_newbcast:10 row_mask:0xf bank_mask:0xf
v_and_b32_dpp v72, v81, v8 row_newbcast:14 row_mask:0xf bank_mask:0xf
v_and_b32_dpp v73, v81, v9 row_newbcast:14 row_mask:0xf bank_mask:0xf
v_and_b32_dpp v74, v81, v10 row_newbcast:14 row_mask:0xf bank_mask:0xf
v_and_b32_dpp v75, v81, v11 row_newbcast:14 row_mask:0xf bank_mask:0xf
s_waitcnt vmcnt(35)
v_mfma_f32_16x16x32_bf16 v[20:23], v[60:63], v[152:155], v[20:23]
v_mfma_f32_16x16x32_bf16 v[20:23], v[64:67], v[156:159], v[20:23]
v_mfma_f32_16x16x32_bf16 v[20:23], v[68:71], v[160:163], v[20:23]
v_mfma_f32_16x16x32_bf16 v[20:23], v[72:75], v[164:167], v[20:23]
v_add_u32 v117, 1, v117
buffer_store_dword v117, v118, s[64:67], 0 offen
buffer_load_dwordx4 v[152:155], v2, s[52:55], s12 offen offset:0 nt
buffer_load_dwordx4 v[156:159], v2, s[52:55], s12 offen offset:1024 nt
buffer_load_dwordx4 v[160:163], v2, s[52:55], s12 offen offset:2048 nt
buffer_load_dwordx4 v[164:167], v2, s[52:55], s12 offen offset:3072 nt
s_add_u32 s13, s13, 24576
s_min_u32 s12, s13, 2146435072
ds_read_b64_tr_b16 a[184:185], v90 offset:136
ds_read_b64_tr_b16 a[186:187], v90 offset:4744
ds_read_b64_tr_b16 a[188:189], v90 offset:37000
ds_read_b64_tr_b16 a[190:191], v90 offset:41608
v_and_b32_dpp v60, v81, v8 row_newbcast:3 row_mask:0xf bank_mask:0xf
v_and_b32_dpp v61, v81, v9 row_newbcast:3 row_mask:0xf bank_mask:0xf
v_and_b32_dpp v62, v81, v10 row_newbcast:3 row_mask:0xf bank_mask:0xf
v_and_b32_dpp v63, v81, v11 row_newbcast:3 row_mask:0xf bank_mask:0xf
v_and_b32_dpp v64, v81, v8 row_newbcast:7 row_mask:0xf bank_mask:0xf
v_and_b32_dpp v65, v81, v9 row_newbcast:7 row_mask:0xf bank_mask:0xf
v_and_b32_dpp v66, v81, v10 row_newbcast:7 row_mask:0xf bank_mask:0xf
v_and_b32_dpp v67, v81, v11 row_newbcast:7 row_mask:0xf bank_mask:0xf
v_and_b32_dpp v68, v81, v8 row_newbcast:11 row_mask:0xf bank_mask:0xf
v_and_b32_dpp v69, v81, v9 row_newbcast:11 row_mask:0xf bank_mask:0xf
v_and_b32_dpp v70, v81, v10 row_newbcast:11 row_mask:0xf bank_mask:0xf
v_and_b32_dpp v71, v81, v11 row_newbcast:11 row_mask:0xf bank_mask:0xf
v_and_b32_dpp v72, v81, v8 row_newbcast:15 row_mask:0xf bank_mask:0xf
v_and_b32_dpp v73, v81, v9 row_newbcast:15 row_mask:0xf bank_mask:0xf
v_and_b32_dpp v74, v81, v10 row_newbcast:15 row_mask:0xf bank_mask:0xf
v_and_b32_dpp v75, v81, v11 row_newbcast:15 row_mask:0xf bank_mask:0xf
s_waitcnt vmcnt(35)
v_mfma_f32_16x16x32_bf16 v[20:23], v[60:63], v[168:171], v[20:23]
v_mfma_f32_16x16x32_bf16 v[20:23], v[64:67], v[172:175], v[20:23]
v_mfma_f32_16x16x32_bf16 v[20:23], v[68:71], v[176:179], v[20:23]
v_mfma_f32_16x16x32_bf16 v[20:23], v[72:75], v[180:183], v[20:23]
v_add_u32 v117, 1, v117
buffer_store_dword v117, v118, s[64:67], 0 offen
buffer_load_dwordx4 v[168:171], v2, s[52:55], s12 offen offset:0 nt
buffer_load_dwordx4 v[172:175], v2, s[52:55], s12 offen offset:1024 nt
buffer_load_dwordx4 v[176:179], v2, s[52:55], s12 offen offset:2048 nt
buffer_load_dwordx4 v[180:183], v2, s[52:55], s12 offen offset:3072 nt
s_add_u32 s13, s13, 24576
s_min_u32 s12, s13, 2146435072
ds_read_b64_tr_b16 a[192:193], v88 offset:144
ds_read_b64_tr_b16 a[194:195], v88 offset:4752
ds_read_b64_tr_b16 a[196:197], v88 offset:37008
ds_read_b64_tr_b16 a[198:199], v88 offset:41616
v_and_b32_dpp v60, v82, v8 row_newbcast:0 row_mask:0xf bank_mask:0xf
v_and_b32_dpp v61, v82, v9 row_newbcast:0 row_mask:0xf bank_mask:0xf
v_and_b32_dpp v62, v82, v10 row_newbcast:0 row_mask:0xf bank_mask:0xf
v_and_b32_dpp v63, v82, v11 row_newbcast:0 row_mask:0xf bank_mask:0xf
v_and_b32_dpp v64, v82, v8 row_newbcast:4 row_mask:0xf bank_mask:0xf
v_and_b32_dpp v65, v82, v9 row_newbcast:4 row_mask:0xf bank_mask:0xf
v_and_b32_dpp v66, v82, v10 row_newbcast:4 row_mask:0xf bank_mask:0xf
v_and_b32_dpp v67, v82, v11 row_newbcast:4 row_mask:0xf bank_mask:0xf
v_and_b32_dpp v68, v82, v8 row_newbcast:8 row_mask:0xf bank_mask:0xf
v_and_b32_dpp v69, v82, v9 row_newbcast:8 row_mask:0xf bank_mask:0xf
v_and_b32_dpp v70, v82, v10 row_newbcast:8 row_mask:0xf bank_mask:0xf
v_and_b32_dpp v71, v82, v11 row_newbcast:8 row_mask:0xf bank_mask:0xf
v_and_b32_dpp v72, v82, v8 row_newbcast:12 row_mask:0xf bank_mask:0xf
v_and_b32_dpp v73, v82, v9 row_newbcast:12 row_mask:0xf bank_mask:0xf
v_and_b32_dpp v74, v82, v10 row_newbcast:12 row_mask:0xf bank_mask:0xf
v_and_b32_dpp v75, v82, v11 row_newbcast:12 row_mask:0xf bank_mask:0xf
s_waitcnt vmcnt(35)
v_mfma_f32_16x16x32_bf16 v[20:23], v[60:63], v[184:187], v[20:23]
v_mfma_f32_16x16x32_bf16 v[20:23], v[64:67], v[188:191], v[20:23]
v_mfma_f32_16x16x32_bf16 v[20:23], v[68:71], v[192:195], v[20:23]
v_mfma_f32_16x16x32_bf16 v[20:23], v[72:75], v[196:199], v[20:23]
v_add_u32 v117, 1, v117
buffer_store_dword v117, v118, s[64:67], 0 offen
buffer_load_dwordx4 v[184:187], v2, s[52:55], s12 offen offset:0 nt
buffer_load_dwordx4 v[188:191], v2, s[52:55], s12 offen offset:1024 nt
buffer_load_dwordx4 v[192:195], v2, s[52:55], s12 offen offset:2048 nt
buffer_load_dwordx4 v[196:199], v2, s[52:55], s12 offen offset:3072 nt
s_add_u32 s13, s13, 24576
s_min_u32 s12, s13, 2146435072
ds_read_b64_tr_b16 a[200:201], v90 offset:144
ds_read_b64_tr_b16 a[202:203], v90 offset:4752
ds_read_b64_tr_b16 a[204:205], v90 offset:37008
ds_read_b64_tr_b16 a[206:207], v90 offset:41616
v_and_b32_dpp v60, v82, v8 row_newbcast:1 row_mask:0xf bank_mask:0xf
v_and_b32_dpp v61, v82, v9 row_newbcast:1 row_mask:0xf bank_mask:0xf
v_and_b32_dpp v62, v82, v10 row_newbcast:1 row_mask:0xf bank_mask:0xf
v_and_b32_dpp v63, v82, v11 row_newbcast:1 row_mask:0xf bank_mask:0xf
v_and_b32_dpp v64, v82, v8 row_newbcast:5 row_mask:0xf bank_mask:0xf
v_and_b32_dpp v65, v82, v9 row_newbcast:5 row_mask:0xf bank_mask:0xf
v_and_b32_dpp v66, v82, v10 row_newbcast:5 row_mask:0xf bank_mask:0xf
v_and_b32_dpp v67, v82, v11 row_newbcast:5 row_mask:0xf bank_mask:0xf
v_and_b32_dpp v68, v82, v8 row_newbcast:9 row_mask:0xf bank_mask:0xf
v_and_b32_dpp v69, v82, v9 row_newbcast:9 row_mask:0xf bank_mask:0xf
v_and_b32_dpp v70, v82, v10 row_newbcast:9 row_mask:0xf bank_mask:0xf
v_and_b32_dpp v71, v82, v11 row_newbcast:9 row_mask:0xf bank_mask:0xf
v_and_b32_dpp v72, v82, v8 row_newbcast:13 row_mask:0xf bank_mask:0xf
v_and_b32_dpp v73, v82, v9 row_newbcast:13 row_mask:0xf bank_mask:0xf
v_and_b32_dpp v74, v82, v10 row_newbcast:13 row_mask:0xf bank_mask:0xf
v_and_b32_dpp v75, v82, v11 row_newbcast:13 row_mask:0xf bank_mask:0xf
s_waitcnt vmcnt(35)
v_mfma_f32_16x16x32_bf16 v[20:23], v[60:63], v[200:203], v[20:23]
v_mfma_f32_16x16x32_bf16 v[20:23], v[64:67], v[204:207], v[20:23]
v_mfma_f32_16x16x32_bf16 v[20:23], v[68:71], v[208:211], v[20:23]
v_mfma_f32_16x16x32_bf16 v[20:23], v[72:75], v[212:215], v[20:23]
v_add_u32 v117, 1, v117
buffer_store_dword v117, v118, s[64:67], 0 offen
buffer_load_dwordx4 v[200:203], v2, s[52:55], s12 offen offset:0 nt
buffer_load_dwordx4 v[204:207], v2, s[52:55], s12 offen offset:1024 nt
buffer_load_dwordx4 v[208:211], v2, s[52:55], s12 offen offset:2048 nt
buffer_load_dwordx4 v[212:215], v2, s[52:55], s12 offen offset:3072 nt
s_add_u32 s13, s13, 24576
s_min_u32 s12, s13, 2146435072
ds_read_b64_tr_b16 a[208:209], v88 offset:152
ds_read_b64_tr_b16 a[210:211], v88 offset:4760
ds_read_b64_tr_b16 a[212:213], v88 offset:37016
ds_read_b64_tr_b16 a[214:215], v88 offset:41624
v_and_b32_dpp v60, v77, v8 row_newbcast:1 row_mask:0xf bank_mask:0xf
v_and_b32_dpp v61, v77, v9 row_newbcast:1 row_mask:0xf bank_mask:0xf
v_and_b32_dpp v62, v77, v10 row_newbcast:1 row_mask:0xf bank_mask:0xf
v_and_b32_dpp v63, v77, v11 row_newbcast:1 row_mask:0xf bank_mask:0xf
v_and_b32_dpp v64, v77, v8 row_newbcast:5 row_mask:0xf bank_mask:0xf
v_and_b32_dpp v65, v77, v9 row_newbcast:5 row_mask:0xf bank_mask:0xf
v_and_b32_dpp v66, v77, v10 row_newbcast:5 row_mask:0xf bank_mask:0xf
v_and_b32_dpp v67, v77, v11 row_newbcast:5 row_mask:0xf bank_mask:0xf
v_and_b32_dpp v68, v77, v8 row_newbcast:9 row_mask:0xf bank_mask:0xf
v_and_b32_dpp v69, v77, v9 row_newbcast:9 row_mask:0xf bank_mask:0xf
v_and_b32_dpp v70, v77, v10 row_newbcast:9 row_mask:0xf bank_mask:0xf
v_and_b32_dpp v71, v77, v11 row_newbcast:9 row_mask:0xf bank_mask:0xf
v_and_b32_dpp v72, v77, v8 row_newbcast:13 row_mask:0xf bank_mask:0xf
v_and_b32_dpp v73, v77, v9 row_newbcast:13 row_mask:0xf bank_mask:0xf
v_and_b32_dpp v74, v77, v10 row_newbcast:13 row_mask:0xf bank_mask:0xf
v_and_b32_dpp v75, v77, v11 row_newbcast:13 row_mask:0xf bank_mask:0xf
v_mfma_f32_16x16x32_bf16 v[20:23], v[60:63], a[64:67], v[20:23]
v_mfma_f32_16x16x32_bf16 v[20:23], v[64:67], a[68:71], v[20:23]
v_mfma_f32_16x16x32_bf16 v[20:23], v[68:71], a[72:75], v[20:23]
v_mfma_f32_16x16x32_bf16 v[20:23], v[72:75], a[76:79], v[20:23]
s_nop 3
v_and_b32_dpp v60, v82, v8 row_newbcast:2 row_mask:0xf bank_mask:0xf
v_and_b32_dpp v61, v82, v9 row_newbcast:2 row_mask:0xf bank_mask:0xf
v_and_b32_dpp v62, v82, v10 row_newbcast:2 row_mask:0xf bank_mask:0xf
v_and_b32_dpp v63, v82, v11 row_newbcast:2 row_mask:0xf bank_mask:0xf
v_and_b32_dpp v64, v82, v8 row_newbcast:6 row_mask:0xf bank_mask:0xf
v_and_b32_dpp v65, v82, v9 row_newbcast:6 row_mask:0xf bank_mask:0xf
v_and_b32_dpp v66, v82, v10 row_newbcast:6 row_mask:0xf bank_mask:0xf
v_and_b32_dpp v67, v82, v11 row_newbcast:6 row_mask:0xf bank_mask:0xf
v_and_b32_dpp v68, v82, v8 row_newbcast:10 row_mask:0xf bank_mask:0xf
v_and_b32_dpp v69, v82, v9 row_newbcast:10 row_mask:0xf bank_mask:0xf
v_and_b32_dpp v70, v82, v10 row_newbcast:10 row_mask:0xf bank_mask:0xf
v_and_b32_dpp v71, v82, v11 row_newbcast:10 row_mask:0xf bank_mask:0xf
v_and_b32_dpp v72, v82, v8 row_newbcast:14 row_mask:0xf bank_mask:0xf
v_and_b32_dpp v73, v82, v9 row_newbcast:14 row_mask:0xf bank_mask:0xf
v_and_b32_dpp v74, v82, v10 row_newbcast:14 row_mask:0xf bank_mask:0xf
v_and_b32_dpp v75, v82, v11 row_newbcast:14 row_mask:0xf bank_mask:0xf
s_waitcnt vmcnt(35)
v_mfma_f32_16x16x32_bf16 v[20:23], v[60:63], v[216:219], v[20:23]
v_mfma_f32_16x16x32_bf16 v[20:23], v[64:67], v[220:223], v[20:23]
v_mfma_f32_16x16x32_bf16 v[20:23], v[68:71], v[224:227], v[20:23]
v_mfma_f32_16x16x32_bf16 v[20:23], v[72:75], v[228:231], v[20:23]
v_add_u32 v117, 1, v117
buffer_store_dword v117, v118, s[64:67], 0 offen
buffer_load_dwordx4 v[216:219], v2, s[52:55], s12 offen offset:0 nt
buffer_load_dwordx4 v[220:223], v2, s[52:55], s12 offen offset:1024 nt
buffer_load_dwordx4 v[224:227], v2, s[52:55], s12 offen offset:2048 nt
buffer_load_dwordx4 v[228:231], v2, s[52:55], s12 offen offset:3072 nt
s_add_u32 s13, s13, 24576
s_min_u32 s12, s13, 2146435072
ds_read_b64_tr_b16 a[216:217], v90 offset:152
ds_read_b64_tr_b16 a[218:219], v90 offset:4760
ds_read_b64_tr_b16 a[220:221], v90 offset:37016
ds_read_b64_tr_b16 a[222:223], v90 offset:41624
v_and_b32_dpp v60, v82, v8 row_newbcast:3 row_mask:0xf bank_mask:0xf
v_and_b32_dpp v61, v82, v9 row_newbcast:3 row_mask:0xf bank_mask:0xf
v_and_b32_dpp v62, v82, v10 row_newbcast:3 row_mask:0xf bank_mask:0xf
v_and_b32_dpp v63, v82, v11 row_newbcast:3 row_mask:0xf bank_mask:0xf
v_and_b32_dpp v64, v82, v8 row_newbcast:7 row_mask:0xf bank_mask:0xf
v_and_b32_dpp v65, v82, v9 row_newbcast:7 row_mask:0xf bank_mask:0xf
v_and_b32_dpp v66, v82, v10 row_newbcast:7 row_mask:0xf bank_mask:0xf
v_and_b32_dpp v67, v82, v11 row_newbcast:7 row_mask:0xf bank_mask:0xf
v_and_b32_dpp v68, v82, v8 row_newbcast:11 row_mask:0xf bank_mask:0xf
v_and_b32_dpp v69, v82, v9 row_newbcast:11 row_mask:0xf bank_mask:0xf
v_and_b32_dpp v70, v82, v10 row_newbcast:11 row_mask:0xf bank_mask:0xf
v_and_b32_dpp v71, v82, v11 row_newbcast:11 row_mask:0xf bank_mask:0xf
v_and_b32_dpp v72, v82, v8 row_newbcast:15 row_mask:0xf bank_mask:0xf
v_and_b32_dpp v73, v82, v9 row_newbcast:15 row_mask:0xf bank_mask:0xf
v_and_b32_dpp v74, v82, v10 row_newbcast:15 row_mask:0xf bank_mask:0xf
v_and_b32_dpp v75, v82, v11 row_newbcast:15 row_mask:0xf bank_mask:0xf
s_waitcnt vmcnt(35)
v_mfma_f32_16x16x32_bf16 v[20:23], v[60:63], v[232:235], v[20:23]
v_mfma_f32_16x16x32_bf16 v[20:23], v[64:67], v[236:239], v[20:23]
v_mfma_f32_16x16x32_bf16 v[20:23], v[68:71], v[240:243], v[20:23]
v_mfma_f32_16x16x32_bf16 v[20:23], v[72:75], v[244:247], v[20:23]
v_add_u32 v117, 1, v117
buffer_store_dword v117, v118, s[64:67], 0 offen
buffer_load_dwordx4 v[232:235], v2, s[52:55], s12 offen offset:0 nt
buffer_load_dwordx4 v[236:239], v2, s[52:55], s12 offen offset:1024 nt
buffer_load_dwordx4 v[240:243], v2, s[52:55], s12 offen offset:2048 nt
buffer_load_dwordx4 v[244:247], v2, s[52:55], s12 offen offset:3072 nt
s_add_u32 s13, s13, 24576
s_min_u32 s12, s13, 2146435072
ds_read_b64_tr_b16 a[224:225], v89 offset:0
ds_read_b64_tr_b16 a[226:227], v89 offset:4608
ds_read_b64_tr_b16 a[228:229], v89 offset:36864
ds_read_b64_tr_b16 a[230:231], v89 offset:41472
buffer_load_dwordx4 v[40:43], off, s[64:67], s82 offset:0 sc1
buffer_load_dwordx4 v[44:47], off, s[64:67], s82 offset:16 sc1
buffer_load_dwordx4 v[48:51], off, s[64:67], s82 offset:32 sc1
v_and_b32_dpp v60, v83, v8 row_newbcast:0 row_mask:0xf bank_mask:0xf
v_and_b32_dpp v61, v83, v9 row_newbcast:0 row_mask:0xf bank_mask:0xf
v_and_b32_dpp v62, v83, v10 row_newbcast:0 row_mask:0xf bank_mask:0xf
v_and_b32_dpp v63, v83, v11 row_newbcast:0 row_mask:0xf bank_mask:0xf
v_and_b32_dpp v64, v83, v8 row_newbcast:4 row_mask:0xf bank_mask:0xf
v_and_b32_dpp v65, v83, v9 row_newbcast:4 row_mask:0xf bank_mask:0xf
v_and_b32_dpp v66, v83, v10 row_newbcast:4 row_mask:0xf bank_mask:0xf
v_and_b32_dpp v67, v83, v11 row_newbcast:4 row_mask:0xf bank_mask:0xf
v_and_b32_dpp v68, v83, v8 row_newbcast:8 row_mask:0xf bank_mask:0xf
v_and_b32_dpp v69, v83, v9 row_newbcast:8 row_mask:0xf bank_mask:0xf
v_and_b32_dpp v70, v83, v10 row_newbcast:8 row_mask:0xf bank_mask:0xf
v_and_b32_dpp v71, v83, v11 row_newbcast:8 row_mask:0xf bank_mask:0xf
v_and_b32_dpp v72, v83, v8 row_newbcast:12 row_mask:0xf bank_mask:0xf
v_and_b32_dpp v73, v83, v9 row_newbcast:12 row_mask:0xf bank_mask:0xf
v_and_b32_dpp v74, v83, v10 row_newbcast:12 row_mask:0xf bank_mask:0xf
v_and_b32_dpp v75, v83, v11 row_newbcast:12 row_mask:0xf bank_mask:0xf
s_waitcnt vmcnt(38)
v_mfma_f32_16x16x32_bf16 v[20:23], v[60:63], v[120:123], v[20:23]
v_mfma_f32_16x16x32_bf16 v[20:23], v[64:67], v[124:127], v[20:23]
v_mfma_f32_16x16x32_bf16 v[20:23], v[68:71], v[128:131], v[20:23]
v_mfma_f32_16x16x32_bf16 v[20:23], v[72:75], v[132:135], v[20:23]
v_add_u32 v117, 1, v117
buffer_store_dword v117, v118, s[64:67], 0 offen
buffer_load_dwordx4 v[120:123], v2, s[52:55], s12 offen offset:0 nt
buffer_load_dwordx4 v[124:127], v2, s[52:55], s12 offen offset:1024 nt
buffer_load_dwordx4 v[128:131], v2, s[52:55], s12 offen offset:2048 nt
buffer_load_dwordx4 v[132:135], v2, s[52:55], s12 offen offset:3072 nt
s_add_u32 s13, s13, 24576
s_min_u32 s12, s13, 2146435072
ds_read_b64_tr_b16 a[232:233], v91 offset:0
ds_read_b64_tr_b16 a[234:235], v91 offset:4608
ds_read_b64_tr_b16 a[236:237], v91 offset:36864
ds_read_b64_tr_b16 a[238:239], v91 offset:41472
v_and_b32_dpp v60, v83, v8 row_newbcast:1 row_mask:0xf bank_mask:0xf
v_and_b32_dpp v61, v83, v9 row_newbcast:1 row_mask:0xf bank_mask:0xf
v_and_b32_dpp v62, v83, v10 row_newbcast:1 row_mask:0xf bank_mask:0xf
v_and_b32_dpp v63, v83, v11 row_newbcast:1 row_mask:0xf bank_mask:0xf
v_and_b32_dpp v64, v83, v8 row_newbcast:5 row_mask:0xf bank_mask:0xf
v_and_b32_dpp v65, v83, v9 row_newbcast:5 row_mask:0xf bank_mask:0xf
v_and_b32_dpp v66, v83, v10 row_newbcast:5 row_mask:0xf bank_mask:0xf
v_and_b32_dpp v67, v83, v11 row_newbcast:5 row_mask:0xf bank_mask:0xf
v_and_b32_dpp v68, v83, v8 row_newbcast:9 row_mask:0xf bank_mask:0xf
v_and_b32_dpp v69, v83, v9 row_newbcast:9 row_mask:0xf bank_mask:0xf
v_and_b32_dpp v70, v83, v10 row_newbcast:9 row_mask:0xf bank_mask:0xf
v_and_b32_dpp v71, v83, v11 row_newbcast:9 row_mask:0xf bank_mask:0xf
v_and_b32_dpp v72, v83, v8 row_newbcast:13 row_mask:0xf bank_mask:0xf
v_and_b32_dpp v73, v83, v9 row_newbcast:13 row_mask:0xf bank_mask:0xf
v_and_b32_dpp v74, v83, v10 row_newbcast:13 row_mask:0xf bank_mask:0xf
v_and_b32_dpp v75, v83, v11 row_newbcast:13 row_mask:0xf bank_mask:0xf
s_waitcnt vmcnt(38)
v_mfma_f32_16x16x32_bf16 v[20:23], v[60:63], v[136:139], v[20:23]
v_mfma_f32_16x16x32_bf16 v[20:23], v[64:67], v[140:143], v[20:23]
v_mfma_f32_16x16x32_bf16 v[20:23], v[68:71], v[144:147], v[20:23]
v_mfma_f32_16x16x32_bf16 v[20:23], v[72:75], v[148:151], v[20:23]
s_nop 3
v_and_b32_dpp v60, v83, v8 row_newbcast:2 row_mask:0xf bank_mask:0xf
v_and_b32_dpp v61, v83, v9 row_newbcast:2 row_mask:0xf bank_mask:0xf
v_and_b32_dpp v62, v83, v10 row_newbcast:2 row_mask:0xf bank_mask:0xf
v_and_b32_dpp v63, v83, v11 row_newbcast:2 row_mask:0xf bank_mask:0xf
v_and_b32_dpp v64, v83, v8 row_newbcast:6 row_mask:0xf bank_mask:0xf
v_and_b32_dpp v65, v83, v9 row_newbcast:6 row_mask:0xf bank_mask:0xf
v_and_b32_dpp v66, v83, v10 row_newbcast:6 row_mask:0xf bank_mask:0xf
v_and_b32_dpp v67, v83, v11 row_newbcast:6 row_mask:0xf bank_mask:0xf
v_and_b32_dpp v68, v83, v8 row_newbcast:10 row_mask:0xf bank_mask:0xf
v_and_b32_dpp v69, v83, v9 row_newbcast:10 row_mask:0xf bank_mask:0xf
v_and_b32_dpp v70, v83, v10 row_newbcast:10 row_mask:0xf bank_mask:0xf
v_and_b32_dpp v71, v83, v11 row_newbcast:10 row_mask:0xf bank_mask:0xf
v_and_b32_dpp v72, v83, v8 row_newbcast:14 row_mask:0xf bank_mask:0xf
v_and_b32_dpp v73, v83, v9 row_newbcast:14 row_mask:0xf bank_mask:0xf
v_and_b32_dpp v74, v83, v10 row_newbcast:14 row_mask:0xf bank_mask:0xf
v_and_b32_dpp v75, v83, v11 row_newbcast:14 row_mask:0xf bank_mask:0xf
s_waitcnt vmcnt(33)
v_mfma_f32_16x16x32_bf16 v[20:23], v[60:63], v[152:155], v[20:23]
v_mfma_f32_16x16x32_bf16 v[20:23], v[64:67], v[156:159], v[20:23]
v_mfma_f32_16x16x32_bf16 v[20:23], v[68:71], v[160:163], v[20:23]
v_mfma_f32_16x16x32_bf16 v[20:23], v[72:75], v[164:167], v[20:23]
v_add_u32 v117, 1, v117
buffer_store_dword v117, v118, s[64:67], 0 offen
buffer_load_dwordx4 v[136:139], v2, s[52:55], s12 offen offset:0 nt
buffer_load_dwordx4 v[140:143], v2, s[52:55], s12 offen offset:1024 nt
buffer_load_dwordx4 v[144:147], v2, s[52:55], s12 offen offset:2048 nt
buffer_load_dwordx4 v[148:151], v2, s[52:55], s12 offen offset:3072 nt
s_add_u32 s13, s13, 24576
s_min_u32 s12, s13, 2146435072
v_and_b32_dpp v60, v77, v8 row_newbcast:2 row_mask:0xf bank_mask:0xf
v_and_b32_dpp v61, v77, v9 row_newbcast:2 row_mask:0xf bank_mask:0xf
v_and_b32_dpp v62, v77, v10 row_newbcast:2 row_mask:0xf bank_mask:0xf
v_and_b32_dpp v63, v77, v11 row_newbcast:2 row_mask:0xf bank_mask:0xf
v_and_b32_dpp v64, v77, v8 row_newbcast:6 row_mask:0xf bank_mask:0xf
v_and_b32_dpp v65, v77, v9 row_newbcast:6 row_mask:0xf bank_mask:0xf
v_and_b32_dpp v66, v77, v10 row_newbcast:6 row_mask:0xf bank_mask:0xf
v_and_b32_dpp v67, v77, v11 row_newbcast:6 row_mask:0xf bank_mask:0xf
v_and_b32_dpp v68, v77, v8 row_newbcast:10 row_mask:0xf bank_mask:0xf
v_and_b32_dpp v69, v77, v9 row_newbcast:10 row_mask:0xf bank_mask:0xf
v_and_b32_dpp v70, v77, v10 row_newbcast:10 row_mask:0xf bank_mask:0xf
v_and_b32_dpp v71, v77, v11 row_newbcast:10 row_mask:0xf bank_mask:0xf
v_and_b32_dpp v72, v77, v8 row_newbcast:14 row_mask:0xf bank_mask:0xf
v_and_b32_dpp v73, v77, v9 row_newbcast:14 row_mask:0xf bank_mask:0xf
v_and_b32_dpp v74, v77, v10 row_newbcast:14 row_mask:0xf bank_mask:0xf
v_and_b32_dpp v75, v77, v11 row_newbcast:14 row_mask:0xf bank_mask:0xf
v_mfma_f32_16x16x32_bf16 v[20:23], v[60:63], a[80:83], v[20:23]
v_mfma_f32_16x16x32_bf16 v[20:23], v[64:67], a[84:87], v[20:23]
v_mfma_f32_16x16x32_bf16 v[20:23], v[68:71], a[88:91], v[20:23]
v_mfma_f32_16x16x32_bf16 v[20:23], v[72:75], a[92:95], v[20:23]
s_nop 3
v_and_b32_dpp v60, v83, v8 row_newbcast:3 row_mask:0xf bank_mask:0xf
v_and_b32_dpp v61, v83, v9 row_newbcast:3 row_mask:0xf bank_mask:0xf
v_and_b32_dpp v62, v83, v10 row_newbcast:3 row_mask:0xf bank_mask:0xf
v_and_b32_dpp v63, v83, v11 row_newbcast:3 row_mask:0xf bank_mask:0xf
v_and_b32_dpp v64, v83, v8 row_newbcast:7 row_mask:0xf bank_mask:0xf
v_and_b32_dpp v65, v83, v9 row_newbcast:7 row_mask:0xf bank_mask:0xf
v_and_b32_dpp v66, v83, v10 row_newbcast:7 row_mask:0xf bank_mask:0xf
v_and_b32_dpp v67, v83, v11 row_newbcast:7 row_mask:0xf bank_mask:0xf
v_and_b32_dpp v68, v83, v8 row_newbcast:11 row_mask:0xf bank_mask:0xf
v_and_b32_dpp v69, v83, v9 row_newbcast:11 row_mask:0xf bank_mask:0xf
v_and_b32_dpp v70, v83, v10 row_newbcast:11 row_mask:0xf bank_mask:0xf
v_and_b32_dpp v71, v83, v11 row_newbcast:11 row_mask:0xf bank_mask:0xf
v_and_b32_dpp v72, v83, v8 row_newbcast:15 row_mask:0xf bank_mask:0xf
v_and_b32_dpp v73, v83, v9 row_newbcast:15 row_mask:0xf bank_mask:0xf
v_and_b32_dpp v74, v83, v10 row_newbcast:15 row_mask:0xf bank_mask:0xf
v_and_b32_dpp v75, v83, v11 row_newbcast:15 row_mask:0xf bank_mask:0xf
s_waitcnt vmcnt(33)
v_mfma_f32_16x16x32_bf16 v[20:23], v[60:63], v[168:171], v[20:23]
v_mfma_f32_16x16x32_bf16 v[20:23], v[64:67], v[172:175], v[20:23]
v_mfma_f32_16x16x32_bf16 v[20:23], v[68:71], v[176:179], v[20:23]
v_mfma_f32_16x16x32_bf16 v[20:23], v[72:75], v[180:183], v[20:23]
s_nop 3
v_and_b32_dpp v60, v84, v8 row_newbcast:0 row_mask:0xf bank_mask:0xf
v_and_b32_dpp v61, v84, v9 row_newbcast:0 row_mask:0xf bank_mask:0xf
v_and_b32_dpp v62, v84, v10 row_newbcast:0 row_mask:0xf bank_mask:0xf
v_and_b32_dpp v63, v84, v11 row_newbcast:0 row_mask:0xf bank_mask:0xf
v_and_b32_dpp v64, v84, v8 row_newbcast:4 row_mask:0xf bank_mask:0xf
v_and_b32_dpp v65, v84, v9 row_newbcast:4 row_mask:0xf bank_mask:0xf
v_and_b32_dpp v66, v84, v10 row_newbcast:4 row_mask:0xf bank_mask:0xf
v_and_b32_dpp v67, v84, v11 row_newbcast:4 row_mask:0xf bank_mask:0xf
v_and_b32_dpp v68, v84, v8 row_newbcast:8 row_mask:0xf bank_mask:0xf
v_and_b32_dpp v69, v84, v9 row_newbcast:8 row_mask:0xf bank_mask:0xf
v_and_b32_dpp v70, v84, v10 row_newbcast:8 row_mask:0xf bank_mask:0xf
v_and_b32_dpp v71, v84, v11 row_newbcast:8 row_mask:0xf bank_mask:0xf
v_and_b32_dpp v72, v84, v8 row_newbcast:12 row_mask:0xf bank_mask:0xf
v_and_b32_dpp v73, v84, v9 row_newbcast:12 row_mask:0xf bank_mask:0xf
v_and_b32_dpp v74, v84, v10 row_newbcast:12 row_mask:0xf bank_mask:0xf
v_and_b32_dpp v75, v84, v11 row_newbcast:12 row_mask:0xf bank_mask:0xf
s_waitcnt vmcnt(28)
v_mfma_f32_16x16x32_bf16 v[20:23], v[60:63], v[184:187], v[20:23]
v_mfma_f32_16x16x32_bf16 v[20:23], v[64:67], v[188:191], v[20:23]
v_mfma_f32_16x16x32_bf16 v[20:23], v[68:71], v[192:195], v[20:23]
v_mfma_f32_16x16x32_bf16 v[20:23], v[72:75], v[196:199], v[20:23]
v_add_u32 v117, 1, v117
buffer_store_dword v117, v118, s[64:67], 0 offen
buffer_load_dwordx4 v[152:155], v2, s[52:55], s12 offen offset:0 nt
buffer_load_dwordx4 v[156:159], v2, s[52:55], s12 offen offset:1024 nt
buffer_load_dwordx4 v[160:163], v2, s[52:55], s12 offen offset:2048 nt
buffer_load_dwordx4 v[164:167], v2, s[52:55], s12 offen offset:3072 nt
s_add_u32 s13, s13, 24576
s_min_u32 s12, s13, 2146435072
v_and_b32_dpp v60, v84, v8 row_newbcast:1 row_mask:0xf bank_mask:0xf
v_and_b32_dpp v61, v84, v9 row_newbcast:1 row_mask:0xf bank_mask:0xf
v_and_b32_dpp v62, v84, v10 row_newbcast:1 row_mask:0xf bank_mask:0xf
v_and_b32_dpp v63, v84, v11 row_newbcast:1 row_mask:0xf bank_mask:0xf
v_and_b32_dpp v64, v84, v8 row_newbcast:5 row_mask:0xf bank_mask:0xf
v_and_b32_dpp v65, v84, v9 row_newbcast:5 row_mask:0xf bank_mask:0xf
v_and_b32_dpp v66, v84, v10 row_newbcast:5 row_mask:0xf bank_mask:0xf
v_and_b32_dpp v67, v84, v11 row_newbcast:5 row_mask:0xf bank_mask:0xf
v_and_b32_dpp v68, v84, v8 row_newbcast:9 row_mask:0xf bank_mask:0xf
v_and_b32_dpp v69, v84, v9 row_newbcast:9 row_mask:0xf bank_mask:0xf
v_and_b32_dpp v70, v84, v10 row_newbcast:9 row_mask:0xf bank_mask:0xf
v_and_b32_dpp v71, v84, v11 row_newbcast:9 row_mask:0xf bank_mask:0xf
v_and_b32_dpp v72, v84, v8 row_newbcast:13 row_mask:0xf bank_mask:0xf
v_and_b32_dpp v73, v84, v9 row_newbcast:13 row_mask:0xf bank_mask:0xf
v_and_b32_dpp v74, v84, v10 row_newbcast:13 row_mask:0xf bank_mask:0xf
v_and_b32_dpp v75, v84, v11 row_newbcast:13 row_mask:0xf bank_mask:0xf
s_waitcnt vmcnt(28)
v_mfma_f32_16x16x32_bf16 v[20:23], v[60:63], v[200:203], v[20:23]
v_mfma_f32_16x16x32_bf16 v[20:23], v[64:67], v[204:207], v[20:23]
v_mfma_f32_16x16x32_bf16 v[20:23], v[68:71], v[208:211], v[20:23]
v_mfma_f32_16x16x32_bf16 v[20:23], v[72:75], v[212:215], v[20:23]
s_nop 3
v_and_b32_dpp v60, v84, v8 row_newbcast:2 row_mask:0xf bank_mask:0xf
v_and_b32_dpp v61, v84, v9 row_newbcast:2 row_mask:0xf bank_mask:0xf
v_and_b32_dpp v62, v84, v10 row_newbcast:2 row_mask:0xf bank_mask:0xf
v_and_b32_dpp v63, v84, v11 row_newbcast:2 row_mask:0xf bank_mask:0xf
v_and_b32_dpp v64, v84, v8 row_newbcast:6 row_mask:0xf bank_mask:0xf
v_and_b32_dpp v65, v84, v9 row_newbcast:6 row_mask:0xf bank_mask:0xf
v_and_b32_dpp v66, v84, v10 row_newbcast:6 row_mask:0xf bank_mask:0xf
v_and_b32_dpp v67, v84, v11 row_newbcast:6 row_mask:0xf bank_mask:0xf
v_and_b32_dpp v68, v84, v8 row_newbcast:10 row_mask:0xf bank_mask:0xf
v_and_b32_dpp v69, v84, v9 row_newbcast:10 row_mask:0xf bank_mask:0xf
v_and_b32_dpp v70, v84, v10 row_newbcast:10 row_mask:0xf bank_mask:0xf
v_and_b32_dpp v71, v84, v11 row_newbcast:10 row_mask:0xf bank_mask:0xf
v_and_b32_dpp v72, v84, v8 row_newbcast:14 row_mask:0xf bank_mask:0xf
v_and_b32_dpp v73, v84, v9 row_newbcast:14 row_mask:0xf bank_mask:0xf
v_and_b32_dpp v74, v84, v10 row_newbcast:14 row_mask:0xf bank_mask:0xf
v_and_b32_dpp v75, v84, v11 row_newbcast:14 row_mask:0xf bank_mask:0xf
s_waitcnt vmcnt(23)
v_mfma_f32_16x16x32_bf16 v[20:23], v[60:63], v[216:219], v[20:23]
v_mfma_f32_16x16x32_bf16 v[20:23], v[64:67], v[220:223], v[20:23]
v_mfma_f32_16x16x32_bf16 v[20:23], v[68:71], v[224:227], v[20:23]
v_mfma_f32_16x16x32_bf16 v[20:23], v[72:75], v[228:231], v[20:23]
v_add_u32 v117, 1, v117
buffer_store_dword v117, v118, s[64:67], 0 offen
buffer_load_dwordx4 v[168:171], v2, s[52:55], s12 offen offset:0 nt
buffer_load_dwordx4 v[172:175], v2, s[52:55], s12 offen offset:1024 nt
buffer_load_dwordx4 v[176:179], v2, s[52:55], s12 offen offset:2048 nt
buffer_load_dwordx4 v[180:183], v2, s[52:55], s12 offen offset:3072 nt
s_add_u32 s13, s13, 24576
s_min_u32 s12, s13, 2146435072
v_and_b32_dpp v60, v84, v8 row_newbcast:3 row_mask:0xf bank_mask:0xf
v_and_b32_dpp v61, v84, v9 row_newbcast:3 row_mask:0xf bank_mask:0xf
v_and_b32_dpp v62, v84, v10 row_newbcast:3 row_mask:0xf bank_mask:0xf
v_and_b32_dpp v63, v84, v11 row_newbcast:3 row_mask:0xf bank_mask:0xf
v_and_b32_dpp v64, v84, v8 row_newbcast:7 row_mask:0xf bank_mask:0xf
v_and_b32_dpp v65, v84, v9 row_newbcast:7 row_mask:0xf bank_mask:0xf
v_and_b32_dpp v66, v84, v10 row_newbcast:7 row_mask:0xf bank_mask:0xf
v_and_b32_dpp v67, v84, v11 row_newbcast:7 row_mask:0xf bank_mask:0xf
v_and_b32_dpp v68, v84, v8 row_newbcast:11 row_mask:0xf bank_mask:0xf
v_and_b32_dpp v69, v84, v9 row_newbcast:11 row_mask:0xf bank_mask:0xf
v_and_b32_dpp v70, v84, v10 row_newbcast:11 row_mask:0xf bank_mask:0xf
v_and_b32_dpp v71, v84, v11 row_newbcast:11 row_mask:0xf bank_mask:0xf
v_and_b32_dpp v72, v84, v8 row_newbcast:15 row_mask:0xf bank_mask:0xf
v_and_b32_dpp v73, v84, v9 row_newbcast:15 row_mask:0xf bank_mask:0xf
v_and_b32_dpp v74, v84, v10 row_newbcast:15 row_mask:0xf bank_mask:0xf
v_and_b32_dpp v75, v84, v11 row_newbcast:15 row_mask:0xf bank_mask:0xf
s_waitcnt vmcnt(23)
v_mfma_f32_16x16x32_bf16 v[20:23], v[60:63], v[232:235], v[20:23]
v_mfma_f32_16x16x32_bf16 v[20:23], v[64:67], v[236:239], v[20:23]
v_mfma_f32_16x16x32_bf16 v[20:23], v[68:71], v[240:243], v[20:23]
v_mfma_f32_16x16x32_bf16 v[20:23], v[72:75], v[244:247], v[20:23]
s_nop 3
v_and_b32_dpp v60, v85, v8 row_newbcast:0 row_mask:0xf bank_mask:0xf
v_and_b32_dpp v61, v85, v9 row_newbcast:0 row_mask:0xf bank_mask:0xf
v_and_b32_dpp v62, v85, v10 row_newbcast:0 row_mask:0xf bank_mask:0xf
v_and_b32_dpp v63, v85, v11 row_newbcast:0 row_mask:0xf bank_mask:0xf
v_and_b32_dpp v64, v85, v8 row_newbcast:4 row_mask:0xf bank_mask:0xf
v_and_b32_dpp v65, v85, v9 row_newbcast:4 row_mask:0xf bank_mask:0xf
v_and_b32_dpp v66, v85, v10 row_newbcast:4 row_mask:0xf bank_mask:0xf
v_and_b32_dpp v67, v85, v11 row_newbcast:4 row_mask:0xf bank_mask:0xf
v_and_b32_dpp v68, v85, v8 row_newbcast:8 row_mask:0xf bank_mask:0xf
v_and_b32_dpp v69, v85, v9 row_newbcast:8 row_mask:0xf bank_mask:0xf
v_and_b32_dpp v70, v85, v10 row_newbcast:8 row_mask:0xf bank_mask:0xf
v_and_b32_dpp v71, v85, v11 row_newbcast:8 row_mask:0xf bank_mask:0xf
v_and_b32_dpp v72, v85, v8 row_newbcast:12 row_mask:0xf bank_mask:0xf
v_and_b32_dpp v73, v85, v9 row_newbcast:12 row_mask:0xf bank_mask:0xf
v_and_b32_dpp v74, v85, v10 row_newbcast:12 row_mask:0xf bank_mask:0xf
v_and_b32_dpp v75, v85, v11 row_newbcast:12 row_mask:0xf bank_mask:0xf
s_waitcnt vmcnt(15)
v_mfma_f32_16x16x32_bf16 v[20:23], v[60:63], v[120:123], v[20:23]
v_mfma_f32_16x16x32_bf16 v[20:23], v[64:67], v[124:127], v[20:23]
v_mfma_f32_16x16x32_bf16 v[20:23], v[68:71], v[128:131], v[20:23]
v_mfma_f32_16x16x32_bf16 v[20:23], v[72:75], v[132:135], v[20:23]
v_add_u32 v117, 1, v117
buffer_store_dword v117, v118, s[64:67], 0 offen
buffer_load_dwordx4 v[184:187], v2, s[52:55], s12 offen offset:0 nt
buffer_load_dwordx4 v[188:191], v2, s[52:55], s12 offen offset:1024 nt
buffer_load_dwordx4 v[192:195], v2, s[52:55], s12 offen offset:2048 nt
buffer_load_dwordx4 v[196:199], v2, s[52:55], s12 offen offset:3072 nt
s_add_u32 s13, s13, 24576
s_min_u32 s12, s13, 2146435072
s_mov_b32 s7, 400000
A_ev2_chk:
v_max3_u32 v35, v40, v41, v42
v_max3_u32 v35, v35, v43, v44
v_max3_u32 v35, v35, v45, v46
v_max3_u32 v35, v35, v47, v48
v_max3_u32 v35, v35, v49, v50
v_max_u32 v35, v35, v51
v_cmp_eq_u32 vcc, -1, v35
s_cbranch_vccz A_ev2_ok
buffer_load_dwordx4 v[40:43], off, s[64:67], s82 offset:0 sc1
buffer_load_dwordx4 v[44:47], off, s[64:67], s82 offset:16 sc1
buffer_load_dwordx4 v[48:51], off, s[64:67], s82 offset:32 sc1
s_waitcnt vmcnt(0)
s_sub_u32 s7, s7, 1
s_cmp_lg_u32 s7, 0
s_cbranch_scc1 A_ev2_chk
A_ev2_ok:
v_max3_f32 v35, v40, v42, v44
v_max3_f32 v36, v46, v48, v50
v_max_f32 v35, v35, v36
v_sub_f32 v40, v40, v35
v_sub_f32 v42, v42, v35
v_sub_f32 v44, v44, v35
v_sub_f32 v46, v46, v35
v_sub_f32 v48, v48, v35
v_sub_f32 v50, v50, v35
v_sub_f32 v37, v32, v35
v_exp_f32 v40, v40
v_exp_f32 v42, v42
v_exp_f32 v44, v44
v_exp_f32 v46, v46
v_exp_f32 v48, v48
v_exp_f32 v50, v50
v_exp_f32 v37, v37
v_mul_f32 v35, v40, v41
v_fma_f32 v35, v42, v43, v35
v_fma_f32 v35, v44, v45, v35
v_fma_f32 v35, v46, v47, v35
v_fma_f32 v35, v48, v49, v35
v_fma_f32 v35, v50, v51, v35
v_rcp_f32 v35, v35
s_nop 0
v_mul_f32 v37, v37, v35
v_and_b32_dpp v60, v85, v8 row_newbcast:1 row_mask:0xf bank_mask:0xf
v_and_b32_dpp v61, v85, v9 row_newbcast:1 row_mask:0xf bank_mask:0xf
v_and_b32_dpp v62, v85, v10 row_newbcast:1 row_mask:0xf bank_mask:0xf
v_and_b32_dpp v63, v85, v11 row_newbcast:1 row_mask:0xf bank_mask:0xf
v_and_b32_dpp v64, v85, v8 row_newbcast:5 row_mask:0xf bank_mask:0xf
v_and_b32_dpp v65, v85, v9 row_newbcast:5 row_mask:0xf bank_mask:0xf
v_and_b32_dpp v66, v85, v10 row_newbcast:5 row_mask:0xf bank_mask:0xf
v_and_b32_dpp v67, v85, v11 row_newbcast:5 row_mask:0xf bank_mask:0xf
v_and_b32_dpp v68, v85, v8 row_newbcast:9 row_mask:0xf bank_mask:0xf
v_and_b32_dpp v69, v85, v9 row_newbcast:9 row_mask:0xf bank_mask:0xf
v_and_b32_dpp v70, v85, v10 row_newbcast:9 row_mask:0xf bank_mask:0xf
v_and_b32_dpp v71, v85, v11 row_newbcast:9 row_mask:0xf bank_mask:0xf
v_and_b32_dpp v72, v85, v8 row_newbcast:13 row_mask:0xf bank_mask:0xf
v_and_b32_dpp v73, v85, v9 row_newbcast:13 row_mask:0xf bank_mask:0xf
v_and_b32_dpp v74, v85, v10 row_newbcast:13 row_mask:0xf bank_mask:0xf
v_and_b32_dpp v75, v85, v11 row_newbcast:13 row_mask:0xf bank_mask:0xf
s_waitcnt vmcnt(15)
v_mfma_f32_16x16x32_bf16 v[20:23], v[60:63], v[136:139], v[20:23]
v_mfma_f32_16x16x32_bf16 v[20:23], v[64:67], v[140:143], v[20:23]
v_mfma_f32_16x16x32_bf16 v[20:23], v[68:71], v[144:147], v[20:23]
v_mfma_f32_16x16x32_bf16 v[20:23], v[72:75], v[148:151], v[20:23]
v_add_u32 v117, 1, v117
buffer_store_dword v117, v118, s[64:67], 0 offen
buffer_load_dwordx4 v[200:203], v2, s[52:55], s12 offen offset:0 nt
buffer_load_dwordx4 v[204:207], v2, s[52:55], s12 offen offset:1024 nt
buffer_load_dwordx4 v[208:211], v2, s[52:55], s12 offen offset:2048 nt
buffer_load_dwordx4 v[212:215], v2, s[52:55], s12 offen offset:3072 nt
s_add_u32 s13, s13, 24576
s_min_u32 s12, s13, 2146435072
v_and_b32_dpp v60, v77, v8 row_newbcast:3 row_mask:0xf bank_mask:0xf
v_and_b32_dpp v61, v77, v9 row_newbcast:3 row_mask:0xf bank_mask:0xf
v_and_b32_dpp v62, v77, v10 row_newbcast:3 row_mask:0xf bank_mask:0xf
v_and_b32_dpp v63, v77, v11 row_newbcast:3 row_mask:0xf bank_mask:0xf
v_and_b32_dpp v64, v77, v8 row_newbcast:7 row_mask:0xf bank_mask:0xf
v_and_b32_dpp v65, v77, v9 row_newbcast:7 row_mask:0xf bank_mask:0xf
v_and_b32_dpp v66, v77, v10 row_newbcast:7 row_mask:0xf bank_mask:0xf
v_and_b32_dpp v67, v77, v11 row_newbcast:7 row_mask:0xf bank_mask:0xf
v_and_b32_dpp v68, v77, v8 row_newbcast:11 row_mask:0xf bank_mask:0xf
v_and_b32_dpp v69, v77, v9 row_newbcast:11 row_mask:0xf bank_mask:0xf
v_and_b32_dpp v70, v77, v10 row_newbcast:11 row_mask:0xf bank_mask:0xf
v_and_b32_dpp v71, v77, v11 row_newbcast:11 row_mask:0xf bank_mask:0xf
v_and_b32_dpp v72, v77, v8 row_newbcast:15 row_mask:0xf bank_mask:0xf
v_and_b32_dpp v73, v77, v9 row_newbcast:15 row_mask:0xf bank_mask:0xf
v_and_b32_dpp v74, v77, v10 row_newbcast:15 row_mask:0xf bank_mask:0xf
v_and_b32_dpp v75, v77, v11 row_newbcast:15 row_mask:0xf bank_mask:0xf
v_mfma_f32_16x16x32_bf16 v[20:23], v[60:63], a[240:243], v[20:23]
v_mfma_f32_16x16x32_bf16 v[20:23], v[64:67], a[244:247], v[20:23]
v_mfma_f32_16x16x32_bf16 v[20:23], v[68:71], a[248:251], v[20:23]
v_mfma_f32_16x16x32_bf16 v[20:23], v[72:75], a[252:255], v[20:23]
s_nop 3
v_and_b32_dpp v60, v85, v8 row_newbcast:2 row_mask:0xf bank_mask:0xf
v_and_b32_dpp v61, v85, v9 row_newbcast:2 row_mask:0xf bank_mask:0xf
v_and_b32_dpp v62, v85, v10 row_newbcast:2 row_mask:0xf bank_mask:0xf
v_and_b32_dpp v63, v85, v11 row_newbcast:2 row_mask:0xf bank_mask:0xf
v_and_b32_dpp v64, v85, v8 row_newbcast:6 row_mask:0xf bank_mask:0xf
v_and_b32_dpp v65, v85, v9 row_newbcast:6 row_mask:0xf bank_mask:0xf
v_and_b32_dpp v66, v85, v10 row_newbcast:6 row_mask:0xf bank_mask:0xf
v_and_b32_dpp v67, v85, v11 row_newbcast:6 row_mask:0xf bank_mask:0xf
v_and_b32_dpp v68, v85, v8 row_newbcast:10 row_mask:0xf bank_mask:0xf
v_and_b32_dpp v69, v85, v9 row_newbcast:10 row_mask:0xf bank_mask:0xf
v_and_b32_dpp v70, v85, v10 row_newbcast:10 row_mask:0xf bank_mask:0xf
v_and_b32_dpp v71, v85, v11 row_newbcast:10 row_mask:0xf bank_mask:0xf
v_and_b32_dpp v72, v85, v8 row_newbcast:14 row_mask:0xf bank_mask:0xf
v_and_b32_dpp v73, v85, v9 row_newbcast:14 row_mask:0xf bank_mask:0xf
v_and_b32_dpp v74, v85, v10 row_newbcast:14 row_mask:0xf bank_mask:0xf
v_and_b32_dpp v75, v85, v11 row_newbcast:14 row_mask:0xf bank_mask:0xf
s_waitcnt vmcnt(15)
v_mfma_f32_16x16x32_bf16 v[20:23], v[60:63], v[152:155], v[20:23]
v_mfma_f32_16x16x32_bf16 v[20:23], v[64:67], v[156:159], v[20:23]
v_mfma_f32_16x16x32_bf16 v[20:23], v[68:71], v[160:163], v[20:23]
v_mfma_f32_16x16x32_bf16 v[20:23], v[72:75], v[164:167], v[20:23]
v_add_u32 v117, 1, v117
buffer_store_dword v117, v118, s[64:67], 0 offen
buffer_load_dwordx4 v[216:219], v2, s[52:55], s12 offen offset:0 nt
buffer_load_dwordx4 v[220:223], v2, s[52:55], s12 offen offset:1024 nt
buffer_load_dwordx4 v[224:227], v2, s[52:55], s12 offen offset:2048 nt
buffer_load_dwordx4 v[228:231], v2, s[52:55], s12 offen offset:3072 nt
s_add_u32 s13, s13, 24576
s_min_u32 s12, s13, 2146435072
v_and_b32_dpp v60, v85, v8 row_newbcast:3 row_mask:0xf bank_mask:0xf
v_and_b32_dpp v61, v85, v9 row_newbcast:3 row_mask:0xf bank_mask:0xf
v_and_b32_dpp v62, v85, v10 row_newbcast:3 row_mask:0xf bank_mask:0xf
v_and_b32_dpp v63, v85, v11 row_newbcast:3 row_mask:0xf bank_mask:0xf
v_and_b32_dpp v64, v85, v8 row_newbcast:7 row_mask:0xf bank_mask:0xf
v_and_b32_dpp v65, v85, v9 row_newbcast:7 row_mask:0xf bank_mask:0xf
v_and_b32_dpp v66, v85, v10 row_newbcast:7 row_mask:0xf bank_mask:0xf
v_and_b32_dpp v67, v85, v11 row_newbcast:7 row_mask:0xf bank_mask:0xf
v_and_b32_dpp v68, v85, v8 row_newbcast:11 row_mask:0xf bank_mask:0xf
v_and_b32_dpp v69, v85, v9 row_newbcast:11 row_mask:0xf bank_mask:0xf
v_and_b32_dpp v70, v85, v10 row_newbcast:11 row_mask:0xf bank_mask:0xf
v_and_b32_dpp v71, v85, v11 row_newbcast:11 row_mask:0xf bank_mask:0xf
v_and_b32_dpp v72, v85, v8 row_newbcast:15 row_mask:0xf bank_mask:0xf
v_and_b32_dpp v73, v85, v9 row_newbcast:15 row_mask:0xf bank_mask:0xf
v_and_b32_dpp v74, v85, v10 row_newbcast:15 row_mask:0xf bank_mask:0xf
v_and_b32_dpp v75, v85, v11 row_newbcast:15 row_mask:0xf bank_mask:0xf
s_waitcnt vmcnt(15)
v_mfma_f32_16x16x32_bf16 v[20:23], v[60:63], v[168:171], v[20:23]
v_mfma_f32_16x16x32_bf16 v[20:23], v[64:67], v[172:175], v[20:23]
v_mfma_f32_16x16x32_bf16 v[20:23], v[68:71], v[176:179], v[20:23]
v_mfma_f32_16x16x32_bf16 v[20:23], v[72:75], v[180:183], v[20:23]
v_add_u32 v117, 1, v117
buffer_store_dword v117, v118, s[64:67], 0 offen
buffer_load_dwordx4 v[232:235], v2, s[52:55], s12 offen offset:0 nt
buffer_load_dwordx4 v[236:239], v2, s[52:55], s12 offen offset:1024 nt
buffer_load_dwordx4 v[240:243], v2, s[52:55], s12 offen offset:2048 nt
buffer_load_dwordx4 v[244:247], v2, s[52:55], s12 offen offset:3072 nt
s_add_u32 s13, s13, 24576
s_min_u32 s12, s13, 2146435072
v_and_b32_dpp v60, v86, v8 row_newbcast:0 row_mask:0xf bank_mask:0xf
v_and_b32_dpp v61, v86, v9 row_newbcast:0 row_mask:0xf bank_mask:0xf
v_and_b32_dpp v62, v86, v10 row_newbcast:0 row_mask:0xf bank_mask:0xf
v_and_b32_dpp v63, v86, v11 row_newbcast:0 row_mask:0xf bank_mask:0xf
v_and_b32_dpp v64, v86, v8 row_newbcast:4 row_mask:0xf bank_mask:0xf
v_and_b32_dpp v65, v86, v9 row_newbcast:4 row_mask:0xf bank_mask:0xf
v_and_b32_dpp v66, v86, v10 row_newbcast:4 row_mask:0xf bank_mask:0xf
v_and_b32_dpp v67, v86, v11 row_newbcast:4 row_mask:0xf bank_mask:0xf
v_and_b32_dpp v68, v86, v8 row_newbcast:8 row_mask:0xf bank_mask:0xf
v_and_b32_dpp v69, v86, v9 row_newbcast:8 row_mask:0xf bank_mask:0xf
v_and_b32_dpp v70, v86, v10 row_newbcast:8 row_mask:0xf bank_mask:0xf
v_and_b32_dpp v71, v86, v11 row_newbcast:8 row_mask:0xf bank_mask:0xf
v_and_b32_dpp v72, v86, v8 row_newbcast:12 row_mask:0xf bank_mask:0xf
v_and_b32_dpp v73, v86, v9 row_newbcast:12 row_mask:0xf bank_mask:0xf
v_and_b32_dpp v74, v86, v10 row_newbcast:12 row_mask:0xf bank_mask:0xf
v_and_b32_dpp v75, v86, v11 row_newbcast:12 row_mask:0xf bank_mask:0xf
s_waitcnt vmcnt(15)
v_mfma_f32_16x16x32_bf16 v[20:23], v[60:63], v[184:187], v[20:23]
v_mfma_f32_16x16x32_bf16 v[20:23], v[64:67], v[188:191], v[20:23]
v_mfma_f32_16x16x32_bf16 v[20:23], v[68:71], v[192:195], v[20:23]
v_mfma_f32_16x16x32_bf16 v[20:23], v[72:75], v[196:199], v[20:23]
s_nop 3
v_and_b32_dpp v60, v86, v8 row_newbcast:1 row_mask:0xf bank_mask:0xf
v_and_b32_dpp v61, v86, v9 row_newbcast:1 row_mask:0xf bank_mask:0xf
v_and_b32_dpp v62, v86, v10 row_newbcast:1 row_mask:0xf bank_mask:0xf
v_and_b32_dpp v63, v86, v11 row_newbcast:1 row_mask:0xf bank_mask:0xf
v_and_b32_dpp v64, v86, v8 row_newbcast:5 row_mask:0xf bank_mask:0xf
v_and_b32_dpp v65, v86, v9 row_newbcast:5 row_mask:0xf bank_mask:0xf
v_and_b32_dpp v66, v86, v10 row_newbcast:5 row_mask:0xf bank_mask:0xf
v_and_b32_dpp v67, v86, v11 row_newbcast:5 row_mask:0xf bank_mask:0xf
v_and_b32_dpp v68, v86, v8 row_newbcast:9 row_mask:0xf bank_mask:0xf
v_and_b32_dpp v69, v86, v9 row_newbcast:9 row_mask:0xf bank_mask:0xf
v_and_b32_dpp v70, v86, v10 row_newbcast:9 row_mask:0xf bank_mask:0xf
v_and_b32_dpp v71, v86, v11 row_newbcast:9 row_mask:0xf bank_mask:0xf
v_and_b32_dpp v72, v86, v8 row_newbcast:13 row_mask:0xf bank_mask:0xf
v_and_b32_dpp v73, v86, v9 row_newbcast:13 row_mask:0xf bank_mask:0xf
v_and_b32_dpp v74, v86, v10 row_newbcast:13 row_mask:0xf bank_mask:0xf
v_and_b32_dpp v75, v86, v11 row_newbcast:13 row_mask:0xf bank_mask:0xf
s_waitcnt vmcnt(10)
v_mfma_f32_16x16x32_bf16 v[20:23], v[60:63], v[200:203], v[20:23]
v_mfma_f32_16x16x32_bf16 v[20:23], v[64:67], v[204:207], v[20:23]
v_mfma_f32_16x16x32_bf16 v[20:23], v[68:71], v[208:211], v[20:23]
v_mfma_f32_16x16x32_bf16 v[20:23], v[72:75], v[212:215], v[20:23]
s_nop 3
v_and_b32_dpp v60, v86, v8 row_newbcast:2 row_mask:0xf bank_mask:0xf
v_and_b32_dpp v61, v86, v9 row_newbcast:2 row_mask:0xf bank_mask:0xf
v_and_b32_dpp v62, v86, v10 row_newbcast:2 row_mask:0xf bank_mask:0xf
v_and_b32_dpp v63, v86, v11 row_newbcast:2 row_mask:0xf bank_mask:0xf
v_and_b32_dpp v64, v86, v8 row_newbcast:6 row_mask:0xf bank_mask:0xf
v_and_b32_dpp v65, v86, v9 row_newbcast:6 row_mask:0xf bank_mask:0xf
v_and_b32_dpp v66, v86, v10 row_newbcast:6 row_mask:0xf bank_mask:0xf
v_and_b32_dpp v67, v86, v11 row_newbcast:6 row_mask:0xf bank_mask:0xf
v_and_b32_dpp v68, v86, v8 row_newbcast:10 row_mask:0xf bank_mask:0xf
v_and_b32_dpp v69, v86, v9 row_newbcast:10 row_mask:0xf bank_mask:0xf
v_and_b32_dpp v70, v86, v10 row_newbcast:10 row_mask:0xf bank_mask:0xf
v_and_b32_dpp v71, v86, v11 row_newbcast:10 row_mask:0xf bank_mask:0xf
v_and_b32_dpp v72, v86, v8 row_newbcast:14 row_mask:0xf bank_mask:0xf
v_and_b32_dpp v73, v86, v9 row_newbcast:14 row_mask:0xf bank_mask:0xf
v_and_b32_dpp v74, v86, v10 row_newbcast:14 row_mask:0xf bank_mask:0xf
v_and_b32_dpp v75, v86, v11 row_newbcast:14 row_mask:0xf bank_mask:0xf
v_and_b32_dpp v184, v86, v8 row_newbcast:3 row_mask:0xf bank_mask:0xf
v_and_b32_dpp v185, v86, v9 row_newbcast:3 row_mask:0xf bank_mask:0xf
v_and_b32_dpp v186, v86, v10 row_newbcast:3 row_mask:0xf bank_mask:0xf
v_and_b32_dpp v187, v86, v11 row_newbcast:3 row_mask:0xf bank_mask:0xf
v_and_b32_dpp v188, v86, v8 row_newbcast:7 row_mask:0xf bank_mask:0xf
v_and_b32_dpp v189, v86, v9 row_newbcast:7 row_mask:0xf bank_mask:0xf
v_and_b32_dpp v190, v86, v10 row_newbcast:7 row_mask:0xf bank_mask:0xf
v_and_b32_dpp v191, v86, v11 row_newbcast:7 row_mask:0xf bank_mask:0xf
v_and_b32_dpp v192, v86, v8 row_newbcast:11 row_mask:0xf bank_mask:0xf
v_and_b32_dpp v193, v86, v9 row_newbcast:11 row_mask:0xf bank_mask:0xf
v_and_b32_dpp v194, v86, v10 row_newbcast:11 row_mask:0xf bank_mask:0xf
v_and_b32_dpp v195, v86, v11 row_newbcast:11 row_mask:0xf bank_mask:0xf
v_and_b32_dpp v196, v86, v8 row_newbcast:15 row_mask:0xf bank_mask:0xf
v_and_b32_dpp v197, v86, v9 row_newbcast:15 row_mask:0xf bank_mask:0xf
v_and_b32_dpp v198, v86, v10 row_newbcast:15 row_mask:0xf bank_mask:0xf
v_and_b32_dpp v199, v86, v11 row_newbcast:15 row_mask:0xf bank_mask:0xf
s_waitcnt vmcnt(5)
v_mfma_f32_16x16x32_bf16 v[20:23], v[60:63], v[216:219], v[20:23]
v_mfma_f32_16x16x32_bf16 v[20:23], v[64:67], v[220:223], v[20:23]
v_mfma_f32_16x16x32_bf16 v[20:23], v[68:71], v[224:227], v[20:23]
v_mfma_f32_16x16x32_bf16 v[20:23], v[72:75], v[228:231], v[20:23]
s_waitcnt vmcnt(3)
v_mfma_f32_16x16x32_bf16 v[20:23], v[184:187], v[232:235], v[20:23]
s_waitcnt vmcnt(2)
v_mfma_f32_16x16x32_bf16 v[20:23], v[188:191], v[236:239], v[20:23]
s_waitcnt vmcnt(1)
v_mfma_f32_16x16x32_bf16 v[20:23], v[192:195], v[240:243], v[20:23]
s_waitcnt vmcnt(0)
v_mfma_f32_16x16x32_bf16 v[20:23], v[196:199], v[244:247], v[20:23]
A_tail:
s_nop 7
v_mul_f32 v20, v20, v37
v_mul_f32 v21, v21, v37
v_mul_f32 v22, v22, v37
v_mul_f32 v23, v23, v37
v_cvt_pk_bf16_f32 v28, v20, v21
v_cvt_pk_bf16_f32 v29, v22, v23
ds_write_b64 v94, v[28:29]
s_waitcnt lgkmcnt(0)
s_barrier
ds_read_b128 a[0:3], v95 offset:0
ds_read_b128 a[4:7], v95 offset:64
ds_read_b128 a[8:11], v95 offset:128
ds_read_b128 a[12:15], v95 offset:192
s_waitcnt lgkmcnt(0)
v_mfma_f32_16x16x32_bf16 v[72:75], a[0:3], a[224:227], 0
v_mfma_f32_16x16x32_bf16 v[72:75], a[4:7], a[228:231], v[72:75]
v_mfma_f32_16x16x32_bf16 v[72:75], a[8:11], a[232:235], v[72:75]
v_mfma_f32_16x16x32_bf16 v[72:75], a[12:15], a[236:239], v[72:75]
v_mfma_f32_16x16x32_bf16 v[40:43], a[0:3], a[96:99], 0
v_mfma_f32_16x16x32_bf16 v[40:43], a[4:7], a[100:103], v[40:43]
v_mfma_f32_16x16x32_bf16 v[40:43], a[8:11], a[104:107], v[40:43]
v_mfma_f32_16x16x32_bf16 v[40:43], a[12:15], a[108:111], v[40:43]
v_mfma_f32_16x16x32_bf16 v[44:47], a[0:3], a[112:115], 0
v_mfma_f32_16x16x32_bf16 v[44:47], a[4:7], a[116:119], v[44:47]
v_mfma_f32_16x16x32_bf16 v[44:47], a[8:11], a[120:123], v[44:47]
v_mfma_f32_16x16x32_bf16 v[44:47], a[12:15], a[124:127], v[44:47]
v_mul_f32 v114, v106, v72
v_fma_f32 v114, v107, v73, v114
v_fma_f32 v114, v108, v74, v114
v_fma_f32 v114, v109, v75, v114
v_mfma_f32_16x16x32_bf16 v[48:51], a[0:3], a[128:131], 0
v_mfma_f32_16x16x32_bf16 v[48:51], a[4:7], a[132:135], v[48:51]
v_mfma_f32_16x16x32_bf16 v[48:51], a[8:11], a[136:139], v[48:51]
v_mfma_f32_16x16x32_bf16 v[48:51], a[12:15], a[140:143], v[48:51]
v_min_u32 v114, -2, v114
s_mov_b64 exec, 0xffffffff
buffer_store_dword v114, v93, s[64:67], 0 offen offset:512 sc1
s_mov_b64 exec, -1
v_mul_f32 v110, v98, v40
v_fma_f32 v110, v99, v41, v110
v_fma_f32 v110, v100, v42, v110
v_fma_f32 v110, v101, v43, v110
v_mfma_f32_16x16x32_bf16 v[52:55], a[0:3], a[144:147], 0
v_mfma_f32_16x16x32_bf16 v[52:55], a[4:7], a[148:151], v[52:55]
v_mfma_f32_16x16x32_bf16 v[52:55], a[8:11], a[152:155], v[52:55]
v_mfma_f32_16x16x32_bf16 v[52:55], a[12:15], a[156:159], v[52:55]
v_mul_f32 v111, v98, v44
v_fma_f32 v111, v99, v45, v111
v_fma_f32 v111, v100, v46, v111
v_fma_f32 v111, v101, v47, v111
v_mfma_f32_16x16x32_bf16 v[56:59], a[0:3], a[160:163], 0
v_mfma_f32_16x16x32_bf16 v[56:59], a[4:7], a[164:167], v[56:59]
v_mfma_f32_16x16x32_bf16 v[56:59], a[8:11], a[168:171], v[56:59]
v_mfma_f32_16x16x32_bf16 v[56:59], a[12:15], a[172:175], v[56:59]
v_mul_f32 v112, v98, v48
v_fma_f32 v112, v99, v49, v112
v_fma_f32 v112, v100, v50, v112
v_fma_f32 v112, v101, v51, v112
v_mfma_f32_16x16x32_bf16 v[60:63], a[0:3], a[176:179], 0
v_mfma_f32_16x16x32_bf16 v[60:63], a[4:7], a[180:183], v[60:63]
v_mfma_f32_16x16x32_bf16 v[60:63], a[8:11], a[184:187], v[60:63]
v_mfma_f32_16x16x32_bf16 v[60:63], a[12:15], a[188:191], v[60:63]
v_mul_f32 v113, v98, v52
v_fma_f32 v113, v99, v53, v113
v_fma_f32 v113, v100, v54, v113
v_fma_f32 v113, v101, v55, v113
v_mfma_f32_16x16x32_bf16 v[64:67], a[0:3], a[192:195], 0
v_mfma_f32_16x16x32_bf16 v[64:67], a[4:7], a[196:199], v[64:67]
v_mfma_f32_16x16x32_bf16 v[64:67], a[8:11], a[200:203], v[64:67]
v_mfma_f32_16x16x32_bf16 v[64:67], a[12:15], a[204:207], v[64:67]
v_fma_f32 v110, v102, v56, v110
v_fma_f32 v110, v103, v57, v110
v_fma_f32 v110, v104, v58, v110
v_fma_f32 v110, v105, v59, v110
v_mfma_f32_16x16x32_bf16 v[68:71], a[0:3], a[208:211], 0
v_mfma_f32_16x16x32_bf16 v[68:71], a[4:7], a[212:215], v[68:71]
v_mfma_f32_16x16x32_bf16 v[68:71], a[8:11], a[216:219], v[68:71]
v_mfma_f32_16x16x32_bf16 v[68:71], a[12:15], a[220:223], v[68:71]
v_fma_f32 v111, v102, v60, v111
v_fma_f32 v111, v103, v61, v111
v_fma_f32 v111, v104, v62, v111
v_fma_f32 v111, v105, v63, v111
v_fma_f32 v112, v102, v64, v112
v_fma_f32 v112, v103, v65, v112
v_fma_f32 v112, v104, v66, v112
v_fma_f32 v112, v105, v67, v112
v_min_u32 v110, -2, v110
v_min_u32 v111, -2, v111
v_min_u32 v112, -2, v112
v_fma_f32 v113, v102, v68, v113
v_fma_f32 v113, v103, v69, v113
v_fma_f32 v113, v104, v70, v113
v_fma_f32 v113, v105, v71, v113
v_min_u32 v113, -2, v113
buffer_store_dwordx4 v[110:113], v92, s[64:67], 0 offen sc1
s_endpgm
L_exit:
s_endpgm
B_role:
s_mov_b32 s8, s5
s_lshl_b32 s9, s4, 1
s_add_u32 s9, s9, s8
v_and_b32 v1, 63, v0
v_lshlrev_b32 v2, 4, v1
v_lshrrev_b32 v9, 4, v1
v_and_b32 v8, 15, v1
s_cmp_eq_u32 s8, 1
s_cbranch_scc1 D_role
v_mul_u32_u24 v3, 294912, v9
v_lshl_add_u32 v3, v8, 4, v3
v_mul_u32_u24 v4, 72, v9
v_lshrrev_b32 v6, 3, v8
v_mul_u32_u24 v6, 1152, v6
v_add_u32 v4, v4, v6
v_lshlrev_b32 v238, 17, v9
v_lshl_add_u32 v238, v8, 4, v238
s_waitcnt lgkmcnt(0)
s_mul_i32 s6, s3, 288
s_sub_u32 s7, 4608, s6
s_add_u32 s44, s26, s6
s_addc_u32 s45, s27, 0
s_mov_b32 s46, s7
s_mov_b32 s47, 0x20000
s_mul_i32 s6, s3, 1179648
s_lshl_b32 s7, s4, 8
s_add_u32 s6, s6, s7
s_sub_u32 s7, 4718592, s6
s_add_u32 s48, s30, s6
s_addc_u32 s49, s31, 0
s_mov_b32 s50, s7
s_mov_b32 s51, 0x20000
buffer_load_dwordx4 v[24:27], v4, s[44:47], 0 offen offset:0
buffer_load_dwordx4 v[28:31], v4, s[44:47], 0 offen offset:16
buffer_load_dwordx4 v[32:35], v4, s[44:47], 0 offen offset:32
buffer_load_dwordx4 v[36:39], v4, s[44:47], 0 offen offset:48
buffer_load_dwordx2 v[40:41], v4, s[44:47], 0 offen offset:64
buffer_load_dwordx4 v[44:47], v4, s[44:47], 0 offen offset:2304
buffer_load_dwordx4 v[48:51], v4, s[44:47], 0 offen offset:2320
buffer_load_dwordx4 v[52:55], v4, s[44:47], 0 offen offset:2336
buffer_load_dwordx4 v[56:59], v4, s[44:47], 0 offen offset:2352
buffer_load_dwordx2 v[60:61], v4, s[44:47], 0 offen offset:2368
s_mov_b32 s6, 0
buffer_load_dwordx4 a[96:99], v3, s[48:51], s6 offen nt
s_mov_b32 s6, 8192
buffer_load_dwordx4 a[100:103], v3, s[48:51], s6 offen nt
s_mov_b32 s6, 16384
buffer_load_dwordx4 a[104:107], v3, s[48:51], s6 offen nt
s_mov_b32 s6, 24576
buffer_load_dwordx4 a[108:111], v3, s[48:51], s6 offen nt
s_mov_b32 s6, 32768
buffer_load_dwordx4 a[112:115], v3, s[48:51], s6 offen nt
s_mov_b32 s6, 40960
buffer_load_dwordx4 a[116:119], v3, s[48:51], s6 offen nt
s_mov_b32 s6, 49152
buffer_load_dwordx4 a[120:123], v3, s[48:51], s6 offen nt
s_mov_b32 s6, 57344
buffer_load_dwordx4 a[124:127], v3, s[48:51], s6 offen nt
s_mov_b32 s6, 65536
buffer_load_dwordx4 a[128:131], v3, s[48:51], s6 offen nt
s_mov_b32 s6, 73728
buffer_load_dwordx4 a[132:135], v3, s[48:51], s6 offen nt
s_mov_b32 s6, 81920
buffer_load_dwordx4 a[136:139], v3, s[48:51], s6 offen nt
s_mov_b32 s6, 90112
buffer_load_dwordx4 a[140:143], v3, s[48:51], s6 offen nt
s_mov_b32 s6, 98304
buffer_load_dwordx4 a[144:147], v3, s[48:51], s6 offen nt
s_mov_b32 s6, 106496
buffer_load_dwordx4 a[148:151], v3, s[48:51], s6 offen nt
s_mov_b32 s6, 114688
buffer_load_dwordx4 a[152:155], v3, s[48:51], s6 offen nt
s_mov_b32 s6, 122880
buffer_load_dwordx4 a[156:159], v3, s[48:51], s6 offen nt
s_mov_b32 s6, 131072
buffer_load_dwordx4 a[160:163], v3, s[48:51], s6 offen nt
s_mov_b32 s6, 139264
buffer_load_dwordx4 a[164:167], v3, s[48:51], s6 offen nt
s_mov_b32 s6, 147456
buffer_load_dwordx4 a[168:171], v3, s[48:51], s6 offen nt
s_mov_b32 s6, 155648
buffer_load_dwordx4 a[172:175], v3, s[48:51], s6 offen nt
s_mov_b32 s6, 163840
buffer_load_dwordx4 a[176:179], v3, s[48:51], s6 offen nt
s_mov_b32 s6, 172032
buffer_load_dwordx4 a[180:183], v3, s[48:51], s6 offen nt
s_mov_b32 s6, 180224
buffer_load_dwordx4 a[184:187], v3, s[48:51], s6 offen nt
s_mov_b32 s6, 188416
buffer_load_dwordx4 a[188:191], v3, s[48:51], s6 offen nt
s_mov_b32 s6, 196608
buffer_load_dwordx4 a[192:195], v3, s[48:51], s6 offen nt
s_mov_b32 s6, 204800
buffer_load_dwordx4 a[196:199], v3, s[48:51], s6 offen nt
s_mov_b32 s6, 212992
buffer_load_dwordx4 a[200:203], v3, s[48:51], s6 offen nt
s_mov_b32 s6, 221184
buffer_load_dwordx4 a[204:207], v3, s[48:51], s6 offen nt
s_mov_b32 s6, 229376
buffer_load_dwordx4 a[208:211], v3, s[48:51], s6 offen nt
s_mov_b32 s6, 237568
buffer_load_dwordx4 a[212:215], v3, s[48:51], s6 offen nt
s_mov_b32 s6, 245760
buffer_load_dwordx4 a[216:219], v3, s[48:51], s6 offen nt
s_mov_b32 s6, 253952
buffer_load_dwordx4 a[220:223], v3, s[48:51], s6 offen nt
s_mov_b32 s6, 262144
buffer_load_dwordx4 a[224:227], v3, s[48:51], s6 offen nt
s_mov_b32 s6, 270336
buffer_load_dwordx4 a[228:231], v3, s[48:51], s6 offen nt
s_mov_b32 s6, 278528
buffer_load_dwordx4 a[232:235], v3, s[48:51], s6 offen nt
s_mov_b32 s6, 286720
buffer_load_dwordx4 a[236:239], v3, s[48:51], s6 offen nt
s_lshl_b32 s6, s3, 20
s_lshl_b32 s7, s4, 8
s_add_u32 s6, s6, s7
s_sub_u32 s7, 4194304, s6
s_add_u32 s76, s32, s6
s_addc_u32 s77, s33, 0
s_mov_b32 s78, s7
s_mov_b32 s79, 0x20000
s_add_u32 s52, s34, s6
s_addc_u32 s53, s35, 0
s_mov_b32 s54, s7
s_mov_b32 s55, 0x20000
s_mov_b32 s6, 0
buffer_load_dwordx4 v[88:91], v238, s[76:79], s6 offen nt
s_mov_b32 s6, 8192
buffer_load_dwordx4 v[92:95], v238, s[76:79], s6 offen nt
s_mov_b32 s6, 16384
buffer_load_dwordx4 v[96:99], v238, s[76:79], s6 offen nt
s_mov_b32 s6, 24576
buffer_load_dwordx4 v[100:103], v238, s[76:79], s6 offen nt
s_mov_b32 s6, 32768
buffer_load_dwordx4 v[104:107], v238, s[76:79], s6 offen nt
s_mov_b32 s6, 40960
buffer_load_dwordx4 v[108:111], v238, s[76:79], s6 offen nt
s_mov_b32 s6, 49152
buffer_load_dwordx4 v[112:115], v238, s[76:79], s6 offen nt
s_mov_b32 s6, 57344
buffer_load_dwordx4 v[116:119], v238, s[76:79], s6 offen nt
s_mov_b32 s6, 65536
buffer_load_dwordx4 v[120:123], v238, s[76:79], s6 offen nt
s_mov_b32 s6, 73728
buffer_load_dwordx4 v[124:127], v238, s[76:79], s6 offen nt
s_mov_b32 s6, 81920
buffer_load_dwordx4 v[128:131], v238, s[76:79], s6 offen nt
s_mov_b32 s6, 90112
buffer_load_dwordx4 v[132:135], v238, s[76:79], s6 offen nt
s_mov_b32 s64, s42
s_mov_b32 s65, s43
s_mov_b32 s66, 6291456
s_mov_b32 s67, 0x20000
s_mov_b32 s68, s40
s_mov_b32 s69, s41
s_mov_b32 s70, 256
s_mov_b32 s71, 0x20000
s_mov_b32 s72, s38
s_mov_b32 s73, s39
s_mov_b32 s74, 9216
s_mov_b32 s75, 0x20000
s_mul_i32 s6, s4, 147456
s_add_u32 s60, s36, s6
s_addc_u32 s61, s37, 0
s_mov_b32 s62, 147456
s_mov_b32 s63, 0x20000
v_and_b32 v5, 1, v1
v_lshlrev_b32 v5, 4, v5
v_mov_b32 v6, 0xffff
v_lshlrev_b32 v5, v5, v6
v_bfe_u32 v6, v1, 1, 2
v_cmp_eq_u32 vcc, 0, v6
s_nop 1
v_cndmask_b32 v12, 0, v5, vcc
v_cmp_eq_u32 vcc, 1, v6
s_nop 1
v_cndmask_b32 v13, 0, v5, vcc
v_cmp_eq_u32 vcc, 2, v6
s_nop 1
v_cndmask_b32 v14, 0, v5, vcc
v_cmp_eq_u32 vcc, 3, v6
s_nop 1
v_cndmask_b32 v15, 0, v5, vcc
v_mov_b32 v5, 0x0c0c0c0c
s_mov_b32 s6, 0x01000100
s_mov_b32 s7, 0x03020302
v_bfi_b32 v16, v12, s6, v5
v_bfi_b32 v17, v13, s6, v5
v_bfi_b32 v18, v14, s6, v5
v_bfi_b32 v19, v15, s6, v5
v_bfi_b32 v20, v12, s7, v5
v_bfi_b32 v21, v13, s7, v5
v_bfi_b32 v22, v14, s7, v5
v_bfi_b32 v23, v15, s7, v5
v_lshrrev_b32 v5, 4, v1
v_lshlrev_b32 v5, 3, v5
v_bfe_u32 v6, v1, 2, 2
v_add_u32 v5, v5, v6
v_mul_u32_u24 v5, 1152, v5
s_mul_i32 s6, s3, 288
v_add_u32 v5, s6, v5
v_and_b32 v6, 3, v1
v_lshl_add_u32 v240, v6, 5, v5
v_lshl_add_u32 v241, v6, 3, v5
v_add_u32 v241, 256, v241
v_add_u32 v242, 73728, v240
v_add_u32 v243, 73728, v241
s_mul_i32 s12, s3, 36864
s_waitcnt vmcnt(47)
v_perm_b32 v64, v24, v24, v16
v_perm_b32 v65, v24, v24, v17
v_perm_b32 v66, v24, v24, v18
v_perm_b32 v67, v24, v24, v19
s_nop 1
v_mfma_f32_16x16x32_bf16 v[80:83], v[64:67], a[96:99], 0
v_perm_b32 v68, v44, v44, v16
v_perm_b32 v69, v44, v44, v17
v_perm_b32 v70, v44, v44, v18
v_perm_b32 v71, v44, v44, v19
s_nop 1
v_mfma_f32_16x16x32_bf16 v[84:87], v[68:71], a[96:99], 0
s_mov_b32 s6, 98304
buffer_load_dwordx4 v[136:139], v238, s[76:79], s6 offen nt
s_waitcnt vmcnt(47)
v_perm_b32 v72, v24, v24, v20
v_perm_b32 v73, v24, v24, v21
v_perm_b32 v74, v24, v24, v22
v_perm_b32 v75, v24, v24, v23
s_nop 1
v_mfma_f32_16x16x32_bf16 v[80:83], v[72:75], a[100:103], v[80:83]
v_perm_b32 v76, v44, v44, v20
v_perm_b32 v77, v44, v44, v21
v_perm_b32 v78, v44, v44, v22
v_perm_b32 v79, v44, v44, v23
s_nop 1
v_mfma_f32_16x16x32_bf16 v[84:87], v[76:79], a[100:103], v[84:87]
s_mov_b32 s6, 106496
buffer_load_dwordx4 v[140:143], v238, s[76:79], s6 offen nt
s_waitcnt vmcnt(47)
v_perm_b32 v64, v25, v25, v16
v_perm_b32 v65, v25, v25, v17
v_perm_b32 v66, v25, v25, v18
v_perm_b32 v67, v25, v25, v19
s_nop 1
v_mfma_f32_16x16x32_bf16 v[80:83], v[64:67], a[104:107], v[80:83]
v_perm_b32 v68, v45, v45, v16
v_perm_b32 v69, v45, v45, v17
v_perm_b32 v70, v45, v45, v18
v_perm_b32 v71, v45, v45, v19
s_nop 1
v_mfma_f32_16x16x32_bf16 v[84:87], v[68:71], a[104:107], v[84:87]
s_mov_b32 s6, 114688
buffer_load_dwordx4 v[144:147], v238, s[76:79], s6 offen nt
s_waitcnt vmcnt(47)
v_perm_b32 v72, v25, v25, v20
v_perm_b32 v73, v25, v25, v21
v_perm_b32 v74, v25, v25, v22
v_perm_b32 v75, v25, v25, v23
s_nop 1
v_mfma_f32_16x16x32_bf16 v[80:83], v[72:75], a[108:111], v[80:83]
v_perm_b32 v76, v45, v45, v20
v_perm_b32 v77, v45, v45, v21
v_perm_b32 v78, v45, v45, v22
v_perm_b32 v79, v45, v45, v23
s_nop 1
v_mfma_f32_16x16x32_bf16 v[84:87], v[76:79], a[108:111], v[84:87]
s_mov_b32 s6, 122880
buffer_load_dwordx4 v[148:151], v238, s[76:79], s6 offen nt
s_waitcnt vmcnt(47)
v_perm_b32 v64, v26, v26, v16
v_perm_b32 v65, v26, v26, v17
v_perm_b32 v66, v26, v26, v18
v_perm_b32 v67, v26, v26, v19
s_nop 1
v_mfma_f32_16x16x32_bf16 v[80:83], v[64:67], a[112:115], v[80:83]
v_perm_b32 v68, v46, v46, v16
v_perm_b32 v69, v46, v46, v17
v_perm_b32 v70, v46, v46, v18
v_perm_b32 v71, v46, v46, v19
s_nop 1
v_mfma_f32_16x16x32_bf16 v[84:87], v[68:71], a[112:115], v[84:87]
s_mov_b32 s6, 524288
buffer_load_dwordx4 v[152:155], v238, s[76:79], s6 offen nt
s_waitcnt vmcnt(47)
v_perm_b32 v72, v26, v26, v20
v_perm_b32 v73, v26, v26, v21
v_perm_b32 v74, v26, v26, v22
v_perm_b32 v75, v26, v26, v23
s_nop 1
v_mfma_f32_16x16x32_bf16 v[80:83], v[72:75], a[116:119], v[80:83]
v_perm_b32 v76, v46, v46, v20
v_perm_b32 v77, v46, v46, v21
v_perm_b32 v78, v46, v46, v22
v_perm_b32 v79, v46, v46, v23
s_nop 1
v_mfma_f32_16x16x32_bf16 v[84:87], v[76:79], a[116:119], v[84:87]
s_mov_b32 s6, 532480
buffer_load_dwordx4 v[156:159], v238, s[76:79], s6 offen nt
s_waitcnt vmcnt(47)
v_perm_b32 v64, v27, v27, v16
v_perm_b32 v65, v27, v27, v17
v_perm_b32 v66, v27, v27, v18
v_perm_b32 v67, v27, v27, v19
s_nop 1
v_mfma_f32_16x16x32_bf16 v[80:83], v[64:67], a[120:123], v[80:83]
v_perm_b32 v68, v47, v47, v16
v_perm_b32 v69, v47, v47, v17
v_perm_b32 v70, v47, v47, v18
v_perm_b32 v71, v47, v47, v19
s_nop 1
v_mfma_f32_16x16x32_bf16 v[84:87], v[68:71], a[120:123], v[84:87]
s_mov_b32 s6, 540672
buffer_load_dwordx4 v[160:163], v238, s[76:79], s6 offen nt
s_waitcnt vmcnt(47)
v_perm_b32 v72, v27, v27, v20
v_perm_b32 v73, v27, v27, v21
v_perm_b32 v74, v27, v27, v22
v_perm_b32 v75, v27, v27, v23
s_nop 1
v_mfma_f32_16x16x32_bf16 v[80:83], v[72:75], a[124:127], v[80:83]
v_perm_b32 v76, v47, v47, v20
v_perm_b32 v77, v47, v47, v21
v_perm_b32 v78, v47, v47, v22
v_perm_b32 v79, v47, v47, v23
s_nop 1
v_mfma_f32_16x16x32_bf16 v[84:87], v[76:79], a[124:127], v[84:87]
s_mov_b32 s6, 548864
buffer_load_dwordx4 v[164:167], v238, s[76:79], s6 offen nt
s_waitcnt vmcnt(47)
v_perm_b32 v64, v28, v28, v16
v_perm_b32 v65, v28, v28, v17
v_perm_b32 v66, v28, v28, v18
v_perm_b32 v67, v28, v28, v19
s_nop 1
v_mfma_f32_16x16x32_bf16 v[80:83], v[64:67], a[128:131], v[80:83]
v_perm_b32 v68, v48, v48, v16
v_perm_b32 v69, v48, v48, v17
v_perm_b32 v70, v48, v48, v18
v_perm_b32 v71, v48, v48, v19
s_nop 1
v_mfma_f32_16x16x32_bf16 v[84:87], v[68:71], a[128:131], v[84:87]
s_mov_b32 s6, 557056
buffer_load_dwordx4 v[168:171], v238, s[76:79], s6 offen nt
s_waitcnt vmcnt(47)
v_perm_b32 v72, v28, v28, v20
v_perm_b32 v73, v28, v28, v21
v_perm_b32 v74, v28, v28, v22
v_perm_b32 v75, v28, v28, v23
s_nop 1
v_mfma_f32_16x16x32_bf16 v[80:83], v[72:75], a[132:135], v[80:83]
v_perm_b32 v76, v48, v48, v20
v_perm_b32 v77, v48, v48, v21
v_perm_b32 v78, v48, v48, v22
v_perm_b32 v79, v48, v48, v23
s_nop 1
v_mfma_f32_16x16x32_bf16 v[84:87], v[76:79], a[132:135], v[84:87]
s_mov_b32 s6, 565248
buffer_load_dwordx4 v[172:175], v238, s[76:79], s6 offen nt
s_waitcnt vmcnt(47)
v_perm_b32 v64, v29, v29, v16
v_perm_b32 v65, v29, v29, v17
v_perm_b32 v66, v29, v29, v18
v_perm_b32 v67, v29, v29, v19
s_nop 1
v_mfma_f32_16x16x32_bf16 v[80:83], v[64:67], a[136:139], v[80:83]
v_perm_b32 v68, v49, v49, v16
v_perm_b32 v69, v49, v49, v17
v_perm_b32 v70, v49, v49, v18
v_perm_b32 v71, v49, v49, v19
s_nop 1
v_mfma_f32_16x16x32_bf16 v[84:87], v[68:71], a[136:139], v[84:87]
s_mov_b32 s6, 573440
buffer_load_dwordx4 v[176:179], v238, s[76:79], s6 offen nt
s_waitcnt vmcnt(47)
v_perm_b32 v72, v29, v29, v20
v_perm_b32 v73, v29, v29, v21
v_perm_b32 v74, v29, v29, v22
v_perm_b32 v75, v29, v29, v23
s_nop 1
v_mfma_f32_16x16x32_bf16 v[80:83], v[72:75], a[140:143], v[80:83]
v_perm_b32 v76, v49, v49, v20
v_perm_b32 v77, v49, v49, v21
v_perm_b32 v78, v49, v49, v22
v_perm_b32 v79, v49, v49, v23
s_nop 1
v_mfma_f32_16x16x32_bf16 v[84:87], v[76:79], a[140:143], v[84:87]
s_mov_b32 s6, 581632
buffer_load_dwordx4 v[180:183], v238, s[76:79], s6 offen nt
s_waitcnt vmcnt(47)
v_perm_b32 v64, v30, v30, v16
v_perm_b32 v65, v30, v30, v17
v_perm_b32 v66, v30, v30, v18
v_perm_b32 v67, v30, v30, v19
s_nop 1
v_mfma_f32_16x16x32_bf16 v[80:83], v[64:67], a[144:147], v[80:83]
v_perm_b32 v68, v50, v50, v16
v_perm_b32 v69, v50, v50, v17
v_perm_b32 v70, v50, v50, v18
v_perm_b32 v71, v50, v50, v19
s_nop 1
v_mfma_f32_16x16x32_bf16 v[84:87], v[68:71], a[144:147], v[84:87]
s_mov_b32 s6, 589824
buffer_load_dwordx4 v[184:187], v238, s[76:79], s6 offen nt
s_waitcnt vmcnt(47)
v_perm_b32 v72, v30, v30, v20
v_perm_b32 v73, v30, v30, v21
v_perm_b32 v74, v30, v30, v22
v_perm_b32 v75, v30, v30, v23
s_nop 1
v_mfma_f32_16x16x32_bf16 v[80:83], v[72:75], a[148:151], v[80:83]
v_perm_b32 v76, v50, v50, v20
v_perm_b32 v77, v50, v50, v21
v_perm_b32 v78, v50, v50, v22
v_perm_b32 v79, v50, v50, v23
s_nop 1
v_mfma_f32_16x16x32_bf16 v[84:87], v[76:79], a[148:151], v[84:87]
s_mov_b32 s6, 598016
buffer_load_dwordx4 v[188:191], v238, s[76:79], s6 offen nt
s_waitcnt vmcnt(47)
v_perm_b32 v64, v31, v31, v16
v_perm_b32 v65, v31, v31, v17
v_perm_b32 v66, v31, v31, v18
v_perm_b32 v67, v31, v31, v19
s_nop 1
v_mfma_f32_16x16x32_bf16 v[80:83], v[64:67], a[152:155], v[80:83]
v_perm_b32 v68, v51, v51, v16
v_perm_b32 v69, v51, v51, v17
v_perm_b32 v70, v51, v51, v18
v_perm_b32 v71, v51, v51, v19
s_nop 1
v_mfma_f32_16x16x32_bf16 v[84:87], v[68:71], a[152:155], v[84:87]
s_mov_b32 s6, 606208
buffer_load_dwordx4 v[192:195], v238, s[76:79], s6 offen nt
s_waitcnt vmcnt(47)
v_perm_b32 v72, v31, v31, v20
v_perm_b32 v73, v31, v31, v21
v_perm_b32 v74, v31, v31, v22
v_perm_b32 v75, v31, v31, v23
s_nop 1
v_mfma_f32_16x16x32_bf16 v[80:83], v[72:75], a[156:159], v[80:83]
v_perm_b32 v76, v51, v51, v20
v_perm_b32 v77, v51, v51, v21
v_perm_b32 v78, v51, v51, v22
v_perm_b32 v79, v51, v51, v23
s_nop 1
v_mfma_f32_16x16x32_bf16 v[84:87], v[76:79], a[156:159], v[84:87]
s_mov_b32 s6, 614400
buffer_load_dwordx4 v[196:199], v238, s[76:79], s6 offen nt
s_waitcnt vmcnt(47)
v_perm_b32 v64, v32, v32, v16
v_perm_b32 v65, v32, v32, v17
v_perm_b32 v66, v32, v32, v18
v_perm_b32 v67, v32, v32, v19
s_nop 1
v_mfma_f32_16x16x32_bf16 v[80:83], v[64:67], a[160:163], v[80:83]
v_perm_b32 v68, v52, v52, v16
v_perm_b32 v69, v52, v52, v17
v_perm_b32 v70, v52, v52, v18
v_perm_b32 v71, v52, v52, v19
s_nop 1
v_mfma_f32_16x16x32_bf16 v[84:87], v[68:71], a[160:163], v[84:87]
s_mov_b32 s6, 622592
buffer_load_dwordx4 v[200:203], v238, s[76:79], s6 offen nt
s_waitcnt vmcnt(47)
v_perm_b32 v72, v32, v32, v20
v_perm_b32 v73, v32, v32, v21
v_perm_b32 v74, v32, v32, v22
v_perm_b32 v75, v32, v32, v23
s_nop 1
v_mfma_f32_16x16x32_bf16 v[80:83], v[72:75], a[164:167], v[80:83]
v_perm_b32 v76, v52, v52, v20
v_perm_b32 v77, v52, v52, v21
v_perm_b32 v78, v52, v52, v22
v_perm_b32 v79, v52, v52, v23
s_nop 1
v_mfma_f32_16x16x32_bf16 v[84:87], v[76:79], a[164:167], v[84:87]
s_mov_b32 s6, 630784
buffer_load_dwordx4 v[204:207], v238, s[76:79], s6 offen nt
s_waitcnt vmcnt(47)
v_perm_b32 v64, v33, v33, v16
v_perm_b32 v65, v33, v33, v17
v_perm_b32 v66, v33, v33, v18
v_perm_b32 v67, v33, v33, v19
s_nop 1
v_mfma_f32_16x16x32_bf16 v[80:83], v[64:67], a[168:171], v[80:83]
v_perm_b32 v68, v53, v53, v16
v_perm_b32 v69, v53, v53, v17
v_perm_b32 v70, v53, v53, v18
v_perm_b32 v71, v53, v53, v19
s_nop 1
v_mfma_f32_16x16x32_bf16 v[84:87], v[68:71], a[168:171], v[84:87]
s_mov_b32 s6, 638976
buffer_load_dwordx4 v[208:211], v238, s[76:79], s6 offen nt
s_waitcnt vmcnt(47)
v_perm_b32 v72, v33, v33, v20
v_perm_b32 v73, v33, v33, v21
v_perm_b32 v74, v33, v33, v22
v_perm_b32 v75, v33, v33, v23
s_nop 1
v_mfma_f32_16x16x32_bf16 v[80:83], v[72:75], a[172:175], v[80:83]
v_perm_b32 v76, v53, v53, v20
v_perm_b32 v77, v53, v53, v21
v_perm_b32 v78, v53, v53, v22
v_perm_b32 v79, v53, v53, v23
s_nop 1
v_mfma_f32_16x16x32_bf16 v[84:87], v[76:79], a[172:175], v[84:87]
s_mov_b32 s6, 647168
buffer_load_dwordx4 v[212:215], v238, s[76:79], s6 offen nt
s_waitcnt vmcnt(47)
v_perm_b32 v64, v34, v34, v16
v_perm_b32 v65, v34, v34, v17
v_perm_b32 v66, v34, v34, v18
v_perm_b32 v67, v34, v34, v19
s_nop 1
v_mfma_f32_16x16x32_bf16 v[80:83], v[64:67], a[176:179], v[80:83]
v_perm_b32 v68, v54, v54, v16
v_perm_b32 v69, v54, v54, v17
v_perm_b32 v70, v54, v54, v18
v_perm_b32 v71, v54, v54, v19
s_nop 1
v_mfma_f32_16x16x32_bf16 v[84:87], v[68:71], a[176:179], v[84:87]
buffer_load_dword v11, off, s[68:71], 0 offset:0 sc1
s_waitcnt vmcnt(47)
v_perm_b32 v72, v34, v34, v20
v_perm_b32 v73, v34, v34, v21
v_perm_b32 v74, v34, v34, v22
v_perm_b32 v75, v34, v34, v23
s_nop 1
v_mfma_f32_16x16x32_bf16 v[80:83], v[72:75], a[180:183], v[80:83]
v_perm_b32 v76, v54, v54, v20
v_perm_b32 v77, v54, v54, v21
v_perm_b32 v78, v54, v54, v22
v_perm_b32 v79, v54, v54, v23
s_nop 1
v_mfma_f32_16x16x32_bf16 v[84:87], v[76:79], a[180:183], v[84:87]
s_waitcnt vmcnt(46)
v_perm_b32 v64, v35, v35, v16
v_perm_b32 v65, v35, v35, v17
v_perm_b32 v66, v35, v35, v18
v_perm_b32 v67, v35, v35, v19
s_nop 1
v_mfma_f32_16x16x32_bf16 v[80:83], v[64:67], a[184:187], v[80:83]
v_perm_b32 v68, v55, v55, v16
v_perm_b32 v69, v55, v55, v17
v_perm_b32 v70, v55, v55, v18
v_perm_b32 v71, v55, v55, v19
s_nop 1
v_mfma_f32_16x16x32_bf16 v[84:87], v[68:71], a[184:187], v[84:87]
s_waitcnt vmcnt(45)
v_perm_b32 v72, v35, v35, v20
v_perm_b32 v73, v35, v35, v21
v_perm_b32 v74, v35, v35, v22
v_perm_b32 v75, v35, v35, v23
s_nop 1
v_mfma_f32_16x16x32_bf16 v[80:83], v[72:75], a[188:191], v[80:83]
v_perm_b32 v76, v55, v55, v20
v_perm_b32 v77, v55, v55, v21
v_perm_b32 v78, v55, v55, v22
v_perm_b32 v79, v55, v55, v23
s_nop 1
v_mfma_f32_16x16x32_bf16 v[84:87], v[76:79], a[188:191], v[84:87]
s_waitcnt vmcnt(44)
v_perm_b32 v64, v36, v36, v16
v_perm_b32 v65, v36, v36, v17
v_perm_b32 v66, v36, v36, v18
v_perm_b32 v67, v36, v36, v19
s_nop 1
v_mfma_f32_16x16x32_bf16 v[80:83], v[64:67], a[192:195], v[80:83]
v_perm_b32 v68, v56, v56, v16
v_perm_b32 v69, v56, v56, v17
v_perm_b32 v70, v56, v56, v18
v_perm_b32 v71, v56, v56, v19
s_nop 1
v_mfma_f32_16x16x32_bf16 v[84:87], v[68:71], a[192:195], v[84:87]
s_waitcnt vmcnt(43)
v_perm_b32 v72, v36, v36, v20
v_perm_b32 v73, v36, v36, v21
v_perm_b32 v74, v36, v36, v22
v_perm_b32 v75, v36, v36, v23
s_nop 1
v_mfma_f32_16x16x32_bf16 v[80:83], v[72:75], a[196:199], v[80:83]
v_perm_b32 v76, v56, v56, v20
v_perm_b32 v77, v56, v56, v21
v_perm_b32 v78, v56, v56, v22
v_perm_b32 v79, v56, v56, v23
s_nop 1
v_mfma_f32_16x16x32_bf16 v[84:87], v[76:79], a[196:199], v[84:87]
s_waitcnt vmcnt(42)
v_perm_b32 v64, v37, v37, v16
v_perm_b32 v65, v37, v37, v17
v_perm_b32 v66, v37, v37, v18
v_perm_b32 v67, v37, v37, v19
s_nop 1
v_mfma_f32_16x16x32_bf16 v[80:83], v[64:67], a[200:203], v[80:83]
v_perm_b32 v68, v57, v57, v16
v_perm_b32 v69, v57, v57, v17
v_perm_b32 v70, v57, v57, v18
v_perm_b32 v71, v57, v57, v19
s_nop 1
v_mfma_f32_16x16x32_bf16 v[84:87], v[68:71], a[200:203], v[84:87]
s_waitcnt vmcnt(41)
v_perm_b32 v72, v37, v37, v20
v_perm_b32 v73, v37, v37, v21
v_perm_b32 v74, v37, v37, v22
v_perm_b32 v75, v37, v37, v23
s_nop 1
v_mfma_f32_16x16x32_bf16 v[80:83], v[72:75], a[204:207], v[80:83]
v_perm_b32 v76, v57, v57, v20
v_perm_b32 v77, v57, v57, v21
v_perm_b32 v78, v57, v57, v22
v_perm_b32 v79, v57, v57, v23
s_nop 1
v_mfma_f32_16x16x32_bf16 v[84:87], v[76:79], a[204:207], v[84:87]
s_waitcnt vmcnt(40)
v_perm_b32 v64, v38, v38, v16
v_perm_b32 v65, v38, v38, v17
v_perm_b32 v66, v38, v38, v18
v_perm_b32 v67, v38, v38, v19
s_nop 1
v_mfma_f32_16x16x32_bf16 v[80:83], v[64:67], a[208:211], v[80:83]
v_perm_b32 v68, v58, v58, v16
v_perm_b32 v69, v58, v58, v17
v_perm_b32 v70, v58, v58, v18
v_perm_b32 v71, v58, v58, v19
s_nop 1
v_mfma_f32_16x16x32_bf16 v[84:87], v[68:71], a[208:211], v[84:87]
s_waitcnt vmcnt(39)
v_perm_b32 v72, v38, v38, v20
v_perm_b32 v73, v38, v38, v21
v_perm_b32 v74, v38, v38, v22
v_perm_b32 v75, v38, v38, v23
s_nop 1
v_mfma_f32_16x16x32_bf16 v[80:83], v[72:75], a[212:215], v[80:83]
v_perm_b32 v76, v58, v58, v20
v_perm_b32 v77, v58, v58, v21
v_perm_b32 v78, v58, v58, v22
v_perm_b32 v79, v58, v58, v23
s_nop 1
v_mfma_f32_16x16x32_bf16 v[84:87], v[76:79], a[212:215], v[84:87]
s_waitcnt vmcnt(38)
v_perm_b32 v64, v39, v39, v16
v_perm_b32 v65, v39, v39, v17
v_perm_b32 v66, v39, v39, v18
v_perm_b32 v67, v39, v39, v19
s_nop 1
v_mfma_f32_16x16x32_bf16 v[80:83], v[64:67], a[216:219], v[80:83]
v_perm_b32 v68, v59, v59, v16
v_perm_b32 v69, v59, v59, v17
v_perm_b32 v70, v59, v59, v18
v_perm_b32 v71, v59, v59, v19
s_nop 1
v_mfma_f32_16x16x32_bf16 v[84:87], v[68:71], a[216:219], v[84:87]
s_waitcnt vmcnt(37)
v_perm_b32 v72, v39, v39, v20
v_perm_b32 v73, v39, v39, v21
v_perm_b32 v74, v39, v39, v22
v_perm_b32 v75, v39, v39, v23
s_nop 1
v_mfma_f32_16x16x32_bf16 v[80:83], v[72:75], a[220:223], v[80:83]
v_perm_b32 v76, v59, v59, v20
v_perm_b32 v77, v59, v59, v21
v_perm_b32 v78, v59, v59, v22
v_perm_b32 v79, v59, v59, v23
s_nop 1
v_mfma_f32_16x16x32_bf16 v[84:87], v[76:79], a[220:223], v[84:87]
s_waitcnt vmcnt(36)
v_perm_b32 v64, v40, v40, v16
v_perm_b32 v65, v40, v40, v17
v_perm_b32 v66, v40, v40, v18
v_perm_b32 v67, v40, v40, v19
s_nop 1
v_mfma_f32_16x16x32_bf16 v[80:83], v[64:67], a[224:227], v[80:83]
v_perm_b32 v68, v60, v60, v16
v_perm_b32 v69, v60, v60, v17
v_perm_b32 v70, v60, v60, v18
v_perm_b32 v71, v60, v60, v19
s_nop 1
v_mfma_f32_16x16x32_bf16 v[84:87], v[68:71], a[224:227], v[84:87]
s_waitcnt vmcnt(35)
v_perm_b32 v72, v40, v40, v20
v_perm_b32 v73, v40, v40, v21
v_perm_b32 v74, v40, v40, v22
v_perm_b32 v75, v40, v40, v23
s_nop 1
v_mfma_f32_16x16x32_bf16 v[80:83], v[72:75], a[228:231], v[80:83]
v_perm_b32 v76, v60, v60, v20
v_perm_b32 v77, v60, v60, v21
v_perm_b32 v78, v60, v60, v22
v_perm_b32 v79, v60, v60, v23
s_nop 1
v_mfma_f32_16x16x32_bf16 v[84:87], v[76:79], a[228:231], v[84:87]
s_waitcnt vmcnt(34)
v_perm_b32 v64, v41, v41, v16
v_perm_b32 v65, v41, v41, v17
v_perm_b32 v66, v41, v41, v18
v_perm_b32 v67, v41, v41, v19
s_nop 1
v_mfma_f32_16x16x32_bf16 v[80:83], v[64:67], a[232:235], v[80:83]
v_perm_b32 v68, v61, v61, v16
v_perm_b32 v69, v61, v61, v17
v_perm_b32 v70, v61, v61, v18
v_perm_b32 v71, v61, v61, v19
s_nop 1
v_mfma_f32_16x16x32_bf16 v[84:87], v[68:71], a[232:235], v[84:87]
s_waitcnt vmcnt(33)
v_perm_b32 v72, v41, v41, v20
v_perm_b32 v73, v41, v41, v21
v_perm_b32 v74, v41, v41, v22
v_perm_b32 v75, v41, v41, v23
s_nop 1
v_mfma_f32_16x16x32_bf16 v[80:83], v[72:75], a[236:239], v[80:83]
v_perm_b32 v76, v61, v61, v20
v_perm_b32 v77, v61, v61, v21
v_perm_b32 v78, v61, v61, v22
v_perm_b32 v79, v61, v61, v23
s_nop 1
v_mfma_f32_16x16x32_bf16 v[84:87], v[76:79], a[236:239], v[84:87]
v_lshlrev_b32 v5, 5, v8
v_and_b32 v6, 1, v9
v_lshl_add_u32 v6, v6, 4, v5
v_lshrrev_b32 v7, 5, v1
v_lshl_add_u32 v6, v7, 9, v6
s_lshl_b32 s6, s3, 11
s_add_u32 s6, s6, 147456
v_add_u32 v6, s6, v6
ds_write_b128 v6, v[80:83]
ds_write_b128 v6, v[84:87] offset:1024
v_add_u32 v5, 147456, v5
s_waitcnt lgkmcnt(0)
s_barrier
ds_read_b128 v[24:27], v5 offset:0
ds_read_b128 v[28:31], v5 offset:16
ds_read_b128 v[32:35], v5 offset:2048
ds_read_b128 v[36:39], v5 offset:2064
ds_read_b128 v[40:43], v5 offset:4096
ds_read_b128 v[44:47], v5 offset:4112
ds_read_b128 v[48:51], v5 offset:6144
ds_read_b128 v[52:55], v5 offset:6160
s_waitcnt lgkmcnt(0)
v_add_f32 v24, v24, v32
v_add_f32 v40, v40, v48
v_add_f32 v25, v25, v33
v_add_f32 v41, v41, v49
v_add_f32 v26, v26, v34
v_add_f32 v42, v42, v50
v_add_f32 v27, v27, v35
v_add_f32 v43, v43, v51
v_add_f32 v28, v28, v36
v_add_f32 v44, v44, v52
v_add_f32 v29, v29, v37
v_add_f32 v45, v45, v53
v_add_f32 v30, v30, v38
v_add_f32 v46, v46, v54
v_add_f32 v31, v31, v39
v_add_f32 v47, v47, v55
v_add_f32 v24, v24, v40
v_add_f32 v25, v25, v41
v_add_f32 v26, v26, v42
v_add_f32 v27, v27, v43
v_add_f32 v28, v28, v44
v_add_f32 v29, v29, v45
v_add_f32 v30, v30, v46
v_add_f32 v31, v31, v47
v_cvt_pk_bf16_f32 v216, v24, v25
v_cvt_pk_bf16_f32 v217, v26, v27
v_cvt_pk_bf16_f32 v218, v28, v29
v_cvt_pk_bf16_f32 v219, v30, v31
ds_read_b128 v[24:27], v5 offset:512
ds_read_b128 v[28:31], v5 offset:528
ds_read_b128 v[32:35], v5 offset:2560
ds_read_b128 v[36:39], v5 offset:2576
ds_read_b128 v[40:43], v5 offset:4608
ds_read_b128 v[44:47], v5 offset:4624
ds_read_b128 v[48:51], v5 offset:6656
ds_read_b128 v[52:55], v5 offset:6672
s_waitcnt lgkmcnt(0)
v_add_f32 v24, v24, v32
v_add_f32 v40, v40, v48
v_add_f32 v25, v25, v33
v_add_f32 v41, v41, v49
v_add_f32 v26, v26, v34
v_add_f32 v42, v42, v50
v_add_f32 v27, v27, v35
v_add_f32 v43, v43, v51
v_add_f32 v28, v28, v36
v_add_f32 v44, v44, v52
v_add_f32 v29, v29, v37
v_add_f32 v45, v45, v53
v_add_f32 v30, v30, v38
v_add_f32 v46, v46, v54
v_add_f32 v31, v31, v39
v_add_f32 v47, v47, v55
v_add_f32 v24, v24, v40
v_add_f32 v25, v25, v41
v_add_f32 v26, v26, v42
v_add_f32 v27, v27, v43
v_add_f32 v28, v28, v44
v_add_f32 v29, v29, v45
v_add_f32 v30, v30, v46
v_add_f32 v31, v31, v47
v_cvt_pk_bf16_f32 v220, v24, v25
v_cvt_pk_bf16_f32 v221, v26, v27
v_cvt_pk_bf16_f32 v222, v28, v29
v_cvt_pk_bf16_f32 v223, v30, v31
ds_read_b128 v[24:27], v5 offset:1024
ds_read_b128 v[28:31], v5 offset:1040
ds_read_b128 v[32:35], v5 offset:3072
ds_read_b128 v[36:39], v5 offset:3088
ds_read_b128 v[40:43], v5 offset:5120
ds_read_b128 v[44:47], v5 offset:5136
ds_read_b128 v[48:51], v5 offset:7168
ds_read_b128 v[52:55], v5 offset:7184
s_waitcnt lgkmcnt(0)
v_add_f32 v24, v24, v32
v_add_f32 v40, v40, v48
v_add_f32 v25, v25, v33
v_add_f32 v41, v41, v49
v_add_f32 v26, v26, v34
v_add_f32 v42, v42, v50
v_add_f32 v27, v27, v35
v_add_f32 v43, v43, v51
v_add_f32 v28, v28, v36
v_add_f32 v44, v44, v52
v_add_f32 v29, v29, v37
v_add_f32 v45, v45, v53
v_add_f32 v30, v30, v38
v_add_f32 v46, v46, v54
v_add_f32 v31, v31, v39
v_add_f32 v47, v47, v55
v_add_f32 v24, v24, v40
v_add_f32 v25, v25, v41
v_add_f32 v26, v26, v42
v_add_f32 v27, v27, v43
v_add_f32 v28, v28, v44
v_add_f32 v29, v29, v45
v_add_f32 v30, v30, v46
v_add_f32 v31, v31, v47
v_cvt_pk_bf16_f32 v224, v24, v25
v_cvt_pk_bf16_f32 v225, v26, v27
v_cvt_pk_bf16_f32 v226, v28, v29
v_cvt_pk_bf16_f32 v227, v30, v31
ds_read_b128 v[24:27], v5 offset:1536
ds_read_b128 v[28:31], v5 offset:1552
ds_read_b128 v[32:35], v5 offset:3584
ds_read_b128 v[36:39], v5 offset:3600
ds_read_b128 v[40:43], v5 offset:5632
ds_read_b128 v[44:47], v5 offset:5648
ds_read_b128 v[48:51], v5 offset:7680
ds_read_b128 v[52:55], v5 offset:7696
s_waitcnt lgkmcnt(0)
v_add_f32 v24, v24, v32
v_add_f32 v40, v40, v48
v_add_f32 v25, v25, v33
v_add_f32 v41, v41, v49
v_add_f32 v26, v26, v34
v_add_f32 v42, v42, v50
v_add_f32 v27, v27, v35
v_add_f32 v43, v43, v51
v_add_f32 v28, v28, v36
v_add_f32 v44, v44, v52
v_add_f32 v29, v29, v37
v_add_f32 v45, v45, v53
v_add_f32 v30, v30, v38
v_add_f32 v46, v46, v54
v_add_f32 v31, v31, v39
v_add_f32 v47, v47, v55
v_add_f32 v24, v24, v40
v_add_f32 v25, v25, v41
v_add_f32 v26, v26, v42
v_add_f32 v27, v27, v43
v_add_f32 v28, v28, v44
v_add_f32 v29, v29, v45
v_add_f32 v30, v30, v46
v_add_f32 v31, v31, v47
v_cvt_pk_bf16_f32 v228, v24, v25
v_cvt_pk_bf16_f32 v229, v26, v27
v_cvt_pk_bf16_f32 v230, v28, v29
v_cvt_pk_bf16_f32 v231, v30, v31
v_bfe_u32 v5, v1, 2, 2
v_lshlrev_b32 v5, 15, v5
v_lshl_add_u32 v5, v9, 5, v5
v_and_b32 v6, 1, v1
v_lshl_add_u32 v5, v6, 4, v5
v_bfe_u32 v7, v1, 1, 1
v_lshl_add_u32 v5, v7, 7, v5
s_waitcnt vmcnt(32)
v_dot2_f32_bf16 v232, v88, v216, 0
v_dot2_f32_bf16 v233, v88, v220, 0
v_dot2_f32_bf16 v234, v88, v224, 0
v_dot2_f32_bf16 v235, v88, v228, 0
v_dot2_f32_bf16 v232, v89, v217, v232
v_dot2_f32_bf16 v233, v89, v221, v233
v_dot2_f32_bf16 v234, v89, v225, v234
v_dot2_f32_bf16 v235, v89, v229, v235
v_dot2_f32_bf16 v232, v90, v218, v232
v_dot2_f32_bf16 v233, v90, v222, v233
v_dot2_f32_bf16 v234, v90, v226, v234
v_dot2_f32_bf16 v235, v90, v230, v235
v_dot2_f32_bf16 v232, v91, v219, v232
v_dot2_f32_bf16 v233, v91, v223, v233
v_dot2_f32_bf16 v234, v91, v227, v234
v_dot2_f32_bf16 v235, v91, v231, v235
v_add_f32_dpp v236, v232, v232 row_ror:8 row_mask:0xf bank_mask:0x3
v_add_f32_dpp v237, v233, v233 row_ror:8 row_mask:0xf bank_mask:0x3
v_add_f32_dpp v236, v234, v234 row_ror:8 row_mask:0xf bank_mask:0xc
v_add_f32_dpp v237, v235, v235 row_ror:8 row_mask:0xf bank_mask:0xc
s_nop 0
v_add_f32_dpp v64, v236, v236 row_half_mirror row_mask:0xf bank_mask:0x5
v_add_f32_dpp v64, v237, v237 row_half_mirror row_mask:0xf bank_mask:0xa
s_nop 1
v_add_f32_dpp v64, v64, v64 quad_perm:[1,0,3,2] row_mask:0xf bank_mask:0xf
s_nop 1
v_add_f32_dpp v64, v64, v64 quad_perm:[2,3,0,1] row_mask:0xf bank_mask:0xf
s_waitcnt vmcnt(31)
v_dot2_f32_bf16 v232, v92, v216, 0
v_dot2_f32_bf16 v233, v92, v220, 0
v_dot2_f32_bf16 v234, v92, v224, 0
v_dot2_f32_bf16 v235, v92, v228, 0
v_dot2_f32_bf16 v232, v93, v217, v232
v_dot2_f32_bf16 v233, v93, v221, v233
v_dot2_f32_bf16 v234, v93, v225, v234
v_dot2_f32_bf16 v235, v93, v229, v235
v_dot2_f32_bf16 v232, v94, v218, v232
v_dot2_f32_bf16 v233, v94, v222, v233
v_dot2_f32_bf16 v234, v94, v226, v234
v_dot2_f32_bf16 v235, v94, v230, v235
v_dot2_f32_bf16 v232, v95, v219, v232
v_dot2_f32_bf16 v233, v95, v223, v233
v_dot2_f32_bf16 v234, v95, v227, v234
v_dot2_f32_bf16 v235, v95, v231, v235
v_add_f32_dpp v236, v232, v232 row_ror:8 row_mask:0xf bank_mask:0x3
v_add_f32_dpp v237, v233, v233 row_ror:8 row_mask:0xf bank_mask:0x3
v_add_f32_dpp v236, v234, v234 row_ror:8 row_mask:0xf bank_mask:0xc
v_add_f32_dpp v237, v235, v235 row_ror:8 row_mask:0xf bank_mask:0xc
s_nop 0
v_add_f32_dpp v65, v236, v236 row_half_mirror row_mask:0xf bank_mask:0x5
v_add_f32_dpp v65, v237, v237 row_half_mirror row_mask:0xf bank_mask:0xa
s_nop 1
v_add_f32_dpp v65, v65, v65 quad_perm:[1,0,3,2] row_mask:0xf bank_mask:0xf
s_nop 1
v_add_f32_dpp v65, v65, v65 quad_perm:[2,3,0,1] row_mask:0xf bank_mask:0xf
s_waitcnt vmcnt(30)
v_dot2_f32_bf16 v232, v96, v216, 0
v_dot2_f32_bf16 v233, v96, v220, 0
v_dot2_f32_bf16 v234, v96, v224, 0
v_dot2_f32_bf16 v235, v96, v228, 0
v_dot2_f32_bf16 v232, v97, v217, v232
v_dot2_f32_bf16 v233, v97, v221, v233
v_dot2_f32_bf16 v234, v97, v225, v234
v_dot2_f32_bf16 v235, v97, v229, v235
v_dot2_f32_bf16 v232, v98, v218, v232
v_dot2_f32_bf16 v233, v98, v222, v233
v_dot2_f32_bf16 v234, v98, v226, v234
v_dot2_f32_bf16 v235, v98, v230, v235
v_dot2_f32_bf16 v232, v99, v219, v232
v_dot2_f32_bf16 v233, v99, v223, v233
v_dot2_f32_bf16 v234, v99, v227, v234
v_dot2_f32_bf16 v235, v99, v231, v235
v_add_f32_dpp v236, v232, v232 row_ror:8 row_mask:0xf bank_mask:0x3
v_add_f32_dpp v237, v233, v233 row_ror:8 row_mask:0xf bank_mask:0x3
v_add_f32_dpp v236, v234, v234 row_ror:8 row_mask:0xf bank_mask:0xc
v_add_f32_dpp v237, v235, v235 row_ror:8 row_mask:0xf bank_mask:0xc
s_nop 0
v_add_f32_dpp v66, v236, v236 row_half_mirror row_mask:0xf bank_mask:0x5
v_add_f32_dpp v66, v237, v237 row_half_mirror row_mask:0xf bank_mask:0xa
s_nop 1
v_add_f32_dpp v66, v66, v66 quad_perm:[1,0,3,2] row_mask:0xf bank_mask:0xf
s_nop 1
v_add_f32_dpp v66, v66, v66 quad_perm:[2,3,0,1] row_mask:0xf bank_mask:0xf
s_waitcnt vmcnt(29)
v_dot2_f32_bf16 v232, v100, v216, 0
v_dot2_f32_bf16 v233, v100, v220, 0
v_dot2_f32_bf16 v234, v100, v224, 0
v_dot2_f32_bf16 v235, v100, v228, 0
v_dot2_f32_bf16 v232, v101, v217, v232
v_dot2_f32_bf16 v233, v101, v221, v233
v_dot2_f32_bf16 v234, v101, v225, v234
v_dot2_f32_bf16 v235, v101, v229, v235
v_dot2_f32_bf16 v232, v102, v218, v232
v_dot2_f32_bf16 v233, v102, v222, v233
v_dot2_f32_bf16 v234, v102, v226, v234
v_dot2_f32_bf16 v235, v102, v230, v235
v_dot2_f32_bf16 v232, v103, v219, v232
v_dot2_f32_bf16 v233, v103, v223, v233
v_dot2_f32_bf16 v234, v103, v227, v234
v_dot2_f32_bf16 v235, v103, v231, v235
v_add_f32_dpp v236, v232, v232 row_ror:8 row_mask:0xf bank_mask:0x3
v_add_f32_dpp v237, v233, v233 row_ror:8 row_mask:0xf bank_mask:0x3
v_add_f32_dpp v236, v234, v234 row_ror:8 row_mask:0xf bank_mask:0xc
v_add_f32_dpp v237, v235, v235 row_ror:8 row_mask:0xf bank_mask:0xc
s_nop 0
v_add_f32_dpp v67, v236, v236 row_half_mirror row_mask:0xf bank_mask:0x5
v_add_f32_dpp v67, v237, v237 row_half_mirror row_mask:0xf bank_mask:0xa
s_nop 1
v_add_f32_dpp v67, v67, v67 quad_perm:[1,0,3,2] row_mask:0xf bank_mask:0xf
s_nop 1
v_add_f32_dpp v67, v67, v67 quad_perm:[2,3,0,1] row_mask:0xf bank_mask:0xf
s_waitcnt vmcnt(28)
v_dot2_f32_bf16 v232, v104, v216, 0
v_dot2_f32_bf16 v233, v104, v220, 0
v_dot2_f32_bf16 v234, v104, v224, 0
v_dot2_f32_bf16 v235, v104, v228, 0
v_dot2_f32_bf16 v232, v105, v217, v232
v_dot2_f32_bf16 v233, v105, v221, v233
v_dot2_f32_bf16 v234, v105, v225, v234
v_dot2_f32_bf16 v235, v105, v229, v235
v_dot2_f32_bf16 v232, v106, v218, v232
v_dot2_f32_bf16 v233, v106, v222, v233
v_dot2_f32_bf16 v234, v106, v226, v234
v_dot2_f32_bf16 v235, v106, v230, v235
v_dot2_f32_bf16 v232, v107, v219, v232
v_dot2_f32_bf16 v233, v107, v223, v233
v_dot2_f32_bf16 v234, v107, v227, v234
v_dot2_f32_bf16 v235, v107, v231, v235
v_add_f32_dpp v236, v232, v232 row_ror:8 row_mask:0xf bank_mask:0x3
v_add_f32_dpp v237, v233, v233 row_ror:8 row_mask:0xf bank_mask:0x3
v_add_f32_dpp v236, v234, v234 row_ror:8 row_mask:0xf bank_mask:0xc
v_add_f32_dpp v237, v235, v235 row_ror:8 row_mask:0xf bank_mask:0xc
s_nop 0
v_add_f32_dpp v68, v236, v236 row_half_mirror row_mask:0xf bank_mask:0x5
v_add_f32_dpp v68, v237, v237 row_half_mirror row_mask:0xf bank_mask:0xa
s_nop 1
v_add_f32_dpp v68, v68, v68 quad_perm:[1,0,3,2] row_mask:0xf bank_mask:0xf
s_nop 1
v_add_f32_dpp v68, v68, v68 quad_perm:[2,3,0,1] row_mask:0xf bank_mask:0xf
s_waitcnt vmcnt(27)
v_dot2_f32_bf16 v232, v108, v216, 0
v_dot2_f32_bf16 v233, v108, v220, 0
v_dot2_f32_bf16 v234, v108, v224, 0
v_dot2_f32_bf16 v235, v108, v228, 0
v_dot2_f32_bf16 v232, v109, v217, v232
v_dot2_f32_bf16 v233, v109, v221, v233
v_dot2_f32_bf16 v234, v109, v225, v234
v_dot2_f32_bf16 v235, v109, v229, v235
v_dot2_f32_bf16 v232, v110, v218, v232
v_dot2_f32_bf16 v233, v110, v222, v233
v_dot2_f32_bf16 v234, v110, v226, v234
v_dot2_f32_bf16 v235, v110, v230, v235
v_dot2_f32_bf16 v232, v111, v219, v232
v_dot2_f32_bf16 v233, v111, v223, v233
v_dot2_f32_bf16 v234, v111, v227, v234
v_dot2_f32_bf16 v235, v111, v231, v235
v_add_f32_dpp v236, v232, v232 row_ror:8 row_mask:0xf bank_mask:0x3
v_add_f32_dpp v237, v233, v233 row_ror:8 row_mask:0xf bank_mask:0x3
v_add_f32_dpp v236, v234, v234 row_ror:8 row_mask:0xf bank_mask:0xc
v_add_f32_dpp v237, v235, v235 row_ror:8 row_mask:0xf bank_mask:0xc
s_nop 0
v_add_f32_dpp v69, v236, v236 row_half_mirror row_mask:0xf bank_mask:0x5
v_add_f32_dpp v69, v237, v237 row_half_mirror row_mask:0xf bank_mask:0xa
s_nop 1
v_add_f32_dpp v69, v69, v69 quad_perm:[1,0,3,2] row_mask:0xf bank_mask:0xf
s_nop 1
v_add_f32_dpp v69, v69, v69 quad_perm:[2,3,0,1] row_mask:0xf bank_mask:0xf
s_waitcnt vmcnt(26)
v_dot2_f32_bf16 v232, v112, v216, 0
v_dot2_f32_bf16 v233, v112, v220, 0
v_dot2_f32_bf16 v234, v112, v224, 0
v_dot2_f32_bf16 v235, v112, v228, 0
v_dot2_f32_bf16 v232, v113, v217, v232
v_dot2_f32_bf16 v233, v113, v221, v233
v_dot2_f32_bf16 v234, v113, v225, v234
v_dot2_f32_bf16 v235, v113, v229, v235
v_dot2_f32_bf16 v232, v114, v218, v232
v_dot2_f32_bf16 v233, v114, v222, v233
v_dot2_f32_bf16 v234, v114, v226, v234
v_dot2_f32_bf16 v235, v114, v230, v235
v_dot2_f32_bf16 v232, v115, v219, v232
v_dot2_f32_bf16 v233, v115, v223, v233
v_dot2_f32_bf16 v234, v115, v227, v234
v_dot2_f32_bf16 v235, v115, v231, v235
v_add_f32_dpp v236, v232, v232 row_ror:8 row_mask:0xf bank_mask:0x3
v_add_f32_dpp v237, v233, v233 row_ror:8 row_mask:0xf bank_mask:0x3
v_add_f32_dpp v236, v234, v234 row_ror:8 row_mask:0xf bank_mask:0xc
v_add_f32_dpp v237, v235, v235 row_ror:8 row_mask:0xf bank_mask:0xc
s_nop 0
v_add_f32_dpp v70, v236, v236 row_half_mirror row_mask:0xf bank_mask:0x5
v_add_f32_dpp v70, v237, v237 row_half_mirror row_mask:0xf bank_mask:0xa
s_nop 1
v_add_f32_dpp v70, v70, v70 quad_perm:[1,0,3,2] row_mask:0xf bank_mask:0xf
s_nop 1
v_add_f32_dpp v70, v70, v70 quad_perm:[2,3,0,1] row_mask:0xf bank_mask:0xf
s_waitcnt vmcnt(25)
v_dot2_f32_bf16 v232, v116, v216, 0
v_dot2_f32_bf16 v233, v116, v220, 0
v_dot2_f32_bf16 v234, v116, v224, 0
v_dot2_f32_bf16 v235, v116, v228, 0
v_dot2_f32_bf16 v232, v117, v217, v232
v_dot2_f32_bf16 v233, v117, v221, v233
v_dot2_f32_bf16 v234, v117, v225, v234
v_dot2_f32_bf16 v235, v117, v229, v235
v_dot2_f32_bf16 v232, v118, v218, v232
v_dot2_f32_bf16 v233, v118, v222, v233
v_dot2_f32_bf16 v234, v118, v226, v234
v_dot2_f32_bf16 v235, v118, v230, v235
v_dot2_f32_bf16 v232, v119, v219, v232
v_dot2_f32_bf16 v233, v119, v223, v233
v_dot2_f32_bf16 v234, v119, v227, v234
v_dot2_f32_bf16 v235, v119, v231, v235
v_add_f32_dpp v236, v232, v232 row_ror:8 row_mask:0xf bank_mask:0x3
v_add_f32_dpp v237, v233, v233 row_ror:8 row_mask:0xf bank_mask:0x3
v_add_f32_dpp v236, v234, v234 row_ror:8 row_mask:0xf bank_mask:0xc
v_add_f32_dpp v237, v235, v235 row_ror:8 row_mask:0xf bank_mask:0xc
s_nop 0
v_add_f32_dpp v71, v236, v236 row_half_mirror row_mask:0xf bank_mask:0x5
v_add_f32_dpp v71, v237, v237 row_half_mirror row_mask:0xf bank_mask:0xa
s_nop 1
v_add_f32_dpp v71, v71, v71 quad_perm:[1,0,3,2] row_mask:0xf bank_mask:0xf
s_nop 1
v_add_f32_dpp v71, v71, v71 quad_perm:[2,3,0,1] row_mask:0xf bank_mask:0xf
s_waitcnt vmcnt(24)
v_dot2_f32_bf16 v232, v120, v216, 0
v_dot2_f32_bf16 v233, v120, v220, 0
v_dot2_f32_bf16 v234, v120, v224, 0
v_dot2_f32_bf16 v235, v120, v228, 0
v_dot2_f32_bf16 v232, v121, v217, v232
v_dot2_f32_bf16 v233, v121, v221, v233
v_dot2_f32_bf16 v234, v121, v225, v234
v_dot2_f32_bf16 v235, v121, v229, v235
v_dot2_f32_bf16 v232, v122, v218, v232
v_dot2_f32_bf16 v233, v122, v222, v233
v_dot2_f32_bf16 v234, v122, v226, v234
v_dot2_f32_bf16 v235, v122, v230, v235
v_dot2_f32_bf16 v232, v123, v219, v232
v_dot2_f32_bf16 v233, v123, v223, v233
v_dot2_f32_bf16 v234, v123, v227, v234
v_dot2_f32_bf16 v235, v123, v231, v235
v_add_f32_dpp v236, v232, v232 row_ror:8 row_mask:0xf bank_mask:0x3
v_add_f32_dpp v237, v233, v233 row_ror:8 row_mask:0xf bank_mask:0x3
v_add_f32_dpp v236, v234, v234 row_ror:8 row_mask:0xf bank_mask:0xc
v_add_f32_dpp v237, v235, v235 row_ror:8 row_mask:0xf bank_mask:0xc
s_nop 0
v_add_f32_dpp v72, v236, v236 row_half_mirror row_mask:0xf bank_mask:0x5
v_add_f32_dpp v72, v237, v237 row_half_mirror row_mask:0xf bank_mask:0xa
s_nop 1
v_add_f32_dpp v72, v72, v72 quad_perm:[1,0,3,2] row_mask:0xf bank_mask:0xf
s_nop 1
v_add_f32_dpp v72, v72, v72 quad_perm:[2,3,0,1] row_mask:0xf bank_mask:0xf
s_waitcnt vmcnt(23)
v_dot2_f32_bf16 v232, v124, v216, 0
v_dot2_f32_bf16 v233, v124, v220, 0
v_dot2_f32_bf16 v234, v124, v224, 0
v_dot2_f32_bf16 v235, v124, v228, 0
v_dot2_f32_bf16 v232, v125, v217, v232
v_dot2_f32_bf16 v233, v125, v221, v233
v_dot2_f32_bf16 v234, v125, v225, v234
v_dot2_f32_bf16 v235, v125, v229, v235
v_dot2_f32_bf16 v232, v126, v218, v232
v_dot2_f32_bf16 v233, v126, v222, v233
v_dot2_f32_bf16 v234, v126, v226, v234
v_dot2_f32_bf16 v235, v126, v230, v235
v_dot2_f32_bf16 v232, v127, v219, v232
v_dot2_f32_bf16 v233, v127, v223, v233
v_dot2_f32_bf16 v234, v127, v227, v234
v_dot2_f32_bf16 v235, v127, v231, v235
v_add_f32_dpp v236, v232, v232 row_ror:8 row_mask:0xf bank_mask:0x3
v_add_f32_dpp v237, v233, v233 row_ror:8 row_mask:0xf bank_mask:0x3
v_add_f32_dpp v236, v234, v234 row_ror:8 row_mask:0xf bank_mask:0xc
v_add_f32_dpp v237, v235, v235 row_ror:8 row_mask:0xf bank_mask:0xc
s_nop 0
v_add_f32_dpp v73, v236, v236 row_half_mirror row_mask:0xf bank_mask:0x5
v_add_f32_dpp v73, v237, v237 row_half_mirror row_mask:0xf bank_mask:0xa
s_nop 1
v_add_f32_dpp v73, v73, v73 quad_perm:[1,0,3,2] row_mask:0xf bank_mask:0xf
s_nop 1
v_add_f32_dpp v73, v73, v73 quad_perm:[2,3,0,1] row_mask:0xf bank_mask:0xf
s_waitcnt vmcnt(22)
v_dot2_f32_bf16 v232, v128, v216, 0
v_dot2_f32_bf16 v233, v128, v220, 0
v_dot2_f32_bf16 v234, v128, v224, 0
v_dot2_f32_bf16 v235, v128, v228, 0
v_dot2_f32_bf16 v232, v129, v217, v232
v_dot2_f32_bf16 v233, v129, v221, v233
v_dot2_f32_bf16 v234, v129, v225, v234
v_dot2_f32_bf16 v235, v129, v229, v235
v_dot2_f32_bf16 v232, v130, v218, v232
v_dot2_f32_bf16 v233, v130, v222, v233
v_dot2_f32_bf16 v234, v130, v226, v234
v_dot2_f32_bf16 v235, v130, v230, v235
v_dot2_f32_bf16 v232, v131, v219, v232
v_dot2_f32_bf16 v233, v131, v223, v233
v_dot2_f32_bf16 v234, v131, v227, v234
v_dot2_f32_bf16 v235, v131, v231, v235
v_add_f32_dpp v236, v232, v232 row_ror:8 row_mask:0xf bank_mask:0x3
v_add_f32_dpp v237, v233, v233 row_ror:8 row_mask:0xf bank_mask:0x3
v_add_f32_dpp v236, v234, v234 row_ror:8 row_mask:0xf bank_mask:0xc
v_add_f32_dpp v237, v235, v235 row_ror:8 row_mask:0xf bank_mask:0xc
s_nop 0
v_add_f32_dpp v74, v236, v236 row_half_mirror row_mask:0xf bank_mask:0x5
v_add_f32_dpp v74, v237, v237 row_half_mirror row_mask:0xf bank_mask:0xa
s_nop 1
v_add_f32_dpp v74, v74, v74 quad_perm:[1,0,3,2] row_mask:0xf bank_mask:0xf
s_nop 1
v_add_f32_dpp v74, v74, v74 quad_perm:[2,3,0,1] row_mask:0xf bank_mask:0xf
s_waitcnt vmcnt(21)
v_dot2_f32_bf16 v232, v132, v216, 0
v_dot2_f32_bf16 v233, v132, v220, 0
v_dot2_f32_bf16 v234, v132, v224, 0
v_dot2_f32_bf16 v235, v132, v228, 0
v_dot2_f32_bf16 v232, v133, v217, v232
v_dot2_f32_bf16 v233, v133, v221, v233
v_dot2_f32_bf16 v234, v133, v225, v234
v_dot2_f32_bf16 v235, v133, v229, v235
v_dot2_f32_bf16 v232, v134, v218, v232
v_dot2_f32_bf16 v233, v134, v222, v233
v_dot2_f32_bf16 v234, v134, v226, v234
v_dot2_f32_bf16 v235, v134, v230, v235
v_dot2_f32_bf16 v232, v135, v219, v232
v_dot2_f32_bf16 v233, v135, v223, v233
v_dot2_f32_bf16 v234, v135, v227, v234
v_dot2_f32_bf16 v235, v135, v231, v235
v_add_f32_dpp v236, v232, v232 row_ror:8 row_mask:0xf bank_mask:0x3
v_add_f32_dpp v237, v233, v233 row_ror:8 row_mask:0xf bank_mask:0x3
v_add_f32_dpp v236, v234, v234 row_ror:8 row_mask:0xf bank_mask:0xc
v_add_f32_dpp v237, v235, v235 row_ror:8 row_mask:0xf bank_mask:0xc
s_nop 0
v_add_f32_dpp v75, v236, v236 row_half_mirror row_mask:0xf bank_mask:0x5
v_add_f32_dpp v75, v237, v237 row_half_mirror row_mask:0xf bank_mask:0xa
s_nop 1
v_add_f32_dpp v75, v75, v75 quad_perm:[1,0,3,2] row_mask:0xf bank_mask:0xf
s_nop 1
v_add_f32_dpp v75, v75, v75 quad_perm:[2,3,0,1] row_mask:0xf bank_mask:0xf
s_waitcnt vmcnt(20)
v_dot2_f32_bf16 v232, v136, v216, 0
v_dot2_f32_bf16 v233, v136, v220, 0
v_dot2_f32_bf16 v234, v136, v224, 0
v_dot2_f32_bf16 v235, v136, v228, 0
v_dot2_f32_bf16 v232, v137, v217, v232
v_dot2_f32_bf16 v233, v137, v221, v233
v_dot2_f32_bf16 v234, v137, v225, v234
v_dot2_f32_bf16 v235, v137, v229, v235
v_dot2_f32_bf16 v232, v138, v218, v232
v_dot2_f32_bf16 v233, v138, v222, v233
v_dot2_f32_bf16 v234, v138, v226, v234
v_dot2_f32_bf16 v235, v138, v230, v235
v_dot2_f32_bf16 v232, v139, v219, v232
v_dot2_f32_bf16 v233, v139, v223, v233
v_dot2_f32_bf16 v234, v139, v227, v234
v_dot2_f32_bf16 v235, v139, v231, v235
v_add_f32_dpp v236, v232, v232 row_ror:8 row_mask:0xf bank_mask:0x3
v_add_f32_dpp v237, v233, v233 row_ror:8 row_mask:0xf bank_mask:0x3
v_add_f32_dpp v236, v234, v234 row_ror:8 row_mask:0xf bank_mask:0xc
v_add_f32_dpp v237, v235, v235 row_ror:8 row_mask:0xf bank_mask:0xc
s_nop 0
v_add_f32_dpp v76, v236, v236 row_half_mirror row_mask:0xf bank_mask:0x5
v_add_f32_dpp v76, v237, v237 row_half_mirror row_mask:0xf bank_mask:0xa
s_nop 1
v_add_f32_dpp v76, v76, v76 quad_perm:[1,0,3,2] row_mask:0xf bank_mask:0xf
s_nop 1
v_add_f32_dpp v76, v76, v76 quad_perm:[2,3,0,1] row_mask:0xf bank_mask:0xf
s_waitcnt vmcnt(19)
v_dot2_f32_bf16 v232, v140, v216, 0
v_dot2_f32_bf16 v233, v140, v220, 0
v_dot2_f32_bf16 v234, v140, v224, 0
v_dot2_f32_bf16 v235, v140, v228, 0
v_dot2_f32_bf16 v232, v141, v217, v232
v_dot2_f32_bf16 v233, v141, v221, v233
v_dot2_f32_bf16 v234, v141, v225, v234
v_dot2_f32_bf16 v235, v141, v229, v235
v_dot2_f32_bf16 v232, v142, v218, v232
v_dot2_f32_bf16 v233, v142, v222, v233
v_dot2_f32_bf16 v234, v142, v226, v234
v_dot2_f32_bf16 v235, v142, v230, v235
v_dot2_f32_bf16 v232, v143, v219, v232
v_dot2_f32_bf16 v233, v143, v223, v233
v_dot2_f32_bf16 v234, v143, v227, v234
v_dot2_f32_bf16 v235, v143, v231, v235
v_add_f32_dpp v236, v232, v232 row_ror:8 row_mask:0xf bank_mask:0x3
v_add_f32_dpp v237, v233, v233 row_ror:8 row_mask:0xf bank_mask:0x3
v_add_f32_dpp v236, v234, v234 row_ror:8 row_mask:0xf bank_mask:0xc
v_add_f32_dpp v237, v235, v235 row_ror:8 row_mask:0xf bank_mask:0xc
s_nop 0
v_add_f32_dpp v77, v236, v236 row_half_mirror row_mask:0xf bank_mask:0x5
v_add_f32_dpp v77, v237, v237 row_half_mirror row_mask:0xf bank_mask:0xa
s_nop 1
v_add_f32_dpp v77, v77, v77 quad_perm:[1,0,3,2] row_mask:0xf bank_mask:0xf
s_nop 1
v_add_f32_dpp v77, v77, v77 quad_perm:[2,3,0,1] row_mask:0xf bank_mask:0xf
s_waitcnt vmcnt(18)
v_dot2_f32_bf16 v232, v144, v216, 0
v_dot2_f32_bf16 v233, v144, v220, 0
v_dot2_f32_bf16 v234, v144, v224, 0
v_dot2_f32_bf16 v235, v144, v228, 0
v_dot2_f32_bf16 v232, v145, v217, v232
v_dot2_f32_bf16 v233, v145, v221, v233
v_dot2_f32_bf16 v234, v145, v225, v234
v_dot2_f32_bf16 v235, v145, v229, v235
v_dot2_f32_bf16 v232, v146, v218, v232
v_dot2_f32_bf16 v233, v146, v222, v233
v_dot2_f32_bf16 v234, v146, v226, v234
v_dot2_f32_bf16 v235, v146, v230, v235
v_dot2_f32_bf16 v232, v147, v219, v232
v_dot2_f32_bf16 v233, v147, v223, v233
v_dot2_f32_bf16 v234, v147, v227, v234
v_dot2_f32_bf16 v235, v147, v231, v235
v_add_f32_dpp v236, v232, v232 row_ror:8 row_mask:0xf bank_mask:0x3
v_add_f32_dpp v237, v233, v233 row_ror:8 row_mask:0xf bank_mask:0x3
v_add_f32_dpp v236, v234, v234 row_ror:8 row_mask:0xf bank_mask:0xc
v_add_f32_dpp v237, v235, v235 row_ror:8 row_mask:0xf bank_mask:0xc
s_nop 0
v_add_f32_dpp v78, v236, v236 row_half_mirror row_mask:0xf bank_mask:0x5
v_add_f32_dpp v78, v237, v237 row_half_mirror row_mask:0xf bank_mask:0xa
s_nop 1
v_add_f32_dpp v78, v78, v78 quad_perm:[1,0,3,2] row_mask:0xf bank_mask:0xf
s_nop 1
v_add_f32_dpp v78, v78, v78 quad_perm:[2,3,0,1] row_mask:0xf bank_mask:0xf
s_waitcnt vmcnt(17)
v_dot2_f32_bf16 v232, v148, v216, 0
v_dot2_f32_bf16 v233, v148, v220, 0
v_dot2_f32_bf16 v234, v148, v224, 0
v_dot2_f32_bf16 v235, v148, v228, 0
v_dot2_f32_bf16 v232, v149, v217, v232
v_dot2_f32_bf16 v233, v149, v221, v233
v_dot2_f32_bf16 v234, v149, v225, v234
v_dot2_f32_bf16 v235, v149, v229, v235
v_dot2_f32_bf16 v232, v150, v218, v232
v_dot2_f32_bf16 v233, v150, v222, v233
v_dot2_f32_bf16 v234, v150, v226, v234
v_dot2_f32_bf16 v235, v150, v230, v235
v_dot2_f32_bf16 v232, v151, v219, v232
v_dot2_f32_bf16 v233, v151, v223, v233
v_dot2_f32_bf16 v234, v151, v227, v234
v_dot2_f32_bf16 v235, v151, v231, v235
v_add_f32_dpp v236, v232, v232 row_ror:8 row_mask:0xf bank_mask:0x3
v_add_f32_dpp v237, v233, v233 row_ror:8 row_mask:0xf bank_mask:0x3
v_add_f32_dpp v236, v234, v234 row_ror:8 row_mask:0xf bank_mask:0xc
v_add_f32_dpp v237, v235, v235 row_ror:8 row_mask:0xf bank_mask:0xc
s_nop 0
v_add_f32_dpp v79, v236, v236 row_half_mirror row_mask:0xf bank_mask:0x5
v_add_f32_dpp v79, v237, v237 row_half_mirror row_mask:0xf bank_mask:0xa
s_nop 1
v_add_f32_dpp v79, v79, v79 quad_perm:[1,0,3,2] row_mask:0xf bank_mask:0xf
s_nop 1
v_add_f32_dpp v79, v79, v79 quad_perm:[2,3,0,1] row_mask:0xf bank_mask:0xf
v_cvt_pk_bf16_f32 v24, v64, v65
v_cvt_pk_bf16_f32 v25, v66, v67
v_cvt_pk_bf16_f32 v26, v68, v69
v_cvt_pk_bf16_f32 v27, v70, v71
v_cvt_pk_bf16_f32 v28, v72, v73
v_cvt_pk_bf16_f32 v29, v74, v75
v_cvt_pk_bf16_f32 v30, v76, v77
v_cvt_pk_bf16_f32 v31, v78, v79
v_cmp_eq_u32 vcc, 1, v6
s_nop 1
v_cndmask_b32 v244, v24, v28, vcc
v_cndmask_b32 v245, v25, v29, vcc
v_cndmask_b32 v246, v26, v30, vcc
v_cndmask_b32 v247, v27, v31, vcc
s_waitcnt vmcnt(16)
v_dot2_f32_bf16 v232, v152, v216, 0
v_dot2_f32_bf16 v233, v152, v220, 0
v_dot2_f32_bf16 v234, v152, v224, 0
v_dot2_f32_bf16 v235, v152, v228, 0
v_dot2_f32_bf16 v232, v153, v217, v232
v_dot2_f32_bf16 v233, v153, v221, v233
v_dot2_f32_bf16 v234, v153, v225, v234
v_dot2_f32_bf16 v235, v153, v229, v235
v_dot2_f32_bf16 v232, v154, v218, v232
v_dot2_f32_bf16 v233, v154, v222, v233
v_dot2_f32_bf16 v234, v154, v226, v234
v_dot2_f32_bf16 v235, v154, v230, v235
v_dot2_f32_bf16 v232, v155, v219, v232
v_dot2_f32_bf16 v233, v155, v223, v233
v_dot2_f32_bf16 v234, v155, v227, v234
v_dot2_f32_bf16 v235, v155, v231, v235
v_add_f32_dpp v236, v232, v232 row_ror:8 row_mask:0xf bank_mask:0x3
v_add_f32_dpp v237, v233, v233 row_ror:8 row_mask:0xf bank_mask:0x3
v_add_f32_dpp v236, v234, v234 row_ror:8 row_mask:0xf bank_mask:0xc
v_add_f32_dpp v237, v235, v235 row_ror:8 row_mask:0xf bank_mask:0xc
s_nop 0
v_add_f32_dpp v64, v236, v236 row_half_mirror row_mask:0xf bank_mask:0x5
v_add_f32_dpp v64, v237, v237 row_half_mirror row_mask:0xf bank_mask:0xa
s_nop 1
v_add_f32_dpp v64, v64, v64 quad_perm:[1,0,3,2] row_mask:0xf bank_mask:0xf
s_nop 1
v_add_f32_dpp v64, v64, v64 quad_perm:[2,3,0,1] row_mask:0xf bank_mask:0xf
s_waitcnt vmcnt(15)
v_dot2_f32_bf16 v232, v156, v216, 0
v_dot2_f32_bf16 v233, v156, v220, 0
v_dot2_f32_bf16 v234, v156, v224, 0
v_dot2_f32_bf16 v235, v156, v228, 0
v_dot2_f32_bf16 v232, v157, v217, v232
v_dot2_f32_bf16 v233, v157, v221, v233
v_dot2_f32_bf16 v234, v157, v225, v234
v_dot2_f32_bf16 v235, v157, v229, v235
v_dot2_f32_bf16 v232, v158, v218, v232
v_dot2_f32_bf16 v233, v158, v222, v233
v_dot2_f32_bf16 v234, v158, v226, v234
v_dot2_f32_bf16 v235, v158, v230, v235
v_dot2_f32_bf16 v232, v159, v219, v232
v_dot2_f32_bf16 v233, v159, v223, v233
v_dot2_f32_bf16 v234, v159, v227, v234
v_dot2_f32_bf16 v235, v159, v231, v235
v_add_f32_dpp v236, v232, v232 row_ror:8 row_mask:0xf bank_mask:0x3
v_add_f32_dpp v237, v233, v233 row_ror:8 row_mask:0xf bank_mask:0x3
v_add_f32_dpp v236, v234, v234 row_ror:8 row_mask:0xf bank_mask:0xc
v_add_f32_dpp v237, v235, v235 row_ror:8 row_mask:0xf bank_mask:0xc
s_nop 0
v_add_f32_dpp v65, v236, v236 row_half_mirror row_mask:0xf bank_mask:0x5
v_add_f32_dpp v65, v237, v237 row_half_mirror row_mask:0xf bank_mask:0xa
s_nop 1
v_add_f32_dpp v65, v65, v65 quad_perm:[1,0,3,2] row_mask:0xf bank_mask:0xf
s_nop 1
v_add_f32_dpp v65, v65, v65 quad_perm:[2,3,0,1] row_mask:0xf bank_mask:0xf
s_waitcnt vmcnt(14)
v_dot2_f32_bf16 v232, v160, v216, 0
v_dot2_f32_bf16 v233, v160, v220, 0
v_dot2_f32_bf16 v234, v160, v224, 0
v_dot2_f32_bf16 v235, v160, v228, 0
v_dot2_f32_bf16 v232, v161, v217, v232
v_dot2_f32_bf16 v233, v161, v221, v233
v_dot2_f32_bf16 v234, v161, v225, v234
v_dot2_f32_bf16 v235, v161, v229, v235
v_dot2_f32_bf16 v232, v162, v218, v232
v_dot2_f32_bf16 v233, v162, v222, v233
v_dot2_f32_bf16 v234, v162, v226, v234
v_dot2_f32_bf16 v235, v162, v230, v235
v_dot2_f32_bf16 v232, v163, v219, v232
v_dot2_f32_bf16 v233, v163, v223, v233
v_dot2_f32_bf16 v234, v163, v227, v234
v_dot2_f32_bf16 v235, v163, v231, v235
v_add_f32_dpp v236, v232, v232 row_ror:8 row_mask:0xf bank_mask:0x3
v_add_f32_dpp v237, v233, v233 row_ror:8 row_mask:0xf bank_mask:0x3
v_add_f32_dpp v236, v234, v234 row_ror:8 row_mask:0xf bank_mask:0xc
v_add_f32_dpp v237, v235, v235 row_ror:8 row_mask:0xf bank_mask:0xc
s_nop 0
v_add_f32_dpp v66, v236, v236 row_half_mirror row_mask:0xf bank_mask:0x5
v_add_f32_dpp v66, v237, v237 row_half_mirror row_mask:0xf bank_mask:0xa
s_nop 1
v_add_f32_dpp v66, v66, v66 quad_perm:[1,0,3,2] row_mask:0xf bank_mask:0xf
s_nop 1
v_add_f32_dpp v66, v66, v66 quad_perm:[2,3,0,1] row_mask:0xf bank_mask:0xf
s_waitcnt vmcnt(13)
v_dot2_f32_bf16 v232, v164, v216, 0
v_dot2_f32_bf16 v233, v164, v220, 0
v_dot2_f32_bf16 v234, v164, v224, 0
v_dot2_f32_bf16 v235, v164, v228, 0
v_dot2_f32_bf16 v232, v165, v217, v232
v_dot2_f32_bf16 v233, v165, v221, v233
v_dot2_f32_bf16 v234, v165, v225, v234
v_dot2_f32_bf16 v235, v165, v229, v235
v_dot2_f32_bf16 v232, v166, v218, v232
v_dot2_f32_bf16 v233, v166, v222, v233
v_dot2_f32_bf16 v234, v166, v226, v234
v_dot2_f32_bf16 v235, v166, v230, v235
v_dot2_f32_bf16 v232, v167, v219, v232
v_dot2_f32_bf16 v233, v167, v223, v233
v_dot2_f32_bf16 v234, v167, v227, v234
v_dot2_f32_bf16 v235, v167, v231, v235
v_add_f32_dpp v236, v232, v232 row_ror:8 row_mask:0xf bank_mask:0x3
v_add_f32_dpp v237, v233, v233 row_ror:8 row_mask:0xf bank_mask:0x3
v_add_f32_dpp v236, v234, v234 row_ror:8 row_mask:0xf bank_mask:0xc
v_add_f32_dpp v237, v235, v235 row_ror:8 row_mask:0xf bank_mask:0xc
s_nop 0
v_add_f32_dpp v67, v236, v236 row_half_mirror row_mask:0xf bank_mask:0x5
v_add_f32_dpp v67, v237, v237 row_half_mirror row_mask:0xf bank_mask:0xa
s_nop 1
v_add_f32_dpp v67, v67, v67 quad_perm:[1,0,3,2] row_mask:0xf bank_mask:0xf
s_nop 1
v_add_f32_dpp v67, v67, v67 quad_perm:[2,3,0,1] row_mask:0xf bank_mask:0xf
s_waitcnt vmcnt(12)
v_dot2_f32_bf16 v232, v168, v216, 0
v_dot2_f32_bf16 v233, v168, v220, 0
v_dot2_f32_bf16 v234, v168, v224, 0
v_dot2_f32_bf16 v235, v168, v228, 0
v_dot2_f32_bf16 v232, v169, v217, v232
v_dot2_f32_bf16 v233, v169, v221, v233
v_dot2_f32_bf16 v234, v169, v225, v234
v_dot2_f32_bf16 v235, v169, v229, v235
v_dot2_f32_bf16 v232, v170, v218, v232
v_dot2_f32_bf16 v233, v170, v222, v233
v_dot2_f32_bf16 v234, v170, v226, v234
v_dot2_f32_bf16 v235, v170, v230, v235
v_dot2_f32_bf16 v232, v171, v219, v232
v_dot2_f32_bf16 v233, v171, v223, v233
v_dot2_f32_bf16 v234, v171, v227, v234
v_dot2_f32_bf16 v235, v171, v231, v235
v_add_f32_dpp v236, v232, v232 row_ror:8 row_mask:0xf bank_mask:0x3
v_add_f32_dpp v237, v233, v233 row_ror:8 row_mask:0xf bank_mask:0x3
v_add_f32_dpp v236, v234, v234 row_ror:8 row_mask:0xf bank_mask:0xc
v_add_f32_dpp v237, v235, v235 row_ror:8 row_mask:0xf bank_mask:0xc
s_nop 0
v_add_f32_dpp v68, v236, v236 row_half_mirror row_mask:0xf bank_mask:0x5
v_add_f32_dpp v68, v237, v237 row_half_mirror row_mask:0xf bank_mask:0xa
s_nop 1
v_add_f32_dpp v68, v68, v68 quad_perm:[1,0,3,2] row_mask:0xf bank_mask:0xf
s_nop 1
v_add_f32_dpp v68, v68, v68 quad_perm:[2,3,0,1] row_mask:0xf bank_mask:0xf
s_waitcnt vmcnt(11)
v_dot2_f32_bf16 v232, v172, v216, 0
v_dot2_f32_bf16 v233, v172, v220, 0
v_dot2_f32_bf16 v234, v172, v224, 0
v_dot2_f32_bf16 v235, v172, v228, 0
v_dot2_f32_bf16 v232, v173, v217, v232
v_dot2_f32_bf16 v233, v173, v221, v233
v_dot2_f32_bf16 v234, v173, v225, v234
v_dot2_f32_bf16 v235, v173, v229, v235
v_dot2_f32_bf16 v232, v174, v218, v232
v_dot2_f32_bf16 v233, v174, v222, v233
v_dot2_f32_bf16 v234, v174, v226, v234
v_dot2_f32_bf16 v235, v174, v230, v235
v_dot2_f32_bf16 v232, v175, v219, v232
v_dot2_f32_bf16 v233, v175, v223, v233
v_dot2_f32_bf16 v234, v175, v227, v234
v_dot2_f32_bf16 v235, v175, v231, v235
v_add_f32_dpp v236, v232, v232 row_ror:8 row_mask:0xf bank_mask:0x3
v_add_f32_dpp v237, v233, v233 row_ror:8 row_mask:0xf bank_mask:0x3
v_add_f32_dpp v236, v234, v234 row_ror:8 row_mask:0xf bank_mask:0xc
v_add_f32_dpp v237, v235, v235 row_ror:8 row_mask:0xf bank_mask:0xc
s_nop 0
v_add_f32_dpp v69, v236, v236 row_half_mirror row_mask:0xf bank_mask:0x5
v_add_f32_dpp v69, v237, v237 row_half_mirror row_mask:0xf bank_mask:0xa
s_nop 1
v_add_f32_dpp v69, v69, v69 quad_perm:[1,0,3,2] row_mask:0xf bank_mask:0xf
s_nop 1
v_add_f32_dpp v69, v69, v69 quad_perm:[2,3,0,1] row_mask:0xf bank_mask:0xf
s_waitcnt vmcnt(10)
v_dot2_f32_bf16 v232, v176, v216, 0
v_dot2_f32_bf16 v233, v176, v220, 0
v_dot2_f32_bf16 v234, v176, v224, 0
v_dot2_f32_bf16 v235, v176, v228, 0
v_dot2_f32_bf16 v232, v177, v217, v232
v_dot2_f32_bf16 v233, v177, v221, v233
v_dot2_f32_bf16 v234, v177, v225, v234
v_dot2_f32_bf16 v235, v177, v229, v235
v_dot2_f32_bf16 v232, v178, v218, v232
v_dot2_f32_bf16 v233, v178, v222, v233
v_dot2_f32_bf16 v234, v178, v226, v234
v_dot2_f32_bf16 v235, v178, v230, v235
v_dot2_f32_bf16 v232, v179, v219, v232
v_dot2_f32_bf16 v233, v179, v223, v233
v_dot2_f32_bf16 v234, v179, v227, v234
v_dot2_f32_bf16 v235, v179, v231, v235
v_add_f32_dpp v236, v232, v232 row_ror:8 row_mask:0xf bank_mask:0x3
v_add_f32_dpp v237, v233, v233 row_ror:8 row_mask:0xf bank_mask:0x3
v_add_f32_dpp v236, v234, v234 row_ror:8 row_mask:0xf bank_mask:0xc
v_add_f32_dpp v237, v235, v235 row_ror:8 row_mask:0xf bank_mask:0xc
s_nop 0
v_add_f32_dpp v70, v236, v236 row_half_mirror row_mask:0xf bank_mask:0x5
v_add_f32_dpp v70, v237, v237 row_half_mirror row_mask:0xf bank_mask:0xa
s_nop 1
v_add_f32_dpp v70, v70, v70 quad_perm:[1,0,3,2] row_mask:0xf bank_mask:0xf
s_nop 1
v_add_f32_dpp v70, v70, v70 quad_perm:[2,3,0,1] row_mask:0xf bank_mask:0xf
s_waitcnt vmcnt(9)
v_dot2_f32_bf16 v232, v180, v216, 0
v_dot2_f32_bf16 v233, v180, v220, 0
v_dot2_f32_bf16 v234, v180, v224, 0
v_dot2_f32_bf16 v235, v180, v228, 0
v_dot2_f32_bf16 v232, v181, v217, v232
v_dot2_f32_bf16 v233, v181, v221, v233
v_dot2_f32_bf16 v234, v181, v225, v234
v_dot2_f32_bf16 v235, v181, v229, v235
v_dot2_f32_bf16 v232, v182, v218, v232
v_dot2_f32_bf16 v233, v182, v222, v233
v_dot2_f32_bf16 v234, v182, v226, v234
v_dot2_f32_bf16 v235, v182, v230, v235
v_dot2_f32_bf16 v232, v183, v219, v232
v_dot2_f32_bf16 v233, v183, v223, v233
v_dot2_f32_bf16 v234, v183, v227, v234
v_dot2_f32_bf16 v235, v183, v231, v235
v_add_f32_dpp v236, v232, v232 row_ror:8 row_mask:0xf bank_mask:0x3
v_add_f32_dpp v237, v233, v233 row_ror:8 row_mask:0xf bank_mask:0x3
v_add_f32_dpp v236, v234, v234 row_ror:8 row_mask:0xf bank_mask:0xc
v_add_f32_dpp v237, v235, v235 row_ror:8 row_mask:0xf bank_mask:0xc
s_nop 0
v_add_f32_dpp v71, v236, v236 row_half_mirror row_mask:0xf bank_mask:0x5
v_add_f32_dpp v71, v237, v237 row_half_mirror row_mask:0xf bank_mask:0xa
s_nop 1
v_add_f32_dpp v71, v71, v71 quad_perm:[1,0,3,2] row_mask:0xf bank_mask:0xf
s_nop 1
v_add_f32_dpp v71, v71, v71 quad_perm:[2,3,0,1] row_mask:0xf bank_mask:0xf
s_waitcnt vmcnt(8)
v_dot2_f32_bf16 v232, v184, v216, 0
v_dot2_f32_bf16 v233, v184, v220, 0
v_dot2_f32_bf16 v234, v184, v224, 0
v_dot2_f32_bf16 v235, v184, v228, 0
v_dot2_f32_bf16 v232, v185, v217, v232
v_dot2_f32_bf16 v233, v185, v221, v233
v_dot2_f32_bf16 v234, v185, v225, v234
v_dot2_f32_bf16 v235, v185, v229, v235
v_dot2_f32_bf16 v232, v186, v218, v232
v_dot2_f32_bf16 v233, v186, v222, v233
v_dot2_f32_bf16 v234, v186, v226, v234
v_dot2_f32_bf16 v235, v186, v230, v235
v_dot2_f32_bf16 v232, v187, v219, v232
v_dot2_f32_bf16 v233, v187, v223, v233
v_dot2_f32_bf16 v234, v187, v227, v234
v_dot2_f32_bf16 v235, v187, v231, v235
v_add_f32_dpp v236, v232, v232 row_ror:8 row_mask:0xf bank_mask:0x3
v_add_f32_dpp v237, v233, v233 row_ror:8 row_mask:0xf bank_mask:0x3
v_add_f32_dpp v236, v234, v234 row_ror:8 row_mask:0xf bank_mask:0xc
v_add_f32_dpp v237, v235, v235 row_ror:8 row_mask:0xf bank_mask:0xc
s_nop 0
v_add_f32_dpp v72, v236, v236 row_half_mirror row_mask:0xf bank_mask:0x5
v_add_f32_dpp v72, v237, v237 row_half_mirror row_mask:0xf bank_mask:0xa
s_nop 1
v_add_f32_dpp v72, v72, v72 quad_perm:[1,0,3,2] row_mask:0xf bank_mask:0xf
s_nop 1
v_add_f32_dpp v72, v72, v72 quad_perm:[2,3,0,1] row_mask:0xf bank_mask:0xf
s_waitcnt vmcnt(7)
v_dot2_f32_bf16 v232, v188, v216, 0
v_dot2_f32_bf16 v233, v188, v220, 0
v_dot2_f32_bf16 v234, v188, v224, 0
v_dot2_f32_bf16 v235, v188, v228, 0
v_dot2_f32_bf16 v232, v189, v217, v232
v_dot2_f32_bf16 v233, v189, v221, v233
v_dot2_f32_bf16 v234, v189, v225, v234
v_dot2_f32_bf16 v235, v189, v229, v235
v_dot2_f32_bf16 v232, v190, v218, v232
v_dot2_f32_bf16 v233, v190, v222, v233
v_dot2_f32_bf16 v234, v190, v226, v234
v_dot2_f32_bf16 v235, v190, v230, v235
v_dot2_f32_bf16 v232, v191, v219, v232
v_dot2_f32_bf16 v233, v191, v223, v233
v_dot2_f32_bf16 v234, v191, v227, v234
v_dot2_f32_bf16 v235, v191, v231, v235
v_add_f32_dpp v236, v232, v232 row_ror:8 row_mask:0xf bank_mask:0x3
v_add_f32_dpp v237, v233, v233 row_ror:8 row_mask:0xf bank_mask:0x3
v_add_f32_dpp v236, v234, v234 row_ror:8 row_mask:0xf bank_mask:0xc
v_add_f32_dpp v237, v235, v235 row_ror:8 row_mask:0xf bank_mask:0xc
s_nop 0
v_add_f32_dpp v73, v236, v236 row_half_mirror row_mask:0xf bank_mask:0x5
v_add_f32_dpp v73, v237, v237 row_half_mirror row_mask:0xf bank_mask:0xa
s_nop 1
v_add_f32_dpp v73, v73, v73 quad_perm:[1,0,3,2] row_mask:0xf bank_mask:0xf
s_nop 1
v_add_f32_dpp v73, v73, v73 quad_perm:[2,3,0,1] row_mask:0xf bank_mask:0xf
s_waitcnt vmcnt(6)
v_dot2_f32_bf16 v232, v192, v216, 0
v_dot2_f32_bf16 v233, v192, v220, 0
v_dot2_f32_bf16 v234, v192, v224, 0
v_dot2_f32_bf16 v235, v192, v228, 0
v_dot2_f32_bf16 v232, v193, v217, v232
v_dot2_f32_bf16 v233, v193, v221, v233
v_dot2_f32_bf16 v234, v193, v225, v234
v_dot2_f32_bf16 v235, v193, v229, v235
v_dot2_f32_bf16 v232, v194, v218, v232
v_dot2_f32_bf16 v233, v194, v222, v233
v_dot2_f32_bf16 v234, v194, v226, v234
v_dot2_f32_bf16 v235, v194, v230, v235
v_dot2_f32_bf16 v232, v195, v219, v232
v_dot2_f32_bf16 v233, v195, v223, v233
v_dot2_f32_bf16 v234, v195, v227, v234
v_dot2_f32_bf16 v235, v195, v231, v235
v_add_f32_dpp v236, v232, v232 row_ror:8 row_mask:0xf bank_mask:0x3
v_add_f32_dpp v237, v233, v233 row_ror:8 row_mask:0xf bank_mask:0x3
v_add_f32_dpp v236, v234, v234 row_ror:8 row_mask:0xf bank_mask:0xc
v_add_f32_dpp v237, v235, v235 row_ror:8 row_mask:0xf bank_mask:0xc
s_nop 0
v_add_f32_dpp v74, v236, v236 row_half_mirror row_mask:0xf bank_mask:0x5
v_add_f32_dpp v74, v237, v237 row_half_mirror row_mask:0xf bank_mask:0xa
s_nop 1
v_add_f32_dpp v74, v74, v74 quad_perm:[1,0,3,2] row_mask:0xf bank_mask:0xf
s_nop 1
v_add_f32_dpp v74, v74, v74 quad_perm:[2,3,0,1] row_mask:0xf bank_mask:0xf
s_waitcnt vmcnt(5)
v_dot2_f32_bf16 v232, v196, v216, 0
v_dot2_f32_bf16 v233, v196, v220, 0
v_dot2_f32_bf16 v234, v196, v224, 0
v_dot2_f32_bf16 v235, v196, v228, 0
v_dot2_f32_bf16 v232, v197, v217, v232
v_dot2_f32_bf16 v233, v197, v221, v233
v_dot2_f32_bf16 v234, v197, v225, v234
v_dot2_f32_bf16 v235, v197, v229, v235
v_dot2_f32_bf16 v232, v198, v218, v232
v_dot2_f32_bf16 v233, v198, v222, v233
v_dot2_f32_bf16 v234, v198, v226, v234
v_dot2_f32_bf16 v235, v198, v230, v235
v_dot2_f32_bf16 v232, v199, v219, v232
v_dot2_f32_bf16 v233, v199, v223, v233
v_dot2_f32_bf16 v234, v199, v227, v234
v_dot2_f32_bf16 v235, v199, v231, v235
v_add_f32_dpp v236, v232, v232 row_ror:8 row_mask:0xf bank_mask:0x3
v_add_f32_dpp v237, v233, v233 row_ror:8 row_mask:0xf bank_mask:0x3
v_add_f32_dpp v236, v234, v234 row_ror:8 row_mask:0xf bank_mask:0xc
v_add_f32_dpp v237, v235, v235 row_ror:8 row_mask:0xf bank_mask:0xc
s_nop 0
v_add_f32_dpp v75, v236, v236 row_half_mirror row_mask:0xf bank_mask:0x5
v_add_f32_dpp v75, v237, v237 row_half_mirror row_mask:0xf bank_mask:0xa
s_nop 1
v_add_f32_dpp v75, v75, v75 quad_perm:[1,0,3,2] row_mask:0xf bank_mask:0xf
s_nop 1
v_add_f32_dpp v75, v75, v75 quad_perm:[2,3,0,1] row_mask:0xf bank_mask:0xf
s_waitcnt vmcnt(4)
v_dot2_f32_bf16 v232, v200, v216, 0
v_dot2_f32_bf16 v233, v200, v220, 0
v_dot2_f32_bf16 v234, v200, v224, 0
v_dot2_f32_bf16 v235, v200, v228, 0
v_dot2_f32_bf16 v232, v201, v217, v232
v_dot2_f32_bf16 v233, v201, v221, v233
v_dot2_f32_bf16 v234, v201, v225, v234
v_dot2_f32_bf16 v235, v201, v229, v235
v_dot2_f32_bf16 v232, v202, v218, v232
v_dot2_f32_bf16 v233, v202, v222, v233
v_dot2_f32_bf16 v234, v202, v226, v234
v_dot2_f32_bf16 v235, v202, v230, v235
v_dot2_f32_bf16 v232, v203, v219, v232
v_dot2_f32_bf16 v233, v203, v223, v233
v_dot2_f32_bf16 v234, v203, v227, v234
v_dot2_f32_bf16 v235, v203, v231, v235
v_add_f32_dpp v236, v232, v232 row_ror:8 row_mask:0xf bank_mask:0x3
v_add_f32_dpp v237, v233, v233 row_ror:8 row_mask:0xf bank_mask:0x3
v_add_f32_dpp v236, v234, v234 row_ror:8 row_mask:0xf bank_mask:0xc
v_add_f32_dpp v237, v235, v235 row_ror:8 row_mask:0xf bank_mask:0xc
s_nop 0
v_add_f32_dpp v76, v236, v236 row_half_mirror row_mask:0xf bank_mask:0x5
v_add_f32_dpp v76, v237, v237 row_half_mirror row_mask:0xf bank_mask:0xa
s_nop 1
v_add_f32_dpp v76, v76, v76 quad_perm:[1,0,3,2] row_mask:0xf bank_mask:0xf
s_nop 1
v_add_f32_dpp v76, v76, v76 quad_perm:[2,3,0,1] row_mask:0xf bank_mask:0xf
s_waitcnt vmcnt(3)
v_dot2_f32_bf16 v232, v204, v216, 0
v_dot2_f32_bf16 v233, v204, v220, 0
v_dot2_f32_bf16 v234, v204, v224, 0
v_dot2_f32_bf16 v235, v204, v228, 0
v_dot2_f32_bf16 v232, v205, v217, v232
v_dot2_f32_bf16 v233, v205, v221, v233
v_dot2_f32_bf16 v234, v205, v225, v234
v_dot2_f32_bf16 v235, v205, v229, v235
v_dot2_f32_bf16 v232, v206, v218, v232
v_dot2_f32_bf16 v233, v206, v222, v233
v_dot2_f32_bf16 v234, v206, v226, v234
v_dot2_f32_bf16 v235, v206, v230, v235
v_dot2_f32_bf16 v232, v207, v219, v232
v_dot2_f32_bf16 v233, v207, v223, v233
v_dot2_f32_bf16 v234, v207, v227, v234
v_dot2_f32_bf16 v235, v207, v231, v235
v_add_f32_dpp v236, v232, v232 row_ror:8 row_mask:0xf bank_mask:0x3
v_add_f32_dpp v237, v233, v233 row_ror:8 row_mask:0xf bank_mask:0x3
v_add_f32_dpp v236, v234, v234 row_ror:8 row_mask:0xf bank_mask:0xc
v_add_f32_dpp v237, v235, v235 row_ror:8 row_mask:0xf bank_mask:0xc
s_nop 0
v_add_f32_dpp v77, v236, v236 row_half_mirror row_mask:0xf bank_mask:0x5
v_add_f32_dpp v77, v237, v237 row_half_mirror row_mask:0xf bank_mask:0xa
s_nop 1
v_add_f32_dpp v77, v77, v77 quad_perm:[1,0,3,2] row_mask:0xf bank_mask:0xf
s_nop 1
v_add_f32_dpp v77, v77, v77 quad_perm:[2,3,0,1] row_mask:0xf bank_mask:0xf
s_waitcnt vmcnt(2)
v_dot2_f32_bf16 v232, v208, v216, 0
v_dot2_f32_bf16 v233, v208, v220, 0
v_dot2_f32_bf16 v234, v208, v224, 0
v_dot2_f32_bf16 v235, v208, v228, 0
v_dot2_f32_bf16 v232, v209, v217, v232
v_dot2_f32_bf16 v233, v209, v221, v233
v_dot2_f32_bf16 v234, v209, v225, v234
v_dot2_f32_bf16 v235, v209, v229, v235
v_dot2_f32_bf16 v232, v210, v218, v232
v_dot2_f32_bf16 v233, v210, v222, v233
v_dot2_f32_bf16 v234, v210, v226, v234
v_dot2_f32_bf16 v235, v210, v230, v235
v_dot2_f32_bf16 v232, v211, v219, v232
v_dot2_f32_bf16 v233, v211, v223, v233
v_dot2_f32_bf16 v234, v211, v227, v234
v_dot2_f32_bf16 v235, v211, v231, v235
v_add_f32_dpp v236, v232, v232 row_ror:8 row_mask:0xf bank_mask:0x3
v_add_f32_dpp v237, v233, v233 row_ror:8 row_mask:0xf bank_mask:0x3
v_add_f32_dpp v236, v234, v234 row_ror:8 row_mask:0xf bank_mask:0xc
v_add_f32_dpp v237, v235, v235 row_ror:8 row_mask:0xf bank_mask:0xc
s_nop 0
v_add_f32_dpp v78, v236, v236 row_half_mirror row_mask:0xf bank_mask:0x5
v_add_f32_dpp v78, v237, v237 row_half_mirror row_mask:0xf bank_mask:0xa
s_nop 1
v_add_f32_dpp v78, v78, v78 quad_perm:[1,0,3,2] row_mask:0xf bank_mask:0xf
s_nop 1
v_add_f32_dpp v78, v78, v78 quad_perm:[2,3,0,1] row_mask:0xf bank_mask:0xf
s_waitcnt vmcnt(1)
v_dot2_f32_bf16 v232, v212, v216, 0
v_dot2_f32_bf16 v233, v212, v220, 0
v_dot2_f32_bf16 v234, v212, v224, 0
v_dot2_f32_bf16 v235, v212, v228, 0
v_dot2_f32_bf16 v232, v213, v217, v232
v_dot2_f32_bf16 v233, v213, v221, v233
v_dot2_f32_bf16 v234, v213, v225, v234
v_dot2_f32_bf16 v235, v213, v229, v235
v_dot2_f32_bf16 v232, v214, v218, v232
v_dot2_f32_bf16 v233, v214, v222, v233
v_dot2_f32_bf16 v234, v214, v226, v234
v_dot2_f32_bf16 v235, v214, v230, v235
v_dot2_f32_bf16 v232, v215, v219, v232
v_dot2_f32_bf16 v233, v215, v223, v233
v_dot2_f32_bf16 v234, v215, v227, v234
v_dot2_f32_bf16 v235, v215, v231, v235
v_add_f32_dpp v236, v232, v232 row_ror:8 row_mask:0xf bank_mask:0x3
v_add_f32_dpp v237, v233, v233 row_ror:8 row_mask:0xf bank_mask:0x3
v_add_f32_dpp v236, v234, v234 row_ror:8 row_mask:0xf bank_mask:0xc
v_add_f32_dpp v237, v235, v235 row_ror:8 row_mask:0xf bank_mask:0xc
s_nop 0
v_add_f32_dpp v79, v236, v236 row_half_mirror row_mask:0xf bank_mask:0x5
v_add_f32_dpp v79, v237, v237 row_half_mirror row_mask:0xf bank_mask:0xa
s_nop 1
v_add_f32_dpp v79, v79, v79 quad_perm:[1,0,3,2] row_mask:0xf bank_mask:0xf
s_nop 1
v_add_f32_dpp v79, v79, v79 quad_perm:[2,3,0,1] row_mask:0xf bank_mask:0xf
v_cvt_pk_bf16_f32 v24, v64, v65
v_cvt_pk_bf16_f32 v25, v66, v67
v_cvt_pk_bf16_f32 v26, v68, v69
v_cvt_pk_bf16_f32 v27, v70, v71
v_cvt_pk_bf16_f32 v28, v72, v73
v_cvt_pk_bf16_f32 v29, v74, v75
v_cvt_pk_bf16_f32 v30, v76, v77
v_cvt_pk_bf16_f32 v31, v78, v79
v_cmp_eq_u32 vcc, 1, v6
s_nop 1
v_cndmask_b32 v248, v24, v28, vcc
v_cndmask_b32 v249, v25, v29, vcc
v_cndmask_b32 v250, v26, v30, vcc
v_cndmask_b32 v251, v27, v31, vcc
v_cmp_eq_u32 vcc, 1, v7
s_nop 1
v_cndmask_b32 v244, v244, v248, vcc
v_cndmask_b32 v245, v245, v249, vcc
v_cndmask_b32 v246, v246, v250, vcc
v_cndmask_b32 v247, v247, v251, vcc
v_min_u32 v244, -2, v244
v_min_u32 v245, -2, v245
v_min_u32 v246, -2, v246
v_min_u32 v247, -2, v247
s_waitcnt vmcnt(0)
s_mov_b32 s7, 400000
L_ens_15:
v_readfirstlane_b32 s6, v11
s_cmp_ge_u32 s6, 128
s_cbranch_scc1 L_ensd_16
s_sleep 16
buffer_load_dword v11, off, s[68:71], 0 offset:0 sc1
s_waitcnt vmcnt(0)
s_sub_u32 s7, s7, 1
s_cmp_lg_u32 s7, 0
s_cbranch_scc1 L_ens_15
L_ensd_16:
s_lshl_b32 s6, s4, 10
s_lshl_b32 s7, s3, 8
s_add_u32 s6, s6, s7
s_add_u32 s6, s6, 0
buffer_store_dwordx4 v[244:247], v5, s[64:67], s6 offen sc1
s_mov_b32 m0, s12
s_nop 0
buffer_load_dwordx4 v2, s[60:63], s12 offen offset:0 nt lds
buffer_load_dwordx4 v2, s[60:63], s12 offen offset:1024 nt lds
buffer_load_dwordx4 v2, s[60:63], s12 offen offset:2048 nt lds
buffer_load_dwordx4 v2, s[60:63], s12 offen offset:3072 nt lds
s_add_u32 s12, s12, 4096
s_mov_b32 m0, s12
s_nop 0
buffer_load_dwordx4 v2, s[60:63], s12 offen offset:0 nt lds
buffer_load_dwordx4 v2, s[60:63], s12 offen offset:1024 nt lds
buffer_load_dwordx4 v2, s[60:63], s12 offen offset:2048 nt lds
buffer_load_dwordx4 v2, s[60:63], s12 offen offset:3072 nt lds
s_add_u32 s12, s12, 4096
s_mov_b32 m0, s12
s_nop 0
buffer_load_dwordx4 v2, s[60:63], s12 offen offset:0 nt lds
buffer_load_dwordx4 v2, s[60:63], s12 offen offset:1024 nt lds
buffer_load_dwordx4 v2, s[60:63], s12 offen offset:2048 nt lds
buffer_load_dwordx4 v2, s[60:63], s12 offen offset:3072 nt lds
s_add_u32 s12, s12, 4096
s_mov_b32 m0, s12
s_nop 0
buffer_load_dwordx4 v2, s[60:63], s12 offen offset:0 nt lds
buffer_load_dwordx4 v2, s[60:63], s12 offen offset:1024 nt lds
buffer_load_dwordx4 v2, s[60:63], s12 offen offset:2048 nt lds
buffer_load_dwordx4 v2, s[60:63], s12 offen offset:3072 nt lds
s_add_u32 s12, s12, 4096
s_mov_b32 m0, s12
s_nop 0
buffer_load_dwordx4 v2, s[60:63], s12 offen offset:0 nt lds
buffer_load_dwordx4 v2, s[60:63], s12 offen offset:1024 nt lds
buffer_load_dwordx4 v2, s[60:63], s12 offen offset:2048 nt lds
buffer_load_dwordx4 v2, s[60:63], s12 offen offset:3072 nt lds
s_add_u32 s12, s12, 4096
s_mov_b32 m0, s12
s_nop 0
buffer_load_dwordx4 v2, s[60:63], s12 offen offset:0 nt lds
buffer_load_dwordx4 v2, s[60:63], s12 offen offset:1024 nt lds
buffer_load_dwordx4 v2, s[60:63], s12 offen offset:2048 nt lds
buffer_load_dwordx4 v2, s[60:63], s12 offen offset:3072 nt lds
s_add_u32 s12, s12, 4096
s_mov_b32 m0, s12
s_nop 0
buffer_load_dwordx4 v2, s[60:63], s12 offen offset:0 nt lds
buffer_load_dwordx4 v2, s[60:63], s12 offen offset:1024 nt lds
buffer_load_dwordx4 v2, s[60:63], s12 offen offset:2048 nt lds
buffer_load_dwordx4 v2, s[60:63], s12 offen offset:3072 nt lds
s_add_u32 s12, s12, 4096
s_mov_b32 m0, s12
s_nop 0
buffer_load_dwordx4 v2, s[60:63], s12 offen offset:0 nt lds
buffer_load_dwordx4 v2, s[60:63], s12 offen offset:1024 nt lds
buffer_load_dwordx4 v2, s[60:63], s12 offen offset:2048 nt lds
buffer_load_dwordx4 v2, s[60:63], s12 offen offset:3072 nt lds
s_add_u32 s12, s12, 4096
s_mov_b32 m0, s12
s_nop 0
buffer_load_dwordx4 v2, s[60:63], s12 offen offset:0 nt lds
buffer_load_dwordx4 v2, s[60:63], s12 offen offset:1024 nt lds
buffer_load_dwordx4 v2, s[60:63], s12 offen offset:2048 nt lds
buffer_load_dwordx4 v2, s[60:63], s12 offen offset:3072 nt lds
v_lshlrev_b32 v238, 18, v9
v_lshl_add_u32 v238, v8, 4, v238
s_mov_b32 s6, 0
buffer_load_dwordx4 v[88:91], v238, s[52:55], s6 offen nt
s_mov_b32 s6, 8192
buffer_load_dwordx4 v[92:95], v238, s[52:55], s6 offen nt
s_mov_b32 s6, 16384
buffer_load_dwordx4 v[96:99], v238, s[52:55], s6 offen nt
s_mov_b32 s6, 24576
buffer_load_dwordx4 v[100:103], v238, s[52:55], s6 offen nt
s_mov_b32 s6, 32768
buffer_load_dwordx4 v[104:107], v238, s[52:55], s6 offen nt
s_mov_b32 s6, 40960
buffer_load_dwordx4 v[108:111], v238, s[52:55], s6 offen nt
s_mov_b32 s6, 49152
buffer_load_dwordx4 v[112:115], v238, s[52:55], s6 offen nt
s_mov_b32 s6, 57344
buffer_load_dwordx4 v[116:119], v238, s[52:55], s6 offen nt
s_mov_b32 s6, 65536
buffer_load_dwordx4 v[120:123], v238, s[52:55], s6 offen nt
s_mov_b32 s6, 73728
buffer_load_dwordx4 v[124:127], v238, s[52:55], s6 offen nt
s_mov_b32 s6, 81920
buffer_load_dwordx4 v[128:131], v238, s[52:55], s6 offen nt
s_mov_b32 s6, 90112
buffer_load_dwordx4 v[132:135], v238, s[52:55], s6 offen nt
s_mov_b32 s6, 98304
buffer_load_dwordx4 v[136:139], v238, s[52:55], s6 offen nt
s_mov_b32 s6, 106496
buffer_load_dwordx4 v[140:143], v238, s[52:55], s6 offen nt
s_mov_b32 s6, 114688
buffer_load_dwordx4 v[144:147], v238, s[52:55], s6 offen nt
s_mov_b32 s6, 122880
buffer_load_dwordx4 v[148:151], v238, s[52:55], s6 offen nt
s_mov_b32 s6, 131072
buffer_load_dwordx4 v[152:155], v238, s[52:55], s6 offen nt
s_mov_b32 s6, 139264
buffer_load_dwordx4 v[156:159], v238, s[52:55], s6 offen nt
s_mov_b32 s6, 147456
buffer_load_dwordx4 v[160:163], v238, s[52:55], s6 offen nt
s_mov_b32 s6, 155648
buffer_load_dwordx4 v[164:167], v238, s[52:55], s6 offen nt
s_mov_b32 s6, 163840
buffer_load_dwordx4 v[168:171], v238, s[52:55], s6 offen nt
s_mov_b32 s6, 172032
buffer_load_dwordx4 v[172:175], v238, s[52:55], s6 offen nt
s_mov_b32 s6, 180224
buffer_load_dwordx4 v[176:179], v238, s[52:55], s6 offen nt
s_mov_b32 s6, 188416
buffer_load_dwordx4 v[180:183], v238, s[52:55], s6 offen nt
s_mov_b32 s6, 196608
buffer_load_dwordx4 v[184:187], v238, s[52:55], s6 offen nt
s_mov_b32 s6, 204800
s_waitcnt vmcnt(61)
buffer_load_dwordx4 v[188:191], v238, s[52:55], s6 offen nt
s_mov_b32 s6, 212992
s_waitcnt vmcnt(61)
buffer_load_dwordx4 v[192:195], v238, s[52:55], s6 offen nt
s_mov_b32 s6, 221184
s_waitcnt vmcnt(61)
buffer_load_dwordx4 v[196:199], v238, s[52:55], s6 offen nt
s_mov_b32 s6, 229376
s_waitcnt vmcnt(61)
buffer_load_dwordx4 v[200:203], v238, s[52:55], s6 offen nt
s_mov_b32 s6, 237568
s_waitcnt vmcnt(61)
buffer_load_dwordx4 v[204:207], v238, s[52:55], s6 offen nt
s_mov_b32 s6, 245760
s_waitcnt vmcnt(61)
buffer_load_dwordx4 v[208:211], v238, s[52:55], s6 offen nt
s_mov_b32 s6, 253952
s_waitcnt vmcnt(61)
buffer_load_dwordx4 v[212:215], v238, s[52:55], s6 offen nt
s_waitcnt vmcnt(32)
v_mov_b32 v11, 163824
v_mov_b32 v7, 0
ds_write_b32 v11, v7
s_waitcnt lgkmcnt(0)
s_barrier
ds_read_b64_tr_b16 a[96:97], v240 offset:0
ds_read_b64_tr_b16 a[98:99], v240 offset:4608
ds_read_b64_tr_b16 a[100:101], v240 offset:36864
ds_read_b64_tr_b16 a[102:103], v240 offset:41472
ds_read_b64_tr_b16 a[104:105], v242 offset:0
ds_read_b64_tr_b16 a[106:107], v242 offset:4608
ds_read_b64_tr_b16 a[108:109], v242 offset:36864
ds_read_b64_tr_b16 a[110:111], v242 offset:41472
ds_read_b64_tr_b16 a[112:113], v240 offset:8
ds_read_b64_tr_b16 a[114:115], v240 offset:4616
ds_read_b64_tr_b16 a[116:117], v240 offset:36872
ds_read_b64_tr_b16 a[118:119], v240 offset:41480
ds_read_b64_tr_b16 a[120:121], v242 offset:8
ds_read_b64_tr_b16 a[122:123], v242 offset:4616
ds_read_b64_tr_b16 a[124:125], v242 offset:36872
ds_read_b64_tr_b16 a[126:127], v242 offset:41480
ds_read_b64_tr_b16 a[128:129], v240 offset:16
ds_read_b64_tr_b16 a[130:131], v240 offset:4624
ds_read_b64_tr_b16 a[132:133], v240 offset:36880
ds_read_b64_tr_b16 a[134:135], v240 offset:41488
ds_read_b64_tr_b16 a[136:137], v242 offset:16
ds_read_b64_tr_b16 a[138:139], v242 offset:4624
ds_read_b64_tr_b16 a[140:141], v242 offset:36880
ds_read_b64_tr_b16 a[142:143], v242 offset:41488
ds_read_b64_tr_b16 a[144:145], v240 offset:24
ds_read_b64_tr_b16 a[146:147], v240 offset:4632
ds_read_b64_tr_b16 a[148:149], v240 offset:36888
ds_read_b64_tr_b16 a[150:151], v240 offset:41496
ds_read_b64_tr_b16 a[152:153], v242 offset:24
ds_read_b64_tr_b16 a[154:155], v242 offset:4632
ds_read_b64_tr_b16 a[156:157], v242 offset:36888
ds_read_b64_tr_b16 a[158:159], v242 offset:41496
ds_read_b64_tr_b16 a[160:161], v240 offset:128
ds_read_b64_tr_b16 a[162:163], v240 offset:4736
ds_read_b64_tr_b16 a[164:165], v240 offset:36992
ds_read_b64_tr_b16 a[166:167], v240 offset:41600
ds_read_b64_tr_b16 a[168:169], v242 offset:128
ds_read_b64_tr_b16 a[170:171], v242 offset:4736
ds_read_b64_tr_b16 a[172:173], v242 offset:36992
ds_read_b64_tr_b16 a[174:175], v242 offset:41600
ds_read_b64_tr_b16 a[176:177], v240 offset:136
ds_read_b64_tr_b16 a[178:179], v240 offset:4744
ds_read_b64_tr_b16 a[180:181], v240 offset:37000
ds_read_b64_tr_b16 a[182:183], v240 offset:41608
ds_read_b64_tr_b16 a[184:185], v242 offset:136
ds_read_b64_tr_b16 a[186:187], v242 offset:4744
ds_read_b64_tr_b16 a[188:189], v242 offset:37000
ds_read_b64_tr_b16 a[190:191], v242 offset:41608
ds_read_b64_tr_b16 a[192:193], v240 offset:144
ds_read_b64_tr_b16 a[194:195], v240 offset:4752
ds_read_b64_tr_b16 a[196:197], v240 offset:37008
ds_read_b64_tr_b16 a[198:199], v240 offset:41616
ds_read_b64_tr_b16 a[200:201], v242 offset:144
ds_read_b64_tr_b16 a[202:203], v242 offset:4752
ds_read_b64_tr_b16 a[204:205], v242 offset:37008
ds_read_b64_tr_b16 a[206:207], v242 offset:41616
ds_read_b64_tr_b16 a[208:209], v240 offset:152
ds_read_b64_tr_b16 a[210:211], v240 offset:4760
ds_read_b64_tr_b16 a[212:213], v240 offset:37016
ds_read_b64_tr_b16 a[214:215], v240 offset:41624
ds_read_b64_tr_b16 a[216:217], v242 offset:152
ds_read_b64_tr_b16 a[218:219], v242 offset:4760
ds_read_b64_tr_b16 a[220:221], v242 offset:37016
ds_read_b64_tr_b16 a[222:223], v242 offset:41624
ds_read_b64_tr_b16 a[224:225], v241 offset:0
ds_read_b64_tr_b16 a[226:227], v241 offset:4608
ds_read_b64_tr_b16 a[228:229], v241 offset:36864
ds_read_b64_tr_b16 a[230:231], v241 offset:41472
ds_read_b64_tr_b16 a[232:233], v243 offset:0
ds_read_b64_tr_b16 a[234:235], v243 offset:4608
ds_read_b64_tr_b16 a[236:237], v243 offset:36864
ds_read_b64_tr_b16 a[238:239], v243 offset:41472
v_and_b32 v6, 7, v1
v_lshlrev_b32 v6, 3, v6
s_lshl_b32 s6, s4, 8
s_lshl_b32 s7, s3, 6
s_add_u32 s6, s6, s7
s_add_u32 s6, s6, 262144
s_mov_b32 s7, 400000
P_poll:
buffer_load_dwordx2 v[232:233], v6, s[64:67], s6 offen sc1
s_waitcnt vmcnt(0)
v_max_u32 v234, v232, v233
v_cmp_eq_u32 vcc, -1, v234
s_cbranch_vccz P_ok
s_sleep 16
s_sub_u32 s7, s7, 1
s_cmp_lg_u32 s7, 0
s_cbranch_scc1 P_poll
P_ok:
s_lshl_b32 s6, s4, 15
s_lshl_b32 s7, s3, 13
s_add_u32 s6, s6, s7
s_add_u32 s6, s6, 1048576
buffer_load_dwordx4 v[24:27], v2, s[64:67], s6 offen offset:0 sc1
buffer_load_dwordx4 v[28:31], v2, s[64:67], s6 offen offset:1024 sc1
buffer_load_dwordx4 v[32:35], v2, s[64:67], s6 offen offset:2048 sc1
buffer_load_dwordx4 v[36:39], v2, s[64:67], s6 offen offset:3072 sc1
s_add_u32 s6, s6, 4096
buffer_load_dwordx4 v[40:43], v2, s[64:67], s6 offen offset:0 sc1
buffer_load_dwordx4 v[44:47], v2, s[64:67], s6 offen offset:1024 sc1
buffer_load_dwordx4 v[48:51], v2, s[64:67], s6 offen offset:2048 sc1
buffer_load_dwordx4 v[52:55], v2, s[64:67], s6 offen offset:3072 sc1
v_mov_b32 v234, v232
s_nop 1
v_max_f32_dpp v234, v234, v234 row_ror:4 row_mask:0xf bank_mask:0xf
s_nop 1
v_max_f32_dpp v234, v234, v234 row_ror:2 row_mask:0xf bank_mask:0xf
s_nop 1
v_max_f32_dpp v234, v234, v234 row_ror:1 row_mask:0xf bank_mask:0xf
v_sub_f32 v232, v232, v234
v_exp_f32 v232, v232
s_nop 0
v_mul_f32 v235, v232, v233
s_nop 1
v_add_f32_dpp v235, v235, v235 row_ror:4 row_mask:0xf bank_mask:0xf
s_nop 1
v_add_f32_dpp v235, v235, v235 row_ror:2 row_mask:0xf bank_mask:0xf
s_nop 1
v_add_f32_dpp v235, v235, v235 row_ror:1 row_mask:0xf bank_mask:0xf
v_rcp_f32 v235, v235
s_nop 0
v_mul_f32 v232, v232, v235
s_nop 0
v_readlane_b32 s26, v232, 0
v_readlane_b32 s27, v232, 1
v_readlane_b32 s28, v232, 2
v_readlane_b32 s29, v232, 3
v_readlane_b32 s30, v232, 4
v_readlane_b32 s31, v232, 5
v_readlane_b32 s32, v232, 6
v_readlane_b32 s33, v232, 7
s_mul_i32 s6, s3, 1040
s_add_u32 s6, s6, 147456
v_add_u32 v5, s6, v2
v_lshrrev_b32 v6, 3, v8
v_mul_u32_u24 v6, 1040, v6
v_lshl_add_u32 v6, v9, 6, v6
s_lshl_b32 s6, s3, 8
s_add_u32 s6, s6, 147456
v_add_u32 v6, s6, v6
s_waitcnt vmcnt(7)
v_lshlrev_b32 v244, 16, v24
v_and_b32 v245, 0xffff0000, v24
v_lshlrev_b32 v246, 16, v25
v_and_b32 v247, 0xffff0000, v25
v_lshlrev_b32 v248, 16, v26
v_and_b32 v249, 0xffff0000, v26
v_lshlrev_b32 v250, 16, v27
v_and_b32 v251, 0xffff0000, v27
v_mul_f32 v216, s26, v244
v_mul_f32 v217, s26, v245
v_mul_f32 v218, s26, v246
v_mul_f32 v219, s26, v247
v_mul_f32 v220, s26, v248
v_mul_f32 v221, s26, v249
v_mul_f32 v222, s26, v250
v_mul_f32 v223, s26, v251
s_waitcnt vmcnt(6)
v_lshlrev_b32 v244, 16, v28
v_and_b32 v245, 0xffff0000, v28
v_lshlrev_b32 v246, 16, v29
v_and_b32 v247, 0xffff0000, v29
v_lshlrev_b32 v248, 16, v30
v_and_b32 v249, 0xffff0000, v30
v_lshlrev_b32 v250, 16, v31
v_and_b32 v251, 0xffff0000, v31
v_fma_f32 v216, v244, s27, v216
v_fma_f32 v217, v245, s27, v217
v_fma_f32 v218, v246, s27, v218
v_fma_f32 v219, v247, s27, v219
v_fma_f32 v220, v248, s27, v220
v_fma_f32 v221, v249, s27, v221
v_fma_f32 v222, v250, s27, v222
v_fma_f32 v223, v251, s27, v223
s_waitcnt vmcnt(5)
v_lshlrev_b32 v244, 16, v32
v_and_b32 v245, 0xffff0000, v32
v_lshlrev_b32 v246, 16, v33
v_and_b32 v247, 0xffff0000, v33
v_lshlrev_b32 v248, 16, v34
v_and_b32 v249, 0xffff0000, v34
v_lshlrev_b32 v250, 16, v35
v_and_b32 v251, 0xffff0000, v35
v_fma_f32 v216, v244, s28, v216
v_fma_f32 v217, v245, s28, v217
v_fma_f32 v218, v246, s28, v218
v_fma_f32 v219, v247, s28, v219
v_fma_f32 v220, v248, s28, v220
v_fma_f32 v221, v249, s28, v221
v_fma_f32 v222, v250, s28, v222
v_fma_f32 v223, v251, s28, v223
s_waitcnt vmcnt(4)
v_lshlrev_b32 v244, 16, v36
v_and_b32 v245, 0xffff0000, v36
v_lshlrev_b32 v246, 16, v37
v_and_b32 v247, 0xffff0000, v37
v_lshlrev_b32 v248, 16, v38
v_and_b32 v249, 0xffff0000, v38
v_lshlrev_b32 v250, 16, v39
v_and_b32 v251, 0xffff0000, v39
v_fma_f32 v216, v244, s29, v216
v_fma_f32 v217, v245, s29, v217
v_fma_f32 v218, v246, s29, v218
v_fma_f32 v219, v247, s29, v219
v_fma_f32 v220, v248, s29, v220
v_fma_f32 v221, v249, s29, v221
v_fma_f32 v222, v250, s29, v222
v_fma_f32 v223, v251, s29, v223
s_waitcnt vmcnt(3)
v_lshlrev_b32 v244, 16, v40
v_and_b32 v245, 0xffff0000, v40
v_lshlrev_b32 v246, 16, v41
v_and_b32 v247, 0xffff0000, v41
v_lshlrev_b32 v248, 16, v42
v_and_b32 v249, 0xffff0000, v42
v_lshlrev_b32 v250, 16, v43
v_and_b32 v251, 0xffff0000, v43
v_fma_f32 v216, v244, s30, v216
v_fma_f32 v217, v245, s30, v217
v_fma_f32 v218, v246, s30, v218
v_fma_f32 v219, v247, s30, v219
v_fma_f32 v220, v248, s30, v220
v_fma_f32 v221, v249, s30, v221
v_fma_f32 v222, v250, s30, v222
v_fma_f32 v223, v251, s30, v223
s_waitcnt vmcnt(2)
v_lshlrev_b32 v244, 16, v44
v_and_b32 v245, 0xffff0000, v44
v_lshlrev_b32 v246, 16, v45
v_and_b32 v247, 0xffff0000, v45
v_lshlrev_b32 v248, 16, v46
v_and_b32 v249, 0xffff0000, v46
v_lshlrev_b32 v250, 16, v47
v_and_b32 v251, 0xffff0000, v47
v_fma_f32 v216, v244, s31, v216
v_fma_f32 v217, v245, s31, v217
v_fma_f32 v218, v246, s31, v218
v_fma_f32 v219, v247, s31, v219
v_fma_f32 v220, v248, s31, v220
v_fma_f32 v221, v249, s31, v221
v_fma_f32 v222, v250, s31, v222
v_fma_f32 v223, v251, s31, v223
s_waitcnt vmcnt(1)
v_lshlrev_b32 v244, 16, v48
v_and_b32 v245, 0xffff0000, v48
v_lshlrev_b32 v246, 16, v49
v_and_b32 v247, 0xffff0000, v49
v_lshlrev_b32 v248, 16, v50
v_and_b32 v249, 0xffff0000, v50
v_lshlrev_b32 v250, 16, v51
v_and_b32 v251, 0xffff0000, v51
v_fma_f32 v216, v244, s32, v216
v_fma_f32 v217, v245, s32, v217
v_fma_f32 v218, v246, s32, v218
v_fma_f32 v219, v247, s32, v219
v_fma_f32 v220, v248, s32, v220
v_fma_f32 v221, v249, s32, v221
v_fma_f32 v222, v250, s32, v222
v_fma_f32 v223, v251, s32, v223
s_waitcnt vmcnt(0)
v_lshlrev_b32 v244, 16, v52
v_and_b32 v245, 0xffff0000, v52
v_lshlrev_b32 v246, 16, v53
v_and_b32 v247, 0xffff0000, v53
v_lshlrev_b32 v248, 16, v54
v_and_b32 v249, 0xffff0000, v54
v_lshlrev_b32 v250, 16, v55
v_and_b32 v251, 0xffff0000, v55
v_fma_f32 v216, v244, s33, v216
v_fma_f32 v217, v245, s33, v217
v_fma_f32 v218, v246, s33, v218
v_fma_f32 v219, v247, s33, v219
v_fma_f32 v220, v248, s33, v220
v_fma_f32 v221, v249, s33, v221
v_fma_f32 v222, v250, s33, v222
v_fma_f32 v223, v251, s33, v223
v_cvt_pk_bf16_f32 v224, v216, v217
v_cvt_pk_bf16_f32 v225, v218, v219
v_cvt_pk_bf16_f32 v226, v220, v221
v_cvt_pk_bf16_f32 v227, v222, v223
ds_write_b128 v5, v[224:227]
s_waitcnt lgkmcnt(0)
s_barrier
ds_read_b128 v[24:27], v6 offset:0
ds_read_b128 v[44:47], v6 offset:2080
ds_read_b128 v[28:31], v6 offset:16
ds_read_b128 v[48:51], v6 offset:2096
ds_read_b128 v[32:35], v6 offset:32
ds_read_b128 v[52:55], v6 offset:2112
ds_read_b128 v[36:39], v6 offset:48
ds_read_b128 v[56:59], v6 offset:2128
v_lshrrev_b32 v5, 5, v1
v_mul_u32_u24 v5, 1088, v5
v_lshl_add_u32 v5, v8, 4, v5
v_and_b32 v7, 1, v9
v_lshl_add_u32 v5, v7, 3, v5
s_mul_i32 s6, s3, 272
s_add_u32 s6, s6, 155648
v_add_u32 v5, s6, v5
v_mul_u32_u24 v7, 272, v8
v_lshl_add_u32 v7, v9, 4, v7
v_add_u32 v7, 155648, v7
s_waitcnt lgkmcnt(0)
v_perm_b32 v64, v24, v24, v16
v_perm_b32 v65, v24, v24, v17
v_perm_b32 v66, v24, v24, v18
v_perm_b32 v67, v24, v24, v19
s_nop 1
v_mfma_f32_16x16x32_bf16 v[80:83], v[64:67], v[88:91], 0
v_perm_b32 v68, v44, v44, v16
v_perm_b32 v69, v44, v44, v17
v_perm_b32 v70, v44, v44, v18
v_perm_b32 v71, v44, v44, v19
s_nop 1
v_mfma_f32_16x16x32_bf16 v[84:87], v[68:71], v[88:91], 0
v_perm_b32 v72, v24, v24, v20
v_perm_b32 v73, v24, v24, v21
v_perm_b32 v74, v24, v24, v22
v_perm_b32 v75, v24, v24, v23
s_nop 1
v_mfma_f32_16x16x32_bf16 v[80:83], v[72:75], v[92:95], v[80:83]
v_perm_b32 v76, v44, v44, v20
v_perm_b32 v77, v44, v44, v21
v_perm_b32 v78, v44, v44, v22
v_perm_b32 v79, v44, v44, v23
s_nop 1
v_mfma_f32_16x16x32_bf16 v[84:87], v[76:79], v[92:95], v[84:87]
v_perm_b32 v64, v25, v25, v16
v_perm_b32 v65, v25, v25, v17
v_perm_b32 v66, v25, v25, v18
v_perm_b32 v67, v25, v25, v19
s_nop 1
v_mfma_f32_16x16x32_bf16 v[80:83], v[64:67], v[96:99], v[80:83]
v_perm_b32 v68, v45, v45, v16
v_perm_b32 v69, v45, v45, v17
v_perm_b32 v70, v45, v45, v18
v_perm_b32 v71, v45, v45, v19
s_nop 1
v_mfma_f32_16x16x32_bf16 v[84:87], v[68:71], v[96:99], v[84:87]
v_perm_b32 v72, v25, v25, v20
v_perm_b32 v73, v25, v25, v21
v_perm_b32 v74, v25, v25, v22
v_perm_b32 v75, v25, v25, v23
s_nop 1
v_mfma_f32_16x16x32_bf16 v[80:83], v[72:75], v[100:103], v[80:83]
v_perm_b32 v76, v45, v45, v20
v_perm_b32 v77, v45, v45, v21
v_perm_b32 v78, v45, v45, v22
v_perm_b32 v79, v45, v45, v23
s_nop 1
v_mfma_f32_16x16x32_bf16 v[84:87], v[76:79], v[100:103], v[84:87]
v_perm_b32 v64, v26, v26, v16
v_perm_b32 v65, v26, v26, v17
v_perm_b32 v66, v26, v26, v18
v_perm_b32 v67, v26, v26, v19
s_nop 1
v_mfma_f32_16x16x32_bf16 v[80:83], v[64:67], v[104:107], v[80:83]
v_perm_b32 v68, v46, v46, v16
v_perm_b32 v69, v46, v46, v17
v_perm_b32 v70, v46, v46, v18
v_perm_b32 v71, v46, v46, v19
s_nop 1
v_mfma_f32_16x16x32_bf16 v[84:87], v[68:71], v[104:107], v[84:87]
v_perm_b32 v72, v26, v26, v20
v_perm_b32 v73, v26, v26, v21
v_perm_b32 v74, v26, v26, v22
v_perm_b32 v75, v26, v26, v23
s_nop 1
v_mfma_f32_16x16x32_bf16 v[80:83], v[72:75], v[108:111], v[80:83]
v_perm_b32 v76, v46, v46, v20
v_perm_b32 v77, v46, v46, v21
v_perm_b32 v78, v46, v46, v22
v_perm_b32 v79, v46, v46, v23
s_nop 1
v_mfma_f32_16x16x32_bf16 v[84:87], v[76:79], v[108:111], v[84:87]
v_perm_b32 v64, v27, v27, v16
v_perm_b32 v65, v27, v27, v17
v_perm_b32 v66, v27, v27, v18
v_perm_b32 v67, v27, v27, v19
s_nop 1
v_mfma_f32_16x16x32_bf16 v[80:83], v[64:67], v[112:115], v[80:83]
v_perm_b32 v68, v47, v47, v16
v_perm_b32 v69, v47, v47, v17
v_perm_b32 v70, v47, v47, v18
v_perm_b32 v71, v47, v47, v19
s_nop 1
v_mfma_f32_16x16x32_bf16 v[84:87], v[68:71], v[112:115], v[84:87]
v_perm_b32 v72, v27, v27, v20
v_perm_b32 v73, v27, v27, v21
v_perm_b32 v74, v27, v27, v22
v_perm_b32 v75, v27, v27, v23
s_nop 1
v_mfma_f32_16x16x32_bf16 v[80:83], v[72:75], v[116:119], v[80:83]
v_perm_b32 v76, v47, v47, v20
v_perm_b32 v77, v47, v47, v21
v_perm_b32 v78, v47, v47, v22
v_perm_b32 v79, v47, v47, v23
s_nop 1
v_mfma_f32_16x16x32_bf16 v[84:87], v[76:79], v[116:119], v[84:87]
v_perm_b32 v64, v28, v28, v16
v_perm_b32 v65, v28, v28, v17
v_perm_b32 v66, v28, v28, v18
v_perm_b32 v67, v28, v28, v19
s_nop 1
v_mfma_f32_16x16x32_bf16 v[80:83], v[64:67], v[120:123], v[80:83]
v_perm_b32 v68, v48, v48, v16
v_perm_b32 v69, v48, v48, v17
v_perm_b32 v70, v48, v48, v18
v_perm_b32 v71, v48, v48, v19
s_nop 1
v_mfma_f32_16x16x32_bf16 v[84:87], v[68:71], v[120:123], v[84:87]
v_perm_b32 v72, v28, v28, v20
v_perm_b32 v73, v28, v28, v21
v_perm_b32 v74, v28, v28, v22
v_perm_b32 v75, v28, v28, v23
s_nop 1
v_mfma_f32_16x16x32_bf16 v[80:83], v[72:75], v[124:127], v[80:83]
v_perm_b32 v76, v48, v48, v20
v_perm_b32 v77, v48, v48, v21
v_perm_b32 v78, v48, v48, v22
v_perm_b32 v79, v48, v48, v23
s_nop 1
v_mfma_f32_16x16x32_bf16 v[84:87], v[76:79], v[124:127], v[84:87]
v_perm_b32 v64, v29, v29, v16
v_perm_b32 v65, v29, v29, v17
v_perm_b32 v66, v29, v29, v18
v_perm_b32 v67, v29, v29, v19
s_nop 1
v_mfma_f32_16x16x32_bf16 v[80:83], v[64:67], v[128:131], v[80:83]
v_perm_b32 v68, v49, v49, v16
v_perm_b32 v69, v49, v49, v17
v_perm_b32 v70, v49, v49, v18
v_perm_b32 v71, v49, v49, v19
s_nop 1
v_mfma_f32_16x16x32_bf16 v[84:87], v[68:71], v[128:131], v[84:87]
v_perm_b32 v72, v29, v29, v20
v_perm_b32 v73, v29, v29, v21
v_perm_b32 v74, v29, v29, v22
v_perm_b32 v75, v29, v29, v23
s_nop 1
v_mfma_f32_16x16x32_bf16 v[80:83], v[72:75], v[132:135], v[80:83]
v_perm_b32 v76, v49, v49, v20
v_perm_b32 v77, v49, v49, v21
v_perm_b32 v78, v49, v49, v22
v_perm_b32 v79, v49, v49, v23
s_nop 1
v_mfma_f32_16x16x32_bf16 v[84:87], v[76:79], v[132:135], v[84:87]
v_perm_b32 v64, v30, v30, v16
v_perm_b32 v65, v30, v30, v17
v_perm_b32 v66, v30, v30, v18
v_perm_b32 v67, v30, v30, v19
s_nop 1
v_mfma_f32_16x16x32_bf16 v[80:83], v[64:67], v[136:139], v[80:83]
v_perm_b32 v68, v50, v50, v16
v_perm_b32 v69, v50, v50, v17
v_perm_b32 v70, v50, v50, v18
v_perm_b32 v71, v50, v50, v19
s_nop 1
v_mfma_f32_16x16x32_bf16 v[84:87], v[68:71], v[136:139], v[84:87]
v_perm_b32 v72, v30, v30, v20
v_perm_b32 v73, v30, v30, v21
v_perm_b32 v74, v30, v30, v22
v_perm_b32 v75, v30, v30, v23
s_nop 1
v_mfma_f32_16x16x32_bf16 v[80:83], v[72:75], v[140:143], v[80:83]
v_perm_b32 v76, v50, v50, v20
v_perm_b32 v77, v50, v50, v21
v_perm_b32 v78, v50, v50, v22
v_perm_b32 v79, v50, v50, v23
s_nop 1
v_mfma_f32_16x16x32_bf16 v[84:87], v[76:79], v[140:143], v[84:87]
v_perm_b32 v64, v31, v31, v16
v_perm_b32 v65, v31, v31, v17
v_perm_b32 v66, v31, v31, v18
v_perm_b32 v67, v31, v31, v19
s_nop 1
v_mfma_f32_16x16x32_bf16 v[80:83], v[64:67], v[144:147], v[80:83]
v_perm_b32 v68, v51, v51, v16
v_perm_b32 v69, v51, v51, v17
v_perm_b32 v70, v51, v51, v18
v_perm_b32 v71, v51, v51, v19
s_nop 1
v_mfma_f32_16x16x32_bf16 v[84:87], v[68:71], v[144:147], v[84:87]
v_perm_b32 v72, v31, v31, v20
v_perm_b32 v73, v31, v31, v21
v_perm_b32 v74, v31, v31, v22
v_perm_b32 v75, v31, v31, v23
s_nop 1
v_mfma_f32_16x16x32_bf16 v[80:83], v[72:75], v[148:151], v[80:83]
v_perm_b32 v76, v51, v51, v20
v_perm_b32 v77, v51, v51, v21
v_perm_b32 v78, v51, v51, v22
v_perm_b32 v79, v51, v51, v23
s_nop 1
v_mfma_f32_16x16x32_bf16 v[84:87], v[76:79], v[148:151], v[84:87]
v_perm_b32 v64, v32, v32, v16
v_perm_b32 v65, v32, v32, v17
v_perm_b32 v66, v32, v32, v18
v_perm_b32 v67, v32, v32, v19
s_nop 1
v_mfma_f32_16x16x32_bf16 v[80:83], v[64:67], v[152:155], v[80:83]
v_perm_b32 v68, v52, v52, v16
v_perm_b32 v69, v52, v52, v17
v_perm_b32 v70, v52, v52, v18
v_perm_b32 v71, v52, v52, v19
s_nop 1
v_mfma_f32_16x16x32_bf16 v[84:87], v[68:71], v[152:155], v[84:87]
v_perm_b32 v72, v32, v32, v20
v_perm_b32 v73, v32, v32, v21
v_perm_b32 v74, v32, v32, v22
v_perm_b32 v75, v32, v32, v23
s_nop 1
v_mfma_f32_16x16x32_bf16 v[80:83], v[72:75], v[156:159], v[80:83]
v_perm_b32 v76, v52, v52, v20
v_perm_b32 v77, v52, v52, v21
v_perm_b32 v78, v52, v52, v22
v_perm_b32 v79, v52, v52, v23
s_nop 1
v_mfma_f32_16x16x32_bf16 v[84:87], v[76:79], v[156:159], v[84:87]
v_perm_b32 v64, v33, v33, v16
v_perm_b32 v65, v33, v33, v17
v_perm_b32 v66, v33, v33, v18
v_perm_b32 v67, v33, v33, v19
s_nop 1
v_mfma_f32_16x16x32_bf16 v[80:83], v[64:67], v[160:163], v[80:83]
v_perm_b32 v68, v53, v53, v16
v_perm_b32 v69, v53, v53, v17
v_perm_b32 v70, v53, v53, v18
v_perm_b32 v71, v53, v53, v19
s_nop 1
v_mfma_f32_16x16x32_bf16 v[84:87], v[68:71], v[160:163], v[84:87]
v_perm_b32 v72, v33, v33, v20
v_perm_b32 v73, v33, v33, v21
v_perm_b32 v74, v33, v33, v22
v_perm_b32 v75, v33, v33, v23
s_nop 1
v_mfma_f32_16x16x32_bf16 v[80:83], v[72:75], v[164:167], v[80:83]
v_perm_b32 v76, v53, v53, v20
v_perm_b32 v77, v53, v53, v21
v_perm_b32 v78, v53, v53, v22
v_perm_b32 v79, v53, v53, v23
s_nop 1
v_mfma_f32_16x16x32_bf16 v[84:87], v[76:79], v[164:167], v[84:87]
v_perm_b32 v64, v34, v34, v16
v_perm_b32 v65, v34, v34, v17
v_perm_b32 v66, v34, v34, v18
v_perm_b32 v67, v34, v34, v19
s_nop 1
v_mfma_f32_16x16x32_bf16 v[80:83], v[64:67], v[168:171], v[80:83]
v_perm_b32 v68, v54, v54, v16
v_perm_b32 v69, v54, v54, v17
v_perm_b32 v70, v54, v54, v18
v_perm_b32 v71, v54, v54, v19
s_nop 1
v_mfma_f32_16x16x32_bf16 v[84:87], v[68:71], v[168:171], v[84:87]
v_perm_b32 v72, v34, v34, v20
v_perm_b32 v73, v34, v34, v21
v_perm_b32 v74, v34, v34, v22
v_perm_b32 v75, v34, v34, v23
s_nop 1
v_mfma_f32_16x16x32_bf16 v[80:83], v[72:75], v[172:175], v[80:83]
v_perm_b32 v76, v54, v54, v20
v_perm_b32 v77, v54, v54, v21
v_perm_b32 v78, v54, v54, v22
v_perm_b32 v79, v54, v54, v23
s_nop 1
v_mfma_f32_16x16x32_bf16 v[84:87], v[76:79], v[172:175], v[84:87]
v_perm_b32 v64, v35, v35, v16
v_perm_b32 v65, v35, v35, v17
v_perm_b32 v66, v35, v35, v18
v_perm_b32 v67, v35, v35, v19
s_nop 1
v_mfma_f32_16x16x32_bf16 v[80:83], v[64:67], v[176:179], v[80:83]
v_perm_b32 v68, v55, v55, v16
v_perm_b32 v69, v55, v55, v17
v_perm_b32 v70, v55, v55, v18
v_perm_b32 v71, v55, v55, v19
s_nop 1
v_mfma_f32_16x16x32_bf16 v[84:87], v[68:71], v[176:179], v[84:87]
v_perm_b32 v72, v35, v35, v20
v_perm_b32 v73, v35, v35, v21
v_perm_b32 v74, v35, v35, v22
v_perm_b32 v75, v35, v35, v23
s_nop 1
v_mfma_f32_16x16x32_bf16 v[80:83], v[72:75], v[180:183], v[80:83]
v_perm_b32 v76, v55, v55, v20
v_perm_b32 v77, v55, v55, v21
v_perm_b32 v78, v55, v55, v22
v_perm_b32 v79, v55, v55, v23
s_nop 1
v_mfma_f32_16x16x32_bf16 v[84:87], v[76:79], v[180:183], v[84:87]
v_perm_b32 v64, v36, v36, v16
v_perm_b32 v65, v36, v36, v17
v_perm_b32 v66, v36, v36, v18
v_perm_b32 v67, v36, v36, v19
s_nop 1
v_mfma_f32_16x16x32_bf16 v[80:83], v[64:67], v[184:187], v[80:83]
v_perm_b32 v68, v56, v56, v16
v_perm_b32 v69, v56, v56, v17
v_perm_b32 v70, v56, v56, v18
v_perm_b32 v71, v56, v56, v19
s_nop 1
v_mfma_f32_16x16x32_bf16 v[84:87], v[68:71], v[184:187], v[84:87]
v_perm_b32 v72, v36, v36, v20
v_perm_b32 v73, v36, v36, v21
v_perm_b32 v74, v36, v36, v22
v_perm_b32 v75, v36, v36, v23
s_nop 1
v_mfma_f32_16x16x32_bf16 v[80:83], v[72:75], v[188:191], v[80:83]
v_perm_b32 v76, v56, v56, v20
v_perm_b32 v77, v56, v56, v21
v_perm_b32 v78, v56, v56, v22
v_perm_b32 v79, v56, v56, v23
s_nop 1
v_mfma_f32_16x16x32_bf16 v[84:87], v[76:79], v[188:191], v[84:87]
v_perm_b32 v64, v37, v37, v16
v_perm_b32 v65, v37, v37, v17
v_perm_b32 v66, v37, v37, v18
v_perm_b32 v67, v37, v37, v19
s_nop 1
v_mfma_f32_16x16x32_bf16 v[80:83], v[64:67], v[192:195], v[80:83]
v_perm_b32 v68, v57, v57, v16
v_perm_b32 v69, v57, v57, v17
v_perm_b32 v70, v57, v57, v18
v_perm_b32 v71, v57, v57, v19
s_nop 1
v_mfma_f32_16x16x32_bf16 v[84:87], v[68:71], v[192:195], v[84:87]
v_perm_b32 v72, v37, v37, v20
v_perm_b32 v73, v37, v37, v21
v_perm_b32 v74, v37, v37, v22
v_perm_b32 v75, v37, v37, v23
s_nop 1
v_mfma_f32_16x16x32_bf16 v[80:83], v[72:75], v[196:199], v[80:83]
v_perm_b32 v76, v57, v57, v20
v_perm_b32 v77, v57, v57, v21
v_perm_b32 v78, v57, v57, v22
v_perm_b32 v79, v57, v57, v23
s_nop 1
v_mfma_f32_16x16x32_bf16 v[84:87], v[76:79], v[196:199], v[84:87]
v_perm_b32 v64, v38, v38, v16
v_perm_b32 v65, v38, v38, v17
v_perm_b32 v66, v38, v38, v18
v_perm_b32 v67, v38, v38, v19
s_nop 1
v_mfma_f32_16x16x32_bf16 v[80:83], v[64:67], v[200:203], v[80:83]
v_perm_b32 v68, v58, v58, v16
v_perm_b32 v69, v58, v58, v17
v_perm_b32 v70, v58, v58, v18
v_perm_b32 v71, v58, v58, v19
s_nop 1
v_mfma_f32_16x16x32_bf16 v[84:87], v[68:71], v[200:203], v[84:87]
v_perm_b32 v72, v38, v38, v20
v_perm_b32 v73, v38, v38, v21
v_perm_b32 v74, v38, v38, v22
v_perm_b32 v75, v38, v38, v23
s_nop 1
v_mfma_f32_16x16x32_bf16 v[80:83], v[72:75], v[204:207], v[80:83]
v_perm_b32 v76, v58, v58, v20
v_perm_b32 v77, v58, v58, v21
v_perm_b32 v78, v58, v58, v22
v_perm_b32 v79, v58, v58, v23
s_nop 1
v_mfma_f32_16x16x32_bf16 v[84:87], v[76:79], v[204:207], v[84:87]
v_perm_b32 v64, v39, v39, v16
v_perm_b32 v65, v39, v39, v17
v_perm_b32 v66, v39, v39, v18
v_perm_b32 v67, v39, v39, v19
s_nop 1
v_mfma_f32_16x16x32_bf16 v[80:83], v[64:67], v[208:211], v[80:83]
v_perm_b32 v68, v59, v59, v16
v_perm_b32 v69, v59, v59, v17
v_perm_b32 v70, v59, v59, v18
v_perm_b32 v71, v59, v59, v19
s_nop 1
v_mfma_f32_16x16x32_bf16 v[84:87], v[68:71], v[208:211], v[84:87]
v_perm_b32 v72, v39, v39, v20
v_perm_b32 v73, v39, v39, v21
v_perm_b32 v74, v39, v39, v22
v_perm_b32 v75, v39, v39, v23
s_nop 1
v_mfma_f32_16x16x32_bf16 v[80:83], v[72:75], v[212:215], v[80:83]
v_perm_b32 v76, v59, v59, v20
v_perm_b32 v77, v59, v59, v21
v_perm_b32 v78, v59, v59, v22
v_perm_b32 v79, v59, v59, v23
s_nop 1
v_mfma_f32_16x16x32_bf16 v[84:87], v[76:79], v[212:215], v[84:87]
s_nop 0
v_cvt_pk_bf16_f32 v244, v80, v81
v_cvt_pk_bf16_f32 v245, v82, v83
ds_write_b64 v5, v[244:245] offset:0
s_nop 3
v_cvt_pk_bf16_f32 v246, v84, v85
v_cvt_pk_bf16_f32 v247, v86, v87
ds_write_b64 v5, v[246:247] offset:2176
s_waitcnt lgkmcnt(0)
s_barrier
ds_read_b128 v[64:67], v7 offset:0
ds_read_b128 v[68:71], v7 offset:64
ds_read_b128 v[72:75], v7 offset:128
ds_read_b128 v[76:79], v7 offset:192
v_mul_u32_u24 v5, 73728, v9
v_and_b32 v6, 3, v1
v_bfe_u32 v7, v1, 2, 2
v_lshl_add_u32 v6, v6, 2, v7
v_lshl_add_u32 v6, v6, 2, v5
v_lshl_add_u32 v5, v8, 4, v5
s_mul_i32 s6, s4, 2304
s_mul_i32 s7, s3, 576
s_add_u32 s6, s6, s7
s_add_u32 s6, s6, 5242880
s_waitcnt lgkmcnt(0)
v_mfma_f32_16x16x32_bf16 v[24:27], v[64:67], a[96:99], 0
v_mfma_f32_16x16x32_bf16 v[24:27], v[68:71], a[100:103], v[24:27]
v_mfma_f32_16x16x32_bf16 v[24:27], v[72:75], a[104:107], v[24:27]
v_mfma_f32_16x16x32_bf16 v[24:27], v[76:79], a[108:111], v[24:27]
v_mfma_f32_16x16x32_bf16 v[28:31], v[64:67], a[112:115], 0
v_mfma_f32_16x16x32_bf16 v[28:31], v[68:71], a[116:119], v[28:31]
v_mfma_f32_16x16x32_bf16 v[28:31], v[72:75], a[120:123], v[28:31]
v_mfma_f32_16x16x32_bf16 v[28:31], v[76:79], a[124:127], v[28:31]
v_mfma_f32_16x16x32_bf16 v[32:35], v[64:67], a[128:131], 0
v_mfma_f32_16x16x32_bf16 v[32:35], v[68:71], a[132:135], v[32:35]
v_mfma_f32_16x16x32_bf16 v[32:35], v[72:75], a[136:139], v[32:35]
v_mfma_f32_16x16x32_bf16 v[32:35], v[76:79], a[140:143], v[32:35]
v_mfma_f32_16x16x32_bf16 v[36:39], v[64:67], a[144:147], 0
v_mfma_f32_16x16x32_bf16 v[36:39], v[68:71], a[148:151], v[36:39]
v_mfma_f32_16x16x32_bf16 v[36:39], v[72:75], a[152:155], v[36:39]
v_mfma_f32_16x16x32_bf16 v[36:39], v[76:79], a[156:159], v[36:39]
v_mfma_f32_16x16x32_bf16 v[40:43], v[64:67], a[160:163], 0
v_mfma_f32_16x16x32_bf16 v[40:43], v[68:71], a[164:167], v[40:43]
v_mfma_f32_16x16x32_bf16 v[40:43], v[72:75], a[168:171], v[40:43]
v_mfma_f32_16x16x32_bf16 v[40:43], v[76:79], a[172:175], v[40:43]
v_mfma_f32_16x16x32_bf16 v[44:47], v[64:67], a[176:179], 0
v_mfma_f32_16x16x32_bf16 v[44:47], v[68:71], a[180:183], v[44:47]
v_mfma_f32_16x16x32_bf16 v[44:47], v[72:75], a[184:187], v[44:47]
v_mfma_f32_16x16x32_bf16 v[44:47], v[76:79], a[188:191], v[44:47]
v_mfma_f32_16x16x32_bf16 v[48:51], v[64:67], a[192:195], 0
v_mfma_f32_16x16x32_bf16 v[48:51], v[68:71], a[196:199], v[48:51]
v_mfma_f32_16x16x32_bf16 v[48:51], v[72:75], a[200:203], v[48:51]
v_mfma_f32_16x16x32_bf16 v[48:51], v[76:79], a[204:207], v[48:51]
v_mfma_f32_16x16x32_bf16 v[52:55], v[64:67], a[208:211], 0
v_mfma_f32_16x16x32_bf16 v[52:55], v[68:71], a[212:215], v[52:55]
v_mfma_f32_16x16x32_bf16 v[52:55], v[72:75], a[216:219], v[52:55]
v_mfma_f32_16x16x32_bf16 v[52:55], v[76:79], a[220:223], v[52:55]
v_mfma_f32_16x16x32_bf16 v[56:59], v[64:67], a[224:227], 0
v_mfma_f32_16x16x32_bf16 v[56:59], v[68:71], a[228:231], v[56:59]
v_mfma_f32_16x16x32_bf16 v[56:59], v[72:75], a[232:235], v[56:59]
v_mfma_f32_16x16x32_bf16 v[56:59], v[76:79], a[236:239], v[56:59]
v_add_f32 v24, v24, v25
v_add_f32 v26, v26, v27
v_add_f32 v216, v24, v26
v_min_u32 v216, -2, v216
v_add_f32 v28, v28, v29
v_add_f32 v30, v30, v31
v_add_f32 v217, v28, v30
v_min_u32 v217, -2, v217
v_add_f32 v32, v32, v33
v_add_f32 v34, v34, v35
v_add_f32 v218, v32, v34
v_min_u32 v218, -2, v218
v_add_f32 v36, v36, v37
v_add_f32 v38, v38, v39
v_add_f32 v219, v36, v38
v_min_u32 v219, -2, v219
v_add_f32 v40, v40, v41
v_add_f32 v42, v42, v43
v_add_f32 v220, v40, v42
v_min_u32 v220, -2, v220
v_add_f32 v44, v44, v45
v_add_f32 v46, v46, v47
v_add_f32 v221, v44, v46
v_min_u32 v221, -2, v221
v_add_f32 v48, v48, v49
v_add_f32 v50, v50, v51
v_add_f32 v222, v48, v50
v_min_u32 v222, -2, v222
v_add_f32 v52, v52, v53
v_add_f32 v54, v54, v55
v_add_f32 v223, v52, v54
v_min_u32 v223, -2, v223
v_add_f32 v56, v56, v57
v_add_f32 v58, v58, v59
v_add_f32 v224, v56, v58
v_min_u32 v224, -2, v224
buffer_store_dwordx4 v[216:219], v5, s[64:67], s6 offen sc1
buffer_store_dwordx4 v[220:223], v5, s[64:67], s6 offen offset:256 sc1
buffer_store_dword v224, v6, s[64:67], s6 offen offset:512 sc1
s_nop 1
s_branch B_final
D_role:
s_lshr_b32 s10, s4, 3
s_and_b32 s11, s4, 7
v_xor_b32 v10, 32, v2
v_mov_b32 v76, -1
v_mov_b32 v77, -1
v_mov_b32 v78, -1
v_mov_b32 v79, -1
s_waitcnt lgkmcnt(0)
s_mov_b32 s64, s42
s_mov_b32 s65, s43
s_mov_b32 s66, 6291456
s_mov_b32 s67, 0x20000
s_lshl_b32 s6, s10, 22
s_add_u32 s52, s28, s6
s_addc_u32 s53, s29, 0
s_mov_b32 s54, 4194304
s_mov_b32 s55, 0x20000
s_cmp_eq_u32 s3, 3
s_cbranch_scc1 L_clr3_17
s_add_u32 s6, s9, s3
s_sub_u32 s6, s6, 1
s_cmp_eq_u32 s3, 2
s_cselect_b32 s6, s4, s6
s_cselect_b32 s7, 1, 0
s_mul_i32 s7, s7, 1048576
s_mul_i32 s6, s6, 9216
s_add_u32 s6, s6, s7
s_add_u32 s6, s6, 4194304
buffer_store_dwordx4 v[76:79], v2, s[64:67], s6 offen offset:0 sc1
buffer_store_dwordx4 v[76:79], v2, s[64:67], s6 offen offset:1024 sc1
buffer_store_dwordx4 v[76:79], v2, s[64:67], s6 offen offset:2048 sc1
buffer_store_dwordx4 v[76:79], v2, s[64:67], s6 offen offset:3072 sc1
s_add_u32 s6, s6, 4096
buffer_store_dwordx4 v[76:79], v2, s[64:67], s6 offen offset:0 sc1
buffer_store_dwordx4 v[76:79], v2, s[64:67], s6 offen offset:1024 sc1
buffer_store_dwordx4 v[76:79], v2, s[64:67], s6 offen offset:2048 sc1
buffer_store_dwordx4 v[76:79], v2, s[64:67], s6 offen offset:3072 sc1
s_add_u32 s6, s6, 4096
buffer_store_dwordx4 v[76:79], v2, s[64:67], s6 offen offset:0 sc1
s_branch L_clrd_18
L_clr3_17:
s_lshl_b32 s6, s4, 12
s_add_u32 s6, s6, 0
buffer_store_dwordx4 v[76:79], v2, s[64:67], s6 offen offset:0 sc1
buffer_store_dwordx4 v[76:79], v2, s[64:67], s6 offen offset:1024 sc1
buffer_store_dwordx4 v[76:79], v2, s[64:67], s6 offen offset:2048 sc1
buffer_store_dwordx4 v[76:79], v2, s[64:67], s6 offen offset:3072 sc1
s_mov_b64 exec, 0xffff
s_lshl_b32 s6, s4, 8
s_add_u32 s7, s6, 327680
s_add_u32 s6, s6, 262144
buffer_store_dwordx4 v[76:79], v2, s[64:67], s6 offen sc1
buffer_store_dwordx4 v[76:79], v2, s[64:67], s7 offen sc1
s_mov_b64 exec, 3
s_lshl_b32 s6, s4, 5
s_add_u32 s6, s6, 393216
buffer_store_dwordx4 v[76:79], v2, s[64:67], s6 offen sc1
s_mov_b64 exec, -1
L_clrd_18:
s_mov_b32 s68, s40
s_mov_b32 s69, s41
s_mov_b32 s70, 256
s_mov_b32 s71, 0x20000
s_mov_b32 s72, s38
s_mov_b32 s73, s39
s_mov_b32 s74, 9216
s_mov_b32 s75, 0x20000
s_mul_i32 s12, s3, 17408
s_lshl_b32 s13, s11, 2
s_add_u32 s13, s13, s3
s_lshl_b32 s13, s13, 12
s_add_u32 m0, s12, 0
s_add_u32 s6, s13, 0
buffer_load_dwordx4 v2, s[52:55], s6 offen nt lds
s_add_u32 m0, s12, 1088
s_add_u32 s6, s13, 1024
buffer_load_dwordx4 v2, s[52:55], s6 offen nt lds
s_add_u32 m0, s12, 2176
s_add_u32 s6, s13, 2048
buffer_load_dwordx4 v2, s[52:55], s6 offen nt lds
s_add_u32 m0, s12, 3264
s_add_u32 s6, s13, 3072
buffer_load_dwordx4 v2, s[52:55], s6 offen nt lds
s_add_u32 m0, s12, 4352
s_add_u32 s6, s13, 131072
buffer_load_dwordx4 v2, s[52:55], s6 offen nt lds
s_add_u32 m0, s12, 5440
s_add_u32 s6, s13, 132096
buffer_load_dwordx4 v2, s[52:55], s6 offen nt lds
s_add_u32 m0, s12, 6528
s_add_u32 s6, s13, 133120
buffer_load_dwordx4 v2, s[52:55], s6 offen nt lds
s_add_u32 m0, s12, 7616
s_add_u32 s6, s13, 134144
buffer_load_dwordx4 v2, s[52:55], s6 offen nt lds
s_waitcnt vmcnt(8)
v_mov_b32 v7, 1
s_mov_b64 exec, 1
buffer_atomic_add v7, off, s[68:71], 0 offset:0
s_mov_b64 exec, -1
s_add_u32 m0, s12, 8704
s_add_u32 s6, s13, 262144
buffer_load_dwordx4 v10, s[52:55], s6 offen nt lds
s_add_u32 m0, s12, 9792
s_add_u32 s6, s13, 263168
buffer_load_dwordx4 v10, s[52:55], s6 offen nt lds
s_add_u32 m0, s12, 10880
s_add_u32 s6, s13, 264192
buffer_load_dwordx4 v10, s[52:55], s6 offen nt lds
s_add_u32 m0, s12, 11968
s_add_u32 s6, s13, 265216
buffer_load_dwordx4 v10, s[52:55], s6 offen nt lds
s_add_u32 m0, s12, 13056
s_add_u32 s6, s13, 393216
buffer_load_dwordx4 v10, s[52:55], s6 offen nt lds
s_add_u32 m0, s12, 14144
s_add_u32 s6, s13, 394240
buffer_load_dwordx4 v10, s[52:55], s6 offen nt lds
s_add_u32 m0, s12, 15232
s_add_u32 s6, s13, 395264
buffer_load_dwordx4 v10, s[52:55], s6 offen nt lds
s_add_u32 m0, s12, 16320
s_add_u32 s6, s13, 396288
buffer_load_dwordx4 v10, s[52:55], s6 offen nt lds
s_add_u32 m0, s12, 69632
s_add_u32 s6, s13, 524288
buffer_load_dwordx4 v2, s[52:55], s6 offen nt lds
s_add_u32 m0, s12, 70720
s_add_u32 s6, s13, 525312
buffer_load_dwordx4 v2, s[52:55], s6 offen nt lds
s_add_u32 m0, s12, 71808
s_add_u32 s6, s13, 526336
buffer_load_dwordx4 v2, s[52:55], s6 offen nt lds
s_add_u32 m0, s12, 72896
s_add_u32 s6, s13, 527360
buffer_load_dwordx4 v2, s[52:55], s6 offen nt lds
s_add_u32 m0, s12, 73984
s_add_u32 s6, s13, 655360
buffer_load_dwordx4 v2, s[52:55], s6 offen nt lds
s_add_u32 m0, s12, 75072
s_add_u32 s6, s13, 656384
buffer_load_dwordx4 v2, s[52:55], s6 offen nt lds
s_add_u32 m0, s12, 76160
s_add_u32 s6, s13, 657408
buffer_load_dwordx4 v2, s[52:55], s6 offen nt lds
s_add_u32 m0, s12, 77248
s_add_u32 s6, s13, 658432
buffer_load_dwordx4 v2, s[52:55], s6 offen nt lds
s_add_u32 m0, s12, 78336
s_add_u32 s6, s13, 786432
buffer_load_dwordx4 v10, s[52:55], s6 offen nt lds
s_add_u32 m0, s12, 79424
s_add_u32 s6, s13, 787456
buffer_load_dwordx4 v10, s[52:55], s6 offen nt lds
s_add_u32 m0, s12, 80512
s_add_u32 s6, s13, 788480
buffer_load_dwordx4 v10, s[52:55], s6 offen nt lds
s_add_u32 m0, s12, 81600
s_add_u32 s6, s13, 789504
buffer_load_dwordx4 v10, s[52:55], s6 offen nt lds
s_add_u32 m0, s12, 82688
s_add_u32 s6, s13, 917504
buffer_load_dwordx4 v10, s[52:55], s6 offen nt lds
s_add_u32 m0, s12, 83776
s_add_u32 s6, s13, 918528
buffer_load_dwordx4 v10, s[52:55], s6 offen nt lds
s_add_u32 m0, s12, 84864
s_add_u32 s6, s13, 919552
buffer_load_dwordx4 v10, s[52:55], s6 offen nt lds
s_add_u32 m0, s12, 85952
s_add_u32 s6, s13, 920576
buffer_load_dwordx4 v10, s[52:55], s6 offen nt lds
s_add_u32 s6, s13, 1048576
buffer_load_dwordx4 a[128:131], v2, s[52:55], s6 offen nt
s_add_u32 s6, s13, 1049600
buffer_load_dwordx4 a[132:135], v2, s[52:55], s6 offen nt
s_add_u32 s6, s13, 1050624
buffer_load_dwordx4 a[136:139], v2, s[52:55], s6 offen nt
s_add_u32 s6, s13, 1051648
buffer_load_dwordx4 a[140:143], v2, s[52:55], s6 offen nt
s_add_u32 s6, s13, 1179648
buffer_load_dwordx4 a[144:147], v2, s[52:55], s6 offen nt
s_add_u32 s6, s13, 1180672
buffer_load_dwordx4 a[148:151], v2, s[52:55], s6 offen nt
s_add_u32 s6, s13, 1181696
buffer_load_dwordx4 a[152:155], v2, s[52:55], s6 offen nt
s_add_u32 s6, s13, 1182720
buffer_load_dwordx4 a[156:159], v2, s[52:55], s6 offen nt
s_add_u32 s6, s13, 1310720
buffer_load_dwordx4 a[160:163], v10, s[52:55], s6 offen nt
s_add_u32 s6, s13, 1311744
buffer_load_dwordx4 a[164:167], v10, s[52:55], s6 offen nt
s_add_u32 s6, s13, 1312768
buffer_load_dwordx4 a[168:171], v10, s[52:55], s6 offen nt
s_add_u32 s6, s13, 1313792
buffer_load_dwordx4 a[172:175], v10, s[52:55], s6 offen nt
s_add_u32 s6, s13, 1441792
buffer_load_dwordx4 a[176:179], v10, s[52:55], s6 offen nt
s_add_u32 s6, s13, 1442816
buffer_load_dwordx4 a[180:183], v10, s[52:55], s6 offen nt
s_add_u32 s6, s13, 1443840
buffer_load_dwordx4 a[184:187], v10, s[52:55], s6 offen nt
s_add_u32 s6, s13, 1444864
buffer_load_dwordx4 a[188:191], v10, s[52:55], s6 offen nt
s_add_u32 s6, s13, 1572864
buffer_load_dwordx4 a[192:195], v2, s[52:55], s6 offen nt
s_add_u32 s6, s13, 1573888
buffer_load_dwordx4 a[196:199], v2, s[52:55], s6 offen nt
s_add_u32 s6, s13, 1574912
buffer_load_dwordx4 a[200:203], v2, s[52:55], s6 offen nt
s_add_u32 s6, s13, 1575936
buffer_load_dwordx4 a[204:207], v2, s[52:55], s6 offen nt
s_add_u32 s6, s13, 1703936
buffer_load_dwordx4 a[208:211], v2, s[52:55], s6 offen nt
s_add_u32 s6, s13, 1704960
buffer_load_dwordx4 a[212:215], v2, s[52:55], s6 offen nt
s_add_u32 s6, s13, 1705984
buffer_load_dwordx4 a[216:219], v2, s[52:55], s6 offen nt
s_add_u32 s6, s13, 1707008
buffer_load_dwordx4 a[220:223], v2, s[52:55], s6 offen nt
s_add_u32 s6, s13, 1835008
buffer_load_dwordx4 a[224:227], v10, s[52:55], s6 offen nt
s_add_u32 s6, s13, 1836032
buffer_load_dwordx4 a[228:231], v10, s[52:55], s6 offen nt
s_add_u32 s6, s13, 1837056
buffer_load_dwordx4 a[232:235], v10, s[52:55], s6 offen nt
s_add_u32 s6, s13, 1838080
buffer_load_dwordx4 a[236:239], v10, s[52:55], s6 offen nt
s_add_u32 s6, s13, 1966080
buffer_load_dwordx4 a[240:243], v10, s[52:55], s6 offen nt
s_add_u32 s6, s13, 1967104
s_waitcnt vmcnt(60)
buffer_load_dwordx4 a[244:247], v10, s[52:55], s6 offen nt
s_add_u32 s6, s13, 1968128
s_waitcnt vmcnt(60)
buffer_load_dwordx4 a[248:251], v10, s[52:55], s6 offen nt
s_add_u32 s6, s13, 1969152
s_waitcnt vmcnt(60)
buffer_load_dwordx4 a[252:255], v10, s[52:55], s6 offen nt
s_waitcnt vmcnt(60)
buffer_load_dword v11, off, s[68:71], 0 offset:0 sc1
s_lshl_b32 s14, s10, 15
s_lshl_b32 s6, s3, 12
s_add_u32 s14, s14, s6
s_add_u32 s14, s14, 0
s_add_u32 s15, s14, 16384
s_lshl_b32 s6, s3, 4
v_add_u32 v5, s6, v8
v_mul_u32_u24 v5, 1088, v5
v_lshrrev_b32 v6, 3, v8
v_lshlrev_b32 v6, 1, v6
v_xor_b32 v6, v6, v9
v_lshl_add_u32 v194, v6, 4, v5
v_add_u32 v195, 69632, v194
v_lshrrev_b32 v5, 5, v1
v_lshlrev_b32 v5, 3, v5
v_bfe_u32 v6, v1, 2, 2
v_add_u32 v5, v5, v6
v_mul_u32_u24 v5, 1088, v5
v_lshrrev_b32 v6, 1, v9
v_xor_b32 v6, v6, v9
v_and_b32 v6, 1, v6
v_lshl_add_u32 v5, v6, 5, v5
v_and_b32 v6, 3, v1
v_lshl_add_u32 v5, v6, 3, v5
s_lshl_b32 s6, s3, 8
v_add_u32 v196, s6, v5
v_add_u32 v197, 69632, v196
v_lshlrev_b32 v199, 4, v8
v_add_u32 v199, 160256, v199
s_lshl_b32 s6, s3, 2
v_add_u32 v198, s6, v199
v_and_b32 v5, 31, v1
v_lshlrev_b32 v200, 4, v5
v_add_u32 v200, 160256, v200
v_lshlrev_b32 v202, 5, v5
v_lshrrev_b32 v6, 5, v1
v_lshl_add_u32 v202, v6, 4, v202
v_add_u32 v202, 156160, v202
v_lshlrev_b32 v201, 5, v8
v_lshl_add_u32 v201, v9, 3, v201
s_lshl_b32 s6, s3, 10
s_add_u32 s6, s6, 156160
v_add_u32 v201, s6, v201
v_mul_u32_u24 v203, 1056, v8
v_lshl_add_u32 v203, v9, 4, v203
v_add_u32 v203, 139264, v203
s_mul_i32 s6, s3, 4224
s_add_u32 s6, s6, 139264
v_add_u32 v204, s6, v2
v_add_u32 v206, s12, v2
v_add_u32 v207, 69632, v206
v_mov_b32 v185, 0x3e0293ee
v_mov_b32 v176, 0xff800000
v_mov_b32 v177, 0xff800000
v_mov_b32 v178, 0xff800000
v_mov_b32 v180, 0
v_mov_b32 v181, 0
s_waitcnt vmcnt(0)
s_mov_b32 s7, 400000
L_ens_19:
v_readfirstlane_b32 s6, v11
s_cmp_ge_u32 s6, 128
s_cbranch_scc1 L_ensd_20
s_sleep 16
buffer_load_dword v11, off, s[68:71], 0 offset:0 sc1
s_waitcnt vmcnt(0)
s_sub_u32 s7, s7, 1
s_cmp_lg_u32 s7, 0
s_cbranch_scc1 L_ens_19
L_ensd_20:
s_mov_b32 s7, 400000
v_and_b32 v5, 3, v1
v_bfe_u32 v6, v1, 2, 1
v_lshl_add_u32 v5, v6, 4, v5
v_lshlrev_b32 v5, 10, v5
Q_slow:
buffer_load_dword v192, v5, s[64:67], s14 offen offset:768 sc1
s_waitcnt vmcnt(0)
v_cmp_eq_u32 vcc, -1, v192
s_cbranch_vccz Q_chk
s_sleep 8
s_sub_u32 s7, s7, 1
s_cmp_lg_u32 s7, 1
s_cbranch_scc1 Q_slow
Q_chk:
buffer_load_dwordx4 v[84:87], v2, s[64:67], s14 offen offset:0 sc1
buffer_load_dwordx4 v[88:91], v2, s[64:67], s14 offen offset:1024 sc1
buffer_load_dwordx4 v[92:95], v2, s[64:67], s14 offen offset:2048 sc1
buffer_load_dwordx4 v[96:99], v2, s[64:67], s14 offen offset:3072 sc1
buffer_load_dwordx4 v[100:103], v2, s[64:67], s15 offen offset:0 sc1
buffer_load_dwordx4 v[104:107], v2, s[64:67], s15 offen offset:1024 sc1
buffer_load_dwordx4 v[108:111], v2, s[64:67], s15 offen offset:2048 sc1
buffer_load_dwordx4 v[112:115], v2, s[64:67], s15 offen offset:3072 sc1
s_waitcnt vmcnt(0)
v_max3_u32 v192, v84, v85, v86
v_max3_u32 v192, v192, v87, v88
v_max3_u32 v192, v192, v89, v90
v_max3_u32 v192, v192, v91, v92
v_max3_u32 v192, v192, v93, v94
v_max3_u32 v192, v192, v95, v96
v_max3_u32 v192, v192, v97, v98
v_max3_u32 v192, v192, v99, v100
v_max3_u32 v192, v192, v101, v102
v_max3_u32 v192, v192, v103, v104
v_max3_u32 v192, v192, v105, v106
v_max3_u32 v192, v192, v107, v108
v_max3_u32 v192, v192, v109, v110
v_max3_u32 v192, v192, v111, v112
v_max3_u32 v192, v192, v113, v114
v_max_u32 v192, v192, v115
v_cmp_eq_u32 vcc, -1, v192
s_cbranch_vccz Q_ok
s_sleep 16
s_sub_u32 s7, s7, 1
s_cmp_lg_u32 s7, 0
s_cbranch_scc1 Q_chk
Q_ok:
ds_write_b128 v204, v[84:87] offset:0
ds_write_b128 v204, v[88:91] offset:1056
ds_write_b128 v204, v[92:95] offset:2112
ds_write_b128 v204, v[96:99] offset:3168
s_waitcnt lgkmcnt(0)
s_barrier
ds_read_b128 a[0:3], v203 offset:0
ds_read_b128 a[4:7], v203 offset:64
ds_read_b128 a[8:11], v203 offset:128
ds_read_b128 a[12:15], v203 offset:192
ds_read_b128 a[16:19], v203 offset:256
ds_read_b128 a[20:23], v203 offset:320
ds_read_b128 a[24:27], v203 offset:384
ds_read_b128 a[28:31], v203 offset:448
ds_read_b128 a[32:35], v203 offset:512
ds_read_b128 a[36:39], v203 offset:576
ds_read_b128 a[40:43], v203 offset:640
ds_read_b128 a[44:47], v203 offset:704
ds_read_b128 a[48:51], v203 offset:768
ds_read_b128 a[52:55], v203 offset:832
ds_read_b128 a[56:59], v203 offset:896
ds_read_b128 a[60:63], v203 offset:960
s_waitcnt lgkmcnt(0)
s_barrier
ds_write_b128 v204, v[100:103] offset:0
ds_write_b128 v204, v[104:107] offset:1056
ds_write_b128 v204, v[108:111] offset:2112
ds_write_b128 v204, v[112:115] offset:3168
s_waitcnt lgkmcnt(0)
s_barrier
ds_read_b128 a[64:67], v203 offset:0
ds_read_b128 a[68:71], v203 offset:64
ds_read_b128 a[72:75], v203 offset:128
ds_read_b128 a[76:79], v203 offset:192
ds_read_b128 a[80:83], v203 offset:256
ds_read_b128 a[84:87], v203 offset:320
ds_read_b128 a[88:91], v203 offset:384
ds_read_b128 a[92:95], v203 offset:448
ds_read_b128 a[96:99], v203 offset:512
ds_read_b128 a[100:103], v203 offset:576
ds_read_b128 a[104:107], v203 offset:640
ds_read_b128 a[108:111], v203 offset:704
ds_read_b128 a[112:115], v203 offset:768
ds_read_b128 a[116:119], v203 offset:832
ds_read_b128 a[120:123], v203 offset:896
ds_read_b128 a[124:127], v203 offset:960
s_waitcnt lgkmcnt(0)
ds_read_b128 v[84:87], v194 offset:0
ds_read_b128 v[88:91], v194 offset:64
ds_read_b128 v[92:95], v194 offset:128
ds_read_b128 v[96:99], v194 offset:192
ds_read_b128 v[100:103], v194 offset:256
ds_read_b128 v[104:107], v194 offset:320
ds_read_b128 v[108:111], v194 offset:384
ds_read_b128 v[112:115], v194 offset:448
ds_read_b128 v[116:119], v194 offset:512
ds_read_b128 v[120:123], v194 offset:576
ds_read_b128 v[124:127], v194 offset:640
ds_read_b128 v[128:131], v194 offset:704
ds_read_b128 v[132:135], v194 offset:768
ds_read_b128 v[136:139], v194 offset:832
ds_read_b128 v[140:143], v194 offset:896
ds_read_b128 v[144:147], v194 offset:960
s_waitcnt lgkmcnt(15)
v_mfma_f32_16x16x32_bf16 v[76:79], v[84:87], a[0:3], 0
v_mfma_f32_16x16x32_bf16 v[80:83], v[84:87], a[64:67], 0
s_waitcnt lgkmcnt(14)
v_mfma_f32_16x16x32_bf16 v[76:79], v[88:91], a[4:7], v[76:79]
v_mfma_f32_16x16x32_bf16 v[80:83], v[88:91], a[68:71], v[80:83]
s_waitcnt lgkmcnt(13)
v_mfma_f32_16x16x32_bf16 v[76:79], v[92:95], a[8:11], v[76:79]
v_mfma_f32_16x16x32_bf16 v[80:83], v[92:95], a[72:75], v[80:83]
s_waitcnt lgkmcnt(12)
v_mfma_f32_16x16x32_bf16 v[76:79], v[96:99], a[12:15], v[76:79]
v_mfma_f32_16x16x32_bf16 v[80:83], v[96:99], a[76:79], v[80:83]
s_waitcnt lgkmcnt(11)
v_mfma_f32_16x16x32_bf16 v[76:79], v[100:103], a[16:19], v[76:79]
v_mfma_f32_16x16x32_bf16 v[80:83], v[100:103], a[80:83], v[80:83]
s_waitcnt lgkmcnt(10)
v_mfma_f32_16x16x32_bf16 v[76:79], v[104:107], a[20:23], v[76:79]
v_mfma_f32_16x16x32_bf16 v[80:83], v[104:107], a[84:87], v[80:83]
s_waitcnt lgkmcnt(9)
v_mfma_f32_16x16x32_bf16 v[76:79], v[108:111], a[24:27], v[76:79]
v_mfma_f32_16x16x32_bf16 v[80:83], v[108:111], a[88:91], v[80:83]
s_waitcnt lgkmcnt(8)
v_mfma_f32_16x16x32_bf16 v[76:79], v[112:115], a[28:31], v[76:79]
v_mfma_f32_16x16x32_bf16 v[80:83], v[112:115], a[92:95], v[80:83]
s_waitcnt lgkmcnt(7)
v_mfma_f32_16x16x32_bf16 v[76:79], v[116:119], a[32:35], v[76:79]
v_mfma_f32_16x16x32_bf16 v[80:83], v[116:119], a[96:99], v[80:83]
s_waitcnt lgkmcnt(6)
v_mfma_f32_16x16x32_bf16 v[76:79], v[120:123], a[36:39], v[76:79]
v_mfma_f32_16x16x32_bf16 v[80:83], v[120:123], a[100:103], v[80:83]
s_waitcnt lgkmcnt(5)
v_mfma_f32_16x16x32_bf16 v[76:79], v[124:127], a[40:43], v[76:79]
v_mfma_f32_16x16x32_bf16 v[80:83], v[124:127], a[104:107], v[80:83]
s_waitcnt lgkmcnt(4)
v_mfma_f32_16x16x32_bf16 v[76:79], v[128:131], a[44:47], v[76:79]
v_mfma_f32_16x16x32_bf16 v[80:83], v[128:131], a[108:111], v[80:83]
s_waitcnt lgkmcnt(3)
v_mfma_f32_16x16x32_bf16 v[76:79], v[132:135], a[48:51], v[76:79]
v_mfma_f32_16x16x32_bf16 v[80:83], v[132:135], a[112:115], v[80:83]
s_waitcnt lgkmcnt(2)
v_mfma_f32_16x16x32_bf16 v[76:79], v[136:139], a[52:55], v[76:79]
v_mfma_f32_16x16x32_bf16 v[80:83], v[136:139], a[116:119], v[80:83]
s_waitcnt lgkmcnt(1)
v_mfma_f32_16x16x32_bf16 v[76:79], v[140:143], a[56:59], v[76:79]
v_mfma_f32_16x16x32_bf16 v[80:83], v[140:143], a[120:123], v[80:83]
s_waitcnt lgkmcnt(0)
v_mfma_f32_16x16x32_bf16 v[76:79], v[144:147], a[60:63], v[76:79]
v_mfma_f32_16x16x32_bf16 v[80:83], v[144:147], a[124:127], v[80:83]
s_nop 6
v_max_f32 v190, v76, v77
v_max3_f32 v190, v190, v78, v79
v_mov_b32 v192, v190
s_nop 1
v_permlane16_swap_b32 v190, v192
v_max_f32 v190, v190, v192
v_mov_b32 v192, v190
s_nop 1
v_permlane32_swap_b32 v190, v192
v_max_f32 v190, v190, v192
ds_write_b32 v198, v190 offset:0
v_max_f32 v191, v80, v81
v_max3_f32 v191, v191, v82, v83
v_mov_b32 v192, v191
s_nop 1
v_permlane16_swap_b32 v191, v192
v_max_f32 v191, v191, v192
v_mov_b32 v192, v191
s_nop 1
v_permlane32_swap_b32 v191, v192
v_max_f32 v191, v191, v192
ds_write_b32 v198, v191 offset:256
s_waitcnt lgkmcnt(0)
s_barrier
ds_read_b128 v[164:167], v199
ds_read_b128 v[168:171], v199 offset:256
ds_read_b128 v[172:175], v200
s_waitcnt lgkmcnt(0)
v_max_f32 v164, v164, v165
v_max3_f32 v164, v164, v166, v167
v_mul_f32 v164, v164, v185
v_max_f32 v164, v164, v176
v_sub_f32 v182, v176, v164
v_exp_f32 v182, v182
v_mov_b32 v176, v164
v_max_f32 v168, v168, v169
v_max3_f32 v168, v168, v170, v171
v_mul_f32 v168, v168, v185
v_max_f32 v168, v168, v177
v_sub_f32 v183, v177, v168
v_exp_f32 v183, v183
v_mov_b32 v177, v168
v_max_f32 v172, v172, v173
v_max3_f32 v172, v172, v174, v175
v_mul_f32 v172, v172, v185
v_max_f32 v172, v172, v178
v_sub_f32 v184, v178, v172
v_exp_f32 v184, v184
v_mov_b32 v178, v172
v_fma_f32 v76, v76, v185, -v176
v_fma_f32 v77, v77, v185, -v176
v_fma_f32 v78, v78, v185, -v176
v_fma_f32 v79, v79, v185, -v176
v_exp_f32 v76, v76
v_exp_f32 v77, v77
v_exp_f32 v78, v78
v_exp_f32 v79, v79
v_mul_f32 v180, v180, v182
v_cvt_pk_bf16_f32 v186, v76, v77
v_cvt_pk_bf16_f32 v187, v78, v79
ds_write_b64 v201, v[186:187] offset:0
v_add_f32 v180, v180, v76
v_add_f32 v180, v180, v77
v_add_f32 v180, v180, v78
v_add_f32 v180, v180, v79
v_fma_f32 v80, v80, v185, -v177
v_fma_f32 v81, v81, v185, -v177
v_fma_f32 v82, v82, v185, -v177
v_fma_f32 v83, v83, v185, -v177
v_exp_f32 v80, v80
v_exp_f32 v81, v81
v_exp_f32 v82, v82
v_exp_f32 v83, v83
v_mul_f32 v181, v181, v183
v_cvt_pk_bf16_f32 v188, v80, v81
v_cvt_pk_bf16_f32 v189, v82, v83
ds_write_b64 v201, v[188:189] offset:512
v_add_f32 v181, v181, v80
v_add_f32 v181, v181, v81
v_add_f32 v181, v181, v82
v_add_f32 v181, v181, v83
s_waitcnt lgkmcnt(0)
s_barrier
ds_read_b128 v[148:151], v202 offset:0
ds_read_b128 v[152:155], v202 offset:1024
ds_read_b128 v[156:159], v202 offset:2048
ds_read_b128 v[160:163], v202 offset:3072
ds_read_b64_tr_b16 v[84:85], v196 offset:0
ds_read_b64_tr_b16 v[86:87], v196 offset:4352
ds_read_b64_tr_b16 v[88:89], v196 offset:64
ds_read_b64_tr_b16 v[90:91], v196 offset:4416
ds_read_b64_tr_b16 v[92:93], v196 offset:128
ds_read_b64_tr_b16 v[94:95], v196 offset:4480
ds_read_b64_tr_b16 v[96:97], v196 offset:192
ds_read_b64_tr_b16 v[98:99], v196 offset:4544
ds_read_b64_tr_b16 v[100:101], v196 offset:17408
ds_read_b64_tr_b16 v[102:103], v196 offset:21760
ds_read_b64_tr_b16 v[104:105], v196 offset:17472
ds_read_b64_tr_b16 v[106:107], v196 offset:21824
ds_read_b64_tr_b16 v[108:109], v196 offset:17536
ds_read_b64_tr_b16 v[110:111], v196 offset:21888
ds_read_b64_tr_b16 v[112:113], v196 offset:17600
ds_read_b64_tr_b16 v[114:115], v196 offset:21952
ds_read_b64_tr_b16 v[116:117], v196 offset:34816
ds_read_b64_tr_b16 v[118:119], v196 offset:39168
ds_read_b64_tr_b16 v[120:121], v196 offset:34880
ds_read_b64_tr_b16 v[122:123], v196 offset:39232
ds_read_b64_tr_b16 v[124:125], v196 offset:34944
ds_read_b64_tr_b16 v[126:127], v196 offset:39296
ds_read_b64_tr_b16 v[128:129], v196 offset:35008
ds_read_b64_tr_b16 v[130:131], v196 offset:39360
ds_read_b64_tr_b16 v[132:133], v196 offset:52224
ds_read_b64_tr_b16 v[134:135], v196 offset:56576
ds_read_b64_tr_b16 v[136:137], v196 offset:52288
ds_read_b64_tr_b16 v[138:139], v196 offset:56640
ds_read_b64_tr_b16 v[140:141], v196 offset:52352
ds_read_b64_tr_b16 v[142:143], v196 offset:56704
ds_read_b64_tr_b16 v[144:145], v196 offset:52416
ds_read_b64_tr_b16 v[146:147], v196 offset:56768
s_waitcnt lgkmcnt(15)
v_mfma_f32_32x32x16_bf16 v[12:27], v[84:87], v[148:151], 0
v_mfma_f32_32x32x16_bf16 v[28:43], v[88:91], v[148:151], 0
v_mfma_f32_32x32x16_bf16 v[44:59], v[92:95], v[148:151], 0
v_mfma_f32_32x32x16_bf16 v[60:75], v[96:99], v[148:151], 0
s_waitcnt lgkmcnt(15)
v_mfma_f32_32x32x16_bf16 v[12:27], v[100:103], v[152:155], v[12:27]
v_mfma_f32_32x32x16_bf16 v[28:43], v[104:107], v[152:155], v[28:43]
v_mfma_f32_32x32x16_bf16 v[44:59], v[108:111], v[152:155], v[44:59]
v_mfma_f32_32x32x16_bf16 v[60:75], v[112:115], v[152:155], v[60:75]
s_waitcnt lgkmcnt(8)
v_mfma_f32_32x32x16_bf16 v[12:27], v[116:119], v[156:159], v[12:27]
v_mfma_f32_32x32x16_bf16 v[28:43], v[120:123], v[156:159], v[28:43]
v_mfma_f32_32x32x16_bf16 v[44:59], v[124:127], v[156:159], v[44:59]
v_mfma_f32_32x32x16_bf16 v[60:75], v[128:131], v[156:159], v[60:75]
s_waitcnt lgkmcnt(0)
v_mfma_f32_32x32x16_bf16 v[12:27], v[132:135], v[160:163], v[12:27]
v_mfma_f32_32x32x16_bf16 v[28:43], v[136:139], v[160:163], v[28:43]
v_mfma_f32_32x32x16_bf16 v[44:59], v[140:143], v[160:163], v[44:59]
v_mfma_f32_32x32x16_bf16 v[60:75], v[144:147], v[160:163], v[60:75]
ds_read_b128 v[84:87], v195 offset:0
ds_read_b128 v[88:91], v195 offset:64
ds_read_b128 v[92:95], v195 offset:128
ds_read_b128 v[96:99], v195 offset:192
ds_read_b128 v[100:103], v195 offset:256
ds_read_b128 v[104:107], v195 offset:320
ds_read_b128 v[108:111], v195 offset:384
ds_read_b128 v[112:115], v195 offset:448
ds_read_b128 v[116:119], v195 offset:512
ds_read_b128 v[120:123], v195 offset:576
ds_read_b128 v[124:127], v195 offset:640
ds_read_b128 v[128:131], v195 offset:704
ds_read_b128 v[132:135], v195 offset:768
ds_read_b128 v[136:139], v195 offset:832
ds_read_b128 v[140:143], v195 offset:896
ds_read_b128 v[144:147], v195 offset:960
s_waitcnt lgkmcnt(15)
v_mfma_f32_16x16x32_bf16 v[76:79], v[84:87], a[0:3], 0
v_mfma_f32_16x16x32_bf16 v[80:83], v[84:87], a[64:67], 0
s_waitcnt lgkmcnt(14)
v_mfma_f32_16x16x32_bf16 v[76:79], v[88:91], a[4:7], v[76:79]
v_mfma_f32_16x16x32_bf16 v[80:83], v[88:91], a[68:71], v[80:83]
s_waitcnt lgkmcnt(13)
v_mfma_f32_16x16x32_bf16 v[76:79], v[92:95], a[8:11], v[76:79]
v_mfma_f32_16x16x32_bf16 v[80:83], v[92:95], a[72:75], v[80:83]
s_waitcnt lgkmcnt(12)
v_mfma_f32_16x16x32_bf16 v[76:79], v[96:99], a[12:15], v[76:79]
v_mfma_f32_16x16x32_bf16 v[80:83], v[96:99], a[76:79], v[80:83]
s_waitcnt lgkmcnt(11)
v_mfma_f32_16x16x32_bf16 v[76:79], v[100:103], a[16:19], v[76:79]
v_mfma_f32_16x16x32_bf16 v[80:83], v[100:103], a[80:83], v[80:83]
s_waitcnt lgkmcnt(10)
v_mfma_f32_16x16x32_bf16 v[76:79], v[104:107], a[20:23], v[76:79]
v_mfma_f32_16x16x32_bf16 v[80:83], v[104:107], a[84:87], v[80:83]
s_waitcnt lgkmcnt(9)
v_mfma_f32_16x16x32_bf16 v[76:79], v[108:111], a[24:27], v[76:79]
v_mfma_f32_16x16x32_bf16 v[80:83], v[108:111], a[88:91], v[80:83]
s_waitcnt lgkmcnt(8)
v_mfma_f32_16x16x32_bf16 v[76:79], v[112:115], a[28:31], v[76:79]
v_mfma_f32_16x16x32_bf16 v[80:83], v[112:115], a[92:95], v[80:83]
s_waitcnt lgkmcnt(7)
v_mfma_f32_16x16x32_bf16 v[76:79], v[116:119], a[32:35], v[76:79]
v_mfma_f32_16x16x32_bf16 v[80:83], v[116:119], a[96:99], v[80:83]
s_waitcnt lgkmcnt(6)
v_mfma_f32_16x16x32_bf16 v[76:79], v[120:123], a[36:39], v[76:79]
v_mfma_f32_16x16x32_bf16 v[80:83], v[120:123], a[100:103], v[80:83]
s_waitcnt lgkmcnt(5)
v_mfma_f32_16x16x32_bf16 v[76:79], v[124:127], a[40:43], v[76:79]
v_mfma_f32_16x16x32_bf16 v[80:83], v[124:127], a[104:107], v[80:83]
s_waitcnt lgkmcnt(4)
v_mfma_f32_16x16x32_bf16 v[76:79], v[128:131], a[44:47], v[76:79]
v_mfma_f32_16x16x32_bf16 v[80:83], v[128:131], a[108:111], v[80:83]
s_waitcnt lgkmcnt(3)
v_mfma_f32_16x16x32_bf16 v[76:79], v[132:135], a[48:51], v[76:79]
v_mfma_f32_16x16x32_bf16 v[80:83], v[132:135], a[112:115], v[80:83]
s_waitcnt lgkmcnt(2)
v_mfma_f32_16x16x32_bf16 v[76:79], v[136:139], a[52:55], v[76:79]
v_mfma_f32_16x16x32_bf16 v[80:83], v[136:139], a[116:119], v[80:83]
s_waitcnt lgkmcnt(1)
v_mfma_f32_16x16x32_bf16 v[76:79], v[140:143], a[56:59], v[76:79]
v_mfma_f32_16x16x32_bf16 v[80:83], v[140:143], a[120:123], v[80:83]
s_waitcnt lgkmcnt(0)
v_mfma_f32_16x16x32_bf16 v[76:79], v[144:147], a[60:63], v[76:79]
v_mfma_f32_16x16x32_bf16 v[80:83], v[144:147], a[124:127], v[80:83]
s_nop 6
v_max_f32 v190, v76, v77
v_max3_f32 v190, v190, v78, v79
v_mov_b32 v192, v190
s_nop 1
v_permlane16_swap_b32 v190, v192
v_max_f32 v190, v190, v192
v_mov_b32 v192, v190
s_nop 1
v_permlane32_swap_b32 v190, v192
v_max_f32 v190, v190, v192
ds_write_b32 v198, v190 offset:0
v_max_f32 v191, v80, v81
v_max3_f32 v191, v191, v82, v83
v_mov_b32 v192, v191
s_nop 1
v_permlane16_swap_b32 v191, v192
v_max_f32 v191, v191, v192
v_mov_b32 v192, v191
s_nop 1
v_permlane32_swap_b32 v191, v192
v_max_f32 v191, v191, v192
ds_write_b32 v198, v191 offset:256
s_waitcnt lgkmcnt(0)
s_barrier
ds_read_b128 v[164:167], v199
ds_read_b128 v[168:171], v199 offset:256
ds_read_b128 v[172:175], v200
ds_write_b128 v206, a[128:131] offset:0
ds_write_b128 v206, a[132:135] offset:1088
ds_write_b128 v206, a[136:139] offset:2176
ds_write_b128 v206, a[140:143] offset:3264
ds_write_b128 v206, a[144:147] offset:4352
ds_write_b128 v206, a[148:151] offset:5440
ds_write_b128 v206, a[152:155] offset:6528
ds_write_b128 v206, a[156:159] offset:7616
ds_write_b128 v206, a[160:163] offset:8704
ds_write_b128 v206, a[164:167] offset:9792
ds_write_b128 v206, a[168:171] offset:10880
ds_write_b128 v206, a[172:175] offset:11968
ds_write_b128 v206, a[176:179] offset:13056
ds_write_b128 v206, a[180:183] offset:14144
ds_write_b128 v206, a[184:187] offset:15232
ds_write_b128 v206, a[188:191] offset:16320
s_waitcnt lgkmcnt(15)
v_max_f32 v164, v164, v165
v_max3_f32 v164, v164, v166, v167
v_mul_f32 v164, v164, v185
v_max_f32 v164, v164, v176
v_sub_f32 v182, v176, v164
v_exp_f32 v182, v182
v_mov_b32 v176, v164
v_max_f32 v168, v168, v169
v_max3_f32 v168, v168, v170, v171
v_mul_f32 v168, v168, v185
v_max_f32 v168, v168, v177
v_sub_f32 v183, v177, v168
v_exp_f32 v183, v183
v_mov_b32 v177, v168
v_max_f32 v172, v172, v173
v_max3_f32 v172, v172, v174, v175
v_mul_f32 v172, v172, v185
v_max_f32 v172, v172, v178
v_sub_f32 v184, v178, v172
v_exp_f32 v184, v184
v_mov_b32 v178, v172
v_fma_f32 v76, v76, v185, -v176
v_fma_f32 v77, v77, v185, -v176
v_fma_f32 v78, v78, v185, -v176
v_fma_f32 v79, v79, v185, -v176
v_exp_f32 v76, v76
v_exp_f32 v77, v77
v_exp_f32 v78, v78
v_exp_f32 v79, v79
v_mul_f32 v180, v180, v182
v_cvt_pk_bf16_f32 v186, v76, v77
v_cvt_pk_bf16_f32 v187, v78, v79
ds_write_b64 v201, v[186:187] offset:0
v_add_f32 v180, v180, v76
v_add_f32 v180, v180, v77
v_add_f32 v180, v180, v78
v_add_f32 v180, v180, v79
v_fma_f32 v80, v80, v185, -v177
v_fma_f32 v81, v81, v185, -v177
v_fma_f32 v82, v82, v185, -v177
v_fma_f32 v83, v83, v185, -v177
v_exp_f32 v80, v80
v_exp_f32 v81, v81
v_exp_f32 v82, v82
v_exp_f32 v83, v83
v_mul_f32 v181, v181, v183
v_cvt_pk_bf16_f32 v188, v80, v81
v_cvt_pk_bf16_f32 v189, v82, v83
ds_write_b64 v201, v[188:189] offset:512
v_add_f32 v181, v181, v80
v_add_f32 v181, v181, v81
v_add_f32 v181, v181, v82
v_add_f32 v181, v181, v83
v_mul_f32 v12, v12, v184
v_mul_f32 v13, v13, v184
v_mul_f32 v14, v14, v184
v_mul_f32 v15, v15, v184
v_mul_f32 v16, v16, v184
v_mul_f32 v17, v17, v184
v_mul_f32 v18, v18, v184
v_mul_f32 v19, v19, v184
v_mul_f32 v20, v20, v184
v_mul_f32 v21, v21, v184
v_mul_f32 v22, v22, v184
v_mul_f32 v23, v23, v184
v_mul_f32 v24, v24, v184
v_mul_f32 v25, v25, v184
v_mul_f32 v26, v26, v184
v_mul_f32 v27, v27, v184
v_mul_f32 v28, v28, v184
v_mul_f32 v29, v29, v184
v_mul_f32 v30, v30, v184
v_mul_f32 v31, v31, v184
v_mul_f32 v32, v32, v184
v_mul_f32 v33, v33, v184
v_mul_f32 v34, v34, v184
v_mul_f32 v35, v35, v184
v_mul_f32 v36, v36, v184
v_mul_f32 v37, v37, v184
v_mul_f32 v38, v38, v184
v_mul_f32 v39, v39, v184
v_mul_f32 v40, v40, v184
v_mul_f32 v41, v41, v184
v_mul_f32 v42, v42, v184
v_mul_f32 v43, v43, v184
v_mul_f32 v44, v44, v184
v_mul_f32 v45, v45, v184
v_mul_f32 v46, v46, v184
v_mul_f32 v47, v47, v184
v_mul_f32 v48, v48, v184
v_mul_f32 v49, v49, v184
v_mul_f32 v50, v50, v184
v_mul_f32 v51, v51, v184
v_mul_f32 v52, v52, v184
v_mul_f32 v53, v53, v184
v_mul_f32 v54, v54, v184
v_mul_f32 v55, v55, v184
v_mul_f32 v56, v56, v184
v_mul_f32 v57, v57, v184
v_mul_f32 v58, v58, v184
v_mul_f32 v59, v59, v184
v_mul_f32 v60, v60, v184
v_mul_f32 v61, v61, v184
v_mul_f32 v62, v62, v184
v_mul_f32 v63, v63, v184
v_mul_f32 v64, v64, v184
v_mul_f32 v65, v65, v184
v_mul_f32 v66, v66, v184
v_mul_f32 v67, v67, v184
v_mul_f32 v68, v68, v184
v_mul_f32 v69, v69, v184
v_mul_f32 v70, v70, v184
v_mul_f32 v71, v71, v184
v_mul_f32 v72, v72, v184
v_mul_f32 v73, v73, v184
v_mul_f32 v74, v74, v184
v_mul_f32 v75, v75, v184
s_waitcnt lgkmcnt(0)
s_barrier
ds_read_b128 v[148:151], v202 offset:0
ds_read_b128 v[152:155], v202 offset:1024
ds_read_b128 v[156:159], v202 offset:2048
ds_read_b128 v[160:163], v202 offset:3072
ds_read_b64_tr_b16 v[84:85], v197 offset:0
ds_read_b64_tr_b16 v[86:87], v197 offset:4352
ds_read_b64_tr_b16 v[88:89], v197 offset:64
ds_read_b64_tr_b16 v[90:91], v197 offset:4416
ds_read_b64_tr_b16 v[92:93], v197 offset:128
ds_read_b64_tr_b16 v[94:95], v197 offset:4480
ds_read_b64_tr_b16 v[96:97], v197 offset:192
ds_read_b64_tr_b16 v[98:99], v197 offset:4544
ds_read_b64_tr_b16 v[100:101], v197 offset:17408
ds_read_b64_tr_b16 v[102:103], v197 offset:21760
ds_read_b64_tr_b16 v[104:105], v197 offset:17472
ds_read_b64_tr_b16 v[106:107], v197 offset:21824
ds_read_b64_tr_b16 v[108:109], v197 offset:17536
ds_read_b64_tr_b16 v[110:111], v197 offset:21888
ds_read_b64_tr_b16 v[112:113], v197 offset:17600
ds_read_b64_tr_b16 v[114:115], v197 offset:21952
ds_read_b64_tr_b16 v[116:117], v197 offset:34816
ds_read_b64_tr_b16 v[118:119], v197 offset:39168
ds_read_b64_tr_b16 v[120:121], v197 offset:34880
ds_read_b64_tr_b16 v[122:123], v197 offset:39232
ds_read_b64_tr_b16 v[124:125], v197 offset:34944
ds_read_b64_tr_b16 v[126:127], v197 offset:39296
ds_read_b64_tr_b16 v[128:129], v197 offset:35008
ds_read_b64_tr_b16 v[130:131], v197 offset:39360
ds_read_b64_tr_b16 v[132:133], v197 offset:52224
ds_read_b64_tr_b16 v[134:135], v197 offset:56576
ds_read_b64_tr_b16 v[136:137], v197 offset:52288
ds_read_b64_tr_b16 v[138:139], v197 offset:56640
ds_read_b64_tr_b16 v[140:141], v197 offset:52352
ds_read_b64_tr_b16 v[142:143], v197 offset:56704
ds_read_b64_tr_b16 v[144:145], v197 offset:52416
ds_read_b64_tr_b16 v[146:147], v197 offset:56768
s_waitcnt lgkmcnt(15)
v_mfma_f32_32x32x16_bf16 v[12:27], v[84:87], v[148:151], v[12:27]
v_mfma_f32_32x32x16_bf16 v[28:43], v[88:91], v[148:151], v[28:43]
s_add_u32 s6, s13, 2097152
buffer_load_dwordx4 a[128:131], v2, s[52:55], s6 offen nt
v_mfma_f32_32x32x16_bf16 v[44:59], v[92:95], v[148:151], v[44:59]
v_mfma_f32_32x32x16_bf16 v[60:75], v[96:99], v[148:151], v[60:75]
s_add_u32 s6, s13, 2098176
buffer_load_dwordx4 a[132:135], v2, s[52:55], s6 offen nt
s_waitcnt lgkmcnt(15)
v_mfma_f32_32x32x16_bf16 v[12:27], v[100:103], v[152:155], v[12:27]
v_mfma_f32_32x32x16_bf16 v[28:43], v[104:107], v[152:155], v[28:43]
s_add_u32 s6, s13, 2099200
buffer_load_dwordx4 a[136:139], v2, s[52:55], s6 offen nt
v_mfma_f32_32x32x16_bf16 v[44:59], v[108:111], v[152:155], v[44:59]
v_mfma_f32_32x32x16_bf16 v[60:75], v[112:115], v[152:155], v[60:75]
s_add_u32 s6, s13, 2100224
buffer_load_dwordx4 a[140:143], v2, s[52:55], s6 offen nt
s_waitcnt lgkmcnt(8)
v_mfma_f32_32x32x16_bf16 v[12:27], v[116:119], v[156:159], v[12:27]
v_mfma_f32_32x32x16_bf16 v[28:43], v[120:123], v[156:159], v[28:43]
s_add_u32 s6, s13, 2228224
buffer_load_dwordx4 a[144:147], v2, s[52:55], s6 offen nt
v_mfma_f32_32x32x16_bf16 v[44:59], v[124:127], v[156:159], v[44:59]
v_mfma_f32_32x32x16_bf16 v[60:75], v[128:131], v[156:159], v[60:75]
s_add_u32 s6, s13, 2229248
buffer_load_dwordx4 a[148:151], v2, s[52:55], s6 offen nt
s_waitcnt lgkmcnt(0)
v_mfma_f32_32x32x16_bf16 v[12:27], v[132:135], v[160:163], v[12:27]
v_mfma_f32_32x32x16_bf16 v[28:43], v[136:139], v[160:163], v[28:43]
s_add_u32 s6, s13, 2230272
buffer_load_dwordx4 a[152:155], v2, s[52:55], s6 offen nt
v_mfma_f32_32x32x16_bf16 v[44:59], v[140:143], v[160:163], v[44:59]
v_mfma_f32_32x32x16_bf16 v[60:75], v[144:147], v[160:163], v[60:75]
s_add_u32 s6, s13, 2231296
buffer_load_dwordx4 a[156:159], v2, s[52:55], s6 offen nt
ds_read_b128 v[84:87], v194 offset:0
ds_read_b128 v[88:91], v194 offset:64
ds_read_b128 v[92:95], v194 offset:128
ds_read_b128 v[96:99], v194 offset:192
ds_read_b128 v[100:103], v194 offset:256
ds_read_b128 v[104:107], v194 offset:320
ds_read_b128 v[108:111], v194 offset:384
ds_read_b128 v[112:115], v194 offset:448
ds_read_b128 v[116:119], v194 offset:512
ds_read_b128 v[120:123], v194 offset:576
ds_read_b128 v[124:127], v194 offset:640
ds_read_b128 v[128:131], v194 offset:704
ds_read_b128 v[132:135], v194 offset:768
ds_read_b128 v[136:139], v194 offset:832
ds_read_b128 v[140:143], v194 offset:896
ds_read_b128 v[144:147], v194 offset:960
s_waitcnt lgkmcnt(15)
v_mfma_f32_16x16x32_bf16 v[76:79], v[84:87], a[0:3], 0
v_mfma_f32_16x16x32_bf16 v[80:83], v[84:87], a[64:67], 0
s_waitcnt lgkmcnt(14)
v_mfma_f32_16x16x32_bf16 v[76:79], v[88:91], a[4:7], v[76:79]
v_mfma_f32_16x16x32_bf16 v[80:83], v[88:91], a[68:71], v[80:83]
s_add_u32 s6, s13, 2359296
buffer_load_dwordx4 a[160:163], v10, s[52:55], s6 offen nt
s_waitcnt lgkmcnt(13)
v_mfma_f32_16x16x32_bf16 v[76:79], v[92:95], a[8:11], v[76:79]
v_mfma_f32_16x16x32_bf16 v[80:83], v[92:95], a[72:75], v[80:83]
s_waitcnt lgkmcnt(12)
v_mfma_f32_16x16x32_bf16 v[76:79], v[96:99], a[12:15], v[76:79]
v_mfma_f32_16x16x32_bf16 v[80:83], v[96:99], a[76:79], v[80:83]
s_add_u32 s6, s13, 2360320
buffer_load_dwordx4 a[164:167], v10, s[52:55], s6 offen nt
s_waitcnt lgkmcnt(11)
v_mfma_f32_16x16x32_bf16 v[76:79], v[100:103], a[16:19], v[76:79]
v_mfma_f32_16x16x32_bf16 v[80:83], v[100:103], a[80:83], v[80:83]
s_waitcnt lgkmcnt(10)
v_mfma_f32_16x16x32_bf16 v[76:79], v[104:107], a[20:23], v[76:79]
v_mfma_f32_16x16x32_bf16 v[80:83], v[104:107], a[84:87], v[80:83]
s_add_u32 s6, s13, 2361344
buffer_load_dwordx4 a[168:171], v10, s[52:55], s6 offen nt
s_waitcnt lgkmcnt(9)
v_mfma_f32_16x16x32_bf16 v[76:79], v[108:111], a[24:27], v[76:79]
v_mfma_f32_16x16x32_bf16 v[80:83], v[108:111], a[88:91], v[80:83]
s_waitcnt lgkmcnt(8)
v_mfma_f32_16x16x32_bf16 v[76:79], v[112:115], a[28:31], v[76:79]
v_mfma_f32_16x16x32_bf16 v[80:83], v[112:115], a[92:95], v[80:83]
s_add_u32 s6, s13, 2362368
buffer_load_dwordx4 a[172:175], v10, s[52:55], s6 offen nt
s_waitcnt lgkmcnt(7)
v_mfma_f32_16x16x32_bf16 v[76:79], v[116:119], a[32:35], v[76:79]
v_mfma_f32_16x16x32_bf16 v[80:83], v[116:119], a[96:99], v[80:83]
s_waitcnt lgkmcnt(6)
v_mfma_f32_16x16x32_bf16 v[76:79], v[120:123], a[36:39], v[76:79]
v_mfma_f32_16x16x32_bf16 v[80:83], v[120:123], a[100:103], v[80:83]
s_add_u32 s6, s13, 2490368
buffer_load_dwordx4 a[176:179], v10, s[52:55], s6 offen nt
s_waitcnt lgkmcnt(5)
v_mfma_f32_16x16x32_bf16 v[76:79], v[124:127], a[40:43], v[76:79]
v_mfma_f32_16x16x32_bf16 v[80:83], v[124:127], a[104:107], v[80:83]
s_waitcnt lgkmcnt(4)
v_mfma_f32_16x16x32_bf16 v[76:79], v[128:131], a[44:47], v[76:79]
v_mfma_f32_16x16x32_bf16 v[80:83], v[128:131], a[108:111], v[80:83]
s_add_u32 s6, s13, 2491392
buffer_load_dwordx4 a[180:183], v10, s[52:55], s6 offen nt
s_waitcnt lgkmcnt(3)
v_mfma_f32_16x16x32_bf16 v[76:79], v[132:135], a[48:51], v[76:79]
v_mfma_f32_16x16x32_bf16 v[80:83], v[132:135], a[112:115], v[80:83]
s_waitcnt lgkmcnt(2)
v_mfma_f32_16x16x32_bf16 v[76:79], v[136:139], a[52:55], v[76:79]
v_mfma_f32_16x16x32_bf16 v[80:83], v[136:139], a[116:119], v[80:83]
s_add_u32 s6, s13, 2492416
buffer_load_dwordx4 a[184:187], v10, s[52:55], s6 offen nt
s_waitcnt lgkmcnt(1)
v_mfma_f32_16x16x32_bf16 v[76:79], v[140:143], a[56:59], v[76:79]
v_mfma_f32_16x16x32_bf16 v[80:83], v[140:143], a[120:123], v[80:83]
s_waitcnt lgkmcnt(0)
v_mfma_f32_16x16x32_bf16 v[76:79], v[144:147], a[60:63], v[76:79]
v_mfma_f32_16x16x32_bf16 v[80:83], v[144:147], a[124:127], v[80:83]
s_add_u32 s6, s13, 2493440
buffer_load_dwordx4 a[188:191], v10, s[52:55], s6 offen nt
s_nop 4
v_max_f32 v190, v76, v77
v_max3_f32 v190, v190, v78, v79
v_mov_b32 v192, v190
s_nop 1
v_permlane16_swap_b32 v190, v192
v_max_f32 v190, v190, v192
v_mov_b32 v192, v190
s_nop 1
v_permlane32_swap_b32 v190, v192
v_max_f32 v190, v190, v192
ds_write_b32 v198, v190 offset:0
v_max_f32 v191, v80, v81
v_max3_f32 v191, v191, v82, v83
v_mov_b32 v192, v191
s_nop 1
v_permlane16_swap_b32 v191, v192
v_max_f32 v191, v191, v192
v_mov_b32 v192, v191
s_nop 1
v_permlane32_swap_b32 v191, v192
v_max_f32 v191, v191, v192
ds_write_b32 v198, v191 offset:256
s_waitcnt lgkmcnt(0)
s_barrier
ds_read_b128 v[164:167], v199
ds_read_b128 v[168:171], v199 offset:256
ds_read_b128 v[172:175], v200
ds_write_b128 v207, a[192:195] offset:0
ds_write_b128 v207, a[196:199] offset:1088
ds_write_b128 v207, a[200:203] offset:2176
ds_write_b128 v207, a[204:207] offset:3264
ds_write_b128 v207, a[208:211] offset:4352
ds_write_b128 v207, a[212:215] offset:5440
ds_write_b128 v207, a[216:219] offset:6528
ds_write_b128 v207, a[220:223] offset:7616
ds_write_b128 v207, a[224:227] offset:8704
ds_write_b128 v207, a[228:231] offset:9792
ds_write_b128 v207, a[232:235] offset:10880
ds_write_b128 v207, a[236:239] offset:11968
ds_write_b128 v207, a[240:243] offset:13056
ds_write_b128 v207, a[244:247] offset:14144
ds_write_b128 v207, a[248:251] offset:15232
ds_write_b128 v207, a[252:255] offset:16320
s_waitcnt lgkmcnt(15)
v_max_f32 v164, v164, v165
v_max3_f32 v164, v164, v166, v167
v_mul_f32 v164, v164, v185
v_max_f32 v164, v164, v176
v_sub_f32 v182, v176, v164
v_exp_f32 v182, v182
v_mov_b32 v176, v164
v_max_f32 v168, v168, v169
v_max3_f32 v168, v168, v170, v171
v_mul_f32 v168, v168, v185
v_max_f32 v168, v168, v177
v_sub_f32 v183, v177, v168
v_exp_f32 v183, v183
v_mov_b32 v177, v168
v_max_f32 v172, v172, v173
v_max3_f32 v172, v172, v174, v175
v_mul_f32 v172, v172, v185
v_max_f32 v172, v172, v178
v_sub_f32 v184, v178, v172
v_exp_f32 v184, v184
v_mov_b32 v178, v172
v_fma_f32 v76, v76, v185, -v176
v_fma_f32 v77, v77, v185, -v176
v_fma_f32 v78, v78, v185, -v176
v_fma_f32 v79, v79, v185, -v176
v_exp_f32 v76, v76
v_exp_f32 v77, v77
v_exp_f32 v78, v78
v_exp_f32 v79, v79
v_mul_f32 v180, v180, v182
v_cvt_pk_bf16_f32 v186, v76, v77
v_cvt_pk_bf16_f32 v187, v78, v79
ds_write_b64 v201, v[186:187] offset:0
v_add_f32 v180, v180, v76
v_add_f32 v180, v180, v77
v_add_f32 v180, v180, v78
v_add_f32 v180, v180, v79
v_fma_f32 v80, v80, v185, -v177
v_fma_f32 v81, v81, v185, -v177
v_fma_f32 v82, v82, v185, -v177
v_fma_f32 v83, v83, v185, -v177
v_exp_f32 v80, v80
v_exp_f32 v81, v81
v_exp_f32 v82, v82
v_exp_f32 v83, v83
v_mul_f32 v181, v181, v183
v_cvt_pk_bf16_f32 v188, v80, v81
v_cvt_pk_bf16_f32 v189, v82, v83
ds_write_b64 v201, v[188:189] offset:512
v_add_f32 v181, v181, v80
v_add_f32 v181, v181, v81
v_add_f32 v181, v181, v82
v_add_f32 v181, v181, v83
v_mul_f32 v12, v12, v184
v_mul_f32 v13, v13, v184
v_mul_f32 v14, v14, v184
v_mul_f32 v15, v15, v184
v_mul_f32 v16, v16, v184
v_mul_f32 v17, v17, v184
v_mul_f32 v18, v18, v184
v_mul_f32 v19, v19, v184
v_mul_f32 v20, v20, v184
v_mul_f32 v21, v21, v184
v_mul_f32 v22, v22, v184
v_mul_f32 v23, v23, v184
v_mul_f32 v24, v24, v184
v_mul_f32 v25, v25, v184
v_mul_f32 v26, v26, v184
v_mul_f32 v27, v27, v184
v_mul_f32 v28, v28, v184
v_mul_f32 v29, v29, v184
v_mul_f32 v30, v30, v184
v_mul_f32 v31, v31, v184
v_mul_f32 v32, v32, v184
v_mul_f32 v33, v33, v184
v_mul_f32 v34, v34, v184
v_mul_f32 v35, v35, v184
v_mul_f32 v36, v36, v184
v_mul_f32 v37, v37, v184
v_mul_f32 v38, v38, v184
v_mul_f32 v39, v39, v184
v_mul_f32 v40, v40, v184
v_mul_f32 v41, v41, v184
v_mul_f32 v42, v42, v184
v_mul_f32 v43, v43, v184
v_mul_f32 v44, v44, v184
v_mul_f32 v45, v45, v184
v_mul_f32 v46, v46, v184
v_mul_f32 v47, v47, v184
v_mul_f32 v48, v48, v184
v_mul_f32 v49, v49, v184
v_mul_f32 v50, v50, v184
v_mul_f32 v51, v51, v184
v_mul_f32 v52, v52, v184
v_mul_f32 v53, v53, v184
v_mul_f32 v54, v54, v184
v_mul_f32 v55, v55, v184
v_mul_f32 v56, v56, v184
v_mul_f32 v57, v57, v184
v_mul_f32 v58, v58, v184
v_mul_f32 v59, v59, v184
v_mul_f32 v60, v60, v184
v_mul_f32 v61, v61, v184
v_mul_f32 v62, v62, v184
v_mul_f32 v63, v63, v184
v_mul_f32 v64, v64, v184
v_mul_f32 v65, v65, v184
v_mul_f32 v66, v66, v184
v_mul_f32 v67, v67, v184
v_mul_f32 v68, v68, v184
v_mul_f32 v69, v69, v184
v_mul_f32 v70, v70, v184
v_mul_f32 v71, v71, v184
v_mul_f32 v72, v72, v184
v_mul_f32 v73, v73, v184
v_mul_f32 v74, v74, v184
v_mul_f32 v75, v75, v184
s_waitcnt lgkmcnt(0)
s_barrier
ds_read_b128 v[148:151], v202 offset:0
ds_read_b128 v[152:155], v202 offset:1024
ds_read_b128 v[156:159], v202 offset:2048
ds_read_b128 v[160:163], v202 offset:3072
ds_read_b64_tr_b16 v[84:85], v196 offset:0
ds_read_b64_tr_b16 v[86:87], v196 offset:4352
ds_read_b64_tr_b16 v[88:89], v196 offset:64
ds_read_b64_tr_b16 v[90:91], v196 offset:4416
ds_read_b64_tr_b16 v[92:93], v196 offset:128
ds_read_b64_tr_b16 v[94:95], v196 offset:4480
ds_read_b64_tr_b16 v[96:97], v196 offset:192
ds_read_b64_tr_b16 v[98:99], v196 offset:4544
ds_read_b64_tr_b16 v[100:101], v196 offset:17408
ds_read_b64_tr_b16 v[102:103], v196 offset:21760
ds_read_b64_tr_b16 v[104:105], v196 offset:17472
ds_read_b64_tr_b16 v[106:107], v196 offset:21824
ds_read_b64_tr_b16 v[108:109], v196 offset:17536
ds_read_b64_tr_b16 v[110:111], v196 offset:21888
ds_read_b64_tr_b16 v[112:113], v196 offset:17600
ds_read_b64_tr_b16 v[114:115], v196 offset:21952
ds_read_b64_tr_b16 v[116:117], v196 offset:34816
ds_read_b64_tr_b16 v[118:119], v196 offset:39168
ds_read_b64_tr_b16 v[120:121], v196 offset:34880
ds_read_b64_tr_b16 v[122:123], v196 offset:39232
ds_read_b64_tr_b16 v[124:125], v196 offset:34944
ds_read_b64_tr_b16 v[126:127], v196 offset:39296
ds_read_b64_tr_b16 v[128:129], v196 offset:35008
ds_read_b64_tr_b16 v[130:131], v196 offset:39360
ds_read_b64_tr_b16 v[132:133], v196 offset:52224
ds_read_b64_tr_b16 v[134:135], v196 offset:56576
ds_read_b64_tr_b16 v[136:137], v196 offset:52288
ds_read_b64_tr_b16 v[138:139], v196 offset:56640
ds_read_b64_tr_b16 v[140:141], v196 offset:52352
ds_read_b64_tr_b16 v[142:143], v196 offset:56704
ds_read_b64_tr_b16 v[144:145], v196 offset:52416
ds_read_b64_tr_b16 v[146:147], v196 offset:56768
s_waitcnt lgkmcnt(15)
v_mfma_f32_32x32x16_bf16 v[12:27], v[84:87], v[148:151], v[12:27]
v_mfma_f32_32x32x16_bf16 v[28:43], v[88:91], v[148:151], v[28:43]
s_add_u32 s6, s13, 2621440
buffer_load_dwordx4 a[192:195], v2, s[52:55], s6 offen nt
v_mfma_f32_32x32x16_bf16 v[44:59], v[92:95], v[148:151], v[44:59]
v_mfma_f32_32x32x16_bf16 v[60:75], v[96:99], v[148:151], v[60:75]
s_add_u32 s6, s13, 2622464
buffer_load_dwordx4 a[196:199], v2, s[52:55], s6 offen nt
s_waitcnt lgkmcnt(15)
v_mfma_f32_32x32x16_bf16 v[12:27], v[100:103], v[152:155], v[12:27]
v_mfma_f32_32x32x16_bf16 v[28:43], v[104:107], v[152:155], v[28:43]
s_add_u32 s6, s13, 2623488
buffer_load_dwordx4 a[200:203], v2, s[52:55], s6 offen nt
v_mfma_f32_32x32x16_bf16 v[44:59], v[108:111], v[152:155], v[44:59]
v_mfma_f32_32x32x16_bf16 v[60:75], v[112:115], v[152:155], v[60:75]
s_add_u32 s6, s13, 2624512
buffer_load_dwordx4 a[204:207], v2, s[52:55], s6 offen nt
s_waitcnt lgkmcnt(8)
v_mfma_f32_32x32x16_bf16 v[12:27], v[116:119], v[156:159], v[12:27]
v_mfma_f32_32x32x16_bf16 v[28:43], v[120:123], v[156:159], v[28:43]
s_add_u32 s6, s13, 2752512
buffer_load_dwordx4 a[208:211], v2, s[52:55], s6 offen nt
v_mfma_f32_32x32x16_bf16 v[44:59], v[124:127], v[156:159], v[44:59]
v_mfma_f32_32x32x16_bf16 v[60:75], v[128:131], v[156:159], v[60:75]
s_add_u32 s6, s13, 2753536
buffer_load_dwordx4 a[212:215], v2, s[52:55], s6 offen nt
s_waitcnt lgkmcnt(0)
v_mfma_f32_32x32x16_bf16 v[12:27], v[132:135], v[160:163], v[12:27]
v_mfma_f32_32x32x16_bf16 v[28:43], v[136:139], v[160:163], v[28:43]
s_add_u32 s6, s13, 2754560
buffer_load_dwordx4 a[216:219], v2, s[52:55], s6 offen nt
v_mfma_f32_32x32x16_bf16 v[44:59], v[140:143], v[160:163], v[44:59]
v_mfma_f32_32x32x16_bf16 v[60:75], v[144:147], v[160:163], v[60:75]
s_add_u32 s6, s13, 2755584
buffer_load_dwordx4 a[220:223], v2, s[52:55], s6 offen nt
ds_read_b128 v[84:87], v195 offset:0
ds_read_b128 v[88:91], v195 offset:64
ds_read_b128 v[92:95], v195 offset:128
ds_read_b128 v[96:99], v195 offset:192
ds_read_b128 v[100:103], v195 offset:256
ds_read_b128 v[104:107], v195 offset:320
ds_read_b128 v[108:111], v195 offset:384
ds_read_b128 v[112:115], v195 offset:448
ds_read_b128 v[116:119], v195 offset:512
ds_read_b128 v[120:123], v195 offset:576
ds_read_b128 v[124:127], v195 offset:640
ds_read_b128 v[128:131], v195 offset:704
ds_read_b128 v[132:135], v195 offset:768
ds_read_b128 v[136:139], v195 offset:832
ds_read_b128 v[140:143], v195 offset:896
ds_read_b128 v[144:147], v195 offset:960
s_waitcnt lgkmcnt(15)
v_mfma_f32_16x16x32_bf16 v[76:79], v[84:87], a[0:3], 0
v_mfma_f32_16x16x32_bf16 v[80:83], v[84:87], a[64:67], 0
s_waitcnt lgkmcnt(14)
v_mfma_f32_16x16x32_bf16 v[76:79], v[88:91], a[4:7], v[76:79]
v_mfma_f32_16x16x32_bf16 v[80:83], v[88:91], a[68:71], v[80:83]
s_add_u32 s6, s13, 2883584
buffer_load_dwordx4 a[224:227], v10, s[52:55], s6 offen nt
s_waitcnt lgkmcnt(13)
v_mfma_f32_16x16x32_bf16 v[76:79], v[92:95], a[8:11], v[76:79]
v_mfma_f32_16x16x32_bf16 v[80:83], v[92:95], a[72:75], v[80:83]
s_waitcnt lgkmcnt(12)
v_mfma_f32_16x16x32_bf16 v[76:79], v[96:99], a[12:15], v[76:79]
v_mfma_f32_16x16x32_bf16 v[80:83], v[96:99], a[76:79], v[80:83]
s_add_u32 s6, s13, 2884608
buffer_load_dwordx4 a[228:231], v10, s[52:55], s6 offen nt
s_waitcnt lgkmcnt(11)
v_mfma_f32_16x16x32_bf16 v[76:79], v[100:103], a[16:19], v[76:79]
v_mfma_f32_16x16x32_bf16 v[80:83], v[100:103], a[80:83], v[80:83]
s_waitcnt lgkmcnt(10)
v_mfma_f32_16x16x32_bf16 v[76:79], v[104:107], a[20:23], v[76:79]
v_mfma_f32_16x16x32_bf16 v[80:83], v[104:107], a[84:87], v[80:83]
s_add_u32 s6, s13, 2885632
buffer_load_dwordx4 a[232:235], v10, s[52:55], s6 offen nt
s_waitcnt lgkmcnt(9)
v_mfma_f32_16x16x32_bf16 v[76:79], v[108:111], a[24:27], v[76:79]
v_mfma_f32_16x16x32_bf16 v[80:83], v[108:111], a[88:91], v[80:83]
s_waitcnt lgkmcnt(8)
v_mfma_f32_16x16x32_bf16 v[76:79], v[112:115], a[28:31], v[76:79]
v_mfma_f32_16x16x32_bf16 v[80:83], v[112:115], a[92:95], v[80:83]
s_add_u32 s6, s13, 2886656
buffer_load_dwordx4 a[236:239], v10, s[52:55], s6 offen nt
s_waitcnt lgkmcnt(7)
v_mfma_f32_16x16x32_bf16 v[76:79], v[116:119], a[32:35], v[76:79]
v_mfma_f32_16x16x32_bf16 v[80:83], v[116:119], a[96:99], v[80:83]
s_waitcnt lgkmcnt(6)
v_mfma_f32_16x16x32_bf16 v[76:79], v[120:123], a[36:39], v[76:79]
v_mfma_f32_16x16x32_bf16 v[80:83], v[120:123], a[100:103], v[80:83]
s_add_u32 s6, s13, 3014656
buffer_load_dwordx4 a[240:243], v10, s[52:55], s6 offen nt
s_waitcnt lgkmcnt(5)
v_mfma_f32_16x16x32_bf16 v[76:79], v[124:127], a[40:43], v[76:79]
v_mfma_f32_16x16x32_bf16 v[80:83], v[124:127], a[104:107], v[80:83]
s_waitcnt lgkmcnt(4)
v_mfma_f32_16x16x32_bf16 v[76:79], v[128:131], a[44:47], v[76:79]
v_mfma_f32_16x16x32_bf16 v[80:83], v[128:131], a[108:111], v[80:83]
s_add_u32 s6, s13, 3015680
buffer_load_dwordx4 a[244:247], v10, s[52:55], s6 offen nt
s_waitcnt lgkmcnt(3)
v_mfma_f32_16x16x32_bf16 v[76:79], v[132:135], a[48:51], v[76:79]
v_mfma_f32_16x16x32_bf16 v[80:83], v[132:135], a[112:115], v[80:83]
s_waitcnt lgkmcnt(2)
v_mfma_f32_16x16x32_bf16 v[76:79], v[136:139], a[52:55], v[76:79]
v_mfma_f32_16x16x32_bf16 v[80:83], v[136:139], a[116:119], v[80:83]
s_add_u32 s6, s13, 3016704
buffer_load_dwordx4 a[248:251], v10, s[52:55], s6 offen nt
s_waitcnt lgkmcnt(1)
v_mfma_f32_16x16x32_bf16 v[76:79], v[140:143], a[56:59], v[76:79]
v_mfma_f32_16x16x32_bf16 v[80:83], v[140:143], a[120:123], v[80:83]
s_waitcnt lgkmcnt(0)
v_mfma_f32_16x16x32_bf16 v[76:79], v[144:147], a[60:63], v[76:79]
v_mfma_f32_16x16x32_bf16 v[80:83], v[144:147], a[124:127], v[80:83]
s_add_u32 s6, s13, 3017728
buffer_load_dwordx4 a[252:255], v10, s[52:55], s6 offen nt
s_nop 4
v_max_f32 v190, v76, v77
v_max3_f32 v190, v190, v78, v79
v_mov_b32 v192, v190
s_nop 1
v_permlane16_swap_b32 v190, v192
v_max_f32 v190, v190, v192
v_mov_b32 v192, v190
s_nop 1
v_permlane32_swap_b32 v190, v192
v_max_f32 v190, v190, v192
ds_write_b32 v198, v190 offset:0
v_max_f32 v191, v80, v81
v_max3_f32 v191, v191, v82, v83
v_mov_b32 v192, v191
s_nop 1
v_permlane16_swap_b32 v191, v192
v_max_f32 v191, v191, v192
v_mov_b32 v192, v191
s_nop 1
v_permlane32_swap_b32 v191, v192
v_max_f32 v191, v191, v192
ds_write_b32 v198, v191 offset:256
s_waitcnt lgkmcnt(0)
s_barrier
ds_read_b128 v[164:167], v199
ds_read_b128 v[168:171], v199 offset:256
ds_read_b128 v[172:175], v200
s_waitcnt vmcnt(16)
ds_write_b128 v206, a[128:131] offset:0
ds_write_b128 v206, a[132:135] offset:1088
ds_write_b128 v206, a[136:139] offset:2176
ds_write_b128 v206, a[140:143] offset:3264
ds_write_b128 v206, a[144:147] offset:4352
ds_write_b128 v206, a[148:151] offset:5440
ds_write_b128 v206, a[152:155] offset:6528
ds_write_b128 v206, a[156:159] offset:7616
ds_write_b128 v206, a[160:163] offset:8704
ds_write_b128 v206, a[164:167] offset:9792
ds_write_b128 v206, a[168:171] offset:10880
ds_write_b128 v206, a[172:175] offset:11968
ds_write_b128 v206, a[176:179] offset:13056
ds_write_b128 v206, a[180:183] offset:14144
ds_write_b128 v206, a[184:187] offset:15232
ds_write_b128 v206, a[188:191] offset:16320
s_waitcnt lgkmcnt(15)
v_max_f32 v164, v164, v165
v_max3_f32 v164, v164, v166, v167
v_mul_f32 v164, v164, v185
v_max_f32 v164, v164, v176
v_sub_f32 v182, v176, v164
v_exp_f32 v182, v182
v_mov_b32 v176, v164
v_max_f32 v168, v168, v169
v_max3_f32 v168, v168, v170, v171
v_mul_f32 v168, v168, v185
v_max_f32 v168, v168, v177
v_sub_f32 v183, v177, v168
v_exp_f32 v183, v183
v_mov_b32 v177, v168
v_max_f32 v172, v172, v173
v_max3_f32 v172, v172, v174, v175
v_mul_f32 v172, v172, v185
v_max_f32 v172, v172, v178
v_sub_f32 v184, v178, v172
v_exp_f32 v184, v184
v_mov_b32 v178, v172
v_fma_f32 v76, v76, v185, -v176
v_fma_f32 v77, v77, v185, -v176
v_fma_f32 v78, v78, v185, -v176
v_fma_f32 v79, v79, v185, -v176
v_exp_f32 v76, v76
v_exp_f32 v77, v77
v_exp_f32 v78, v78
v_exp_f32 v79, v79
v_mul_f32 v180, v180, v182
v_cvt_pk_bf16_f32 v186, v76, v77
v_cvt_pk_bf16_f32 v187, v78, v79
ds_write_b64 v201, v[186:187] offset:0
v_add_f32 v180, v180, v76
v_add_f32 v180, v180, v77
v_add_f32 v180, v180, v78
v_add_f32 v180, v180, v79
v_fma_f32 v80, v80, v185, -v177
v_fma_f32 v81, v81, v185, -v177
v_fma_f32 v82, v82, v185, -v177
v_fma_f32 v83, v83, v185, -v177
v_exp_f32 v80, v80
v_exp_f32 v81, v81
v_exp_f32 v82, v82
v_exp_f32 v83, v83
v_mul_f32 v181, v181, v183
v_cvt_pk_bf16_f32 v188, v80, v81
v_cvt_pk_bf16_f32 v189, v82, v83
ds_write_b64 v201, v[188:189] offset:512
v_add_f32 v181, v181, v80
v_add_f32 v181, v181, v81
v_add_f32 v181, v181, v82
v_add_f32 v181, v181, v83
v_mul_f32 v12, v12, v184
v_mul_f32 v13, v13, v184
v_mul_f32 v14, v14, v184
v_mul_f32 v15, v15, v184
v_mul_f32 v16, v16, v184
v_mul_f32 v17, v17, v184
v_mul_f32 v18, v18, v184
v_mul_f32 v19, v19, v184
v_mul_f32 v20, v20, v184
v_mul_f32 v21, v21, v184
v_mul_f32 v22, v22, v184
v_mul_f32 v23, v23, v184
v_mul_f32 v24, v24, v184
v_mul_f32 v25, v25, v184
v_mul_f32 v26, v26, v184
v_mul_f32 v27, v27, v184
v_mul_f32 v28, v28, v184
v_mul_f32 v29, v29, v184
v_mul_f32 v30, v30, v184
v_mul_f32 v31, v31, v184
v_mul_f32 v32, v32, v184
v_mul_f32 v33, v33, v184
v_mul_f32 v34, v34, v184
v_mul_f32 v35, v35, v184
v_mul_f32 v36, v36, v184
v_mul_f32 v37, v37, v184
v_mul_f32 v38, v38, v184
v_mul_f32 v39, v39, v184
v_mul_f32 v40, v40, v184
v_mul_f32 v41, v41, v184
v_mul_f32 v42, v42, v184
v_mul_f32 v43, v43, v184
v_mul_f32 v44, v44, v184
v_mul_f32 v45, v45, v184
v_mul_f32 v46, v46, v184
v_mul_f32 v47, v47, v184
v_mul_f32 v48, v48, v184
v_mul_f32 v49, v49, v184
v_mul_f32 v50, v50, v184
v_mul_f32 v51, v51, v184
v_mul_f32 v52, v52, v184
v_mul_f32 v53, v53, v184
v_mul_f32 v54, v54, v184
v_mul_f32 v55, v55, v184
v_mul_f32 v56, v56, v184
v_mul_f32 v57, v57, v184
v_mul_f32 v58, v58, v184
v_mul_f32 v59, v59, v184
v_mul_f32 v60, v60, v184
v_mul_f32 v61, v61, v184
v_mul_f32 v62, v62, v184
v_mul_f32 v63, v63, v184
v_mul_f32 v64, v64, v184
v_mul_f32 v65, v65, v184
v_mul_f32 v66, v66, v184
v_mul_f32 v67, v67, v184
v_mul_f32 v68, v68, v184
v_mul_f32 v69, v69, v184
v_mul_f32 v70, v70, v184
v_mul_f32 v71, v71, v184
v_mul_f32 v72, v72, v184
v_mul_f32 v73, v73, v184
v_mul_f32 v74, v74, v184
v_mul_f32 v75, v75, v184
s_waitcnt lgkmcnt(0)
s_barrier
ds_read_b128 v[148:151], v202 offset:0
ds_read_b128 v[152:155], v202 offset:1024
ds_read_b128 v[156:159], v202 offset:2048
ds_read_b128 v[160:163], v202 offset:3072
ds_read_b64_tr_b16 v[84:85], v197 offset:0
ds_read_b64_tr_b16 v[86:87], v197 offset:4352
ds_read_b64_tr_b16 v[88:89], v197 offset:64
ds_read_b64_tr_b16 v[90:91], v197 offset:4416
ds_read_b64_tr_b16 v[92:93], v197 offset:128
ds_read_b64_tr_b16 v[94:95], v197 offset:4480
ds_read_b64_tr_b16 v[96:97], v197 offset:192
ds_read_b64_tr_b16 v[98:99], v197 offset:4544
ds_read_b64_tr_b16 v[100:101], v197 offset:17408
ds_read_b64_tr_b16 v[102:103], v197 offset:21760
ds_read_b64_tr_b16 v[104:105], v197 offset:17472
ds_read_b64_tr_b16 v[106:107], v197 offset:21824
ds_read_b64_tr_b16 v[108:109], v197 offset:17536
ds_read_b64_tr_b16 v[110:111], v197 offset:21888
ds_read_b64_tr_b16 v[112:113], v197 offset:17600
ds_read_b64_tr_b16 v[114:115], v197 offset:21952
ds_read_b64_tr_b16 v[116:117], v197 offset:34816
ds_read_b64_tr_b16 v[118:119], v197 offset:39168
ds_read_b64_tr_b16 v[120:121], v197 offset:34880
ds_read_b64_tr_b16 v[122:123], v197 offset:39232
ds_read_b64_tr_b16 v[124:125], v197 offset:34944
ds_read_b64_tr_b16 v[126:127], v197 offset:39296
ds_read_b64_tr_b16 v[128:129], v197 offset:35008
ds_read_b64_tr_b16 v[130:131], v197 offset:39360
ds_read_b64_tr_b16 v[132:133], v197 offset:52224
ds_read_b64_tr_b16 v[134:135], v197 offset:56576
ds_read_b64_tr_b16 v[136:137], v197 offset:52288
ds_read_b64_tr_b16 v[138:139], v197 offset:56640
ds_read_b64_tr_b16 v[140:141], v197 offset:52352
ds_read_b64_tr_b16 v[142:143], v197 offset:56704
ds_read_b64_tr_b16 v[144:145], v197 offset:52416
ds_read_b64_tr_b16 v[146:147], v197 offset:56768
s_waitcnt lgkmcnt(15)
v_mfma_f32_32x32x16_bf16 v[12:27], v[84:87], v[148:151], v[12:27]
v_mfma_f32_32x32x16_bf16 v[28:43], v[88:91], v[148:151], v[28:43]
s_add_u32 s6, s13, 3145728
buffer_load_dwordx4 a[128:131], v2, s[52:55], s6 offen nt
v_mfma_f32_32x32x16_bf16 v[44:59], v[92:95], v[148:151], v[44:59]
v_mfma_f32_32x32x16_bf16 v[60:75], v[96:99], v[148:151], v[60:75]
s_add_u32 s6, s13, 3146752
buffer_load_dwordx4 a[132:135], v2, s[52:55], s6 offen nt
s_waitcnt lgkmcnt(15)
v_mfma_f32_32x32x16_bf16 v[12:27], v[100:103], v[152:155], v[12:27]
v_mfma_f32_32x32x16_bf16 v[28:43], v[104:107], v[152:155], v[28:43]
s_add_u32 s6, s13, 3147776
buffer_load_dwordx4 a[136:139], v2, s[52:55], s6 offen nt
v_mfma_f32_32x32x16_bf16 v[44:59], v[108:111], v[152:155], v[44:59]
v_mfma_f32_32x32x16_bf16 v[60:75], v[112:115], v[152:155], v[60:75]
s_add_u32 s6, s13, 3148800
buffer_load_dwordx4 a[140:143], v2, s[52:55], s6 offen nt
s_waitcnt lgkmcnt(8)
v_mfma_f32_32x32x16_bf16 v[12:27], v[116:119], v[156:159], v[12:27]
v_mfma_f32_32x32x16_bf16 v[28:43], v[120:123], v[156:159], v[28:43]
s_add_u32 s6, s13, 3276800
buffer_load_dwordx4 a[144:147], v2, s[52:55], s6 offen nt
v_mfma_f32_32x32x16_bf16 v[44:59], v[124:127], v[156:159], v[44:59]
v_mfma_f32_32x32x16_bf16 v[60:75], v[128:131], v[156:159], v[60:75]
s_add_u32 s6, s13, 3277824
buffer_load_dwordx4 a[148:151], v2, s[52:55], s6 offen nt
s_waitcnt lgkmcnt(0)
v_mfma_f32_32x32x16_bf16 v[12:27], v[132:135], v[160:163], v[12:27]
v_mfma_f32_32x32x16_bf16 v[28:43], v[136:139], v[160:163], v[28:43]
s_add_u32 s6, s13, 3278848
buffer_load_dwordx4 a[152:155], v2, s[52:55], s6 offen nt
v_mfma_f32_32x32x16_bf16 v[44:59], v[140:143], v[160:163], v[44:59]
v_mfma_f32_32x32x16_bf16 v[60:75], v[144:147], v[160:163], v[60:75]
s_add_u32 s6, s13, 3279872
buffer_load_dwordx4 a[156:159], v2, s[52:55], s6 offen nt
ds_read_b128 v[84:87], v194 offset:0
ds_read_b128 v[88:91], v194 offset:64
ds_read_b128 v[92:95], v194 offset:128
ds_read_b128 v[96:99], v194 offset:192
ds_read_b128 v[100:103], v194 offset:256
ds_read_b128 v[104:107], v194 offset:320
ds_read_b128 v[108:111], v194 offset:384
ds_read_b128 v[112:115], v194 offset:448
ds_read_b128 v[116:119], v194 offset:512
ds_read_b128 v[120:123], v194 offset:576
ds_read_b128 v[124:127], v194 offset:640
ds_read_b128 v[128:131], v194 offset:704
ds_read_b128 v[132:135], v194 offset:768
ds_read_b128 v[136:139], v194 offset:832
ds_read_b128 v[140:143], v194 offset:896
ds_read_b128 v[144:147], v194 offset:960
s_waitcnt lgkmcnt(15)
v_mfma_f32_16x16x32_bf16 v[76:79], v[84:87], a[0:3], 0
v_mfma_f32_16x16x32_bf16 v[80:83], v[84:87], a[64:67], 0
s_waitcnt lgkmcnt(14)
v_mfma_f32_16x16x32_bf16 v[76:79], v[88:91], a[4:7], v[76:79]
v_mfma_f32_16x16x32_bf16 v[80:83], v[88:91], a[68:71], v[80:83]
s_add_u32 s6, s13, 3407872
buffer_load_dwordx4 a[160:163], v10, s[52:55], s6 offen nt
s_waitcnt lgkmcnt(13)
v_mfma_f32_16x16x32_bf16 v[76:79], v[92:95], a[8:11], v[76:79]
v_mfma_f32_16x16x32_bf16 v[80:83], v[92:95], a[72:75], v[80:83]
s_waitcnt lgkmcnt(12)
v_mfma_f32_16x16x32_bf16 v[76:79], v[96:99], a[12:15], v[76:79]
v_mfma_f32_16x16x32_bf16 v[80:83], v[96:99], a[76:79], v[80:83]
s_add_u32 s6, s13, 3408896
buffer_load_dwordx4 a[164:167], v10, s[52:55], s6 offen nt
s_waitcnt lgkmcnt(11)
v_mfma_f32_16x16x32_bf16 v[76:79], v[100:103], a[16:19], v[76:79]
v_mfma_f32_16x16x32_bf16 v[80:83], v[100:103], a[80:83], v[80:83]
s_waitcnt lgkmcnt(10)
v_mfma_f32_16x16x32_bf16 v[76:79], v[104:107], a[20:23], v[76:79]
v_mfma_f32_16x16x32_bf16 v[80:83], v[104:107], a[84:87], v[80:83]
s_add_u32 s6, s13, 3409920
buffer_load_dwordx4 a[168:171], v10, s[52:55], s6 offen nt
s_waitcnt lgkmcnt(9)
v_mfma_f32_16x16x32_bf16 v[76:79], v[108:111], a[24:27], v[76:79]
v_mfma_f32_16x16x32_bf16 v[80:83], v[108:111], a[88:91], v[80:83]
s_waitcnt lgkmcnt(8)
v_mfma_f32_16x16x32_bf16 v[76:79], v[112:115], a[28:31], v[76:79]
v_mfma_f32_16x16x32_bf16 v[80:83], v[112:115], a[92:95], v[80:83]
s_add_u32 s6, s13, 3410944
buffer_load_dwordx4 a[172:175], v10, s[52:55], s6 offen nt
s_waitcnt lgkmcnt(7)
v_mfma_f32_16x16x32_bf16 v[76:79], v[116:119], a[32:35], v[76:79]
v_mfma_f32_16x16x32_bf16 v[80:83], v[116:119], a[96:99], v[80:83]
s_waitcnt lgkmcnt(6)
v_mfma_f32_16x16x32_bf16 v[76:79], v[120:123], a[36:39], v[76:79]
v_mfma_f32_16x16x32_bf16 v[80:83], v[120:123], a[100:103], v[80:83]
s_add_u32 s6, s13, 3538944
buffer_load_dwordx4 a[176:179], v10, s[52:55], s6 offen nt
s_waitcnt lgkmcnt(5)
v_mfma_f32_16x16x32_bf16 v[76:79], v[124:127], a[40:43], v[76:79]
v_mfma_f32_16x16x32_bf16 v[80:83], v[124:127], a[104:107], v[80:83]
s_waitcnt lgkmcnt(4)
v_mfma_f32_16x16x32_bf16 v[76:79], v[128:131], a[44:47], v[76:79]
v_mfma_f32_16x16x32_bf16 v[80:83], v[128:131], a[108:111], v[80:83]
s_add_u32 s6, s13, 3539968
buffer_load_dwordx4 a[180:183], v10, s[52:55], s6 offen nt
s_waitcnt lgkmcnt(3)
v_mfma_f32_16x16x32_bf16 v[76:79], v[132:135], a[48:51], v[76:79]
v_mfma_f32_16x16x32_bf16 v[80:83], v[132:135], a[112:115], v[80:83]
s_waitcnt lgkmcnt(2)
v_mfma_f32_16x16x32_bf16 v[76:79], v[136:139], a[52:55], v[76:79]
v_mfma_f32_16x16x32_bf16 v[80:83], v[136:139], a[116:119], v[80:83]
s_add_u32 s6, s13, 3540992
buffer_load_dwordx4 a[184:187], v10, s[52:55], s6 offen nt
s_waitcnt lgkmcnt(1)
v_mfma_f32_16x16x32_bf16 v[76:79], v[140:143], a[56:59], v[76:79]
v_mfma_f32_16x16x32_bf16 v[80:83], v[140:143], a[120:123], v[80:83]
s_waitcnt lgkmcnt(0)
v_mfma_f32_16x16x32_bf16 v[76:79], v[144:147], a[60:63], v[76:79]
v_mfma_f32_16x16x32_bf16 v[80:83], v[144:147], a[124:127], v[80:83]
s_add_u32 s6, s13, 3542016
buffer_load_dwordx4 a[188:191], v10, s[52:55], s6 offen nt
s_nop 4
v_max_f32 v190, v76, v77
v_max3_f32 v190, v190, v78, v79
v_mov_b32 v192, v190
s_nop 1
v_permlane16_swap_b32 v190, v192
v_max_f32 v190, v190, v192
v_mov_b32 v192, v190
s_nop 1
v_permlane32_swap_b32 v190, v192
v_max_f32 v190, v190, v192
ds_write_b32 v198, v190 offset:0
v_max_f32 v191, v80, v81
v_max3_f32 v191, v191, v82, v83
v_mov_b32 v192, v191
s_nop 1
v_permlane16_swap_b32 v191, v192
v_max_f32 v191, v191, v192
v_mov_b32 v192, v191
s_nop 1
v_permlane32_swap_b32 v191, v192
v_max_f32 v191, v191, v192
ds_write_b32 v198, v191 offset:256
s_waitcnt lgkmcnt(0)
s_barrier
ds_read_b128 v[164:167], v199
ds_read_b128 v[168:171], v199 offset:256
ds_read_b128 v[172:175], v200
s_waitcnt vmcnt(16)
ds_write_b128 v207, a[192:195] offset:0
ds_write_b128 v207, a[196:199] offset:1088
ds_write_b128 v207, a[200:203] offset:2176
ds_write_b128 v207, a[204:207] offset:3264
ds_write_b128 v207, a[208:211] offset:4352
ds_write_b128 v207, a[212:215] offset:5440
ds_write_b128 v207, a[216:219] offset:6528
ds_write_b128 v207, a[220:223] offset:7616
ds_write_b128 v207, a[224:227] offset:8704
ds_write_b128 v207, a[228:231] offset:9792
ds_write_b128 v207, a[232:235] offset:10880
ds_write_b128 v207, a[236:239] offset:11968
ds_write_b128 v207, a[240:243] offset:13056
ds_write_b128 v207, a[244:247] offset:14144
ds_write_b128 v207, a[248:251] offset:15232
ds_write_b128 v207, a[252:255] offset:16320
s_waitcnt lgkmcnt(15)
v_max_f32 v164, v164, v165
v_max3_f32 v164, v164, v166, v167
v_mul_f32 v164, v164, v185
v_max_f32 v164, v164, v176
v_sub_f32 v182, v176, v164
v_exp_f32 v182, v182
v_mov_b32 v176, v164
v_max_f32 v168, v168, v169
v_max3_f32 v168, v168, v170, v171
v_mul_f32 v168, v168, v185
v_max_f32 v168, v168, v177
v_sub_f32 v183, v177, v168
v_exp_f32 v183, v183
v_mov_b32 v177, v168
v_max_f32 v172, v172, v173
v_max3_f32 v172, v172, v174, v175
v_mul_f32 v172, v172, v185
v_max_f32 v172, v172, v178
v_sub_f32 v184, v178, v172
v_exp_f32 v184, v184
v_mov_b32 v178, v172
v_fma_f32 v76, v76, v185, -v176
v_fma_f32 v77, v77, v185, -v176
v_fma_f32 v78, v78, v185, -v176
v_fma_f32 v79, v79, v185, -v176
v_exp_f32 v76, v76
v_exp_f32 v77, v77
v_exp_f32 v78, v78
v_exp_f32 v79, v79
v_mul_f32 v180, v180, v182
v_cvt_pk_bf16_f32 v186, v76, v77
v_cvt_pk_bf16_f32 v187, v78, v79
ds_write_b64 v201, v[186:187] offset:0
v_add_f32 v180, v180, v76
v_add_f32 v180, v180, v77
v_add_f32 v180, v180, v78
v_add_f32 v180, v180, v79
v_fma_f32 v80, v80, v185, -v177
v_fma_f32 v81, v81, v185, -v177
v_fma_f32 v82, v82, v185, -v177
v_fma_f32 v83, v83, v185, -v177
v_exp_f32 v80, v80
v_exp_f32 v81, v81
v_exp_f32 v82, v82
v_exp_f32 v83, v83
v_mul_f32 v181, v181, v183
v_cvt_pk_bf16_f32 v188, v80, v81
v_cvt_pk_bf16_f32 v189, v82, v83
ds_write_b64 v201, v[188:189] offset:512
v_add_f32 v181, v181, v80
v_add_f32 v181, v181, v81
v_add_f32 v181, v181, v82
v_add_f32 v181, v181, v83
v_mul_f32 v12, v12, v184
v_mul_f32 v13, v13, v184
v_mul_f32 v14, v14, v184
v_mul_f32 v15, v15, v184
v_mul_f32 v16, v16, v184
v_mul_f32 v17, v17, v184
v_mul_f32 v18, v18, v184
v_mul_f32 v19, v19, v184
v_mul_f32 v20, v20, v184
v_mul_f32 v21, v21, v184
v_mul_f32 v22, v22, v184
v_mul_f32 v23, v23, v184
v_mul_f32 v24, v24, v184
v_mul_f32 v25, v25, v184
v_mul_f32 v26, v26, v184
v_mul_f32 v27, v27, v184
v_mul_f32 v28, v28, v184
v_mul_f32 v29, v29, v184
v_mul_f32 v30, v30, v184
v_mul_f32 v31, v31, v184
v_mul_f32 v32, v32, v184
v_mul_f32 v33, v33, v184
v_mul_f32 v34, v34, v184
v_mul_f32 v35, v35, v184
v_mul_f32 v36, v36, v184
v_mul_f32 v37, v37, v184
v_mul_f32 v38, v38, v184
v_mul_f32 v39, v39, v184
v_mul_f32 v40, v40, v184
v_mul_f32 v41, v41, v184
v_mul_f32 v42, v42, v184
v_mul_f32 v43, v43, v184
v_mul_f32 v44, v44, v184
v_mul_f32 v45, v45, v184
v_mul_f32 v46, v46, v184
v_mul_f32 v47, v47, v184
v_mul_f32 v48, v48, v184
v_mul_f32 v49, v49, v184
v_mul_f32 v50, v50, v184
v_mul_f32 v51, v51, v184
v_mul_f32 v52, v52, v184
v_mul_f32 v53, v53, v184
v_mul_f32 v54, v54, v184
v_mul_f32 v55, v55, v184
v_mul_f32 v56, v56, v184
v_mul_f32 v57, v57, v184
v_mul_f32 v58, v58, v184
v_mul_f32 v59, v59, v184
v_mul_f32 v60, v60, v184
v_mul_f32 v61, v61, v184
v_mul_f32 v62, v62, v184
v_mul_f32 v63, v63, v184
v_mul_f32 v64, v64, v184
v_mul_f32 v65, v65, v184
v_mul_f32 v66, v66, v184
v_mul_f32 v67, v67, v184
v_mul_f32 v68, v68, v184
v_mul_f32 v69, v69, v184
v_mul_f32 v70, v70, v184
v_mul_f32 v71, v71, v184
v_mul_f32 v72, v72, v184
v_mul_f32 v73, v73, v184
v_mul_f32 v74, v74, v184
v_mul_f32 v75, v75, v184
s_waitcnt lgkmcnt(0)
s_barrier
ds_read_b128 v[148:151], v202 offset:0
ds_read_b128 v[152:155], v202 offset:1024
ds_read_b128 v[156:159], v202 offset:2048
ds_read_b128 v[160:163], v202 offset:3072
ds_read_b64_tr_b16 v[84:85], v196 offset:0
ds_read_b64_tr_b16 v[86:87], v196 offset:4352
ds_read_b64_tr_b16 v[88:89], v196 offset:64
ds_read_b64_tr_b16 v[90:91], v196 offset:4416
ds_read_b64_tr_b16 v[92:93], v196 offset:128
ds_read_b64_tr_b16 v[94:95], v196 offset:4480
ds_read_b64_tr_b16 v[96:97], v196 offset:192
ds_read_b64_tr_b16 v[98:99], v196 offset:4544
ds_read_b64_tr_b16 v[100:101], v196 offset:17408
ds_read_b64_tr_b16 v[102:103], v196 offset:21760
ds_read_b64_tr_b16 v[104:105], v196 offset:17472
ds_read_b64_tr_b16 v[106:107], v196 offset:21824
ds_read_b64_tr_b16 v[108:109], v196 offset:17536
ds_read_b64_tr_b16 v[110:111], v196 offset:21888
ds_read_b64_tr_b16 v[112:113], v196 offset:17600
ds_read_b64_tr_b16 v[114:115], v196 offset:21952
ds_read_b64_tr_b16 v[116:117], v196 offset:34816
ds_read_b64_tr_b16 v[118:119], v196 offset:39168
ds_read_b64_tr_b16 v[120:121], v196 offset:34880
ds_read_b64_tr_b16 v[122:123], v196 offset:39232
ds_read_b64_tr_b16 v[124:125], v196 offset:34944
ds_read_b64_tr_b16 v[126:127], v196 offset:39296
ds_read_b64_tr_b16 v[128:129], v196 offset:35008
ds_read_b64_tr_b16 v[130:131], v196 offset:39360
ds_read_b64_tr_b16 v[132:133], v196 offset:52224
ds_read_b64_tr_b16 v[134:135], v196 offset:56576
ds_read_b64_tr_b16 v[136:137], v196 offset:52288
ds_read_b64_tr_b16 v[138:139], v196 offset:56640
ds_read_b64_tr_b16 v[140:141], v196 offset:52352
ds_read_b64_tr_b16 v[142:143], v196 offset:56704
ds_read_b64_tr_b16 v[144:145], v196 offset:52416
ds_read_b64_tr_b16 v[146:147], v196 offset:56768
s_waitcnt lgkmcnt(15)
v_mfma_f32_32x32x16_bf16 v[12:27], v[84:87], v[148:151], v[12:27]
v_mfma_f32_32x32x16_bf16 v[28:43], v[88:91], v[148:151], v[28:43]
s_add_u32 s6, s13, 3670016
buffer_load_dwordx4 a[192:195], v2, s[52:55], s6 offen nt
v_mfma_f32_32x32x16_bf16 v[44:59], v[92:95], v[148:151], v[44:59]
v_mfma_f32_32x32x16_bf16 v[60:75], v[96:99], v[148:151], v[60:75]
s_add_u32 s6, s13, 3671040
buffer_load_dwordx4 a[196:199], v2, s[52:55], s6 offen nt
s_waitcnt lgkmcnt(15)
v_mfma_f32_32x32x16_bf16 v[12:27], v[100:103], v[152:155], v[12:27]
v_mfma_f32_32x32x16_bf16 v[28:43], v[104:107], v[152:155], v[28:43]
s_add_u32 s6, s13, 3672064
buffer_load_dwordx4 a[200:203], v2, s[52:55], s6 offen nt
v_mfma_f32_32x32x16_bf16 v[44:59], v[108:111], v[152:155], v[44:59]
v_mfma_f32_32x32x16_bf16 v[60:75], v[112:115], v[152:155], v[60:75]
s_add_u32 s6, s13, 3673088
buffer_load_dwordx4 a[204:207], v2, s[52:55], s6 offen nt
s_waitcnt lgkmcnt(8)
v_mfma_f32_32x32x16_bf16 v[12:27], v[116:119], v[156:159], v[12:27]
v_mfma_f32_32x32x16_bf16 v[28:43], v[120:123], v[156:159], v[28:43]
s_add_u32 s6, s13, 3801088
buffer_load_dwordx4 a[208:211], v2, s[52:55], s6 offen nt
v_mfma_f32_32x32x16_bf16 v[44:59], v[124:127], v[156:159], v[44:59]
v_mfma_f32_32x32x16_bf16 v[60:75], v[128:131], v[156:159], v[60:75]
s_add_u32 s6, s13, 3802112
buffer_load_dwordx4 a[212:215], v2, s[52:55], s6 offen nt
s_waitcnt lgkmcnt(0)
v_mfma_f32_32x32x16_bf16 v[12:27], v[132:135], v[160:163], v[12:27]
v_mfma_f32_32x32x16_bf16 v[28:43], v[136:139], v[160:163], v[28:43]
s_add_u32 s6, s13, 3803136
buffer_load_dwordx4 a[216:219], v2, s[52:55], s6 offen nt
v_mfma_f32_32x32x16_bf16 v[44:59], v[140:143], v[160:163], v[44:59]
v_mfma_f32_32x32x16_bf16 v[60:75], v[144:147], v[160:163], v[60:75]
s_add_u32 s6, s13, 3804160
buffer_load_dwordx4 a[220:223], v2, s[52:55], s6 offen nt
ds_read_b128 v[84:87], v195 offset:0
ds_read_b128 v[88:91], v195 offset:64
ds_read_b128 v[92:95], v195 offset:128
ds_read_b128 v[96:99], v195 offset:192
ds_read_b128 v[100:103], v195 offset:256
ds_read_b128 v[104:107], v195 offset:320
ds_read_b128 v[108:111], v195 offset:384
ds_read_b128 v[112:115], v195 offset:448
ds_read_b128 v[116:119], v195 offset:512
ds_read_b128 v[120:123], v195 offset:576
ds_read_b128 v[124:127], v195 offset:640
ds_read_b128 v[128:131], v195 offset:704
ds_read_b128 v[132:135], v195 offset:768
ds_read_b128 v[136:139], v195 offset:832
ds_read_b128 v[140:143], v195 offset:896
ds_read_b128 v[144:147], v195 offset:960
s_waitcnt lgkmcnt(15)
v_mfma_f32_16x16x32_bf16 v[76:79], v[84:87], a[0:3], 0
v_mfma_f32_16x16x32_bf16 v[80:83], v[84:87], a[64:67], 0
s_waitcnt lgkmcnt(14)
v_mfma_f32_16x16x32_bf16 v[76:79], v[88:91], a[4:7], v[76:79]
v_mfma_f32_16x16x32_bf16 v[80:83], v[88:91], a[68:71], v[80:83]
s_add_u32 s6, s13, 3932160
buffer_load_dwordx4 a[224:227], v10, s[52:55], s6 offen nt
s_waitcnt lgkmcnt(13)
v_mfma_f32_16x16x32_bf16 v[76:79], v[92:95], a[8:11], v[76:79]
v_mfma_f32_16x16x32_bf16 v[80:83], v[92:95], a[72:75], v[80:83]
s_waitcnt lgkmcnt(12)
v_mfma_f32_16x16x32_bf16 v[76:79], v[96:99], a[12:15], v[76:79]
v_mfma_f32_16x16x32_bf16 v[80:83], v[96:99], a[76:79], v[80:83]
s_add_u32 s6, s13, 3933184
buffer_load_dwordx4 a[228:231], v10, s[52:55], s6 offen nt
s_waitcnt lgkmcnt(11)
v_mfma_f32_16x16x32_bf16 v[76:79], v[100:103], a[16:19], v[76:79]
v_mfma_f32_16x16x32_bf16 v[80:83], v[100:103], a[80:83], v[80:83]
s_waitcnt lgkmcnt(10)
v_mfma_f32_16x16x32_bf16 v[76:79], v[104:107], a[20:23], v[76:79]
v_mfma_f32_16x16x32_bf16 v[80:83], v[104:107], a[84:87], v[80:83]
s_add_u32 s6, s13, 3934208
buffer_load_dwordx4 a[232:235], v10, s[52:55], s6 offen nt
s_waitcnt lgkmcnt(9)
v_mfma_f32_16x16x32_bf16 v[76:79], v[108:111], a[24:27], v[76:79]
v_mfma_f32_16x16x32_bf16 v[80:83], v[108:111], a[88:91], v[80:83]
s_waitcnt lgkmcnt(8)
v_mfma_f32_16x16x32_bf16 v[76:79], v[112:115], a[28:31], v[76:79]
v_mfma_f32_16x16x32_bf16 v[80:83], v[112:115], a[92:95], v[80:83]
s_add_u32 s6, s13, 3935232
buffer_load_dwordx4 a[236:239], v10, s[52:55], s6 offen nt
s_waitcnt lgkmcnt(7)
v_mfma_f32_16x16x32_bf16 v[76:79], v[116:119], a[32:35], v[76:79]
v_mfma_f32_16x16x32_bf16 v[80:83], v[116:119], a[96:99], v[80:83]
s_waitcnt lgkmcnt(6)
v_mfma_f32_16x16x32_bf16 v[76:79], v[120:123], a[36:39], v[76:79]
v_mfma_f32_16x16x32_bf16 v[80:83], v[120:123], a[100:103], v[80:83]
s_add_u32 s6, s13, 4063232
buffer_load_dwordx4 a[240:243], v10, s[52:55], s6 offen nt
s_waitcnt lgkmcnt(5)
v_mfma_f32_16x16x32_bf16 v[76:79], v[124:127], a[40:43], v[76:79]
v_mfma_f32_16x16x32_bf16 v[80:83], v[124:127], a[104:107], v[80:83]
s_waitcnt lgkmcnt(4)
v_mfma_f32_16x16x32_bf16 v[76:79], v[128:131], a[44:47], v[76:79]
v_mfma_f32_16x16x32_bf16 v[80:83], v[128:131], a[108:111], v[80:83]
s_add_u32 s6, s13, 4064256
buffer_load_dwordx4 a[244:247], v10, s[52:55], s6 offen nt
s_waitcnt lgkmcnt(3)
v_mfma_f32_16x16x32_bf16 v[76:79], v[132:135], a[48:51], v[76:79]
v_mfma_f32_16x16x32_bf16 v[80:83], v[132:135], a[112:115], v[80:83]
s_waitcnt lgkmcnt(2)
v_mfma_f32_16x16x32_bf16 v[76:79], v[136:139], a[52:55], v[76:79]
v_mfma_f32_16x16x32_bf16 v[80:83], v[136:139], a[116:119], v[80:83]
s_add_u32 s6, s13, 4065280
buffer_load_dwordx4 a[248:251], v10, s[52:55], s6 offen nt
s_waitcnt lgkmcnt(1)
v_mfma_f32_16x16x32_bf16 v[76:79], v[140:143], a[56:59], v[76:79]
v_mfma_f32_16x16x32_bf16 v[80:83], v[140:143], a[120:123], v[80:83]
s_waitcnt lgkmcnt(0)
v_mfma_f32_16x16x32_bf16 v[76:79], v[144:147], a[60:63], v[76:79]
v_mfma_f32_16x16x32_bf16 v[80:83], v[144:147], a[124:127], v[80:83]
s_add_u32 s6, s13, 4066304
buffer_load_dwordx4 a[252:255], v10, s[52:55], s6 offen nt
s_nop 4
v_max_f32 v190, v76, v77
v_max3_f32 v190, v190, v78, v79
v_mov_b32 v192, v190
s_nop 1
v_permlane16_swap_b32 v190, v192
v_max_f32 v190, v190, v192
v_mov_b32 v192, v190
s_nop 1
v_permlane32_swap_b32 v190, v192
v_max_f32 v190, v190, v192
ds_write_b32 v198, v190 offset:0
v_max_f32 v191, v80, v81
v_max3_f32 v191, v191, v82, v83
v_mov_b32 v192, v191
s_nop 1
v_permlane16_swap_b32 v191, v192
v_max_f32 v191, v191, v192
v_mov_b32 v192, v191
s_nop 1
v_permlane32_swap_b32 v191, v192
v_max_f32 v191, v191, v192
ds_write_b32 v198, v191 offset:256
s_waitcnt lgkmcnt(0)
s_barrier
ds_read_b128 v[164:167], v199
ds_read_b128 v[168:171], v199 offset:256
ds_read_b128 v[172:175], v200
s_waitcnt vmcnt(16)
ds_write_b128 v206, a[128:131] offset:0
ds_write_b128 v206, a[132:135] offset:1088
ds_write_b128 v206, a[136:139] offset:2176
ds_write_b128 v206, a[140:143] offset:3264
ds_write_b128 v206, a[144:147] offset:4352
ds_write_b128 v206, a[148:151] offset:5440
ds_write_b128 v206, a[152:155] offset:6528
ds_write_b128 v206, a[156:159] offset:7616
ds_write_b128 v206, a[160:163] offset:8704
ds_write_b128 v206, a[164:167] offset:9792
ds_write_b128 v206, a[168:171] offset:10880
ds_write_b128 v206, a[172:175] offset:11968
ds_write_b128 v206, a[176:179] offset:13056
ds_write_b128 v206, a[180:183] offset:14144
ds_write_b128 v206, a[184:187] offset:15232
ds_write_b128 v206, a[188:191] offset:16320
s_waitcnt lgkmcnt(15)
v_max_f32 v164, v164, v165
v_max3_f32 v164, v164, v166, v167
v_mul_f32 v164, v164, v185
v_max_f32 v164, v164, v176
v_sub_f32 v182, v176, v164
v_exp_f32 v182, v182
v_mov_b32 v176, v164
v_max_f32 v168, v168, v169
v_max3_f32 v168, v168, v170, v171
v_mul_f32 v168, v168, v185
v_max_f32 v168, v168, v177
v_sub_f32 v183, v177, v168
v_exp_f32 v183, v183
v_mov_b32 v177, v168
v_max_f32 v172, v172, v173
v_max3_f32 v172, v172, v174, v175
v_mul_f32 v172, v172, v185
v_max_f32 v172, v172, v178
v_sub_f32 v184, v178, v172
v_exp_f32 v184, v184
v_mov_b32 v178, v172
v_fma_f32 v76, v76, v185, -v176
v_fma_f32 v77, v77, v185, -v176
v_fma_f32 v78, v78, v185, -v176
v_fma_f32 v79, v79, v185, -v176
v_exp_f32 v76, v76
v_exp_f32 v77, v77
v_exp_f32 v78, v78
v_exp_f32 v79, v79
v_mul_f32 v180, v180, v182
v_cvt_pk_bf16_f32 v186, v76, v77
v_cvt_pk_bf16_f32 v187, v78, v79
ds_write_b64 v201, v[186:187] offset:0
v_add_f32 v180, v180, v76
v_add_f32 v180, v180, v77
v_add_f32 v180, v180, v78
v_add_f32 v180, v180, v79
v_fma_f32 v80, v80, v185, -v177
v_fma_f32 v81, v81, v185, -v177
v_fma_f32 v82, v82, v185, -v177
v_fma_f32 v83, v83, v185, -v177
v_exp_f32 v80, v80
v_exp_f32 v81, v81
v_exp_f32 v82, v82
v_exp_f32 v83, v83
v_mul_f32 v181, v181, v183
v_cvt_pk_bf16_f32 v188, v80, v81
v_cvt_pk_bf16_f32 v189, v82, v83
ds_write_b64 v201, v[188:189] offset:512
v_add_f32 v181, v181, v80
v_add_f32 v181, v181, v81
v_add_f32 v181, v181, v82
v_add_f32 v181, v181, v83
v_mul_f32 v12, v12, v184
v_mul_f32 v13, v13, v184
v_mul_f32 v14, v14, v184
v_mul_f32 v15, v15, v184
v_mul_f32 v16, v16, v184
v_mul_f32 v17, v17, v184
v_mul_f32 v18, v18, v184
v_mul_f32 v19, v19, v184
v_mul_f32 v20, v20, v184
v_mul_f32 v21, v21, v184
v_mul_f32 v22, v22, v184
v_mul_f32 v23, v23, v184
v_mul_f32 v24, v24, v184
v_mul_f32 v25, v25, v184
v_mul_f32 v26, v26, v184
v_mul_f32 v27, v27, v184
v_mul_f32 v28, v28, v184
v_mul_f32 v29, v29, v184
v_mul_f32 v30, v30, v184
v_mul_f32 v31, v31, v184
v_mul_f32 v32, v32, v184
v_mul_f32 v33, v33, v184
v_mul_f32 v34, v34, v184
v_mul_f32 v35, v35, v184
v_mul_f32 v36, v36, v184
v_mul_f32 v37, v37, v184
v_mul_f32 v38, v38, v184
v_mul_f32 v39, v39, v184
v_mul_f32 v40, v40, v184
v_mul_f32 v41, v41, v184
v_mul_f32 v42, v42, v184
v_mul_f32 v43, v43, v184
v_mul_f32 v44, v44, v184
v_mul_f32 v45, v45, v184
v_mul_f32 v46, v46, v184
v_mul_f32 v47, v47, v184
v_mul_f32 v48, v48, v184
v_mul_f32 v49, v49, v184
v_mul_f32 v50, v50, v184
v_mul_f32 v51, v51, v184
v_mul_f32 v52, v52, v184
v_mul_f32 v53, v53, v184
v_mul_f32 v54, v54, v184
v_mul_f32 v55, v55, v184
v_mul_f32 v56, v56, v184
v_mul_f32 v57, v57, v184
v_mul_f32 v58, v58, v184
v_mul_f32 v59, v59, v184
v_mul_f32 v60, v60, v184
v_mul_f32 v61, v61, v184
v_mul_f32 v62, v62, v184
v_mul_f32 v63, v63, v184
v_mul_f32 v64, v64, v184
v_mul_f32 v65, v65, v184
v_mul_f32 v66, v66, v184
v_mul_f32 v67, v67, v184
v_mul_f32 v68, v68, v184
v_mul_f32 v69, v69, v184
v_mul_f32 v70, v70, v184
v_mul_f32 v71, v71, v184
v_mul_f32 v72, v72, v184
v_mul_f32 v73, v73, v184
v_mul_f32 v74, v74, v184
v_mul_f32 v75, v75, v184
s_waitcnt lgkmcnt(0)
s_barrier
ds_read_b128 v[148:151], v202 offset:0
ds_read_b128 v[152:155], v202 offset:1024
ds_read_b128 v[156:159], v202 offset:2048
ds_read_b128 v[160:163], v202 offset:3072
ds_read_b64_tr_b16 v[84:85], v197 offset:0
ds_read_b64_tr_b16 v[86:87], v197 offset:4352
ds_read_b64_tr_b16 v[88:89], v197 offset:64
ds_read_b64_tr_b16 v[90:91], v197 offset:4416
ds_read_b64_tr_b16 v[92:93], v197 offset:128
ds_read_b64_tr_b16 v[94:95], v197 offset:4480
ds_read_b64_tr_b16 v[96:97], v197 offset:192
ds_read_b64_tr_b16 v[98:99], v197 offset:4544
ds_read_b64_tr_b16 v[100:101], v197 offset:17408
ds_read_b64_tr_b16 v[102:103], v197 offset:21760
ds_read_b64_tr_b16 v[104:105], v197 offset:17472
ds_read_b64_tr_b16 v[106:107], v197 offset:21824
ds_read_b64_tr_b16 v[108:109], v197 offset:17536
ds_read_b64_tr_b16 v[110:111], v197 offset:21888
ds_read_b64_tr_b16 v[112:113], v197 offset:17600
ds_read_b64_tr_b16 v[114:115], v197 offset:21952
ds_read_b64_tr_b16 v[116:117], v197 offset:34816
ds_read_b64_tr_b16 v[118:119], v197 offset:39168
ds_read_b64_tr_b16 v[120:121], v197 offset:34880
ds_read_b64_tr_b16 v[122:123], v197 offset:39232
ds_read_b64_tr_b16 v[124:125], v197 offset:34944
ds_read_b64_tr_b16 v[126:127], v197 offset:39296
ds_read_b64_tr_b16 v[128:129], v197 offset:35008
ds_read_b64_tr_b16 v[130:131], v197 offset:39360
ds_read_b64_tr_b16 v[132:133], v197 offset:52224
ds_read_b64_tr_b16 v[134:135], v197 offset:56576
ds_read_b64_tr_b16 v[136:137], v197 offset:52288
ds_read_b64_tr_b16 v[138:139], v197 offset:56640
ds_read_b64_tr_b16 v[140:141], v197 offset:52352
ds_read_b64_tr_b16 v[142:143], v197 offset:56704
ds_read_b64_tr_b16 v[144:145], v197 offset:52416
ds_read_b64_tr_b16 v[146:147], v197 offset:56768
s_waitcnt lgkmcnt(15)
v_mfma_f32_32x32x16_bf16 v[12:27], v[84:87], v[148:151], v[12:27]
v_mfma_f32_32x32x16_bf16 v[28:43], v[88:91], v[148:151], v[28:43]
v_mfma_f32_32x32x16_bf16 v[44:59], v[92:95], v[148:151], v[44:59]
v_mfma_f32_32x32x16_bf16 v[60:75], v[96:99], v[148:151], v[60:75]
s_waitcnt lgkmcnt(15)
v_mfma_f32_32x32x16_bf16 v[12:27], v[100:103], v[152:155], v[12:27]
v_mfma_f32_32x32x16_bf16 v[28:43], v[104:107], v[152:155], v[28:43]
v_mfma_f32_32x32x16_bf16 v[44:59], v[108:111], v[152:155], v[44:59]
v_mfma_f32_32x32x16_bf16 v[60:75], v[112:115], v[152:155], v[60:75]
s_waitcnt lgkmcnt(8)
v_mfma_f32_32x32x16_bf16 v[12:27], v[116:119], v[156:159], v[12:27]
v_mfma_f32_32x32x16_bf16 v[28:43], v[120:123], v[156:159], v[28:43]
v_mfma_f32_32x32x16_bf16 v[44:59], v[124:127], v[156:159], v[44:59]
v_mfma_f32_32x32x16_bf16 v[60:75], v[128:131], v[156:159], v[60:75]
s_waitcnt lgkmcnt(0)
v_mfma_f32_32x32x16_bf16 v[12:27], v[132:135], v[160:163], v[12:27]
v_mfma_f32_32x32x16_bf16 v[28:43], v[136:139], v[160:163], v[28:43]
v_mfma_f32_32x32x16_bf16 v[44:59], v[140:143], v[160:163], v[44:59]
v_mfma_f32_32x32x16_bf16 v[60:75], v[144:147], v[160:163], v[60:75]
ds_read_b128 v[84:87], v194 offset:0
ds_read_b128 v[88:91], v194 offset:64
ds_read_b128 v[92:95], v194 offset:128
ds_read_b128 v[96:99], v194 offset:192
ds_read_b128 v[100:103], v194 offset:256
ds_read_b128 v[104:107], v194 offset:320
ds_read_b128 v[108:111], v194 offset:384
ds_read_b128 v[112:115], v194 offset:448
ds_read_b128 v[116:119], v194 offset:512
ds_read_b128 v[120:123], v194 offset:576
ds_read_b128 v[124:127], v194 offset:640
ds_read_b128 v[128:131], v194 offset:704
ds_read_b128 v[132:135], v194 offset:768
ds_read_b128 v[136:139], v194 offset:832
ds_read_b128 v[140:143], v194 offset:896
ds_read_b128 v[144:147], v194 offset:960
s_waitcnt lgkmcnt(15)
v_mfma_f32_16x16x32_bf16 v[76:79], v[84:87], a[0:3], 0
v_mfma_f32_16x16x32_bf16 v[80:83], v[84:87], a[64:67], 0
s_waitcnt lgkmcnt(14)
v_mfma_f32_16x16x32_bf16 v[76:79], v[88:91], a[4:7], v[76:79]
v_mfma_f32_16x16x32_bf16 v[80:83], v[88:91], a[68:71], v[80:83]
s_waitcnt lgkmcnt(13)
v_mfma_f32_16x16x32_bf16 v[76:79], v[92:95], a[8:11], v[76:79]
v_mfma_f32_16x16x32_bf16 v[80:83], v[92:95], a[72:75], v[80:83]
s_waitcnt lgkmcnt(12)
v_mfma_f32_16x16x32_bf16 v[76:79], v[96:99], a[12:15], v[76:79]
v_mfma_f32_16x16x32_bf16 v[80:83], v[96:99], a[76:79], v[80:83]
s_waitcnt lgkmcnt(11)
v_mfma_f32_16x16x32_bf16 v[76:79], v[100:103], a[16:19], v[76:79]
v_mfma_f32_16x16x32_bf16 v[80:83], v[100:103], a[80:83], v[80:83]
s_waitcnt lgkmcnt(10)
v_mfma_f32_16x16x32_bf16 v[76:79], v[104:107], a[20:23], v[76:79]
v_mfma_f32_16x16x32_bf16 v[80:83], v[104:107], a[84:87], v[80:83]
s_waitcnt lgkmcnt(9)
v_mfma_f32_16x16x32_bf16 v[76:79], v[108:111], a[24:27], v[76:79]
v_mfma_f32_16x16x32_bf16 v[80:83], v[108:111], a[88:91], v[80:83]
s_waitcnt lgkmcnt(8)
v_mfma_f32_16x16x32_bf16 v[76:79], v[112:115], a[28:31], v[76:79]
v_mfma_f32_16x16x32_bf16 v[80:83], v[112:115], a[92:95], v[80:83]
s_waitcnt lgkmcnt(7)
v_mfma_f32_16x16x32_bf16 v[76:79], v[116:119], a[32:35], v[76:79]
v_mfma_f32_16x16x32_bf16 v[80:83], v[116:119], a[96:99], v[80:83]
s_waitcnt lgkmcnt(6)
v_mfma_f32_16x16x32_bf16 v[76:79], v[120:123], a[36:39], v[76:79]
v_mfma_f32_16x16x32_bf16 v[80:83], v[120:123], a[100:103], v[80:83]
s_waitcnt lgkmcnt(5)
v_mfma_f32_16x16x32_bf16 v[76:79], v[124:127], a[40:43], v[76:79]
v_mfma_f32_16x16x32_bf16 v[80:83], v[124:127], a[104:107], v[80:83]
s_waitcnt lgkmcnt(4)
v_mfma_f32_16x16x32_bf16 v[76:79], v[128:131], a[44:47], v[76:79]
v_mfma_f32_16x16x32_bf16 v[80:83], v[128:131], a[108:111], v[80:83]
s_waitcnt lgkmcnt(3)
v_mfma_f32_16x16x32_bf16 v[76:79], v[132:135], a[48:51], v[76:79]
v_mfma_f32_16x16x32_bf16 v[80:83], v[132:135], a[112:115], v[80:83]
s_waitcnt lgkmcnt(2)
v_mfma_f32_16x16x32_bf16 v[76:79], v[136:139], a[52:55], v[76:79]
v_mfma_f32_16x16x32_bf16 v[80:83], v[136:139], a[116:119], v[80:83]
s_waitcnt lgkmcnt(1)
v_mfma_f32_16x16x32_bf16 v[76:79], v[140:143], a[56:59], v[76:79]
v_mfma_f32_16x16x32_bf16 v[80:83], v[140:143], a[120:123], v[80:83]
s_waitcnt lgkmcnt(0)
v_mfma_f32_16x16x32_bf16 v[76:79], v[144:147], a[60:63], v[76:79]
v_mfma_f32_16x16x32_bf16 v[80:83], v[144:147], a[124:127], v[80:83]
s_nop 6
v_max_f32 v190, v76, v77
v_max3_f32 v190, v190, v78, v79
v_mov_b32 v192, v190
s_nop 1
v_permlane16_swap_b32 v190, v192
v_max_f32 v190, v190, v192
v_mov_b32 v192, v190
s_nop 1
v_permlane32_swap_b32 v190, v192
v_max_f32 v190, v190, v192
ds_write_b32 v198, v190 offset:0
v_max_f32 v191, v80, v81
v_max3_f32 v191, v191, v82, v83
v_mov_b32 v192, v191
s_nop 1
v_permlane16_swap_b32 v191, v192
v_max_f32 v191, v191, v192
v_mov_b32 v192, v191
s_nop 1
v_permlane32_swap_b32 v191, v192
v_max_f32 v191, v191, v192
ds_write_b32 v198, v191 offset:256
s_waitcnt lgkmcnt(0)
s_barrier
ds_read_b128 v[164:167], v199
ds_read_b128 v[168:171], v199 offset:256
ds_read_b128 v[172:175], v200
s_waitcnt vmcnt(0)
ds_write_b128 v207, a[192:195] offset:0
ds_write_b128 v207, a[196:199] offset:1088
ds_write_b128 v207, a[200:203] offset:2176
ds_write_b128 v207, a[204:207] offset:3264
ds_write_b128 v207, a[208:211] offset:4352
ds_write_b128 v207, a[212:215] offset:5440
ds_write_b128 v207, a[216:219] offset:6528
ds_write_b128 v207, a[220:223] offset:7616
ds_write_b128 v207, a[224:227] offset:8704
ds_write_b128 v207, a[228:231] offset:9792
ds_write_b128 v207, a[232:235] offset:10880
ds_write_b128 v207, a[236:239] offset:11968
ds_write_b128 v207, a[240:243] offset:13056
ds_write_b128 v207, a[244:247] offset:14144
ds_write_b128 v207, a[248:251] offset:15232
ds_write_b128 v207, a[252:255] offset:16320
s_waitcnt lgkmcnt(15)
v_max_f32 v164, v164, v165
v_max3_f32 v164, v164, v166, v167
v_mul_f32 v164, v164, v185
v_max_f32 v164, v164, v176
v_sub_f32 v182, v176, v164
v_exp_f32 v182, v182
v_mov_b32 v176, v164
v_max_f32 v168, v168, v169
v_max3_f32 v168, v168, v170, v171
v_mul_f32 v168, v168, v185
v_max_f32 v168, v168, v177
v_sub_f32 v183, v177, v168
v_exp_f32 v183, v183
v_mov_b32 v177, v168
v_max_f32 v172, v172, v173
v_max3_f32 v172, v172, v174, v175
v_mul_f32 v172, v172, v185
v_max_f32 v172, v172, v178
v_sub_f32 v184, v178, v172
v_exp_f32 v184, v184
v_mov_b32 v178, v172
v_fma_f32 v76, v76, v185, -v176
v_fma_f32 v77, v77, v185, -v176
v_fma_f32 v78, v78, v185, -v176
v_fma_f32 v79, v79, v185, -v176
v_exp_f32 v76, v76
v_exp_f32 v77, v77
v_exp_f32 v78, v78
v_exp_f32 v79, v79
v_mul_f32 v180, v180, v182
v_cvt_pk_bf16_f32 v186, v76, v77
v_cvt_pk_bf16_f32 v187, v78, v79
ds_write_b64 v201, v[186:187] offset:0
v_add_f32 v180, v180, v76
v_add_f32 v180, v180, v77
v_add_f32 v180, v180, v78
v_add_f32 v180, v180, v79
v_fma_f32 v80, v80, v185, -v177
v_fma_f32 v81, v81, v185, -v177
v_fma_f32 v82, v82, v185, -v177
v_fma_f32 v83, v83, v185, -v177
v_exp_f32 v80, v80
v_exp_f32 v81, v81
v_exp_f32 v82, v82
v_exp_f32 v83, v83
v_mul_f32 v181, v181, v183
v_cvt_pk_bf16_f32 v188, v80, v81
v_cvt_pk_bf16_f32 v189, v82, v83
ds_write_b64 v201, v[188:189] offset:512
v_add_f32 v181, v181, v80
v_add_f32 v181, v181, v81
v_add_f32 v181, v181, v82
v_add_f32 v181, v181, v83
v_mul_f32 v12, v12, v184
v_mul_f32 v13, v13, v184
v_mul_f32 v14, v14, v184
v_mul_f32 v15, v15, v184
v_mul_f32 v16, v16, v184
v_mul_f32 v17, v17, v184
v_mul_f32 v18, v18, v184
v_mul_f32 v19, v19, v184
v_mul_f32 v20, v20, v184
v_mul_f32 v21, v21, v184
v_mul_f32 v22, v22, v184
v_mul_f32 v23, v23, v184
v_mul_f32 v24, v24, v184
v_mul_f32 v25, v25, v184
v_mul_f32 v26, v26, v184
v_mul_f32 v27, v27, v184
v_mul_f32 v28, v28, v184
v_mul_f32 v29, v29, v184
v_mul_f32 v30, v30, v184
v_mul_f32 v31, v31, v184
v_mul_f32 v32, v32, v184
v_mul_f32 v33, v33, v184
v_mul_f32 v34, v34, v184
v_mul_f32 v35, v35, v184
v_mul_f32 v36, v36, v184
v_mul_f32 v37, v37, v184
v_mul_f32 v38, v38, v184
v_mul_f32 v39, v39, v184
v_mul_f32 v40, v40, v184
v_mul_f32 v41, v41, v184
v_mul_f32 v42, v42, v184
v_mul_f32 v43, v43, v184
v_mul_f32 v44, v44, v184
v_mul_f32 v45, v45, v184
v_mul_f32 v46, v46, v184
v_mul_f32 v47, v47, v184
v_mul_f32 v48, v48, v184
v_mul_f32 v49, v49, v184
v_mul_f32 v50, v50, v184
v_mul_f32 v51, v51, v184
v_mul_f32 v52, v52, v184
v_mul_f32 v53, v53, v184
v_mul_f32 v54, v54, v184
v_mul_f32 v55, v55, v184
v_mul_f32 v56, v56, v184
v_mul_f32 v57, v57, v184
v_mul_f32 v58, v58, v184
v_mul_f32 v59, v59, v184
v_mul_f32 v60, v60, v184
v_mul_f32 v61, v61, v184
v_mul_f32 v62, v62, v184
v_mul_f32 v63, v63, v184
v_mul_f32 v64, v64, v184
v_mul_f32 v65, v65, v184
v_mul_f32 v66, v66, v184
v_mul_f32 v67, v67, v184
v_mul_f32 v68, v68, v184
v_mul_f32 v69, v69, v184
v_mul_f32 v70, v70, v184
v_mul_f32 v71, v71, v184
v_mul_f32 v72, v72, v184
v_mul_f32 v73, v73, v184
v_mul_f32 v74, v74, v184
v_mul_f32 v75, v75, v184
s_waitcnt lgkmcnt(0)
s_barrier
ds_read_b128 v[148:151], v202 offset:0
ds_read_b128 v[152:155], v202 offset:1024
ds_read_b128 v[156:159], v202 offset:2048
ds_read_b128 v[160:163], v202 offset:3072
ds_read_b64_tr_b16 v[84:85], v196 offset:0
ds_read_b64_tr_b16 v[86:87], v196 offset:4352
ds_read_b64_tr_b16 v[88:89], v196 offset:64
ds_read_b64_tr_b16 v[90:91], v196 offset:4416
ds_read_b64_tr_b16 v[92:93], v196 offset:128
ds_read_b64_tr_b16 v[94:95], v196 offset:4480
ds_read_b64_tr_b16 v[96:97], v196 offset:192
ds_read_b64_tr_b16 v[98:99], v196 offset:4544
ds_read_b64_tr_b16 v[100:101], v196 offset:17408
ds_read_b64_tr_b16 v[102:103], v196 offset:21760
ds_read_b64_tr_b16 v[104:105], v196 offset:17472
ds_read_b64_tr_b16 v[106:107], v196 offset:21824
ds_read_b64_tr_b16 v[108:109], v196 offset:17536
ds_read_b64_tr_b16 v[110:111], v196 offset:21888
ds_read_b64_tr_b16 v[112:113], v196 offset:17600
ds_read_b64_tr_b16 v[114:115], v196 offset:21952
ds_read_b64_tr_b16 v[116:117], v196 offset:34816
ds_read_b64_tr_b16 v[118:119], v196 offset:39168
ds_read_b64_tr_b16 v[120:121], v196 offset:34880
ds_read_b64_tr_b16 v[122:123], v196 offset:39232
ds_read_b64_tr_b16 v[124:125], v196 offset:34944
ds_read_b64_tr_b16 v[126:127], v196 offset:39296
ds_read_b64_tr_b16 v[128:129], v196 offset:35008
ds_read_b64_tr_b16 v[130:131], v196 offset:39360
ds_read_b64_tr_b16 v[132:133], v196 offset:52224
ds_read_b64_tr_b16 v[134:135], v196 offset:56576
ds_read_b64_tr_b16 v[136:137], v196 offset:52288
ds_read_b64_tr_b16 v[138:139], v196 offset:56640
ds_read_b64_tr_b16 v[140:141], v196 offset:52352
ds_read_b64_tr_b16 v[142:143], v196 offset:56704
ds_read_b64_tr_b16 v[144:145], v196 offset:52416
ds_read_b64_tr_b16 v[146:147], v196 offset:56768
s_waitcnt lgkmcnt(15)
v_mfma_f32_32x32x16_bf16 v[12:27], v[84:87], v[148:151], v[12:27]
v_mfma_f32_32x32x16_bf16 v[28:43], v[88:91], v[148:151], v[28:43]
v_mfma_f32_32x32x16_bf16 v[44:59], v[92:95], v[148:151], v[44:59]
v_mfma_f32_32x32x16_bf16 v[60:75], v[96:99], v[148:151], v[60:75]
s_waitcnt lgkmcnt(15)
v_mfma_f32_32x32x16_bf16 v[12:27], v[100:103], v[152:155], v[12:27]
v_mfma_f32_32x32x16_bf16 v[28:43], v[104:107], v[152:155], v[28:43]
v_mfma_f32_32x32x16_bf16 v[44:59], v[108:111], v[152:155], v[44:59]
v_mfma_f32_32x32x16_bf16 v[60:75], v[112:115], v[152:155], v[60:75]
s_waitcnt lgkmcnt(8)
v_mfma_f32_32x32x16_bf16 v[12:27], v[116:119], v[156:159], v[12:27]
v_mfma_f32_32x32x16_bf16 v[28:43], v[120:123], v[156:159], v[28:43]
v_mfma_f32_32x32x16_bf16 v[44:59], v[124:127], v[156:159], v[44:59]
v_mfma_f32_32x32x16_bf16 v[60:75], v[128:131], v[156:159], v[60:75]
s_waitcnt lgkmcnt(0)
v_mfma_f32_32x32x16_bf16 v[12:27], v[132:135], v[160:163], v[12:27]
v_mfma_f32_32x32x16_bf16 v[28:43], v[136:139], v[160:163], v[28:43]
v_mfma_f32_32x32x16_bf16 v[44:59], v[140:143], v[160:163], v[44:59]
v_mfma_f32_32x32x16_bf16 v[60:75], v[144:147], v[160:163], v[60:75]
ds_read_b128 v[84:87], v195 offset:0
ds_read_b128 v[88:91], v195 offset:64
ds_read_b128 v[92:95], v195 offset:128
ds_read_b128 v[96:99], v195 offset:192
ds_read_b128 v[100:103], v195 offset:256
ds_read_b128 v[104:107], v195 offset:320
ds_read_b128 v[108:111], v195 offset:384
ds_read_b128 v[112:115], v195 offset:448
ds_read_b128 v[116:119], v195 offset:512
ds_read_b128 v[120:123], v195 offset:576
ds_read_b128 v[124:127], v195 offset:640
ds_read_b128 v[128:131], v195 offset:704
ds_read_b128 v[132:135], v195 offset:768
ds_read_b128 v[136:139], v195 offset:832
ds_read_b128 v[140:143], v195 offset:896
ds_read_b128 v[144:147], v195 offset:960
s_waitcnt lgkmcnt(15)
v_mfma_f32_16x16x32_bf16 v[76:79], v[84:87], a[0:3], 0
v_mfma_f32_16x16x32_bf16 v[80:83], v[84:87], a[64:67], 0
s_waitcnt lgkmcnt(14)
v_mfma_f32_16x16x32_bf16 v[76:79], v[88:91], a[4:7], v[76:79]
v_mfma_f32_16x16x32_bf16 v[80:83], v[88:91], a[68:71], v[80:83]
s_waitcnt lgkmcnt(13)
v_mfma_f32_16x16x32_bf16 v[76:79], v[92:95], a[8:11], v[76:79]
v_mfma_f32_16x16x32_bf16 v[80:83], v[92:95], a[72:75], v[80:83]
s_waitcnt lgkmcnt(12)
v_mfma_f32_16x16x32_bf16 v[76:79], v[96:99], a[12:15], v[76:79]
v_mfma_f32_16x16x32_bf16 v[80:83], v[96:99], a[76:79], v[80:83]
s_waitcnt lgkmcnt(11)
v_mfma_f32_16x16x32_bf16 v[76:79], v[100:103], a[16:19], v[76:79]
v_mfma_f32_16x16x32_bf16 v[80:83], v[100:103], a[80:83], v[80:83]
s_waitcnt lgkmcnt(10)
v_mfma_f32_16x16x32_bf16 v[76:79], v[104:107], a[20:23], v[76:79]
v_mfma_f32_16x16x32_bf16 v[80:83], v[104:107], a[84:87], v[80:83]
s_waitcnt lgkmcnt(9)
v_mfma_f32_16x16x32_bf16 v[76:79], v[108:111], a[24:27], v[76:79]
v_mfma_f32_16x16x32_bf16 v[80:83], v[108:111], a[88:91], v[80:83]
s_waitcnt lgkmcnt(8)
v_mfma_f32_16x16x32_bf16 v[76:79], v[112:115], a[28:31], v[76:79]
v_mfma_f32_16x16x32_bf16 v[80:83], v[112:115], a[92:95], v[80:83]
s_waitcnt lgkmcnt(7)
v_mfma_f32_16x16x32_bf16 v[76:79], v[116:119], a[32:35], v[76:79]
v_mfma_f32_16x16x32_bf16 v[80:83], v[116:119], a[96:99], v[80:83]
s_waitcnt lgkmcnt(6)
v_mfma_f32_16x16x32_bf16 v[76:79], v[120:123], a[36:39], v[76:79]
v_mfma_f32_16x16x32_bf16 v[80:83], v[120:123], a[100:103], v[80:83]
s_waitcnt lgkmcnt(5)
v_mfma_f32_16x16x32_bf16 v[76:79], v[124:127], a[40:43], v[76:79]
v_mfma_f32_16x16x32_bf16 v[80:83], v[124:127], a[104:107], v[80:83]
s_waitcnt lgkmcnt(4)
v_mfma_f32_16x16x32_bf16 v[76:79], v[128:131], a[44:47], v[76:79]
v_mfma_f32_16x16x32_bf16 v[80:83], v[128:131], a[108:111], v[80:83]
s_waitcnt lgkmcnt(3)
v_mfma_f32_16x16x32_bf16 v[76:79], v[132:135], a[48:51], v[76:79]
v_mfma_f32_16x16x32_bf16 v[80:83], v[132:135], a[112:115], v[80:83]
s_waitcnt lgkmcnt(2)
v_mfma_f32_16x16x32_bf16 v[76:79], v[136:139], a[52:55], v[76:79]
v_mfma_f32_16x16x32_bf16 v[80:83], v[136:139], a[116:119], v[80:83]
s_waitcnt lgkmcnt(1)
v_mfma_f32_16x16x32_bf16 v[76:79], v[140:143], a[56:59], v[76:79]
v_mfma_f32_16x16x32_bf16 v[80:83], v[140:143], a[120:123], v[80:83]
s_waitcnt lgkmcnt(0)
v_mfma_f32_16x16x32_bf16 v[76:79], v[144:147], a[60:63], v[76:79]
v_mfma_f32_16x16x32_bf16 v[80:83], v[144:147], a[124:127], v[80:83]
s_nop 6
v_max_f32 v190, v76, v77
v_max3_f32 v190, v190, v78, v79
v_mov_b32 v192, v190
s_nop 1
v_permlane16_swap_b32 v190, v192
v_max_f32 v190, v190, v192
v_mov_b32 v192, v190
s_nop 1
v_permlane32_swap_b32 v190, v192
v_max_f32 v190, v190, v192
ds_write_b32 v198, v190 offset:0
v_max_f32 v191, v80, v81
v_max3_f32 v191, v191, v82, v83
v_mov_b32 v192, v191
s_nop 1
v_permlane16_swap_b32 v191, v192
v_max_f32 v191, v191, v192
v_mov_b32 v192, v191
s_nop 1
v_permlane32_swap_b32 v191, v192
v_max_f32 v191, v191, v192
ds_write_b32 v198, v191 offset:256
s_waitcnt lgkmcnt(0)
s_barrier
ds_read_b128 v[164:167], v199
ds_read_b128 v[168:171], v199 offset:256
ds_read_b128 v[172:175], v200
s_waitcnt lgkmcnt(0)
v_max_f32 v164, v164, v165
v_max3_f32 v164, v164, v166, v167
v_mul_f32 v164, v164, v185
v_max_f32 v164, v164, v176
v_sub_f32 v182, v176, v164
v_exp_f32 v182, v182
v_mov_b32 v176, v164
v_max_f32 v168, v168, v169
v_max3_f32 v168, v168, v170, v171
v_mul_f32 v168, v168, v185
v_max_f32 v168, v168, v177
v_sub_f32 v183, v177, v168
v_exp_f32 v183, v183
v_mov_b32 v177, v168
v_max_f32 v172, v172, v173
v_max3_f32 v172, v172, v174, v175
v_mul_f32 v172, v172, v185
v_max_f32 v172, v172, v178
v_sub_f32 v184, v178, v172
v_exp_f32 v184, v184
v_mov_b32 v178, v172
v_fma_f32 v76, v76, v185, -v176
v_fma_f32 v77, v77, v185, -v176
v_fma_f32 v78, v78, v185, -v176
v_fma_f32 v79, v79, v185, -v176
v_exp_f32 v76, v76
v_exp_f32 v77, v77
v_exp_f32 v78, v78
v_exp_f32 v79, v79
v_mul_f32 v180, v180, v182
v_cvt_pk_bf16_f32 v186, v76, v77
v_cvt_pk_bf16_f32 v187, v78, v79
ds_write_b64 v201, v[186:187] offset:0
v_add_f32 v180, v180, v76
v_add_f32 v180, v180, v77
v_add_f32 v180, v180, v78
v_add_f32 v180, v180, v79
v_fma_f32 v80, v80, v185, -v177
v_fma_f32 v81, v81, v185, -v177
v_fma_f32 v82, v82, v185, -v177
v_fma_f32 v83, v83, v185, -v177
v_exp_f32 v80, v80
v_exp_f32 v81, v81
v_exp_f32 v82, v82
v_exp_f32 v83, v83
v_mul_f32 v181, v181, v183
v_cvt_pk_bf16_f32 v188, v80, v81
v_cvt_pk_bf16_f32 v189, v82, v83
ds_write_b64 v201, v[188:189] offset:512
v_add_f32 v181, v181, v80
v_add_f32 v181, v181, v81
v_add_f32 v181, v181, v82
v_add_f32 v181, v181, v83
v_mul_f32 v12, v12, v184
v_mul_f32 v13, v13, v184
v_mul_f32 v14, v14, v184
v_mul_f32 v15, v15, v184
v_mul_f32 v16, v16, v184
v_mul_f32 v17, v17, v184
v_mul_f32 v18, v18, v184
v_mul_f32 v19, v19, v184
v_mul_f32 v20, v20, v184
v_mul_f32 v21, v21, v184
v_mul_f32 v22, v22, v184
v_mul_f32 v23, v23, v184
v_mul_f32 v24, v24, v184
v_mul_f32 v25, v25, v184
v_mul_f32 v26, v26, v184
v_mul_f32 v27, v27, v184
v_mul_f32 v28, v28, v184
v_mul_f32 v29, v29, v184
v_mul_f32 v30, v30, v184
v_mul_f32 v31, v31, v184
v_mul_f32 v32, v32, v184
v_mul_f32 v33, v33, v184
v_mul_f32 v34, v34, v184
v_mul_f32 v35, v35, v184
v_mul_f32 v36, v36, v184
v_mul_f32 v37, v37, v184
v_mul_f32 v38, v38, v184
v_mul_f32 v39, v39, v184
v_mul_f32 v40, v40, v184
v_mul_f32 v41, v41, v184
v_mul_f32 v42, v42, v184
v_mul_f32 v43, v43, v184
v_mul_f32 v44, v44, v184
v_mul_f32 v45, v45, v184
v_mul_f32 v46, v46, v184
v_mul_f32 v47, v47, v184
v_mul_f32 v48, v48, v184
v_mul_f32 v49, v49, v184
v_mul_f32 v50, v50, v184
v_mul_f32 v51, v51, v184
v_mul_f32 v52, v52, v184
v_mul_f32 v53, v53, v184
v_mul_f32 v54, v54, v184
v_mul_f32 v55, v55, v184
v_mul_f32 v56, v56, v184
v_mul_f32 v57, v57, v184
v_mul_f32 v58, v58, v184
v_mul_f32 v59, v59, v184
v_mul_f32 v60, v60, v184
v_mul_f32 v61, v61, v184
v_mul_f32 v62, v62, v184
v_mul_f32 v63, v63, v184
v_mul_f32 v64, v64, v184
v_mul_f32 v65, v65, v184
v_mul_f32 v66, v66, v184
v_mul_f32 v67, v67, v184
v_mul_f32 v68, v68, v184
v_mul_f32 v69, v69, v184
v_mul_f32 v70, v70, v184
v_mul_f32 v71, v71, v184
v_mul_f32 v72, v72, v184
v_mul_f32 v73, v73, v184
v_mul_f32 v74, v74, v184
v_mul_f32 v75, v75, v184
s_waitcnt lgkmcnt(0)
s_barrier
ds_read_b128 v[148:151], v202 offset:0
ds_read_b128 v[152:155], v202 offset:1024
ds_read_b128 v[156:159], v202 offset:2048
ds_read_b128 v[160:163], v202 offset:3072
ds_read_b64_tr_b16 v[84:85], v197 offset:0
ds_read_b64_tr_b16 v[86:87], v197 offset:4352
ds_read_b64_tr_b16 v[88:89], v197 offset:64
ds_read_b64_tr_b16 v[90:91], v197 offset:4416
ds_read_b64_tr_b16 v[92:93], v197 offset:128
ds_read_b64_tr_b16 v[94:95], v197 offset:4480
ds_read_b64_tr_b16 v[96:97], v197 offset:192
ds_read_b64_tr_b16 v[98:99], v197 offset:4544
ds_read_b64_tr_b16 v[100:101], v197 offset:17408
ds_read_b64_tr_b16 v[102:103], v197 offset:21760
ds_read_b64_tr_b16 v[104:105], v197 offset:17472
ds_read_b64_tr_b16 v[106:107], v197 offset:21824
ds_read_b64_tr_b16 v[108:109], v197 offset:17536
ds_read_b64_tr_b16 v[110:111], v197 offset:21888
ds_read_b64_tr_b16 v[112:113], v197 offset:17600
ds_read_b64_tr_b16 v[114:115], v197 offset:21952
ds_read_b64_tr_b16 v[116:117], v197 offset:34816
ds_read_b64_tr_b16 v[118:119], v197 offset:39168
ds_read_b64_tr_b16 v[120:121], v197 offset:34880
ds_read_b64_tr_b16 v[122:123], v197 offset:39232
ds_read_b64_tr_b16 v[124:125], v197 offset:34944
ds_read_b64_tr_b16 v[126:127], v197 offset:39296
ds_read_b64_tr_b16 v[128:129], v197 offset:35008
ds_read_b64_tr_b16 v[130:131], v197 offset:39360
ds_read_b64_tr_b16 v[132:133], v197 offset:52224
ds_read_b64_tr_b16 v[134:135], v197 offset:56576
ds_read_b64_tr_b16 v[136:137], v197 offset:52288
ds_read_b64_tr_b16 v[138:139], v197 offset:56640
ds_read_b64_tr_b16 v[140:141], v197 offset:52352
ds_read_b64_tr_b16 v[142:143], v197 offset:56704
ds_read_b64_tr_b16 v[144:145], v197 offset:52416
ds_read_b64_tr_b16 v[146:147], v197 offset:56768
s_waitcnt lgkmcnt(15)
v_mfma_f32_32x32x16_bf16 v[12:27], v[84:87], v[148:151], v[12:27]
v_mfma_f32_32x32x16_bf16 v[28:43], v[88:91], v[148:151], v[28:43]
v_mfma_f32_32x32x16_bf16 v[44:59], v[92:95], v[148:151], v[44:59]
v_mfma_f32_32x32x16_bf16 v[60:75], v[96:99], v[148:151], v[60:75]
s_waitcnt lgkmcnt(15)
v_mfma_f32_32x32x16_bf16 v[12:27], v[100:103], v[152:155], v[12:27]
v_mfma_f32_32x32x16_bf16 v[28:43], v[104:107], v[152:155], v[28:43]
v_mfma_f32_32x32x16_bf16 v[44:59], v[108:111], v[152:155], v[44:59]
v_mfma_f32_32x32x16_bf16 v[60:75], v[112:115], v[152:155], v[60:75]
s_waitcnt lgkmcnt(8)
v_mfma_f32_32x32x16_bf16 v[12:27], v[116:119], v[156:159], v[12:27]
v_mfma_f32_32x32x16_bf16 v[28:43], v[120:123], v[156:159], v[28:43]
v_mfma_f32_32x32x16_bf16 v[44:59], v[124:127], v[156:159], v[44:59]
v_mfma_f32_32x32x16_bf16 v[60:75], v[128:131], v[156:159], v[60:75]
s_waitcnt lgkmcnt(0)
v_mfma_f32_32x32x16_bf16 v[12:27], v[132:135], v[160:163], v[12:27]
v_mfma_f32_32x32x16_bf16 v[28:43], v[136:139], v[160:163], v[28:43]
v_mfma_f32_32x32x16_bf16 v[44:59], v[140:143], v[160:163], v[44:59]
v_mfma_f32_32x32x16_bf16 v[60:75], v[144:147], v[160:163], v[60:75]
v_mov_b32 v192, v180
s_nop 1
v_permlane16_swap_b32 v180, v192
v_add_f32 v180, v180, v192
v_mov_b32 v192, v180
s_nop 1
v_permlane32_swap_b32 v180, v192
v_add_f32 v180, v180, v192
ds_write_b32 v198, v180 offset:512
v_mov_b32 v192, v181
s_nop 1
v_permlane16_swap_b32 v181, v192
v_add_f32 v181, v181, v192
v_mov_b32 v192, v181
s_nop 1
v_permlane32_swap_b32 v181, v192
v_add_f32 v181, v181, v192
ds_write_b32 v198, v181 offset:768
v_and_b32 v5, 31, v1
v_mul_u32_u24 v5, 1040, v5
v_lshrrev_b32 v6, 5, v1
v_lshl_add_u32 v5, v6, 3, v5
s_lshl_b32 s6, s3, 8
v_add_u32 v5, s6, v5
v_cvt_pk_bf16_f32 v84, v12, v13
v_cvt_pk_bf16_f32 v85, v14, v15
ds_write_b64 v5, v[84:85] offset:0
v_cvt_pk_bf16_f32 v86, v16, v17
v_cvt_pk_bf16_f32 v87, v18, v19
ds_write_b64 v5, v[86:87] offset:16
v_cvt_pk_bf16_f32 v88, v20, v21
v_cvt_pk_bf16_f32 v89, v22, v23
ds_write_b64 v5, v[88:89] offset:32
v_cvt_pk_bf16_f32 v90, v24, v25
v_cvt_pk_bf16_f32 v91, v26, v27
ds_write_b64 v5, v[90:91] offset:48
v_cvt_pk_bf16_f32 v92, v28, v29
v_cvt_pk_bf16_f32 v93, v30, v31
ds_write_b64 v5, v[92:93] offset:64
v_cvt_pk_bf16_f32 v94, v32, v33
v_cvt_pk_bf16_f32 v95, v34, v35
ds_write_b64 v5, v[94:95] offset:80
v_cvt_pk_bf16_f32 v96, v36, v37
v_cvt_pk_bf16_f32 v97, v38, v39
ds_write_b64 v5, v[96:97] offset:96
v_cvt_pk_bf16_f32 v98, v40, v41
v_cvt_pk_bf16_f32 v99, v42, v43
ds_write_b64 v5, v[98:99] offset:112
v_cvt_pk_bf16_f32 v100, v44, v45
v_cvt_pk_bf16_f32 v101, v46, v47
ds_write_b64 v5, v[100:101] offset:128
v_cvt_pk_bf16_f32 v102, v48, v49
v_cvt_pk_bf16_f32 v103, v50, v51
ds_write_b64 v5, v[102:103] offset:144
v_cvt_pk_bf16_f32 v104, v52, v53
v_cvt_pk_bf16_f32 v105, v54, v55
ds_write_b64 v5, v[104:105] offset:160
v_cvt_pk_bf16_f32 v106, v56, v57
v_cvt_pk_bf16_f32 v107, v58, v59
ds_write_b64 v5, v[106:107] offset:176
v_cvt_pk_bf16_f32 v108, v60, v61
v_cvt_pk_bf16_f32 v109, v62, v63
ds_write_b64 v5, v[108:109] offset:192
v_cvt_pk_bf16_f32 v110, v64, v65
v_cvt_pk_bf16_f32 v111, v66, v67
ds_write_b64 v5, v[110:111] offset:208
v_cvt_pk_bf16_f32 v112, v68, v69
v_cvt_pk_bf16_f32 v113, v70, v71
ds_write_b64 v5, v[112:113] offset:224
v_cvt_pk_bf16_f32 v114, v72, v73
v_cvt_pk_bf16_f32 v115, v74, v75
ds_write_b64 v5, v[114:115] offset:240
v_mov_b32 v11, 163824
v_mov_b32 v7, 0
ds_write_b32 v11, v7
s_waitcnt lgkmcnt(0)
s_barrier
s_mul_i32 s6, s3, 8320
v_add_u32 v5, s6, v2
ds_read_b128 v[116:119], v5 offset:0
ds_read_b128 v[120:123], v5 offset:1040
ds_read_b128 v[124:127], v5 offset:2080
ds_read_b128 v[128:131], v5 offset:3120
ds_read_b128 v[132:135], v5 offset:4160
ds_read_b128 v[136:139], v5 offset:5200
ds_read_b128 v[140:143], v5 offset:6240
ds_read_b128 v[144:147], v5 offset:7280
ds_read_b128 v[164:167], v200 offset:512
s_lshl_b32 s7, s3, 18
s_lshl_b32 s6, s4, 10
s_add_u32 s7, s7, s6
s_add_u32 s7, s7, 1048576
s_waitcnt lgkmcnt(8)
s_add_u32 s6, s7, 0
buffer_store_dwordx4 v[116:119], v2, s[64:67], s6 offen sc1
s_waitcnt lgkmcnt(7)
s_add_u32 s6, s7, 32768
buffer_store_dwordx4 v[120:123], v2, s[64:67], s6 offen sc1
s_waitcnt lgkmcnt(6)
s_add_u32 s6, s7, 65536
buffer_store_dwordx4 v[124:127], v2, s[64:67], s6 offen sc1
s_waitcnt lgkmcnt(5)
s_add_u32 s6, s7, 98304
buffer_store_dwordx4 v[128:131], v2, s[64:67], s6 offen sc1
s_waitcnt lgkmcnt(4)
s_add_u32 s6, s7, 131072
buffer_store_dwordx4 v[132:135], v2, s[64:67], s6 offen sc1
s_waitcnt lgkmcnt(3)
s_add_u32 s6, s7, 163840
buffer_store_dwordx4 v[136:139], v2, s[64:67], s6 offen sc1
s_waitcnt lgkmcnt(2)
s_add_u32 s6, s7, 196608
buffer_store_dwordx4 v[140:143], v2, s[64:67], s6 offen sc1
s_waitcnt lgkmcnt(1)
s_add_u32 s6, s7, 229376
buffer_store_dwordx4 v[144:147], v2, s[64:67], s6 offen sc1
s_waitcnt lgkmcnt(0)
v_add_f32 v164, v164, v165
v_add_f32 v166, v166, v167
v_add_f32 v187, v164, v166
v_mov_b32 v186, v178
v_lshlrev_b32 v5, 8, v1
s_lshl_b32 s6, s4, 3
s_add_u32 s6, s6, 262144
v_min_u32 v186, -2, v186
v_min_u32 v187, -2, v187
s_waitcnt vmcnt(0)
s_barrier
s_cmp_lg_u32 s3, 0
s_cbranch_scc1 L_nops_21
s_mov_b64 exec, 0xffffffff
buffer_store_dwordx2 v[186:187], v5, s[64:67], s6 offen sc1
s_mov_b64 exec, -1
L_nops_21:
B_final:
s_cmp_eq_u32 s3, 3
s_cbranch_scc1 H_start
s_mov_b32 s14, s9
s_lshr_b32 s7, s3, 1
s_cmp_lg_u32 s3, 1
s_cbranch_scc1 L_w1_22
s_and_b32 s7, s9, 7
s_cmp_ge_u32 s7, 2
s_cbranch_scc1 B_end
s_lshr_b32 s14, s9, 3
s_add_u32 s14, s14, 64
L_w1_22:
s_mul_i32 s15, s14, 57
s_lshr_b32 s15, s15, 10
s_mul_i32 s6, s15, 18
s_sub_u32 s80, s14, s6
s_mul_i32 s81, s15, 147456
s_lshr_b32 s81, s81, s7
s_lshl_b32 s6, s80, 7
s_add_u32 s81, s81, s6
s_mul_i32 s6, s7, 1048576
s_add_u32 s81, s81, s6
s_add_u32 s81, s81, 4194304
s_mul_i32 s83, s15, 2304
s_lshl_b32 s6, s80, 6
s_add_u32 s83, s83, s6
s_mul_i32 s6, s7, 1152
s_add_u32 s83, s83, s6
v_lshrrev_b32 v5, 3, v1
v_and_b32 v6, 7, v1
v_mul_u32_u24 v44, 2304, v5
v_lshl_add_u32 v44, v6, 4, v44
v_bfe_u32 v5, v1, 2, 1
v_lshl_add_u32 v5, v5, 2, v9
v_and_b32 v6, 3, v1
v_lshl_add_u32 v5, v5, 2, v6
v_lshlrev_b32 v45, 1, v5
s_mul_i32 s82, s7, 0xf0
v_mov_b32 v28, 0
v_mov_b32 v29, 0
v_mov_b32 v30, 0
v_mov_b32 v31, 0
v_mov_b32 v32, 0
v_mov_b32 v33, 0
v_mov_b32 v34, 0
v_mov_b32 v35, 0
v_mov_b32 v36, 0
v_mov_b32 v37, 0
v_mov_b32 v38, 0
v_mov_b32 v39, 0
v_mov_b32 v40, 0
v_mov_b32 v41, 0
v_mov_b32 v42, 0
v_mov_b32 v43, 0
s_mov_b32 s7, 400000
v_lshrrev_b32 v5, 3, v1
v_mul_u32_u24 v5, 9216, v5
R_slow:
buffer_load_dword v46, v5, s[64:67], s81 offen sc1
s_waitcnt vmcnt(0)
v_cmp_ne_u32 vcc, -1, v46
s_cbranch_vccnz R_pass
s_sleep 8
s_sub_u32 s7, s7, 1
s_cmp_lg_u32 s7, 1
s_cbranch_scc1 R_slow
R_pass:
s_bitcmp1_b32 s82, 0
s_cbranch_scc1 L_ld_23
s_add_u32 s6, s81, 0
buffer_load_dwordx4 v[12:15], v44, s[64:67], s6 offen sc1
L_ld_23:
s_bitcmp1_b32 s82, 1
s_cbranch_scc1 L_ld_24
s_add_u32 s6, s81, 18432
buffer_load_dwordx4 v[16:19], v44, s[64:67], s6 offen sc1
L_ld_24:
s_bitcmp1_b32 s82, 2
s_cbranch_scc1 L_ld_25
s_add_u32 s6, s81, 36864
buffer_load_dwordx4 v[20:23], v44, s[64:67], s6 offen sc1
L_ld_25:
s_bitcmp1_b32 s82, 3
s_cbranch_scc1 L_ld_26
s_add_u32 s6, s81, 55296
buffer_load_dwordx4 v[24:27], v44, s[64:67], s6 offen sc1
L_ld_26:
s_bitcmp1_b32 s82, 4
s_cbranch_scc1 L_ld_27
s_add_u32 s6, s81, 73728
buffer_load_dwordx4 v[28:31], v44, s[64:67], s6 offen sc1
L_ld_27:
s_bitcmp1_b32 s82, 5
s_cbranch_scc1 L_ld_28
s_add_u32 s6, s81, 92160
buffer_load_dwordx4 v[32:35], v44, s[64:67], s6 offen sc1
L_ld_28:
s_bitcmp1_b32 s82, 6
s_cbranch_scc1 L_ld_29
s_add_u32 s6, s81, 110592
buffer_load_dwordx4 v[36:39], v44, s[64:67], s6 offen sc1
L_ld_29:
s_bitcmp1_b32 s82, 7
s_cbranch_scc1 L_ld_30
s_add_u32 s6, s81, 129024
buffer_load_dwordx4 v[40:43], v44, s[64:67], s6 offen sc1
L_ld_30:
s_waitcnt vmcnt(0)
s_bitcmp1_b32 s82, 0
s_cbranch_scc1 L_ck_31
v_max3_u32 v46, v12, v13, v14
v_max_u32 v46, v46, v15
v_cmp_eq_u32 vcc, -1, v46
s_cbranch_vccnz L_ck_31
s_bitset1_b32 s82, 0
L_ck_31:
s_bitcmp1_b32 s82, 1
s_cbranch_scc1 L_ck_32
v_max3_u32 v46, v16, v17, v18
v_max_u32 v46, v46, v19
v_cmp_eq_u32 vcc, -1, v46
s_cbranch_vccnz L_ck_32
s_bitset1_b32 s82, 1
L_ck_32:
s_bitcmp1_b32 s82, 2
s_cbranch_scc1 L_ck_33
v_max3_u32 v46, v20, v21, v22
v_max_u32 v46, v46, v23
v_cmp_eq_u32 vcc, -1, v46
s_cbranch_vccnz L_ck_33
s_bitset1_b32 s82, 2
L_ck_33:
s_bitcmp1_b32 s82, 3
s_cbranch_scc1 L_ck_34
v_max3_u32 v46, v24, v25, v26
v_max_u32 v46, v46, v27
v_cmp_eq_u32 vcc, -1, v46
s_cbranch_vccnz L_ck_34
s_bitset1_b32 s82, 3
L_ck_34:
s_bitcmp1_b32 s82, 4
s_cbranch_scc1 L_ck_35
v_max3_u32 v46, v28, v29, v30
v_max_u32 v46, v46, v31
v_cmp_eq_u32 vcc, -1, v46
s_cbranch_vccnz L_ck_35
s_bitset1_b32 s82, 4
L_ck_35:
s_bitcmp1_b32 s82, 5
s_cbranch_scc1 L_ck_36
v_max3_u32 v46, v32, v33, v34
v_max_u32 v46, v46, v35
v_cmp_eq_u32 vcc, -1, v46
s_cbranch_vccnz L_ck_36
s_bitset1_b32 s82, 5
L_ck_36:
s_bitcmp1_b32 s82, 6
s_cbranch_scc1 L_ck_37
v_max3_u32 v46, v36, v37, v38
v_max_u32 v46, v46, v39
v_cmp_eq_u32 vcc, -1, v46
s_cbranch_vccnz L_ck_37
s_bitset1_b32 s82, 6
L_ck_37:
s_bitcmp1_b32 s82, 7
s_cbranch_scc1 L_ck_38
v_max3_u32 v46, v40, v41, v42
v_max_u32 v46, v46, v43
v_cmp_eq_u32 vcc, -1, v46
s_cbranch_vccnz L_ck_38
s_bitset1_b32 s82, 7
L_ck_38:
s_cmp_eq_u32 s82, 255
s_cbranch_scc1 R_done
s_sub_u32 s7, s7, 1
s_cmp_lg_u32 s7, 0
s_cbranch_scc1 R_pass
R_done:
v_pk_add_f32 v[12:13], v[12:13], v[28:29]
v_pk_add_f32 v[14:15], v[14:15], v[30:31]
v_pk_add_f32 v[16:17], v[16:17], v[32:33]
v_pk_add_f32 v[18:19], v[18:19], v[34:35]
v_pk_add_f32 v[20:21], v[20:21], v[36:37]
v_pk_add_f32 v[22:23], v[22:23], v[38:39]
v_pk_add_f32 v[24:25], v[24:25], v[40:41]
v_pk_add_f32 v[26:27], v[26:27], v[42:43]
v_pk_add_f32 v[12:13], v[12:13], v[20:21]
v_pk_add_f32 v[14:15], v[14:15], v[22:23]
v_pk_add_f32 v[16:17], v[16:17], v[24:25]
v_pk_add_f32 v[18:19], v[18:19], v[26:27]
v_pk_add_f32 v[12:13], v[12:13], v[16:17]
v_pk_add_f32 v[14:15], v[14:15], v[18:19]
s_nop 1
v_permlane32_swap_b32 v12, v14
v_permlane32_swap_b32 v13, v15
v_add_f32 v12, v12, v14
v_add_f32 v13, v13, v15
s_nop 1
v_permlane16_swap_b32 v12, v13
v_add_f32 v12, v12, v13
s_nop 1
v_add_f32_dpp v12, v12, v12 row_ror:8 row_mask:0xf bank_mask:0xf
v_cvt_pk_bf16_f32 v12, v12, v12
s_mov_b32 exec_lo, 0x00ff00ff
s_mov_b32 exec_hi, 0x00ff00ff
buffer_store_short v12, v45, s[72:75], s83 offen
s_mov_b64 exec, -1
s_cmp_lg_u32 s3, 0
s_cbranch_scc1 B_fin
ds_write_b32 v11, v11
s_waitcnt lgkmcnt(0)
B_fin:
B_end:
s_endpgm
H_start:
s_lshl_b32 s6, s8, 6
s_add_u32 s6, s6, s4
s_lshl_b32 s6, s6, 20
s_add_u32 s56, s20, s6
s_addc_u32 s57, s21, 0
s_mov_b32 s58, 34603008
s_mov_b32 s59, 0x20000
v_lshlrev_b32 v16, 7, v1
v_and_b32 v17, 4095, v16
v_add_u32 v16, 4096, v16
v_lshrrev_b32 v21, 5, v1
v_mul_u32_u24 v21, 20480, v21
v_add_u32 v17, v17, v21
s_and_b32 s6, s9, 56
v_and_b32 v19, 7, v1
v_add_u32 v19, s6, v19
v_mul_u32_u24 v19, 16, v19
v_add_u32 v19, 393216, v19
s_mov_b32 s16, 43
s_mov_b32 s17, 43
s_mov_b32 s18, 43
s_mov_b32 s31, 400000
buffer_load_dwordx3 v[12:14], v19, s[64:67], 0 offen sc1
s_waitcnt vmcnt(0)
H_loop:
v_med3_i32 v12, v12, -1, 31
v_med3_i32 v13, v13, -1, 31
v_med3_i32 v14, v14, -1, 31
v_add3_u32 v20, v12, v13, v14
s_nop 1
v_add_u32_dpp v20, v20, v20 row_ror:4 row_mask:0xf bank_mask:0xf
s_nop 1
v_add_u32_dpp v20, v20, v20 row_ror:2 row_mask:0xf bank_mask:0xf
s_nop 1
v_add_u32_dpp v20, v20, v20 row_ror:1 row_mask:0xf bank_mask:0xf
v_lshlrev_b32 v20, 3, v20
s_nop 0
v_readfirstlane_b32 s28, v20
v_readlane_b32 s20, v12, s9
v_readlane_b32 s21, v13, s9
v_readlane_b32 s22, v14, s9
buffer_load_dwordx3 v[12:14], v19, s[64:67], 0 offen sc1
s_mul_i32 s6, s20, 192
s_sub_i32 s24, s28, s6
s_mul_i32 s6, s16, 24
s_add_i32 s24, s24, s6
s_add_i32 s6, s16, -15
s_cmp_ge_i32 s6, s20
s_cselect_b32 s24, s24, -1048576
s_mul_i32 s6, s21, 192
s_sub_i32 s25, s28, s6
s_mul_i32 s6, s17, 24
s_add_i32 s25, s25, s6
s_add_i32 s6, s17, -15
s_cmp_ge_i32 s6, s21
s_cselect_b32 s25, s25, -1048576
s_mul_i32 s6, s22, 192
s_sub_i32 s26, s28, s6
s_mul_i32 s6, s18, 24
s_add_i32 s26, s26, s6
s_add_i32 s6, s18, -15
s_cmp_ge_i32 s6, s22
s_cselect_b32 s26, s26, -1048576
s_cmp_ge_i32 s24, s25
s_cselect_b32 s29, 0, 1
s_max_i32 s30, s24, s25
s_cmp_ge_i32 s30, s26
s_cselect_b32 s29, s29, 2
s_max_i32 s30, s30, s26
s_cmp_eq_i32 s30, -1048576
s_cbranch_scc1 H_end
s_sub_u32 s31, s31, 1
s_cmp_eq_u32 s31, 0
s_cbranch_scc1 H_end
s_cmp_lt_i32 s30, 1416
s_cbranch_scc1 H_idle
s_cmp_eq_u32 s29, 0
s_cselect_b32 s6, s16, s6
s_subb_u32 s16, s16, 0
s_cmp_eq_u32 s29, 1
s_cselect_b32 s6, s17, s6
s_subb_u32 s17, s17, 0
s_cmp_eq_u32 s29, 2
s_cselect_b32 s6, s18, s6
s_subb_u32 s18, s18, 0
s_mul_i32 s6, s6, 24576
s_sub_u32 s6, s6, 32768
s_cmp_eq_u32 s29, 2
s_cselect_b32 s7, 33554432, 0
s_add_u32 s6, s6, s7
s_cmp_eq_u32 s29, 1
s_cselect_b64 vcc, -1, 0
s_cselect_b32 s7, 25, 13
s_lshl_b32 s7, 1, s7
s_add_u32 s7, s7, s6
v_cndmask_b32 v18, v16, v17, vcc
buffer_load_dword v22, v18, s[56:59], s6 offen
buffer_load_dword v23, v18, s[56:59], s7 offen
s_waitcnt vmcnt(2)
s_branch H_loop
H_idle:
ds_read_b32 v21, v11
s_waitcnt vmcnt(0) lgkmcnt(0)
s_sleep 4
v_cmp_eq_u32 vcc, 0, v21
s_cbranch_vccnz H_loop
H_end:
s_branch B_end
.section .rodata,"a"
.p2align 6
.amdhsa_kernel concat_heads__mha_block_cached__compressed_kv_cla__decode_kernel
  .amdhsa_next_free_vgpr 512
  .amdhsa_next_free_sgpr 102
  .amdhsa_accum_offset 256
  .amdhsa_group_segment_fixed_size 0
  .amdhsa_kernarg_size 112
  .amdhsa_user_sgpr_count 2
  .amdhsa_user_sgpr_kernarg_segment_ptr 1
  .amdhsa_system_sgpr_workgroup_id_x 1
.end_amdhsa_kernel
```

```asm
; @launch grid=(256,1,1) block=(256,1,1) lds=163840
.amdgcn_target "amdgcn-amd-amdhsa--gfx950"
.text
.globl concat_heads__mha_block_cached__compressed_kv_cla__decode_kernel
.p2align 8
.type concat_heads__mha_block_cached__compressed_kv_cla__decode_kernel,@function
concat_heads__mha_block_cached__compressed_kv_cla__decode_kernel:
s_cmp_ge_u32 s2, 256
s_cbranch_scc1 L_exit
s_load_dwordx16 s[16:31], s[0:1], 0
s_load_dwordx8 s[32:39], s[0:1], 64
s_load_dwordx4 s[40:43], s[0:1], 96
v_lshrrev_b32 v1, 6, v0
s_nop 0
v_readfirstlane_b32 s3, v1
s_and_b32 s6, s2, 7
s_bfe_u32 s7, s2, 0x20003
s_lshl_b32 s4, s6, 2
s_add_u32 s4, s4, s7
s_lshr_b32 s5, s2, 5
s_cmp_lt_u32 s5, 2
s_cbranch_scc1 B_role
A_role:
s_sub_u32 s8, s5, 2
s_cmp_ge_u32 s8, 3
s_cselect_b32 s9, 1, 0
s_cselect_b32 s6, 3, 0
s_sub_u32 s8, s8, s6
s_lshl_b32 s11, s8, 2
s_add_u32 s11, s11, s3
s_cmp_ge_u32 s11, 6
s_cselect_b32 s83, 1, 0
s_cselect_b32 s6, -1, 1
s_add_u32 s11, s11, s6
s_cmp_ge_u32 s11, 6
s_cselect_b32 s6, 6, 0
s_sub_u32 s11, s11, s6
s_lshl_b32 s10, s9, 1
s_add_u32 s10, s10, s83
v_and_b32 v1, 63, v0
v_lshlrev_b32 v2, 4, v1
s_sub_u32 s14, s11, 8
s_lshl_b32 s14, s14, 12
s_mov_b32 s13, s14
s_add_u32 s13, s13, 24576
s_min_u32 s12, s13, 2146435072
s_lshl_b32 s82, s10, 5
s_add_u32 s82, s82, s4
s_lshl_b32 s6, s82, 20
s_waitcnt lgkmcnt(0)
s_add_u32 s52, s18, s6
s_addc_u32 s53, s19, 0
s_mov_b32 s54, 1048576
s_mov_b32 s55, 0x20000
s_add_u32 s56, s20, s6
s_addc_u32 s57, s21, 0
s_mov_b32 s58, 1048576
s_mov_b32 s59, 0x20000
s_mul_i32 s6, s9, 2304
s_mul_i32 s7, s3, 288
s_add_u32 s6, s6, s7
s_sub_u32 s7, 4608, s6
s_add_u32 s44, s16, s6
s_addc_u32 s45, s17, 0
s_mov_b32 s46, s7
s_mov_b32 s47, 0x20000
s_mul_i32 s6, s3, 1179648
s_lshl_b32 s7, s4, 8
s_add_u32 s6, s6, s7
s_sub_u32 s7, 4718592, s6
s_add_u32 s48, s22, s6
s_addc_u32 s49, s23, 0
s_mov_b32 s50, s7
s_mov_b32 s51, 0x20000
v_lshrrev_b32 v5, 4, v1
v_and_b32 v6, 15, v1
v_mul_u32_u24 v3, 294912, v5
v_lshl_add_u32 v3, v6, 4, v3
v_mul_u32_u24 v4, 72, v5
v_lshrrev_b32 v6, 3, v6
v_mul_u32_u24 v6, 1152, v6
v_add_u32 v4, v4, v6
v_mov_b32 v7, 7168
s_lshr_b32 s6, s2, 3
s_sub_u32 s6, s6, 8
s_lshl_b32 s6, s6, 2
s_add_u32 s6, s6, s3
s_mul_i32 s6, s6, 49152
s_and_b32 s7, s2, 7
s_lshl_b32 s7, s7, 10
s_add_u32 s6, s6, s7
s_mov_b32 s60, s22
s_mov_b32 s61, s23
s_mov_b32 s62, 4718592
s_mov_b32 s63, 0x20000
v_min_u32 v35, 47, v1
v_lshrrev_b32 v36, 3, v35
v_lshlrev_b32 v35, 7, v35
v_mad_u32_u24 v36, v36, v7, v35
buffer_load_dword v120, v36, s[60:63], s6 offen
buffer_load_dwordx4 v[40:43], v4, s[44:47], 0 offen offset:0
buffer_load_dwordx4 v[44:47], v4, s[44:47], 0 offen offset:16
buffer_load_dwordx4 v[48:51], v4, s[44:47], 0 offen offset:32
buffer_load_dwordx4 v[52:55], v4, s[44:47], 0 offen offset:48
buffer_load_dwordx2 v[56:57], v4, s[44:47], 0 offen offset:64
s_waitcnt vmcnt(54)
buffer_load_dwordx4 v[136:139], v2, s[52:55], s12 offen offset:0 nt
buffer_load_dwordx4 v[140:143], v2, s[52:55], s12 offen offset:1024 nt
buffer_load_dwordx4 v[144:147], v2, s[52:55], s12 offen offset:2048 nt
buffer_load_dwordx4 v[148:151], v2, s[52:55], s12 offen offset:3072 nt
s_add_u32 s13, s13, 24576
s_min_u32 s12, s13, 2146435072
s_waitcnt vmcnt(54)
buffer_load_dwordx4 v[152:155], v2, s[52:55], s12 offen offset:0 nt
buffer_load_dwordx4 v[156:159], v2, s[52:55], s12 offen offset:1024 nt
buffer_load_dwordx4 v[160:163], v2, s[52:55], s12 offen offset:2048 nt
buffer_load_dwordx4 v[164:167], v2, s[52:55], s12 offen offset:3072 nt
s_add_u32 s13, s13, 24576
s_min_u32 s12, s13, 2146435072
s_cmp_lg_u32 s8, 0
s_cbranch_scc1 L_nowq_1
s_waitcnt vmcnt(20)
s_mov_b32 s6, 0
buffer_load_dwordx4 a[96:99], v3, s[48:51], s6 offen
s_mov_b32 s6, 8192
buffer_load_dwordx4 a[100:103], v3, s[48:51], s6 offen
s_mov_b32 s6, 16384
buffer_load_dwordx4 a[104:107], v3, s[48:51], s6 offen
s_mov_b32 s6, 24576
buffer_load_dwordx4 a[108:111], v3, s[48:51], s6 offen
s_mov_b32 s6, 32768
buffer_load_dwordx4 a[112:115], v3, s[48:51], s6 offen
s_mov_b32 s6, 40960
buffer_load_dwordx4 a[116:119], v3, s[48:51], s6 offen
s_mov_b32 s6, 49152
buffer_load_dwordx4 a[120:123], v3, s[48:51], s6 offen
s_mov_b32 s6, 57344
buffer_load_dwordx4 a[124:127], v3, s[48:51], s6 offen
s_mov_b32 s6, 65536
buffer_load_dwordx4 a[128:131], v3, s[48:51], s6 offen
s_mov_b32 s6, 73728
buffer_load_dwordx4 a[132:135], v3, s[48:51], s6 offen
s_mov_b32 s6, 81920
buffer_load_dwordx4 a[136:139], v3, s[48:51], s6 offen
s_mov_b32 s6, 90112
buffer_load_dwordx4 a[140:143], v3, s[48:51], s6 offen
s_mov_b32 s6, 98304
buffer_load_dwordx4 a[144:147], v3, s[48:51], s6 offen
s_mov_b32 s6, 106496
buffer_load_dwordx4 a[148:151], v3, s[48:51], s6 offen
s_mov_b32 s6, 114688
buffer_load_dwordx4 a[152:155], v3, s[48:51], s6 offen
s_mov_b32 s6, 122880
buffer_load_dwordx4 a[156:159], v3, s[48:51], s6 offen
s_mov_b32 s6, 131072
buffer_load_dwordx4 a[160:163], v3, s[48:51], s6 offen
s_mov_b32 s6, 139264
buffer_load_dwordx4 a[164:167], v3, s[48:51], s6 offen
s_mov_b32 s6, 147456
buffer_load_dwordx4 a[168:171], v3, s[48:51], s6 offen
s_mov_b32 s6, 155648
buffer_load_dwordx4 a[172:175], v3, s[48:51], s6 offen
s_mov_b32 s6, 163840
buffer_load_dwordx4 a[176:179], v3, s[48:51], s6 offen
s_mov_b32 s6, 172032
buffer_load_dwordx4 a[180:183], v3, s[48:51], s6 offen
s_mov_b32 s6, 180224
buffer_load_dwordx4 a[184:187], v3, s[48:51], s6 offen
s_mov_b32 s6, 188416
buffer_load_dwordx4 a[188:191], v3, s[48:51], s6 offen
s_mov_b32 s6, 196608
buffer_load_dwordx4 a[192:195], v3, s[48:51], s6 offen
s_mov_b32 s6, 204800
buffer_load_dwordx4 a[196:199], v3, s[48:51], s6 offen
s_mov_b32 s6, 212992
buffer_load_dwordx4 a[200:203], v3, s[48:51], s6 offen
s_mov_b32 s6, 221184
buffer_load_dwordx4 a[204:207], v3, s[48:51], s6 offen
s_mov_b32 s6, 229376
buffer_load_dwordx4 a[208:211], v3, s[48:51], s6 offen
s_mov_b32 s6, 237568
buffer_load_dwordx4 a[212:215], v3, s[48:51], s6 offen
s_mov_b32 s6, 245760
buffer_load_dwordx4 a[216:219], v3, s[48:51], s6 offen
s_mov_b32 s6, 253952
buffer_load_dwordx4 a[220:223], v3, s[48:51], s6 offen
s_mov_b32 s6, 262144
buffer_load_dwordx4 a[224:227], v3, s[48:51], s6 offen
s_mov_b32 s6, 270336
buffer_load_dwordx4 a[228:231], v3, s[48:51], s6 offen
s_mov_b32 s6, 278528
buffer_load_dwordx4 a[232:235], v3, s[48:51], s6 offen
s_mov_b32 s6, 286720
buffer_load_dwordx4 a[236:239], v3, s[48:51], s6 offen
L_nowq_1:
s_waitcnt vmcnt(54)
buffer_load_dwordx4 v[168:171], v2, s[52:55], s12 offen offset:0 nt
buffer_load_dwordx4 v[172:175], v2, s[52:55], s12 offen offset:1024 nt
buffer_load_dwordx4 v[176:179], v2, s[52:55], s12 offen offset:2048 nt
buffer_load_dwordx4 v[180:183], v2, s[52:55], s12 offen offset:3072 nt
s_add_u32 s13, s13, 24576
s_min_u32 s12, s13, 2146435072
s_waitcnt vmcnt(54)
buffer_load_dwordx4 v[184:187], v2, s[52:55], s12 offen offset:0 nt
buffer_load_dwordx4 v[188:191], v2, s[52:55], s12 offen offset:1024 nt
buffer_load_dwordx4 v[192:195], v2, s[52:55], s12 offen offset:2048 nt
buffer_load_dwordx4 v[196:199], v2, s[52:55], s12 offen offset:3072 nt
s_add_u32 s13, s13, 24576
s_min_u32 s12, s13, 2146435072
s_waitcnt vmcnt(54)
buffer_load_dwordx4 v[200:203], v2, s[52:55], s12 offen offset:0 nt
buffer_load_dwordx4 v[204:207], v2, s[52:55], s12 offen offset:1024 nt
buffer_load_dwordx4 v[208:211], v2, s[52:55], s12 offen offset:2048 nt
buffer_load_dwordx4 v[212:215], v2, s[52:55], s12 offen offset:3072 nt
s_add_u32 s13, s13, 24576
s_min_u32 s12, s13, 2146435072
s_cmp_lg_u32 s8, 1
s_cbranch_scc1 L_nowq_2
s_waitcnt vmcnt(20)
s_mov_b32 s6, 0
buffer_load_dwordx4 a[96:99], v3, s[48:51], s6 offen
s_mov_b32 s6, 8192
buffer_load_dwordx4 a[100:103], v3, s[48:51], s6 offen
s_mov_b32 s6, 16384
buffer_load_dwordx4 a[104:107], v3, s[48:51], s6 offen
s_mov_b32 s6, 24576
buffer_load_dwordx4 a[108:111], v3, s[48:51], s6 offen
s_mov_b32 s6, 32768
buffer_load_dwordx4 a[112:115], v3, s[48:51], s6 offen
s_mov_b32 s6, 40960
buffer_load_dwordx4 a[116:119], v3, s[48:51], s6 offen
s_mov_b32 s6, 49152
buffer_load_dwordx4 a[120:123], v3, s[48:51], s6 offen
s_mov_b32 s6, 57344
buffer_load_dwordx4 a[124:127], v3, s[48:51], s6 offen
s_mov_b32 s6, 65536
buffer_load_dwordx4 a[128:131], v3, s[48:51], s6 offen
s_mov_b32 s6, 73728
buffer_load_dwordx4 a[132:135], v3, s[48:51], s6 offen
s_mov_b32 s6, 81920
buffer_load_dwordx4 a[136:139], v3, s[48:51], s6 offen
s_mov_b32 s6, 90112
buffer_load_dwordx4 a[140:143], v3, s[48:51], s6 offen
s_mov_b32 s6, 98304
buffer_load_dwordx4 a[144:147], v3, s[48:51], s6 offen
s_mov_b32 s6, 106496
buffer_load_dwordx4 a[148:151], v3, s[48:51], s6 offen
s_mov_b32 s6, 114688
buffer_load_dwordx4 a[152:155], v3, s[48:51], s6 offen
s_mov_b32 s6, 122880
buffer_load_dwordx4 a[156:159], v3, s[48:51], s6 offen
s_mov_b32 s6, 131072
buffer_load_dwordx4 a[160:163], v3, s[48:51], s6 offen
s_mov_b32 s6, 139264
buffer_load_dwordx4 a[164:167], v3, s[48:51], s6 offen
s_mov_b32 s6, 147456
buffer_load_dwordx4 a[168:171], v3, s[48:51], s6 offen
s_mov_b32 s6, 155648
buffer_load_dwordx4 a[172:175], v3, s[48:51], s6 offen
s_mov_b32 s6, 163840
buffer_load_dwordx4 a[176:179], v3, s[48:51], s6 offen
s_mov_b32 s6, 172032
buffer_load_dwordx4 a[180:183], v3, s[48:51], s6 offen
s_mov_b32 s6, 180224
buffer_load_dwordx4 a[184:187], v3, s[48:51], s6 offen
s_mov_b32 s6, 188416
buffer_load_dwordx4 a[188:191], v3, s[48:51], s6 offen
s_mov_b32 s6, 196608
buffer_load_dwordx4 a[192:195], v3, s[48:51], s6 offen
s_mov_b32 s6, 204800
buffer_load_dwordx4 a[196:199], v3, s[48:51], s6 offen
s_mov_b32 s6, 212992
buffer_load_dwordx4 a[200:203], v3, s[48:51], s6 offen
s_mov_b32 s6, 221184
buffer_load_dwordx4 a[204:207], v3, s[48:51], s6 offen
s_mov_b32 s6, 229376
buffer_load_dwordx4 a[208:211], v3, s[48:51], s6 offen
s_mov_b32 s6, 237568
buffer_load_dwordx4 a[212:215], v3, s[48:51], s6 offen
s_mov_b32 s6, 245760
buffer_load_dwordx4 a[216:219], v3, s[48:51], s6 offen
s_mov_b32 s6, 253952
buffer_load_dwordx4 a[220:223], v3, s[48:51], s6 offen
s_mov_b32 s6, 262144
buffer_load_dwordx4 a[224:227], v3, s[48:51], s6 offen
s_mov_b32 s6, 270336
buffer_load_dwordx4 a[228:231], v3, s[48:51], s6 offen
s_mov_b32 s6, 278528
buffer_load_dwordx4 a[232:235], v3, s[48:51], s6 offen
s_mov_b32 s6, 286720
buffer_load_dwordx4 a[236:239], v3, s[48:51], s6 offen
L_nowq_2:
s_waitcnt vmcnt(54)
buffer_load_dwordx4 v[216:219], v2, s[52:55], s12 offen offset:0 nt
buffer_load_dwordx4 v[220:223], v2, s[52:55], s12 offen offset:1024 nt
buffer_load_dwordx4 v[224:227], v2, s[52:55], s12 offen offset:2048 nt
buffer_load_dwordx4 v[228:231], v2, s[52:55], s12 offen offset:3072 nt
s_add_u32 s13, s13, 24576
s_min_u32 s12, s13, 2146435072
s_waitcnt vmcnt(54)
buffer_load_dwordx4 v[232:235], v2, s[52:55], s12 offen offset:0 nt
buffer_load_dwordx4 v[236:239], v2, s[52:55], s12 offen offset:1024 nt
buffer_load_dwordx4 v[240:243], v2, s[52:55], s12 offen offset:2048 nt
buffer_load_dwordx4 v[244:247], v2, s[52:55], s12 offen offset:3072 nt
s_add_u32 s13, s13, 24576
s_min_u32 s12, s13, 2146435072
s_waitcnt vmcnt(54)
s_add_u32 s34, s14, 24576
s_min_u32 s34, s34, 2146435072
buffer_load_dwordx4 a[0:3], v2, s[56:59], s34 offen offset:0 nt
buffer_load_dwordx4 a[4:7], v2, s[56:59], s34 offen offset:1024 nt
buffer_load_dwordx4 a[8:11], v2, s[56:59], s34 offen offset:2048 nt
buffer_load_dwordx4 a[12:15], v2, s[56:59], s34 offen offset:3072 nt
s_cmp_lg_u32 s8, 2
s_cbranch_scc1 L_nowq_3
s_waitcnt vmcnt(20)
s_mov_b32 s6, 0
buffer_load_dwordx4 a[96:99], v3, s[48:51], s6 offen
s_mov_b32 s6, 8192
buffer_load_dwordx4 a[100:103], v3, s[48:51], s6 offen
s_mov_b32 s6, 16384
buffer_load_dwordx4 a[104:107], v3, s[48:51], s6 offen
s_mov_b32 s6, 24576
buffer_load_dwordx4 a[108:111], v3, s[48:51], s6 offen
s_mov_b32 s6, 32768
buffer_load_dwordx4 a[112:115], v3, s[48:51], s6 offen
s_mov_b32 s6, 40960
buffer_load_dwordx4 a[116:119], v3, s[48:51], s6 offen
s_mov_b32 s6, 49152
buffer_load_dwordx4 a[120:123], v3, s[48:51], s6 offen
s_mov_b32 s6, 57344
buffer_load_dwordx4 a[124:127], v3, s[48:51], s6 offen
s_mov_b32 s6, 65536
buffer_load_dwordx4 a[128:131], v3, s[48:51], s6 offen
s_mov_b32 s6, 73728
buffer_load_dwordx4 a[132:135], v3, s[48:51], s6 offen
s_mov_b32 s6, 81920
buffer_load_dwordx4 a[136:139], v3, s[48:51], s6 offen
s_mov_b32 s6, 90112
buffer_load_dwordx4 a[140:143], v3, s[48:51], s6 offen
s_mov_b32 s6, 98304
buffer_load_dwordx4 a[144:147], v3, s[48:51], s6 offen
s_mov_b32 s6, 106496
buffer_load_dwordx4 a[148:151], v3, s[48:51], s6 offen
s_mov_b32 s6, 114688
buffer_load_dwordx4 a[152:155], v3, s[48:51], s6 offen
s_mov_b32 s6, 122880
buffer_load_dwordx4 a[156:159], v3, s[48:51], s6 offen
s_mov_b32 s6, 131072
buffer_load_dwordx4 a[160:163], v3, s[48:51], s6 offen
s_mov_b32 s6, 139264
buffer_load_dwordx4 a[164:167], v3, s[48:51], s6 offen
s_mov_b32 s6, 147456
buffer_load_dwordx4 a[168:171], v3, s[48:51], s6 offen
s_mov_b32 s6, 155648
buffer_load_dwordx4 a[172:175], v3, s[48:51], s6 offen
s_mov_b32 s6, 163840
buffer_load_dwordx4 a[176:179], v3, s[48:51], s6 offen
s_mov_b32 s6, 172032
buffer_load_dwordx4 a[180:183], v3, s[48:51], s6 offen
s_mov_b32 s6, 180224
buffer_load_dwordx4 a[184:187], v3, s[48:51], s6 offen
s_mov_b32 s6, 188416
buffer_load_dwordx4 a[188:191], v3, s[48:51], s6 offen
s_mov_b32 s6, 196608
buffer_load_dwordx4 a[192:195], v3, s[48:51], s6 offen
s_mov_b32 s6, 204800
buffer_load_dwordx4 a[196:199], v3, s[48:51], s6 offen
s_mov_b32 s6, 212992
buffer_load_dwordx4 a[200:203], v3, s[48:51], s6 offen
s_mov_b32 s6, 221184
buffer_load_dwordx4 a[204:207], v3, s[48:51], s6 offen
s_mov_b32 s6, 229376
buffer_load_dwordx4 a[208:211], v3, s[48:51], s6 offen
s_mov_b32 s6, 237568
buffer_load_dwordx4 a[212:215], v3, s[48:51], s6 offen
s_mov_b32 s6, 245760
buffer_load_dwordx4 a[216:219], v3, s[48:51], s6 offen
s_mov_b32 s6, 253952
buffer_load_dwordx4 a[220:223], v3, s[48:51], s6 offen
s_mov_b32 s6, 262144
buffer_load_dwordx4 a[224:227], v3, s[48:51], s6 offen
s_mov_b32 s6, 270336
buffer_load_dwordx4 a[228:231], v3, s[48:51], s6 offen
s_mov_b32 s6, 278528
buffer_load_dwordx4 a[232:235], v3, s[48:51], s6 offen
s_mov_b32 s6, 286720
buffer_load_dwordx4 a[236:239], v3, s[48:51], s6 offen
L_nowq_3:
s_mov_b32 s64, s42
s_mov_b32 s65, s43
s_mov_b32 s66, 16777216
s_mov_b32 s67, 0x20000
s_mov_b32 s68, s40
s_mov_b32 s69, s41
s_mov_b32 s70, 256
s_mov_b32 s71, 0x20000
s_mul_i32 s6, s4, 147456
s_add_u32 s60, s24, s6
s_addc_u32 s61, s25, 0
s_mov_b32 s62, 147456
s_mov_b32 s63, 0x20000
v_and_b32 v5, 1, v1
v_lshlrev_b32 v5, 4, v5
v_mov_b32 v6, 0xffff
v_lshlrev_b32 v5, v5, v6
v_bfe_u32 v6, v1, 1, 2
v_cmp_eq_u32 vcc, 0, v6
s_nop 1
v_cndmask_b32 v8, 0, v5, vcc
v_cmp_eq_u32 vcc, 1, v6
s_nop 1
v_cndmask_b32 v9, 0, v5, vcc
v_cmp_eq_u32 vcc, 2, v6
s_nop 1
v_cndmask_b32 v10, 0, v5, vcc
v_cmp_eq_u32 vcc, 3, v6
s_nop 1
v_cndmask_b32 v11, 0, v5, vcc
v_mov_b32 v5, 0x0c0c0c0c
s_mov_b32 s6, 0x01000100
s_mov_b32 s7, 0x03020302
v_bfi_b32 v12, v8, s6, v5
v_bfi_b32 v13, v9, s6, v5
v_bfi_b32 v14, v10, s6, v5
v_bfi_b32 v15, v11, s6, v5
v_bfi_b32 v16, v8, s7, v5
v_bfi_b32 v17, v9, s7, v5
v_bfi_b32 v18, v10, s7, v5
v_bfi_b32 v19, v11, s7, v5
v_mov_b32 v7, 0x3e0293ee
v_mov_b32 v86, 0xff800000
v_lshrrev_b32 v5, 4, v1
v_lshlrev_b32 v5, 3, v5
v_bfe_u32 v6, v1, 2, 2
v_add_u32 v5, v5, v6
v_mul_u32_u24 v5, 1152, v5
s_mul_i32 s6, s3, 288
v_add_u32 v5, s6, v5
v_and_b32 v6, 3, v1
v_lshl_add_u32 v88, v6, 5, v5
v_lshl_add_u32 v89, v6, 3, v5
v_add_u32 v89, 256, v89
v_add_u32 v90, 73728, v88
v_add_u32 v91, 73728, v89
s_mul_i32 s82, s82, 64
s_add_u32 s82, s82, 327680
s_mov_b64 s[72:73], 0
s_cmp_ge_u32 s11, 2
s_cselect_b32 s74, 0x22222222, 0
s_mov_b32 s75, s74
s_mov_b32 s76, 0x44444444
s_mov_b32 s77, s76
s_mov_b32 s78, 0x88888888
s_mov_b32 s79, s78
v_bfe_u32 v5, v1, 4, 1
s_lshl_b32 s6, s9, 7
s_lshl_b32 s7, s4, 1
s_add_u32 s6, s6, s7
s_add_u32 s6, s6, s8
v_mul_u32_u24 v6, 63, v5
v_add_u32 v6, s6, v6
v_mul_u32_u24 v92, 1152, v6
v_add_u32 v92, 4194304, v92
v_sub_u32 v6, s8, v5
v_cmp_lt_u32 vcc, 1, v6
v_mov_b32 v6, 2146435072
s_nop 0
v_cndmask_b32 v92, v92, v6, vcc
v_and_b32 v35, 15, v1
v_lshl_add_u32 v92, v35, 4, v92
s_lshl_b32 s6, s3, 5
v_add_u32 v93, s6, v92
s_lshl_b32 s6, s3, 8
v_add_u32 v92, s6, v92
s_lshl_b32 s6, s8, 2
s_add_u32 s6, s6, 0
s_cmp_ge_u32 s6, 6
s_cselect_b32 s6, 1, 0
v_cmp_eq_u32 vcc, s6, v5
s_nop 1
v_cndmask_b32 v106, 0, 1.0, vcc
s_lshl_b32 s6, s8, 2
s_add_u32 s6, s6, 1
s_cmp_ge_u32 s6, 6
s_cselect_b32 s6, 1, 0
v_cmp_eq_u32 vcc, s6, v5
s_nop 1
v_cndmask_b32 v107, 0, 1.0, vcc
s_lshl_b32 s6, s8, 2
s_add_u32 s6, s6, 2
s_cmp_ge_u32 s6, 6
s_cselect_b32 s6, 1, 0
v_cmp_eq_u32 vcc, s6, v5
s_nop 1
v_cndmask_b32 v108, 0, 1.0, vcc
s_lshl_b32 s6, s8, 2
s_add_u32 s6, s6, 3
s_cmp_ge_u32 s6, 6
s_cselect_b32 s6, 1, 0
v_cmp_eq_u32 vcc, s6, v5
s_nop 1
v_cndmask_b32 v109, 0, 1.0, vcc
v_cmp_gt_u32 vcc, 32, v1
s_nop 1
v_cndmask_b32 v98, 0, v106, vcc
v_cndmask_b32 v102, v106, 0, vcc
v_cndmask_b32 v99, 0, v107, vcc
v_cndmask_b32 v103, v107, 0, vcc
v_cndmask_b32 v100, 0, v108, vcc
v_cndmask_b32 v104, v108, 0, vcc
v_cndmask_b32 v101, 0, v109, vcc
v_cndmask_b32 v105, v109, 0, vcc
v_and_b32 v35, 15, v1
v_lshlrev_b32 v35, 4, v35
v_lshl_add_u32 v94, v5, 3, v35
s_lshl_b32 s6, s3, 8
s_add_u32 s6, s6, 151552
v_add_u32 v94, s6, v94
v_and_b32 v35, 3, v1
v_lshlrev_b32 v35, 8, v35
v_lshrrev_b32 v36, 4, v1
v_lshl_add_u32 v95, v36, 4, v35
v_add_u32 v95, 151552, v95
s_mul_i32 s15, s3, 36864
s_mov_b32 s80, 0x0
s_mov_b32 s81, 0
s_lshl_b32 s6, s4, 1
s_add_u32 s6, s6, s9
s_mul_i32 s6, s6, 4
s_add_u32 s6, s6, s8
s_lshl_b32 s6, s6, 2
s_add_u32 s6, s6, 393216
s_lshr_b32 s7, s4, 2
s_mul_i32 s7, s7, 4224
s_add_u32 s6, s6, s7
v_mov_b32 v118, 2146435072
v_mov_b32 v117, s6
v_cmp_eq_u32 vcc, 0, v0
s_nop 1
v_cndmask_b32 v118, v118, v117, vcc
v_mov_b32 v117, 3
v_and_b32 v35, 15, v1
v_lshlrev_b32 v35, 5, v35
v_lshl_add_u32 v36, v5, 4, v35
v_lshrrev_b32 v6, 5, v1
v_lshl_add_u32 v36, v6, 9, v36
s_lshl_b32 s6, s3, 10
s_add_u32 s6, s6, 147456
v_add_u32 v36, s6, v36
s_lshl_b32 s6, s83, 9
s_add_u32 s6, s6, 147456
v_add_u32 v35, s6, v35
s_waitcnt vmcnt(35)
v_perm_b32 v60, v40, v40, v12
v_perm_b32 v61, v40, v40, v13
v_perm_b32 v62, v40, v40, v14
v_perm_b32 v63, v40, v40, v15
s_nop 1
v_mfma_f32_16x16x32_bf16 v[20:23], v[60:63], a[96:99], 0
s_add_u32 s34, s14, 49152
s_min_u32 s34, s34, 2146435072
buffer_load_dwordx4 a[16:19], v2, s[56:59], s34 offen offset:0 nt
s_waitcnt vmcnt(35)
v_perm_b32 v64, v40, v40, v16
v_perm_b32 v65, v40, v40, v17
v_perm_b32 v66, v40, v40, v18
v_perm_b32 v67, v40, v40, v19
s_nop 1
v_mfma_f32_16x16x32_bf16 v[20:23], v[64:67], a[100:103], v[20:23]
buffer_load_dwordx4 a[20:23], v2, s[56:59], s34 offen offset:1024 nt
s_waitcnt vmcnt(35)
v_perm_b32 v68, v41, v41, v12
v_perm_b32 v69, v41, v41, v13
v_perm_b32 v70, v41, v41, v14
v_perm_b32 v71, v41, v41, v15
s_nop 1
v_mfma_f32_16x16x32_bf16 v[20:23], v[68:71], a[104:107], v[20:23]
buffer_load_dwordx4 a[24:27], v2, s[56:59], s34 offen offset:2048 nt
s_waitcnt vmcnt(35)
v_perm_b32 v72, v41, v41, v16
v_perm_b32 v73, v41, v41, v17
v_perm_b32 v74, v41, v41, v18
v_perm_b32 v75, v41, v41, v19
s_nop 1
v_mfma_f32_16x16x32_bf16 v[20:23], v[72:75], a[108:111], v[20:23]
buffer_load_dwordx4 a[28:31], v2, s[56:59], s34 offen offset:3072 nt
s_waitcnt vmcnt(35)
v_perm_b32 v60, v42, v42, v12
v_perm_b32 v61, v42, v42, v13
v_perm_b32 v62, v42, v42, v14
v_perm_b32 v63, v42, v42, v15
s_nop 1
v_mfma_f32_16x16x32_bf16 v[20:23], v[60:63], a[112:115], v[20:23]
s_add_u32 s34, s14, 73728
s_min_u32 s34, s34, 2146435072
buffer_load_dwordx4 a[32:35], v2, s[56:59], s34 offen offset:0 nt
s_waitcnt vmcnt(35)
v_perm_b32 v64, v42, v42, v16
v_perm_b32 v65, v42, v42, v17
v_perm_b32 v66, v42, v42, v18
v_perm_b32 v67, v42, v42, v19
s_nop 1
v_mfma_f32_16x16x32_bf16 v[20:23], v[64:67], a[116:119], v[20:23]
buffer_load_dwordx4 a[36:39], v2, s[56:59], s34 offen offset:1024 nt
s_waitcnt vmcnt(35)
v_perm_b32 v68, v43, v43, v12
v_perm_b32 v69, v43, v43, v13
v_perm_b32 v70, v43, v43, v14
v_perm_b32 v71, v43, v43, v15
s_nop 1
v_mfma_f32_16x16x32_bf16 v[20:23], v[68:71], a[120:123], v[20:23]
buffer_load_dwordx4 a[40:43], v2, s[56:59], s34 offen offset:2048 nt
s_waitcnt vmcnt(35)
v_perm_b32 v72, v43, v43, v16
v_perm_b32 v73, v43, v43, v17
v_perm_b32 v74, v43, v43, v18
v_perm_b32 v75, v43, v43, v19
s_nop 1
v_mfma_f32_16x16x32_bf16 v[20:23], v[72:75], a[124:127], v[20:23]
buffer_load_dwordx4 a[44:47], v2, s[56:59], s34 offen offset:3072 nt
s_waitcnt vmcnt(35)
v_perm_b32 v60, v44, v44, v12
v_perm_b32 v61, v44, v44, v13
v_perm_b32 v62, v44, v44, v14
v_perm_b32 v63, v44, v44, v15
s_nop 1
v_mfma_f32_16x16x32_bf16 v[20:23], v[60:63], a[128:131], v[20:23]
s_add_u32 s34, s14, 98304
s_min_u32 s34, s34, 2146435072
buffer_load_dwordx4 a[48:51], v2, s[56:59], s34 offen offset:0 nt
s_waitcnt vmcnt(35)
v_perm_b32 v64, v44, v44, v16
v_perm_b32 v65, v44, v44, v17
v_perm_b32 v66, v44, v44, v18
v_perm_b32 v67, v44, v44, v19
s_nop 1
v_mfma_f32_16x16x32_bf16 v[20:23], v[64:67], a[132:135], v[20:23]
buffer_load_dwordx4 a[52:55], v2, s[56:59], s34 offen offset:1024 nt
s_waitcnt vmcnt(35)
v_perm_b32 v68, v45, v45, v12
v_perm_b32 v69, v45, v45, v13
v_perm_b32 v70, v45, v45, v14
v_perm_b32 v71, v45, v45, v15
s_nop 1
v_mfma_f32_16x16x32_bf16 v[20:23], v[68:71], a[136:139], v[20:23]
buffer_load_dwordx4 a[56:59], v2, s[56:59], s34 offen offset:2048 nt
s_waitcnt vmcnt(35)
v_perm_b32 v72, v45, v45, v16
v_perm_b32 v73, v45, v45, v17
v_perm_b32 v74, v45, v45, v18
v_perm_b32 v75, v45, v45, v19
s_nop 1
v_mfma_f32_16x16x32_bf16 v[20:23], v[72:75], a[140:143], v[20:23]
buffer_load_dwordx4 a[60:63], v2, s[56:59], s34 offen offset:3072 nt
s_waitcnt vmcnt(35)
v_perm_b32 v60, v46, v46, v12
v_perm_b32 v61, v46, v46, v13
v_perm_b32 v62, v46, v46, v14
v_perm_b32 v63, v46, v46, v15
s_nop 1
v_mfma_f32_16x16x32_bf16 v[20:23], v[60:63], a[144:147], v[20:23]
s_add_u32 s34, s14, 122880
s_min_u32 s34, s34, 2146435072
buffer_load_dwordx4 a[64:67], v2, s[56:59], s34 offen offset:0 nt
s_waitcnt vmcnt(35)
v_perm_b32 v64, v46, v46, v16
v_perm_b32 v65, v46, v46, v17
v_perm_b32 v66, v46, v46, v18
v_perm_b32 v67, v46, v46, v19
s_nop 1
v_mfma_f32_16x16x32_bf16 v[20:23], v[64:67], a[148:151], v[20:23]
buffer_load_dwordx4 a[68:71], v2, s[56:59], s34 offen offset:1024 nt
s_waitcnt vmcnt(35)
v_perm_b32 v68, v47, v47, v12
v_perm_b32 v69, v47, v47, v13
v_perm_b32 v70, v47, v47, v14
v_perm_b32 v71, v47, v47, v15
s_nop 1
v_mfma_f32_16x16x32_bf16 v[20:23], v[68:71], a[152:155], v[20:23]
buffer_load_dwordx4 a[72:75], v2, s[56:59], s34 offen offset:2048 nt
s_waitcnt vmcnt(35)
v_perm_b32 v72, v47, v47, v16
v_perm_b32 v73, v47, v47, v17
v_perm_b32 v74, v47, v47, v18
v_perm_b32 v75, v47, v47, v19
s_nop 1
v_mfma_f32_16x16x32_bf16 v[20:23], v[72:75], a[156:159], v[20:23]
buffer_load_dwordx4 a[76:79], v2, s[56:59], s34 offen offset:3072 nt
s_waitcnt vmcnt(35)
v_perm_b32 v60, v48, v48, v12
v_perm_b32 v61, v48, v48, v13
v_perm_b32 v62, v48, v48, v14
v_perm_b32 v63, v48, v48, v15
s_nop 1
v_mfma_f32_16x16x32_bf16 v[20:23], v[60:63], a[160:163], v[20:23]
s_add_u32 s34, s14, 147456
s_min_u32 s34, s34, 2146435072
buffer_load_dwordx4 a[80:83], v2, s[56:59], s34 offen offset:0 nt
s_waitcnt vmcnt(35)
v_perm_b32 v64, v48, v48, v16
v_perm_b32 v65, v48, v48, v17
v_perm_b32 v66, v48, v48, v18
v_perm_b32 v67, v48, v48, v19
s_nop 1
v_mfma_f32_16x16x32_bf16 v[20:23], v[64:67], a[164:167], v[20:23]
buffer_load_dwordx4 a[84:87], v2, s[56:59], s34 offen offset:1024 nt
s_waitcnt vmcnt(35)
v_perm_b32 v68, v49, v49, v12
v_perm_b32 v69, v49, v49, v13
v_perm_b32 v70, v49, v49, v14
v_perm_b32 v71, v49, v49, v15
s_nop 1
v_mfma_f32_16x16x32_bf16 v[20:23], v[68:71], a[168:171], v[20:23]
buffer_load_dwordx4 a[88:91], v2, s[56:59], s34 offen offset:2048 nt
s_waitcnt vmcnt(35)
v_perm_b32 v72, v49, v49, v16
v_perm_b32 v73, v49, v49, v17
v_perm_b32 v74, v49, v49, v18
v_perm_b32 v75, v49, v49, v19
s_nop 1
v_mfma_f32_16x16x32_bf16 v[20:23], v[72:75], a[172:175], v[20:23]
buffer_load_dwordx4 a[92:95], v2, s[56:59], s34 offen offset:3072 nt
s_waitcnt vmcnt(35)
v_perm_b32 v60, v50, v50, v12
v_perm_b32 v61, v50, v50, v13
v_perm_b32 v62, v50, v50, v14
v_perm_b32 v63, v50, v50, v15
s_nop 1
v_mfma_f32_16x16x32_bf16 v[20:23], v[60:63], a[176:179], v[20:23]
s_add_u32 s34, s14, 172032
s_min_u32 s34, s34, 2146435072
buffer_load_dwordx4 a[240:243], v2, s[56:59], s34 offen offset:0 nt
s_waitcnt vmcnt(35)
v_perm_b32 v64, v50, v50, v16
v_perm_b32 v65, v50, v50, v17
v_perm_b32 v66, v50, v50, v18
v_perm_b32 v67, v50, v50, v19
s_nop 1
v_mfma_f32_16x16x32_bf16 v[20:23], v[64:67], a[180:183], v[20:23]
buffer_load_dwordx4 a[244:247], v2, s[56:59], s34 offen offset:1024 nt
s_waitcnt vmcnt(35)
v_perm_b32 v68, v51, v51, v12
v_perm_b32 v69, v51, v51, v13
v_perm_b32 v70, v51, v51, v14
v_perm_b32 v71, v51, v51, v15
s_nop 1
v_mfma_f32_16x16x32_bf16 v[20:23], v[68:71], a[184:187], v[20:23]
buffer_load_dwordx4 a[248:251], v2, s[56:59], s34 offen offset:2048 nt
s_waitcnt vmcnt(35)
v_perm_b32 v72, v51, v51, v16
v_perm_b32 v73, v51, v51, v17
v_perm_b32 v74, v51, v51, v18
v_perm_b32 v75, v51, v51, v19
s_nop 1
v_mfma_f32_16x16x32_bf16 v[20:23], v[72:75], a[188:191], v[20:23]
buffer_load_dwordx4 a[252:255], v2, s[56:59], s34 offen offset:3072 nt
s_waitcnt vmcnt(35)
v_perm_b32 v60, v52, v52, v12
v_perm_b32 v61, v52, v52, v13
v_perm_b32 v62, v52, v52, v14
v_perm_b32 v63, v52, v52, v15
s_nop 1
v_mfma_f32_16x16x32_bf16 v[20:23], v[60:63], a[192:195], v[20:23]
s_waitcnt vmcnt(34)
v_perm_b32 v64, v52, v52, v16
v_perm_b32 v65, v52, v52, v17
v_perm_b32 v66, v52, v52, v18
v_perm_b32 v67, v52, v52, v19
s_nop 1
v_mfma_f32_16x16x32_bf16 v[20:23], v[64:67], a[196:199], v[20:23]
s_waitcnt vmcnt(33)
v_perm_b32 v68, v53, v53, v12
v_perm_b32 v69, v53, v53, v13
v_perm_b32 v70, v53, v53, v14
v_perm_b32 v71, v53, v53, v15
s_nop 1
v_mfma_f32_16x16x32_bf16 v[20:23], v[68:71], a[200:203], v[20:23]
s_waitcnt vmcnt(32)
v_perm_b32 v72, v53, v53, v16
v_perm_b32 v73, v53, v53, v17
v_perm_b32 v74, v53, v53, v18
v_perm_b32 v75, v53, v53, v19
s_nop 1
v_mfma_f32_16x16x32_bf16 v[20:23], v[72:75], a[204:207], v[20:23]
s_waitcnt vmcnt(31)
v_perm_b32 v60, v54, v54, v12
v_perm_b32 v61, v54, v54, v13
v_perm_b32 v62, v54, v54, v14
v_perm_b32 v63, v54, v54, v15
s_nop 1
v_mfma_f32_16x16x32_bf16 v[20:23], v[60:63], a[208:211], v[20:23]
s_waitcnt vmcnt(30)
v_perm_b32 v64, v54, v54, v16
v_perm_b32 v65, v54, v54, v17
v_perm_b32 v66, v54, v54, v18
v_perm_b32 v67, v54, v54, v19
s_nop 1
v_mfma_f32_16x16x32_bf16 v[20:23], v[64:67], a[212:215], v[20:23]
s_waitcnt vmcnt(29)
v_perm_b32 v68, v55, v55, v12
v_perm_b32 v69, v55, v55, v13
v_perm_b32 v70, v55, v55, v14
v_perm_b32 v71, v55, v55, v15
s_nop 1
v_mfma_f32_16x16x32_bf16 v[20:23], v[68:71], a[216:219], v[20:23]
s_waitcnt vmcnt(28)
v_perm_b32 v72, v55, v55, v16
v_perm_b32 v73, v55, v55, v17
v_perm_b32 v74, v55, v55, v18
v_perm_b32 v75, v55, v55, v19
s_nop 1
v_mfma_f32_16x16x32_bf16 v[20:23], v[72:75], a[220:223], v[20:23]
s_waitcnt vmcnt(27)
v_perm_b32 v60, v56, v56, v12
v_perm_b32 v61, v56, v56, v13
v_perm_b32 v62, v56, v56, v14
v_perm_b32 v63, v56, v56, v15
s_nop 1
v_mfma_f32_16x16x32_bf16 v[20:23], v[60:63], a[224:227], v[20:23]
s_waitcnt vmcnt(26)
v_perm_b32 v64, v56, v56, v16
v_perm_b32 v65, v56, v56, v17
v_perm_b32 v66, v56, v56, v18
v_perm_b32 v67, v56, v56, v19
s_nop 1
v_mfma_f32_16x16x32_bf16 v[20:23], v[64:67], a[228:231], v[20:23]
s_waitcnt vmcnt(25)
v_perm_b32 v68, v57, v57, v12
v_perm_b32 v69, v57, v57, v13
v_perm_b32 v70, v57, v57, v14
v_perm_b32 v71, v57, v57, v15
s_nop 1
v_mfma_f32_16x16x32_bf16 v[20:23], v[68:71], a[232:235], v[20:23]
s_waitcnt vmcnt(24)
v_perm_b32 v72, v57, v57, v16
v_perm_b32 v73, v57, v57, v17
v_perm_b32 v74, v57, v57, v18
v_perm_b32 v75, v57, v57, v19
s_nop 1
v_mfma_f32_16x16x32_bf16 v[20:23], v[72:75], a[236:239], v[20:23]
s_nop 7
ds_write_b128 v36, v[20:23]
s_waitcnt lgkmcnt(0)
s_barrier
ds_read_b128 v[40:43], v35 offset:0
ds_read_b128 v[44:47], v35 offset:16
ds_read_b128 v[48:51], v35 offset:1024
ds_read_b128 v[52:55], v35 offset:1040
ds_read_b128 v[56:59], v35 offset:2048
ds_read_b128 v[60:63], v35 offset:2064
ds_read_b128 v[64:67], v35 offset:3072
ds_read_b128 v[68:71], v35 offset:3088
v_mov_b32 v20, 0
v_mov_b32 v21, 0
v_mov_b32 v22, 0
v_mov_b32 v23, 0
s_waitcnt lgkmcnt(0)
v_add_f32 v40, v40, v48
v_add_f32 v56, v56, v64
v_add_f32 v41, v41, v49
v_add_f32 v57, v57, v65
v_add_f32 v42, v42, v50
v_add_f32 v58, v58, v66
v_add_f32 v43, v43, v51
v_add_f32 v59, v59, v67
v_add_f32 v44, v44, v52
v_add_f32 v60, v60, v68
v_add_f32 v45, v45, v53
v_add_f32 v61, v61, v69
v_add_f32 v46, v46, v54
v_add_f32 v62, v62, v70
v_add_f32 v47, v47, v55
v_add_f32 v63, v63, v71
v_add_f32 v40, v40, v56
v_add_f32 v41, v41, v57
v_add_f32 v42, v42, v58
v_add_f32 v43, v43, v59
v_add_f32 v44, v44, v60
v_add_f32 v45, v45, v61
v_add_f32 v46, v46, v62
v_add_f32 v47, v47, v63
v_cvt_pk_bf16_f32 v24, v40, v41
v_cvt_pk_bf16_f32 v25, v42, v43
v_cvt_pk_bf16_f32 v26, v44, v45
v_cvt_pk_bf16_f32 v27, v46, v47
s_add_u32 s14, s14, 196608
K_loop:
s_cmp_lg_u32 s81, 8
s_cbranch_scc1 L_c0_4
buffer_load_dword v96, off, s[68:71], 0 offset:0 sc1
L_c0_4:
s_waitcnt vmcnt(28)
v_dot2_f32_bf16 v28, v120, v24, 0
v_dot2_f32_bf16 v29, v124, v24, 0
v_dot2_f32_bf16 v30, v128, v24, 0
v_dot2_f32_bf16 v31, v132, v24, 0
v_dot2_f32_bf16 v28, v121, v25, v28
v_dot2_f32_bf16 v29, v125, v25, v29
v_dot2_f32_bf16 v30, v129, v25, v30
v_dot2_f32_bf16 v31, v133, v25, v31
v_dot2_f32_bf16 v28, v122, v26, v28
v_dot2_f32_bf16 v29, v126, v26, v29
v_dot2_f32_bf16 v30, v130, v26, v30
v_dot2_f32_bf16 v31, v134, v26, v31
v_dot2_f32_bf16 v28, v123, v27, v28
v_dot2_f32_bf16 v29, v127, v27, v29
v_dot2_f32_bf16 v30, v131, v27, v30
v_dot2_f32_bf16 v31, v135, v27, v31
buffer_load_dwordx4 v[120:123], v2, s[52:55], s12 offen offset:0 nt
buffer_load_dwordx4 v[124:127], v2, s[52:55], s12 offen offset:1024 nt
buffer_load_dwordx4 v[128:131], v2, s[52:55], s12 offen offset:2048 nt
buffer_load_dwordx4 v[132:135], v2, s[52:55], s12 offen offset:3072 nt
s_add_u32 s13, s13, 24576
s_min_u32 s12, s13, 2146435072
s_cmp_ge_u32 s80, 36
s_cbranch_scc1 L_nodma_5
s_mov_b32 m0, s15
s_nop 0
buffer_load_dwordx4 v2, s[60:63], s15 offen  lds
s_add_u32 s15, s15, 1024
L_nodma_5:
s_add_u32 s80, s80, 1
v_add_f32_dpp v32, v28, v28 row_ror:8 row_mask:0xf bank_mask:0x3
v_add_f32_dpp v33, v29, v29 row_ror:8 row_mask:0xf bank_mask:0x3
v_add_f32_dpp v32, v30, v30 row_ror:8 row_mask:0xf bank_mask:0xc
v_add_f32_dpp v33, v31, v31 row_ror:8 row_mask:0xf bank_mask:0xc
s_nop 0
v_add_f32_dpp v34, v32, v32 row_half_mirror row_mask:0xf bank_mask:0x5
v_add_f32_dpp v34, v33, v33 row_half_mirror row_mask:0xf bank_mask:0xa
s_nop 1
v_add_f32_dpp v34, v34, v34 quad_perm:[1,0,3,2] row_mask:0xf bank_mask:0xf
s_nop 1
v_add_f32_dpp v34, v34, v34 quad_perm:[2,3,0,1] row_mask:0xf bank_mask:0xf
v_cndmask_b32 v86, v86, v34, s[72:73]
s_waitcnt vmcnt(28)
v_dot2_f32_bf16 v28, v136, v24, 0
v_dot2_f32_bf16 v29, v140, v24, 0
v_dot2_f32_bf16 v30, v144, v24, 0
v_dot2_f32_bf16 v31, v148, v24, 0
v_dot2_f32_bf16 v28, v137, v25, v28
v_dot2_f32_bf16 v29, v141, v25, v29
v_dot2_f32_bf16 v30, v145, v25, v30
v_dot2_f32_bf16 v31, v149, v25, v31
v_dot2_f32_bf16 v28, v138, v26, v28
v_dot2_f32_bf16 v29, v142, v26, v29
v_dot2_f32_bf16 v30, v146, v26, v30
v_dot2_f32_bf16 v31, v150, v26, v31
v_dot2_f32_bf16 v28, v139, v27, v28
v_dot2_f32_bf16 v29, v143, v27, v29
v_dot2_f32_bf16 v30, v147, v27, v30
v_dot2_f32_bf16 v31, v151, v27, v31
buffer_load_dwordx4 v[136:139], v2, s[52:55], s12 offen offset:0 nt
buffer_load_dwordx4 v[140:143], v2, s[52:55], s12 offen offset:1024 nt
buffer_load_dwordx4 v[144:147], v2, s[52:55], s12 offen offset:2048 nt
buffer_load_dwordx4 v[148:151], v2, s[52:55], s12 offen offset:3072 nt
s_add_u32 s13, s13, 24576
s_min_u32 s12, s13, 2146435072
s_cmp_ge_u32 s80, 36
s_cbranch_scc1 L_nodma_6
s_mov_b32 m0, s15
s_nop 0
buffer_load_dwordx4 v2, s[60:63], s15 offen  lds
s_add_u32 s15, s15, 1024
L_nodma_6:
s_add_u32 s80, s80, 1
v_add_f32_dpp v32, v28, v28 row_ror:8 row_mask:0xf bank_mask:0x3
v_add_f32_dpp v33, v29, v29 row_ror:8 row_mask:0xf bank_mask:0x3
v_add_f32_dpp v32, v30, v30 row_ror:8 row_mask:0xf bank_mask:0xc
v_add_f32_dpp v33, v31, v31 row_ror:8 row_mask:0xf bank_mask:0xc
s_nop 0
v_add_f32_dpp v34, v32, v32 row_half_mirror row_mask:0xf bank_mask:0x5
v_add_f32_dpp v34, v33, v33 row_half_mirror row_mask:0xf bank_mask:0xa
s_nop 1
v_add_f32_dpp v34, v34, v34 quad_perm:[1,0,3,2] row_mask:0xf bank_mask:0xf
s_nop 1
v_add_f32_dpp v34, v34, v34 quad_perm:[2,3,0,1] row_mask:0xf bank_mask:0xf
v_cndmask_b32 v86, v86, v34, s[74:75]
s_waitcnt vmcnt(28)
v_dot2_f32_bf16 v28, v152, v24, 0
v_dot2_f32_bf16 v29, v156, v24, 0
v_dot2_f32_bf16 v30, v160, v24, 0
v_dot2_f32_bf16 v31, v164, v24, 0
v_dot2_f32_bf16 v28, v153, v25, v28
v_dot2_f32_bf16 v29, v157, v25, v29
v_dot2_f32_bf16 v30, v161, v25, v30
v_dot2_f32_bf16 v31, v165, v25, v31
v_dot2_f32_bf16 v28, v154, v26, v28
v_dot2_f32_bf16 v29, v158, v26, v29
v_dot2_f32_bf16 v30, v162, v26, v30
v_dot2_f32_bf16 v31, v166, v26, v31
v_dot2_f32_bf16 v28, v155, v27, v28
v_dot2_f32_bf16 v29, v159, v27, v29
v_dot2_f32_bf16 v30, v163, v27, v30
v_dot2_f32_bf16 v31, v167, v27, v31
buffer_load_dwordx4 v[152:155], v2, s[52:55], s12 offen offset:0 nt
buffer_load_dwordx4 v[156:159], v2, s[52:55], s12 offen offset:1024 nt
buffer_load_dwordx4 v[160:163], v2, s[52:55], s12 offen offset:2048 nt
buffer_load_dwordx4 v[164:167], v2, s[52:55], s12 offen offset:3072 nt
s_add_u32 s13, s13, 24576
s_min_u32 s12, s13, 2146435072
s_cmp_ge_u32 s80, 36
s_cbranch_scc1 L_nodma_7
s_mov_b32 m0, s15
s_nop 0
buffer_load_dwordx4 v2, s[60:63], s15 offen  lds
s_add_u32 s15, s15, 1024
L_nodma_7:
s_add_u32 s80, s80, 1
v_add_f32_dpp v32, v28, v28 row_ror:8 row_mask:0xf bank_mask:0x3
v_add_f32_dpp v33, v29, v29 row_ror:8 row_mask:0xf bank_mask:0x3
v_add_f32_dpp v32, v30, v30 row_ror:8 row_mask:0xf bank_mask:0xc
v_add_f32_dpp v33, v31, v31 row_ror:8 row_mask:0xf bank_mask:0xc
s_nop 0
v_add_f32_dpp v34, v32, v32 row_half_mirror row_mask:0xf bank_mask:0x5
v_add_f32_dpp v34, v33, v33 row_half_mirror row_mask:0xf bank_mask:0xa
s_nop 1
v_add_f32_dpp v34, v34, v34 quad_perm:[1,0,3,2] row_mask:0xf bank_mask:0xf
s_nop 1
v_add_f32_dpp v34, v34, v34 quad_perm:[2,3,0,1] row_mask:0xf bank_mask:0xf
v_cndmask_b32 v86, v86, v34, s[76:77]
s_waitcnt vmcnt(28)
v_dot2_f32_bf16 v28, v168, v24, 0
v_dot2_f32_bf16 v29, v172, v24, 0
v_dot2_f32_bf16 v30, v176, v24, 0
v_dot2_f32_bf16 v31, v180, v24, 0
v_dot2_f32_bf16 v28, v169, v25, v28
v_dot2_f32_bf16 v29, v173, v25, v29
v_dot2_f32_bf16 v30, v177, v25, v30
v_dot2_f32_bf16 v31, v181, v25, v31
v_dot2_f32_bf16 v28, v170, v26, v28
v_dot2_f32_bf16 v29, v174, v26, v29
v_dot2_f32_bf16 v30, v178, v26, v30
v_dot2_f32_bf16 v31, v182, v26, v31
v_dot2_f32_bf16 v28, v171, v27, v28
v_dot2_f32_bf16 v29, v175, v27, v29
v_dot2_f32_bf16 v30, v179, v27, v30
v_dot2_f32_bf16 v31, v183, v27, v31
buffer_load_dwordx4 v[168:171], v2, s[52:55], s12 offen offset:0 nt
buffer_load_dwordx4 v[172:175], v2, s[52:55], s12 offen offset:1024 nt
buffer_load_dwordx4 v[176:179], v2, s[52:55], s12 offen offset:2048 nt
buffer_load_dwordx4 v[180:183], v2, s[52:55], s12 offen offset:3072 nt
s_add_u32 s13, s13, 24576
s_min_u32 s12, s13, 2146435072
s_cmp_ge_u32 s80, 36
s_cbranch_scc1 L_nodma_8
s_mov_b32 m0, s15
s_nop 0
buffer_load_dwordx4 v2, s[60:63], s15 offen  lds
s_add_u32 s15, s15, 1024
L_nodma_8:
s_add_u32 s80, s80, 1
v_add_f32_dpp v32, v28, v28 row_ror:8 row_mask:0xf bank_mask:0x3
v_add_f32_dpp v33, v29, v29 row_ror:8 row_mask:0xf bank_mask:0x3
v_add_f32_dpp v32, v30, v30 row_ror:8 row_mask:0xf bank_mask:0xc
v_add_f32_dpp v33, v31, v31 row_ror:8 row_mask:0xf bank_mask:0xc
s_nop 0
v_add_f32_dpp v34, v32, v32 row_half_mirror row_mask:0xf bank_mask:0x5
v_add_f32_dpp v34, v33, v33 row_half_mirror row_mask:0xf bank_mask:0xa
s_nop 1
v_add_f32_dpp v34, v34, v34 quad_perm:[1,0,3,2] row_mask:0xf bank_mask:0xf
s_nop 1
v_add_f32_dpp v34, v34, v34 quad_perm:[2,3,0,1] row_mask:0xf bank_mask:0xf
v_cndmask_b32 v86, v86, v34, s[78:79]
s_add_u32 s81, s81, 1
s_cmp_eq_u32 s81, 11
s_cbranch_scc1 A_mid
v_mov_b32 v76, v77
v_mov_b32 v77, v78
v_mov_b32 v78, v79
v_mov_b32 v79, v80
v_mov_b32 v80, v81
v_mov_b32 v81, v82
v_mov_b32 v82, v83
v_mov_b32 v83, v84
v_mov_b32 v84, v85
v_mov_b32 v85, v86
s_lshr_b64 s[72:73], s[76:77], 2
s_lshr_b64 s[74:75], s[76:77], 1
s_cmp_eq_u32 s81, 9
s_cselect_b32 s52, s56, s52
s_cselect_b32 s53, s57, s53
s_cselect_b32 s13, s14, s13
s_min_u32 s12, s13, 2146435072
s_waitcnt vmcnt(28)
v_dot2_f32_bf16 v28, v184, v24, 0
v_dot2_f32_bf16 v29, v188, v24, 0
v_dot2_f32_bf16 v30, v192, v24, 0
v_dot2_f32_bf16 v31, v196, v24, 0
v_dot2_f32_bf16 v28, v185, v25, v28
v_dot2_f32_bf16 v29, v189, v25, v29
v_dot2_f32_bf16 v30, v193, v25, v30
v_dot2_f32_bf16 v31, v197, v25, v31
v_dot2_f32_bf16 v28, v186, v26, v28
v_dot2_f32_bf16 v29, v190, v26, v29
v_dot2_f32_bf16 v30, v194, v26, v30
v_dot2_f32_bf16 v31, v198, v26, v31
v_dot2_f32_bf16 v28, v187, v27, v28
v_dot2_f32_bf16 v29, v191, v27, v29
v_dot2_f32_bf16 v30, v195, v27, v30
v_dot2_f32_bf16 v31, v199, v27, v31
buffer_load_dwordx4 v[184:187], v2, s[52:55], s12 offen offset:0 nt
buffer_load_dwordx4 v[188:191], v2, s[52:55], s12 offen offset:1024 nt
buffer_load_dwordx4 v[192:195], v2, s[52:55], s12 offen offset:2048 nt
buffer_load_dwordx4 v[196:199], v2, s[52:55], s12 offen offset:3072 nt
s_add_u32 s13, s13, 24576
s_min_u32 s12, s13, 2146435072
s_cmp_ge_u32 s80, 36
s_cbranch_scc1 L_nodma_9
s_mov_b32 m0, s15
s_nop 0
buffer_load_dwordx4 v2, s[60:63], s15 offen  lds
s_add_u32 s15, s15, 1024
L_nodma_9:
s_add_u32 s80, s80, 1
v_add_f32_dpp v32, v28, v28 row_ror:8 row_mask:0xf bank_mask:0x3
v_add_f32_dpp v33, v29, v29 row_ror:8 row_mask:0xf bank_mask:0x3
v_add_f32_dpp v32, v30, v30 row_ror:8 row_mask:0xf bank_mask:0xc
v_add_f32_dpp v33, v31, v31 row_ror:8 row_mask:0xf bank_mask:0xc
s_nop 0
v_add_f32_dpp v34, v32, v32 row_half_mirror row_mask:0xf bank_mask:0x5
v_add_f32_dpp v34, v33, v33 row_half_mirror row_mask:0xf bank_mask:0xa
s_nop 1
v_add_f32_dpp v34, v34, v34 quad_perm:[1,0,3,2] row_mask:0xf bank_mask:0xf
s_nop 1
v_add_f32_dpp v34, v34, v34 quad_perm:[2,3,0,1] row_mask:0xf bank_mask:0xf
v_cndmask_b32 v86, v86, v34, s[72:73]
s_waitcnt vmcnt(28)
v_dot2_f32_bf16 v28, v200, v24, 0
v_dot2_f32_bf16 v29, v204, v24, 0
v_dot2_f32_bf16 v30, v208, v24, 0
v_dot2_f32_bf16 v31, v212, v24, 0
v_dot2_f32_bf16 v28, v201, v25, v28
v_dot2_f32_bf16 v29, v205, v25, v29
v_dot2_f32_bf16 v30, v209, v25, v30
v_dot2_f32_bf16 v31, v213, v25, v31
v_dot2_f32_bf16 v28, v202, v26, v28
v_dot2_f32_bf16 v29, v206, v26, v29
v_dot2_f32_bf16 v30, v210, v26, v30
v_dot2_f32_bf16 v31, v214, v26, v31
v_dot2_f32_bf16 v28, v203, v27, v28
v_dot2_f32_bf16 v29, v207, v27, v29
v_dot2_f32_bf16 v30, v211, v27, v30
v_dot2_f32_bf16 v31, v215, v27, v31
buffer_load_dwordx4 v[200:203], v2, s[52:55], s12 offen offset:0 nt
buffer_load_dwordx4 v[204:207], v2, s[52:55], s12 offen offset:1024 nt
buffer_load_dwordx4 v[208:211], v2, s[52:55], s12 offen offset:2048 nt
buffer_load_dwordx4 v[212:215], v2, s[52:55], s12 offen offset:3072 nt
s_add_u32 s13, s13, 24576
s_min_u32 s12, s13, 2146435072
s_cmp_ge_u32 s80, 36
s_cbranch_scc1 L_nodma_10
s_mov_b32 m0, s15
s_nop 0
buffer_load_dwordx4 v2, s[60:63], s15 offen  lds
s_add_u32 s15, s15, 1024
L_nodma_10:
s_add_u32 s80, s80, 1
v_add_f32_dpp v32, v28, v28 row_ror:8 row_mask:0xf bank_mask:0x3
v_add_f32_dpp v33, v29, v29 row_ror:8 row_mask:0xf bank_mask:0x3
v_add_f32_dpp v32, v30, v30 row_ror:8 row_mask:0xf bank_mask:0xc
v_add_f32_dpp v33, v31, v31 row_ror:8 row_mask:0xf bank_mask:0xc
s_nop 0
v_add_f32_dpp v34, v32, v32 row_half_mirror row_mask:0xf bank_mask:0x5
v_add_f32_dpp v34, v33, v33 row_half_mirror row_mask:0xf bank_mask:0xa
s_nop 1
v_add_f32_dpp v34, v34, v34 quad_perm:[1,0,3,2] row_mask:0xf bank_mask:0xf
s_nop 1
v_add_f32_dpp v34, v34, v34 quad_perm:[2,3,0,1] row_mask:0xf bank_mask:0xf
v_cndmask_b32 v86, v86, v34, s[74:75]
s_waitcnt vmcnt(28)
v_dot2_f32_bf16 v28, v216, v24, 0
v_dot2_f32_bf16 v29, v220, v24, 0
v_dot2_f32_bf16 v30, v224, v24, 0
v_dot2_f32_bf16 v31, v228, v24, 0
v_dot2_f32_bf16 v28, v217, v25, v28
v_dot2_f32_bf16 v29, v221, v25, v29
v_dot2_f32_bf16 v30, v225, v25, v30
v_dot2_f32_bf16 v31, v229, v25, v31
v_dot2_f32_bf16 v28, v218, v26, v28
v_dot2_f32_bf16 v29, v222, v26, v29
v_dot2_f32_bf16 v30, v226, v26, v30
v_dot2_f32_bf16 v31, v230, v26, v31
v_dot2_f32_bf16 v28, v219, v27, v28
v_dot2_f32_bf16 v29, v223, v27, v29
v_dot2_f32_bf16 v30, v227, v27, v30
v_dot2_f32_bf16 v31, v231, v27, v31
buffer_load_dwordx4 v[216:219], v2, s[52:55], s12 offen offset:0 nt
buffer_load_dwordx4 v[220:223], v2, s[52:55], s12 offen offset:1024 nt
buffer_load_dwordx4 v[224:227], v2, s[52:55], s12 offen offset:2048 nt
buffer_load_dwordx4 v[228:231], v2, s[52:55], s12 offen offset:3072 nt
s_add_u32 s13, s13, 24576
s_min_u32 s12, s13, 2146435072
s_cmp_ge_u32 s80, 36
s_cbranch_scc1 L_nodma_11
s_mov_b32 m0, s15
s_nop 0
buffer_load_dwordx4 v2, s[60:63], s15 offen  lds
s_add_u32 s15, s15, 1024
L_nodma_11:
s_add_u32 s80, s80, 1
v_add_f32_dpp v32, v28, v28 row_ror:8 row_mask:0xf bank_mask:0x3
v_add_f32_dpp v33, v29, v29 row_ror:8 row_mask:0xf bank_mask:0x3
v_add_f32_dpp v32, v30, v30 row_ror:8 row_mask:0xf bank_mask:0xc
v_add_f32_dpp v33, v31, v31 row_ror:8 row_mask:0xf bank_mask:0xc
s_nop 0
v_add_f32_dpp v34, v32, v32 row_half_mirror row_mask:0xf bank_mask:0x5
v_add_f32_dpp v34, v33, v33 row_half_mirror row_mask:0xf bank_mask:0xa
s_nop 1
v_add_f32_dpp v34, v34, v34 quad_perm:[1,0,3,2] row_mask:0xf bank_mask:0xf
s_nop 1
v_add_f32_dpp v34, v34, v34 quad_perm:[2,3,0,1] row_mask:0xf bank_mask:0xf
v_cndmask_b32 v86, v86, v34, s[76:77]
s_waitcnt vmcnt(28)
v_dot2_f32_bf16 v28, v232, v24, 0
v_dot2_f32_bf16 v29, v236, v24, 0
v_dot2_f32_bf16 v30, v240, v24, 0
v_dot2_f32_bf16 v31, v244, v24, 0
v_dot2_f32_bf16 v28, v233, v25, v28
v_dot2_f32_bf16 v29, v237, v25, v29
v_dot2_f32_bf16 v30, v241, v25, v30
v_dot2_f32_bf16 v31, v245, v25, v31
v_dot2_f32_bf16 v28, v234, v26, v28
v_dot2_f32_bf16 v29, v238, v26, v29
v_dot2_f32_bf16 v30, v242, v26, v30
v_dot2_f32_bf16 v31, v246, v26, v31
v_dot2_f32_bf16 v28, v235, v27, v28
v_dot2_f32_bf16 v29, v239, v27, v29
v_dot2_f32_bf16 v30, v243, v27, v30
v_dot2_f32_bf16 v31, v247, v27, v31
buffer_load_dwordx4 v[232:235], v2, s[52:55], s12 offen offset:0 nt
buffer_load_dwordx4 v[236:239], v2, s[52:55], s12 offen offset:1024 nt
buffer_load_dwordx4 v[240:243], v2, s[52:55], s12 offen offset:2048 nt
buffer_load_dwordx4 v[244:247], v2, s[52:55], s12 offen offset:3072 nt
s_add_u32 s13, s13, 24576
s_min_u32 s12, s13, 2146435072
s_cmp_ge_u32 s80, 36
s_cbranch_scc1 L_nodma_12
s_mov_b32 m0, s15
s_nop 0
buffer_load_dwordx4 v2, s[60:63], s15 offen  lds
s_add_u32 s15, s15, 1024
L_nodma_12:
s_add_u32 s80, s80, 1
v_add_f32_dpp v32, v28, v28 row_ror:8 row_mask:0xf bank_mask:0x3
v_add_f32_dpp v33, v29, v29 row_ror:8 row_mask:0xf bank_mask:0x3
v_add_f32_dpp v32, v30, v30 row_ror:8 row_mask:0xf bank_mask:0xc
v_add_f32_dpp v33, v31, v31 row_ror:8 row_mask:0xf bank_mask:0xc
s_nop 0
v_add_f32_dpp v34, v32, v32 row_half_mirror row_mask:0xf bank_mask:0x5
v_add_f32_dpp v34, v33, v33 row_half_mirror row_mask:0xf bank_mask:0xa
s_nop 1
v_add_f32_dpp v34, v34, v34 quad_perm:[1,0,3,2] row_mask:0xf bank_mask:0xf
s_nop 1
v_add_f32_dpp v34, v34, v34 quad_perm:[2,3,0,1] row_mask:0xf bank_mask:0xf
v_cndmask_b32 v86, v86, v34, s[78:79]
s_add_u32 s81, s81, 1
v_mov_b32 v76, v77
v_mov_b32 v77, v78
v_mov_b32 v78, v79
v_mov_b32 v79, v80
v_mov_b32 v80, v81
v_mov_b32 v81, v82
v_mov_b32 v82, v83
v_mov_b32 v83, v84
v_mov_b32 v84, v85
v_mov_b32 v85, v86
s_branch K_loop
A_mid:
v_max3_f32 v35, v76, v77, v78
v_max3_f32 v35, v35, v79, v80
v_max3_f32 v35, v35, v81, v82
v_max3_f32 v35, v35, v83, v84
v_max3_f32 v35, v35, v85, v86
s_nop 1
v_max_f32_dpp v35, v35, v35 row_ror:8 row_mask:0xf bank_mask:0xf
s_nop 1
v_max_f32_dpp v35, v35, v35 row_ror:4 row_mask:0xf bank_mask:0xf
s_nop 1
v_max_f32_dpp v35, v35, v35 row_ror:2 row_mask:0xf bank_mask:0xf
s_nop 1
v_max_f32_dpp v35, v35, v35 row_ror:1 row_mask:0xf bank_mask:0xf
v_mov_b32 v36, v35
s_nop 1
v_permlane16_swap_b32 v35, v36
v_max_f32 v35, v35, v36
v_mov_b32 v36, v35
s_nop 1
v_permlane32_swap_b32 v35, v36
v_max_f32 v35, v35, v36
v_mul_f32 v32, v35, v7
v_fma_f32 v76, v76, v7, -v32
v_fma_f32 v77, v77, v7, -v32
v_fma_f32 v78, v78, v7, -v32
v_fma_f32 v79, v79, v7, -v32
v_fma_f32 v80, v80, v7, -v32
v_fma_f32 v81, v81, v7, -v32
v_fma_f32 v82, v82, v7, -v32
v_fma_f32 v83, v83, v7, -v32
v_fma_f32 v84, v84, v7, -v32
v_fma_f32 v85, v85, v7, -v32
v_fma_f32 v86, v86, v7, -v32
v_exp_f32 v76, v76
v_exp_f32 v77, v77
v_exp_f32 v78, v78
v_exp_f32 v79, v79
v_exp_f32 v80, v80
v_exp_f32 v81, v81
v_exp_f32 v82, v82
v_exp_f32 v83, v83
v_exp_f32 v84, v84
v_exp_f32 v85, v85
v_exp_f32 v86, v86
v_add_f32 v35, v76, v77
v_add_f32 v35, v35, v78
v_add_f32 v35, v35, v79
v_add_f32 v35, v35, v80
v_add_f32 v35, v35, v81
v_add_f32 v35, v35, v82
v_add_f32 v35, v35, v83
v_add_f32 v35, v35, v84
v_add_f32 v35, v35, v85
v_add_f32 v35, v35, v86
v_cvt_pk_bf16_f32 v76, v76, v76
v_cvt_pk_bf16_f32 v77, v77, v77
v_cvt_pk_bf16_f32 v78, v78, v78
v_cvt_pk_bf16_f32 v79, v79, v79
v_cvt_pk_bf16_f32 v80, v80, v80
v_cvt_pk_bf16_f32 v81, v81, v81
v_cvt_pk_bf16_f32 v82, v82, v82
v_cvt_pk_bf16_f32 v83, v83, v83
v_cvt_pk_bf16_f32 v84, v84, v84
v_cvt_pk_bf16_f32 v85, v85, v85
v_cvt_pk_bf16_f32 v86, v86, v86
v_add_f32_dpp v35, v35, v35 row_ror:8 row_mask:0xf bank_mask:0xf
s_nop 1
v_add_f32_dpp v35, v35, v35 row_ror:4 row_mask:0xf bank_mask:0xf
s_nop 1
v_add_f32_dpp v35, v35, v35 row_ror:2 row_mask:0xf bank_mask:0xf
s_nop 1
v_add_f32_dpp v35, v35, v35 row_ror:1 row_mask:0xf bank_mask:0xf
v_mov_b32 v36, v35
s_nop 1
v_permlane16_swap_b32 v35, v36
v_add_f32 v35, v35, v36
v_mov_b32 v36, v35
s_nop 1
v_permlane32_swap_b32 v35, v36
v_add_f32 v35, v35, v36
v_min_u32 v32, -2, v32
v_min_u32 v33, -2, v35
s_mov_b32 s7, 400000
L_ens_13:
v_readfirstlane_b32 s6, v96
s_cmp_ge_u32 s6, 128
s_cbranch_scc1 L_ensd_14
s_sleep 16
buffer_load_dword v96, off, s[68:71], 0 offset:0 sc1
s_waitcnt vmcnt(0)
s_sub_u32 s7, s7, 1
s_cmp_lg_u32 s7, 0
s_cbranch_scc1 L_ens_13
L_ensd_14:
s_lshl_b32 s6, s11, 3
s_add_u32 s6, s6, s82
s_mov_b64 exec, 1
buffer_store_dwordx2 v[32:33], off, s[64:67], s6 sc1
s_mov_b64 exec, -1
v_and_b32_dpp v60, v78, v8 row_newbcast:0 row_mask:0xf bank_mask:0xf
v_and_b32_dpp v61, v78, v9 row_newbcast:0 row_mask:0xf bank_mask:0xf
v_and_b32_dpp v62, v78, v10 row_newbcast:0 row_mask:0xf bank_mask:0xf
v_and_b32_dpp v63, v78, v11 row_newbcast:0 row_mask:0xf bank_mask:0xf
v_and_b32_dpp v64, v78, v8 row_newbcast:4 row_mask:0xf bank_mask:0xf
v_and_b32_dpp v65, v78, v9 row_newbcast:4 row_mask:0xf bank_mask:0xf
v_and_b32_dpp v66, v78, v10 row_newbcast:4 row_mask:0xf bank_mask:0xf
v_and_b32_dpp v67, v78, v11 row_newbcast:4 row_mask:0xf bank_mask:0xf
v_and_b32_dpp v68, v78, v8 row_newbcast:8 row_mask:0xf bank_mask:0xf
v_and_b32_dpp v69, v78, v9 row_newbcast:8 row_mask:0xf bank_mask:0xf
v_and_b32_dpp v70, v78, v10 row_newbcast:8 row_mask:0xf bank_mask:0xf
v_and_b32_dpp v71, v78, v11 row_newbcast:8 row_mask:0xf bank_mask:0xf
v_and_b32_dpp v72, v78, v8 row_newbcast:12 row_mask:0xf bank_mask:0xf
v_and_b32_dpp v73, v78, v9 row_newbcast:12 row_mask:0xf bank_mask:0xf
v_and_b32_dpp v74, v78, v10 row_newbcast:12 row_mask:0xf bank_mask:0xf
v_and_b32_dpp v75, v78, v11 row_newbcast:12 row_mask:0xf bank_mask:0xf
s_waitcnt vmcnt(29)
v_mfma_f32_16x16x32_bf16 v[20:23], v[60:63], v[184:187], v[20:23]
v_mfma_f32_16x16x32_bf16 v[20:23], v[64:67], v[188:191], v[20:23]
v_mfma_f32_16x16x32_bf16 v[20:23], v[68:71], v[192:195], v[20:23]
v_mfma_f32_16x16x32_bf16 v[20:23], v[72:75], v[196:199], v[20:23]
v_add_u32 v117, 1, v117
buffer_store_dword v117, v118, s[64:67], 0 offen
buffer_load_dwordx4 v[184:187], v2, s[52:55], s12 offen offset:0 nt
buffer_load_dwordx4 v[188:191], v2, s[52:55], s12 offen offset:1024 nt
buffer_load_dwordx4 v[192:195], v2, s[52:55], s12 offen offset:2048 nt
buffer_load_dwordx4 v[196:199], v2, s[52:55], s12 offen offset:3072 nt
s_add_u32 s13, s13, 24576
s_min_u32 s12, s13, 2146435072
v_and_b32_dpp v60, v78, v8 row_newbcast:1 row_mask:0xf bank_mask:0xf
v_and_b32_dpp v61, v78, v9 row_newbcast:1 row_mask:0xf bank_mask:0xf
v_and_b32_dpp v62, v78, v10 row_newbcast:1 row_mask:0xf bank_mask:0xf
v_and_b32_dpp v63, v78, v11 row_newbcast:1 row_mask:0xf bank_mask:0xf
v_and_b32_dpp v64, v78, v8 row_newbcast:5 row_mask:0xf bank_mask:0xf
v_and_b32_dpp v65, v78, v9 row_newbcast:5 row_mask:0xf bank_mask:0xf
v_and_b32_dpp v66, v78, v10 row_newbcast:5 row_mask:0xf bank_mask:0xf
v_and_b32_dpp v67, v78, v11 row_newbcast:5 row_mask:0xf bank_mask:0xf
v_and_b32_dpp v68, v78, v8 row_newbcast:9 row_mask:0xf bank_mask:0xf
v_and_b32_dpp v69, v78, v9 row_newbcast:9 row_mask:0xf bank_mask:0xf
v_and_b32_dpp v70, v78, v10 row_newbcast:9 row_mask:0xf bank_mask:0xf
v_and_b32_dpp v71, v78, v11 row_newbcast:9 row_mask:0xf bank_mask:0xf
v_and_b32_dpp v72, v78, v8 row_newbcast:13 row_mask:0xf bank_mask:0xf
v_and_b32_dpp v73, v78, v9 row_newbcast:13 row_mask:0xf bank_mask:0xf
v_and_b32_dpp v74, v78, v10 row_newbcast:13 row_mask:0xf bank_mask:0xf
v_and_b32_dpp v75, v78, v11 row_newbcast:13 row_mask:0xf bank_mask:0xf
s_waitcnt vmcnt(30)
v_mfma_f32_16x16x32_bf16 v[20:23], v[60:63], v[200:203], v[20:23]
v_mfma_f32_16x16x32_bf16 v[20:23], v[64:67], v[204:207], v[20:23]
v_mfma_f32_16x16x32_bf16 v[20:23], v[68:71], v[208:211], v[20:23]
v_mfma_f32_16x16x32_bf16 v[20:23], v[72:75], v[212:215], v[20:23]
v_add_u32 v117, 1, v117
buffer_store_dword v117, v118, s[64:67], 0 offen
buffer_load_dwordx4 v[200:203], v2, s[52:55], s12 offen offset:0 nt
buffer_load_dwordx4 v[204:207], v2, s[52:55], s12 offen offset:1024 nt
buffer_load_dwordx4 v[208:211], v2, s[52:55], s12 offen offset:2048 nt
buffer_load_dwordx4 v[212:215], v2, s[52:55], s12 offen offset:3072 nt
s_add_u32 s13, s13, 24576
s_min_u32 s12, s13, 2146435072
v_and_b32_dpp v60, v76, v8 row_newbcast:1 row_mask:0xf bank_mask:0xf
v_and_b32_dpp v61, v76, v9 row_newbcast:1 row_mask:0xf bank_mask:0xf
v_and_b32_dpp v62, v76, v10 row_newbcast:1 row_mask:0xf bank_mask:0xf
v_and_b32_dpp v63, v76, v11 row_newbcast:1 row_mask:0xf bank_mask:0xf
v_and_b32_dpp v64, v76, v8 row_newbcast:5 row_mask:0xf bank_mask:0xf
v_and_b32_dpp v65, v76, v9 row_newbcast:5 row_mask:0xf bank_mask:0xf
v_and_b32_dpp v66, v76, v10 row_newbcast:5 row_mask:0xf bank_mask:0xf
v_and_b32_dpp v67, v76, v11 row_newbcast:5 row_mask:0xf bank_mask:0xf
v_and_b32_dpp v68, v76, v8 row_newbcast:9 row_mask:0xf bank_mask:0xf
v_and_b32_dpp v69, v76, v9 row_newbcast:9 row_mask:0xf bank_mask:0xf
v_and_b32_dpp v70, v76, v10 row_newbcast:9 row_mask:0xf bank_mask:0xf
v_and_b32_dpp v71, v76, v11 row_newbcast:9 row_mask:0xf bank_mask:0xf
v_and_b32_dpp v72, v76, v8 row_newbcast:13 row_mask:0xf bank_mask:0xf
v_and_b32_dpp v73, v76, v9 row_newbcast:13 row_mask:0xf bank_mask:0xf
v_and_b32_dpp v74, v76, v10 row_newbcast:13 row_mask:0xf bank_mask:0xf
v_and_b32_dpp v75, v76, v11 row_newbcast:13 row_mask:0xf bank_mask:0xf
v_mfma_f32_16x16x32_bf16 v[20:23], v[60:63], a[0:3], v[20:23]
v_mfma_f32_16x16x32_bf16 v[20:23], v[64:67], a[4:7], v[20:23]
v_mfma_f32_16x16x32_bf16 v[20:23], v[68:71], a[8:11], v[20:23]
v_mfma_f32_16x16x32_bf16 v[20:23], v[72:75], a[12:15], v[20:23]
s_nop 3
v_and_b32_dpp v60, v78, v8 row_newbcast:2 row_mask:0xf bank_mask:0xf
v_and_b32_dpp v61, v78, v9 row_newbcast:2 row_mask:0xf bank_mask:0xf
v_and_b32_dpp v62, v78, v10 row_newbcast:2 row_mask:0xf bank_mask:0xf
v_and_b32_dpp v63, v78, v11 row_newbcast:2 row_mask:0xf bank_mask:0xf
v_and_b32_dpp v64, v78, v8 row_newbcast:6 row_mask:0xf bank_mask:0xf
v_and_b32_dpp v65, v78, v9 row_newbcast:6 row_mask:0xf bank_mask:0xf
v_and_b32_dpp v66, v78, v10 row_newbcast:6 row_mask:0xf bank_mask:0xf
v_and_b32_dpp v67, v78, v11 row_newbcast:6 row_mask:0xf bank_mask:0xf
v_and_b32_dpp v68, v78, v8 row_newbcast:10 row_mask:0xf bank_mask:0xf
v_and_b32_dpp v69, v78, v9 row_newbcast:10 row_mask:0xf bank_mask:0xf
v_and_b32_dpp v70, v78, v10 row_newbcast:10 row_mask:0xf bank_mask:0xf
v_and_b32_dpp v71, v78, v11 row_newbcast:10 row_mask:0xf bank_mask:0xf
v_and_b32_dpp v72, v78, v8 row_newbcast:14 row_mask:0xf bank_mask:0xf
v_and_b32_dpp v73, v78, v9 row_newbcast:14 row_mask:0xf bank_mask:0xf
v_and_b32_dpp v74, v78, v10 row_newbcast:14 row_mask:0xf bank_mask:0xf
v_and_b32_dpp v75, v78, v11 row_newbcast:14 row_mask:0xf bank_mask:0xf
s_waitcnt vmcnt(31)
v_mfma_f32_16x16x32_bf16 v[20:23], v[60:63], v[216:219], v[20:23]
v_mfma_f32_16x16x32_bf16 v[20:23], v[64:67], v[220:223], v[20:23]
v_mfma_f32_16x16x32_bf16 v[20:23], v[68:71], v[224:227], v[20:23]
v_mfma_f32_16x16x32_bf16 v[20:23], v[72:75], v[228:231], v[20:23]
v_add_u32 v117, 1, v117
buffer_store_dword v117, v118, s[64:67], 0 offen
buffer_load_dwordx4 v[216:219], v2, s[52:55], s12 offen offset:0 nt
buffer_load_dwordx4 v[220:223], v2, s[52:55], s12 offen offset:1024 nt
buffer_load_dwordx4 v[224:227], v2, s[52:55], s12 offen offset:2048 nt
buffer_load_dwordx4 v[228:231], v2, s[52:55], s12 offen offset:3072 nt
s_add_u32 s13, s13, 24576
s_min_u32 s12, s13, 2146435072
v_and_b32_dpp v60, v78, v8 row_newbcast:3 row_mask:0xf bank_mask:0xf
v_and_b32_dpp v61, v78, v9 row_newbcast:3 row_mask:0xf bank_mask:0xf
v_and_b32_dpp v62, v78, v10 row_newbcast:3 row_mask:0xf bank_mask:0xf
v_and_b32_dpp v63, v78, v11 row_newbcast:3 row_mask:0xf bank_mask:0xf
v_and_b32_dpp v64, v78, v8 row_newbcast:7 row_mask:0xf bank_mask:0xf
v_and_b32_dpp v65, v78, v9 row_newbcast:7 row_mask:0xf bank_mask:0xf
v_and_b32_dpp v66, v78, v10 row_newbcast:7 row_mask:0xf bank_mask:0xf
v_and_b32_dpp v67, v78, v11 row_newbcast:7 row_mask:0xf bank_mask:0xf
v_and_b32_dpp v68, v78, v8 row_newbcast:11 row_mask:0xf bank_mask:0xf
v_and_b32_dpp v69, v78, v9 row_newbcast:11 row_mask:0xf bank_mask:0xf
v_and_b32_dpp v70, v78, v10 row_newbcast:11 row_mask:0xf bank_mask:0xf
v_and_b32_dpp v71, v78, v11 row_newbcast:11 row_mask:0xf bank_mask:0xf
v_and_b32_dpp v72, v78, v8 row_newbcast:15 row_mask:0xf bank_mask:0xf
v_and_b32_dpp v73, v78, v9 row_newbcast:15 row_mask:0xf bank_mask:0xf
v_and_b32_dpp v74, v78, v10 row_newbcast:15 row_mask:0xf bank_mask:0xf
v_and_b32_dpp v75, v78, v11 row_newbcast:15 row_mask:0xf bank_mask:0xf
s_waitcnt vmcnt(32)
v_mfma_f32_16x16x32_bf16 v[20:23], v[60:63], v[232:235], v[20:23]
v_mfma_f32_16x16x32_bf16 v[20:23], v[64:67], v[236:239], v[20:23]
v_mfma_f32_16x16x32_bf16 v[20:23], v[68:71], v[240:243], v[20:23]
v_mfma_f32_16x16x32_bf16 v[20:23], v[72:75], v[244:247], v[20:23]
v_add_u32 v117, 1, v117
buffer_store_dword v117, v118, s[64:67], 0 offen
buffer_load_dwordx4 v[232:235], v2, s[52:55], s12 offen offset:0 nt
buffer_load_dwordx4 v[236:239], v2, s[52:55], s12 offen offset:1024 nt
buffer_load_dwordx4 v[240:243], v2, s[52:55], s12 offen offset:2048 nt
buffer_load_dwordx4 v[244:247], v2, s[52:55], s12 offen offset:3072 nt
s_add_u32 s13, s13, 24576
s_min_u32 s12, s13, 2146435072
s_barrier
ds_read_b64_tr_b16 a[96:97], v88 offset:0
ds_read_b64_tr_b16 a[98:99], v88 offset:4608
ds_read_b64_tr_b16 a[100:101], v88 offset:36864
ds_read_b64_tr_b16 a[102:103], v88 offset:41472
v_and_b32_dpp v60, v79, v8 row_newbcast:0 row_mask:0xf bank_mask:0xf
v_and_b32_dpp v61, v79, v9 row_newbcast:0 row_mask:0xf bank_mask:0xf
v_and_b32_dpp v62, v79, v10 row_newbcast:0 row_mask:0xf bank_mask:0xf
v_and_b32_dpp v63, v79, v11 row_newbcast:0 row_mask:0xf bank_mask:0xf
v_and_b32_dpp v64, v79, v8 row_newbcast:4 row_mask:0xf bank_mask:0xf
v_and_b32_dpp v65, v79, v9 row_newbcast:4 row_mask:0xf bank_mask:0xf
v_and_b32_dpp v66, v79, v10 row_newbcast:4 row_mask:0xf bank_mask:0xf
v_and_b32_dpp v67, v79, v11 row_newbcast:4 row_mask:0xf bank_mask:0xf
v_and_b32_dpp v68, v79, v8 row_newbcast:8 row_mask:0xf bank_mask:0xf
v_and_b32_dpp v69, v79, v9 row_newbcast:8 row_mask:0xf bank_mask:0xf
v_and_b32_dpp v70, v79, v10 row_newbcast:8 row_mask:0xf bank_mask:0xf
v_and_b32_dpp v71, v79, v11 row_newbcast:8 row_mask:0xf bank_mask:0xf
v_and_b32_dpp v72, v79, v8 row_newbcast:12 row_mask:0xf bank_mask:0xf
v_and_b32_dpp v73, v79, v9 row_newbcast:12 row_mask:0xf bank_mask:0xf
v_and_b32_dpp v74, v79, v10 row_newbcast:12 row_mask:0xf bank_mask:0xf
v_and_b32_dpp v75, v79, v11 row_newbcast:12 row_mask:0xf bank_mask:0xf
s_waitcnt vmcnt(33)
v_mfma_f32_16x16x32_bf16 v[20:23], v[60:63], v[120:123], v[20:23]
v_mfma_f32_16x16x32_bf16 v[20:23], v[64:67], v[124:127], v[20:23]
v_mfma_f32_16x16x32_bf16 v[20:23], v[68:71], v[128:131], v[20:23]
v_mfma_f32_16x16x32_bf16 v[20:23], v[72:75], v[132:135], v[20:23]
v_add_u32 v117, 1, v117
buffer_store_dword v117, v118, s[64:67], 0 offen
buffer_load_dwordx4 v[120:123], v2, s[52:55], s12 offen offset:0 nt
buffer_load_dwordx4 v[124:127], v2, s[52:55], s12 offen offset:1024 nt
buffer_load_dwordx4 v[128:131], v2, s[52:55], s12 offen offset:2048 nt
buffer_load_dwordx4 v[132:135], v2, s[52:55], s12 offen offset:3072 nt
s_add_u32 s13, s13, 24576
s_min_u32 s12, s13, 2146435072
ds_read_b64_tr_b16 a[104:105], v90 offset:0
ds_read_b64_tr_b16 a[106:107], v90 offset:4608
ds_read_b64_tr_b16 a[108:109], v90 offset:36864
ds_read_b64_tr_b16 a[110:111], v90 offset:41472
v_and_b32_dpp v60, v79, v8 row_newbcast:1 row_mask:0xf bank_mask:0xf
v_and_b32_dpp v61, v79, v9 row_newbcast:1 row_mask:0xf bank_mask:0xf
v_and_b32_dpp v62, v79, v10 row_newbcast:1 row_mask:0xf bank_mask:0xf
v_and_b32_dpp v63, v79, v11 row_newbcast:1 row_mask:0xf bank_mask:0xf
v_and_b32_dpp v64, v79, v8 row_newbcast:5 row_mask:0xf bank_mask:0xf
v_and_b32_dpp v65, v79, v9 row_newbcast:5 row_mask:0xf bank_mask:0xf
v_and_b32_dpp v66, v79, v10 row_newbcast:5 row_mask:0xf bank_mask:0xf
v_and_b32_dpp v67, v79, v11 row_newbcast:5 row_mask:0xf bank_mask:0xf
v_and_b32_dpp v68, v79, v8 row_newbcast:9 row_mask:0xf bank_mask:0xf
v_and_b32_dpp v69, v79, v9 row_newbcast:9 row_mask:0xf bank_mask:0xf
v_and_b32_dpp v70, v79, v10 row_newbcast:9 row_mask:0xf bank_mask:0xf
v_and_b32_dpp v71, v79, v11 row_newbcast:9 row_mask:0xf bank_mask:0xf
v_and_b32_dpp v72, v79, v8 row_newbcast:13 row_mask:0xf bank_mask:0xf
v_and_b32_dpp v73, v79, v9 row_newbcast:13 row_mask:0xf bank_mask:0xf
v_and_b32_dpp v74, v79, v10 row_newbcast:13 row_mask:0xf bank_mask:0xf
v_and_b32_dpp v75, v79, v11 row_newbcast:13 row_mask:0xf bank_mask:0xf
s_waitcnt vmcnt(34)
v_mfma_f32_16x16x32_bf16 v[20:23], v[60:63], v[136:139], v[20:23]
v_mfma_f32_16x16x32_bf16 v[20:23], v[64:67], v[140:143], v[20:23]
v_mfma_f32_16x16x32_bf16 v[20:23], v[68:71], v[144:147], v[20:23]
v_mfma_f32_16x16x32_bf16 v[20:23], v[72:75], v[148:151], v[20:23]
v_add_u32 v117, 1, v117
buffer_store_dword v117, v118, s[64:67], 0 offen
buffer_load_dwordx4 v[136:139], v2, s[52:55], s12 offen offset:0 nt
buffer_load_dwordx4 v[140:143], v2, s[52:55], s12 offen offset:1024 nt
buffer_load_dwordx4 v[144:147], v2, s[52:55], s12 offen offset:2048 nt
buffer_load_dwordx4 v[148:151], v2, s[52:55], s12 offen offset:3072 nt
s_add_u32 s13, s13, 24576
s_min_u32 s12, s13, 2146435072
ds_read_b64_tr_b16 a[112:113], v88 offset:8
ds_read_b64_tr_b16 a[114:115], v88 offset:4616
ds_read_b64_tr_b16 a[116:117], v88 offset:36872
ds_read_b64_tr_b16 a[118:119], v88 offset:41480
v_and_b32_dpp v60, v76, v8 row_newbcast:2 row_mask:0xf bank_mask:0xf
v_and_b32_dpp v61, v76, v9 row_newbcast:2 row_mask:0xf bank_mask:0xf
v_and_b32_dpp v62, v76, v10 row_newbcast:2 row_mask:0xf bank_mask:0xf
v_and_b32_dpp v63, v76, v11 row_newbcast:2 row_mask:0xf bank_mask:0xf
v_and_b32_dpp v64, v76, v8 row_newbcast:6 row_mask:0xf bank_mask:0xf
v_and_b32_dpp v65, v76, v9 row_newbcast:6 row_mask:0xf bank_mask:0xf
v_and_b32_dpp v66, v76, v10 row_newbcast:6 row_mask:0xf bank_mask:0xf
v_and_b32_dpp v67, v76, v11 row_newbcast:6 row_mask:0xf bank_mask:0xf
v_and_b32_dpp v68, v76, v8 row_newbcast:10 row_mask:0xf bank_mask:0xf
v_and_b32_dpp v69, v76, v9 row_newbcast:10 row_mask:0xf bank_mask:0xf
v_and_b32_dpp v70, v76, v10 row_newbcast:10 row_mask:0xf bank_mask:0xf
v_and_b32_dpp v71, v76, v11 row_newbcast:10 row_mask:0xf bank_mask:0xf
v_and_b32_dpp v72, v76, v8 row_newbcast:14 row_mask:0xf bank_mask:0xf
v_and_b32_dpp v73, v76, v9 row_newbcast:14 row_mask:0xf bank_mask:0xf
v_and_b32_dpp v74, v76, v10 row_newbcast:14 row_mask:0xf bank_mask:0xf
v_and_b32_dpp v75, v76, v11 row_newbcast:14 row_mask:0xf bank_mask:0xf
v_mfma_f32_16x16x32_bf16 v[20:23], v[60:63], a[16:19], v[20:23]
v_mfma_f32_16x16x32_bf16 v[20:23], v[64:67], a[20:23], v[20:23]
v_mfma_f32_16x16x32_bf16 v[20:23], v[68:71], a[24:27], v[20:23]
v_mfma_f32_16x16x32_bf16 v[20:23], v[72:75], a[28:31], v[20:23]
s_nop 3
v_and_b32_dpp v60, v79, v8 row_newbcast:2 row_mask:0xf bank_mask:0xf
v_and_b32_dpp v61, v79, v9 row_newbcast:2 row_mask:0xf bank_mask:0xf
v_and_b32_dpp v62, v79, v10 row_newbcast:2 row_mask:0xf bank_mask:0xf
v_and_b32_dpp v63, v79, v11 row_newbcast:2 row_mask:0xf bank_mask:0xf
v_and_b32_dpp v64, v79, v8 row_newbcast:6 row_mask:0xf bank_mask:0xf
v_and_b32_dpp v65, v79, v9 row_newbcast:6 row_mask:0xf bank_mask:0xf
v_and_b32_dpp v66, v79, v10 row_newbcast:6 row_mask:0xf bank_mask:0xf
v_and_b32_dpp v67, v79, v11 row_newbcast:6 row_mask:0xf bank_mask:0xf
v_and_b32_dpp v68, v79, v8 row_newbcast:10 row_mask:0xf bank_mask:0xf
v_and_b32_dpp v69, v79, v9 row_newbcast:10 row_mask:0xf bank_mask:0xf
v_and_b32_dpp v70, v79, v10 row_newbcast:10 row_mask:0xf bank_mask:0xf
v_and_b32_dpp v71, v79, v11 row_newbcast:10 row_mask:0xf bank_mask:0xf
v_and_b32_dpp v72, v79, v8 row_newbcast:14 row_mask:0xf bank_mask:0xf
v_and_b32_dpp v73, v79, v9 row_newbcast:14 row_mask:0xf bank_mask:0xf
v_and_b32_dpp v74, v79, v10 row_newbcast:14 row_mask:0xf bank_mask:0xf
v_and_b32_dpp v75, v79, v11 row_newbcast:14 row_mask:0xf bank_mask:0xf
s_waitcnt vmcnt(35)
v_mfma_f32_16x16x32_bf16 v[20:23], v[60:63], v[152:155], v[20:23]
v_mfma_f32_16x16x32_bf16 v[20:23], v[64:67], v[156:159], v[20:23]
v_mfma_f32_16x16x32_bf16 v[20:23], v[68:71], v[160:163], v[20:23]
v_mfma_f32_16x16x32_bf16 v[20:23], v[72:75], v[164:167], v[20:23]
v_add_u32 v117, 1, v117
buffer_store_dword v117, v118, s[64:67], 0 offen
buffer_load_dwordx4 v[152:155], v2, s[52:55], s12 offen offset:0 nt
buffer_load_dwordx4 v[156:159], v2, s[52:55], s12 offen offset:1024 nt
buffer_load_dwordx4 v[160:163], v2, s[52:55], s12 offen offset:2048 nt
buffer_load_dwordx4 v[164:167], v2, s[52:55], s12 offen offset:3072 nt
s_add_u32 s13, s13, 24576
s_min_u32 s12, s13, 2146435072
ds_read_b64_tr_b16 a[120:121], v90 offset:8
ds_read_b64_tr_b16 a[122:123], v90 offset:4616
ds_read_b64_tr_b16 a[124:125], v90 offset:36872
ds_read_b64_tr_b16 a[126:127], v90 offset:41480
v_and_b32_dpp v60, v79, v8 row_newbcast:3 row_mask:0xf bank_mask:0xf
v_and_b32_dpp v61, v79, v9 row_newbcast:3 row_mask:0xf bank_mask:0xf
v_and_b32_dpp v62, v79, v10 row_newbcast:3 row_mask:0xf bank_mask:0xf
v_and_b32_dpp v63, v79, v11 row_newbcast:3 row_mask:0xf bank_mask:0xf
v_and_b32_dpp v64, v79, v8 row_newbcast:7 row_mask:0xf bank_mask:0xf
v_and_b32_dpp v65, v79, v9 row_newbcast:7 row_mask:0xf bank_mask:0xf
v_and_b32_dpp v66, v79, v10 row_newbcast:7 row_mask:0xf bank_mask:0xf
v_and_b32_dpp v67, v79, v11 row_newbcast:7 row_mask:0xf bank_mask:0xf
v_and_b32_dpp v68, v79, v8 row_newbcast:11 row_mask:0xf bank_mask:0xf
v_and_b32_dpp v69, v79, v9 row_newbcast:11 row_mask:0xf bank_mask:0xf
v_and_b32_dpp v70, v79, v10 row_newbcast:11 row_mask:0xf bank_mask:0xf
v_and_b32_dpp v71, v79, v11 row_newbcast:11 row_mask:0xf bank_mask:0xf
v_and_b32_dpp v72, v79, v8 row_newbcast:15 row_mask:0xf bank_mask:0xf
v_and_b32_dpp v73, v79, v9 row_newbcast:15 row_mask:0xf bank_mask:0xf
v_and_b32_dpp v74, v79, v10 row_newbcast:15 row_mask:0xf bank_mask:0xf
v_and_b32_dpp v75, v79, v11 row_newbcast:15 row_mask:0xf bank_mask:0xf
s_waitcnt vmcnt(36)
v_mfma_f32_16x16x32_bf16 v[20:23], v[60:63], v[168:171], v[20:23]
v_mfma_f32_16x16x32_bf16 v[20:23], v[64:67], v[172:175], v[20:23]
v_mfma_f32_16x16x32_bf16 v[20:23], v[68:71], v[176:179], v[20:23]
v_mfma_f32_16x16x32_bf16 v[20:23], v[72:75], v[180:183], v[20:23]
v_add_u32 v117, 1, v117
buffer_store_dword v117, v118, s[64:67], 0 offen
buffer_load_dwordx4 v[168:171], v2, s[52:55], s12 offen offset:0 nt
buffer_load_dwordx4 v[172:175], v2, s[52:55], s12 offen offset:1024 nt
buffer_load_dwordx4 v[176:179], v2, s[52:55], s12 offen offset:2048 nt
buffer_load_dwordx4 v[180:183], v2, s[52:55], s12 offen offset:3072 nt
s_add_u32 s13, s13, 24576
s_min_u32 s12, s13, 2146435072
ds_read_b64_tr_b16 a[128:129], v88 offset:16
ds_read_b64_tr_b16 a[130:131], v88 offset:4624
ds_read_b64_tr_b16 a[132:133], v88 offset:36880
ds_read_b64_tr_b16 a[134:135], v88 offset:41488
v_and_b32_dpp v60, v80, v8 row_newbcast:0 row_mask:0xf bank_mask:0xf
v_and_b32_dpp v61, v80, v9 row_newbcast:0 row_mask:0xf bank_mask:0xf
v_and_b32_dpp v62, v80, v10 row_newbcast:0 row_mask:0xf bank_mask:0xf
v_and_b32_dpp v63, v80, v11 row_newbcast:0 row_mask:0xf bank_mask:0xf
v_and_b32_dpp v64, v80, v8 row_newbcast:4 row_mask:0xf bank_mask:0xf
v_and_b32_dpp v65, v80, v9 row_newbcast:4 row_mask:0xf bank_mask:0xf
v_and_b32_dpp v66, v80, v10 row_newbcast:4 row_mask:0xf bank_mask:0xf
v_and_b32_dpp v67, v80, v11 row_newbcast:4 row_mask:0xf bank_mask:0xf
v_and_b32_dpp v68, v80, v8 row_newbcast:8 row_mask:0xf bank_mask:0xf
v_and_b32_dpp v69, v80, v9 row_newbcast:8 row_mask:0xf bank_mask:0xf
v_and_b32_dpp v70, v80, v10 row_newbcast:8 row_mask:0xf bank_mask:0xf
v_and_b32_dpp v71, v80, v11 row_newbcast:8 row_mask:0xf bank_mask:0xf
v_and_b32_dpp v72, v80, v8 row_newbcast:12 row_mask:0xf bank_mask:0xf
v_and_b32_dpp v73, v80, v9 row_newbcast:12 row_mask:0xf bank_mask:0xf
v_and_b32_dpp v74, v80, v10 row_newbcast:12 row_mask:0xf bank_mask:0xf
v_and_b32_dpp v75, v80, v11 row_newbcast:12 row_mask:0xf bank_mask:0xf
s_waitcnt vmcnt(35)
v_mfma_f32_16x16x32_bf16 v[20:23], v[60:63], v[184:187], v[20:23]
v_mfma_f32_16x16x32_bf16 v[20:23], v[64:67], v[188:191], v[20:23]
v_mfma_f32_16x16x32_bf16 v[20:23], v[68:71], v[192:195], v[20:23]
v_mfma_f32_16x16x32_bf16 v[20:23], v[72:75], v[196:199], v[20:23]
v_add_u32 v117, 1, v117
buffer_store_dword v117, v118, s[64:67], 0 offen
buffer_load_dwordx4 v[184:187], v2, s[52:55], s12 offen offset:0 nt
buffer_load_dwordx4 v[188:191], v2, s[52:55], s12 offen offset:1024 nt
buffer_load_dwordx4 v[192:195], v2, s[52:55], s12 offen offset:2048 nt
buffer_load_dwordx4 v[196:199], v2, s[52:55], s12 offen offset:3072 nt
s_add_u32 s13, s13, 24576
s_min_u32 s12, s13, 2146435072
ds_read_b64_tr_b16 a[136:137], v90 offset:16
ds_read_b64_tr_b16 a[138:139], v90 offset:4624
ds_read_b64_tr_b16 a[140:141], v90 offset:36880
ds_read_b64_tr_b16 a[142:143], v90 offset:41488
v_and_b32_dpp v60, v80, v8 row_newbcast:1 row_mask:0xf bank_mask:0xf
v_and_b32_dpp v61, v80, v9 row_newbcast:1 row_mask:0xf bank_mask:0xf
v_and_b32_dpp v62, v80, v10 row_newbcast:1 row_mask:0xf bank_mask:0xf
v_and_b32_dpp v63, v80, v11 row_newbcast:1 row_mask:0xf bank_mask:0xf
v_and_b32_dpp v64, v80, v8 row_newbcast:5 row_mask:0xf bank_mask:0xf
v_and_b32_dpp v65, v80, v9 row_newbcast:5 row_mask:0xf bank_mask:0xf
v_and_b32_dpp v66, v80, v10 row_newbcast:5 row_mask:0xf bank_mask:0xf
v_and_b32_dpp v67, v80, v11 row_newbcast:5 row_mask:0xf bank_mask:0xf
v_and_b32_dpp v68, v80, v8 row_newbcast:9 row_mask:0xf bank_mask:0xf
v_and_b32_dpp v69, v80, v9 row_newbcast:9 row_mask:0xf bank_mask:0xf
v_and_b32_dpp v70, v80, v10 row_newbcast:9 row_mask:0xf bank_mask:0xf
v_and_b32_dpp v71, v80, v11 row_newbcast:9 row_mask:0xf bank_mask:0xf
v_and_b32_dpp v72, v80, v8 row_newbcast:13 row_mask:0xf bank_mask:0xf
v_and_b32_dpp v73, v80, v9 row_newbcast:13 row_mask:0xf bank_mask:0xf
v_and_b32_dpp v74, v80, v10 row_newbcast:13 row_mask:0xf bank_mask:0xf
v_and_b32_dpp v75, v80, v11 row_newbcast:13 row_mask:0xf bank_mask:0xf
s_waitcnt vmcnt(35)
v_mfma_f32_16x16x32_bf16 v[20:23], v[60:63], v[200:203], v[20:23]
v_mfma_f32_16x16x32_bf16 v[20:23], v[64:67], v[204:207], v[20:23]
v_mfma_f32_16x16x32_bf16 v[20:23], v[68:71], v[208:211], v[20:23]
v_mfma_f32_16x16x32_bf16 v[20:23], v[72:75], v[212:215], v[20:23]
v_add_u32 v117, 1, v117
buffer_store_dword v117, v118, s[64:67], 0 offen
buffer_load_dwordx4 v[200:203], v2, s[52:55], s12 offen offset:0 nt
buffer_load_dwordx4 v[204:207], v2, s[52:55], s12 offen offset:1024 nt
buffer_load_dwordx4 v[208:211], v2, s[52:55], s12 offen offset:2048 nt
buffer_load_dwordx4 v[212:215], v2, s[52:55], s12 offen offset:3072 nt
s_add_u32 s13, s13, 24576
s_min_u32 s12, s13, 2146435072
ds_read_b64_tr_b16 a[144:145], v88 offset:24
ds_read_b64_tr_b16 a[146:147], v88 offset:4632
ds_read_b64_tr_b16 a[148:149], v88 offset:36888
ds_read_b64_tr_b16 a[150:151], v88 offset:41496
v_and_b32_dpp v60, v76, v8 row_newbcast:3 row_mask:0xf bank_mask:0xf
v_and_b32_dpp v61, v76, v9 row_newbcast:3 row_mask:0xf bank_mask:0xf
v_and_b32_dpp v62, v76, v10 row_newbcast:3 row_mask:0xf bank_mask:0xf
v_and_b32_dpp v63, v76, v11 row_newbcast:3 row_mask:0xf bank_mask:0xf
v_and_b32_dpp v64, v76, v8 row_newbcast:7 row_mask:0xf bank_mask:0xf
v_and_b32_dpp v65, v76, v9 row_newbcast:7 row_mask:0xf bank_mask:0xf
v_and_b32_dpp v66, v76, v10 row_newbcast:7 row_mask:0xf bank_mask:0xf
v_and_b32_dpp v67, v76, v11 row_newbcast:7 row_mask:0xf bank_mask:0xf
v_and_b32_dpp v68, v76, v8 row_newbcast:11 row_mask:0xf bank_mask:0xf
v_and_b32_dpp v69, v76, v9 row_newbcast:11 row_mask:0xf bank_mask:0xf
v_and_b32_dpp v70, v76, v10 row_newbcast:11 row_mask:0xf bank_mask:0xf
v_and_b32_dpp v71, v76, v11 row_newbcast:11 row_mask:0xf bank_mask:0xf
v_and_b32_dpp v72, v76, v8 row_newbcast:15 row_mask:0xf bank_mask:0xf
v_and_b32_dpp v73, v76, v9 row_newbcast:15 row_mask:0xf bank_mask:0xf
v_and_b32_dpp v74, v76, v10 row_newbcast:15 row_mask:0xf bank_mask:0xf
v_and_b32_dpp v75, v76, v11 row_newbcast:15 row_mask:0xf bank_mask:0xf
v_mfma_f32_16x16x32_bf16 v[20:23], v[60:63], a[32:35], v[20:23]
v_mfma_f32_16x16x32_bf16 v[20:23], v[64:67], a[36:39], v[20:23]
v_mfma_f32_16x16x32_bf16 v[20:23], v[68:71], a[40:43], v[20:23]
v_mfma_f32_16x16x32_bf16 v[20:23], v[72:75], a[44:47], v[20:23]
s_nop 3
v_and_b32_dpp v60, v80, v8 row_newbcast:2 row_mask:0xf bank_mask:0xf
v_and_b32_dpp v61, v80, v9 row_newbcast:2 row_mask:0xf bank_mask:0xf
v_and_b32_dpp v62, v80, v10 row_newbcast:2 row_mask:0xf bank_mask:0xf
v_and_b32_dpp v63, v80, v11 row_newbcast:2 row_mask:0xf bank_mask:0xf
v_and_b32_dpp v64, v80, v8 row_newbcast:6 row_mask:0xf bank_mask:0xf
v_and_b32_dpp v65, v80, v9 row_newbcast:6 row_mask:0xf bank_mask:0xf
v_and_b32_dpp v66, v80, v10 row_newbcast:6 row_mask:0xf bank_mask:0xf
v_and_b32_dpp v67, v80, v11 row_newbcast:6 row_mask:0xf bank_mask:0xf
v_and_b32_dpp v68, v80, v8 row_newbcast:10 row_mask:0xf bank_mask:0xf
v_and_b32_dpp v69, v80, v9 row_newbcast:10 row_mask:0xf bank_mask:0xf
v_and_b32_dpp v70, v80, v10 row_newbcast:10 row_mask:0xf bank_mask:0xf
v_and_b32_dpp v71, v80, v11 row_newbcast:10 row_mask:0xf bank_mask:0xf
v_and_b32_dpp v72, v80, v8 row_newbcast:14 row_mask:0xf bank_mask:0xf
v_and_b32_dpp v73, v80, v9 row_newbcast:14 row_mask:0xf bank_mask:0xf
v_and_b32_dpp v74, v80, v10 row_newbcast:14 row_mask:0xf bank_mask:0xf
v_and_b32_dpp v75, v80, v11 row_newbcast:14 row_mask:0xf bank_mask:0xf
s_waitcnt vmcnt(35)
v_mfma_f32_16x16x32_bf16 v[20:23], v[60:63], v[216:219], v[20:23]
v_mfma_f32_16x16x32_bf16 v[20:23], v[64:67], v[220:223], v[20:23]
v_mfma_f32_16x16x32_bf16 v[20:23], v[68:71], v[224:227], v[20:23]
v_mfma_f32_16x16x32_bf16 v[20:23], v[72:75], v[228:231], v[20:23]
v_add_u32 v117, 1, v117
buffer_store_dword v117, v118, s[64:67], 0 offen
buffer_load_dwordx4 v[216:219], v2, s[52:55], s12 offen offset:0 nt
buffer_load_dwordx4 v[220:223], v2, s[52:55], s12 offen offset:1024 nt
buffer_load_dwordx4 v[224:227], v2, s[52:55], s12 offen offset:2048 nt
buffer_load_dwordx4 v[228:231], v2, s[52:55], s12 offen offset:3072 nt
s_add_u32 s13, s13, 24576
s_min_u32 s12, s13, 2146435072
ds_read_b64_tr_b16 a[152:153], v90 offset:24
ds_read_b64_tr_b16 a[154:155], v90 offset:4632
ds_read_b64_tr_b16 a[156:157], v90 offset:36888
ds_read_b64_tr_b16 a[158:159], v90 offset:41496
v_and_b32_dpp v60, v80, v8 row_newbcast:3 row_mask:0xf bank_mask:0xf
v_and_b32_dpp v61, v80, v9 row_newbcast:3 row_mask:0xf bank_mask:0xf
v_and_b32_dpp v62, v80, v10 row_newbcast:3 row_mask:0xf bank_mask:0xf
v_and_b32_dpp v63, v80, v11 row_newbcast:3 row_mask:0xf bank_mask:0xf
v_and_b32_dpp v64, v80, v8 row_newbcast:7 row_mask:0xf bank_mask:0xf
v_and_b32_dpp v65, v80, v9 row_newbcast:7 row_mask:0xf bank_mask:0xf
v_and_b32_dpp v66, v80, v10 row_newbcast:7 row_mask:0xf bank_mask:0xf
v_and_b32_dpp v67, v80, v11 row_newbcast:7 row_mask:0xf bank_mask:0xf
v_and_b32_dpp v68, v80, v8 row_newbcast:11 row_mask:0xf bank_mask:0xf
v_and_b32_dpp v69, v80, v9 row_newbcast:11 row_mask:0xf bank_mask:0xf
v_and_b32_dpp v70, v80, v10 row_newbcast:11 row_mask:0xf bank_mask:0xf
v_and_b32_dpp v71, v80, v11 row_newbcast:11 row_mask:0xf bank_mask:0xf
v_and_b32_dpp v72, v80, v8 row_newbcast:15 row_mask:0xf bank_mask:0xf
v_and_b32_dpp v73, v80, v9 row_newbcast:15 row_mask:0xf bank_mask:0xf
v_and_b32_dpp v74, v80, v10 row_newbcast:15 row_mask:0xf bank_mask:0xf
v_and_b32_dpp v75, v80, v11 row_newbcast:15 row_mask:0xf bank_mask:0xf
s_waitcnt vmcnt(35)
v_mfma_f32_16x16x32_bf16 v[20:23], v[60:63], v[232:235], v[20:23]
v_mfma_f32_16x16x32_bf16 v[20:23], v[64:67], v[236:239], v[20:23]
v_mfma_f32_16x16x32_bf16 v[20:23], v[68:71], v[240:243], v[20:23]
v_mfma_f32_16x16x32_bf16 v[20:23], v[72:75], v[244:247], v[20:23]
v_add_u32 v117, 1, v117
buffer_store_dword v117, v118, s[64:67], 0 offen
buffer_load_dwordx4 v[232:235], v2, s[52:55], s12 offen offset:0 nt
buffer_load_dwordx4 v[236:239], v2, s[52:55], s12 offen offset:1024 nt
buffer_load_dwordx4 v[240:243], v2, s[52:55], s12 offen offset:2048 nt
buffer_load_dwordx4 v[244:247], v2, s[52:55], s12 offen offset:3072 nt
s_add_u32 s13, s13, 24576
s_min_u32 s12, s13, 2146435072
ds_read_b64_tr_b16 a[160:161], v88 offset:128
ds_read_b64_tr_b16 a[162:163], v88 offset:4736
ds_read_b64_tr_b16 a[164:165], v88 offset:36992
ds_read_b64_tr_b16 a[166:167], v88 offset:41600
v_and_b32_dpp v60, v81, v8 row_newbcast:0 row_mask:0xf bank_mask:0xf
v_and_b32_dpp v61, v81, v9 row_newbcast:0 row_mask:0xf bank_mask:0xf
v_and_b32_dpp v62, v81, v10 row_newbcast:0 row_mask:0xf bank_mask:0xf
v_and_b32_dpp v63, v81, v11 row_newbcast:0 row_mask:0xf bank_mask:0xf
v_and_b32_dpp v64, v81, v8 row_newbcast:4 row_mask:0xf bank_mask:0xf
v_and_b32_dpp v65, v81, v9 row_newbcast:4 row_mask:0xf bank_mask:0xf
v_and_b32_dpp v66, v81, v10 row_newbcast:4 row_mask:0xf bank_mask:0xf
v_and_b32_dpp v67, v81, v11 row_newbcast:4 row_mask:0xf bank_mask:0xf
v_and_b32_dpp v68, v81, v8 row_newbcast:8 row_mask:0xf bank_mask:0xf
v_and_b32_dpp v69, v81, v9 row_newbcast:8 row_mask:0xf bank_mask:0xf
v_and_b32_dpp v70, v81, v10 row_newbcast:8 row_mask:0xf bank_mask:0xf
v_and_b32_dpp v71, v81, v11 row_newbcast:8 row_mask:0xf bank_mask:0xf
v_and_b32_dpp v72, v81, v8 row_newbcast:12 row_mask:0xf bank_mask:0xf
v_and_b32_dpp v73, v81, v9 row_newbcast:12 row_mask:0xf bank_mask:0xf
v_and_b32_dpp v74, v81, v10 row_newbcast:12 row_mask:0xf bank_mask:0xf
v_and_b32_dpp v75, v81, v11 row_newbcast:12 row_mask:0xf bank_mask:0xf
s_waitcnt vmcnt(35)
v_mfma_f32_16x16x32_bf16 v[20:23], v[60:63], v[120:123], v[20:23]
v_mfma_f32_16x16x32_bf16 v[20:23], v[64:67], v[124:127], v[20:23]
v_mfma_f32_16x16x32_bf16 v[20:23], v[68:71], v[128:131], v[20:23]
v_mfma_f32_16x16x32_bf16 v[20:23], v[72:75], v[132:135], v[20:23]
v_add_u32 v117, 1, v117
buffer_store_dword v117, v118, s[64:67], 0 offen
buffer_load_dwordx4 v[120:123], v2, s[52:55], s12 offen offset:0 nt
buffer_load_dwordx4 v[124:127], v2, s[52:55], s12 offen offset:1024 nt
buffer_load_dwordx4 v[128:131], v2, s[52:55], s12 offen offset:2048 nt
buffer_load_dwordx4 v[132:135], v2, s[52:55], s12 offen offset:3072 nt
s_add_u32 s13, s13, 24576
s_min_u32 s12, s13, 2146435072
ds_read_b64_tr_b16 a[168:169], v90 offset:128
ds_read_b64_tr_b16 a[170:171], v90 offset:4736
ds_read_b64_tr_b16 a[172:173], v90 offset:36992
ds_read_b64_tr_b16 a[174:175], v90 offset:41600
v_and_b32_dpp v60, v81, v8 row_newbcast:1 row_mask:0xf bank_mask:0xf
v_and_b32_dpp v61, v81, v9 row_newbcast:1 row_mask:0xf bank_mask:0xf
v_and_b32_dpp v62, v81, v10 row_newbcast:1 row_mask:0xf bank_mask:0xf
v_and_b32_dpp v63, v81, v11 row_newbcast:1 row_mask:0xf bank_mask:0xf
v_and_b32_dpp v64, v81, v8 row_newbcast:5 row_mask:0xf bank_mask:0xf
v_and_b32_dpp v65, v81, v9 row_newbcast:5 row_mask:0xf bank_mask:0xf
v_and_b32_dpp v66, v81, v10 row_newbcast:5 row_mask:0xf bank_mask:0xf
v_and_b32_dpp v67, v81, v11 row_newbcast:5 row_mask:0xf bank_mask:0xf
v_and_b32_dpp v68, v81, v8 row_newbcast:9 row_mask:0xf bank_mask:0xf
v_and_b32_dpp v69, v81, v9 row_newbcast:9 row_mask:0xf bank_mask:0xf
v_and_b32_dpp v70, v81, v10 row_newbcast:9 row_mask:0xf bank_mask:0xf
v_and_b32_dpp v71, v81, v11 row_newbcast:9 row_mask:0xf bank_mask:0xf
v_and_b32_dpp v72, v81, v8 row_newbcast:13 row_mask:0xf bank_mask:0xf
v_and_b32_dpp v73, v81, v9 row_newbcast:13 row_mask:0xf bank_mask:0xf
v_and_b32_dpp v74, v81, v10 row_newbcast:13 row_mask:0xf bank_mask:0xf
v_and_b32_dpp v75, v81, v11 row_newbcast:13 row_mask:0xf bank_mask:0xf
s_waitcnt vmcnt(35)
v_mfma_f32_16x16x32_bf16 v[20:23], v[60:63], v[136:139], v[20:23]
v_mfma_f32_16x16x32_bf16 v[20:23], v[64:67], v[140:143], v[20:23]
v_mfma_f32_16x16x32_bf16 v[20:23], v[68:71], v[144:147], v[20:23]
v_mfma_f32_16x16x32_bf16 v[20:23], v[72:75], v[148:151], v[20:23]
v_add_u32 v117, 1, v117
buffer_store_dword v117, v118, s[64:67], 0 offen
buffer_load_dwordx4 v[136:139], v2, s[52:55], s12 offen offset:0 nt
buffer_load_dwordx4 v[140:143], v2, s[52:55], s12 offen offset:1024 nt
buffer_load_dwordx4 v[144:147], v2, s[52:55], s12 offen offset:2048 nt
buffer_load_dwordx4 v[148:151], v2, s[52:55], s12 offen offset:3072 nt
s_add_u32 s13, s13, 24576
s_min_u32 s12, s13, 2146435072
ds_read_b64_tr_b16 a[176:177], v88 offset:136
ds_read_b64_tr_b16 a[178:179], v88 offset:4744
ds_read_b64_tr_b16 a[180:181], v88 offset:37000
ds_read_b64_tr_b16 a[182:183], v88 offset:41608
v_and_b32_dpp v60, v77, v8 row_newbcast:0 row_mask:0xf bank_mask:0xf
v_and_b32_dpp v61, v77, v9 row_newbcast:0 row_mask:0xf bank_mask:0xf
v_and_b32_dpp v62, v77, v10 row_newbcast:0 row_mask:0xf bank_mask:0xf
v_and_b32_dpp v63, v77, v11 row_newbcast:0 row_mask:0xf bank_mask:0xf
v_and_b32_dpp v64, v77, v8 row_newbcast:4 row_mask:0xf bank_mask:0xf
v_and_b32_dpp v65, v77, v9 row_newbcast:4 row_mask:0xf bank_mask:0xf
v_and_b32_dpp v66, v77, v10 row_newbcast:4 row_mask:0xf bank_mask:0xf
v_and_b32_dpp v67, v77, v11 row_newbcast:4 row_mask:0xf bank_mask:0xf
v_and_b32_dpp v68, v77, v8 row_newbcast:8 row_mask:0xf bank_mask:0xf
v_and_b32_dpp v69, v77, v9 row_newbcast:8 row_mask:0xf bank_mask:0xf
v_and_b32_dpp v70, v77, v10 row_newbcast:8 row_mask:0xf bank_mask:0xf
v_and_b32_dpp v71, v77, v11 row_newbcast:8 row_mask:0xf bank_mask:0xf
v_and_b32_dpp v72, v77, v8 row_newbcast:12 row_mask:0xf bank_mask:0xf
v_and_b32_dpp v73, v77, v9 row_newbcast:12 row_mask:0xf bank_mask:0xf
v_and_b32_dpp v74, v77, v10 row_newbcast:12 row_mask:0xf bank_mask:0xf
v_and_b32_dpp v75, v77, v11 row_newbcast:12 row_mask:0xf bank_mask:0xf
v_mfma_f32_16x16x32_bf16 v[20:23], v[60:63], a[48:51], v[20:23]
v_mfma_f32_16x16x32_bf16 v[20:23], v[64:67], a[52:55], v[20:23]
v_mfma_f32_16x16x32_bf16 v[20:23], v[68:71], a[56:59], v[20:23]
v_mfma_f32_16x16x32_bf16 v[20:23], v[72:75], a[60:63], v[20:23]
s_nop 3
v_and_b32_dpp v60, v81, v8 row_newbcast:2 row_mask:0xf bank_mask:0xf
v_and_b32_dpp v61, v81, v9 row_newbcast:2 row_mask:0xf bank_mask:0xf
v_and_b32_dpp v62, v81, v10 row_newbcast:2 row_mask:0xf bank_mask:0xf
v_and_b32_dpp v63, v81, v11 row_newbcast:2 row_mask:0xf bank_mask:0xf
v_and_b32_dpp v64, v81, v8 row_newbcast:6 row_mask:0xf bank_mask:0xf
v_and_b32_dpp v65, v81, v9 row_newbcast:6 row_mask:0xf bank_mask:0xf
v_and_b32_dpp v66, v81, v10 row_newbcast:6 row_mask:0xf bank_mask:0xf
v_and_b32_dpp v67, v81, v11 row_newbcast:6 row_mask:0xf bank_mask:0xf
v_and_b32_dpp v68, v81, v8 row_newbcast:10 row_mask:0xf bank_mask:0xf
v_and_b32_dpp v69, v81, v9 row_newbcast:10 row_mask:0xf bank_mask:0xf
v_and_b32_dpp v70, v81, v10 row_newbcast:10 row_mask:0xf bank_mask:0xf
v_and_b32_dpp v71, v81, v11 row_newbcast:10 row_mask:0xf bank_mask:0xf
v_and_b32_dpp v72, v81, v8 row_newbcast:14 row_mask:0xf bank_mask:0xf
v_and_b32_dpp v73, v81, v9 row_newbcast:14 row_mask:0xf bank_mask:0xf
v_and_b32_dpp v74, v81, v10 row_newbcast:14 row_mask:0xf bank_mask:0xf
v_and_b32_dpp v75, v81, v11 row_newbcast:14 row_mask:0xf bank_mask:0xf
s_waitcnt vmcnt(35)
v_mfma_f32_16x16x32_bf16 v[20:23], v[60:63], v[152:155], v[20:23]
v_mfma_f32_16x16x32_bf16 v[20:23], v[64:67], v[156:159], v[20:23]
v_mfma_f32_16x16x32_bf16 v[20:23], v[68:71], v[160:163], v[20:23]
v_mfma_f32_16x16x32_bf16 v[20:23], v[72:75], v[164:167], v[20:23]
v_add_u32 v117, 1, v117
buffer_store_dword v117, v118, s[64:67], 0 offen
buffer_load_dwordx4 v[152:155], v2, s[52:55], s12 offen offset:0 nt
buffer_load_dwordx4 v[156:159], v2, s[52:55], s12 offen offset:1024 nt
buffer_load_dwordx4 v[160:163], v2, s[52:55], s12 offen offset:2048 nt
buffer_load_dwordx4 v[164:167], v2, s[52:55], s12 offen offset:3072 nt
s_add_u32 s13, s13, 24576
s_min_u32 s12, s13, 2146435072
ds_read_b64_tr_b16 a[184:185], v90 offset:136
ds_read_b64_tr_b16 a[186:187], v90 offset:4744
ds_read_b64_tr_b16 a[188:189], v90 offset:37000
ds_read_b64_tr_b16 a[190:191], v90 offset:41608
v_and_b32_dpp v60, v81, v8 row_newbcast:3 row_mask:0xf bank_mask:0xf
v_and_b32_dpp v61, v81, v9 row_newbcast:3 row_mask:0xf bank_mask:0xf
v_and_b32_dpp v62, v81, v10 row_newbcast:3 row_mask:0xf bank_mask:0xf
v_and_b32_dpp v63, v81, v11 row_newbcast:3 row_mask:0xf bank_mask:0xf
v_and_b32_dpp v64, v81, v8 row_newbcast:7 row_mask:0xf bank_mask:0xf
v_and_b32_dpp v65, v81, v9 row_newbcast:7 row_mask:0xf bank_mask:0xf
v_and_b32_dpp v66, v81, v10 row_newbcast:7 row_mask:0xf bank_mask:0xf
v_and_b32_dpp v67, v81, v11 row_newbcast:7 row_mask:0xf bank_mask:0xf
v_and_b32_dpp v68, v81, v8 row_newbcast:11 row_mask:0xf bank_mask:0xf
v_and_b32_dpp v69, v81, v9 row_newbcast:11 row_mask:0xf bank_mask:0xf
v_and_b32_dpp v70, v81, v10 row_newbcast:11 row_mask:0xf bank_mask:0xf
v_and_b32_dpp v71, v81, v11 row_newbcast:11 row_mask:0xf bank_mask:0xf
v_and_b32_dpp v72, v81, v8 row_newbcast:15 row_mask:0xf bank_mask:0xf
v_and_b32_dpp v73, v81, v9 row_newbcast:15 row_mask:0xf bank_mask:0xf
v_and_b32_dpp v74, v81, v10 row_newbcast:15 row_mask:0xf bank_mask:0xf
v_and_b32_dpp v75, v81, v11 row_newbcast:15 row_mask:0xf bank_mask:0xf
s_waitcnt vmcnt(35)
v_mfma_f32_16x16x32_bf16 v[20:23], v[60:63], v[168:171], v[20:23]
v_mfma_f32_16x16x32_bf16 v[20:23], v[64:67], v[172:175], v[20:23]
v_mfma_f32_16x16x32_bf16 v[20:23], v[68:71], v[176:179], v[20:23]
v_mfma_f32_16x16x32_bf16 v[20:23], v[72:75], v[180:183], v[20:23]
v_add_u32 v117, 1, v117
buffer_store_dword v117, v118, s[64:67], 0 offen
buffer_load_dwordx4 v[168:171], v2, s[52:55], s12 offen offset:0 nt
buffer_load_dwordx4 v[172:175], v2, s[52:55], s12 offen offset:1024 nt
buffer_load_dwordx4 v[176:179], v2, s[52:55], s12 offen offset:2048 nt
buffer_load_dwordx4 v[180:183], v2, s[52:55], s12 offen offset:3072 nt
s_add_u32 s13, s13, 24576
s_min_u32 s12, s13, 2146435072
ds_read_b64_tr_b16 a[192:193], v88 offset:144
ds_read_b64_tr_b16 a[194:195], v88 offset:4752
ds_read_b64_tr_b16 a[196:197], v88 offset:37008
ds_read_b64_tr_b16 a[198:199], v88 offset:41616
v_and_b32_dpp v60, v82, v8 row_newbcast:0 row_mask:0xf bank_mask:0xf
v_and_b32_dpp v61, v82, v9 row_newbcast:0 row_mask:0xf bank_mask:0xf
v_and_b32_dpp v62, v82, v10 row_newbcast:0 row_mask:0xf bank_mask:0xf
v_and_b32_dpp v63, v82, v11 row_newbcast:0 row_mask:0xf bank_mask:0xf
v_and_b32_dpp v64, v82, v8 row_newbcast:4 row_mask:0xf bank_mask:0xf
v_and_b32_dpp v65, v82, v9 row_newbcast:4 row_mask:0xf bank_mask:0xf
v_and_b32_dpp v66, v82, v10 row_newbcast:4 row_mask:0xf bank_mask:0xf
v_and_b32_dpp v67, v82, v11 row_newbcast:4 row_mask:0xf bank_mask:0xf
v_and_b32_dpp v68, v82, v8 row_newbcast:8 row_mask:0xf bank_mask:0xf
v_and_b32_dpp v69, v82, v9 row_newbcast:8 row_mask:0xf bank_mask:0xf
v_and_b32_dpp v70, v82, v10 row_newbcast:8 row_mask:0xf bank_mask:0xf
v_and_b32_dpp v71, v82, v11 row_newbcast:8 row_mask:0xf bank_mask:0xf
v_and_b32_dpp v72, v82, v8 row_newbcast:12 row_mask:0xf bank_mask:0xf
v_and_b32_dpp v73, v82, v9 row_newbcast:12 row_mask:0xf bank_mask:0xf
v_and_b32_dpp v74, v82, v10 row_newbcast:12 row_mask:0xf bank_mask:0xf
v_and_b32_dpp v75, v82, v11 row_newbcast:12 row_mask:0xf bank_mask:0xf
s_waitcnt vmcnt(35)
v_mfma_f32_16x16x32_bf16 v[20:23], v[60:63], v[184:187], v[20:23]
v_mfma_f32_16x16x32_bf16 v[20:23], v[64:67], v[188:191], v[20:23]
v_mfma_f32_16x16x32_bf16 v[20:23], v[68:71], v[192:195], v[20:23]
v_mfma_f32_16x16x32_bf16 v[20:23], v[72:75], v[196:199], v[20:23]
v_add_u32 v117, 1, v117
buffer_store_dword v117, v118, s[64:67], 0 offen
buffer_load_dwordx4 v[184:187], v2, s[52:55], s12 offen offset:0 nt
buffer_load_dwordx4 v[188:191], v2, s[52:55], s12 offen offset:1024 nt
buffer_load_dwordx4 v[192:195], v2, s[52:55], s12 offen offset:2048 nt
buffer_load_dwordx4 v[196:199], v2, s[52:55], s12 offen offset:3072 nt
s_add_u32 s13, s13, 24576
s_min_u32 s12, s13, 2146435072
ds_read_b64_tr_b16 a[200:201], v90 offset:144
ds_read_b64_tr_b16 a[202:203], v90 offset:4752
ds_read_b64_tr_b16 a[204:205], v90 offset:37008
ds_read_b64_tr_b16 a[206:207], v90 offset:41616
v_and_b32_dpp v60, v82, v8 row_newbcast:1 row_mask:0xf bank_mask:0xf
v_and_b32_dpp v61, v82, v9 row_newbcast:1 row_mask:0xf bank_mask:0xf
v_and_b32_dpp v62, v82, v10 row_newbcast:1 row_mask:0xf bank_mask:0xf
v_and_b32_dpp v63, v82, v11 row_newbcast:1 row_mask:0xf bank_mask:0xf
v_and_b32_dpp v64, v82, v8 row_newbcast:5 row_mask:0xf bank_mask:0xf
v_and_b32_dpp v65, v82, v9 row_newbcast:5 row_mask:0xf bank_mask:0xf
v_and_b32_dpp v66, v82, v10 row_newbcast:5 row_mask:0xf bank_mask:0xf
v_and_b32_dpp v67, v82, v11 row_newbcast:5 row_mask:0xf bank_mask:0xf
v_and_b32_dpp v68, v82, v8 row_newbcast:9 row_mask:0xf bank_mask:0xf
v_and_b32_dpp v69, v82, v9 row_newbcast:9 row_mask:0xf bank_mask:0xf
v_and_b32_dpp v70, v82, v10 row_newbcast:9 row_mask:0xf bank_mask:0xf
v_and_b32_dpp v71, v82, v11 row_newbcast:9 row_mask:0xf bank_mask:0xf
v_and_b32_dpp v72, v82, v8 row_newbcast:13 row_mask:0xf bank_mask:0xf
v_and_b32_dpp v73, v82, v9 row_newbcast:13 row_mask:0xf bank_mask:0xf
v_and_b32_dpp v74, v82, v10 row_newbcast:13 row_mask:0xf bank_mask:0xf
v_and_b32_dpp v75, v82, v11 row_newbcast:13 row_mask:0xf bank_mask:0xf
s_waitcnt vmcnt(35)
v_mfma_f32_16x16x32_bf16 v[20:23], v[60:63], v[200:203], v[20:23]
v_mfma_f32_16x16x32_bf16 v[20:23], v[64:67], v[204:207], v[20:23]
v_mfma_f32_16x16x32_bf16 v[20:23], v[68:71], v[208:211], v[20:23]
v_mfma_f32_16x16x32_bf16 v[20:23], v[72:75], v[212:215], v[20:23]
v_add_u32 v117, 1, v117
buffer_store_dword v117, v118, s[64:67], 0 offen
buffer_load_dwordx4 v[200:203], v2, s[52:55], s12 offen offset:0 nt
buffer_load_dwordx4 v[204:207], v2, s[52:55], s12 offen offset:1024 nt
buffer_load_dwordx4 v[208:211], v2, s[52:55], s12 offen offset:2048 nt
buffer_load_dwordx4 v[212:215], v2, s[52:55], s12 offen offset:3072 nt
s_add_u32 s13, s13, 24576
s_min_u32 s12, s13, 2146435072
ds_read_b64_tr_b16 a[208:209], v88 offset:152
ds_read_b64_tr_b16 a[210:211], v88 offset:4760
ds_read_b64_tr_b16 a[212:213], v88 offset:37016
ds_read_b64_tr_b16 a[214:215], v88 offset:41624
v_and_b32_dpp v60, v77, v8 row_newbcast:1 row_mask:0xf bank_mask:0xf
v_and_b32_dpp v61, v77, v9 row_newbcast:1 row_mask:0xf bank_mask:0xf
v_and_b32_dpp v62, v77, v10 row_newbcast:1 row_mask:0xf bank_mask:0xf
v_and_b32_dpp v63, v77, v11 row_newbcast:1 row_mask:0xf bank_mask:0xf
v_and_b32_dpp v64, v77, v8 row_newbcast:5 row_mask:0xf bank_mask:0xf
v_and_b32_dpp v65, v77, v9 row_newbcast:5 row_mask:0xf bank_mask:0xf
v_and_b32_dpp v66, v77, v10 row_newbcast:5 row_mask:0xf bank_mask:0xf
v_and_b32_dpp v67, v77, v11 row_newbcast:5 row_mask:0xf bank_mask:0xf
v_and_b32_dpp v68, v77, v8 row_newbcast:9 row_mask:0xf bank_mask:0xf
v_and_b32_dpp v69, v77, v9 row_newbcast:9 row_mask:0xf bank_mask:0xf
v_and_b32_dpp v70, v77, v10 row_newbcast:9 row_mask:0xf bank_mask:0xf
v_and_b32_dpp v71, v77, v11 row_newbcast:9 row_mask:0xf bank_mask:0xf
v_and_b32_dpp v72, v77, v8 row_newbcast:13 row_mask:0xf bank_mask:0xf
v_and_b32_dpp v73, v77, v9 row_newbcast:13 row_mask:0xf bank_mask:0xf
v_and_b32_dpp v74, v77, v10 row_newbcast:13 row_mask:0xf bank_mask:0xf
v_and_b32_dpp v75, v77, v11 row_newbcast:13 row_mask:0xf bank_mask:0xf
v_mfma_f32_16x16x32_bf16 v[20:23], v[60:63], a[64:67], v[20:23]
v_mfma_f32_16x16x32_bf16 v[20:23], v[64:67], a[68:71], v[20:23]
v_mfma_f32_16x16x32_bf16 v[20:23], v[68:71], a[72:75], v[20:23]
v_mfma_f32_16x16x32_bf16 v[20:23], v[72:75], a[76:79], v[20:23]
s_nop 3
v_and_b32_dpp v60, v82, v8 row_newbcast:2 row_mask:0xf bank_mask:0xf
v_and_b32_dpp v61, v82, v9 row_newbcast:2 row_mask:0xf bank_mask:0xf
v_and_b32_dpp v62, v82, v10 row_newbcast:2 row_mask:0xf bank_mask:0xf
v_and_b32_dpp v63, v82, v11 row_newbcast:2 row_mask:0xf bank_mask:0xf
v_and_b32_dpp v64, v82, v8 row_newbcast:6 row_mask:0xf bank_mask:0xf
v_and_b32_dpp v65, v82, v9 row_newbcast:6 row_mask:0xf bank_mask:0xf
v_and_b32_dpp v66, v82, v10 row_newbcast:6 row_mask:0xf bank_mask:0xf
v_and_b32_dpp v67, v82, v11 row_newbcast:6 row_mask:0xf bank_mask:0xf
v_and_b32_dpp v68, v82, v8 row_newbcast:10 row_mask:0xf bank_mask:0xf
v_and_b32_dpp v69, v82, v9 row_newbcast:10 row_mask:0xf bank_mask:0xf
v_and_b32_dpp v70, v82, v10 row_newbcast:10 row_mask:0xf bank_mask:0xf
v_and_b32_dpp v71, v82, v11 row_newbcast:10 row_mask:0xf bank_mask:0xf
v_and_b32_dpp v72, v82, v8 row_newbcast:14 row_mask:0xf bank_mask:0xf
v_and_b32_dpp v73, v82, v9 row_newbcast:14 row_mask:0xf bank_mask:0xf
v_and_b32_dpp v74, v82, v10 row_newbcast:14 row_mask:0xf bank_mask:0xf
v_and_b32_dpp v75, v82, v11 row_newbcast:14 row_mask:0xf bank_mask:0xf
s_waitcnt vmcnt(35)
v_mfma_f32_16x16x32_bf16 v[20:23], v[60:63], v[216:219], v[20:23]
v_mfma_f32_16x16x32_bf16 v[20:23], v[64:67], v[220:223], v[20:23]
v_mfma_f32_16x16x32_bf16 v[20:23], v[68:71], v[224:227], v[20:23]
v_mfma_f32_16x16x32_bf16 v[20:23], v[72:75], v[228:231], v[20:23]
v_add_u32 v117, 1, v117
buffer_store_dword v117, v118, s[64:67], 0 offen
buffer_load_dwordx4 v[216:219], v2, s[52:55], s12 offen offset:0 nt
buffer_load_dwordx4 v[220:223], v2, s[52:55], s12 offen offset:1024 nt
buffer_load_dwordx4 v[224:227], v2, s[52:55], s12 offen offset:2048 nt
buffer_load_dwordx4 v[228:231], v2, s[52:55], s12 offen offset:3072 nt
s_add_u32 s13, s13, 24576
s_min_u32 s12, s13, 2146435072
ds_read_b64_tr_b16 a[216:217], v90 offset:152
ds_read_b64_tr_b16 a[218:219], v90 offset:4760
ds_read_b64_tr_b16 a[220:221], v90 offset:37016
ds_read_b64_tr_b16 a[222:223], v90 offset:41624
v_and_b32_dpp v60, v82, v8 row_newbcast:3 row_mask:0xf bank_mask:0xf
v_and_b32_dpp v61, v82, v9 row_newbcast:3 row_mask:0xf bank_mask:0xf
v_and_b32_dpp v62, v82, v10 row_newbcast:3 row_mask:0xf bank_mask:0xf
v_and_b32_dpp v63, v82, v11 row_newbcast:3 row_mask:0xf bank_mask:0xf
v_and_b32_dpp v64, v82, v8 row_newbcast:7 row_mask:0xf bank_mask:0xf
v_and_b32_dpp v65, v82, v9 row_newbcast:7 row_mask:0xf bank_mask:0xf
v_and_b32_dpp v66, v82, v10 row_newbcast:7 row_mask:0xf bank_mask:0xf
v_and_b32_dpp v67, v82, v11 row_newbcast:7 row_mask:0xf bank_mask:0xf
v_and_b32_dpp v68, v82, v8 row_newbcast:11 row_mask:0xf bank_mask:0xf
v_and_b32_dpp v69, v82, v9 row_newbcast:11 row_mask:0xf bank_mask:0xf
v_and_b32_dpp v70, v82, v10 row_newbcast:11 row_mask:0xf bank_mask:0xf
v_and_b32_dpp v71, v82, v11 row_newbcast:11 row_mask:0xf bank_mask:0xf
v_and_b32_dpp v72, v82, v8 row_newbcast:15 row_mask:0xf bank_mask:0xf
v_and_b32_dpp v73, v82, v9 row_newbcast:15 row_mask:0xf bank_mask:0xf
v_and_b32_dpp v74, v82, v10 row_newbcast:15 row_mask:0xf bank_mask:0xf
v_and_b32_dpp v75, v82, v11 row_newbcast:15 row_mask:0xf bank_mask:0xf
s_waitcnt vmcnt(35)
v_mfma_f32_16x16x32_bf16 v[20:23], v[60:63], v[232:235], v[20:23]
v_mfma_f32_16x16x32_bf16 v[20:23], v[64:67], v[236:239], v[20:23]
v_mfma_f32_16x16x32_bf16 v[20:23], v[68:71], v[240:243], v[20:23]
v_mfma_f32_16x16x32_bf16 v[20:23], v[72:75], v[244:247], v[20:23]
v_add_u32 v117, 1, v117
buffer_store_dword v117, v118, s[64:67], 0 offen
buffer_load_dwordx4 v[232:235], v2, s[52:55], s12 offen offset:0 nt
buffer_load_dwordx4 v[236:239], v2, s[52:55], s12 offen offset:1024 nt
buffer_load_dwordx4 v[240:243], v2, s[52:55], s12 offen offset:2048 nt
buffer_load_dwordx4 v[244:247], v2, s[52:55], s12 offen offset:3072 nt
s_add_u32 s13, s13, 24576
s_min_u32 s12, s13, 2146435072
ds_read_b64_tr_b16 a[224:225], v89 offset:0
ds_read_b64_tr_b16 a[226:227], v89 offset:4608
ds_read_b64_tr_b16 a[228:229], v89 offset:36864
ds_read_b64_tr_b16 a[230:231], v89 offset:41472
buffer_load_dwordx4 v[40:43], off, s[64:67], s82 offset:0 sc1
buffer_load_dwordx4 v[44:47], off, s[64:67], s82 offset:16 sc1
buffer_load_dwordx4 v[48:51], off, s[64:67], s82 offset:32 sc1
v_and_b32_dpp v60, v83, v8 row_newbcast:0 row_mask:0xf bank_mask:0xf
v_and_b32_dpp v61, v83, v9 row_newbcast:0 row_mask:0xf bank_mask:0xf
v_and_b32_dpp v62, v83, v10 row_newbcast:0 row_mask:0xf bank_mask:0xf
v_and_b32_dpp v63, v83, v11 row_newbcast:0 row_mask:0xf bank_mask:0xf
v_and_b32_dpp v64, v83, v8 row_newbcast:4 row_mask:0xf bank_mask:0xf
v_and_b32_dpp v65, v83, v9 row_newbcast:4 row_mask:0xf bank_mask:0xf
v_and_b32_dpp v66, v83, v10 row_newbcast:4 row_mask:0xf bank_mask:0xf
v_and_b32_dpp v67, v83, v11 row_newbcast:4 row_mask:0xf bank_mask:0xf
v_and_b32_dpp v68, v83, v8 row_newbcast:8 row_mask:0xf bank_mask:0xf
v_and_b32_dpp v69, v83, v9 row_newbcast:8 row_mask:0xf bank_mask:0xf
v_and_b32_dpp v70, v83, v10 row_newbcast:8 row_mask:0xf bank_mask:0xf
v_and_b32_dpp v71, v83, v11 row_newbcast:8 row_mask:0xf bank_mask:0xf
v_and_b32_dpp v72, v83, v8 row_newbcast:12 row_mask:0xf bank_mask:0xf
v_and_b32_dpp v73, v83, v9 row_newbcast:12 row_mask:0xf bank_mask:0xf
v_and_b32_dpp v74, v83, v10 row_newbcast:12 row_mask:0xf bank_mask:0xf
v_and_b32_dpp v75, v83, v11 row_newbcast:12 row_mask:0xf bank_mask:0xf
s_waitcnt vmcnt(38)
v_mfma_f32_16x16x32_bf16 v[20:23], v[60:63], v[120:123], v[20:23]
v_mfma_f32_16x16x32_bf16 v[20:23], v[64:67], v[124:127], v[20:23]
v_mfma_f32_16x16x32_bf16 v[20:23], v[68:71], v[128:131], v[20:23]
v_mfma_f32_16x16x32_bf16 v[20:23], v[72:75], v[132:135], v[20:23]
v_add_u32 v117, 1, v117
buffer_store_dword v117, v118, s[64:67], 0 offen
buffer_load_dwordx4 v[120:123], v2, s[52:55], s12 offen offset:0 nt
buffer_load_dwordx4 v[124:127], v2, s[52:55], s12 offen offset:1024 nt
buffer_load_dwordx4 v[128:131], v2, s[52:55], s12 offen offset:2048 nt
buffer_load_dwordx4 v[132:135], v2, s[52:55], s12 offen offset:3072 nt
s_add_u32 s13, s13, 24576
s_min_u32 s12, s13, 2146435072
ds_read_b64_tr_b16 a[232:233], v91 offset:0
ds_read_b64_tr_b16 a[234:235], v91 offset:4608
ds_read_b64_tr_b16 a[236:237], v91 offset:36864
ds_read_b64_tr_b16 a[238:239], v91 offset:41472
v_and_b32_dpp v60, v83, v8 row_newbcast:1 row_mask:0xf bank_mask:0xf
v_and_b32_dpp v61, v83, v9 row_newbcast:1 row_mask:0xf bank_mask:0xf
v_and_b32_dpp v62, v83, v10 row_newbcast:1 row_mask:0xf bank_mask:0xf
v_and_b32_dpp v63, v83, v11 row_newbcast:1 row_mask:0xf bank_mask:0xf
v_and_b32_dpp v64, v83, v8 row_newbcast:5 row_mask:0xf bank_mask:0xf
v_and_b32_dpp v65, v83, v9 row_newbcast:5 row_mask:0xf bank_mask:0xf
v_and_b32_dpp v66, v83, v10 row_newbcast:5 row_mask:0xf bank_mask:0xf
v_and_b32_dpp v67, v83, v11 row_newbcast:5 row_mask:0xf bank_mask:0xf
v_and_b32_dpp v68, v83, v8 row_newbcast:9 row_mask:0xf bank_mask:0xf
v_and_b32_dpp v69, v83, v9 row_newbcast:9 row_mask:0xf bank_mask:0xf
v_and_b32_dpp v70, v83, v10 row_newbcast:9 row_mask:0xf bank_mask:0xf
v_and_b32_dpp v71, v83, v11 row_newbcast:9 row_mask:0xf bank_mask:0xf
v_and_b32_dpp v72, v83, v8 row_newbcast:13 row_mask:0xf bank_mask:0xf
v_and_b32_dpp v73, v83, v9 row_newbcast:13 row_mask:0xf bank_mask:0xf
v_and_b32_dpp v74, v83, v10 row_newbcast:13 row_mask:0xf bank_mask:0xf
v_and_b32_dpp v75, v83, v11 row_newbcast:13 row_mask:0xf bank_mask:0xf
s_waitcnt vmcnt(38)
v_mfma_f32_16x16x32_bf16 v[20:23], v[60:63], v[136:139], v[20:23]
v_mfma_f32_16x16x32_bf16 v[20:23], v[64:67], v[140:143], v[20:23]
v_mfma_f32_16x16x32_bf16 v[20:23], v[68:71], v[144:147], v[20:23]
v_mfma_f32_16x16x32_bf16 v[20:23], v[72:75], v[148:151], v[20:23]
s_nop 3
v_and_b32_dpp v60, v83, v8 row_newbcast:2 row_mask:0xf bank_mask:0xf
v_and_b32_dpp v61, v83, v9 row_newbcast:2 row_mask:0xf bank_mask:0xf
v_and_b32_dpp v62, v83, v10 row_newbcast:2 row_mask:0xf bank_mask:0xf
v_and_b32_dpp v63, v83, v11 row_newbcast:2 row_mask:0xf bank_mask:0xf
v_and_b32_dpp v64, v83, v8 row_newbcast:6 row_mask:0xf bank_mask:0xf
v_and_b32_dpp v65, v83, v9 row_newbcast:6 row_mask:0xf bank_mask:0xf
v_and_b32_dpp v66, v83, v10 row_newbcast:6 row_mask:0xf bank_mask:0xf
v_and_b32_dpp v67, v83, v11 row_newbcast:6 row_mask:0xf bank_mask:0xf
v_and_b32_dpp v68, v83, v8 row_newbcast:10 row_mask:0xf bank_mask:0xf
v_and_b32_dpp v69, v83, v9 row_newbcast:10 row_mask:0xf bank_mask:0xf
v_and_b32_dpp v70, v83, v10 row_newbcast:10 row_mask:0xf bank_mask:0xf
v_and_b32_dpp v71, v83, v11 row_newbcast:10 row_mask:0xf bank_mask:0xf
v_and_b32_dpp v72, v83, v8 row_newbcast:14 row_mask:0xf bank_mask:0xf
v_and_b32_dpp v73, v83, v9 row_newbcast:14 row_mask:0xf bank_mask:0xf
v_and_b32_dpp v74, v83, v10 row_newbcast:14 row_mask:0xf bank_mask:0xf
v_and_b32_dpp v75, v83, v11 row_newbcast:14 row_mask:0xf bank_mask:0xf
s_waitcnt vmcnt(33)
v_mfma_f32_16x16x32_bf16 v[20:23], v[60:63], v[152:155], v[20:23]
v_mfma_f32_16x16x32_bf16 v[20:23], v[64:67], v[156:159], v[20:23]
v_mfma_f32_16x16x32_bf16 v[20:23], v[68:71], v[160:163], v[20:23]
v_mfma_f32_16x16x32_bf16 v[20:23], v[72:75], v[164:167], v[20:23]
v_add_u32 v117, 1, v117
buffer_store_dword v117, v118, s[64:67], 0 offen
buffer_load_dwordx4 v[136:139], v2, s[52:55], s12 offen offset:0 nt
buffer_load_dwordx4 v[140:143], v2, s[52:55], s12 offen offset:1024 nt
buffer_load_dwordx4 v[144:147], v2, s[52:55], s12 offen offset:2048 nt
buffer_load_dwordx4 v[148:151], v2, s[52:55], s12 offen offset:3072 nt
s_add_u32 s13, s13, 24576
s_min_u32 s12, s13, 2146435072
v_and_b32_dpp v60, v77, v8 row_newbcast:2 row_mask:0xf bank_mask:0xf
v_and_b32_dpp v61, v77, v9 row_newbcast:2 row_mask:0xf bank_mask:0xf
v_and_b32_dpp v62, v77, v10 row_newbcast:2 row_mask:0xf bank_mask:0xf
v_and_b32_dpp v63, v77, v11 row_newbcast:2 row_mask:0xf bank_mask:0xf
v_and_b32_dpp v64, v77, v8 row_newbcast:6 row_mask:0xf bank_mask:0xf
v_and_b32_dpp v65, v77, v9 row_newbcast:6 row_mask:0xf bank_mask:0xf
v_and_b32_dpp v66, v77, v10 row_newbcast:6 row_mask:0xf bank_mask:0xf
v_and_b32_dpp v67, v77, v11 row_newbcast:6 row_mask:0xf bank_mask:0xf
v_and_b32_dpp v68, v77, v8 row_newbcast:10 row_mask:0xf bank_mask:0xf
v_and_b32_dpp v69, v77, v9 row_newbcast:10 row_mask:0xf bank_mask:0xf
v_and_b32_dpp v70, v77, v10 row_newbcast:10 row_mask:0xf bank_mask:0xf
v_and_b32_dpp v71, v77, v11 row_newbcast:10 row_mask:0xf bank_mask:0xf
v_and_b32_dpp v72, v77, v8 row_newbcast:14 row_mask:0xf bank_mask:0xf
v_and_b32_dpp v73, v77, v9 row_newbcast:14 row_mask:0xf bank_mask:0xf
v_and_b32_dpp v74, v77, v10 row_newbcast:14 row_mask:0xf bank_mask:0xf
v_and_b32_dpp v75, v77, v11 row_newbcast:14 row_mask:0xf bank_mask:0xf
v_mfma_f32_16x16x32_bf16 v[20:23], v[60:63], a[80:83], v[20:23]
v_mfma_f32_16x16x32_bf16 v[20:23], v[64:67], a[84:87], v[20:23]
v_mfma_f32_16x16x32_bf16 v[20:23], v[68:71], a[88:91], v[20:23]
v_mfma_f32_16x16x32_bf16 v[20:23], v[72:75], a[92:95], v[20:23]
s_nop 3
v_and_b32_dpp v60, v83, v8 row_newbcast:3 row_mask:0xf bank_mask:0xf
v_and_b32_dpp v61, v83, v9 row_newbcast:3 row_mask:0xf bank_mask:0xf
v_and_b32_dpp v62, v83, v10 row_newbcast:3 row_mask:0xf bank_mask:0xf
v_and_b32_dpp v63, v83, v11 row_newbcast:3 row_mask:0xf bank_mask:0xf
v_and_b32_dpp v64, v83, v8 row_newbcast:7 row_mask:0xf bank_mask:0xf
v_and_b32_dpp v65, v83, v9 row_newbcast:7 row_mask:0xf bank_mask:0xf
v_and_b32_dpp v66, v83, v10 row_newbcast:7 row_mask:0xf bank_mask:0xf
v_and_b32_dpp v67, v83, v11 row_newbcast:7 row_mask:0xf bank_mask:0xf
v_and_b32_dpp v68, v83, v8 row_newbcast:11 row_mask:0xf bank_mask:0xf
v_and_b32_dpp v69, v83, v9 row_newbcast:11 row_mask:0xf bank_mask:0xf
v_and_b32_dpp v70, v83, v10 row_newbcast:11 row_mask:0xf bank_mask:0xf
v_and_b32_dpp v71, v83, v11 row_newbcast:11 row_mask:0xf bank_mask:0xf
v_and_b32_dpp v72, v83, v8 row_newbcast:15 row_mask:0xf bank_mask:0xf
v_and_b32_dpp v73, v83, v9 row_newbcast:15 row_mask:0xf bank_mask:0xf
v_and_b32_dpp v74, v83, v10 row_newbcast:15 row_mask:0xf bank_mask:0xf
v_and_b32_dpp v75, v83, v11 row_newbcast:15 row_mask:0xf bank_mask:0xf
s_waitcnt vmcnt(33)
v_mfma_f32_16x16x32_bf16 v[20:23], v[60:63], v[168:171], v[20:23]
v_mfma_f32_16x16x32_bf16 v[20:23], v[64:67], v[172:175], v[20:23]
v_mfma_f32_16x16x32_bf16 v[20:23], v[68:71], v[176:179], v[20:23]
v_mfma_f32_16x16x32_bf16 v[20:23], v[72:75], v[180:183], v[20:23]
s_nop 3
v_and_b32_dpp v60, v84, v8 row_newbcast:0 row_mask:0xf bank_mask:0xf
v_and_b32_dpp v61, v84, v9 row_newbcast:0 row_mask:0xf bank_mask:0xf
v_and_b32_dpp v62, v84, v10 row_newbcast:0 row_mask:0xf bank_mask:0xf
v_and_b32_dpp v63, v84, v11 row_newbcast:0 row_mask:0xf bank_mask:0xf
v_and_b32_dpp v64, v84, v8 row_newbcast:4 row_mask:0xf bank_mask:0xf
v_and_b32_dpp v65, v84, v9 row_newbcast:4 row_mask:0xf bank_mask:0xf
v_and_b32_dpp v66, v84, v10 row_newbcast:4 row_mask:0xf bank_mask:0xf
v_and_b32_dpp v67, v84, v11 row_newbcast:4 row_mask:0xf bank_mask:0xf
v_and_b32_dpp v68, v84, v8 row_newbcast:8 row_mask:0xf bank_mask:0xf
v_and_b32_dpp v69, v84, v9 row_newbcast:8 row_mask:0xf bank_mask:0xf
v_and_b32_dpp v70, v84, v10 row_newbcast:8 row_mask:0xf bank_mask:0xf
v_and_b32_dpp v71, v84, v11 row_newbcast:8 row_mask:0xf bank_mask:0xf
v_and_b32_dpp v72, v84, v8 row_newbcast:12 row_mask:0xf bank_mask:0xf
v_and_b32_dpp v73, v84, v9 row_newbcast:12 row_mask:0xf bank_mask:0xf
v_and_b32_dpp v74, v84, v10 row_newbcast:12 row_mask:0xf bank_mask:0xf
v_and_b32_dpp v75, v84, v11 row_newbcast:12 row_mask:0xf bank_mask:0xf
s_waitcnt vmcnt(28)
v_mfma_f32_16x16x32_bf16 v[20:23], v[60:63], v[184:187], v[20:23]
v_mfma_f32_16x16x32_bf16 v[20:23], v[64:67], v[188:191], v[20:23]
v_mfma_f32_16x16x32_bf16 v[20:23], v[68:71], v[192:195], v[20:23]
v_mfma_f32_16x16x32_bf16 v[20:23], v[72:75], v[196:199], v[20:23]
v_add_u32 v117, 1, v117
buffer_store_dword v117, v118, s[64:67], 0 offen
buffer_load_dwordx4 v[152:155], v2, s[52:55], s12 offen offset:0 nt
buffer_load_dwordx4 v[156:159], v2, s[52:55], s12 offen offset:1024 nt
buffer_load_dwordx4 v[160:163], v2, s[52:55], s12 offen offset:2048 nt
buffer_load_dwordx4 v[164:167], v2, s[52:55], s12 offen offset:3072 nt
s_add_u32 s13, s13, 24576
s_min_u32 s12, s13, 2146435072
v_and_b32_dpp v60, v84, v8 row_newbcast:1 row_mask:0xf bank_mask:0xf
v_and_b32_dpp v61, v84, v9 row_newbcast:1 row_mask:0xf bank_mask:0xf
v_and_b32_dpp v62, v84, v10 row_newbcast:1 row_mask:0xf bank_mask:0xf
v_and_b32_dpp v63, v84, v11 row_newbcast:1 row_mask:0xf bank_mask:0xf
v_and_b32_dpp v64, v84, v8 row_newbcast:5 row_mask:0xf bank_mask:0xf
v_and_b32_dpp v65, v84, v9 row_newbcast:5 row_mask:0xf bank_mask:0xf
v_and_b32_dpp v66, v84, v10 row_newbcast:5 row_mask:0xf bank_mask:0xf
v_and_b32_dpp v67, v84, v11 row_newbcast:5 row_mask:0xf bank_mask:0xf
v_and_b32_dpp v68, v84, v8 row_newbcast:9 row_mask:0xf bank_mask:0xf
v_and_b32_dpp v69, v84, v9 row_newbcast:9 row_mask:0xf bank_mask:0xf
v_and_b32_dpp v70, v84, v10 row_newbcast:9 row_mask:0xf bank_mask:0xf
v_and_b32_dpp v71, v84, v11 row_newbcast:9 row_mask:0xf bank_mask:0xf
v_and_b32_dpp v72, v84, v8 row_newbcast:13 row_mask:0xf bank_mask:0xf
v_and_b32_dpp v73, v84, v9 row_newbcast:13 row_mask:0xf bank_mask:0xf
v_and_b32_dpp v74, v84, v10 row_newbcast:13 row_mask:0xf bank_mask:0xf
v_and_b32_dpp v75, v84, v11 row_newbcast:13 row_mask:0xf bank_mask:0xf
s_waitcnt vmcnt(28)
v_mfma_f32_16x16x32_bf16 v[20:23], v[60:63], v[200:203], v[20:23]
v_mfma_f32_16x16x32_bf16 v[20:23], v[64:67], v[204:207], v[20:23]
v_mfma_f32_16x16x32_bf16 v[20:23], v[68:71], v[208:211], v[20:23]
v_mfma_f32_16x16x32_bf16 v[20:23], v[72:75], v[212:215], v[20:23]
s_nop 3
v_and_b32_dpp v60, v84, v8 row_newbcast:2 row_mask:0xf bank_mask:0xf
v_and_b32_dpp v61, v84, v9 row_newbcast:2 row_mask:0xf bank_mask:0xf
v_and_b32_dpp v62, v84, v10 row_newbcast:2 row_mask:0xf bank_mask:0xf
v_and_b32_dpp v63, v84, v11 row_newbcast:2 row_mask:0xf bank_mask:0xf
v_and_b32_dpp v64, v84, v8 row_newbcast:6 row_mask:0xf bank_mask:0xf
v_and_b32_dpp v65, v84, v9 row_newbcast:6 row_mask:0xf bank_mask:0xf
v_and_b32_dpp v66, v84, v10 row_newbcast:6 row_mask:0xf bank_mask:0xf
v_and_b32_dpp v67, v84, v11 row_newbcast:6 row_mask:0xf bank_mask:0xf
v_and_b32_dpp v68, v84, v8 row_newbcast:10 row_mask:0xf bank_mask:0xf
v_and_b32_dpp v69, v84, v9 row_newbcast:10 row_mask:0xf bank_mask:0xf
v_and_b32_dpp v70, v84, v10 row_newbcast:10 row_mask:0xf bank_mask:0xf
v_and_b32_dpp v71, v84, v11 row_newbcast:10 row_mask:0xf bank_mask:0xf
v_and_b32_dpp v72, v84, v8 row_newbcast:14 row_mask:0xf bank_mask:0xf
v_and_b32_dpp v73, v84, v9 row_newbcast:14 row_mask:0xf bank_mask:0xf
v_and_b32_dpp v74, v84, v10 row_newbcast:14 row_mask:0xf bank_mask:0xf
v_and_b32_dpp v75, v84, v11 row_newbcast:14 row_mask:0xf bank_mask:0xf
s_waitcnt vmcnt(23)
v_mfma_f32_16x16x32_bf16 v[20:23], v[60:63], v[216:219], v[20:23]
v_mfma_f32_16x16x32_bf16 v[20:23], v[64:67], v[220:223], v[20:23]
v_mfma_f32_16x16x32_bf16 v[20:23], v[68:71], v[224:227], v[20:23]
v_mfma_f32_16x16x32_bf16 v[20:23], v[72:75], v[228:231], v[20:23]
v_add_u32 v117, 1, v117
buffer_store_dword v117, v118, s[64:67], 0 offen
buffer_load_dwordx4 v[168:171], v2, s[52:55], s12 offen offset:0 nt
buffer_load_dwordx4 v[172:175], v2, s[52:55], s12 offen offset:1024 nt
buffer_load_dwordx4 v[176:179], v2, s[52:55], s12 offen offset:2048 nt
buffer_load_dwordx4 v[180:183], v2, s[52:55], s12 offen offset:3072 nt
s_add_u32 s13, s13, 24576
s_min_u32 s12, s13, 2146435072
v_and_b32_dpp v60, v84, v8 row_newbcast:3 row_mask:0xf bank_mask:0xf
v_and_b32_dpp v61, v84, v9 row_newbcast:3 row_mask:0xf bank_mask:0xf
v_and_b32_dpp v62, v84, v10 row_newbcast:3 row_mask:0xf bank_mask:0xf
v_and_b32_dpp v63, v84, v11 row_newbcast:3 row_mask:0xf bank_mask:0xf
v_and_b32_dpp v64, v84, v8 row_newbcast:7 row_mask:0xf bank_mask:0xf
v_and_b32_dpp v65, v84, v9 row_newbcast:7 row_mask:0xf bank_mask:0xf
v_and_b32_dpp v66, v84, v10 row_newbcast:7 row_mask:0xf bank_mask:0xf
v_and_b32_dpp v67, v84, v11 row_newbcast:7 row_mask:0xf bank_mask:0xf
v_and_b32_dpp v68, v84, v8 row_newbcast:11 row_mask:0xf bank_mask:0xf
v_and_b32_dpp v69, v84, v9 row_newbcast:11 row_mask:0xf bank_mask:0xf
v_and_b32_dpp v70, v84, v10 row_newbcast:11 row_mask:0xf bank_mask:0xf
v_and_b32_dpp v71, v84, v11 row_newbcast:11 row_mask:0xf bank_mask:0xf
v_and_b32_dpp v72, v84, v8 row_newbcast:15 row_mask:0xf bank_mask:0xf
v_and_b32_dpp v73, v84, v9 row_newbcast:15 row_mask:0xf bank_mask:0xf
v_and_b32_dpp v74, v84, v10 row_newbcast:15 row_mask:0xf bank_mask:0xf
v_and_b32_dpp v75, v84, v11 row_newbcast:15 row_mask:0xf bank_mask:0xf
s_waitcnt vmcnt(23)
v_mfma_f32_16x16x32_bf16 v[20:23], v[60:63], v[232:235], v[20:23]
v_mfma_f32_16x16x32_bf16 v[20:23], v[64:67], v[236:239], v[20:23]
v_mfma_f32_16x16x32_bf16 v[20:23], v[68:71], v[240:243], v[20:23]
v_mfma_f32_16x16x32_bf16 v[20:23], v[72:75], v[244:247], v[20:23]
s_nop 3
v_and_b32_dpp v60, v85, v8 row_newbcast:0 row_mask:0xf bank_mask:0xf
v_and_b32_dpp v61, v85, v9 row_newbcast:0 row_mask:0xf bank_mask:0xf
v_and_b32_dpp v62, v85, v10 row_newbcast:0 row_mask:0xf bank_mask:0xf
v_and_b32_dpp v63, v85, v11 row_newbcast:0 row_mask:0xf bank_mask:0xf
v_and_b32_dpp v64, v85, v8 row_newbcast:4 row_mask:0xf bank_mask:0xf
v_and_b32_dpp v65, v85, v9 row_newbcast:4 row_mask:0xf bank_mask:0xf
v_and_b32_dpp v66, v85, v10 row_newbcast:4 row_mask:0xf bank_mask:0xf
v_and_b32_dpp v67, v85, v11 row_newbcast:4 row_mask:0xf bank_mask:0xf
v_and_b32_dpp v68, v85, v8 row_newbcast:8 row_mask:0xf bank_mask:0xf
v_and_b32_dpp v69, v85, v9 row_newbcast:8 row_mask:0xf bank_mask:0xf
v_and_b32_dpp v70, v85, v10 row_newbcast:8 row_mask:0xf bank_mask:0xf
v_and_b32_dpp v71, v85, v11 row_newbcast:8 row_mask:0xf bank_mask:0xf
v_and_b32_dpp v72, v85, v8 row_newbcast:12 row_mask:0xf bank_mask:0xf
v_and_b32_dpp v73, v85, v9 row_newbcast:12 row_mask:0xf bank_mask:0xf
v_and_b32_dpp v74, v85, v10 row_newbcast:12 row_mask:0xf bank_mask:0xf
v_and_b32_dpp v75, v85, v11 row_newbcast:12 row_mask:0xf bank_mask:0xf
s_waitcnt vmcnt(15)
v_mfma_f32_16x16x32_bf16 v[20:23], v[60:63], v[120:123], v[20:23]
v_mfma_f32_16x16x32_bf16 v[20:23], v[64:67], v[124:127], v[20:23]
v_mfma_f32_16x16x32_bf16 v[20:23], v[68:71], v[128:131], v[20:23]
v_mfma_f32_16x16x32_bf16 v[20:23], v[72:75], v[132:135], v[20:23]
v_add_u32 v117, 1, v117
buffer_store_dword v117, v118, s[64:67], 0 offen
buffer_load_dwordx4 v[184:187], v2, s[52:55], s12 offen offset:0 nt
buffer_load_dwordx4 v[188:191], v2, s[52:55], s12 offen offset:1024 nt
buffer_load_dwordx4 v[192:195], v2, s[52:55], s12 offen offset:2048 nt
buffer_load_dwordx4 v[196:199], v2, s[52:55], s12 offen offset:3072 nt
s_add_u32 s13, s13, 24576
s_min_u32 s12, s13, 2146435072
s_mov_b32 s7, 400000
A_ev2_chk:
v_max3_u32 v35, v40, v41, v42
v_max3_u32 v35, v35, v43, v44
v_max3_u32 v35, v35, v45, v46
v_max3_u32 v35, v35, v47, v48
v_max3_u32 v35, v35, v49, v50
v_max_u32 v35, v35, v51
v_cmp_eq_u32 vcc, -1, v35
s_cbranch_vccz A_ev2_ok
buffer_load_dwordx4 v[40:43], off, s[64:67], s82 offset:0 sc1
buffer_load_dwordx4 v[44:47], off, s[64:67], s82 offset:16 sc1
buffer_load_dwordx4 v[48:51], off, s[64:67], s82 offset:32 sc1
s_waitcnt vmcnt(0)
s_sub_u32 s7, s7, 1
s_cmp_lg_u32 s7, 0
s_cbranch_scc1 A_ev2_chk
A_ev2_ok:
v_max3_f32 v35, v40, v42, v44
v_max3_f32 v36, v46, v48, v50
v_max_f32 v35, v35, v36
v_sub_f32 v40, v40, v35
v_sub_f32 v42, v42, v35
v_sub_f32 v44, v44, v35
v_sub_f32 v46, v46, v35
v_sub_f32 v48, v48, v35
v_sub_f32 v50, v50, v35
v_sub_f32 v37, v32, v35
v_exp_f32 v40, v40
v_exp_f32 v42, v42
v_exp_f32 v44, v44
v_exp_f32 v46, v46
v_exp_f32 v48, v48
v_exp_f32 v50, v50
v_exp_f32 v37, v37
v_mul_f32 v35, v40, v41
v_fma_f32 v35, v42, v43, v35
v_fma_f32 v35, v44, v45, v35
v_fma_f32 v35, v46, v47, v35
v_fma_f32 v35, v48, v49, v35
v_fma_f32 v35, v50, v51, v35
v_rcp_f32 v35, v35
s_nop 0
v_mul_f32 v37, v37, v35
v_and_b32_dpp v60, v85, v8 row_newbcast:1 row_mask:0xf bank_mask:0xf
v_and_b32_dpp v61, v85, v9 row_newbcast:1 row_mask:0xf bank_mask:0xf
v_and_b32_dpp v62, v85, v10 row_newbcast:1 row_mask:0xf bank_mask:0xf
v_and_b32_dpp v63, v85, v11 row_newbcast:1 row_mask:0xf bank_mask:0xf
v_and_b32_dpp v64, v85, v8 row_newbcast:5 row_mask:0xf bank_mask:0xf
v_and_b32_dpp v65, v85, v9 row_newbcast:5 row_mask:0xf bank_mask:0xf
v_and_b32_dpp v66, v85, v10 row_newbcast:5 row_mask:0xf bank_mask:0xf
v_and_b32_dpp v67, v85, v11 row_newbcast:5 row_mask:0xf bank_mask:0xf
v_and_b32_dpp v68, v85, v8 row_newbcast:9 row_mask:0xf bank_mask:0xf
v_and_b32_dpp v69, v85, v9 row_newbcast:9 row_mask:0xf bank_mask:0xf
v_and_b32_dpp v70, v85, v10 row_newbcast:9 row_mask:0xf bank_mask:0xf
v_and_b32_dpp v71, v85, v11 row_newbcast:9 row_mask:0xf bank_mask:0xf
v_and_b32_dpp v72, v85, v8 row_newbcast:13 row_mask:0xf bank_mask:0xf
v_and_b32_dpp v73, v85, v9 row_newbcast:13 row_mask:0xf bank_mask:0xf
v_and_b32_dpp v74, v85, v10 row_newbcast:13 row_mask:0xf bank_mask:0xf
v_and_b32_dpp v75, v85, v11 row_newbcast:13 row_mask:0xf bank_mask:0xf
s_waitcnt vmcnt(15)
v_mfma_f32_16x16x32_bf16 v[20:23], v[60:63], v[136:139], v[20:23]
v_mfma_f32_16x16x32_bf16 v[20:23], v[64:67], v[140:143], v[20:23]
v_mfma_f32_16x16x32_bf16 v[20:23], v[68:71], v[144:147], v[20:23]
v_mfma_f32_16x16x32_bf16 v[20:23], v[72:75], v[148:151], v[20:23]
v_add_u32 v117, 1, v117
buffer_store_dword v117, v118, s[64:67], 0 offen
buffer_load_dwordx4 v[200:203], v2, s[52:55], s12 offen offset:0 nt
buffer_load_dwordx4 v[204:207], v2, s[52:55], s12 offen offset:1024 nt
buffer_load_dwordx4 v[208:211], v2, s[52:55], s12 offen offset:2048 nt
buffer_load_dwordx4 v[212:215], v2, s[52:55], s12 offen offset:3072 nt
s_add_u32 s13, s13, 24576
s_min_u32 s12, s13, 2146435072
v_and_b32_dpp v60, v77, v8 row_newbcast:3 row_mask:0xf bank_mask:0xf
v_and_b32_dpp v61, v77, v9 row_newbcast:3 row_mask:0xf bank_mask:0xf
v_and_b32_dpp v62, v77, v10 row_newbcast:3 row_mask:0xf bank_mask:0xf
v_and_b32_dpp v63, v77, v11 row_newbcast:3 row_mask:0xf bank_mask:0xf
v_and_b32_dpp v64, v77, v8 row_newbcast:7 row_mask:0xf bank_mask:0xf
v_and_b32_dpp v65, v77, v9 row_newbcast:7 row_mask:0xf bank_mask:0xf
v_and_b32_dpp v66, v77, v10 row_newbcast:7 row_mask:0xf bank_mask:0xf
v_and_b32_dpp v67, v77, v11 row_newbcast:7 row_mask:0xf bank_mask:0xf
v_and_b32_dpp v68, v77, v8 row_newbcast:11 row_mask:0xf bank_mask:0xf
v_and_b32_dpp v69, v77, v9 row_newbcast:11 row_mask:0xf bank_mask:0xf
v_and_b32_dpp v70, v77, v10 row_newbcast:11 row_mask:0xf bank_mask:0xf
v_and_b32_dpp v71, v77, v11 row_newbcast:11 row_mask:0xf bank_mask:0xf
v_and_b32_dpp v72, v77, v8 row_newbcast:15 row_mask:0xf bank_mask:0xf
v_and_b32_dpp v73, v77, v9 row_newbcast:15 row_mask:0xf bank_mask:0xf
v_and_b32_dpp v74, v77, v10 row_newbcast:15 row_mask:0xf bank_mask:0xf
v_and_b32_dpp v75, v77, v11 row_newbcast:15 row_mask:0xf bank_mask:0xf
v_mfma_f32_16x16x32_bf16 v[20:23], v[60:63], a[240:243], v[20:23]
v_mfma_f32_16x16x32_bf16 v[20:23], v[64:67], a[244:247], v[20:23]
v_mfma_f32_16x16x32_bf16 v[20:23], v[68:71], a[248:251], v[20:23]
v_mfma_f32_16x16x32_bf16 v[20:23], v[72:75], a[252:255], v[20:23]
s_nop 3
v_and_b32_dpp v60, v85, v8 row_newbcast:2 row_mask:0xf bank_mask:0xf
v_and_b32_dpp v61, v85, v9 row_newbcast:2 row_mask:0xf bank_mask:0xf
v_and_b32_dpp v62, v85, v10 row_newbcast:2 row_mask:0xf bank_mask:0xf
v_and_b32_dpp v63, v85, v11 row_newbcast:2 row_mask:0xf bank_mask:0xf
v_and_b32_dpp v64, v85, v8 row_newbcast:6 row_mask:0xf bank_mask:0xf
v_and_b32_dpp v65, v85, v9 row_newbcast:6 row_mask:0xf bank_mask:0xf
v_and_b32_dpp v66, v85, v10 row_newbcast:6 row_mask:0xf bank_mask:0xf
v_and_b32_dpp v67, v85, v11 row_newbcast:6 row_mask:0xf bank_mask:0xf
v_and_b32_dpp v68, v85, v8 row_newbcast:10 row_mask:0xf bank_mask:0xf
v_and_b32_dpp v69, v85, v9 row_newbcast:10 row_mask:0xf bank_mask:0xf
v_and_b32_dpp v70, v85, v10 row_newbcast:10 row_mask:0xf bank_mask:0xf
v_and_b32_dpp v71, v85, v11 row_newbcast:10 row_mask:0xf bank_mask:0xf
v_and_b32_dpp v72, v85, v8 row_newbcast:14 row_mask:0xf bank_mask:0xf
v_and_b32_dpp v73, v85, v9 row_newbcast:14 row_mask:0xf bank_mask:0xf
v_and_b32_dpp v74, v85, v10 row_newbcast:14 row_mask:0xf bank_mask:0xf
v_and_b32_dpp v75, v85, v11 row_newbcast:14 row_mask:0xf bank_mask:0xf
s_waitcnt vmcnt(15)
v_mfma_f32_16x16x32_bf16 v[20:23], v[60:63], v[152:155], v[20:23]
v_mfma_f32_16x16x32_bf16 v[20:23], v[64:67], v[156:159], v[20:23]
v_mfma_f32_16x16x32_bf16 v[20:23], v[68:71], v[160:163], v[20:23]
v_mfma_f32_16x16x32_bf16 v[20:23], v[72:75], v[164:167], v[20:23]
v_add_u32 v117, 1, v117
buffer_store_dword v117, v118, s[64:67], 0 offen
buffer_load_dwordx4 v[216:219], v2, s[52:55], s12 offen offset:0 nt
buffer_load_dwordx4 v[220:223], v2, s[52:55], s12 offen offset:1024 nt
buffer_load_dwordx4 v[224:227], v2, s[52:55], s12 offen offset:2048 nt
buffer_load_dwordx4 v[228:231], v2, s[52:55], s12 offen offset:3072 nt
s_add_u32 s13, s13, 24576
s_min_u32 s12, s13, 2146435072
v_and_b32_dpp v60, v85, v8 row_newbcast:3 row_mask:0xf bank_mask:0xf
v_and_b32_dpp v61, v85, v9 row_newbcast:3 row_mask:0xf bank_mask:0xf
v_and_b32_dpp v62, v85, v10 row_newbcast:3 row_mask:0xf bank_mask:0xf
v_and_b32_dpp v63, v85, v11 row_newbcast:3 row_mask:0xf bank_mask:0xf
v_and_b32_dpp v64, v85, v8 row_newbcast:7 row_mask:0xf bank_mask:0xf
v_and_b32_dpp v65, v85, v9 row_newbcast:7 row_mask:0xf bank_mask:0xf
v_and_b32_dpp v66, v85, v10 row_newbcast:7 row_mask:0xf bank_mask:0xf
v_and_b32_dpp v67, v85, v11 row_newbcast:7 row_mask:0xf bank_mask:0xf
v_and_b32_dpp v68, v85, v8 row_newbcast:11 row_mask:0xf bank_mask:0xf
v_and_b32_dpp v69, v85, v9 row_newbcast:11 row_mask:0xf bank_mask:0xf
v_and_b32_dpp v70, v85, v10 row_newbcast:11 row_mask:0xf bank_mask:0xf
v_and_b32_dpp v71, v85, v11 row_newbcast:11 row_mask:0xf bank_mask:0xf
v_and_b32_dpp v72, v85, v8 row_newbcast:15 row_mask:0xf bank_mask:0xf
v_and_b32_dpp v73, v85, v9 row_newbcast:15 row_mask:0xf bank_mask:0xf
v_and_b32_dpp v74, v85, v10 row_newbcast:15 row_mask:0xf bank_mask:0xf
v_and_b32_dpp v75, v85, v11 row_newbcast:15 row_mask:0xf bank_mask:0xf
s_waitcnt vmcnt(15)
v_mfma_f32_16x16x32_bf16 v[20:23], v[60:63], v[168:171], v[20:23]
v_mfma_f32_16x16x32_bf16 v[20:23], v[64:67], v[172:175], v[20:23]
v_mfma_f32_16x16x32_bf16 v[20:23], v[68:71], v[176:179], v[20:23]
v_mfma_f32_16x16x32_bf16 v[20:23], v[72:75], v[180:183], v[20:23]
v_add_u32 v117, 1, v117
buffer_store_dword v117, v118, s[64:67], 0 offen
buffer_load_dwordx4 v[232:235], v2, s[52:55], s12 offen offset:0 nt
buffer_load_dwordx4 v[236:239], v2, s[52:55], s12 offen offset:1024 nt
buffer_load_dwordx4 v[240:243], v2, s[52:55], s12 offen offset:2048 nt
buffer_load_dwordx4 v[244:247], v2, s[52:55], s12 offen offset:3072 nt
s_add_u32 s13, s13, 24576
s_min_u32 s12, s13, 2146435072
v_and_b32_dpp v60, v86, v8 row_newbcast:0 row_mask:0xf bank_mask:0xf
v_and_b32_dpp v61, v86, v9 row_newbcast:0 row_mask:0xf bank_mask:0xf
v_and_b32_dpp v62, v86, v10 row_newbcast:0 row_mask:0xf bank_mask:0xf
v_and_b32_dpp v63, v86, v11 row_newbcast:0 row_mask:0xf bank_mask:0xf
v_and_b32_dpp v64, v86, v8 row_newbcast:4 row_mask:0xf bank_mask:0xf
v_and_b32_dpp v65, v86, v9 row_newbcast:4 row_mask:0xf bank_mask:0xf
v_and_b32_dpp v66, v86, v10 row_newbcast:4 row_mask:0xf bank_mask:0xf
v_and_b32_dpp v67, v86, v11 row_newbcast:4 row_mask:0xf bank_mask:0xf
v_and_b32_dpp v68, v86, v8 row_newbcast:8 row_mask:0xf bank_mask:0xf
v_and_b32_dpp v69, v86, v9 row_newbcast:8 row_mask:0xf bank_mask:0xf
v_and_b32_dpp v70, v86, v10 row_newbcast:8 row_mask:0xf bank_mask:0xf
v_and_b32_dpp v71, v86, v11 row_newbcast:8 row_mask:0xf bank_mask:0xf
v_and_b32_dpp v72, v86, v8 row_newbcast:12 row_mask:0xf bank_mask:0xf
v_and_b32_dpp v73, v86, v9 row_newbcast:12 row_mask:0xf bank_mask:0xf
v_and_b32_dpp v74, v86, v10 row_newbcast:12 row_mask:0xf bank_mask:0xf
v_and_b32_dpp v75, v86, v11 row_newbcast:12 row_mask:0xf bank_mask:0xf
s_waitcnt vmcnt(15)
v_mfma_f32_16x16x32_bf16 v[20:23], v[60:63], v[184:187], v[20:23]
v_mfma_f32_16x16x32_bf16 v[20:23], v[64:67], v[188:191], v[20:23]
v_mfma_f32_16x16x32_bf16 v[20:23], v[68:71], v[192:195], v[20:23]
v_mfma_f32_16x16x32_bf16 v[20:23], v[72:75], v[196:199], v[20:23]
s_nop 3
v_and_b32_dpp v60, v86, v8 row_newbcast:1 row_mask:0xf bank_mask:0xf
v_and_b32_dpp v61, v86, v9 row_newbcast:1 row_mask:0xf bank_mask:0xf
v_and_b32_dpp v62, v86, v10 row_newbcast:1 row_mask:0xf bank_mask:0xf
v_and_b32_dpp v63, v86, v11 row_newbcast:1 row_mask:0xf bank_mask:0xf
v_and_b32_dpp v64, v86, v8 row_newbcast:5 row_mask:0xf bank_mask:0xf
v_and_b32_dpp v65, v86, v9 row_newbcast:5 row_mask:0xf bank_mask:0xf
v_and_b32_dpp v66, v86, v10 row_newbcast:5 row_mask:0xf bank_mask:0xf
v_and_b32_dpp v67, v86, v11 row_newbcast:5 row_mask:0xf bank_mask:0xf
v_and_b32_dpp v68, v86, v8 row_newbcast:9 row_mask:0xf bank_mask:0xf
v_and_b32_dpp v69, v86, v9 row_newbcast:9 row_mask:0xf bank_mask:0xf
v_and_b32_dpp v70, v86, v10 row_newbcast:9 row_mask:0xf bank_mask:0xf
v_and_b32_dpp v71, v86, v11 row_newbcast:9 row_mask:0xf bank_mask:0xf
v_and_b32_dpp v72, v86, v8 row_newbcast:13 row_mask:0xf bank_mask:0xf
v_and_b32_dpp v73, v86, v9 row_newbcast:13 row_mask:0xf bank_mask:0xf
v_and_b32_dpp v74, v86, v10 row_newbcast:13 row_mask:0xf bank_mask:0xf
v_and_b32_dpp v75, v86, v11 row_newbcast:13 row_mask:0xf bank_mask:0xf
s_waitcnt vmcnt(10)
v_mfma_f32_16x16x32_bf16 v[20:23], v[60:63], v[200:203], v[20:23]
v_mfma_f32_16x16x32_bf16 v[20:23], v[64:67], v[204:207], v[20:23]
v_mfma_f32_16x16x32_bf16 v[20:23], v[68:71], v[208:211], v[20:23]
v_mfma_f32_16x16x32_bf16 v[20:23], v[72:75], v[212:215], v[20:23]
s_nop 3
v_and_b32_dpp v60, v86, v8 row_newbcast:2 row_mask:0xf bank_mask:0xf
v_and_b32_dpp v61, v86, v9 row_newbcast:2 row_mask:0xf bank_mask:0xf
v_and_b32_dpp v62, v86, v10 row_newbcast:2 row_mask:0xf bank_mask:0xf
v_and_b32_dpp v63, v86, v11 row_newbcast:2 row_mask:0xf bank_mask:0xf
v_and_b32_dpp v64, v86, v8 row_newbcast:6 row_mask:0xf bank_mask:0xf
v_and_b32_dpp v65, v86, v9 row_newbcast:6 row_mask:0xf bank_mask:0xf
v_and_b32_dpp v66, v86, v10 row_newbcast:6 row_mask:0xf bank_mask:0xf
v_and_b32_dpp v67, v86, v11 row_newbcast:6 row_mask:0xf bank_mask:0xf
v_and_b32_dpp v68, v86, v8 row_newbcast:10 row_mask:0xf bank_mask:0xf
v_and_b32_dpp v69, v86, v9 row_newbcast:10 row_mask:0xf bank_mask:0xf
v_and_b32_dpp v70, v86, v10 row_newbcast:10 row_mask:0xf bank_mask:0xf
v_and_b32_dpp v71, v86, v11 row_newbcast:10 row_mask:0xf bank_mask:0xf
v_and_b32_dpp v72, v86, v8 row_newbcast:14 row_mask:0xf bank_mask:0xf
v_and_b32_dpp v73, v86, v9 row_newbcast:14 row_mask:0xf bank_mask:0xf
v_and_b32_dpp v74, v86, v10 row_newbcast:14 row_mask:0xf bank_mask:0xf
v_and_b32_dpp v75, v86, v11 row_newbcast:14 row_mask:0xf bank_mask:0xf
v_and_b32_dpp v184, v86, v8 row_newbcast:3 row_mask:0xf bank_mask:0xf
v_and_b32_dpp v185, v86, v9 row_newbcast:3 row_mask:0xf bank_mask:0xf
v_and_b32_dpp v186, v86, v10 row_newbcast:3 row_mask:0xf bank_mask:0xf
v_and_b32_dpp v187, v86, v11 row_newbcast:3 row_mask:0xf bank_mask:0xf
v_and_b32_dpp v188, v86, v8 row_newbcast:7 row_mask:0xf bank_mask:0xf
v_and_b32_dpp v189, v86, v9 row_newbcast:7 row_mask:0xf bank_mask:0xf
v_and_b32_dpp v190, v86, v10 row_newbcast:7 row_mask:0xf bank_mask:0xf
v_and_b32_dpp v191, v86, v11 row_newbcast:7 row_mask:0xf bank_mask:0xf
v_and_b32_dpp v192, v86, v8 row_newbcast:11 row_mask:0xf bank_mask:0xf
v_and_b32_dpp v193, v86, v9 row_newbcast:11 row_mask:0xf bank_mask:0xf
v_and_b32_dpp v194, v86, v10 row_newbcast:11 row_mask:0xf bank_mask:0xf
v_and_b32_dpp v195, v86, v11 row_newbcast:11 row_mask:0xf bank_mask:0xf
v_and_b32_dpp v196, v86, v8 row_newbcast:15 row_mask:0xf bank_mask:0xf
v_and_b32_dpp v197, v86, v9 row_newbcast:15 row_mask:0xf bank_mask:0xf
v_and_b32_dpp v198, v86, v10 row_newbcast:15 row_mask:0xf bank_mask:0xf
v_and_b32_dpp v199, v86, v11 row_newbcast:15 row_mask:0xf bank_mask:0xf
s_waitcnt vmcnt(5)
v_mfma_f32_16x16x32_bf16 v[20:23], v[60:63], v[216:219], v[20:23]
v_mfma_f32_16x16x32_bf16 v[20:23], v[64:67], v[220:223], v[20:23]
v_mfma_f32_16x16x32_bf16 v[20:23], v[68:71], v[224:227], v[20:23]
v_mfma_f32_16x16x32_bf16 v[20:23], v[72:75], v[228:231], v[20:23]
s_waitcnt vmcnt(3)
v_mfma_f32_16x16x32_bf16 v[20:23], v[184:187], v[232:235], v[20:23]
s_waitcnt vmcnt(2)
v_mfma_f32_16x16x32_bf16 v[20:23], v[188:191], v[236:239], v[20:23]
s_waitcnt vmcnt(1)
v_mfma_f32_16x16x32_bf16 v[20:23], v[192:195], v[240:243], v[20:23]
s_waitcnt vmcnt(0)
v_mfma_f32_16x16x32_bf16 v[20:23], v[196:199], v[244:247], v[20:23]
A_tail:
s_nop 7
v_mul_f32 v20, v20, v37
v_mul_f32 v21, v21, v37
v_mul_f32 v22, v22, v37
v_mul_f32 v23, v23, v37
v_cvt_pk_bf16_f32 v28, v20, v21
v_cvt_pk_bf16_f32 v29, v22, v23
ds_write_b64 v94, v[28:29]
s_waitcnt lgkmcnt(0)
s_barrier
ds_read_b128 a[0:3], v95 offset:0
ds_read_b128 a[4:7], v95 offset:64
ds_read_b128 a[8:11], v95 offset:128
ds_read_b128 a[12:15], v95 offset:192
s_waitcnt lgkmcnt(0)
v_mfma_f32_16x16x32_bf16 v[72:75], a[0:3], a[224:227], 0
v_mfma_f32_16x16x32_bf16 v[72:75], a[4:7], a[228:231], v[72:75]
v_mfma_f32_16x16x32_bf16 v[72:75], a[8:11], a[232:235], v[72:75]
v_mfma_f32_16x16x32_bf16 v[72:75], a[12:15], a[236:239], v[72:75]
v_mfma_f32_16x16x32_bf16 v[40:43], a[0:3], a[96:99], 0
v_mfma_f32_16x16x32_bf16 v[40:43], a[4:7], a[100:103], v[40:43]
v_mfma_f32_16x16x32_bf16 v[40:43], a[8:11], a[104:107], v[40:43]
v_mfma_f32_16x16x32_bf16 v[40:43], a[12:15], a[108:111], v[40:43]
v_mfma_f32_16x16x32_bf16 v[44:47], a[0:3], a[112:115], 0
v_mfma_f32_16x16x32_bf16 v[44:47], a[4:7], a[116:119], v[44:47]
v_mfma_f32_16x16x32_bf16 v[44:47], a[8:11], a[120:123], v[44:47]
v_mfma_f32_16x16x32_bf16 v[44:47], a[12:15], a[124:127], v[44:47]
v_mul_f32 v114, v106, v72
v_fma_f32 v114, v107, v73, v114
v_fma_f32 v114, v108, v74, v114
v_fma_f32 v114, v109, v75, v114
v_mfma_f32_16x16x32_bf16 v[48:51], a[0:3], a[128:131], 0
v_mfma_f32_16x16x32_bf16 v[48:51], a[4:7], a[132:135], v[48:51]
v_mfma_f32_16x16x32_bf16 v[48:51], a[8:11], a[136:139], v[48:51]
v_mfma_f32_16x16x32_bf16 v[48:51], a[12:15], a[140:143], v[48:51]
v_mov_b32_dpp v29, v114 row_shl:2 row_mask:0xf bank_mask:0xf
v_cvt_pk_bf16_f32 v28, v114, v29
v_min_u32 v28, -2, v28
s_nop 1
v_mov_b32_dpp v29, v28 row_shl:4 row_mask:0xf bank_mask:0xf
v_mov_b32_dpp v30, v28 row_shl:8 row_mask:0xf bank_mask:0xf
v_mov_b32_dpp v31, v28 row_shl:12 row_mask:0xf bank_mask:0xf
s_mov_b32 exec_lo, 0x00030003
s_mov_b32 exec_hi, 0
buffer_store_dwordx4 v[28:31], v93, s[64:67], 0 offen offset:1024 sc1
s_mov_b64 exec, -1
v_mul_f32 v98, v106, v40
v_fma_f32 v98, v107, v41, v98
v_fma_f32 v98, v108, v42, v98
v_fma_f32 v98, v109, v43, v98
v_mfma_f32_16x16x32_bf16 v[52:55], a[0:3], a[144:147], 0
v_mfma_f32_16x16x32_bf16 v[52:55], a[4:7], a[148:151], v[52:55]
v_mfma_f32_16x16x32_bf16 v[52:55], a[8:11], a[152:155], v[52:55]
v_mfma_f32_16x16x32_bf16 v[52:55], a[12:15], a[156:159], v[52:55]
v_mul_f32 v99, v106, v44
v_fma_f32 v99, v107, v45, v99
v_fma_f32 v99, v108, v46, v99
v_fma_f32 v99, v109, v47, v99
v_mfma_f32_16x16x32_bf16 v[56:59], a[0:3], a[160:163], 0
v_mfma_f32_16x16x32_bf16 v[56:59], a[4:7], a[164:167], v[56:59]
v_mfma_f32_16x16x32_bf16 v[56:59], a[8:11], a[168:171], v[56:59]
v_mfma_f32_16x16x32_bf16 v[56:59], a[12:15], a[172:175], v[56:59]
v_mul_f32 v100, v106, v48
v_fma_f32 v100, v107, v49, v100
v_fma_f32 v100, v108, v50, v100
v_fma_f32 v100, v109, v51, v100
v_cvt_pk_bf16_f32 v110, v98, v99
v_min_u32 v110, -2, v110
v_mfma_f32_16x16x32_bf16 v[60:63], a[0:3], a[176:179], 0
v_mfma_f32_16x16x32_bf16 v[60:63], a[4:7], a[180:183], v[60:63]
v_mfma_f32_16x16x32_bf16 v[60:63], a[8:11], a[184:187], v[60:63]
v_mfma_f32_16x16x32_bf16 v[60:63], a[12:15], a[188:191], v[60:63]
v_mul_f32 v101, v106, v52
v_fma_f32 v101, v107, v53, v101
v_fma_f32 v101, v108, v54, v101
v_fma_f32 v101, v109, v55, v101
v_mfma_f32_16x16x32_bf16 v[64:67], a[0:3], a[192:195], 0
v_mfma_f32_16x16x32_bf16 v[64:67], a[4:7], a[196:199], v[64:67]
v_mfma_f32_16x16x32_bf16 v[64:67], a[8:11], a[200:203], v[64:67]
v_mfma_f32_16x16x32_bf16 v[64:67], a[12:15], a[204:207], v[64:67]
v_mul_f32 v102, v106, v56
v_fma_f32 v102, v107, v57, v102
v_fma_f32 v102, v108, v58, v102
v_fma_f32 v102, v109, v59, v102
v_cvt_pk_bf16_f32 v111, v100, v101
v_min_u32 v111, -2, v111
v_mfma_f32_16x16x32_bf16 v[68:71], a[0:3], a[208:211], 0
v_mfma_f32_16x16x32_bf16 v[68:71], a[4:7], a[212:215], v[68:71]
v_mfma_f32_16x16x32_bf16 v[68:71], a[8:11], a[216:219], v[68:71]
v_mfma_f32_16x16x32_bf16 v[68:71], a[12:15], a[220:223], v[68:71]
v_mul_f32 v103, v106, v60
v_fma_f32 v103, v107, v61, v103
v_fma_f32 v103, v108, v62, v103
v_fma_f32 v103, v109, v63, v103
v_cvt_pk_bf16_f32 v112, v102, v103
v_min_u32 v112, -2, v112
v_mul_f32 v104, v106, v64
v_fma_f32 v104, v107, v65, v104
v_fma_f32 v104, v108, v66, v104
v_fma_f32 v104, v109, v67, v104
s_mov_b64 exec, 0xffffffff
v_mul_f32 v105, v106, v68
v_fma_f32 v105, v107, v69, v105
v_fma_f32 v105, v108, v70, v105
v_fma_f32 v105, v109, v71, v105
v_cvt_pk_bf16_f32 v113, v104, v105
v_min_u32 v113, -2, v113
buffer_store_dwordx4 v[110:113], v92, s[64:67], 0 offen sc1
s_mov_b64 exec, -1
s_endpgm
L_exit:
s_endpgm
B_role:
s_mov_b32 s8, s5
s_lshl_b32 s9, s4, 1
s_add_u32 s9, s9, s8
v_and_b32 v1, 63, v0
v_lshlrev_b32 v2, 4, v1
v_lshrrev_b32 v9, 4, v1
v_and_b32 v8, 15, v1
s_cmp_eq_u32 s8, 1
s_cbranch_scc1 D_role
v_mul_u32_u24 v3, 294912, v9
v_lshl_add_u32 v3, v8, 4, v3
v_mul_u32_u24 v4, 72, v9
v_lshrrev_b32 v6, 3, v8
v_mul_u32_u24 v6, 1152, v6
v_add_u32 v4, v4, v6
v_lshlrev_b32 v238, 17, v9
v_lshl_add_u32 v238, v8, 4, v238
s_waitcnt lgkmcnt(0)
s_mul_i32 s6, s3, 288
s_sub_u32 s7, 4608, s6
s_add_u32 s44, s26, s6
s_addc_u32 s45, s27, 0
s_mov_b32 s46, s7
s_mov_b32 s47, 0x20000
s_mul_i32 s6, s3, 1179648
s_lshl_b32 s7, s4, 8
s_add_u32 s6, s6, s7
s_sub_u32 s7, 4718592, s6
s_add_u32 s48, s30, s6
s_addc_u32 s49, s31, 0
s_mov_b32 s50, s7
s_mov_b32 s51, 0x20000
buffer_load_dwordx4 v[24:27], v4, s[44:47], 0 offen offset:0
buffer_load_dwordx4 v[28:31], v4, s[44:47], 0 offen offset:16
buffer_load_dwordx4 v[32:35], v4, s[44:47], 0 offen offset:32
buffer_load_dwordx4 v[36:39], v4, s[44:47], 0 offen offset:48
buffer_load_dwordx2 v[40:41], v4, s[44:47], 0 offen offset:64
buffer_load_dwordx4 v[44:47], v4, s[44:47], 0 offen offset:2304
buffer_load_dwordx4 v[48:51], v4, s[44:47], 0 offen offset:2320
buffer_load_dwordx4 v[52:55], v4, s[44:47], 0 offen offset:2336
buffer_load_dwordx4 v[56:59], v4, s[44:47], 0 offen offset:2352
buffer_load_dwordx2 v[60:61], v4, s[44:47], 0 offen offset:2368
s_mov_b32 s6, 0
buffer_load_dwordx4 a[96:99], v3, s[48:51], s6 offen nt
s_mov_b32 s6, 8192
buffer_load_dwordx4 a[100:103], v3, s[48:51], s6 offen nt
s_mov_b32 s6, 16384
buffer_load_dwordx4 a[104:107], v3, s[48:51], s6 offen nt
s_mov_b32 s6, 24576
buffer_load_dwordx4 a[108:111], v3, s[48:51], s6 offen nt
s_mov_b32 s6, 32768
buffer_load_dwordx4 a[112:115], v3, s[48:51], s6 offen nt
s_mov_b32 s6, 40960
buffer_load_dwordx4 a[116:119], v3, s[48:51], s6 offen nt
s_mov_b32 s6, 49152
buffer_load_dwordx4 a[120:123], v3, s[48:51], s6 offen nt
s_mov_b32 s6, 57344
buffer_load_dwordx4 a[124:127], v3, s[48:51], s6 offen nt
s_mov_b32 s6, 65536
buffer_load_dwordx4 a[128:131], v3, s[48:51], s6 offen nt
s_mov_b32 s6, 73728
buffer_load_dwordx4 a[132:135], v3, s[48:51], s6 offen nt
s_mov_b32 s6, 81920
buffer_load_dwordx4 a[136:139], v3, s[48:51], s6 offen nt
s_mov_b32 s6, 90112
buffer_load_dwordx4 a[140:143], v3, s[48:51], s6 offen nt
s_mov_b32 s6, 98304
buffer_load_dwordx4 a[144:147], v3, s[48:51], s6 offen nt
s_mov_b32 s6, 106496
buffer_load_dwordx4 a[148:151], v3, s[48:51], s6 offen nt
s_mov_b32 s6, 114688
buffer_load_dwordx4 a[152:155], v3, s[48:51], s6 offen nt
s_mov_b32 s6, 122880
buffer_load_dwordx4 a[156:159], v3, s[48:51], s6 offen nt
s_mov_b32 s6, 131072
buffer_load_dwordx4 a[160:163], v3, s[48:51], s6 offen nt
s_mov_b32 s6, 139264
buffer_load_dwordx4 a[164:167], v3, s[48:51], s6 offen nt
s_mov_b32 s6, 147456
buffer_load_dwordx4 a[168:171], v3, s[48:51], s6 offen nt
s_mov_b32 s6, 155648
buffer_load_dwordx4 a[172:175], v3, s[48:51], s6 offen nt
s_mov_b32 s6, 163840
buffer_load_dwordx4 a[176:179], v3, s[48:51], s6 offen nt
s_mov_b32 s6, 172032
buffer_load_dwordx4 a[180:183], v3, s[48:51], s6 offen nt
s_mov_b32 s6, 180224
buffer_load_dwordx4 a[184:187], v3, s[48:51], s6 offen nt
s_mov_b32 s6, 188416
buffer_load_dwordx4 a[188:191], v3, s[48:51], s6 offen nt
s_mov_b32 s6, 196608
buffer_load_dwordx4 a[192:195], v3, s[48:51], s6 offen nt
s_mov_b32 s6, 204800
buffer_load_dwordx4 a[196:199], v3, s[48:51], s6 offen nt
s_mov_b32 s6, 212992
buffer_load_dwordx4 a[200:203], v3, s[48:51], s6 offen nt
s_mov_b32 s6, 221184
buffer_load_dwordx4 a[204:207], v3, s[48:51], s6 offen nt
s_mov_b32 s6, 229376
buffer_load_dwordx4 a[208:211], v3, s[48:51], s6 offen nt
s_mov_b32 s6, 237568
buffer_load_dwordx4 a[212:215], v3, s[48:51], s6 offen nt
s_mov_b32 s6, 245760
buffer_load_dwordx4 a[216:219], v3, s[48:51], s6 offen nt
s_mov_b32 s6, 253952
buffer_load_dwordx4 a[220:223], v3, s[48:51], s6 offen nt
s_mov_b32 s6, 262144
buffer_load_dwordx4 a[224:227], v3, s[48:51], s6 offen nt
s_mov_b32 s6, 270336
buffer_load_dwordx4 a[228:231], v3, s[48:51], s6 offen nt
s_mov_b32 s6, 278528
buffer_load_dwordx4 a[232:235], v3, s[48:51], s6 offen nt
s_mov_b32 s6, 286720
buffer_load_dwordx4 a[236:239], v3, s[48:51], s6 offen nt
s_lshl_b32 s6, s3, 20
s_lshl_b32 s7, s4, 8
s_add_u32 s6, s6, s7
s_sub_u32 s7, 4194304, s6
s_add_u32 s76, s32, s6
s_addc_u32 s77, s33, 0
s_mov_b32 s78, s7
s_mov_b32 s79, 0x20000
s_add_u32 s52, s34, s6
s_addc_u32 s53, s35, 0
s_mov_b32 s54, s7
s_mov_b32 s55, 0x20000
s_mov_b32 s6, 0
buffer_load_dwordx4 v[88:91], v238, s[76:79], s6 offen nt
s_mov_b32 s6, 8192
buffer_load_dwordx4 v[92:95], v238, s[76:79], s6 offen nt
s_mov_b32 s6, 16384
buffer_load_dwordx4 v[96:99], v238, s[76:79], s6 offen nt
s_mov_b32 s6, 24576
buffer_load_dwordx4 v[100:103], v238, s[76:79], s6 offen nt
s_mov_b32 s6, 32768
buffer_load_dwordx4 v[104:107], v238, s[76:79], s6 offen nt
s_mov_b32 s6, 40960
buffer_load_dwordx4 v[108:111], v238, s[76:79], s6 offen nt
s_mov_b32 s6, 49152
buffer_load_dwordx4 v[112:115], v238, s[76:79], s6 offen nt
s_mov_b32 s6, 57344
buffer_load_dwordx4 v[116:119], v238, s[76:79], s6 offen nt
s_mov_b32 s6, 65536
buffer_load_dwordx4 v[120:123], v238, s[76:79], s6 offen nt
s_mov_b32 s6, 73728
buffer_load_dwordx4 v[124:127], v238, s[76:79], s6 offen nt
s_mov_b32 s6, 81920
buffer_load_dwordx4 v[128:131], v238, s[76:79], s6 offen nt
s_mov_b32 s6, 90112
buffer_load_dwordx4 v[132:135], v238, s[76:79], s6 offen nt
s_mov_b32 s64, s42
s_mov_b32 s65, s43
s_mov_b32 s66, 16777216
s_mov_b32 s67, 0x20000
s_mov_b32 s68, s40
s_mov_b32 s69, s41
s_mov_b32 s70, 256
s_mov_b32 s71, 0x20000
s_mov_b32 s72, s38
s_mov_b32 s73, s39
s_mov_b32 s74, 9216
s_mov_b32 s75, 0x20000
s_mul_i32 s6, s4, 147456
s_add_u32 s60, s36, s6
s_addc_u32 s61, s37, 0
s_mov_b32 s62, 147456
s_mov_b32 s63, 0x20000
v_and_b32 v5, 1, v1
v_lshlrev_b32 v5, 4, v5
v_mov_b32 v6, 0xffff
v_lshlrev_b32 v5, v5, v6
v_bfe_u32 v6, v1, 1, 2
v_cmp_eq_u32 vcc, 0, v6
s_nop 1
v_cndmask_b32 v12, 0, v5, vcc
v_cmp_eq_u32 vcc, 1, v6
s_nop 1
v_cndmask_b32 v13, 0, v5, vcc
v_cmp_eq_u32 vcc, 2, v6
s_nop 1
v_cndmask_b32 v14, 0, v5, vcc
v_cmp_eq_u32 vcc, 3, v6
s_nop 1
v_cndmask_b32 v15, 0, v5, vcc
v_mov_b32 v5, 0x0c0c0c0c
s_mov_b32 s6, 0x01000100
s_mov_b32 s7, 0x03020302
v_bfi_b32 v16, v12, s6, v5
v_bfi_b32 v17, v13, s6, v5
v_bfi_b32 v18, v14, s6, v5
v_bfi_b32 v19, v15, s6, v5
v_bfi_b32 v20, v12, s7, v5
v_bfi_b32 v21, v13, s7, v5
v_bfi_b32 v22, v14, s7, v5
v_bfi_b32 v23, v15, s7, v5
v_lshrrev_b32 v5, 4, v1
v_lshlrev_b32 v5, 3, v5
v_bfe_u32 v6, v1, 2, 2
v_add_u32 v5, v5, v6
v_mul_u32_u24 v5, 1152, v5
s_mul_i32 s6, s3, 288
v_add_u32 v5, s6, v5
v_and_b32 v6, 3, v1
v_lshl_add_u32 v240, v6, 5, v5
v_lshl_add_u32 v241, v6, 3, v5
v_add_u32 v241, 256, v241
v_add_u32 v242, 73728, v240
v_add_u32 v243, 73728, v241
s_mul_i32 s12, s3, 36864
s_waitcnt vmcnt(47)
v_perm_b32 v64, v24, v24, v16
v_perm_b32 v65, v24, v24, v17
v_perm_b32 v66, v24, v24, v18
v_perm_b32 v67, v24, v24, v19
s_nop 1
v_mfma_f32_16x16x32_bf16 v[80:83], v[64:67], a[96:99], 0
v_perm_b32 v68, v44, v44, v16
v_perm_b32 v69, v44, v44, v17
v_perm_b32 v70, v44, v44, v18
v_perm_b32 v71, v44, v44, v19
s_nop 1
v_mfma_f32_16x16x32_bf16 v[84:87], v[68:71], a[96:99], 0
s_mov_b32 s6, 98304
buffer_load_dwordx4 v[136:139], v238, s[76:79], s6 offen nt
s_waitcnt vmcnt(47)
v_perm_b32 v72, v24, v24, v20
v_perm_b32 v73, v24, v24, v21
v_perm_b32 v74, v24, v24, v22
v_perm_b32 v75, v24, v24, v23
s_nop 1
v_mfma_f32_16x16x32_bf16 v[80:83], v[72:75], a[100:103], v[80:83]
v_perm_b32 v76, v44, v44, v20
v_perm_b32 v77, v44, v44, v21
v_perm_b32 v78, v44, v44, v22
v_perm_b32 v79, v44, v44, v23
s_nop 1
v_mfma_f32_16x16x32_bf16 v[84:87], v[76:79], a[100:103], v[84:87]
s_mov_b32 s6, 106496
buffer_load_dwordx4 v[140:143], v238, s[76:79], s6 offen nt
s_waitcnt vmcnt(47)
v_perm_b32 v64, v25, v25, v16
v_perm_b32 v65, v25, v25, v17
v_perm_b32 v66, v25, v25, v18
v_perm_b32 v67, v25, v25, v19
s_nop 1
v_mfma_f32_16x16x32_bf16 v[80:83], v[64:67], a[104:107], v[80:83]
v_perm_b32 v68, v45, v45, v16
v_perm_b32 v69, v45, v45, v17
v_perm_b32 v70, v45, v45, v18
v_perm_b32 v71, v45, v45, v19
s_nop 1
v_mfma_f32_16x16x32_bf16 v[84:87], v[68:71], a[104:107], v[84:87]
s_mov_b32 s6, 114688
buffer_load_dwordx4 v[144:147], v238, s[76:79], s6 offen nt
s_waitcnt vmcnt(47)
v_perm_b32 v72, v25, v25, v20
v_perm_b32 v73, v25, v25, v21
v_perm_b32 v74, v25, v25, v22
v_perm_b32 v75, v25, v25, v23
s_nop 1
v_mfma_f32_16x16x32_bf16 v[80:83], v[72:75], a[108:111], v[80:83]
v_perm_b32 v76, v45, v45, v20
v_perm_b32 v77, v45, v45, v21
v_perm_b32 v78, v45, v45, v22
v_perm_b32 v79, v45, v45, v23
s_nop 1
v_mfma_f32_16x16x32_bf16 v[84:87], v[76:79], a[108:111], v[84:87]
s_mov_b32 s6, 122880
buffer_load_dwordx4 v[148:151], v238, s[76:79], s6 offen nt
s_waitcnt vmcnt(47)
v_perm_b32 v64, v26, v26, v16
v_perm_b32 v65, v26, v26, v17
v_perm_b32 v66, v26, v26, v18
v_perm_b32 v67, v26, v26, v19
s_nop 1
v_mfma_f32_16x16x32_bf16 v[80:83], v[64:67], a[112:115], v[80:83]
v_perm_b32 v68, v46, v46, v16
v_perm_b32 v69, v46, v46, v17
v_perm_b32 v70, v46, v46, v18
v_perm_b32 v71, v46, v46, v19
s_nop 1
v_mfma_f32_16x16x32_bf16 v[84:87], v[68:71], a[112:115], v[84:87]
s_mov_b32 s6, 524288
buffer_load_dwordx4 v[152:155], v238, s[76:79], s6 offen nt
s_waitcnt vmcnt(47)
v_perm_b32 v72, v26, v26, v20
v_perm_b32 v73, v26, v26, v21
v_perm_b32 v74, v26, v26, v22
v_perm_b32 v75, v26, v26, v23
s_nop 1
v_mfma_f32_16x16x32_bf16 v[80:83], v[72:75], a[116:119], v[80:83]
v_perm_b32 v76, v46, v46, v20
v_perm_b32 v77, v46, v46, v21
v_perm_b32 v78, v46, v46, v22
v_perm_b32 v79, v46, v46, v23
s_nop 1
v_mfma_f32_16x16x32_bf16 v[84:87], v[76:79], a[116:119], v[84:87]
s_mov_b32 s6, 532480
buffer_load_dwordx4 v[156:159], v238, s[76:79], s6 offen nt
s_waitcnt vmcnt(47)
v_perm_b32 v64, v27, v27, v16
v_perm_b32 v65, v27, v27, v17
v_perm_b32 v66, v27, v27, v18
v_perm_b32 v67, v27, v27, v19
s_nop 1
v_mfma_f32_16x16x32_bf16 v[80:83], v[64:67], a[120:123], v[80:83]
v_perm_b32 v68, v47, v47, v16
v_perm_b32 v69, v47, v47, v17
v_perm_b32 v70, v47, v47, v18
v_perm_b32 v71, v47, v47, v19
s_nop 1
v_mfma_f32_16x16x32_bf16 v[84:87], v[68:71], a[120:123], v[84:87]
s_mov_b32 s6, 540672
buffer_load_dwordx4 v[160:163], v238, s[76:79], s6 offen nt
s_waitcnt vmcnt(47)
v_perm_b32 v72, v27, v27, v20
v_perm_b32 v73, v27, v27, v21
v_perm_b32 v74, v27, v27, v22
v_perm_b32 v75, v27, v27, v23
s_nop 1
v_mfma_f32_16x16x32_bf16 v[80:83], v[72:75], a[124:127], v[80:83]
v_perm_b32 v76, v47, v47, v20
v_perm_b32 v77, v47, v47, v21
v_perm_b32 v78, v47, v47, v22
v_perm_b32 v79, v47, v47, v23
s_nop 1
v_mfma_f32_16x16x32_bf16 v[84:87], v[76:79], a[124:127], v[84:87]
s_mov_b32 s6, 548864
buffer_load_dwordx4 v[164:167], v238, s[76:79], s6 offen nt
s_waitcnt vmcnt(47)
v_perm_b32 v64, v28, v28, v16
v_perm_b32 v65, v28, v28, v17
v_perm_b32 v66, v28, v28, v18
v_perm_b32 v67, v28, v28, v19
s_nop 1
v_mfma_f32_16x16x32_bf16 v[80:83], v[64:67], a[128:131], v[80:83]
v_perm_b32 v68, v48, v48, v16
v_perm_b32 v69, v48, v48, v17
v_perm_b32 v70, v48, v48, v18
v_perm_b32 v71, v48, v48, v19
s_nop 1
v_mfma_f32_16x16x32_bf16 v[84:87], v[68:71], a[128:131], v[84:87]
s_mov_b32 s6, 557056
buffer_load_dwordx4 v[168:171], v238, s[76:79], s6 offen nt
s_waitcnt vmcnt(47)
v_perm_b32 v72, v28, v28, v20
v_perm_b32 v73, v28, v28, v21
v_perm_b32 v74, v28, v28, v22
v_perm_b32 v75, v28, v28, v23
s_nop 1
v_mfma_f32_16x16x32_bf16 v[80:83], v[72:75], a[132:135], v[80:83]
v_perm_b32 v76, v48, v48, v20
v_perm_b32 v77, v48, v48, v21
v_perm_b32 v78, v48, v48, v22
v_perm_b32 v79, v48, v48, v23
s_nop 1
v_mfma_f32_16x16x32_bf16 v[84:87], v[76:79], a[132:135], v[84:87]
s_mov_b32 s6, 565248
buffer_load_dwordx4 v[172:175], v238, s[76:79], s6 offen nt
s_waitcnt vmcnt(47)
v_perm_b32 v64, v29, v29, v16
v_perm_b32 v65, v29, v29, v17
v_perm_b32 v66, v29, v29, v18
v_perm_b32 v67, v29, v29, v19
s_nop 1
v_mfma_f32_16x16x32_bf16 v[80:83], v[64:67], a[136:139], v[80:83]
v_perm_b32 v68, v49, v49, v16
v_perm_b32 v69, v49, v49, v17
v_perm_b32 v70, v49, v49, v18
v_perm_b32 v71, v49, v49, v19
s_nop 1
v_mfma_f32_16x16x32_bf16 v[84:87], v[68:71], a[136:139], v[84:87]
s_mov_b32 s6, 573440
buffer_load_dwordx4 v[176:179], v238, s[76:79], s6 offen nt
s_waitcnt vmcnt(47)
v_perm_b32 v72, v29, v29, v20
v_perm_b32 v73, v29, v29, v21
v_perm_b32 v74, v29, v29, v22
v_perm_b32 v75, v29, v29, v23
s_nop 1
v_mfma_f32_16x16x32_bf16 v[80:83], v[72:75], a[140:143], v[80:83]
v_perm_b32 v76, v49, v49, v20
v_perm_b32 v77, v49, v49, v21
v_perm_b32 v78, v49, v49, v22
v_perm_b32 v79, v49, v49, v23
s_nop 1
v_mfma_f32_16x16x32_bf16 v[84:87], v[76:79], a[140:143], v[84:87]
s_mov_b32 s6, 581632
buffer_load_dwordx4 v[180:183], v238, s[76:79], s6 offen nt
s_waitcnt vmcnt(47)
v_perm_b32 v64, v30, v30, v16
v_perm_b32 v65, v30, v30, v17
v_perm_b32 v66, v30, v30, v18
v_perm_b32 v67, v30, v30, v19
s_nop 1
v_mfma_f32_16x16x32_bf16 v[80:83], v[64:67], a[144:147], v[80:83]
v_perm_b32 v68, v50, v50, v16
v_perm_b32 v69, v50, v50, v17
v_perm_b32 v70, v50, v50, v18
v_perm_b32 v71, v50, v50, v19
s_nop 1
v_mfma_f32_16x16x32_bf16 v[84:87], v[68:71], a[144:147], v[84:87]
s_mov_b32 s6, 589824
buffer_load_dwordx4 v[184:187], v238, s[76:79], s6 offen nt
s_waitcnt vmcnt(47)
v_perm_b32 v72, v30, v30, v20
v_perm_b32 v73, v30, v30, v21
v_perm_b32 v74, v30, v30, v22
v_perm_b32 v75, v30, v30, v23
s_nop 1
v_mfma_f32_16x16x32_bf16 v[80:83], v[72:75], a[148:151], v[80:83]
v_perm_b32 v76, v50, v50, v20
v_perm_b32 v77, v50, v50, v21
v_perm_b32 v78, v50, v50, v22
v_perm_b32 v79, v50, v50, v23
s_nop 1
v_mfma_f32_16x16x32_bf16 v[84:87], v[76:79], a[148:151], v[84:87]
s_mov_b32 s6, 598016
buffer_load_dwordx4 v[188:191], v238, s[76:79], s6 offen nt
s_waitcnt vmcnt(47)
v_perm_b32 v64, v31, v31, v16
v_perm_b32 v65, v31, v31, v17
v_perm_b32 v66, v31, v31, v18
v_perm_b32 v67, v31, v31, v19
s_nop 1
v_mfma_f32_16x16x32_bf16 v[80:83], v[64:67], a[152:155], v[80:83]
v_perm_b32 v68, v51, v51, v16
v_perm_b32 v69, v51, v51, v17
v_perm_b32 v70, v51, v51, v18
v_perm_b32 v71, v51, v51, v19
s_nop 1
v_mfma_f32_16x16x32_bf16 v[84:87], v[68:71], a[152:155], v[84:87]
s_mov_b32 s6, 606208
buffer_load_dwordx4 v[192:195], v238, s[76:79], s6 offen nt
s_waitcnt vmcnt(47)
v_perm_b32 v72, v31, v31, v20
v_perm_b32 v73, v31, v31, v21
v_perm_b32 v74, v31, v31, v22
v_perm_b32 v75, v31, v31, v23
s_nop 1
v_mfma_f32_16x16x32_bf16 v[80:83], v[72:75], a[156:159], v[80:83]
v_perm_b32 v76, v51, v51, v20
v_perm_b32 v77, v51, v51, v21
v_perm_b32 v78, v51, v51, v22
v_perm_b32 v79, v51, v51, v23
s_nop 1
v_mfma_f32_16x16x32_bf16 v[84:87], v[76:79], a[156:159], v[84:87]
s_mov_b32 s6, 614400
buffer_load_dwordx4 v[196:199], v238, s[76:79], s6 offen nt
s_waitcnt vmcnt(47)
v_perm_b32 v64, v32, v32, v16
v_perm_b32 v65, v32, v32, v17
v_perm_b32 v66, v32, v32, v18
v_perm_b32 v67, v32, v32, v19
s_nop 1
v_mfma_f32_16x16x32_bf16 v[80:83], v[64:67], a[160:163], v[80:83]
v_perm_b32 v68, v52, v52, v16
v_perm_b32 v69, v52, v52, v17
v_perm_b32 v70, v52, v52, v18
v_perm_b32 v71, v52, v52, v19
s_nop 1
v_mfma_f32_16x16x32_bf16 v[84:87], v[68:71], a[160:163], v[84:87]
s_mov_b32 s6, 622592
buffer_load_dwordx4 v[200:203], v238, s[76:79], s6 offen nt
s_waitcnt vmcnt(47)
v_perm_b32 v72, v32, v32, v20
v_perm_b32 v73, v32, v32, v21
v_perm_b32 v74, v32, v32, v22
v_perm_b32 v75, v32, v32, v23
s_nop 1
v_mfma_f32_16x16x32_bf16 v[80:83], v[72:75], a[164:167], v[80:83]
v_perm_b32 v76, v52, v52, v20
v_perm_b32 v77, v52, v52, v21
v_perm_b32 v78, v52, v52, v22
v_perm_b32 v79, v52, v52, v23
s_nop 1
v_mfma_f32_16x16x32_bf16 v[84:87], v[76:79], a[164:167], v[84:87]
s_mov_b32 s6, 630784
buffer_load_dwordx4 v[204:207], v238, s[76:79], s6 offen nt
s_waitcnt vmcnt(47)
v_perm_b32 v64, v33, v33, v16
v_perm_b32 v65, v33, v33, v17
v_perm_b32 v66, v33, v33, v18
v_perm_b32 v67, v33, v33, v19
s_nop 1
v_mfma_f32_16x16x32_bf16 v[80:83], v[64:67], a[168:171], v[80:83]
v_perm_b32 v68, v53, v53, v16
v_perm_b32 v69, v53, v53, v17
v_perm_b32 v70, v53, v53, v18
v_perm_b32 v71, v53, v53, v19
s_nop 1
v_mfma_f32_16x16x32_bf16 v[84:87], v[68:71], a[168:171], v[84:87]
s_mov_b32 s6, 638976
buffer_load_dwordx4 v[208:211], v238, s[76:79], s6 offen nt
s_waitcnt vmcnt(47)
v_perm_b32 v72, v33, v33, v20
v_perm_b32 v73, v33, v33, v21
v_perm_b32 v74, v33, v33, v22
v_perm_b32 v75, v33, v33, v23
s_nop 1
v_mfma_f32_16x16x32_bf16 v[80:83], v[72:75], a[172:175], v[80:83]
v_perm_b32 v76, v53, v53, v20
v_perm_b32 v77, v53, v53, v21
v_perm_b32 v78, v53, v53, v22
v_perm_b32 v79, v53, v53, v23
s_nop 1
v_mfma_f32_16x16x32_bf16 v[84:87], v[76:79], a[172:175], v[84:87]
s_mov_b32 s6, 647168
buffer_load_dwordx4 v[212:215], v238, s[76:79], s6 offen nt
s_waitcnt vmcnt(47)
v_perm_b32 v64, v34, v34, v16
v_perm_b32 v65, v34, v34, v17
v_perm_b32 v66, v34, v34, v18
v_perm_b32 v67, v34, v34, v19
s_nop 1
v_mfma_f32_16x16x32_bf16 v[80:83], v[64:67], a[176:179], v[80:83]
v_perm_b32 v68, v54, v54, v16
v_perm_b32 v69, v54, v54, v17
v_perm_b32 v70, v54, v54, v18
v_perm_b32 v71, v54, v54, v19
s_nop 1
v_mfma_f32_16x16x32_bf16 v[84:87], v[68:71], a[176:179], v[84:87]
buffer_load_dword v11, off, s[68:71], 0 offset:0 sc1
s_waitcnt vmcnt(47)
v_perm_b32 v72, v34, v34, v20
v_perm_b32 v73, v34, v34, v21
v_perm_b32 v74, v34, v34, v22
v_perm_b32 v75, v34, v34, v23
s_nop 1
v_mfma_f32_16x16x32_bf16 v[80:83], v[72:75], a[180:183], v[80:83]
v_perm_b32 v76, v54, v54, v20
v_perm_b32 v77, v54, v54, v21
v_perm_b32 v78, v54, v54, v22
v_perm_b32 v79, v54, v54, v23
s_nop 1
v_mfma_f32_16x16x32_bf16 v[84:87], v[76:79], a[180:183], v[84:87]
s_waitcnt vmcnt(46)
v_perm_b32 v64, v35, v35, v16
v_perm_b32 v65, v35, v35, v17
v_perm_b32 v66, v35, v35, v18
v_perm_b32 v67, v35, v35, v19
s_nop 1
v_mfma_f32_16x16x32_bf16 v[80:83], v[64:67], a[184:187], v[80:83]
v_perm_b32 v68, v55, v55, v16
v_perm_b32 v69, v55, v55, v17
v_perm_b32 v70, v55, v55, v18
v_perm_b32 v71, v55, v55, v19
s_nop 1
v_mfma_f32_16x16x32_bf16 v[84:87], v[68:71], a[184:187], v[84:87]
s_waitcnt vmcnt(45)
v_perm_b32 v72, v35, v35, v20
v_perm_b32 v73, v35, v35, v21
v_perm_b32 v74, v35, v35, v22
v_perm_b32 v75, v35, v35, v23
s_nop 1
v_mfma_f32_16x16x32_bf16 v[80:83], v[72:75], a[188:191], v[80:83]
v_perm_b32 v76, v55, v55, v20
v_perm_b32 v77, v55, v55, v21
v_perm_b32 v78, v55, v55, v22
v_perm_b32 v79, v55, v55, v23
s_nop 1
v_mfma_f32_16x16x32_bf16 v[84:87], v[76:79], a[188:191], v[84:87]
s_waitcnt vmcnt(44)
v_perm_b32 v64, v36, v36, v16
v_perm_b32 v65, v36, v36, v17
v_perm_b32 v66, v36, v36, v18
v_perm_b32 v67, v36, v36, v19
s_nop 1
v_mfma_f32_16x16x32_bf16 v[80:83], v[64:67], a[192:195], v[80:83]
v_perm_b32 v68, v56, v56, v16
v_perm_b32 v69, v56, v56, v17
v_perm_b32 v70, v56, v56, v18
v_perm_b32 v71, v56, v56, v19
s_nop 1
v_mfma_f32_16x16x32_bf16 v[84:87], v[68:71], a[192:195], v[84:87]
s_waitcnt vmcnt(43)
v_perm_b32 v72, v36, v36, v20
v_perm_b32 v73, v36, v36, v21
v_perm_b32 v74, v36, v36, v22
v_perm_b32 v75, v36, v36, v23
s_nop 1
v_mfma_f32_16x16x32_bf16 v[80:83], v[72:75], a[196:199], v[80:83]
v_perm_b32 v76, v56, v56, v20
v_perm_b32 v77, v56, v56, v21
v_perm_b32 v78, v56, v56, v22
v_perm_b32 v79, v56, v56, v23
s_nop 1
v_mfma_f32_16x16x32_bf16 v[84:87], v[76:79], a[196:199], v[84:87]
s_waitcnt vmcnt(42)
v_perm_b32 v64, v37, v37, v16
v_perm_b32 v65, v37, v37, v17
v_perm_b32 v66, v37, v37, v18
v_perm_b32 v67, v37, v37, v19
s_nop 1
v_mfma_f32_16x16x32_bf16 v[80:83], v[64:67], a[200:203], v[80:83]
v_perm_b32 v68, v57, v57, v16
v_perm_b32 v69, v57, v57, v17
v_perm_b32 v70, v57, v57, v18
v_perm_b32 v71, v57, v57, v19
s_nop 1
v_mfma_f32_16x16x32_bf16 v[84:87], v[68:71], a[200:203], v[84:87]
s_waitcnt vmcnt(41)
v_perm_b32 v72, v37, v37, v20
v_perm_b32 v73, v37, v37, v21
v_perm_b32 v74, v37, v37, v22
v_perm_b32 v75, v37, v37, v23
s_nop 1
v_mfma_f32_16x16x32_bf16 v[80:83], v[72:75], a[204:207], v[80:83]
v_perm_b32 v76, v57, v57, v20
v_perm_b32 v77, v57, v57, v21
v_perm_b32 v78, v57, v57, v22
v_perm_b32 v79, v57, v57, v23
s_nop 1
v_mfma_f32_16x16x32_bf16 v[84:87], v[76:79], a[204:207], v[84:87]
s_waitcnt vmcnt(40)
v_perm_b32 v64, v38, v38, v16
v_perm_b32 v65, v38, v38, v17
v_perm_b32 v66, v38, v38, v18
v_perm_b32 v67, v38, v38, v19
s_nop 1
v_mfma_f32_16x16x32_bf16 v[80:83], v[64:67], a[208:211], v[80:83]
v_perm_b32 v68, v58, v58, v16
v_perm_b32 v69, v58, v58, v17
v_perm_b32 v70, v58, v58, v18
v_perm_b32 v71, v58, v58, v19
s_nop 1
v_mfma_f32_16x16x32_bf16 v[84:87], v[68:71], a[208:211], v[84:87]
s_waitcnt vmcnt(39)
v_perm_b32 v72, v38, v38, v20
v_perm_b32 v73, v38, v38, v21
v_perm_b32 v74, v38, v38, v22
v_perm_b32 v75, v38, v38, v23
s_nop 1
v_mfma_f32_16x16x32_bf16 v[80:83], v[72:75], a[212:215], v[80:83]
v_perm_b32 v76, v58, v58, v20
v_perm_b32 v77, v58, v58, v21
v_perm_b32 v78, v58, v58, v22
v_perm_b32 v79, v58, v58, v23
s_nop 1
v_mfma_f32_16x16x32_bf16 v[84:87], v[76:79], a[212:215], v[84:87]
s_waitcnt vmcnt(38)
v_perm_b32 v64, v39, v39, v16
v_perm_b32 v65, v39, v39, v17
v_perm_b32 v66, v39, v39, v18
v_perm_b32 v67, v39, v39, v19
s_nop 1
v_mfma_f32_16x16x32_bf16 v[80:83], v[64:67], a[216:219], v[80:83]
v_perm_b32 v68, v59, v59, v16
v_perm_b32 v69, v59, v59, v17
v_perm_b32 v70, v59, v59, v18
v_perm_b32 v71, v59, v59, v19
s_nop 1
v_mfma_f32_16x16x32_bf16 v[84:87], v[68:71], a[216:219], v[84:87]
s_waitcnt vmcnt(37)
v_perm_b32 v72, v39, v39, v20
v_perm_b32 v73, v39, v39, v21
v_perm_b32 v74, v39, v39, v22
v_perm_b32 v75, v39, v39, v23
s_nop 1
v_mfma_f32_16x16x32_bf16 v[80:83], v[72:75], a[220:223], v[80:83]
v_perm_b32 v76, v59, v59, v20
v_perm_b32 v77, v59, v59, v21
v_perm_b32 v78, v59, v59, v22
v_perm_b32 v79, v59, v59, v23
s_nop 1
v_mfma_f32_16x16x32_bf16 v[84:87], v[76:79], a[220:223], v[84:87]
s_waitcnt vmcnt(36)
v_perm_b32 v64, v40, v40, v16
v_perm_b32 v65, v40, v40, v17
v_perm_b32 v66, v40, v40, v18
v_perm_b32 v67, v40, v40, v19
s_nop 1
v_mfma_f32_16x16x32_bf16 v[80:83], v[64:67], a[224:227], v[80:83]
v_perm_b32 v68, v60, v60, v16
v_perm_b32 v69, v60, v60, v17
v_perm_b32 v70, v60, v60, v18
v_perm_b32 v71, v60, v60, v19
s_nop 1
v_mfma_f32_16x16x32_bf16 v[84:87], v[68:71], a[224:227], v[84:87]
s_waitcnt vmcnt(35)
v_perm_b32 v72, v40, v40, v20
v_perm_b32 v73, v40, v40, v21
v_perm_b32 v74, v40, v40, v22
v_perm_b32 v75, v40, v40, v23
s_nop 1
v_mfma_f32_16x16x32_bf16 v[80:83], v[72:75], a[228:231], v[80:83]
v_perm_b32 v76, v60, v60, v20
v_perm_b32 v77, v60, v60, v21
v_perm_b32 v78, v60, v60, v22
v_perm_b32 v79, v60, v60, v23
s_nop 1
v_mfma_f32_16x16x32_bf16 v[84:87], v[76:79], a[228:231], v[84:87]
s_waitcnt vmcnt(34)
v_perm_b32 v64, v41, v41, v16
v_perm_b32 v65, v41, v41, v17
v_perm_b32 v66, v41, v41, v18
v_perm_b32 v67, v41, v41, v19
s_nop 1
v_mfma_f32_16x16x32_bf16 v[80:83], v[64:67], a[232:235], v[80:83]
v_perm_b32 v68, v61, v61, v16
v_perm_b32 v69, v61, v61, v17
v_perm_b32 v70, v61, v61, v18
v_perm_b32 v71, v61, v61, v19
s_nop 1
v_mfma_f32_16x16x32_bf16 v[84:87], v[68:71], a[232:235], v[84:87]
s_waitcnt vmcnt(33)
v_perm_b32 v72, v41, v41, v20
v_perm_b32 v73, v41, v41, v21
v_perm_b32 v74, v41, v41, v22
v_perm_b32 v75, v41, v41, v23
s_nop 1
v_mfma_f32_16x16x32_bf16 v[80:83], v[72:75], a[236:239], v[80:83]
v_perm_b32 v76, v61, v61, v20
v_perm_b32 v77, v61, v61, v21
v_perm_b32 v78, v61, v61, v22
v_perm_b32 v79, v61, v61, v23
s_nop 1
v_mfma_f32_16x16x32_bf16 v[84:87], v[76:79], a[236:239], v[84:87]
v_lshlrev_b32 v5, 5, v8
v_and_b32 v6, 1, v9
v_lshl_add_u32 v6, v6, 4, v5
v_lshrrev_b32 v7, 5, v1
v_lshl_add_u32 v6, v7, 9, v6
s_lshl_b32 s6, s3, 11
s_add_u32 s6, s6, 147456
v_add_u32 v6, s6, v6
ds_write_b128 v6, v[80:83]
ds_write_b128 v6, v[84:87] offset:1024
v_add_u32 v5, 147456, v5
s_waitcnt lgkmcnt(0)
s_barrier
ds_read_b128 v[24:27], v5 offset:0
ds_read_b128 v[28:31], v5 offset:16
ds_read_b128 v[32:35], v5 offset:2048
ds_read_b128 v[36:39], v5 offset:2064
ds_read_b128 v[40:43], v5 offset:4096
ds_read_b128 v[44:47], v5 offset:4112
ds_read_b128 v[48:51], v5 offset:6144
ds_read_b128 v[52:55], v5 offset:6160
s_waitcnt lgkmcnt(0)
v_add_f32 v24, v24, v32
v_add_f32 v40, v40, v48
v_add_f32 v25, v25, v33
v_add_f32 v41, v41, v49
v_add_f32 v26, v26, v34
v_add_f32 v42, v42, v50
v_add_f32 v27, v27, v35
v_add_f32 v43, v43, v51
v_add_f32 v28, v28, v36
v_add_f32 v44, v44, v52
v_add_f32 v29, v29, v37
v_add_f32 v45, v45, v53
v_add_f32 v30, v30, v38
v_add_f32 v46, v46, v54
v_add_f32 v31, v31, v39
v_add_f32 v47, v47, v55
v_add_f32 v24, v24, v40
v_add_f32 v25, v25, v41
v_add_f32 v26, v26, v42
v_add_f32 v27, v27, v43
v_add_f32 v28, v28, v44
v_add_f32 v29, v29, v45
v_add_f32 v30, v30, v46
v_add_f32 v31, v31, v47
v_cvt_pk_bf16_f32 v216, v24, v25
v_cvt_pk_bf16_f32 v217, v26, v27
v_cvt_pk_bf16_f32 v218, v28, v29
v_cvt_pk_bf16_f32 v219, v30, v31
ds_read_b128 v[24:27], v5 offset:512
ds_read_b128 v[28:31], v5 offset:528
ds_read_b128 v[32:35], v5 offset:2560
ds_read_b128 v[36:39], v5 offset:2576
ds_read_b128 v[40:43], v5 offset:4608
ds_read_b128 v[44:47], v5 offset:4624
ds_read_b128 v[48:51], v5 offset:6656
ds_read_b128 v[52:55], v5 offset:6672
s_waitcnt lgkmcnt(0)
v_add_f32 v24, v24, v32
v_add_f32 v40, v40, v48
v_add_f32 v25, v25, v33
v_add_f32 v41, v41, v49
v_add_f32 v26, v26, v34
v_add_f32 v42, v42, v50
v_add_f32 v27, v27, v35
v_add_f32 v43, v43, v51
v_add_f32 v28, v28, v36
v_add_f32 v44, v44, v52
v_add_f32 v29, v29, v37
v_add_f32 v45, v45, v53
v_add_f32 v30, v30, v38
v_add_f32 v46, v46, v54
v_add_f32 v31, v31, v39
v_add_f32 v47, v47, v55
v_add_f32 v24, v24, v40
v_add_f32 v25, v25, v41
v_add_f32 v26, v26, v42
v_add_f32 v27, v27, v43
v_add_f32 v28, v28, v44
v_add_f32 v29, v29, v45
v_add_f32 v30, v30, v46
v_add_f32 v31, v31, v47
v_cvt_pk_bf16_f32 v220, v24, v25
v_cvt_pk_bf16_f32 v221, v26, v27
v_cvt_pk_bf16_f32 v222, v28, v29
v_cvt_pk_bf16_f32 v223, v30, v31
ds_read_b128 v[24:27], v5 offset:1024
ds_read_b128 v[28:31], v5 offset:1040
ds_read_b128 v[32:35], v5 offset:3072
ds_read_b128 v[36:39], v5 offset:3088
ds_read_b128 v[40:43], v5 offset:5120
ds_read_b128 v[44:47], v5 offset:5136
ds_read_b128 v[48:51], v5 offset:7168
ds_read_b128 v[52:55], v5 offset:7184
s_waitcnt lgkmcnt(0)
v_add_f32 v24, v24, v32
v_add_f32 v40, v40, v48
v_add_f32 v25, v25, v33
v_add_f32 v41, v41, v49
v_add_f32 v26, v26, v34
v_add_f32 v42, v42, v50
v_add_f32 v27, v27, v35
v_add_f32 v43, v43, v51
v_add_f32 v28, v28, v36
v_add_f32 v44, v44, v52
v_add_f32 v29, v29, v37
v_add_f32 v45, v45, v53
v_add_f32 v30, v30, v38
v_add_f32 v46, v46, v54
v_add_f32 v31, v31, v39
v_add_f32 v47, v47, v55
v_add_f32 v24, v24, v40
v_add_f32 v25, v25, v41
v_add_f32 v26, v26, v42
v_add_f32 v27, v27, v43
v_add_f32 v28, v28, v44
v_add_f32 v29, v29, v45
v_add_f32 v30, v30, v46
v_add_f32 v31, v31, v47
v_cvt_pk_bf16_f32 v224, v24, v25
v_cvt_pk_bf16_f32 v225, v26, v27
v_cvt_pk_bf16_f32 v226, v28, v29
v_cvt_pk_bf16_f32 v227, v30, v31
ds_read_b128 v[24:27], v5 offset:1536
ds_read_b128 v[28:31], v5 offset:1552
ds_read_b128 v[32:35], v5 offset:3584
ds_read_b128 v[36:39], v5 offset:3600
ds_read_b128 v[40:43], v5 offset:5632
ds_read_b128 v[44:47], v5 offset:5648
ds_read_b128 v[48:51], v5 offset:7680
ds_read_b128 v[52:55], v5 offset:7696
s_waitcnt lgkmcnt(0)
v_add_f32 v24, v24, v32
v_add_f32 v40, v40, v48
v_add_f32 v25, v25, v33
v_add_f32 v41, v41, v49
v_add_f32 v26, v26, v34
v_add_f32 v42, v42, v50
v_add_f32 v27, v27, v35
v_add_f32 v43, v43, v51
v_add_f32 v28, v28, v36
v_add_f32 v44, v44, v52
v_add_f32 v29, v29, v37
v_add_f32 v45, v45, v53
v_add_f32 v30, v30, v38
v_add_f32 v46, v46, v54
v_add_f32 v31, v31, v39
v_add_f32 v47, v47, v55
v_add_f32 v24, v24, v40
v_add_f32 v25, v25, v41
v_add_f32 v26, v26, v42
v_add_f32 v27, v27, v43
v_add_f32 v28, v28, v44
v_add_f32 v29, v29, v45
v_add_f32 v30, v30, v46
v_add_f32 v31, v31, v47
v_cvt_pk_bf16_f32 v228, v24, v25
v_cvt_pk_bf16_f32 v229, v26, v27
v_cvt_pk_bf16_f32 v230, v28, v29
v_cvt_pk_bf16_f32 v231, v30, v31
v_bfe_u32 v5, v1, 2, 2
v_mul_u32_u24 v5, 32768, v5
v_lshl_add_u32 v5, v9, 5, v5
v_and_b32 v6, 1, v1
v_lshl_add_u32 v5, v6, 4, v5
v_bfe_u32 v7, v1, 1, 1
v_lshl_add_u32 v5, v7, 7, v5
s_waitcnt vmcnt(32)
v_dot2_f32_bf16 v232, v88, v216, 0
v_dot2_f32_bf16 v233, v88, v220, 0
v_dot2_f32_bf16 v234, v88, v224, 0
v_dot2_f32_bf16 v235, v88, v228, 0
v_dot2_f32_bf16 v232, v89, v217, v232
v_dot2_f32_bf16 v233, v89, v221, v233
v_dot2_f32_bf16 v234, v89, v225, v234
v_dot2_f32_bf16 v235, v89, v229, v235
v_dot2_f32_bf16 v232, v90, v218, v232
v_dot2_f32_bf16 v233, v90, v222, v233
v_dot2_f32_bf16 v234, v90, v226, v234
v_dot2_f32_bf16 v235, v90, v230, v235
v_dot2_f32_bf16 v232, v91, v219, v232
v_dot2_f32_bf16 v233, v91, v223, v233
v_dot2_f32_bf16 v234, v91, v227, v234
v_dot2_f32_bf16 v235, v91, v231, v235
v_add_f32_dpp v236, v232, v232 row_ror:8 row_mask:0xf bank_mask:0x3
v_add_f32_dpp v237, v233, v233 row_ror:8 row_mask:0xf bank_mask:0x3
v_add_f32_dpp v236, v234, v234 row_ror:8 row_mask:0xf bank_mask:0xc
v_add_f32_dpp v237, v235, v235 row_ror:8 row_mask:0xf bank_mask:0xc
s_nop 0
v_add_f32_dpp v64, v236, v236 row_half_mirror row_mask:0xf bank_mask:0x5
v_add_f32_dpp v64, v237, v237 row_half_mirror row_mask:0xf bank_mask:0xa
s_nop 1
v_add_f32_dpp v64, v64, v64 quad_perm:[1,0,3,2] row_mask:0xf bank_mask:0xf
s_nop 1
v_add_f32_dpp v64, v64, v64 quad_perm:[2,3,0,1] row_mask:0xf bank_mask:0xf
s_waitcnt vmcnt(31)
v_dot2_f32_bf16 v232, v92, v216, 0
v_dot2_f32_bf16 v233, v92, v220, 0
v_dot2_f32_bf16 v234, v92, v224, 0
v_dot2_f32_bf16 v235, v92, v228, 0
v_dot2_f32_bf16 v232, v93, v217, v232
v_dot2_f32_bf16 v233, v93, v221, v233
v_dot2_f32_bf16 v234, v93, v225, v234
v_dot2_f32_bf16 v235, v93, v229, v235
v_dot2_f32_bf16 v232, v94, v218, v232
v_dot2_f32_bf16 v233, v94, v222, v233
v_dot2_f32_bf16 v234, v94, v226, v234
v_dot2_f32_bf16 v235, v94, v230, v235
v_dot2_f32_bf16 v232, v95, v219, v232
v_dot2_f32_bf16 v233, v95, v223, v233
v_dot2_f32_bf16 v234, v95, v227, v234
v_dot2_f32_bf16 v235, v95, v231, v235
v_add_f32_dpp v236, v232, v232 row_ror:8 row_mask:0xf bank_mask:0x3
v_add_f32_dpp v237, v233, v233 row_ror:8 row_mask:0xf bank_mask:0x3
v_add_f32_dpp v236, v234, v234 row_ror:8 row_mask:0xf bank_mask:0xc
v_add_f32_dpp v237, v235, v235 row_ror:8 row_mask:0xf bank_mask:0xc
s_nop 0
v_add_f32_dpp v65, v236, v236 row_half_mirror row_mask:0xf bank_mask:0x5
v_add_f32_dpp v65, v237, v237 row_half_mirror row_mask:0xf bank_mask:0xa
s_nop 1
v_add_f32_dpp v65, v65, v65 quad_perm:[1,0,3,2] row_mask:0xf bank_mask:0xf
s_nop 1
v_add_f32_dpp v65, v65, v65 quad_perm:[2,3,0,1] row_mask:0xf bank_mask:0xf
s_waitcnt vmcnt(30)
v_dot2_f32_bf16 v232, v96, v216, 0
v_dot2_f32_bf16 v233, v96, v220, 0
v_dot2_f32_bf16 v234, v96, v224, 0
v_dot2_f32_bf16 v235, v96, v228, 0
v_dot2_f32_bf16 v232, v97, v217, v232
v_dot2_f32_bf16 v233, v97, v221, v233
v_dot2_f32_bf16 v234, v97, v225, v234
v_dot2_f32_bf16 v235, v97, v229, v235
v_dot2_f32_bf16 v232, v98, v218, v232
v_dot2_f32_bf16 v233, v98, v222, v233
v_dot2_f32_bf16 v234, v98, v226, v234
v_dot2_f32_bf16 v235, v98, v230, v235
v_dot2_f32_bf16 v232, v99, v219, v232
v_dot2_f32_bf16 v233, v99, v223, v233
v_dot2_f32_bf16 v234, v99, v227, v234
v_dot2_f32_bf16 v235, v99, v231, v235
v_add_f32_dpp v236, v232, v232 row_ror:8 row_mask:0xf bank_mask:0x3
v_add_f32_dpp v237, v233, v233 row_ror:8 row_mask:0xf bank_mask:0x3
v_add_f32_dpp v236, v234, v234 row_ror:8 row_mask:0xf bank_mask:0xc
v_add_f32_dpp v237, v235, v235 row_ror:8 row_mask:0xf bank_mask:0xc
s_nop 0
v_add_f32_dpp v66, v236, v236 row_half_mirror row_mask:0xf bank_mask:0x5
v_add_f32_dpp v66, v237, v237 row_half_mirror row_mask:0xf bank_mask:0xa
s_nop 1
v_add_f32_dpp v66, v66, v66 quad_perm:[1,0,3,2] row_mask:0xf bank_mask:0xf
s_nop 1
v_add_f32_dpp v66, v66, v66 quad_perm:[2,3,0,1] row_mask:0xf bank_mask:0xf
s_waitcnt vmcnt(29)
v_dot2_f32_bf16 v232, v100, v216, 0
v_dot2_f32_bf16 v233, v100, v220, 0
v_dot2_f32_bf16 v234, v100, v224, 0
v_dot2_f32_bf16 v235, v100, v228, 0
v_dot2_f32_bf16 v232, v101, v217, v232
v_dot2_f32_bf16 v233, v101, v221, v233
v_dot2_f32_bf16 v234, v101, v225, v234
v_dot2_f32_bf16 v235, v101, v229, v235
v_dot2_f32_bf16 v232, v102, v218, v232
v_dot2_f32_bf16 v233, v102, v222, v233
v_dot2_f32_bf16 v234, v102, v226, v234
v_dot2_f32_bf16 v235, v102, v230, v235
v_dot2_f32_bf16 v232, v103, v219, v232
v_dot2_f32_bf16 v233, v103, v223, v233
v_dot2_f32_bf16 v234, v103, v227, v234
v_dot2_f32_bf16 v235, v103, v231, v235
v_add_f32_dpp v236, v232, v232 row_ror:8 row_mask:0xf bank_mask:0x3
v_add_f32_dpp v237, v233, v233 row_ror:8 row_mask:0xf bank_mask:0x3
v_add_f32_dpp v236, v234, v234 row_ror:8 row_mask:0xf bank_mask:0xc
v_add_f32_dpp v237, v235, v235 row_ror:8 row_mask:0xf bank_mask:0xc
s_nop 0
v_add_f32_dpp v67, v236, v236 row_half_mirror row_mask:0xf bank_mask:0x5
v_add_f32_dpp v67, v237, v237 row_half_mirror row_mask:0xf bank_mask:0xa
s_nop 1
v_add_f32_dpp v67, v67, v67 quad_perm:[1,0,3,2] row_mask:0xf bank_mask:0xf
s_nop 1
v_add_f32_dpp v67, v67, v67 quad_perm:[2,3,0,1] row_mask:0xf bank_mask:0xf
s_waitcnt vmcnt(28)
v_dot2_f32_bf16 v232, v104, v216, 0
v_dot2_f32_bf16 v233, v104, v220, 0
v_dot2_f32_bf16 v234, v104, v224, 0
v_dot2_f32_bf16 v235, v104, v228, 0
v_dot2_f32_bf16 v232, v105, v217, v232
v_dot2_f32_bf16 v233, v105, v221, v233
v_dot2_f32_bf16 v234, v105, v225, v234
v_dot2_f32_bf16 v235, v105, v229, v235
v_dot2_f32_bf16 v232, v106, v218, v232
v_dot2_f32_bf16 v233, v106, v222, v233
v_dot2_f32_bf16 v234, v106, v226, v234
v_dot2_f32_bf16 v235, v106, v230, v235
v_dot2_f32_bf16 v232, v107, v219, v232
v_dot2_f32_bf16 v233, v107, v223, v233
v_dot2_f32_bf16 v234, v107, v227, v234
v_dot2_f32_bf16 v235, v107, v231, v235
v_add_f32_dpp v236, v232, v232 row_ror:8 row_mask:0xf bank_mask:0x3
v_add_f32_dpp v237, v233, v233 row_ror:8 row_mask:0xf bank_mask:0x3
v_add_f32_dpp v236, v234, v234 row_ror:8 row_mask:0xf bank_mask:0xc
v_add_f32_dpp v237, v235, v235 row_ror:8 row_mask:0xf bank_mask:0xc
s_nop 0
v_add_f32_dpp v68, v236, v236 row_half_mirror row_mask:0xf bank_mask:0x5
v_add_f32_dpp v68, v237, v237 row_half_mirror row_mask:0xf bank_mask:0xa
s_nop 1
v_add_f32_dpp v68, v68, v68 quad_perm:[1,0,3,2] row_mask:0xf bank_mask:0xf
s_nop 1
v_add_f32_dpp v68, v68, v68 quad_perm:[2,3,0,1] row_mask:0xf bank_mask:0xf
s_waitcnt vmcnt(27)
v_dot2_f32_bf16 v232, v108, v216, 0
v_dot2_f32_bf16 v233, v108, v220, 0
v_dot2_f32_bf16 v234, v108, v224, 0
v_dot2_f32_bf16 v235, v108, v228, 0
v_dot2_f32_bf16 v232, v109, v217, v232
v_dot2_f32_bf16 v233, v109, v221, v233
v_dot2_f32_bf16 v234, v109, v225, v234
v_dot2_f32_bf16 v235, v109, v229, v235
v_dot2_f32_bf16 v232, v110, v218, v232
v_dot2_f32_bf16 v233, v110, v222, v233
v_dot2_f32_bf16 v234, v110, v226, v234
v_dot2_f32_bf16 v235, v110, v230, v235
v_dot2_f32_bf16 v232, v111, v219, v232
v_dot2_f32_bf16 v233, v111, v223, v233
v_dot2_f32_bf16 v234, v111, v227, v234
v_dot2_f32_bf16 v235, v111, v231, v235
v_add_f32_dpp v236, v232, v232 row_ror:8 row_mask:0xf bank_mask:0x3
v_add_f32_dpp v237, v233, v233 row_ror:8 row_mask:0xf bank_mask:0x3
v_add_f32_dpp v236, v234, v234 row_ror:8 row_mask:0xf bank_mask:0xc
v_add_f32_dpp v237, v235, v235 row_ror:8 row_mask:0xf bank_mask:0xc
s_nop 0
v_add_f32_dpp v69, v236, v236 row_half_mirror row_mask:0xf bank_mask:0x5
v_add_f32_dpp v69, v237, v237 row_half_mirror row_mask:0xf bank_mask:0xa
s_nop 1
v_add_f32_dpp v69, v69, v69 quad_perm:[1,0,3,2] row_mask:0xf bank_mask:0xf
s_nop 1
v_add_f32_dpp v69, v69, v69 quad_perm:[2,3,0,1] row_mask:0xf bank_mask:0xf
s_waitcnt vmcnt(26)
v_dot2_f32_bf16 v232, v112, v216, 0
v_dot2_f32_bf16 v233, v112, v220, 0
v_dot2_f32_bf16 v234, v112, v224, 0
v_dot2_f32_bf16 v235, v112, v228, 0
v_dot2_f32_bf16 v232, v113, v217, v232
v_dot2_f32_bf16 v233, v113, v221, v233
v_dot2_f32_bf16 v234, v113, v225, v234
v_dot2_f32_bf16 v235, v113, v229, v235
v_dot2_f32_bf16 v232, v114, v218, v232
v_dot2_f32_bf16 v233, v114, v222, v233
v_dot2_f32_bf16 v234, v114, v226, v234
v_dot2_f32_bf16 v235, v114, v230, v235
v_dot2_f32_bf16 v232, v115, v219, v232
v_dot2_f32_bf16 v233, v115, v223, v233
v_dot2_f32_bf16 v234, v115, v227, v234
v_dot2_f32_bf16 v235, v115, v231, v235
v_add_f32_dpp v236, v232, v232 row_ror:8 row_mask:0xf bank_mask:0x3
v_add_f32_dpp v237, v233, v233 row_ror:8 row_mask:0xf bank_mask:0x3
v_add_f32_dpp v236, v234, v234 row_ror:8 row_mask:0xf bank_mask:0xc
v_add_f32_dpp v237, v235, v235 row_ror:8 row_mask:0xf bank_mask:0xc
s_nop 0
v_add_f32_dpp v70, v236, v236 row_half_mirror row_mask:0xf bank_mask:0x5
v_add_f32_dpp v70, v237, v237 row_half_mirror row_mask:0xf bank_mask:0xa
s_nop 1
v_add_f32_dpp v70, v70, v70 quad_perm:[1,0,3,2] row_mask:0xf bank_mask:0xf
s_nop 1
v_add_f32_dpp v70, v70, v70 quad_perm:[2,3,0,1] row_mask:0xf bank_mask:0xf
s_waitcnt vmcnt(25)
v_dot2_f32_bf16 v232, v116, v216, 0
v_dot2_f32_bf16 v233, v116, v220, 0
v_dot2_f32_bf16 v234, v116, v224, 0
v_dot2_f32_bf16 v235, v116, v228, 0
v_dot2_f32_bf16 v232, v117, v217, v232
v_dot2_f32_bf16 v233, v117, v221, v233
v_dot2_f32_bf16 v234, v117, v225, v234
v_dot2_f32_bf16 v235, v117, v229, v235
v_dot2_f32_bf16 v232, v118, v218, v232
v_dot2_f32_bf16 v233, v118, v222, v233
v_dot2_f32_bf16 v234, v118, v226, v234
v_dot2_f32_bf16 v235, v118, v230, v235
v_dot2_f32_bf16 v232, v119, v219, v232
v_dot2_f32_bf16 v233, v119, v223, v233
v_dot2_f32_bf16 v234, v119, v227, v234
v_dot2_f32_bf16 v235, v119, v231, v235
v_add_f32_dpp v236, v232, v232 row_ror:8 row_mask:0xf bank_mask:0x3
v_add_f32_dpp v237, v233, v233 row_ror:8 row_mask:0xf bank_mask:0x3
v_add_f32_dpp v236, v234, v234 row_ror:8 row_mask:0xf bank_mask:0xc
v_add_f32_dpp v237, v235, v235 row_ror:8 row_mask:0xf bank_mask:0xc
s_nop 0
v_add_f32_dpp v71, v236, v236 row_half_mirror row_mask:0xf bank_mask:0x5
v_add_f32_dpp v71, v237, v237 row_half_mirror row_mask:0xf bank_mask:0xa
s_nop 1
v_add_f32_dpp v71, v71, v71 quad_perm:[1,0,3,2] row_mask:0xf bank_mask:0xf
s_nop 1
v_add_f32_dpp v71, v71, v71 quad_perm:[2,3,0,1] row_mask:0xf bank_mask:0xf
s_waitcnt vmcnt(24)
v_dot2_f32_bf16 v232, v120, v216, 0
v_dot2_f32_bf16 v233, v120, v220, 0
v_dot2_f32_bf16 v234, v120, v224, 0
v_dot2_f32_bf16 v235, v120, v228, 0
v_dot2_f32_bf16 v232, v121, v217, v232
v_dot2_f32_bf16 v233, v121, v221, v233
v_dot2_f32_bf16 v234, v121, v225, v234
v_dot2_f32_bf16 v235, v121, v229, v235
v_dot2_f32_bf16 v232, v122, v218, v232
v_dot2_f32_bf16 v233, v122, v222, v233
v_dot2_f32_bf16 v234, v122, v226, v234
v_dot2_f32_bf16 v235, v122, v230, v235
v_dot2_f32_bf16 v232, v123, v219, v232
v_dot2_f32_bf16 v233, v123, v223, v233
v_dot2_f32_bf16 v234, v123, v227, v234
v_dot2_f32_bf16 v235, v123, v231, v235
v_add_f32_dpp v236, v232, v232 row_ror:8 row_mask:0xf bank_mask:0x3
v_add_f32_dpp v237, v233, v233 row_ror:8 row_mask:0xf bank_mask:0x3
v_add_f32_dpp v236, v234, v234 row_ror:8 row_mask:0xf bank_mask:0xc
v_add_f32_dpp v237, v235, v235 row_ror:8 row_mask:0xf bank_mask:0xc
s_nop 0
v_add_f32_dpp v72, v236, v236 row_half_mirror row_mask:0xf bank_mask:0x5
v_add_f32_dpp v72, v237, v237 row_half_mirror row_mask:0xf bank_mask:0xa
s_nop 1
v_add_f32_dpp v72, v72, v72 quad_perm:[1,0,3,2] row_mask:0xf bank_mask:0xf
s_nop 1
v_add_f32_dpp v72, v72, v72 quad_perm:[2,3,0,1] row_mask:0xf bank_mask:0xf
s_waitcnt vmcnt(23)
v_dot2_f32_bf16 v232, v124, v216, 0
v_dot2_f32_bf16 v233, v124, v220, 0
v_dot2_f32_bf16 v234, v124, v224, 0
v_dot2_f32_bf16 v235, v124, v228, 0
v_dot2_f32_bf16 v232, v125, v217, v232
v_dot2_f32_bf16 v233, v125, v221, v233
v_dot2_f32_bf16 v234, v125, v225, v234
v_dot2_f32_bf16 v235, v125, v229, v235
v_dot2_f32_bf16 v232, v126, v218, v232
v_dot2_f32_bf16 v233, v126, v222, v233
v_dot2_f32_bf16 v234, v126, v226, v234
v_dot2_f32_bf16 v235, v126, v230, v235
v_dot2_f32_bf16 v232, v127, v219, v232
v_dot2_f32_bf16 v233, v127, v223, v233
v_dot2_f32_bf16 v234, v127, v227, v234
v_dot2_f32_bf16 v235, v127, v231, v235
v_add_f32_dpp v236, v232, v232 row_ror:8 row_mask:0xf bank_mask:0x3
v_add_f32_dpp v237, v233, v233 row_ror:8 row_mask:0xf bank_mask:0x3
v_add_f32_dpp v236, v234, v234 row_ror:8 row_mask:0xf bank_mask:0xc
v_add_f32_dpp v237, v235, v235 row_ror:8 row_mask:0xf bank_mask:0xc
s_nop 0
v_add_f32_dpp v73, v236, v236 row_half_mirror row_mask:0xf bank_mask:0x5
v_add_f32_dpp v73, v237, v237 row_half_mirror row_mask:0xf bank_mask:0xa
s_nop 1
v_add_f32_dpp v73, v73, v73 quad_perm:[1,0,3,2] row_mask:0xf bank_mask:0xf
s_nop 1
v_add_f32_dpp v73, v73, v73 quad_perm:[2,3,0,1] row_mask:0xf bank_mask:0xf
s_waitcnt vmcnt(22)
v_dot2_f32_bf16 v232, v128, v216, 0
v_dot2_f32_bf16 v233, v128, v220, 0
v_dot2_f32_bf16 v234, v128, v224, 0
v_dot2_f32_bf16 v235, v128, v228, 0
v_dot2_f32_bf16 v232, v129, v217, v232
v_dot2_f32_bf16 v233, v129, v221, v233
v_dot2_f32_bf16 v234, v129, v225, v234
v_dot2_f32_bf16 v235, v129, v229, v235
v_dot2_f32_bf16 v232, v130, v218, v232
v_dot2_f32_bf16 v233, v130, v222, v233
v_dot2_f32_bf16 v234, v130, v226, v234
v_dot2_f32_bf16 v235, v130, v230, v235
v_dot2_f32_bf16 v232, v131, v219, v232
v_dot2_f32_bf16 v233, v131, v223, v233
v_dot2_f32_bf16 v234, v131, v227, v234
v_dot2_f32_bf16 v235, v131, v231, v235
v_add_f32_dpp v236, v232, v232 row_ror:8 row_mask:0xf bank_mask:0x3
v_add_f32_dpp v237, v233, v233 row_ror:8 row_mask:0xf bank_mask:0x3
v_add_f32_dpp v236, v234, v234 row_ror:8 row_mask:0xf bank_mask:0xc
v_add_f32_dpp v237, v235, v235 row_ror:8 row_mask:0xf bank_mask:0xc
s_nop 0
v_add_f32_dpp v74, v236, v236 row_half_mirror row_mask:0xf bank_mask:0x5
v_add_f32_dpp v74, v237, v237 row_half_mirror row_mask:0xf bank_mask:0xa
s_nop 1
v_add_f32_dpp v74, v74, v74 quad_perm:[1,0,3,2] row_mask:0xf bank_mask:0xf
s_nop 1
v_add_f32_dpp v74, v74, v74 quad_perm:[2,3,0,1] row_mask:0xf bank_mask:0xf
s_waitcnt vmcnt(21)
v_dot2_f32_bf16 v232, v132, v216, 0
v_dot2_f32_bf16 v233, v132, v220, 0
v_dot2_f32_bf16 v234, v132, v224, 0
v_dot2_f32_bf16 v235, v132, v228, 0
v_dot2_f32_bf16 v232, v133, v217, v232
v_dot2_f32_bf16 v233, v133, v221, v233
v_dot2_f32_bf16 v234, v133, v225, v234
v_dot2_f32_bf16 v235, v133, v229, v235
v_dot2_f32_bf16 v232, v134, v218, v232
v_dot2_f32_bf16 v233, v134, v222, v233
v_dot2_f32_bf16 v234, v134, v226, v234
v_dot2_f32_bf16 v235, v134, v230, v235
v_dot2_f32_bf16 v232, v135, v219, v232
v_dot2_f32_bf16 v233, v135, v223, v233
v_dot2_f32_bf16 v234, v135, v227, v234
v_dot2_f32_bf16 v235, v135, v231, v235
v_add_f32_dpp v236, v232, v232 row_ror:8 row_mask:0xf bank_mask:0x3
v_add_f32_dpp v237, v233, v233 row_ror:8 row_mask:0xf bank_mask:0x3
v_add_f32_dpp v236, v234, v234 row_ror:8 row_mask:0xf bank_mask:0xc
v_add_f32_dpp v237, v235, v235 row_ror:8 row_mask:0xf bank_mask:0xc
s_nop 0
v_add_f32_dpp v75, v236, v236 row_half_mirror row_mask:0xf bank_mask:0x5
v_add_f32_dpp v75, v237, v237 row_half_mirror row_mask:0xf bank_mask:0xa
s_nop 1
v_add_f32_dpp v75, v75, v75 quad_perm:[1,0,3,2] row_mask:0xf bank_mask:0xf
s_nop 1
v_add_f32_dpp v75, v75, v75 quad_perm:[2,3,0,1] row_mask:0xf bank_mask:0xf
s_waitcnt vmcnt(20)
v_dot2_f32_bf16 v232, v136, v216, 0
v_dot2_f32_bf16 v233, v136, v220, 0
v_dot2_f32_bf16 v234, v136, v224, 0
v_dot2_f32_bf16 v235, v136, v228, 0
v_dot2_f32_bf16 v232, v137, v217, v232
v_dot2_f32_bf16 v233, v137, v221, v233
v_dot2_f32_bf16 v234, v137, v225, v234
v_dot2_f32_bf16 v235, v137, v229, v235
v_dot2_f32_bf16 v232, v138, v218, v232
v_dot2_f32_bf16 v233, v138, v222, v233
v_dot2_f32_bf16 v234, v138, v226, v234
v_dot2_f32_bf16 v235, v138, v230, v235
v_dot2_f32_bf16 v232, v139, v219, v232
v_dot2_f32_bf16 v233, v139, v223, v233
v_dot2_f32_bf16 v234, v139, v227, v234
v_dot2_f32_bf16 v235, v139, v231, v235
v_add_f32_dpp v236, v232, v232 row_ror:8 row_mask:0xf bank_mask:0x3
v_add_f32_dpp v237, v233, v233 row_ror:8 row_mask:0xf bank_mask:0x3
v_add_f32_dpp v236, v234, v234 row_ror:8 row_mask:0xf bank_mask:0xc
v_add_f32_dpp v237, v235, v235 row_ror:8 row_mask:0xf bank_mask:0xc
s_nop 0
v_add_f32_dpp v76, v236, v236 row_half_mirror row_mask:0xf bank_mask:0x5
v_add_f32_dpp v76, v237, v237 row_half_mirror row_mask:0xf bank_mask:0xa
s_nop 1
v_add_f32_dpp v76, v76, v76 quad_perm:[1,0,3,2] row_mask:0xf bank_mask:0xf
s_nop 1
v_add_f32_dpp v76, v76, v76 quad_perm:[2,3,0,1] row_mask:0xf bank_mask:0xf
s_waitcnt vmcnt(19)
v_dot2_f32_bf16 v232, v140, v216, 0
v_dot2_f32_bf16 v233, v140, v220, 0
v_dot2_f32_bf16 v234, v140, v224, 0
v_dot2_f32_bf16 v235, v140, v228, 0
v_dot2_f32_bf16 v232, v141, v217, v232
v_dot2_f32_bf16 v233, v141, v221, v233
v_dot2_f32_bf16 v234, v141, v225, v234
v_dot2_f32_bf16 v235, v141, v229, v235
v_dot2_f32_bf16 v232, v142, v218, v232
v_dot2_f32_bf16 v233, v142, v222, v233
v_dot2_f32_bf16 v234, v142, v226, v234
v_dot2_f32_bf16 v235, v142, v230, v235
v_dot2_f32_bf16 v232, v143, v219, v232
v_dot2_f32_bf16 v233, v143, v223, v233
v_dot2_f32_bf16 v234, v143, v227, v234
v_dot2_f32_bf16 v235, v143, v231, v235
v_add_f32_dpp v236, v232, v232 row_ror:8 row_mask:0xf bank_mask:0x3
v_add_f32_dpp v237, v233, v233 row_ror:8 row_mask:0xf bank_mask:0x3
v_add_f32_dpp v236, v234, v234 row_ror:8 row_mask:0xf bank_mask:0xc
v_add_f32_dpp v237, v235, v235 row_ror:8 row_mask:0xf bank_mask:0xc
s_nop 0
v_add_f32_dpp v77, v236, v236 row_half_mirror row_mask:0xf bank_mask:0x5
v_add_f32_dpp v77, v237, v237 row_half_mirror row_mask:0xf bank_mask:0xa
s_nop 1
v_add_f32_dpp v77, v77, v77 quad_perm:[1,0,3,2] row_mask:0xf bank_mask:0xf
s_nop 1
v_add_f32_dpp v77, v77, v77 quad_perm:[2,3,0,1] row_mask:0xf bank_mask:0xf
s_waitcnt vmcnt(18)
v_dot2_f32_bf16 v232, v144, v216, 0
v_dot2_f32_bf16 v233, v144, v220, 0
v_dot2_f32_bf16 v234, v144, v224, 0
v_dot2_f32_bf16 v235, v144, v228, 0
v_dot2_f32_bf16 v232, v145, v217, v232
v_dot2_f32_bf16 v233, v145, v221, v233
v_dot2_f32_bf16 v234, v145, v225, v234
v_dot2_f32_bf16 v235, v145, v229, v235
v_dot2_f32_bf16 v232, v146, v218, v232
v_dot2_f32_bf16 v233, v146, v222, v233
v_dot2_f32_bf16 v234, v146, v226, v234
v_dot2_f32_bf16 v235, v146, v230, v235
v_dot2_f32_bf16 v232, v147, v219, v232
v_dot2_f32_bf16 v233, v147, v223, v233
v_dot2_f32_bf16 v234, v147, v227, v234
v_dot2_f32_bf16 v235, v147, v231, v235
v_add_f32_dpp v236, v232, v232 row_ror:8 row_mask:0xf bank_mask:0x3
v_add_f32_dpp v237, v233, v233 row_ror:8 row_mask:0xf bank_mask:0x3
v_add_f32_dpp v236, v234, v234 row_ror:8 row_mask:0xf bank_mask:0xc
v_add_f32_dpp v237, v235, v235 row_ror:8 row_mask:0xf bank_mask:0xc
s_nop 0
v_add_f32_dpp v78, v236, v236 row_half_mirror row_mask:0xf bank_mask:0x5
v_add_f32_dpp v78, v237, v237 row_half_mirror row_mask:0xf bank_mask:0xa
s_nop 1
v_add_f32_dpp v78, v78, v78 quad_perm:[1,0,3,2] row_mask:0xf bank_mask:0xf
s_nop 1
v_add_f32_dpp v78, v78, v78 quad_perm:[2,3,0,1] row_mask:0xf bank_mask:0xf
s_waitcnt vmcnt(17)
v_dot2_f32_bf16 v232, v148, v216, 0
v_dot2_f32_bf16 v233, v148, v220, 0
v_dot2_f32_bf16 v234, v148, v224, 0
v_dot2_f32_bf16 v235, v148, v228, 0
v_dot2_f32_bf16 v232, v149, v217, v232
v_dot2_f32_bf16 v233, v149, v221, v233
v_dot2_f32_bf16 v234, v149, v225, v234
v_dot2_f32_bf16 v235, v149, v229, v235
v_dot2_f32_bf16 v232, v150, v218, v232
v_dot2_f32_bf16 v233, v150, v222, v233
v_dot2_f32_bf16 v234, v150, v226, v234
v_dot2_f32_bf16 v235, v150, v230, v235
v_dot2_f32_bf16 v232, v151, v219, v232
v_dot2_f32_bf16 v233, v151, v223, v233
v_dot2_f32_bf16 v234, v151, v227, v234
v_dot2_f32_bf16 v235, v151, v231, v235
v_add_f32_dpp v236, v232, v232 row_ror:8 row_mask:0xf bank_mask:0x3
v_add_f32_dpp v237, v233, v233 row_ror:8 row_mask:0xf bank_mask:0x3
v_add_f32_dpp v236, v234, v234 row_ror:8 row_mask:0xf bank_mask:0xc
v_add_f32_dpp v237, v235, v235 row_ror:8 row_mask:0xf bank_mask:0xc
s_nop 0
v_add_f32_dpp v79, v236, v236 row_half_mirror row_mask:0xf bank_mask:0x5
v_add_f32_dpp v79, v237, v237 row_half_mirror row_mask:0xf bank_mask:0xa
s_nop 1
v_add_f32_dpp v79, v79, v79 quad_perm:[1,0,3,2] row_mask:0xf bank_mask:0xf
s_nop 1
v_add_f32_dpp v79, v79, v79 quad_perm:[2,3,0,1] row_mask:0xf bank_mask:0xf
v_cvt_pk_bf16_f32 v24, v64, v65
v_cvt_pk_bf16_f32 v25, v66, v67
v_cvt_pk_bf16_f32 v26, v68, v69
v_cvt_pk_bf16_f32 v27, v70, v71
v_cvt_pk_bf16_f32 v28, v72, v73
v_cvt_pk_bf16_f32 v29, v74, v75
v_cvt_pk_bf16_f32 v30, v76, v77
v_cvt_pk_bf16_f32 v31, v78, v79
v_cmp_eq_u32 vcc, 1, v6
s_nop 1
v_cndmask_b32 v244, v24, v28, vcc
v_cndmask_b32 v245, v25, v29, vcc
v_cndmask_b32 v246, v26, v30, vcc
v_cndmask_b32 v247, v27, v31, vcc
s_waitcnt vmcnt(16)
v_dot2_f32_bf16 v232, v152, v216, 0
v_dot2_f32_bf16 v233, v152, v220, 0
v_dot2_f32_bf16 v234, v152, v224, 0
v_dot2_f32_bf16 v235, v152, v228, 0
v_dot2_f32_bf16 v232, v153, v217, v232
v_dot2_f32_bf16 v233, v153, v221, v233
v_dot2_f32_bf16 v234, v153, v225, v234
v_dot2_f32_bf16 v235, v153, v229, v235
v_dot2_f32_bf16 v232, v154, v218, v232
v_dot2_f32_bf16 v233, v154, v222, v233
v_dot2_f32_bf16 v234, v154, v226, v234
v_dot2_f32_bf16 v235, v154, v230, v235
v_dot2_f32_bf16 v232, v155, v219, v232
v_dot2_f32_bf16 v233, v155, v223, v233
v_dot2_f32_bf16 v234, v155, v227, v234
v_dot2_f32_bf16 v235, v155, v231, v235
v_add_f32_dpp v236, v232, v232 row_ror:8 row_mask:0xf bank_mask:0x3
v_add_f32_dpp v237, v233, v233 row_ror:8 row_mask:0xf bank_mask:0x3
v_add_f32_dpp v236, v234, v234 row_ror:8 row_mask:0xf bank_mask:0xc
v_add_f32_dpp v237, v235, v235 row_ror:8 row_mask:0xf bank_mask:0xc
s_nop 0
v_add_f32_dpp v64, v236, v236 row_half_mirror row_mask:0xf bank_mask:0x5
v_add_f32_dpp v64, v237, v237 row_half_mirror row_mask:0xf bank_mask:0xa
s_nop 1
v_add_f32_dpp v64, v64, v64 quad_perm:[1,0,3,2] row_mask:0xf bank_mask:0xf
s_nop 1
v_add_f32_dpp v64, v64, v64 quad_perm:[2,3,0,1] row_mask:0xf bank_mask:0xf
s_waitcnt vmcnt(15)
v_dot2_f32_bf16 v232, v156, v216, 0
v_dot2_f32_bf16 v233, v156, v220, 0
v_dot2_f32_bf16 v234, v156, v224, 0
v_dot2_f32_bf16 v235, v156, v228, 0
v_dot2_f32_bf16 v232, v157, v217, v232
v_dot2_f32_bf16 v233, v157, v221, v233
v_dot2_f32_bf16 v234, v157, v225, v234
v_dot2_f32_bf16 v235, v157, v229, v235
v_dot2_f32_bf16 v232, v158, v218, v232
v_dot2_f32_bf16 v233, v158, v222, v233
v_dot2_f32_bf16 v234, v158, v226, v234
v_dot2_f32_bf16 v235, v158, v230, v235
v_dot2_f32_bf16 v232, v159, v219, v232
v_dot2_f32_bf16 v233, v159, v223, v233
v_dot2_f32_bf16 v234, v159, v227, v234
v_dot2_f32_bf16 v235, v159, v231, v235
v_add_f32_dpp v236, v232, v232 row_ror:8 row_mask:0xf bank_mask:0x3
v_add_f32_dpp v237, v233, v233 row_ror:8 row_mask:0xf bank_mask:0x3
v_add_f32_dpp v236, v234, v234 row_ror:8 row_mask:0xf bank_mask:0xc
v_add_f32_dpp v237, v235, v235 row_ror:8 row_mask:0xf bank_mask:0xc
s_nop 0
v_add_f32_dpp v65, v236, v236 row_half_mirror row_mask:0xf bank_mask:0x5
v_add_f32_dpp v65, v237, v237 row_half_mirror row_mask:0xf bank_mask:0xa
s_nop 1
v_add_f32_dpp v65, v65, v65 quad_perm:[1,0,3,2] row_mask:0xf bank_mask:0xf
s_nop 1
v_add_f32_dpp v65, v65, v65 quad_perm:[2,3,0,1] row_mask:0xf bank_mask:0xf
s_waitcnt vmcnt(14)
v_dot2_f32_bf16 v232, v160, v216, 0
v_dot2_f32_bf16 v233, v160, v220, 0
v_dot2_f32_bf16 v234, v160, v224, 0
v_dot2_f32_bf16 v235, v160, v228, 0
v_dot2_f32_bf16 v232, v161, v217, v232
v_dot2_f32_bf16 v233, v161, v221, v233
v_dot2_f32_bf16 v234, v161, v225, v234
v_dot2_f32_bf16 v235, v161, v229, v235
v_dot2_f32_bf16 v232, v162, v218, v232
v_dot2_f32_bf16 v233, v162, v222, v233
v_dot2_f32_bf16 v234, v162, v226, v234
v_dot2_f32_bf16 v235, v162, v230, v235
v_dot2_f32_bf16 v232, v163, v219, v232
v_dot2_f32_bf16 v233, v163, v223, v233
v_dot2_f32_bf16 v234, v163, v227, v234
v_dot2_f32_bf16 v235, v163, v231, v235
v_add_f32_dpp v236, v232, v232 row_ror:8 row_mask:0xf bank_mask:0x3
v_add_f32_dpp v237, v233, v233 row_ror:8 row_mask:0xf bank_mask:0x3
v_add_f32_dpp v236, v234, v234 row_ror:8 row_mask:0xf bank_mask:0xc
v_add_f32_dpp v237, v235, v235 row_ror:8 row_mask:0xf bank_mask:0xc
s_nop 0
v_add_f32_dpp v66, v236, v236 row_half_mirror row_mask:0xf bank_mask:0x5
v_add_f32_dpp v66, v237, v237 row_half_mirror row_mask:0xf bank_mask:0xa
s_nop 1
v_add_f32_dpp v66, v66, v66 quad_perm:[1,0,3,2] row_mask:0xf bank_mask:0xf
s_nop 1
v_add_f32_dpp v66, v66, v66 quad_perm:[2,3,0,1] row_mask:0xf bank_mask:0xf
s_waitcnt vmcnt(13)
v_dot2_f32_bf16 v232, v164, v216, 0
v_dot2_f32_bf16 v233, v164, v220, 0
v_dot2_f32_bf16 v234, v164, v224, 0
v_dot2_f32_bf16 v235, v164, v228, 0
v_dot2_f32_bf16 v232, v165, v217, v232
v_dot2_f32_bf16 v233, v165, v221, v233
v_dot2_f32_bf16 v234, v165, v225, v234
v_dot2_f32_bf16 v235, v165, v229, v235
v_dot2_f32_bf16 v232, v166, v218, v232
v_dot2_f32_bf16 v233, v166, v222, v233
v_dot2_f32_bf16 v234, v166, v226, v234
v_dot2_f32_bf16 v235, v166, v230, v235
v_dot2_f32_bf16 v232, v167, v219, v232
v_dot2_f32_bf16 v233, v167, v223, v233
v_dot2_f32_bf16 v234, v167, v227, v234
v_dot2_f32_bf16 v235, v167, v231, v235
v_add_f32_dpp v236, v232, v232 row_ror:8 row_mask:0xf bank_mask:0x3
v_add_f32_dpp v237, v233, v233 row_ror:8 row_mask:0xf bank_mask:0x3
v_add_f32_dpp v236, v234, v234 row_ror:8 row_mask:0xf bank_mask:0xc
v_add_f32_dpp v237, v235, v235 row_ror:8 row_mask:0xf bank_mask:0xc
s_nop 0
v_add_f32_dpp v67, v236, v236 row_half_mirror row_mask:0xf bank_mask:0x5
v_add_f32_dpp v67, v237, v237 row_half_mirror row_mask:0xf bank_mask:0xa
s_nop 1
v_add_f32_dpp v67, v67, v67 quad_perm:[1,0,3,2] row_mask:0xf bank_mask:0xf
s_nop 1
v_add_f32_dpp v67, v67, v67 quad_perm:[2,3,0,1] row_mask:0xf bank_mask:0xf
s_waitcnt vmcnt(12)
v_dot2_f32_bf16 v232, v168, v216, 0
v_dot2_f32_bf16 v233, v168, v220, 0
v_dot2_f32_bf16 v234, v168, v224, 0
v_dot2_f32_bf16 v235, v168, v228, 0
v_dot2_f32_bf16 v232, v169, v217, v232
v_dot2_f32_bf16 v233, v169, v221, v233
v_dot2_f32_bf16 v234, v169, v225, v234
v_dot2_f32_bf16 v235, v169, v229, v235
v_dot2_f32_bf16 v232, v170, v218, v232
v_dot2_f32_bf16 v233, v170, v222, v233
v_dot2_f32_bf16 v234, v170, v226, v234
v_dot2_f32_bf16 v235, v170, v230, v235
v_dot2_f32_bf16 v232, v171, v219, v232
v_dot2_f32_bf16 v233, v171, v223, v233
v_dot2_f32_bf16 v234, v171, v227, v234
v_dot2_f32_bf16 v235, v171, v231, v235
v_add_f32_dpp v236, v232, v232 row_ror:8 row_mask:0xf bank_mask:0x3
v_add_f32_dpp v237, v233, v233 row_ror:8 row_mask:0xf bank_mask:0x3
v_add_f32_dpp v236, v234, v234 row_ror:8 row_mask:0xf bank_mask:0xc
v_add_f32_dpp v237, v235, v235 row_ror:8 row_mask:0xf bank_mask:0xc
s_nop 0
v_add_f32_dpp v68, v236, v236 row_half_mirror row_mask:0xf bank_mask:0x5
v_add_f32_dpp v68, v237, v237 row_half_mirror row_mask:0xf bank_mask:0xa
s_nop 1
v_add_f32_dpp v68, v68, v68 quad_perm:[1,0,3,2] row_mask:0xf bank_mask:0xf
s_nop 1
v_add_f32_dpp v68, v68, v68 quad_perm:[2,3,0,1] row_mask:0xf bank_mask:0xf
s_waitcnt vmcnt(11)
v_dot2_f32_bf16 v232, v172, v216, 0
v_dot2_f32_bf16 v233, v172, v220, 0
v_dot2_f32_bf16 v234, v172, v224, 0
v_dot2_f32_bf16 v235, v172, v228, 0
v_dot2_f32_bf16 v232, v173, v217, v232
v_dot2_f32_bf16 v233, v173, v221, v233
v_dot2_f32_bf16 v234, v173, v225, v234
v_dot2_f32_bf16 v235, v173, v229, v235
v_dot2_f32_bf16 v232, v174, v218, v232
v_dot2_f32_bf16 v233, v174, v222, v233
v_dot2_f32_bf16 v234, v174, v226, v234
v_dot2_f32_bf16 v235, v174, v230, v235
v_dot2_f32_bf16 v232, v175, v219, v232
v_dot2_f32_bf16 v233, v175, v223, v233
v_dot2_f32_bf16 v234, v175, v227, v234
v_dot2_f32_bf16 v235, v175, v231, v235
v_add_f32_dpp v236, v232, v232 row_ror:8 row_mask:0xf bank_mask:0x3
v_add_f32_dpp v237, v233, v233 row_ror:8 row_mask:0xf bank_mask:0x3
v_add_f32_dpp v236, v234, v234 row_ror:8 row_mask:0xf bank_mask:0xc
v_add_f32_dpp v237, v235, v235 row_ror:8 row_mask:0xf bank_mask:0xc
s_nop 0
v_add_f32_dpp v69, v236, v236 row_half_mirror row_mask:0xf bank_mask:0x5
v_add_f32_dpp v69, v237, v237 row_half_mirror row_mask:0xf bank_mask:0xa
s_nop 1
v_add_f32_dpp v69, v69, v69 quad_perm:[1,0,3,2] row_mask:0xf bank_mask:0xf
s_nop 1
v_add_f32_dpp v69, v69, v69 quad_perm:[2,3,0,1] row_mask:0xf bank_mask:0xf
s_waitcnt vmcnt(10)
v_dot2_f32_bf16 v232, v176, v216, 0
v_dot2_f32_bf16 v233, v176, v220, 0
v_dot2_f32_bf16 v234, v176, v224, 0
v_dot2_f32_bf16 v235, v176, v228, 0
v_dot2_f32_bf16 v232, v177, v217, v232
v_dot2_f32_bf16 v233, v177, v221, v233
v_dot2_f32_bf16 v234, v177, v225, v234
v_dot2_f32_bf16 v235, v177, v229, v235
v_dot2_f32_bf16 v232, v178, v218, v232
v_dot2_f32_bf16 v233, v178, v222, v233
v_dot2_f32_bf16 v234, v178, v226, v234
v_dot2_f32_bf16 v235, v178, v230, v235
v_dot2_f32_bf16 v232, v179, v219, v232
v_dot2_f32_bf16 v233, v179, v223, v233
v_dot2_f32_bf16 v234, v179, v227, v234
v_dot2_f32_bf16 v235, v179, v231, v235
v_add_f32_dpp v236, v232, v232 row_ror:8 row_mask:0xf bank_mask:0x3
v_add_f32_dpp v237, v233, v233 row_ror:8 row_mask:0xf bank_mask:0x3
v_add_f32_dpp v236, v234, v234 row_ror:8 row_mask:0xf bank_mask:0xc
v_add_f32_dpp v237, v235, v235 row_ror:8 row_mask:0xf bank_mask:0xc
s_nop 0
v_add_f32_dpp v70, v236, v236 row_half_mirror row_mask:0xf bank_mask:0x5
v_add_f32_dpp v70, v237, v237 row_half_mirror row_mask:0xf bank_mask:0xa
s_nop 1
v_add_f32_dpp v70, v70, v70 quad_perm:[1,0,3,2] row_mask:0xf bank_mask:0xf
s_nop 1
v_add_f32_dpp v70, v70, v70 quad_perm:[2,3,0,1] row_mask:0xf bank_mask:0xf
s_waitcnt vmcnt(9)
v_dot2_f32_bf16 v232, v180, v216, 0
v_dot2_f32_bf16 v233, v180, v220, 0
v_dot2_f32_bf16 v234, v180, v224, 0
v_dot2_f32_bf16 v235, v180, v228, 0
v_dot2_f32_bf16 v232, v181, v217, v232
v_dot2_f32_bf16 v233, v181, v221, v233
v_dot2_f32_bf16 v234, v181, v225, v234
v_dot2_f32_bf16 v235, v181, v229, v235
v_dot2_f32_bf16 v232, v182, v218, v232
v_dot2_f32_bf16 v233, v182, v222, v233
v_dot2_f32_bf16 v234, v182, v226, v234
v_dot2_f32_bf16 v235, v182, v230, v235
v_dot2_f32_bf16 v232, v183, v219, v232
v_dot2_f32_bf16 v233, v183, v223, v233
v_dot2_f32_bf16 v234, v183, v227, v234
v_dot2_f32_bf16 v235, v183, v231, v235
v_add_f32_dpp v236, v232, v232 row_ror:8 row_mask:0xf bank_mask:0x3
v_add_f32_dpp v237, v233, v233 row_ror:8 row_mask:0xf bank_mask:0x3
v_add_f32_dpp v236, v234, v234 row_ror:8 row_mask:0xf bank_mask:0xc
v_add_f32_dpp v237, v235, v235 row_ror:8 row_mask:0xf bank_mask:0xc
s_nop 0
v_add_f32_dpp v71, v236, v236 row_half_mirror row_mask:0xf bank_mask:0x5
v_add_f32_dpp v71, v237, v237 row_half_mirror row_mask:0xf bank_mask:0xa
s_nop 1
v_add_f32_dpp v71, v71, v71 quad_perm:[1,0,3,2] row_mask:0xf bank_mask:0xf
s_nop 1
v_add_f32_dpp v71, v71, v71 quad_perm:[2,3,0,1] row_mask:0xf bank_mask:0xf
s_waitcnt vmcnt(8)
v_dot2_f32_bf16 v232, v184, v216, 0
v_dot2_f32_bf16 v233, v184, v220, 0
v_dot2_f32_bf16 v234, v184, v224, 0
v_dot2_f32_bf16 v235, v184, v228, 0
v_dot2_f32_bf16 v232, v185, v217, v232
v_dot2_f32_bf16 v233, v185, v221, v233
v_dot2_f32_bf16 v234, v185, v225, v234
v_dot2_f32_bf16 v235, v185, v229, v235
v_dot2_f32_bf16 v232, v186, v218, v232
v_dot2_f32_bf16 v233, v186, v222, v233
v_dot2_f32_bf16 v234, v186, v226, v234
v_dot2_f32_bf16 v235, v186, v230, v235
v_dot2_f32_bf16 v232, v187, v219, v232
v_dot2_f32_bf16 v233, v187, v223, v233
v_dot2_f32_bf16 v234, v187, v227, v234
v_dot2_f32_bf16 v235, v187, v231, v235
v_add_f32_dpp v236, v232, v232 row_ror:8 row_mask:0xf bank_mask:0x3
v_add_f32_dpp v237, v233, v233 row_ror:8 row_mask:0xf bank_mask:0x3
v_add_f32_dpp v236, v234, v234 row_ror:8 row_mask:0xf bank_mask:0xc
v_add_f32_dpp v237, v235, v235 row_ror:8 row_mask:0xf bank_mask:0xc
s_nop 0
v_add_f32_dpp v72, v236, v236 row_half_mirror row_mask:0xf bank_mask:0x5
v_add_f32_dpp v72, v237, v237 row_half_mirror row_mask:0xf bank_mask:0xa
s_nop 1
v_add_f32_dpp v72, v72, v72 quad_perm:[1,0,3,2] row_mask:0xf bank_mask:0xf
s_nop 1
v_add_f32_dpp v72, v72, v72 quad_perm:[2,3,0,1] row_mask:0xf bank_mask:0xf
s_waitcnt vmcnt(7)
v_dot2_f32_bf16 v232, v188, v216, 0
v_dot2_f32_bf16 v233, v188, v220, 0
v_dot2_f32_bf16 v234, v188, v224, 0
v_dot2_f32_bf16 v235, v188, v228, 0
v_dot2_f32_bf16 v232, v189, v217, v232
v_dot2_f32_bf16 v233, v189, v221, v233
v_dot2_f32_bf16 v234, v189, v225, v234
v_dot2_f32_bf16 v235, v189, v229, v235
v_dot2_f32_bf16 v232, v190, v218, v232
v_dot2_f32_bf16 v233, v190, v222, v233
v_dot2_f32_bf16 v234, v190, v226, v234
v_dot2_f32_bf16 v235, v190, v230, v235
v_dot2_f32_bf16 v232, v191, v219, v232
v_dot2_f32_bf16 v233, v191, v223, v233
v_dot2_f32_bf16 v234, v191, v227, v234
v_dot2_f32_bf16 v235, v191, v231, v235
v_add_f32_dpp v236, v232, v232 row_ror:8 row_mask:0xf bank_mask:0x3
v_add_f32_dpp v237, v233, v233 row_ror:8 row_mask:0xf bank_mask:0x3
v_add_f32_dpp v236, v234, v234 row_ror:8 row_mask:0xf bank_mask:0xc
v_add_f32_dpp v237, v235, v235 row_ror:8 row_mask:0xf bank_mask:0xc
s_nop 0
v_add_f32_dpp v73, v236, v236 row_half_mirror row_mask:0xf bank_mask:0x5
v_add_f32_dpp v73, v237, v237 row_half_mirror row_mask:0xf bank_mask:0xa
s_nop 1
v_add_f32_dpp v73, v73, v73 quad_perm:[1,0,3,2] row_mask:0xf bank_mask:0xf
s_nop 1
v_add_f32_dpp v73, v73, v73 quad_perm:[2,3,0,1] row_mask:0xf bank_mask:0xf
s_waitcnt vmcnt(6)
v_dot2_f32_bf16 v232, v192, v216, 0
v_dot2_f32_bf16 v233, v192, v220, 0
v_dot2_f32_bf16 v234, v192, v224, 0
v_dot2_f32_bf16 v235, v192, v228, 0
v_dot2_f32_bf16 v232, v193, v217, v232
v_dot2_f32_bf16 v233, v193, v221, v233
v_dot2_f32_bf16 v234, v193, v225, v234
v_dot2_f32_bf16 v235, v193, v229, v235
v_dot2_f32_bf16 v232, v194, v218, v232
v_dot2_f32_bf16 v233, v194, v222, v233
v_dot2_f32_bf16 v234, v194, v226, v234
v_dot2_f32_bf16 v235, v194, v230, v235
v_dot2_f32_bf16 v232, v195, v219, v232
v_dot2_f32_bf16 v233, v195, v223, v233
v_dot2_f32_bf16 v234, v195, v227, v234
v_dot2_f32_bf16 v235, v195, v231, v235
v_add_f32_dpp v236, v232, v232 row_ror:8 row_mask:0xf bank_mask:0x3
v_add_f32_dpp v237, v233, v233 row_ror:8 row_mask:0xf bank_mask:0x3
v_add_f32_dpp v236, v234, v234 row_ror:8 row_mask:0xf bank_mask:0xc
v_add_f32_dpp v237, v235, v235 row_ror:8 row_mask:0xf bank_mask:0xc
s_nop 0
v_add_f32_dpp v74, v236, v236 row_half_mirror row_mask:0xf bank_mask:0x5
v_add_f32_dpp v74, v237, v237 row_half_mirror row_mask:0xf bank_mask:0xa
s_nop 1
v_add_f32_dpp v74, v74, v74 quad_perm:[1,0,3,2] row_mask:0xf bank_mask:0xf
s_nop 1
v_add_f32_dpp v74, v74, v74 quad_perm:[2,3,0,1] row_mask:0xf bank_mask:0xf
s_waitcnt vmcnt(5)
v_dot2_f32_bf16 v232, v196, v216, 0
v_dot2_f32_bf16 v233, v196, v220, 0
v_dot2_f32_bf16 v234, v196, v224, 0
v_dot2_f32_bf16 v235, v196, v228, 0
v_dot2_f32_bf16 v232, v197, v217, v232
v_dot2_f32_bf16 v233, v197, v221, v233
v_dot2_f32_bf16 v234, v197, v225, v234
v_dot2_f32_bf16 v235, v197, v229, v235
v_dot2_f32_bf16 v232, v198, v218, v232
v_dot2_f32_bf16 v233, v198, v222, v233
v_dot2_f32_bf16 v234, v198, v226, v234
v_dot2_f32_bf16 v235, v198, v230, v235
v_dot2_f32_bf16 v232, v199, v219, v232
v_dot2_f32_bf16 v233, v199, v223, v233
v_dot2_f32_bf16 v234, v199, v227, v234
v_dot2_f32_bf16 v235, v199, v231, v235
v_add_f32_dpp v236, v232, v232 row_ror:8 row_mask:0xf bank_mask:0x3
v_add_f32_dpp v237, v233, v233 row_ror:8 row_mask:0xf bank_mask:0x3
v_add_f32_dpp v236, v234, v234 row_ror:8 row_mask:0xf bank_mask:0xc
v_add_f32_dpp v237, v235, v235 row_ror:8 row_mask:0xf bank_mask:0xc
s_nop 0
v_add_f32_dpp v75, v236, v236 row_half_mirror row_mask:0xf bank_mask:0x5
v_add_f32_dpp v75, v237, v237 row_half_mirror row_mask:0xf bank_mask:0xa
s_nop 1
v_add_f32_dpp v75, v75, v75 quad_perm:[1,0,3,2] row_mask:0xf bank_mask:0xf
s_nop 1
v_add_f32_dpp v75, v75, v75 quad_perm:[2,3,0,1] row_mask:0xf bank_mask:0xf
s_waitcnt vmcnt(4)
v_dot2_f32_bf16 v232, v200, v216, 0
v_dot2_f32_bf16 v233, v200, v220, 0
v_dot2_f32_bf16 v234, v200, v224, 0
v_dot2_f32_bf16 v235, v200, v228, 0
v_dot2_f32_bf16 v232, v201, v217, v232
v_dot2_f32_bf16 v233, v201, v221, v233
v_dot2_f32_bf16 v234, v201, v225, v234
v_dot2_f32_bf16 v235, v201, v229, v235
v_dot2_f32_bf16 v232, v202, v218, v232
v_dot2_f32_bf16 v233, v202, v222, v233
v_dot2_f32_bf16 v234, v202, v226, v234
v_dot2_f32_bf16 v235, v202, v230, v235
v_dot2_f32_bf16 v232, v203, v219, v232
v_dot2_f32_bf16 v233, v203, v223, v233
v_dot2_f32_bf16 v234, v203, v227, v234
v_dot2_f32_bf16 v235, v203, v231, v235
v_add_f32_dpp v236, v232, v232 row_ror:8 row_mask:0xf bank_mask:0x3
v_add_f32_dpp v237, v233, v233 row_ror:8 row_mask:0xf bank_mask:0x3
v_add_f32_dpp v236, v234, v234 row_ror:8 row_mask:0xf bank_mask:0xc
v_add_f32_dpp v237, v235, v235 row_ror:8 row_mask:0xf bank_mask:0xc
s_nop 0
v_add_f32_dpp v76, v236, v236 row_half_mirror row_mask:0xf bank_mask:0x5
v_add_f32_dpp v76, v237, v237 row_half_mirror row_mask:0xf bank_mask:0xa
s_nop 1
v_add_f32_dpp v76, v76, v76 quad_perm:[1,0,3,2] row_mask:0xf bank_mask:0xf
s_nop 1
v_add_f32_dpp v76, v76, v76 quad_perm:[2,3,0,1] row_mask:0xf bank_mask:0xf
s_waitcnt vmcnt(3)
v_dot2_f32_bf16 v232, v204, v216, 0
v_dot2_f32_bf16 v233, v204, v220, 0
v_dot2_f32_bf16 v234, v204, v224, 0
v_dot2_f32_bf16 v235, v204, v228, 0
v_dot2_f32_bf16 v232, v205, v217, v232
v_dot2_f32_bf16 v233, v205, v221, v233
v_dot2_f32_bf16 v234, v205, v225, v234
v_dot2_f32_bf16 v235, v205, v229, v235
v_dot2_f32_bf16 v232, v206, v218, v232
v_dot2_f32_bf16 v233, v206, v222, v233
v_dot2_f32_bf16 v234, v206, v226, v234
v_dot2_f32_bf16 v235, v206, v230, v235
v_dot2_f32_bf16 v232, v207, v219, v232
v_dot2_f32_bf16 v233, v207, v223, v233
v_dot2_f32_bf16 v234, v207, v227, v234
v_dot2_f32_bf16 v235, v207, v231, v235
v_add_f32_dpp v236, v232, v232 row_ror:8 row_mask:0xf bank_mask:0x3
v_add_f32_dpp v237, v233, v233 row_ror:8 row_mask:0xf bank_mask:0x3
v_add_f32_dpp v236, v234, v234 row_ror:8 row_mask:0xf bank_mask:0xc
v_add_f32_dpp v237, v235, v235 row_ror:8 row_mask:0xf bank_mask:0xc
s_nop 0
v_add_f32_dpp v77, v236, v236 row_half_mirror row_mask:0xf bank_mask:0x5
v_add_f32_dpp v77, v237, v237 row_half_mirror row_mask:0xf bank_mask:0xa
s_nop 1
v_add_f32_dpp v77, v77, v77 quad_perm:[1,0,3,2] row_mask:0xf bank_mask:0xf
s_nop 1
v_add_f32_dpp v77, v77, v77 quad_perm:[2,3,0,1] row_mask:0xf bank_mask:0xf
s_waitcnt vmcnt(2)
v_dot2_f32_bf16 v232, v208, v216, 0
v_dot2_f32_bf16 v233, v208, v220, 0
v_dot2_f32_bf16 v234, v208, v224, 0
v_dot2_f32_bf16 v235, v208, v228, 0
v_dot2_f32_bf16 v232, v209, v217, v232
v_dot2_f32_bf16 v233, v209, v221, v233
v_dot2_f32_bf16 v234, v209, v225, v234
v_dot2_f32_bf16 v235, v209, v229, v235
v_dot2_f32_bf16 v232, v210, v218, v232
v_dot2_f32_bf16 v233, v210, v222, v233
v_dot2_f32_bf16 v234, v210, v226, v234
v_dot2_f32_bf16 v235, v210, v230, v235
v_dot2_f32_bf16 v232, v211, v219, v232
v_dot2_f32_bf16 v233, v211, v223, v233
v_dot2_f32_bf16 v234, v211, v227, v234
v_dot2_f32_bf16 v235, v211, v231, v235
v_add_f32_dpp v236, v232, v232 row_ror:8 row_mask:0xf bank_mask:0x3
v_add_f32_dpp v237, v233, v233 row_ror:8 row_mask:0xf bank_mask:0x3
v_add_f32_dpp v236, v234, v234 row_ror:8 row_mask:0xf bank_mask:0xc
v_add_f32_dpp v237, v235, v235 row_ror:8 row_mask:0xf bank_mask:0xc
s_nop 0
v_add_f32_dpp v78, v236, v236 row_half_mirror row_mask:0xf bank_mask:0x5
v_add_f32_dpp v78, v237, v237 row_half_mirror row_mask:0xf bank_mask:0xa
s_nop 1
v_add_f32_dpp v78, v78, v78 quad_perm:[1,0,3,2] row_mask:0xf bank_mask:0xf
s_nop 1
v_add_f32_dpp v78, v78, v78 quad_perm:[2,3,0,1] row_mask:0xf bank_mask:0xf
s_waitcnt vmcnt(1)
v_dot2_f32_bf16 v232, v212, v216, 0
v_dot2_f32_bf16 v233, v212, v220, 0
v_dot2_f32_bf16 v234, v212, v224, 0
v_dot2_f32_bf16 v235, v212, v228, 0
v_dot2_f32_bf16 v232, v213, v217, v232
v_dot2_f32_bf16 v233, v213, v221, v233
v_dot2_f32_bf16 v234, v213, v225, v234
v_dot2_f32_bf16 v235, v213, v229, v235
v_dot2_f32_bf16 v232, v214, v218, v232
v_dot2_f32_bf16 v233, v214, v222, v233
v_dot2_f32_bf16 v234, v214, v226, v234
v_dot2_f32_bf16 v235, v214, v230, v235
v_dot2_f32_bf16 v232, v215, v219, v232
v_dot2_f32_bf16 v233, v215, v223, v233
v_dot2_f32_bf16 v234, v215, v227, v234
v_dot2_f32_bf16 v235, v215, v231, v235
v_add_f32_dpp v236, v232, v232 row_ror:8 row_mask:0xf bank_mask:0x3
v_add_f32_dpp v237, v233, v233 row_ror:8 row_mask:0xf bank_mask:0x3
v_add_f32_dpp v236, v234, v234 row_ror:8 row_mask:0xf bank_mask:0xc
v_add_f32_dpp v237, v235, v235 row_ror:8 row_mask:0xf bank_mask:0xc
s_nop 0
v_add_f32_dpp v79, v236, v236 row_half_mirror row_mask:0xf bank_mask:0x5
v_add_f32_dpp v79, v237, v237 row_half_mirror row_mask:0xf bank_mask:0xa
s_nop 1
v_add_f32_dpp v79, v79, v79 quad_perm:[1,0,3,2] row_mask:0xf bank_mask:0xf
s_nop 1
v_add_f32_dpp v79, v79, v79 quad_perm:[2,3,0,1] row_mask:0xf bank_mask:0xf
v_cvt_pk_bf16_f32 v24, v64, v65
v_cvt_pk_bf16_f32 v25, v66, v67
v_cvt_pk_bf16_f32 v26, v68, v69
v_cvt_pk_bf16_f32 v27, v70, v71
v_cvt_pk_bf16_f32 v28, v72, v73
v_cvt_pk_bf16_f32 v29, v74, v75
v_cvt_pk_bf16_f32 v30, v76, v77
v_cvt_pk_bf16_f32 v31, v78, v79
v_cmp_eq_u32 vcc, 1, v6
s_nop 1
v_cndmask_b32 v248, v24, v28, vcc
v_cndmask_b32 v249, v25, v29, vcc
v_cndmask_b32 v250, v26, v30, vcc
v_cndmask_b32 v251, v27, v31, vcc
v_cmp_eq_u32 vcc, 1, v7
s_nop 1
v_cndmask_b32 v244, v244, v248, vcc
v_cndmask_b32 v245, v245, v249, vcc
v_cndmask_b32 v246, v246, v250, vcc
v_cndmask_b32 v247, v247, v251, vcc
v_min_u32 v244, -2, v244
v_min_u32 v245, -2, v245
v_min_u32 v246, -2, v246
v_min_u32 v247, -2, v247
s_waitcnt vmcnt(0)
s_mov_b32 s7, 400000
L_ens_15:
v_readfirstlane_b32 s6, v11
s_cmp_ge_u32 s6, 128
s_cbranch_scc1 L_ensd_16
s_sleep 16
buffer_load_dword v11, off, s[68:71], 0 offset:0 sc1
s_waitcnt vmcnt(0)
s_sub_u32 s7, s7, 1
s_cmp_lg_u32 s7, 0
s_cbranch_scc1 L_ens_15
L_ensd_16:
s_lshl_b32 s6, s4, 10
s_lshl_b32 s7, s3, 8
s_add_u32 s6, s6, s7
s_add_u32 s6, s6, 0
buffer_store_dwordx4 v[244:247], v5, s[64:67], s6 offen sc1
s_mov_b32 m0, s12
s_nop 0
buffer_load_dwordx4 v2, s[60:63], s12 offen offset:0 nt lds
buffer_load_dwordx4 v2, s[60:63], s12 offen offset:1024 nt lds
s_waitcnt vmcnt(2)
buffer_load_dwordx4 v2, s[60:63], s12 offen offset:2048 nt lds
s_waitcnt vmcnt(2)
buffer_load_dwordx4 v2, s[60:63], s12 offen offset:3072 nt lds
s_add_u32 s12, s12, 4096
s_mov_b32 m0, s12
s_waitcnt vmcnt(2)
buffer_load_dwordx4 v2, s[60:63], s12 offen offset:0 nt lds
s_waitcnt vmcnt(2)
buffer_load_dwordx4 v2, s[60:63], s12 offen offset:1024 nt lds
s_waitcnt vmcnt(2)
buffer_load_dwordx4 v2, s[60:63], s12 offen offset:2048 nt lds
s_waitcnt vmcnt(2)
buffer_load_dwordx4 v2, s[60:63], s12 offen offset:3072 nt lds
s_add_u32 s12, s12, 4096
s_mov_b32 m0, s12
s_waitcnt vmcnt(2)
buffer_load_dwordx4 v2, s[60:63], s12 offen offset:0 nt lds
s_waitcnt vmcnt(2)
buffer_load_dwordx4 v2, s[60:63], s12 offen offset:1024 nt lds
s_waitcnt vmcnt(2)
buffer_load_dwordx4 v2, s[60:63], s12 offen offset:2048 nt lds
s_waitcnt vmcnt(2)
buffer_load_dwordx4 v2, s[60:63], s12 offen offset:3072 nt lds
s_add_u32 s12, s12, 4096
s_mov_b32 m0, s12
s_waitcnt vmcnt(2)
buffer_load_dwordx4 v2, s[60:63], s12 offen offset:0 nt lds
s_waitcnt vmcnt(2)
buffer_load_dwordx4 v2, s[60:63], s12 offen offset:1024 nt lds
s_waitcnt vmcnt(2)
buffer_load_dwordx4 v2, s[60:63], s12 offen offset:2048 nt lds
s_waitcnt vmcnt(2)
buffer_load_dwordx4 v2, s[60:63], s12 offen offset:3072 nt lds
s_add_u32 s12, s12, 4096
s_mov_b32 m0, s12
s_waitcnt vmcnt(2)
buffer_load_dwordx4 v2, s[60:63], s12 offen offset:0 nt lds
s_waitcnt vmcnt(2)
buffer_load_dwordx4 v2, s[60:63], s12 offen offset:1024 nt lds
s_waitcnt vmcnt(2)
buffer_load_dwordx4 v2, s[60:63], s12 offen offset:2048 nt lds
s_waitcnt vmcnt(2)
buffer_load_dwordx4 v2, s[60:63], s12 offen offset:3072 nt lds
s_add_u32 s12, s12, 4096
s_mov_b32 m0, s12
s_waitcnt vmcnt(2)
buffer_load_dwordx4 v2, s[60:63], s12 offen offset:0 nt lds
s_waitcnt vmcnt(2)
buffer_load_dwordx4 v2, s[60:63], s12 offen offset:1024 nt lds
s_waitcnt vmcnt(2)
buffer_load_dwordx4 v2, s[60:63], s12 offen offset:2048 nt lds
s_waitcnt vmcnt(2)
buffer_load_dwordx4 v2, s[60:63], s12 offen offset:3072 nt lds
s_add_u32 s12, s12, 4096
s_mov_b32 m0, s12
s_waitcnt vmcnt(2)
buffer_load_dwordx4 v2, s[60:63], s12 offen offset:0 nt lds
s_waitcnt vmcnt(2)
buffer_load_dwordx4 v2, s[60:63], s12 offen offset:1024 nt lds
s_waitcnt vmcnt(2)
buffer_load_dwordx4 v2, s[60:63], s12 offen offset:2048 nt lds
s_waitcnt vmcnt(2)
buffer_load_dwordx4 v2, s[60:63], s12 offen offset:3072 nt lds
s_add_u32 s12, s12, 4096
s_mov_b32 m0, s12
s_waitcnt vmcnt(2)
buffer_load_dwordx4 v2, s[60:63], s12 offen offset:0 nt lds
s_waitcnt vmcnt(2)
buffer_load_dwordx4 v2, s[60:63], s12 offen offset:1024 nt lds
s_waitcnt vmcnt(2)
buffer_load_dwordx4 v2, s[60:63], s12 offen offset:2048 nt lds
s_waitcnt vmcnt(2)
buffer_load_dwordx4 v2, s[60:63], s12 offen offset:3072 nt lds
s_add_u32 s12, s12, 4096
s_mov_b32 m0, s12
s_waitcnt vmcnt(2)
buffer_load_dwordx4 v2, s[60:63], s12 offen offset:0 nt lds
s_waitcnt vmcnt(2)
buffer_load_dwordx4 v2, s[60:63], s12 offen offset:1024 nt lds
s_waitcnt vmcnt(2)
buffer_load_dwordx4 v2, s[60:63], s12 offen offset:2048 nt lds
s_waitcnt vmcnt(2)
buffer_load_dwordx4 v2, s[60:63], s12 offen offset:3072 nt lds
v_lshlrev_b32 v238, 18, v9
v_lshl_add_u32 v238, v8, 4, v238
s_mov_b32 s6, 0
s_waitcnt vmcnt(2)
buffer_load_dwordx4 v[88:91], v238, s[52:55], s6 offen nt
s_mov_b32 s6, 8192
s_waitcnt vmcnt(2)
buffer_load_dwordx4 v[92:95], v238, s[52:55], s6 offen nt
s_mov_b32 s6, 16384
s_waitcnt vmcnt(2)
buffer_load_dwordx4 v[96:99], v238, s[52:55], s6 offen nt
s_mov_b32 s6, 24576
s_waitcnt vmcnt(2)
buffer_load_dwordx4 v[100:103], v238, s[52:55], s6 offen nt
s_mov_b32 s6, 32768
s_waitcnt vmcnt(2)
buffer_load_dwordx4 v[104:107], v238, s[52:55], s6 offen nt
s_mov_b32 s6, 40960
s_waitcnt vmcnt(2)
buffer_load_dwordx4 v[108:111], v238, s[52:55], s6 offen nt
s_mov_b32 s6, 49152
s_waitcnt vmcnt(2)
buffer_load_dwordx4 v[112:115], v238, s[52:55], s6 offen nt
s_mov_b32 s6, 57344
s_waitcnt vmcnt(2)
buffer_load_dwordx4 v[116:119], v238, s[52:55], s6 offen nt
s_mov_b32 s6, 65536
s_waitcnt vmcnt(2)
buffer_load_dwordx4 v[120:123], v238, s[52:55], s6 offen nt
s_mov_b32 s6, 73728
s_waitcnt vmcnt(2)
buffer_load_dwordx4 v[124:127], v238, s[52:55], s6 offen nt
s_mov_b32 s6, 81920
s_waitcnt vmcnt(2)
buffer_load_dwordx4 v[128:131], v238, s[52:55], s6 offen nt
s_mov_b32 s6, 90112
s_waitcnt vmcnt(2)
buffer_load_dwordx4 v[132:135], v238, s[52:55], s6 offen nt
s_mov_b32 s6, 98304
s_waitcnt vmcnt(2)
buffer_load_dwordx4 v[136:139], v238, s[52:55], s6 offen nt
s_mov_b32 s6, 106496
s_waitcnt vmcnt(2)
buffer_load_dwordx4 v[140:143], v238, s[52:55], s6 offen nt
s_mov_b32 s6, 114688
s_waitcnt vmcnt(2)
buffer_load_dwordx4 v[144:147], v238, s[52:55], s6 offen nt
s_mov_b32 s6, 122880
s_waitcnt vmcnt(2)
buffer_load_dwordx4 v[148:151], v238, s[52:55], s6 offen nt
s_mov_b32 s6, 131072
s_waitcnt vmcnt(2)
buffer_load_dwordx4 v[152:155], v238, s[52:55], s6 offen nt
s_mov_b32 s6, 139264
s_waitcnt vmcnt(2)
buffer_load_dwordx4 v[156:159], v238, s[52:55], s6 offen nt
s_mov_b32 s6, 147456
s_waitcnt vmcnt(2)
buffer_load_dwordx4 v[160:163], v238, s[52:55], s6 offen nt
s_mov_b32 s6, 155648
s_waitcnt vmcnt(2)
buffer_load_dwordx4 v[164:167], v238, s[52:55], s6 offen nt
s_mov_b32 s6, 163840
s_waitcnt vmcnt(2)
buffer_load_dwordx4 v[168:171], v238, s[52:55], s6 offen nt
s_mov_b32 s6, 172032
s_waitcnt vmcnt(2)
buffer_load_dwordx4 v[172:175], v238, s[52:55], s6 offen nt
s_mov_b32 s6, 180224
s_waitcnt vmcnt(2)
buffer_load_dwordx4 v[176:179], v238, s[52:55], s6 offen nt
s_mov_b32 s6, 188416
s_waitcnt vmcnt(2)
buffer_load_dwordx4 v[180:183], v238, s[52:55], s6 offen nt
s_mov_b32 s6, 196608
s_waitcnt vmcnt(2)
buffer_load_dwordx4 v[184:187], v238, s[52:55], s6 offen nt
s_mov_b32 s6, 204800
s_waitcnt vmcnt(2)
buffer_load_dwordx4 v[188:191], v238, s[52:55], s6 offen nt
s_mov_b32 s6, 212992
s_waitcnt vmcnt(2)
buffer_load_dwordx4 v[192:195], v238, s[52:55], s6 offen nt
s_mov_b32 s6, 221184
s_waitcnt vmcnt(2)
buffer_load_dwordx4 v[196:199], v238, s[52:55], s6 offen nt
s_mov_b32 s6, 229376
s_waitcnt vmcnt(2)
buffer_load_dwordx4 v[200:203], v238, s[52:55], s6 offen nt
s_mov_b32 s6, 237568
s_waitcnt vmcnt(2)
buffer_load_dwordx4 v[204:207], v238, s[52:55], s6 offen nt
s_mov_b32 s6, 245760
s_waitcnt vmcnt(2)
buffer_load_dwordx4 v[208:211], v238, s[52:55], s6 offen nt
s_mov_b32 s6, 253952
s_waitcnt vmcnt(2)
buffer_load_dwordx4 v[212:215], v238, s[52:55], s6 offen nt
v_mov_b32 v11, 163824
v_mov_b32 v7, 0
ds_write_b32 v11, v7
s_waitcnt lgkmcnt(0)
s_barrier
ds_read_b64_tr_b16 a[96:97], v240 offset:0
ds_read_b64_tr_b16 a[98:99], v240 offset:4608
ds_read_b64_tr_b16 a[100:101], v240 offset:36864
ds_read_b64_tr_b16 a[102:103], v240 offset:41472
ds_read_b64_tr_b16 a[104:105], v242 offset:0
ds_read_b64_tr_b16 a[106:107], v242 offset:4608
ds_read_b64_tr_b16 a[108:109], v242 offset:36864
ds_read_b64_tr_b16 a[110:111], v242 offset:41472
ds_read_b64_tr_b16 a[112:113], v240 offset:8
ds_read_b64_tr_b16 a[114:115], v240 offset:4616
ds_read_b64_tr_b16 a[116:117], v240 offset:36872
ds_read_b64_tr_b16 a[118:119], v240 offset:41480
ds_read_b64_tr_b16 a[120:121], v242 offset:8
ds_read_b64_tr_b16 a[122:123], v242 offset:4616
ds_read_b64_tr_b16 a[124:125], v242 offset:36872
ds_read_b64_tr_b16 a[126:127], v242 offset:41480
ds_read_b64_tr_b16 a[128:129], v240 offset:16
ds_read_b64_tr_b16 a[130:131], v240 offset:4624
ds_read_b64_tr_b16 a[132:133], v240 offset:36880
ds_read_b64_tr_b16 a[134:135], v240 offset:41488
ds_read_b64_tr_b16 a[136:137], v242 offset:16
ds_read_b64_tr_b16 a[138:139], v242 offset:4624
ds_read_b64_tr_b16 a[140:141], v242 offset:36880
ds_read_b64_tr_b16 a[142:143], v242 offset:41488
ds_read_b64_tr_b16 a[144:145], v240 offset:24
ds_read_b64_tr_b16 a[146:147], v240 offset:4632
ds_read_b64_tr_b16 a[148:149], v240 offset:36888
ds_read_b64_tr_b16 a[150:151], v240 offset:41496
ds_read_b64_tr_b16 a[152:153], v242 offset:24
ds_read_b64_tr_b16 a[154:155], v242 offset:4632
ds_read_b64_tr_b16 a[156:157], v242 offset:36888
ds_read_b64_tr_b16 a[158:159], v242 offset:41496
ds_read_b64_tr_b16 a[160:161], v240 offset:128
ds_read_b64_tr_b16 a[162:163], v240 offset:4736
ds_read_b64_tr_b16 a[164:165], v240 offset:36992
ds_read_b64_tr_b16 a[166:167], v240 offset:41600
ds_read_b64_tr_b16 a[168:169], v242 offset:128
ds_read_b64_tr_b16 a[170:171], v242 offset:4736
ds_read_b64_tr_b16 a[172:173], v242 offset:36992
ds_read_b64_tr_b16 a[174:175], v242 offset:41600
ds_read_b64_tr_b16 a[176:177], v240 offset:136
ds_read_b64_tr_b16 a[178:179], v240 offset:4744
ds_read_b64_tr_b16 a[180:181], v240 offset:37000
ds_read_b64_tr_b16 a[182:183], v240 offset:41608
ds_read_b64_tr_b16 a[184:185], v242 offset:136
ds_read_b64_tr_b16 a[186:187], v242 offset:4744
ds_read_b64_tr_b16 a[188:189], v242 offset:37000
ds_read_b64_tr_b16 a[190:191], v242 offset:41608
ds_read_b64_tr_b16 a[192:193], v240 offset:144
ds_read_b64_tr_b16 a[194:195], v240 offset:4752
ds_read_b64_tr_b16 a[196:197], v240 offset:37008
ds_read_b64_tr_b16 a[198:199], v240 offset:41616
ds_read_b64_tr_b16 a[200:201], v242 offset:144
ds_read_b64_tr_b16 a[202:203], v242 offset:4752
ds_read_b64_tr_b16 a[204:205], v242 offset:37008
ds_read_b64_tr_b16 a[206:207], v242 offset:41616
ds_read_b64_tr_b16 a[208:209], v240 offset:152
ds_read_b64_tr_b16 a[210:211], v240 offset:4760
ds_read_b64_tr_b16 a[212:213], v240 offset:37016
ds_read_b64_tr_b16 a[214:215], v240 offset:41624
ds_read_b64_tr_b16 a[216:217], v242 offset:152
ds_read_b64_tr_b16 a[218:219], v242 offset:4760
ds_read_b64_tr_b16 a[220:221], v242 offset:37016
ds_read_b64_tr_b16 a[222:223], v242 offset:41624
ds_read_b64_tr_b16 a[224:225], v241 offset:0
ds_read_b64_tr_b16 a[226:227], v241 offset:4608
ds_read_b64_tr_b16 a[228:229], v241 offset:36864
ds_read_b64_tr_b16 a[230:231], v241 offset:41472
ds_read_b64_tr_b16 a[232:233], v243 offset:0
ds_read_b64_tr_b16 a[234:235], v243 offset:4608
ds_read_b64_tr_b16 a[236:237], v243 offset:36864
ds_read_b64_tr_b16 a[238:239], v243 offset:41472
v_and_b32 v6, 7, v1
v_mul_u32_u24 v6, 8, v6
s_lshl_b32 s6, s4, 8
s_mul_i32 s7, s3, 64
s_add_u32 s6, s6, s7
s_add_u32 s15, s6, 262144
s_mov_b32 s7, 400000
P_poll:
buffer_load_dwordx2 v[232:233], v6, s[64:67], s15 offen sc1
s_waitcnt vmcnt(0)
v_max_u32 v234, v232, v233
v_cmp_eq_u32 vcc, -1, v234
s_cbranch_vccz P_ok
s_sleep 16
s_sub_u32 s7, s7, 1
s_cmp_lg_u32 s7, 0
s_cbranch_scc1 P_poll
P_ok:
s_lshr_b32 s6, s4, 3
s_mul_i32 s6, s6, 524288
s_bitcmp1_b32 s4, 0
s_cselect_b32 s7, 98304, 0
s_add_u32 s6, s6, s7
s_bitcmp1_b32 s4, 1
s_cselect_b32 s7, 131072, 0
s_add_u32 s6, s6, s7
s_bitcmp1_b32 s4, 2
s_cselect_b32 s7, 262144, 0
s_add_u32 s6, s6, s7
s_lshl_b32 s7, s3, 13
s_add_u32 s6, s6, s7
s_add_u32 s6, s6, 2097152
buffer_load_dwordx4 v[24:27], v2, s[64:67], s6 offen offset:0 sc1
buffer_load_dwordx4 v[28:31], v2, s[64:67], s6 offen offset:1024 sc1
buffer_load_dwordx4 v[32:35], v2, s[64:67], s6 offen offset:2048 sc1
buffer_load_dwordx4 v[36:39], v2, s[64:67], s6 offen offset:3072 sc1
s_add_u32 s6, s6, 4096
buffer_load_dwordx4 v[40:43], v2, s[64:67], s6 offen offset:0 sc1
buffer_load_dwordx4 v[44:47], v2, s[64:67], s6 offen offset:1024 sc1
buffer_load_dwordx4 v[48:51], v2, s[64:67], s6 offen offset:2048 sc1
buffer_load_dwordx4 v[52:55], v2, s[64:67], s6 offen offset:3072 sc1
v_mov_b32 v234, v232
s_nop 1
v_max_f32_dpp v234, v234, v234 row_ror:4 row_mask:0xf bank_mask:0xf
s_nop 1
v_max_f32_dpp v234, v234, v234 row_ror:2 row_mask:0xf bank_mask:0xf
s_nop 1
v_max_f32_dpp v234, v234, v234 row_ror:1 row_mask:0xf bank_mask:0xf
v_sub_f32 v232, v232, v234
v_exp_f32 v232, v232
s_nop 0
v_mul_f32 v235, v232, v233
s_nop 1
v_add_f32_dpp v235, v235, v235 row_ror:4 row_mask:0xf bank_mask:0xf
s_nop 1
v_add_f32_dpp v235, v235, v235 row_ror:2 row_mask:0xf bank_mask:0xf
s_nop 1
v_add_f32_dpp v235, v235, v235 row_ror:1 row_mask:0xf bank_mask:0xf
v_rcp_f32 v235, v235
s_nop 0
v_mul_f32 v232, v232, v235
s_nop 0
v_readlane_b32 s26, v232, 0
v_readlane_b32 s27, v232, 1
v_readlane_b32 s28, v232, 2
v_readlane_b32 s29, v232, 3
v_readlane_b32 s30, v232, 4
v_readlane_b32 s31, v232, 5
v_readlane_b32 s32, v232, 6
v_readlane_b32 s33, v232, 7
s_mul_i32 s6, s3, 1040
s_add_u32 s6, s6, 147456
v_add_u32 v5, s6, v2
v_lshrrev_b32 v6, 3, v8
v_mul_u32_u24 v6, 1040, v6
v_lshl_add_u32 v6, v9, 6, v6
s_lshl_b32 s6, s3, 8
s_add_u32 s6, s6, 147456
v_add_u32 v6, s6, v6
s_waitcnt vmcnt(7)
v_lshlrev_b32 v244, 16, v24
v_and_b32 v245, 0xffff0000, v24
v_lshlrev_b32 v246, 16, v25
v_and_b32 v247, 0xffff0000, v25
v_lshlrev_b32 v248, 16, v26
v_and_b32 v249, 0xffff0000, v26
v_lshlrev_b32 v250, 16, v27
v_and_b32 v251, 0xffff0000, v27
v_mul_f32 v216, s26, v244
v_mul_f32 v217, s26, v245
v_mul_f32 v218, s26, v246
v_mul_f32 v219, s26, v247
v_mul_f32 v220, s26, v248
v_mul_f32 v221, s26, v249
v_mul_f32 v222, s26, v250
v_mul_f32 v223, s26, v251
s_waitcnt vmcnt(6)
v_lshlrev_b32 v244, 16, v28
v_and_b32 v245, 0xffff0000, v28
v_lshlrev_b32 v246, 16, v29
v_and_b32 v247, 0xffff0000, v29
v_lshlrev_b32 v248, 16, v30
v_and_b32 v249, 0xffff0000, v30
v_lshlrev_b32 v250, 16, v31
v_and_b32 v251, 0xffff0000, v31
v_fma_f32 v216, v244, s27, v216
v_fma_f32 v217, v245, s27, v217
v_fma_f32 v218, v246, s27, v218
v_fma_f32 v219, v247, s27, v219
v_fma_f32 v220, v248, s27, v220
v_fma_f32 v221, v249, s27, v221
v_fma_f32 v222, v250, s27, v222
v_fma_f32 v223, v251, s27, v223
s_waitcnt vmcnt(5)
v_lshlrev_b32 v244, 16, v32
v_and_b32 v245, 0xffff0000, v32
v_lshlrev_b32 v246, 16, v33
v_and_b32 v247, 0xffff0000, v33
v_lshlrev_b32 v248, 16, v34
v_and_b32 v249, 0xffff0000, v34
v_lshlrev_b32 v250, 16, v35
v_and_b32 v251, 0xffff0000, v35
v_fma_f32 v216, v244, s28, v216
v_fma_f32 v217, v245, s28, v217
v_fma_f32 v218, v246, s28, v218
v_fma_f32 v219, v247, s28, v219
v_fma_f32 v220, v248, s28, v220
v_fma_f32 v221, v249, s28, v221
v_fma_f32 v222, v250, s28, v222
v_fma_f32 v223, v251, s28, v223
s_waitcnt vmcnt(4)
v_lshlrev_b32 v244, 16, v36
v_and_b32 v245, 0xffff0000, v36
v_lshlrev_b32 v246, 16, v37
v_and_b32 v247, 0xffff0000, v37
v_lshlrev_b32 v248, 16, v38
v_and_b32 v249, 0xffff0000, v38
v_lshlrev_b32 v250, 16, v39
v_and_b32 v251, 0xffff0000, v39
v_fma_f32 v216, v244, s29, v216
v_fma_f32 v217, v245, s29, v217
v_fma_f32 v218, v246, s29, v218
v_fma_f32 v219, v247, s29, v219
v_fma_f32 v220, v248, s29, v220
v_fma_f32 v221, v249, s29, v221
v_fma_f32 v222, v250, s29, v222
v_fma_f32 v223, v251, s29, v223
s_waitcnt vmcnt(3)
v_lshlrev_b32 v244, 16, v40
v_and_b32 v245, 0xffff0000, v40
v_lshlrev_b32 v246, 16, v41
v_and_b32 v247, 0xffff0000, v41
v_lshlrev_b32 v248, 16, v42
v_and_b32 v249, 0xffff0000, v42
v_lshlrev_b32 v250, 16, v43
v_and_b32 v251, 0xffff0000, v43
v_fma_f32 v216, v244, s30, v216
v_fma_f32 v217, v245, s30, v217
v_fma_f32 v218, v246, s30, v218
v_fma_f32 v219, v247, s30, v219
v_fma_f32 v220, v248, s30, v220
v_fma_f32 v221, v249, s30, v221
v_fma_f32 v222, v250, s30, v222
v_fma_f32 v223, v251, s30, v223
s_waitcnt vmcnt(2)
v_lshlrev_b32 v244, 16, v44
v_and_b32 v245, 0xffff0000, v44
v_lshlrev_b32 v246, 16, v45
v_and_b32 v247, 0xffff0000, v45
v_lshlrev_b32 v248, 16, v46
v_and_b32 v249, 0xffff0000, v46
v_lshlrev_b32 v250, 16, v47
v_and_b32 v251, 0xffff0000, v47
v_fma_f32 v216, v244, s31, v216
v_fma_f32 v217, v245, s31, v217
v_fma_f32 v218, v246, s31, v218
v_fma_f32 v219, v247, s31, v219
v_fma_f32 v220, v248, s31, v220
v_fma_f32 v221, v249, s31, v221
v_fma_f32 v222, v250, s31, v222
v_fma_f32 v223, v251, s31, v223
s_waitcnt vmcnt(1)
v_lshlrev_b32 v244, 16, v48
v_and_b32 v245, 0xffff0000, v48
v_lshlrev_b32 v246, 16, v49
v_and_b32 v247, 0xffff0000, v49
v_lshlrev_b32 v248, 16, v50
v_and_b32 v249, 0xffff0000, v50
v_lshlrev_b32 v250, 16, v51
v_and_b32 v251, 0xffff0000, v51
v_fma_f32 v216, v244, s32, v216
v_fma_f32 v217, v245, s32, v217
v_fma_f32 v218, v246, s32, v218
v_fma_f32 v219, v247, s32, v219
v_fma_f32 v220, v248, s32, v220
v_fma_f32 v221, v249, s32, v221
v_fma_f32 v222, v250, s32, v222
v_fma_f32 v223, v251, s32, v223
s_waitcnt vmcnt(0)
v_lshlrev_b32 v244, 16, v52
v_and_b32 v245, 0xffff0000, v52
v_lshlrev_b32 v246, 16, v53
v_and_b32 v247, 0xffff0000, v53
v_lshlrev_b32 v248, 16, v54
v_and_b32 v249, 0xffff0000, v54
v_lshlrev_b32 v250, 16, v55
v_and_b32 v251, 0xffff0000, v55
v_fma_f32 v216, v244, s33, v216
v_fma_f32 v217, v245, s33, v217
v_fma_f32 v218, v246, s33, v218
v_fma_f32 v219, v247, s33, v219
v_fma_f32 v220, v248, s33, v220
v_fma_f32 v221, v249, s33, v221
v_fma_f32 v222, v250, s33, v222
v_fma_f32 v223, v251, s33, v223
v_cvt_pk_bf16_f32 v224, v216, v217
v_cvt_pk_bf16_f32 v225, v218, v219
v_cvt_pk_bf16_f32 v226, v220, v221
v_cvt_pk_bf16_f32 v227, v222, v223
ds_write_b128 v5, v[224:227]
s_waitcnt lgkmcnt(0)
s_barrier
ds_read_b128 v[24:27], v6 offset:0
ds_read_b128 v[44:47], v6 offset:2080
ds_read_b128 v[28:31], v6 offset:16
ds_read_b128 v[48:51], v6 offset:2096
ds_read_b128 v[32:35], v6 offset:32
ds_read_b128 v[52:55], v6 offset:2112
ds_read_b128 v[36:39], v6 offset:48
ds_read_b128 v[56:59], v6 offset:2128
v_lshrrev_b32 v5, 5, v1
v_mul_u32_u24 v5, 1088, v5
v_lshl_add_u32 v5, v8, 4, v5
v_and_b32 v7, 1, v9
v_lshl_add_u32 v5, v7, 3, v5
s_mul_i32 s6, s3, 272
s_add_u32 s6, s6, 155648
v_add_u32 v5, s6, v5
v_mul_u32_u24 v7, 272, v8
v_lshl_add_u32 v7, v9, 4, v7
v_add_u32 v7, 155648, v7
s_waitcnt lgkmcnt(0)
v_perm_b32 v64, v24, v24, v16
v_perm_b32 v65, v24, v24, v17
v_perm_b32 v66, v24, v24, v18
v_perm_b32 v67, v24, v24, v19
s_nop 1
v_mfma_f32_16x16x32_bf16 v[80:83], v[64:67], v[88:91], 0
v_perm_b32 v68, v44, v44, v16
v_perm_b32 v69, v44, v44, v17
v_perm_b32 v70, v44, v44, v18
v_perm_b32 v71, v44, v44, v19
s_nop 1
v_mfma_f32_16x16x32_bf16 v[84:87], v[68:71], v[88:91], 0
v_perm_b32 v72, v24, v24, v20
v_perm_b32 v73, v24, v24, v21
v_perm_b32 v74, v24, v24, v22
v_perm_b32 v75, v24, v24, v23
s_nop 1
v_mfma_f32_16x16x32_bf16 v[80:83], v[72:75], v[92:95], v[80:83]
v_perm_b32 v76, v44, v44, v20
v_perm_b32 v77, v44, v44, v21
v_perm_b32 v78, v44, v44, v22
v_perm_b32 v79, v44, v44, v23
s_nop 1
v_mfma_f32_16x16x32_bf16 v[84:87], v[76:79], v[92:95], v[84:87]
v_perm_b32 v64, v25, v25, v16
v_perm_b32 v65, v25, v25, v17
v_perm_b32 v66, v25, v25, v18
v_perm_b32 v67, v25, v25, v19
s_nop 1
v_mfma_f32_16x16x32_bf16 v[80:83], v[64:67], v[96:99], v[80:83]
v_perm_b32 v68, v45, v45, v16
v_perm_b32 v69, v45, v45, v17
v_perm_b32 v70, v45, v45, v18
v_perm_b32 v71, v45, v45, v19
s_nop 1
v_mfma_f32_16x16x32_bf16 v[84:87], v[68:71], v[96:99], v[84:87]
v_perm_b32 v72, v25, v25, v20
v_perm_b32 v73, v25, v25, v21
v_perm_b32 v74, v25, v25, v22
v_perm_b32 v75, v25, v25, v23
s_nop 1
v_mfma_f32_16x16x32_bf16 v[80:83], v[72:75], v[100:103], v[80:83]
v_perm_b32 v76, v45, v45, v20
v_perm_b32 v77, v45, v45, v21
v_perm_b32 v78, v45, v45, v22
v_perm_b32 v79, v45, v45, v23
s_nop 1
v_mfma_f32_16x16x32_bf16 v[84:87], v[76:79], v[100:103], v[84:87]
v_perm_b32 v64, v26, v26, v16
v_perm_b32 v65, v26, v26, v17
v_perm_b32 v66, v26, v26, v18
v_perm_b32 v67, v26, v26, v19
s_nop 1
v_mfma_f32_16x16x32_bf16 v[80:83], v[64:67], v[104:107], v[80:83]
v_perm_b32 v68, v46, v46, v16
v_perm_b32 v69, v46, v46, v17
v_perm_b32 v70, v46, v46, v18
v_perm_b32 v71, v46, v46, v19
s_nop 1
v_mfma_f32_16x16x32_bf16 v[84:87], v[68:71], v[104:107], v[84:87]
v_perm_b32 v72, v26, v26, v20
v_perm_b32 v73, v26, v26, v21
v_perm_b32 v74, v26, v26, v22
v_perm_b32 v75, v26, v26, v23
s_nop 1
v_mfma_f32_16x16x32_bf16 v[80:83], v[72:75], v[108:111], v[80:83]
v_perm_b32 v76, v46, v46, v20
v_perm_b32 v77, v46, v46, v21
v_perm_b32 v78, v46, v46, v22
v_perm_b32 v79, v46, v46, v23
s_nop 1
v_mfma_f32_16x16x32_bf16 v[84:87], v[76:79], v[108:111], v[84:87]
v_perm_b32 v64, v27, v27, v16
v_perm_b32 v65, v27, v27, v17
v_perm_b32 v66, v27, v27, v18
v_perm_b32 v67, v27, v27, v19
s_nop 1
v_mfma_f32_16x16x32_bf16 v[80:83], v[64:67], v[112:115], v[80:83]
v_perm_b32 v68, v47, v47, v16
v_perm_b32 v69, v47, v47, v17
v_perm_b32 v70, v47, v47, v18
v_perm_b32 v71, v47, v47, v19
s_nop 1
v_mfma_f32_16x16x32_bf16 v[84:87], v[68:71], v[112:115], v[84:87]
v_perm_b32 v72, v27, v27, v20
v_perm_b32 v73, v27, v27, v21
v_perm_b32 v74, v27, v27, v22
v_perm_b32 v75, v27, v27, v23
s_nop 1
v_mfma_f32_16x16x32_bf16 v[80:83], v[72:75], v[116:119], v[80:83]
v_perm_b32 v76, v47, v47, v20
v_perm_b32 v77, v47, v47, v21
v_perm_b32 v78, v47, v47, v22
v_perm_b32 v79, v47, v47, v23
s_nop 1
v_mfma_f32_16x16x32_bf16 v[84:87], v[76:79], v[116:119], v[84:87]
v_perm_b32 v64, v28, v28, v16
v_perm_b32 v65, v28, v28, v17
v_perm_b32 v66, v28, v28, v18
v_perm_b32 v67, v28, v28, v19
s_nop 1
v_mfma_f32_16x16x32_bf16 v[80:83], v[64:67], v[120:123], v[80:83]
v_perm_b32 v68, v48, v48, v16
v_perm_b32 v69, v48, v48, v17
v_perm_b32 v70, v48, v48, v18
v_perm_b32 v71, v48, v48, v19
s_nop 1
v_mfma_f32_16x16x32_bf16 v[84:87], v[68:71], v[120:123], v[84:87]
v_perm_b32 v72, v28, v28, v20
v_perm_b32 v73, v28, v28, v21
v_perm_b32 v74, v28, v28, v22
v_perm_b32 v75, v28, v28, v23
s_nop 1
v_mfma_f32_16x16x32_bf16 v[80:83], v[72:75], v[124:127], v[80:83]
v_perm_b32 v76, v48, v48, v20
v_perm_b32 v77, v48, v48, v21
v_perm_b32 v78, v48, v48, v22
v_perm_b32 v79, v48, v48, v23
s_nop 1
v_mfma_f32_16x16x32_bf16 v[84:87], v[76:79], v[124:127], v[84:87]
v_perm_b32 v64, v29, v29, v16
v_perm_b32 v65, v29, v29, v17
v_perm_b32 v66, v29, v29, v18
v_perm_b32 v67, v29, v29, v19
s_nop 1
v_mfma_f32_16x16x32_bf16 v[80:83], v[64:67], v[128:131], v[80:83]
v_perm_b32 v68, v49, v49, v16
v_perm_b32 v69, v49, v49, v17
v_perm_b32 v70, v49, v49, v18
v_perm_b32 v71, v49, v49, v19
s_nop 1
v_mfma_f32_16x16x32_bf16 v[84:87], v[68:71], v[128:131], v[84:87]
v_perm_b32 v72, v29, v29, v20
v_perm_b32 v73, v29, v29, v21
v_perm_b32 v74, v29, v29, v22
v_perm_b32 v75, v29, v29, v23
s_nop 1
v_mfma_f32_16x16x32_bf16 v[80:83], v[72:75], v[132:135], v[80:83]
v_perm_b32 v76, v49, v49, v20
v_perm_b32 v77, v49, v49, v21
v_perm_b32 v78, v49, v49, v22
v_perm_b32 v79, v49, v49, v23
s_nop 1
v_mfma_f32_16x16x32_bf16 v[84:87], v[76:79], v[132:135], v[84:87]
v_perm_b32 v64, v30, v30, v16
v_perm_b32 v65, v30, v30, v17
v_perm_b32 v66, v30, v30, v18
v_perm_b32 v67, v30, v30, v19
s_nop 1
v_mfma_f32_16x16x32_bf16 v[80:83], v[64:67], v[136:139], v[80:83]
v_perm_b32 v68, v50, v50, v16
v_perm_b32 v69, v50, v50, v17
v_perm_b32 v70, v50, v50, v18
v_perm_b32 v71, v50, v50, v19
s_nop 1
v_mfma_f32_16x16x32_bf16 v[84:87], v[68:71], v[136:139], v[84:87]
v_perm_b32 v72, v30, v30, v20
v_perm_b32 v73, v30, v30, v21
v_perm_b32 v74, v30, v30, v22
v_perm_b32 v75, v30, v30, v23
s_nop 1
v_mfma_f32_16x16x32_bf16 v[80:83], v[72:75], v[140:143], v[80:83]
v_perm_b32 v76, v50, v50, v20
v_perm_b32 v77, v50, v50, v21
v_perm_b32 v78, v50, v50, v22
v_perm_b32 v79, v50, v50, v23
s_nop 1
v_mfma_f32_16x16x32_bf16 v[84:87], v[76:79], v[140:143], v[84:87]
v_perm_b32 v64, v31, v31, v16
v_perm_b32 v65, v31, v31, v17
v_perm_b32 v66, v31, v31, v18
v_perm_b32 v67, v31, v31, v19
s_nop 1
v_mfma_f32_16x16x32_bf16 v[80:83], v[64:67], v[144:147], v[80:83]
v_perm_b32 v68, v51, v51, v16
v_perm_b32 v69, v51, v51, v17
v_perm_b32 v70, v51, v51, v18
v_perm_b32 v71, v51, v51, v19
s_nop 1
v_mfma_f32_16x16x32_bf16 v[84:87], v[68:71], v[144:147], v[84:87]
v_perm_b32 v72, v31, v31, v20
v_perm_b32 v73, v31, v31, v21
v_perm_b32 v74, v31, v31, v22
v_perm_b32 v75, v31, v31, v23
s_nop 1
v_mfma_f32_16x16x32_bf16 v[80:83], v[72:75], v[148:151], v[80:83]
v_perm_b32 v76, v51, v51, v20
v_perm_b32 v77, v51, v51, v21
v_perm_b32 v78, v51, v51, v22
v_perm_b32 v79, v51, v51, v23
s_nop 1
v_mfma_f32_16x16x32_bf16 v[84:87], v[76:79], v[148:151], v[84:87]
v_perm_b32 v64, v32, v32, v16
v_perm_b32 v65, v32, v32, v17
v_perm_b32 v66, v32, v32, v18
v_perm_b32 v67, v32, v32, v19
s_nop 1
v_mfma_f32_16x16x32_bf16 v[80:83], v[64:67], v[152:155], v[80:83]
v_perm_b32 v68, v52, v52, v16
v_perm_b32 v69, v52, v52, v17
v_perm_b32 v70, v52, v52, v18
v_perm_b32 v71, v52, v52, v19
s_nop 1
v_mfma_f32_16x16x32_bf16 v[84:87], v[68:71], v[152:155], v[84:87]
v_perm_b32 v72, v32, v32, v20
v_perm_b32 v73, v32, v32, v21
v_perm_b32 v74, v32, v32, v22
v_perm_b32 v75, v32, v32, v23
s_nop 1
v_mfma_f32_16x16x32_bf16 v[80:83], v[72:75], v[156:159], v[80:83]
v_perm_b32 v76, v52, v52, v20
v_perm_b32 v77, v52, v52, v21
v_perm_b32 v78, v52, v52, v22
v_perm_b32 v79, v52, v52, v23
s_nop 1
v_mfma_f32_16x16x32_bf16 v[84:87], v[76:79], v[156:159], v[84:87]
v_perm_b32 v64, v33, v33, v16
v_perm_b32 v65, v33, v33, v17
v_perm_b32 v66, v33, v33, v18
v_perm_b32 v67, v33, v33, v19
s_nop 1
v_mfma_f32_16x16x32_bf16 v[80:83], v[64:67], v[160:163], v[80:83]
v_perm_b32 v68, v53, v53, v16
v_perm_b32 v69, v53, v53, v17
v_perm_b32 v70, v53, v53, v18
v_perm_b32 v71, v53, v53, v19
s_nop 1
v_mfma_f32_16x16x32_bf16 v[84:87], v[68:71], v[160:163], v[84:87]
v_perm_b32 v72, v33, v33, v20
v_perm_b32 v73, v33, v33, v21
v_perm_b32 v74, v33, v33, v22
v_perm_b32 v75, v33, v33, v23
s_nop 1
v_mfma_f32_16x16x32_bf16 v[80:83], v[72:75], v[164:167], v[80:83]
v_perm_b32 v76, v53, v53, v20
v_perm_b32 v77, v53, v53, v21
v_perm_b32 v78, v53, v53, v22
v_perm_b32 v79, v53, v53, v23
s_nop 1
v_mfma_f32_16x16x32_bf16 v[84:87], v[76:79], v[164:167], v[84:87]
v_perm_b32 v64, v34, v34, v16
v_perm_b32 v65, v34, v34, v17
v_perm_b32 v66, v34, v34, v18
v_perm_b32 v67, v34, v34, v19
s_nop 1
v_mfma_f32_16x16x32_bf16 v[80:83], v[64:67], v[168:171], v[80:83]
v_perm_b32 v68, v54, v54, v16
v_perm_b32 v69, v54, v54, v17
v_perm_b32 v70, v54, v54, v18
v_perm_b32 v71, v54, v54, v19
s_nop 1
v_mfma_f32_16x16x32_bf16 v[84:87], v[68:71], v[168:171], v[84:87]
v_perm_b32 v72, v34, v34, v20
v_perm_b32 v73, v34, v34, v21
v_perm_b32 v74, v34, v34, v22
v_perm_b32 v75, v34, v34, v23
s_nop 1
v_mfma_f32_16x16x32_bf16 v[80:83], v[72:75], v[172:175], v[80:83]
v_perm_b32 v76, v54, v54, v20
v_perm_b32 v77, v54, v54, v21
v_perm_b32 v78, v54, v54, v22
v_perm_b32 v79, v54, v54, v23
s_nop 1
v_mfma_f32_16x16x32_bf16 v[84:87], v[76:79], v[172:175], v[84:87]
v_perm_b32 v64, v35, v35, v16
v_perm_b32 v65, v35, v35, v17
v_perm_b32 v66, v35, v35, v18
v_perm_b32 v67, v35, v35, v19
s_nop 1
v_mfma_f32_16x16x32_bf16 v[80:83], v[64:67], v[176:179], v[80:83]
v_perm_b32 v68, v55, v55, v16
v_perm_b32 v69, v55, v55, v17
v_perm_b32 v70, v55, v55, v18
v_perm_b32 v71, v55, v55, v19
s_nop 1
v_mfma_f32_16x16x32_bf16 v[84:87], v[68:71], v[176:179], v[84:87]
v_perm_b32 v72, v35, v35, v20
v_perm_b32 v73, v35, v35, v21
v_perm_b32 v74, v35, v35, v22
v_perm_b32 v75, v35, v35, v23
s_nop 1
v_mfma_f32_16x16x32_bf16 v[80:83], v[72:75], v[180:183], v[80:83]
v_perm_b32 v76, v55, v55, v20
v_perm_b32 v77, v55, v55, v21
v_perm_b32 v78, v55, v55, v22
v_perm_b32 v79, v55, v55, v23
s_nop 1
v_mfma_f32_16x16x32_bf16 v[84:87], v[76:79], v[180:183], v[84:87]
v_perm_b32 v64, v36, v36, v16
v_perm_b32 v65, v36, v36, v17
v_perm_b32 v66, v36, v36, v18
v_perm_b32 v67, v36, v36, v19
s_nop 1
v_mfma_f32_16x16x32_bf16 v[80:83], v[64:67], v[184:187], v[80:83]
v_perm_b32 v68, v56, v56, v16
v_perm_b32 v69, v56, v56, v17
v_perm_b32 v70, v56, v56, v18
v_perm_b32 v71, v56, v56, v19
s_nop 1
v_mfma_f32_16x16x32_bf16 v[84:87], v[68:71], v[184:187], v[84:87]
v_perm_b32 v72, v36, v36, v20
v_perm_b32 v73, v36, v36, v21
v_perm_b32 v74, v36, v36, v22
v_perm_b32 v75, v36, v36, v23
s_nop 1
v_mfma_f32_16x16x32_bf16 v[80:83], v[72:75], v[188:191], v[80:83]
v_perm_b32 v76, v56, v56, v20
v_perm_b32 v77, v56, v56, v21
v_perm_b32 v78, v56, v56, v22
v_perm_b32 v79, v56, v56, v23
s_nop 1
v_mfma_f32_16x16x32_bf16 v[84:87], v[76:79], v[188:191], v[84:87]
v_perm_b32 v64, v37, v37, v16
v_perm_b32 v65, v37, v37, v17
v_perm_b32 v66, v37, v37, v18
v_perm_b32 v67, v37, v37, v19
s_nop 1
v_mfma_f32_16x16x32_bf16 v[80:83], v[64:67], v[192:195], v[80:83]
v_perm_b32 v68, v57, v57, v16
v_perm_b32 v69, v57, v57, v17
v_perm_b32 v70, v57, v57, v18
v_perm_b32 v71, v57, v57, v19
s_nop 1
v_mfma_f32_16x16x32_bf16 v[84:87], v[68:71], v[192:195], v[84:87]
v_perm_b32 v72, v37, v37, v20
v_perm_b32 v73, v37, v37, v21
v_perm_b32 v74, v37, v37, v22
v_perm_b32 v75, v37, v37, v23
s_nop 1
v_mfma_f32_16x16x32_bf16 v[80:83], v[72:75], v[196:199], v[80:83]
v_perm_b32 v76, v57, v57, v20
v_perm_b32 v77, v57, v57, v21
v_perm_b32 v78, v57, v57, v22
v_perm_b32 v79, v57, v57, v23
s_nop 1
v_mfma_f32_16x16x32_bf16 v[84:87], v[76:79], v[196:199], v[84:87]
v_perm_b32 v64, v38, v38, v16
v_perm_b32 v65, v38, v38, v17
v_perm_b32 v66, v38, v38, v18
v_perm_b32 v67, v38, v38, v19
s_nop 1
v_mfma_f32_16x16x32_bf16 v[80:83], v[64:67], v[200:203], v[80:83]
v_perm_b32 v68, v58, v58, v16
v_perm_b32 v69, v58, v58, v17
v_perm_b32 v70, v58, v58, v18
v_perm_b32 v71, v58, v58, v19
s_nop 1
v_mfma_f32_16x16x32_bf16 v[84:87], v[68:71], v[200:203], v[84:87]
v_perm_b32 v72, v38, v38, v20
v_perm_b32 v73, v38, v38, v21
v_perm_b32 v74, v38, v38, v22
v_perm_b32 v75, v38, v38, v23
s_nop 1
v_mfma_f32_16x16x32_bf16 v[80:83], v[72:75], v[204:207], v[80:83]
v_perm_b32 v76, v58, v58, v20
v_perm_b32 v77, v58, v58, v21
v_perm_b32 v78, v58, v58, v22
v_perm_b32 v79, v58, v58, v23
s_nop 1
v_mfma_f32_16x16x32_bf16 v[84:87], v[76:79], v[204:207], v[84:87]
v_perm_b32 v64, v39, v39, v16
v_perm_b32 v65, v39, v39, v17
v_perm_b32 v66, v39, v39, v18
v_perm_b32 v67, v39, v39, v19
s_nop 1
v_mfma_f32_16x16x32_bf16 v[80:83], v[64:67], v[208:211], v[80:83]
v_perm_b32 v68, v59, v59, v16
v_perm_b32 v69, v59, v59, v17
v_perm_b32 v70, v59, v59, v18
v_perm_b32 v71, v59, v59, v19
s_nop 1
v_mfma_f32_16x16x32_bf16 v[84:87], v[68:71], v[208:211], v[84:87]
v_perm_b32 v72, v39, v39, v20
v_perm_b32 v73, v39, v39, v21
v_perm_b32 v74, v39, v39, v22
v_perm_b32 v75, v39, v39, v23
s_nop 1
v_mfma_f32_16x16x32_bf16 v[80:83], v[72:75], v[212:215], v[80:83]
v_perm_b32 v76, v59, v59, v20
v_perm_b32 v77, v59, v59, v21
v_perm_b32 v78, v59, v59, v22
v_perm_b32 v79, v59, v59, v23
s_nop 1
v_mfma_f32_16x16x32_bf16 v[84:87], v[76:79], v[212:215], v[84:87]
s_nop 0
v_cvt_pk_bf16_f32 v244, v80, v81
v_cvt_pk_bf16_f32 v245, v82, v83
ds_write_b64 v5, v[244:245] offset:0
s_nop 3
v_cvt_pk_bf16_f32 v246, v84, v85
v_cvt_pk_bf16_f32 v247, v86, v87
ds_write_b64 v5, v[246:247] offset:2176
s_waitcnt lgkmcnt(0)
s_barrier
ds_read_b128 v[64:67], v7 offset:0
ds_read_b128 v[68:71], v7 offset:64
ds_read_b128 v[72:75], v7 offset:128
ds_read_b128 v[76:79], v7 offset:192
v_mul_u32_u24 v5, 36864, v9
v_lshl_add_u32 v5, v8, 4, v5
s_mul_i32 s6, s4, 1152
s_add_u32 s6, s6, 5242880
s_lshl_b32 s7, s3, 5
v_add_u32 v6, s7, v5
s_lshl_b32 s7, s3, 8
v_add_u32 v5, s7, v5
s_waitcnt lgkmcnt(0)
v_mfma_f32_16x16x32_bf16 v[24:27], v[64:67], a[96:99], 0
v_mfma_f32_16x16x32_bf16 v[24:27], v[68:71], a[100:103], v[24:27]
v_mfma_f32_16x16x32_bf16 v[24:27], v[72:75], a[104:107], v[24:27]
v_mfma_f32_16x16x32_bf16 v[24:27], v[76:79], a[108:111], v[24:27]
v_mfma_f32_16x16x32_bf16 v[28:31], v[64:67], a[112:115], 0
v_mfma_f32_16x16x32_bf16 v[28:31], v[68:71], a[116:119], v[28:31]
v_mfma_f32_16x16x32_bf16 v[28:31], v[72:75], a[120:123], v[28:31]
v_mfma_f32_16x16x32_bf16 v[28:31], v[76:79], a[124:127], v[28:31]
v_mfma_f32_16x16x32_bf16 v[32:35], v[64:67], a[128:131], 0
v_mfma_f32_16x16x32_bf16 v[32:35], v[68:71], a[132:135], v[32:35]
v_mfma_f32_16x16x32_bf16 v[32:35], v[72:75], a[136:139], v[32:35]
v_mfma_f32_16x16x32_bf16 v[32:35], v[76:79], a[140:143], v[32:35]
v_mfma_f32_16x16x32_bf16 v[36:39], v[64:67], a[144:147], 0
v_mfma_f32_16x16x32_bf16 v[36:39], v[68:71], a[148:151], v[36:39]
v_mfma_f32_16x16x32_bf16 v[36:39], v[72:75], a[152:155], v[36:39]
v_mfma_f32_16x16x32_bf16 v[36:39], v[76:79], a[156:159], v[36:39]
v_mfma_f32_16x16x32_bf16 v[40:43], v[64:67], a[160:163], 0
v_mfma_f32_16x16x32_bf16 v[40:43], v[68:71], a[164:167], v[40:43]
v_mfma_f32_16x16x32_bf16 v[40:43], v[72:75], a[168:171], v[40:43]
v_mfma_f32_16x16x32_bf16 v[40:43], v[76:79], a[172:175], v[40:43]
v_mfma_f32_16x16x32_bf16 v[44:47], v[64:67], a[176:179], 0
v_mfma_f32_16x16x32_bf16 v[44:47], v[68:71], a[180:183], v[44:47]
v_mfma_f32_16x16x32_bf16 v[44:47], v[72:75], a[184:187], v[44:47]
v_mfma_f32_16x16x32_bf16 v[44:47], v[76:79], a[188:191], v[44:47]
v_mfma_f32_16x16x32_bf16 v[48:51], v[64:67], a[192:195], 0
v_mfma_f32_16x16x32_bf16 v[48:51], v[68:71], a[196:199], v[48:51]
v_mfma_f32_16x16x32_bf16 v[48:51], v[72:75], a[200:203], v[48:51]
v_mfma_f32_16x16x32_bf16 v[48:51], v[76:79], a[204:207], v[48:51]
v_mfma_f32_16x16x32_bf16 v[52:55], v[64:67], a[208:211], 0
v_mfma_f32_16x16x32_bf16 v[52:55], v[68:71], a[212:215], v[52:55]
v_mfma_f32_16x16x32_bf16 v[52:55], v[72:75], a[216:219], v[52:55]
v_mfma_f32_16x16x32_bf16 v[52:55], v[76:79], a[220:223], v[52:55]
v_mfma_f32_16x16x32_bf16 v[56:59], v[64:67], a[224:227], 0
v_mfma_f32_16x16x32_bf16 v[56:59], v[68:71], a[228:231], v[56:59]
v_mfma_f32_16x16x32_bf16 v[56:59], v[72:75], a[232:235], v[56:59]
v_mfma_f32_16x16x32_bf16 v[56:59], v[76:79], a[236:239], v[56:59]
v_add_f32 v24, v24, v25
v_add_f32 v26, v26, v27
v_add_f32 v216, v24, v26
v_min_u32 v216, -2, v216
v_add_f32 v28, v28, v29
v_add_f32 v30, v30, v31
v_add_f32 v217, v28, v30
v_min_u32 v217, -2, v217
v_add_f32 v32, v32, v33
v_add_f32 v34, v34, v35
v_add_f32 v218, v32, v34
v_min_u32 v218, -2, v218
v_add_f32 v36, v36, v37
v_add_f32 v38, v38, v39
v_add_f32 v219, v36, v38
v_min_u32 v219, -2, v219
v_add_f32 v40, v40, v41
v_add_f32 v42, v42, v43
v_add_f32 v220, v40, v42
v_min_u32 v220, -2, v220
v_add_f32 v44, v44, v45
v_add_f32 v46, v46, v47
v_add_f32 v221, v44, v46
v_min_u32 v221, -2, v221
v_add_f32 v48, v48, v49
v_add_f32 v50, v50, v51
v_add_f32 v222, v48, v50
v_min_u32 v222, -2, v222
v_add_f32 v52, v52, v53
v_add_f32 v54, v54, v55
v_add_f32 v223, v52, v54
v_min_u32 v223, -2, v223
v_add_f32 v56, v56, v57
v_add_f32 v58, v58, v59
v_add_f32 v224, v56, v58
v_min_u32 v224, -2, v224
v_cvt_pk_bf16_f32 v216, v216, v217
v_min_u32 v216, -2, v216
v_cvt_pk_bf16_f32 v217, v218, v219
v_min_u32 v217, -2, v217
v_cvt_pk_bf16_f32 v218, v220, v221
v_min_u32 v218, -2, v218
v_cvt_pk_bf16_f32 v219, v222, v223
v_min_u32 v219, -2, v219
buffer_store_dwordx4 v[216:219], v5, s[64:67], s6 offen sc1
v_mov_b32_dpp v229, v224 row_shl:2 row_mask:0xf bank_mask:0xf
v_cvt_pk_bf16_f32 v228, v224, v229
v_min_u32 v228, -2, v228
s_nop 1
v_mov_b32_dpp v229, v228 row_shl:4 row_mask:0xf bank_mask:0xf
v_mov_b32_dpp v230, v228 row_shl:8 row_mask:0xf bank_mask:0xf
v_mov_b32_dpp v231, v228 row_shl:12 row_mask:0xf bank_mask:0xf
s_mov_b32 exec_lo, 0x00030003
s_mov_b32 exec_hi, 196611
buffer_store_dwordx4 v[228:231], v6, s[64:67], s6 offen offset:1024 sc1
s_mov_b64 exec, -1
s_nop 1
s_branch B_final
D_role:
s_lshr_b32 s10, s4, 3
s_lshr_b32 s80, s4, 0
s_and_b32 s11, s80, 7
v_xor_b32 v10, 32, v2
v_mov_b32 v76, -1
v_mov_b32 v77, -1
v_mov_b32 v78, -1
v_mov_b32 v79, -1
s_waitcnt lgkmcnt(0)
s_mov_b32 s64, s42
s_mov_b32 s65, s43
s_mov_b32 s66, 16777216
s_mov_b32 s67, 0x20000
s_lshl_b32 s6, s10, 22
s_add_u32 s52, s28, s6
s_addc_u32 s53, s29, 0
s_mov_b32 s54, 4194304
s_mov_b32 s55, 0x20000
s_cmp_eq_u32 s3, 3
s_cbranch_scc1 L_clr3_17
s_mul_i32 s6, s4, 9216
s_mul_i32 s7, s3, 4608
s_add_u32 s6, s6, s7
s_add_u32 s6, s6, 4194304
s_mul_i32 s7, s4, 4608
s_add_u32 s7, s7, 5242880
s_cmp_eq_u32 s3, 2
s_cselect_b32 s6, s7, s6
buffer_store_dwordx4 v[76:79], v2, s[64:67], s6 offen offset:0 sc1
buffer_store_dwordx4 v[76:79], v2, s[64:67], s6 offen offset:1024 sc1
buffer_store_dwordx4 v[76:79], v2, s[64:67], s6 offen offset:2048 sc1
buffer_store_dwordx4 v[76:79], v2, s[64:67], s6 offen offset:3072 sc1
s_add_u32 s6, s6, 4096
s_mov_b64 exec, 0xffffffff
buffer_store_dwordx4 v[76:79], v2, s[64:67], s6 offen offset:0 sc1
s_mov_b64 exec, -1
s_branch L_clrd_18
L_clr3_17:
s_mul_i32 s6, s4, 4096
s_add_u32 s6, s6, 0
buffer_store_dwordx4 v[76:79], v2, s[64:67], s6 offen offset:0 sc1
buffer_store_dwordx4 v[76:79], v2, s[64:67], s6 offen offset:1024 sc1
buffer_store_dwordx4 v[76:79], v2, s[64:67], s6 offen offset:2048 sc1
buffer_store_dwordx4 v[76:79], v2, s[64:67], s6 offen offset:3072 sc1
s_mov_b64 exec, 0xffff
s_mul_i32 s6, s4, 256
s_mul_i32 s7, s4, 256
s_add_u32 s7, s7, 327680
s_add_u32 s6, s6, 262144
v_lshrrev_b32 v6, 2, v1
v_mul_u32_u24 v6, 0, v6
v_add_u32 v6, v6, v2
buffer_store_dwordx4 v[76:79], v2, s[64:67], s6 offen sc1
buffer_store_dwordx4 v[76:79], v6, s[64:67], s7 offen sc1
s_mov_b64 exec, 3
s_mul_i32 s6, s4, 32
s_add_u32 s6, s6, 393216
s_lshr_b32 s7, s4, 2
s_mul_i32 s7, s7, 4224
s_add_u32 s6, s6, s7
v_mul_u32_u24 v5, 16, v1
buffer_store_dwordx4 v[76:79], v5, s[64:67], s6 offen sc1
s_mov_b64 exec, -1
L_clrd_18:
s_mov_b32 s68, s40
s_mov_b32 s69, s41
s_mov_b32 s70, 256
s_mov_b32 s71, 0x20000
s_mov_b32 s72, s38
s_mov_b32 s73, s39
s_mov_b32 s74, 9216
s_mov_b32 s75, 0x20000
s_mul_i32 s12, s3, 17408
s_lshl_b32 s13, s11, 2
s_add_u32 s13, s13, s3
s_lshl_b32 s13, s13, 12
s_add_u32 m0, s12, 0
s_add_u32 s6, s13, 0
buffer_load_dwordx4 v2, s[52:55], s6 offen nt lds
s_add_u32 m0, s12, 1088
s_add_u32 s6, s13, 1024
buffer_load_dwordx4 v2, s[52:55], s6 offen nt lds
s_add_u32 m0, s12, 2176
s_add_u32 s6, s13, 2048
buffer_load_dwordx4 v2, s[52:55], s6 offen nt lds
s_add_u32 m0, s12, 3264
s_add_u32 s6, s13, 3072
buffer_load_dwordx4 v2, s[52:55], s6 offen nt lds
s_add_u32 m0, s12, 4352
s_add_u32 s6, s13, 131072
buffer_load_dwordx4 v2, s[52:55], s6 offen nt lds
s_add_u32 m0, s12, 5440
s_add_u32 s6, s13, 132096
buffer_load_dwordx4 v2, s[52:55], s6 offen nt lds
s_add_u32 m0, s12, 6528
s_add_u32 s6, s13, 133120
buffer_load_dwordx4 v2, s[52:55], s6 offen nt lds
s_add_u32 m0, s12, 7616
s_add_u32 s6, s13, 134144
buffer_load_dwordx4 v2, s[52:55], s6 offen nt lds
s_waitcnt vmcnt(8)
v_mov_b32 v7, 1
s_mov_b64 exec, 1
buffer_atomic_add v7, off, s[68:71], 0 offset:0
s_mov_b64 exec, -1
s_add_u32 m0, s12, 8704
s_add_u32 s6, s13, 262144
s_waitcnt vmcnt(3)
buffer_load_dwordx4 v10, s[52:55], s6 offen nt lds
s_add_u32 m0, s12, 9792
s_add_u32 s6, s13, 263168
s_waitcnt vmcnt(3)
buffer_load_dwordx4 v10, s[52:55], s6 offen nt lds
s_add_u32 m0, s12, 10880
s_add_u32 s6, s13, 264192
s_waitcnt vmcnt(3)
buffer_load_dwordx4 v10, s[52:55], s6 offen nt lds
s_add_u32 m0, s12, 11968
s_add_u32 s6, s13, 265216
s_waitcnt vmcnt(3)
buffer_load_dwordx4 v10, s[52:55], s6 offen nt lds
s_add_u32 m0, s12, 13056
s_add_u32 s6, s13, 393216
s_waitcnt vmcnt(3)
buffer_load_dwordx4 v10, s[52:55], s6 offen nt lds
s_add_u32 m0, s12, 14144
s_add_u32 s6, s13, 394240
s_waitcnt vmcnt(3)
buffer_load_dwordx4 v10, s[52:55], s6 offen nt lds
s_add_u32 m0, s12, 15232
s_add_u32 s6, s13, 395264
s_waitcnt vmcnt(3)
buffer_load_dwordx4 v10, s[52:55], s6 offen nt lds
s_add_u32 m0, s12, 16320
s_add_u32 s6, s13, 396288
s_waitcnt vmcnt(3)
buffer_load_dwordx4 v10, s[52:55], s6 offen nt lds
s_add_u32 m0, s12, 69632
s_add_u32 s6, s13, 524288
s_waitcnt vmcnt(3)
buffer_load_dwordx4 v2, s[52:55], s6 offen nt lds
s_add_u32 m0, s12, 70720
s_add_u32 s6, s13, 525312
s_waitcnt vmcnt(3)
buffer_load_dwordx4 v2, s[52:55], s6 offen nt lds
s_add_u32 m0, s12, 71808
s_add_u32 s6, s13, 526336
s_waitcnt vmcnt(3)
buffer_load_dwordx4 v2, s[52:55], s6 offen nt lds
s_add_u32 m0, s12, 72896
s_add_u32 s6, s13, 527360
s_waitcnt vmcnt(3)
buffer_load_dwordx4 v2, s[52:55], s6 offen nt lds
s_add_u32 m0, s12, 73984
s_add_u32 s6, s13, 655360
s_waitcnt vmcnt(3)
buffer_load_dwordx4 v2, s[52:55], s6 offen nt lds
s_add_u32 m0, s12, 75072
s_add_u32 s6, s13, 656384
s_waitcnt vmcnt(3)
buffer_load_dwordx4 v2, s[52:55], s6 offen nt lds
s_add_u32 m0, s12, 76160
s_add_u32 s6, s13, 657408
s_waitcnt vmcnt(3)
buffer_load_dwordx4 v2, s[52:55], s6 offen nt lds
s_add_u32 m0, s12, 77248
s_add_u32 s6, s13, 658432
s_waitcnt vmcnt(3)
buffer_load_dwordx4 v2, s[52:55], s6 offen nt lds
s_add_u32 m0, s12, 78336
s_add_u32 s6, s13, 786432
s_waitcnt vmcnt(3)
buffer_load_dwordx4 v10, s[52:55], s6 offen nt lds
s_add_u32 m0, s12, 79424
s_add_u32 s6, s13, 787456
s_waitcnt vmcnt(3)
buffer_load_dwordx4 v10, s[52:55], s6 offen nt lds
s_add_u32 m0, s12, 80512
s_add_u32 s6, s13, 788480
s_waitcnt vmcnt(3)
buffer_load_dwordx4 v10, s[52:55], s6 offen nt lds
s_add_u32 m0, s12, 81600
s_add_u32 s6, s13, 789504
s_waitcnt vmcnt(3)
buffer_load_dwordx4 v10, s[52:55], s6 offen nt lds
s_add_u32 m0, s12, 82688
s_add_u32 s6, s13, 917504
s_waitcnt vmcnt(3)
buffer_load_dwordx4 v10, s[52:55], s6 offen nt lds
s_add_u32 m0, s12, 83776
s_add_u32 s6, s13, 918528
s_waitcnt vmcnt(3)
buffer_load_dwordx4 v10, s[52:55], s6 offen nt lds
s_add_u32 m0, s12, 84864
s_add_u32 s6, s13, 919552
s_waitcnt vmcnt(3)
buffer_load_dwordx4 v10, s[52:55], s6 offen nt lds
s_add_u32 m0, s12, 85952
s_add_u32 s6, s13, 920576
s_waitcnt vmcnt(3)
buffer_load_dwordx4 v10, s[52:55], s6 offen nt lds
s_add_u32 s6, s13, 1048576
s_waitcnt vmcnt(3)
buffer_load_dwordx4 a[128:131], v2, s[52:55], s6 offen nt
s_add_u32 s6, s13, 1049600
s_waitcnt vmcnt(3)
buffer_load_dwordx4 a[132:135], v2, s[52:55], s6 offen nt
s_add_u32 s6, s13, 1050624
s_waitcnt vmcnt(3)
buffer_load_dwordx4 a[136:139], v2, s[52:55], s6 offen nt
s_add_u32 s6, s13, 1051648
s_waitcnt vmcnt(3)
buffer_load_dwordx4 a[140:143], v2, s[52:55], s6 offen nt
s_add_u32 s6, s13, 1179648
s_waitcnt vmcnt(3)
buffer_load_dwordx4 a[144:147], v2, s[52:55], s6 offen nt
s_add_u32 s6, s13, 1180672
s_waitcnt vmcnt(3)
buffer_load_dwordx4 a[148:151], v2, s[52:55], s6 offen nt
s_add_u32 s6, s13, 1181696
s_waitcnt vmcnt(3)
buffer_load_dwordx4 a[152:155], v2, s[52:55], s6 offen nt
s_add_u32 s6, s13, 1182720
s_waitcnt vmcnt(3)
buffer_load_dwordx4 a[156:159], v2, s[52:55], s6 offen nt
s_add_u32 s6, s13, 1310720
s_waitcnt vmcnt(3)
buffer_load_dwordx4 a[160:163], v10, s[52:55], s6 offen nt
s_add_u32 s6, s13, 1311744
s_waitcnt vmcnt(3)
buffer_load_dwordx4 a[164:167], v10, s[52:55], s6 offen nt
s_add_u32 s6, s13, 1312768
s_waitcnt vmcnt(3)
buffer_load_dwordx4 a[168:171], v10, s[52:55], s6 offen nt
s_add_u32 s6, s13, 1313792
s_waitcnt vmcnt(3)
buffer_load_dwordx4 a[172:175], v10, s[52:55], s6 offen nt
s_add_u32 s6, s13, 1441792
s_waitcnt vmcnt(3)
buffer_load_dwordx4 a[176:179], v10, s[52:55], s6 offen nt
s_add_u32 s6, s13, 1442816
s_waitcnt vmcnt(3)
buffer_load_dwordx4 a[180:183], v10, s[52:55], s6 offen nt
s_add_u32 s6, s13, 1443840
s_waitcnt vmcnt(3)
buffer_load_dwordx4 a[184:187], v10, s[52:55], s6 offen nt
s_add_u32 s6, s13, 1444864
s_waitcnt vmcnt(3)
buffer_load_dwordx4 a[188:191], v10, s[52:55], s6 offen nt
s_add_u32 s6, s13, 1572864
s_waitcnt vmcnt(3)
buffer_load_dwordx4 a[192:195], v2, s[52:55], s6 offen nt
s_add_u32 s6, s13, 1573888
s_waitcnt vmcnt(3)
buffer_load_dwordx4 a[196:199], v2, s[52:55], s6 offen nt
s_add_u32 s6, s13, 1574912
s_waitcnt vmcnt(3)
buffer_load_dwordx4 a[200:203], v2, s[52:55], s6 offen nt
s_add_u32 s6, s13, 1575936
s_waitcnt vmcnt(3)
buffer_load_dwordx4 a[204:207], v2, s[52:55], s6 offen nt
s_add_u32 s6, s13, 1703936
s_waitcnt vmcnt(3)
buffer_load_dwordx4 a[208:211], v2, s[52:55], s6 offen nt
s_add_u32 s6, s13, 1704960
s_waitcnt vmcnt(3)
buffer_load_dwordx4 a[212:215], v2, s[52:55], s6 offen nt
s_add_u32 s6, s13, 1705984
s_waitcnt vmcnt(3)
buffer_load_dwordx4 a[216:219], v2, s[52:55], s6 offen nt
s_add_u32 s6, s13, 1707008
s_waitcnt vmcnt(3)
buffer_load_dwordx4 a[220:223], v2, s[52:55], s6 offen nt
s_add_u32 s6, s13, 1835008
s_waitcnt vmcnt(3)
buffer_load_dwordx4 a[224:227], v10, s[52:55], s6 offen nt
s_add_u32 s6, s13, 1836032
s_waitcnt vmcnt(3)
buffer_load_dwordx4 a[228:231], v10, s[52:55], s6 offen nt
s_add_u32 s6, s13, 1837056
s_waitcnt vmcnt(3)
buffer_load_dwordx4 a[232:235], v10, s[52:55], s6 offen nt
s_add_u32 s6, s13, 1838080
s_waitcnt vmcnt(3)
buffer_load_dwordx4 a[236:239], v10, s[52:55], s6 offen nt
s_add_u32 s6, s13, 1966080
s_waitcnt vmcnt(3)
buffer_load_dwordx4 a[240:243], v10, s[52:55], s6 offen nt
s_add_u32 s6, s13, 1967104
s_waitcnt vmcnt(3)
buffer_load_dwordx4 a[244:247], v10, s[52:55], s6 offen nt
s_add_u32 s6, s13, 1968128
s_waitcnt vmcnt(3)
buffer_load_dwordx4 a[248:251], v10, s[52:55], s6 offen nt
s_add_u32 s6, s13, 1969152
s_waitcnt vmcnt(3)
buffer_load_dwordx4 a[252:255], v10, s[52:55], s6 offen nt
buffer_load_dword v11, off, s[68:71], 0 offset:0 sc1
s_lshl_b32 s14, s10, 3
s_add_u32 s14, s14, s3
s_mul_i32 s14, s14, 4096
s_add_u32 s14, s14, 0
s_add_u32 s15, s14, 16384
s_lshl_b32 s6, s3, 4
v_add_u32 v5, s6, v8
v_mul_u32_u24 v5, 1088, v5
v_lshrrev_b32 v6, 3, v8
v_lshlrev_b32 v6, 1, v6
v_xor_b32 v6, v6, v9
v_lshl_add_u32 v194, v6, 4, v5
v_add_u32 v195, 69632, v194
v_lshrrev_b32 v5, 5, v1
v_lshlrev_b32 v5, 3, v5
v_bfe_u32 v6, v1, 2, 2
v_add_u32 v5, v5, v6
v_mul_u32_u24 v5, 1088, v5
v_lshrrev_b32 v6, 1, v9
v_xor_b32 v6, v6, v9
v_and_b32 v6, 1, v6
v_lshl_add_u32 v5, v6, 5, v5
v_and_b32 v6, 3, v1
v_lshl_add_u32 v5, v6, 3, v5
s_lshl_b32 s6, s3, 8
v_add_u32 v196, s6, v5
v_add_u32 v197, 69632, v196
v_lshlrev_b32 v199, 4, v8
v_add_u32 v199, 160256, v199
s_lshl_b32 s6, s3, 2
v_add_u32 v198, s6, v199
v_and_b32 v5, 31, v1
v_lshlrev_b32 v200, 4, v5
v_add_u32 v200, 160256, v200
v_lshlrev_b32 v202, 5, v5
v_lshrrev_b32 v6, 5, v1
v_lshl_add_u32 v202, v6, 4, v202
v_add_u32 v202, 156160, v202
v_lshlrev_b32 v201, 5, v8
v_lshl_add_u32 v201, v9, 3, v201
s_lshl_b32 s6, s3, 10
s_add_u32 s6, s6, 156160
v_add_u32 v201, s6, v201
v_mul_u32_u24 v203, 1056, v8
v_lshl_add_u32 v203, v9, 4, v203
v_add_u32 v203, 139264, v203
s_mul_i32 s6, s3, 4224
s_add_u32 s6, s6, 139264
v_add_u32 v204, s6, v2
v_add_u32 v206, s12, v2
v_add_u32 v207, 69632, v206
v_mov_b32 v185, 0x3e0293ee
v_mov_b32 v176, 0xff800000
v_mov_b32 v177, 0xff800000
v_mov_b32 v178, 0xff800000
v_mov_b32 v180, 0
v_mov_b32 v181, 0
s_waitcnt vmcnt(0)
s_mov_b32 s7, 400000
L_ens_19:
v_readfirstlane_b32 s6, v11
s_cmp_ge_u32 s6, 128
s_cbranch_scc1 L_ensd_20
s_sleep 16
buffer_load_dword v11, off, s[68:71], 0 offset:0 sc1
s_waitcnt vmcnt(0)
s_sub_u32 s7, s7, 1
s_cmp_lg_u32 s7, 0
s_cbranch_scc1 L_ens_19
L_ensd_20:
s_mov_b32 s7, 400000
v_and_b32 v5, 3, v1
v_bfe_u32 v6, v1, 2, 1
v_mul_u32_u24 v6, 16384, v6
v_lshl_add_u32 v5, v5, 10, v6
Q_slow:
buffer_load_dword v192, v5, s[64:67], s14 offen offset:768 sc1
s_waitcnt vmcnt(0)
v_cmp_eq_u32 vcc, -1, v192
s_cbranch_vccz Q_chk
s_sleep 8
s_sub_u32 s7, s7, 1
s_cmp_lg_u32 s7, 1
s_cbranch_scc1 Q_slow
Q_chk:
buffer_load_dwordx4 v[84:87], v2, s[64:67], s14 offen offset:0 sc1
buffer_load_dwordx4 v[88:91], v2, s[64:67], s14 offen offset:1024 sc1
buffer_load_dwordx4 v[92:95], v2, s[64:67], s14 offen offset:2048 sc1
buffer_load_dwordx4 v[96:99], v2, s[64:67], s14 offen offset:3072 sc1
buffer_load_dwordx4 v[100:103], v2, s[64:67], s15 offen offset:0 sc1
buffer_load_dwordx4 v[104:107], v2, s[64:67], s15 offen offset:1024 sc1
buffer_load_dwordx4 v[108:111], v2, s[64:67], s15 offen offset:2048 sc1
buffer_load_dwordx4 v[112:115], v2, s[64:67], s15 offen offset:3072 sc1
s_waitcnt vmcnt(0)
v_max3_u32 v192, v84, v85, v86
v_max3_u32 v192, v192, v87, v88
v_max3_u32 v192, v192, v89, v90
v_max3_u32 v192, v192, v91, v92
v_max3_u32 v192, v192, v93, v94
v_max3_u32 v192, v192, v95, v96
v_max3_u32 v192, v192, v97, v98
v_max3_u32 v192, v192, v99, v100
v_max3_u32 v192, v192, v101, v102
v_max3_u32 v192, v192, v103, v104
v_max3_u32 v192, v192, v105, v106
v_max3_u32 v192, v192, v107, v108
v_max3_u32 v192, v192, v109, v110
v_max3_u32 v192, v192, v111, v112
v_max3_u32 v192, v192, v113, v114
v_max_u32 v192, v192, v115
v_cmp_eq_u32 vcc, -1, v192
s_cbranch_vccz Q_ok
s_sleep 16
s_sub_u32 s7, s7, 1
s_cmp_lg_u32 s7, 0
s_cbranch_scc1 Q_chk
Q_ok:
ds_write_b128 v204, v[84:87] offset:0
ds_write_b128 v204, v[88:91] offset:1056
ds_write_b128 v204, v[92:95] offset:2112
ds_write_b128 v204, v[96:99] offset:3168
s_waitcnt lgkmcnt(0)
s_barrier
ds_read_b128 a[0:3], v203 offset:0
ds_read_b128 a[4:7], v203 offset:64
ds_read_b128 a[8:11], v203 offset:128
ds_read_b128 a[12:15], v203 offset:192
ds_read_b128 a[16:19], v203 offset:256
ds_read_b128 a[20:23], v203 offset:320
ds_read_b128 a[24:27], v203 offset:384
ds_read_b128 a[28:31], v203 offset:448
ds_read_b128 a[32:35], v203 offset:512
ds_read_b128 a[36:39], v203 offset:576
ds_read_b128 a[40:43], v203 offset:640
ds_read_b128 a[44:47], v203 offset:704
ds_read_b128 a[48:51], v203 offset:768
ds_read_b128 a[52:55], v203 offset:832
ds_read_b128 a[56:59], v203 offset:896
ds_read_b128 a[60:63], v203 offset:960
s_waitcnt lgkmcnt(0)
s_barrier
ds_write_b128 v204, v[100:103] offset:0
ds_write_b128 v204, v[104:107] offset:1056
ds_write_b128 v204, v[108:111] offset:2112
ds_write_b128 v204, v[112:115] offset:3168
s_waitcnt lgkmcnt(0)
s_barrier
ds_read_b128 a[64:67], v203 offset:0
ds_read_b128 a[68:71], v203 offset:64
ds_read_b128 a[72:75], v203 offset:128
ds_read_b128 a[76:79], v203 offset:192
ds_read_b128 a[80:83], v203 offset:256
ds_read_b128 a[84:87], v203 offset:320
ds_read_b128 a[88:91], v203 offset:384
ds_read_b128 a[92:95], v203 offset:448
ds_read_b128 a[96:99], v203 offset:512
ds_read_b128 a[100:103], v203 offset:576
ds_read_b128 a[104:107], v203 offset:640
ds_read_b128 a[108:111], v203 offset:704
ds_read_b128 a[112:115], v203 offset:768
ds_read_b128 a[116:119], v203 offset:832
ds_read_b128 a[120:123], v203 offset:896
ds_read_b128 a[124:127], v203 offset:960
s_waitcnt lgkmcnt(0)
s_mov_b32 s81, 4
ds_read_b128 v[84:87], v194 offset:0
ds_read_b128 v[88:91], v194 offset:64
ds_read_b128 v[92:95], v194 offset:128
ds_read_b128 v[96:99], v194 offset:192
ds_read_b128 v[100:103], v194 offset:256
ds_read_b128 v[104:107], v194 offset:320
ds_read_b128 v[108:111], v194 offset:384
ds_read_b128 v[112:115], v194 offset:448
ds_read_b128 v[116:119], v194 offset:512
ds_read_b128 v[120:123], v194 offset:576
ds_read_b128 v[124:127], v194 offset:640
ds_read_b128 v[128:131], v194 offset:704
ds_read_b128 v[132:135], v194 offset:768
ds_read_b128 v[136:139], v194 offset:832
ds_read_b128 v[140:143], v194 offset:896
ds_read_b128 v[144:147], v194 offset:960
s_waitcnt lgkmcnt(15)
v_mfma_f32_16x16x32_bf16 v[76:79], v[84:87], a[0:3], 0
v_mfma_f32_16x16x32_bf16 v[80:83], v[84:87], a[64:67], 0
s_waitcnt lgkmcnt(14)
v_mfma_f32_16x16x32_bf16 v[76:79], v[88:91], a[4:7], v[76:79]
v_mfma_f32_16x16x32_bf16 v[80:83], v[88:91], a[68:71], v[80:83]
s_waitcnt lgkmcnt(13)
v_mfma_f32_16x16x32_bf16 v[76:79], v[92:95], a[8:11], v[76:79]
v_mfma_f32_16x16x32_bf16 v[80:83], v[92:95], a[72:75], v[80:83]
s_waitcnt lgkmcnt(12)
v_mfma_f32_16x16x32_bf16 v[76:79], v[96:99], a[12:15], v[76:79]
v_mfma_f32_16x16x32_bf16 v[80:83], v[96:99], a[76:79], v[80:83]
s_waitcnt lgkmcnt(11)
v_mfma_f32_16x16x32_bf16 v[76:79], v[100:103], a[16:19], v[76:79]
v_mfma_f32_16x16x32_bf16 v[80:83], v[100:103], a[80:83], v[80:83]
s_waitcnt lgkmcnt(10)
v_mfma_f32_16x16x32_bf16 v[76:79], v[104:107], a[20:23], v[76:79]
v_mfma_f32_16x16x32_bf16 v[80:83], v[104:107], a[84:87], v[80:83]
s_waitcnt lgkmcnt(9)
v_mfma_f32_16x16x32_bf16 v[76:79], v[108:111], a[24:27], v[76:79]
v_mfma_f32_16x16x32_bf16 v[80:83], v[108:111], a[88:91], v[80:83]
s_waitcnt lgkmcnt(8)
v_mfma_f32_16x16x32_bf16 v[76:79], v[112:115], a[28:31], v[76:79]
v_mfma_f32_16x16x32_bf16 v[80:83], v[112:115], a[92:95], v[80:83]
s_waitcnt lgkmcnt(7)
v_mfma_f32_16x16x32_bf16 v[76:79], v[116:119], a[32:35], v[76:79]
v_mfma_f32_16x16x32_bf16 v[80:83], v[116:119], a[96:99], v[80:83]
s_waitcnt lgkmcnt(6)
v_mfma_f32_16x16x32_bf16 v[76:79], v[120:123], a[36:39], v[76:79]
v_mfma_f32_16x16x32_bf16 v[80:83], v[120:123], a[100:103], v[80:83]
s_waitcnt lgkmcnt(5)
v_mfma_f32_16x16x32_bf16 v[76:79], v[124:127], a[40:43], v[76:79]
v_mfma_f32_16x16x32_bf16 v[80:83], v[124:127], a[104:107], v[80:83]
s_waitcnt lgkmcnt(4)
v_mfma_f32_16x16x32_bf16 v[76:79], v[128:131], a[44:47], v[76:79]
v_mfma_f32_16x16x32_bf16 v[80:83], v[128:131], a[108:111], v[80:83]
s_waitcnt lgkmcnt(3)
v_mfma_f32_16x16x32_bf16 v[76:79], v[132:135], a[48:51], v[76:79]
v_mfma_f32_16x16x32_bf16 v[80:83], v[132:135], a[112:115], v[80:83]
s_waitcnt lgkmcnt(2)
v_mfma_f32_16x16x32_bf16 v[76:79], v[136:139], a[52:55], v[76:79]
v_mfma_f32_16x16x32_bf16 v[80:83], v[136:139], a[116:119], v[80:83]
s_waitcnt lgkmcnt(1)
v_mfma_f32_16x16x32_bf16 v[76:79], v[140:143], a[56:59], v[76:79]
v_mfma_f32_16x16x32_bf16 v[80:83], v[140:143], a[120:123], v[80:83]
s_waitcnt lgkmcnt(0)
v_mfma_f32_16x16x32_bf16 v[76:79], v[144:147], a[60:63], v[76:79]
v_mfma_f32_16x16x32_bf16 v[80:83], v[144:147], a[124:127], v[80:83]
s_nop 6
v_max_f32 v190, v76, v77
v_max3_f32 v190, v190, v78, v79
v_mov_b32 v192, v190
s_nop 1
v_permlane16_swap_b32 v190, v192
v_max_f32 v190, v190, v192
v_mov_b32 v192, v190
s_nop 1
v_permlane32_swap_b32 v190, v192
v_max_f32 v190, v190, v192
ds_write_b32 v198, v190 offset:0
v_max_f32 v191, v80, v81
v_max3_f32 v191, v191, v82, v83
v_mov_b32 v192, v191
s_nop 1
v_permlane16_swap_b32 v191, v192
v_max_f32 v191, v191, v192
v_mov_b32 v192, v191
s_nop 1
v_permlane32_swap_b32 v191, v192
v_max_f32 v191, v191, v192
ds_write_b32 v198, v191 offset:256
s_waitcnt lgkmcnt(0)
s_barrier
ds_read_b128 v[164:167], v199
ds_read_b128 v[168:171], v199 offset:256
ds_read_b128 v[172:175], v200
s_waitcnt lgkmcnt(0)
v_max_f32 v164, v164, v165
v_max3_f32 v164, v164, v166, v167
v_mul_f32 v164, v164, v185
v_max_f32 v164, v164, v176
v_sub_f32 v182, v176, v164
v_exp_f32 v182, v182
v_mov_b32 v176, v164
v_max_f32 v168, v168, v169
v_max3_f32 v168, v168, v170, v171
v_mul_f32 v168, v168, v185
v_max_f32 v168, v168, v177
v_sub_f32 v183, v177, v168
v_exp_f32 v183, v183
v_mov_b32 v177, v168
v_max_f32 v172, v172, v173
v_max3_f32 v172, v172, v174, v175
v_mul_f32 v172, v172, v185
v_max_f32 v172, v172, v178
v_sub_f32 v184, v178, v172
v_exp_f32 v184, v184
v_mov_b32 v178, v172
v_fma_f32 v76, v76, v185, -v176
v_fma_f32 v77, v77, v185, -v176
v_fma_f32 v78, v78, v185, -v176
v_fma_f32 v79, v79, v185, -v176
v_exp_f32 v76, v76
v_exp_f32 v77, v77
v_exp_f32 v78, v78
v_exp_f32 v79, v79
v_mul_f32 v180, v180, v182
v_cvt_pk_bf16_f32 v186, v76, v77
v_cvt_pk_bf16_f32 v187, v78, v79
ds_write_b64 v201, v[186:187] offset:0
v_add_f32 v180, v180, v76
v_add_f32 v180, v180, v77
v_add_f32 v180, v180, v78
v_add_f32 v180, v180, v79
v_fma_f32 v80, v80, v185, -v177
v_fma_f32 v81, v81, v185, -v177
v_fma_f32 v82, v82, v185, -v177
v_fma_f32 v83, v83, v185, -v177
v_exp_f32 v80, v80
v_exp_f32 v81, v81
v_exp_f32 v82, v82
v_exp_f32 v83, v83
v_mul_f32 v181, v181, v183
v_cvt_pk_bf16_f32 v188, v80, v81
v_cvt_pk_bf16_f32 v189, v82, v83
ds_write_b64 v201, v[188:189] offset:512
v_add_f32 v181, v181, v80
v_add_f32 v181, v181, v81
v_add_f32 v181, v181, v82
v_add_f32 v181, v181, v83
s_waitcnt lgkmcnt(0)
s_barrier
ds_read_b128 v[148:151], v202 offset:0
ds_read_b128 v[152:155], v202 offset:1024
ds_read_b128 v[156:159], v202 offset:2048
ds_read_b128 v[160:163], v202 offset:3072
ds_read_b64_tr_b16 v[84:85], v196 offset:0
ds_read_b64_tr_b16 v[86:87], v196 offset:4352
ds_read_b64_tr_b16 v[88:89], v196 offset:64
ds_read_b64_tr_b16 v[90:91], v196 offset:4416
ds_read_b64_tr_b16 v[92:93], v196 offset:128
ds_read_b64_tr_b16 v[94:95], v196 offset:4480
ds_read_b64_tr_b16 v[96:97], v196 offset:192
ds_read_b64_tr_b16 v[98:99], v196 offset:4544
ds_read_b64_tr_b16 v[100:101], v196 offset:17408
ds_read_b64_tr_b16 v[102:103], v196 offset:21760
ds_read_b64_tr_b16 v[104:105], v196 offset:17472
ds_read_b64_tr_b16 v[106:107], v196 offset:21824
ds_read_b64_tr_b16 v[108:109], v196 offset:17536
ds_read_b64_tr_b16 v[110:111], v196 offset:21888
ds_read_b64_tr_b16 v[112:113], v196 offset:17600
ds_read_b64_tr_b16 v[114:115], v196 offset:21952
ds_read_b64_tr_b16 v[116:117], v196 offset:34816
ds_read_b64_tr_b16 v[118:119], v196 offset:39168
ds_read_b64_tr_b16 v[120:121], v196 offset:34880
ds_read_b64_tr_b16 v[122:123], v196 offset:39232
ds_read_b64_tr_b16 v[124:125], v196 offset:34944
ds_read_b64_tr_b16 v[126:127], v196 offset:39296
ds_read_b64_tr_b16 v[128:129], v196 offset:35008
ds_read_b64_tr_b16 v[130:131], v196 offset:39360
ds_read_b64_tr_b16 v[132:133], v196 offset:52224
ds_read_b64_tr_b16 v[134:135], v196 offset:56576
ds_read_b64_tr_b16 v[136:137], v196 offset:52288
ds_read_b64_tr_b16 v[138:139], v196 offset:56640
ds_read_b64_tr_b16 v[140:141], v196 offset:52352
ds_read_b64_tr_b16 v[142:143], v196 offset:56704
ds_read_b64_tr_b16 v[144:145], v196 offset:52416
ds_read_b64_tr_b16 v[146:147], v196 offset:56768
s_waitcnt lgkmcnt(15)
v_mfma_f32_32x32x16_bf16 v[12:27], v[84:87], v[148:151], 0
v_mfma_f32_32x32x16_bf16 v[28:43], v[88:91], v[148:151], 0
v_mfma_f32_32x32x16_bf16 v[44:59], v[92:95], v[148:151], 0
v_mfma_f32_32x32x16_bf16 v[60:75], v[96:99], v[148:151], 0
s_waitcnt lgkmcnt(15)
v_mfma_f32_32x32x16_bf16 v[12:27], v[100:103], v[152:155], v[12:27]
v_mfma_f32_32x32x16_bf16 v[28:43], v[104:107], v[152:155], v[28:43]
v_mfma_f32_32x32x16_bf16 v[44:59], v[108:111], v[152:155], v[44:59]
v_mfma_f32_32x32x16_bf16 v[60:75], v[112:115], v[152:155], v[60:75]
s_waitcnt lgkmcnt(8)
v_mfma_f32_32x32x16_bf16 v[12:27], v[116:119], v[156:159], v[12:27]
v_mfma_f32_32x32x16_bf16 v[28:43], v[120:123], v[156:159], v[28:43]
v_mfma_f32_32x32x16_bf16 v[44:59], v[124:127], v[156:159], v[44:59]
v_mfma_f32_32x32x16_bf16 v[60:75], v[128:131], v[156:159], v[60:75]
s_waitcnt lgkmcnt(0)
v_mfma_f32_32x32x16_bf16 v[12:27], v[132:135], v[160:163], v[12:27]
v_mfma_f32_32x32x16_bf16 v[28:43], v[136:139], v[160:163], v[28:43]
v_mfma_f32_32x32x16_bf16 v[44:59], v[140:143], v[160:163], v[44:59]
v_mfma_f32_32x32x16_bf16 v[60:75], v[144:147], v[160:163], v[60:75]
ds_read_b128 v[84:87], v195 offset:0
ds_read_b128 v[88:91], v195 offset:64
ds_read_b128 v[92:95], v195 offset:128
ds_read_b128 v[96:99], v195 offset:192
ds_read_b128 v[100:103], v195 offset:256
ds_read_b128 v[104:107], v195 offset:320
ds_read_b128 v[108:111], v195 offset:384
ds_read_b128 v[112:115], v195 offset:448
ds_read_b128 v[116:119], v195 offset:512
ds_read_b128 v[120:123], v195 offset:576
ds_read_b128 v[124:127], v195 offset:640
ds_read_b128 v[128:131], v195 offset:704
ds_read_b128 v[132:135], v195 offset:768
ds_read_b128 v[136:139], v195 offset:832
ds_read_b128 v[140:143], v195 offset:896
ds_read_b128 v[144:147], v195 offset:960
s_waitcnt lgkmcnt(15)
v_mfma_f32_16x16x32_bf16 v[76:79], v[84:87], a[0:3], 0
v_mfma_f32_16x16x32_bf16 v[80:83], v[84:87], a[64:67], 0
s_waitcnt lgkmcnt(14)
v_mfma_f32_16x16x32_bf16 v[76:79], v[88:91], a[4:7], v[76:79]
v_mfma_f32_16x16x32_bf16 v[80:83], v[88:91], a[68:71], v[80:83]
s_waitcnt lgkmcnt(13)
v_mfma_f32_16x16x32_bf16 v[76:79], v[92:95], a[8:11], v[76:79]
v_mfma_f32_16x16x32_bf16 v[80:83], v[92:95], a[72:75], v[80:83]
s_waitcnt lgkmcnt(12)
v_mfma_f32_16x16x32_bf16 v[76:79], v[96:99], a[12:15], v[76:79]
v_mfma_f32_16x16x32_bf16 v[80:83], v[96:99], a[76:79], v[80:83]
s_waitcnt lgkmcnt(11)
v_mfma_f32_16x16x32_bf16 v[76:79], v[100:103], a[16:19], v[76:79]
v_mfma_f32_16x16x32_bf16 v[80:83], v[100:103], a[80:83], v[80:83]
s_waitcnt lgkmcnt(10)
v_mfma_f32_16x16x32_bf16 v[76:79], v[104:107], a[20:23], v[76:79]
v_mfma_f32_16x16x32_bf16 v[80:83], v[104:107], a[84:87], v[80:83]
s_waitcnt lgkmcnt(9)
v_mfma_f32_16x16x32_bf16 v[76:79], v[108:111], a[24:27], v[76:79]
v_mfma_f32_16x16x32_bf16 v[80:83], v[108:111], a[88:91], v[80:83]
s_waitcnt lgkmcnt(8)
v_mfma_f32_16x16x32_bf16 v[76:79], v[112:115], a[28:31], v[76:79]
v_mfma_f32_16x16x32_bf16 v[80:83], v[112:115], a[92:95], v[80:83]
s_waitcnt lgkmcnt(7)
v_mfma_f32_16x16x32_bf16 v[76:79], v[116:119], a[32:35], v[76:79]
v_mfma_f32_16x16x32_bf16 v[80:83], v[116:119], a[96:99], v[80:83]
s_waitcnt lgkmcnt(6)
v_mfma_f32_16x16x32_bf16 v[76:79], v[120:123], a[36:39], v[76:79]
v_mfma_f32_16x16x32_bf16 v[80:83], v[120:123], a[100:103], v[80:83]
s_waitcnt lgkmcnt(5)
v_mfma_f32_16x16x32_bf16 v[76:79], v[124:127], a[40:43], v[76:79]
v_mfma_f32_16x16x32_bf16 v[80:83], v[124:127], a[104:107], v[80:83]
s_waitcnt lgkmcnt(4)
v_mfma_f32_16x16x32_bf16 v[76:79], v[128:131], a[44:47], v[76:79]
v_mfma_f32_16x16x32_bf16 v[80:83], v[128:131], a[108:111], v[80:83]
s_waitcnt lgkmcnt(3)
v_mfma_f32_16x16x32_bf16 v[76:79], v[132:135], a[48:51], v[76:79]
v_mfma_f32_16x16x32_bf16 v[80:83], v[132:135], a[112:115], v[80:83]
s_waitcnt lgkmcnt(2)
v_mfma_f32_16x16x32_bf16 v[76:79], v[136:139], a[52:55], v[76:79]
v_mfma_f32_16x16x32_bf16 v[80:83], v[136:139], a[116:119], v[80:83]
s_waitcnt lgkmcnt(1)
v_mfma_f32_16x16x32_bf16 v[76:79], v[140:143], a[56:59], v[76:79]
v_mfma_f32_16x16x32_bf16 v[80:83], v[140:143], a[120:123], v[80:83]
s_waitcnt lgkmcnt(0)
v_mfma_f32_16x16x32_bf16 v[76:79], v[144:147], a[60:63], v[76:79]
v_mfma_f32_16x16x32_bf16 v[80:83], v[144:147], a[124:127], v[80:83]
s_nop 6
v_max_f32 v190, v76, v77
v_max3_f32 v190, v190, v78, v79
v_mov_b32 v192, v190
s_nop 1
v_permlane16_swap_b32 v190, v192
v_max_f32 v190, v190, v192
v_mov_b32 v192, v190
s_nop 1
v_permlane32_swap_b32 v190, v192
v_max_f32 v190, v190, v192
ds_write_b32 v198, v190 offset:0
v_max_f32 v191, v80, v81
v_max3_f32 v191, v191, v82, v83
v_mov_b32 v192, v191
s_nop 1
v_permlane16_swap_b32 v191, v192
v_max_f32 v191, v191, v192
v_mov_b32 v192, v191
s_nop 1
v_permlane32_swap_b32 v191, v192
v_max_f32 v191, v191, v192
ds_write_b32 v198, v191 offset:256
s_waitcnt lgkmcnt(0)
s_barrier
ds_read_b128 v[164:167], v199
ds_read_b128 v[168:171], v199 offset:256
ds_read_b128 v[172:175], v200
ds_write_b128 v206, a[128:131] offset:0
ds_write_b128 v206, a[132:135] offset:1088
ds_write_b128 v206, a[136:139] offset:2176
ds_write_b128 v206, a[140:143] offset:3264
ds_write_b128 v206, a[144:147] offset:4352
ds_write_b128 v206, a[148:151] offset:5440
ds_write_b128 v206, a[152:155] offset:6528
ds_write_b128 v206, a[156:159] offset:7616
ds_write_b128 v206, a[160:163] offset:8704
ds_write_b128 v206, a[164:167] offset:9792
ds_write_b128 v206, a[168:171] offset:10880
ds_write_b128 v206, a[172:175] offset:11968
ds_write_b128 v206, a[176:179] offset:13056
ds_write_b128 v206, a[180:183] offset:14144
ds_write_b128 v206, a[184:187] offset:15232
ds_write_b128 v206, a[188:191] offset:16320
s_waitcnt lgkmcnt(15)
v_max_f32 v164, v164, v165
v_max3_f32 v164, v164, v166, v167
v_mul_f32 v164, v164, v185
v_max_f32 v164, v164, v176
v_sub_f32 v182, v176, v164
v_exp_f32 v182, v182
v_mov_b32 v176, v164
v_max_f32 v168, v168, v169
v_max3_f32 v168, v168, v170, v171
v_mul_f32 v168, v168, v185
v_max_f32 v168, v168, v177
v_sub_f32 v183, v177, v168
v_exp_f32 v183, v183
v_mov_b32 v177, v168
v_max_f32 v172, v172, v173
v_max3_f32 v172, v172, v174, v175
v_mul_f32 v172, v172, v185
v_max_f32 v172, v172, v178
v_sub_f32 v184, v178, v172
v_exp_f32 v184, v184
v_mov_b32 v178, v172
v_fma_f32 v76, v76, v185, -v176
v_fma_f32 v77, v77, v185, -v176
v_fma_f32 v78, v78, v185, -v176
v_fma_f32 v79, v79, v185, -v176
v_exp_f32 v76, v76
v_exp_f32 v77, v77
v_exp_f32 v78, v78
v_exp_f32 v79, v79
v_mul_f32 v180, v180, v182
v_cvt_pk_bf16_f32 v186, v76, v77
v_cvt_pk_bf16_f32 v187, v78, v79
ds_write_b64 v201, v[186:187] offset:0
v_add_f32 v180, v180, v76
v_add_f32 v180, v180, v77
v_add_f32 v180, v180, v78
v_add_f32 v180, v180, v79
v_fma_f32 v80, v80, v185, -v177
v_fma_f32 v81, v81, v185, -v177
v_fma_f32 v82, v82, v185, -v177
v_fma_f32 v83, v83, v185, -v177
v_exp_f32 v80, v80
v_exp_f32 v81, v81
v_exp_f32 v82, v82
v_exp_f32 v83, v83
v_mul_f32 v181, v181, v183
v_cvt_pk_bf16_f32 v188, v80, v81
v_cvt_pk_bf16_f32 v189, v82, v83
ds_write_b64 v201, v[188:189] offset:512
v_add_f32 v181, v181, v80
v_add_f32 v181, v181, v81
v_add_f32 v181, v181, v82
v_add_f32 v181, v181, v83
v_mul_f32 v12, v12, v184
v_mul_f32 v13, v13, v184
v_mul_f32 v14, v14, v184
v_mul_f32 v15, v15, v184
v_mul_f32 v16, v16, v184
v_mul_f32 v17, v17, v184
v_mul_f32 v18, v18, v184
v_mul_f32 v19, v19, v184
v_mul_f32 v20, v20, v184
v_mul_f32 v21, v21, v184
v_mul_f32 v22, v22, v184
v_mul_f32 v23, v23, v184
v_mul_f32 v24, v24, v184
v_mul_f32 v25, v25, v184
v_mul_f32 v26, v26, v184
v_mul_f32 v27, v27, v184
v_mul_f32 v28, v28, v184
v_mul_f32 v29, v29, v184
v_mul_f32 v30, v30, v184
v_mul_f32 v31, v31, v184
v_mul_f32 v32, v32, v184
v_mul_f32 v33, v33, v184
v_mul_f32 v34, v34, v184
v_mul_f32 v35, v35, v184
v_mul_f32 v36, v36, v184
v_mul_f32 v37, v37, v184
v_mul_f32 v38, v38, v184
v_mul_f32 v39, v39, v184
v_mul_f32 v40, v40, v184
v_mul_f32 v41, v41, v184
v_mul_f32 v42, v42, v184
v_mul_f32 v43, v43, v184
v_mul_f32 v44, v44, v184
v_mul_f32 v45, v45, v184
v_mul_f32 v46, v46, v184
v_mul_f32 v47, v47, v184
v_mul_f32 v48, v48, v184
v_mul_f32 v49, v49, v184
v_mul_f32 v50, v50, v184
v_mul_f32 v51, v51, v184
v_mul_f32 v52, v52, v184
v_mul_f32 v53, v53, v184
v_mul_f32 v54, v54, v184
v_mul_f32 v55, v55, v184
v_mul_f32 v56, v56, v184
v_mul_f32 v57, v57, v184
v_mul_f32 v58, v58, v184
v_mul_f32 v59, v59, v184
v_mul_f32 v60, v60, v184
v_mul_f32 v61, v61, v184
v_mul_f32 v62, v62, v184
v_mul_f32 v63, v63, v184
v_mul_f32 v64, v64, v184
v_mul_f32 v65, v65, v184
v_mul_f32 v66, v66, v184
v_mul_f32 v67, v67, v184
v_mul_f32 v68, v68, v184
v_mul_f32 v69, v69, v184
v_mul_f32 v70, v70, v184
v_mul_f32 v71, v71, v184
v_mul_f32 v72, v72, v184
v_mul_f32 v73, v73, v184
v_mul_f32 v74, v74, v184
v_mul_f32 v75, v75, v184
s_waitcnt lgkmcnt(0)
s_barrier
ds_read_b128 v[148:151], v202 offset:0
ds_read_b128 v[152:155], v202 offset:1024
ds_read_b128 v[156:159], v202 offset:2048
ds_read_b128 v[160:163], v202 offset:3072
ds_read_b64_tr_b16 v[84:85], v197 offset:0
ds_read_b64_tr_b16 v[86:87], v197 offset:4352
ds_read_b64_tr_b16 v[88:89], v197 offset:64
ds_read_b64_tr_b16 v[90:91], v197 offset:4416
ds_read_b64_tr_b16 v[92:93], v197 offset:128
ds_read_b64_tr_b16 v[94:95], v197 offset:4480
ds_read_b64_tr_b16 v[96:97], v197 offset:192
ds_read_b64_tr_b16 v[98:99], v197 offset:4544
ds_read_b64_tr_b16 v[100:101], v197 offset:17408
ds_read_b64_tr_b16 v[102:103], v197 offset:21760
ds_read_b64_tr_b16 v[104:105], v197 offset:17472
ds_read_b64_tr_b16 v[106:107], v197 offset:21824
ds_read_b64_tr_b16 v[108:109], v197 offset:17536
ds_read_b64_tr_b16 v[110:111], v197 offset:21888
ds_read_b64_tr_b16 v[112:113], v197 offset:17600
ds_read_b64_tr_b16 v[114:115], v197 offset:21952
ds_read_b64_tr_b16 v[116:117], v197 offset:34816
ds_read_b64_tr_b16 v[118:119], v197 offset:39168
ds_read_b64_tr_b16 v[120:121], v197 offset:34880
ds_read_b64_tr_b16 v[122:123], v197 offset:39232
ds_read_b64_tr_b16 v[124:125], v197 offset:34944
ds_read_b64_tr_b16 v[126:127], v197 offset:39296
ds_read_b64_tr_b16 v[128:129], v197 offset:35008
ds_read_b64_tr_b16 v[130:131], v197 offset:39360
ds_read_b64_tr_b16 v[132:133], v197 offset:52224
ds_read_b64_tr_b16 v[134:135], v197 offset:56576
ds_read_b64_tr_b16 v[136:137], v197 offset:52288
ds_read_b64_tr_b16 v[138:139], v197 offset:56640
ds_read_b64_tr_b16 v[140:141], v197 offset:52352
ds_read_b64_tr_b16 v[142:143], v197 offset:56704
ds_read_b64_tr_b16 v[144:145], v197 offset:52416
ds_read_b64_tr_b16 v[146:147], v197 offset:56768
s_waitcnt lgkmcnt(15)
v_mfma_f32_32x32x16_bf16 v[12:27], v[84:87], v[148:151], v[12:27]
v_mfma_f32_32x32x16_bf16 v[28:43], v[88:91], v[148:151], v[28:43]
s_add_u32 s6, s13, 2097152
buffer_load_dwordx4 a[128:131], v2, s[52:55], s6 offen nt
v_mfma_f32_32x32x16_bf16 v[44:59], v[92:95], v[148:151], v[44:59]
v_mfma_f32_32x32x16_bf16 v[60:75], v[96:99], v[148:151], v[60:75]
s_add_u32 s6, s13, 2098176
buffer_load_dwordx4 a[132:135], v2, s[52:55], s6 offen nt
s_waitcnt lgkmcnt(15)
v_mfma_f32_32x32x16_bf16 v[12:27], v[100:103], v[152:155], v[12:27]
v_mfma_f32_32x32x16_bf16 v[28:43], v[104:107], v[152:155], v[28:43]
s_add_u32 s6, s13, 2099200
buffer_load_dwordx4 a[136:139], v2, s[52:55], s6 offen nt
v_mfma_f32_32x32x16_bf16 v[44:59], v[108:111], v[152:155], v[44:59]
v_mfma_f32_32x32x16_bf16 v[60:75], v[112:115], v[152:155], v[60:75]
s_add_u32 s6, s13, 2100224
buffer_load_dwordx4 a[140:143], v2, s[52:55], s6 offen nt
s_waitcnt lgkmcnt(8)
v_mfma_f32_32x32x16_bf16 v[12:27], v[116:119], v[156:159], v[12:27]
v_mfma_f32_32x32x16_bf16 v[28:43], v[120:123], v[156:159], v[28:43]
s_add_u32 s6, s13, 2228224
buffer_load_dwordx4 a[144:147], v2, s[52:55], s6 offen nt
v_mfma_f32_32x32x16_bf16 v[44:59], v[124:127], v[156:159], v[44:59]
v_mfma_f32_32x32x16_bf16 v[60:75], v[128:131], v[156:159], v[60:75]
s_add_u32 s6, s13, 2229248
buffer_load_dwordx4 a[148:151], v2, s[52:55], s6 offen nt
s_waitcnt lgkmcnt(0)
v_mfma_f32_32x32x16_bf16 v[12:27], v[132:135], v[160:163], v[12:27]
v_mfma_f32_32x32x16_bf16 v[28:43], v[136:139], v[160:163], v[28:43]
s_add_u32 s6, s13, 2230272
buffer_load_dwordx4 a[152:155], v2, s[52:55], s6 offen nt
v_mfma_f32_32x32x16_bf16 v[44:59], v[140:143], v[160:163], v[44:59]
v_mfma_f32_32x32x16_bf16 v[60:75], v[144:147], v[160:163], v[60:75]
s_add_u32 s6, s13, 2231296
buffer_load_dwordx4 a[156:159], v2, s[52:55], s6 offen nt
ds_read_b128 v[84:87], v194 offset:0
ds_read_b128 v[88:91], v194 offset:64
ds_read_b128 v[92:95], v194 offset:128
ds_read_b128 v[96:99], v194 offset:192
ds_read_b128 v[100:103], v194 offset:256
ds_read_b128 v[104:107], v194 offset:320
ds_read_b128 v[108:111], v194 offset:384
ds_read_b128 v[112:115], v194 offset:448
ds_read_b128 v[116:119], v194 offset:512
ds_read_b128 v[120:123], v194 offset:576
ds_read_b128 v[124:127], v194 offset:640
ds_read_b128 v[128:131], v194 offset:704
ds_read_b128 v[132:135], v194 offset:768
ds_read_b128 v[136:139], v194 offset:832
ds_read_b128 v[140:143], v194 offset:896
ds_read_b128 v[144:147], v194 offset:960
s_waitcnt lgkmcnt(15)
v_mfma_f32_16x16x32_bf16 v[76:79], v[84:87], a[0:3], 0
v_mfma_f32_16x16x32_bf16 v[80:83], v[84:87], a[64:67], 0
s_waitcnt lgkmcnt(14)
v_mfma_f32_16x16x32_bf16 v[76:79], v[88:91], a[4:7], v[76:79]
v_mfma_f32_16x16x32_bf16 v[80:83], v[88:91], a[68:71], v[80:83]
s_add_u32 s6, s13, 2359296
buffer_load_dwordx4 a[160:163], v10, s[52:55], s6 offen nt
s_waitcnt lgkmcnt(13)
v_mfma_f32_16x16x32_bf16 v[76:79], v[92:95], a[8:11], v[76:79]
v_mfma_f32_16x16x32_bf16 v[80:83], v[92:95], a[72:75], v[80:83]
s_waitcnt lgkmcnt(12)
v_mfma_f32_16x16x32_bf16 v[76:79], v[96:99], a[12:15], v[76:79]
v_mfma_f32_16x16x32_bf16 v[80:83], v[96:99], a[76:79], v[80:83]
s_add_u32 s6, s13, 2360320
buffer_load_dwordx4 a[164:167], v10, s[52:55], s6 offen nt
s_waitcnt lgkmcnt(11)
v_mfma_f32_16x16x32_bf16 v[76:79], v[100:103], a[16:19], v[76:79]
v_mfma_f32_16x16x32_bf16 v[80:83], v[100:103], a[80:83], v[80:83]
s_waitcnt lgkmcnt(10)
v_mfma_f32_16x16x32_bf16 v[76:79], v[104:107], a[20:23], v[76:79]
v_mfma_f32_16x16x32_bf16 v[80:83], v[104:107], a[84:87], v[80:83]
s_add_u32 s6, s13, 2361344
buffer_load_dwordx4 a[168:171], v10, s[52:55], s6 offen nt
s_waitcnt lgkmcnt(9)
v_mfma_f32_16x16x32_bf16 v[76:79], v[108:111], a[24:27], v[76:79]
v_mfma_f32_16x16x32_bf16 v[80:83], v[108:111], a[88:91], v[80:83]
s_waitcnt lgkmcnt(8)
v_mfma_f32_16x16x32_bf16 v[76:79], v[112:115], a[28:31], v[76:79]
v_mfma_f32_16x16x32_bf16 v[80:83], v[112:115], a[92:95], v[80:83]
s_add_u32 s6, s13, 2362368
buffer_load_dwordx4 a[172:175], v10, s[52:55], s6 offen nt
s_waitcnt lgkmcnt(7)
v_mfma_f32_16x16x32_bf16 v[76:79], v[116:119], a[32:35], v[76:79]
v_mfma_f32_16x16x32_bf16 v[80:83], v[116:119], a[96:99], v[80:83]
s_waitcnt lgkmcnt(6)
v_mfma_f32_16x16x32_bf16 v[76:79], v[120:123], a[36:39], v[76:79]
v_mfma_f32_16x16x32_bf16 v[80:83], v[120:123], a[100:103], v[80:83]
s_add_u32 s6, s13, 2490368
buffer_load_dwordx4 a[176:179], v10, s[52:55], s6 offen nt
s_waitcnt lgkmcnt(5)
v_mfma_f32_16x16x32_bf16 v[76:79], v[124:127], a[40:43], v[76:79]
v_mfma_f32_16x16x32_bf16 v[80:83], v[124:127], a[104:107], v[80:83]
s_waitcnt lgkmcnt(4)
v_mfma_f32_16x16x32_bf16 v[76:79], v[128:131], a[44:47], v[76:79]
v_mfma_f32_16x16x32_bf16 v[80:83], v[128:131], a[108:111], v[80:83]
s_add_u32 s6, s13, 2491392
buffer_load_dwordx4 a[180:183], v10, s[52:55], s6 offen nt
s_waitcnt lgkmcnt(3)
v_mfma_f32_16x16x32_bf16 v[76:79], v[132:135], a[48:51], v[76:79]
v_mfma_f32_16x16x32_bf16 v[80:83], v[132:135], a[112:115], v[80:83]
s_waitcnt lgkmcnt(2)
v_mfma_f32_16x16x32_bf16 v[76:79], v[136:139], a[52:55], v[76:79]
v_mfma_f32_16x16x32_bf16 v[80:83], v[136:139], a[116:119], v[80:83]
s_add_u32 s6, s13, 2492416
buffer_load_dwordx4 a[184:187], v10, s[52:55], s6 offen nt
s_waitcnt lgkmcnt(1)
v_mfma_f32_16x16x32_bf16 v[76:79], v[140:143], a[56:59], v[76:79]
v_mfma_f32_16x16x32_bf16 v[80:83], v[140:143], a[120:123], v[80:83]
s_waitcnt lgkmcnt(0)
v_mfma_f32_16x16x32_bf16 v[76:79], v[144:147], a[60:63], v[76:79]
v_mfma_f32_16x16x32_bf16 v[80:83], v[144:147], a[124:127], v[80:83]
s_add_u32 s6, s13, 2493440
buffer_load_dwordx4 a[188:191], v10, s[52:55], s6 offen nt
s_nop 4
v_max_f32 v190, v76, v77
v_max3_f32 v190, v190, v78, v79
v_mov_b32 v192, v190
s_nop 1
v_permlane16_swap_b32 v190, v192
v_max_f32 v190, v190, v192
v_mov_b32 v192, v190
s_nop 1
v_permlane32_swap_b32 v190, v192
v_max_f32 v190, v190, v192
ds_write_b32 v198, v190 offset:0
v_max_f32 v191, v80, v81
v_max3_f32 v191, v191, v82, v83
v_mov_b32 v192, v191
s_nop 1
v_permlane16_swap_b32 v191, v192
v_max_f32 v191, v191, v192
v_mov_b32 v192, v191
s_nop 1
v_permlane32_swap_b32 v191, v192
v_max_f32 v191, v191, v192
ds_write_b32 v198, v191 offset:256
s_waitcnt lgkmcnt(0)
s_barrier
ds_read_b128 v[164:167], v199
ds_read_b128 v[168:171], v199 offset:256
ds_read_b128 v[172:175], v200
ds_write_b128 v207, a[192:195] offset:0
ds_write_b128 v207, a[196:199] offset:1088
ds_write_b128 v207, a[200:203] offset:2176
ds_write_b128 v207, a[204:207] offset:3264
ds_write_b128 v207, a[208:211] offset:4352
ds_write_b128 v207, a[212:215] offset:5440
ds_write_b128 v207, a[216:219] offset:6528
ds_write_b128 v207, a[220:223] offset:7616
ds_write_b128 v207, a[224:227] offset:8704
ds_write_b128 v207, a[228:231] offset:9792
ds_write_b128 v207, a[232:235] offset:10880
ds_write_b128 v207, a[236:239] offset:11968
ds_write_b128 v207, a[240:243] offset:13056
ds_write_b128 v207, a[244:247] offset:14144
ds_write_b128 v207, a[248:251] offset:15232
ds_write_b128 v207, a[252:255] offset:16320
s_waitcnt lgkmcnt(15)
v_max_f32 v164, v164, v165
v_max3_f32 v164, v164, v166, v167
v_mul_f32 v164, v164, v185
v_max_f32 v164, v164, v176
v_sub_f32 v182, v176, v164
v_exp_f32 v182, v182
v_mov_b32 v176, v164
v_max_f32 v168, v168, v169
v_max3_f32 v168, v168, v170, v171
v_mul_f32 v168, v168, v185
v_max_f32 v168, v168, v177
v_sub_f32 v183, v177, v168
v_exp_f32 v183, v183
v_mov_b32 v177, v168
v_max_f32 v172, v172, v173
v_max3_f32 v172, v172, v174, v175
v_mul_f32 v172, v172, v185
v_max_f32 v172, v172, v178
v_sub_f32 v184, v178, v172
v_exp_f32 v184, v184
v_mov_b32 v178, v172
v_fma_f32 v76, v76, v185, -v176
v_fma_f32 v77, v77, v185, -v176
v_fma_f32 v78, v78, v185, -v176
v_fma_f32 v79, v79, v185, -v176
v_exp_f32 v76, v76
v_exp_f32 v77, v77
v_exp_f32 v78, v78
v_exp_f32 v79, v79
v_mul_f32 v180, v180, v182
v_cvt_pk_bf16_f32 v186, v76, v77
v_cvt_pk_bf16_f32 v187, v78, v79
ds_write_b64 v201, v[186:187] offset:0
v_add_f32 v180, v180, v76
v_add_f32 v180, v180, v77
v_add_f32 v180, v180, v78
v_add_f32 v180, v180, v79
v_fma_f32 v80, v80, v185, -v177
v_fma_f32 v81, v81, v185, -v177
v_fma_f32 v82, v82, v185, -v177
v_fma_f32 v83, v83, v185, -v177
v_exp_f32 v80, v80
v_exp_f32 v81, v81
v_exp_f32 v82, v82
v_exp_f32 v83, v83
v_mul_f32 v181, v181, v183
v_cvt_pk_bf16_f32 v188, v80, v81
v_cvt_pk_bf16_f32 v189, v82, v83
ds_write_b64 v201, v[188:189] offset:512
v_add_f32 v181, v181, v80
v_add_f32 v181, v181, v81
v_add_f32 v181, v181, v82
v_add_f32 v181, v181, v83
v_mul_f32 v12, v12, v184
v_mul_f32 v13, v13, v184
v_mul_f32 v14, v14, v184
v_mul_f32 v15, v15, v184
v_mul_f32 v16, v16, v184
v_mul_f32 v17, v17, v184
v_mul_f32 v18, v18, v184
v_mul_f32 v19, v19, v184
v_mul_f32 v20, v20, v184
v_mul_f32 v21, v21, v184
v_mul_f32 v22, v22, v184
v_mul_f32 v23, v23, v184
v_mul_f32 v24, v24, v184
v_mul_f32 v25, v25, v184
v_mul_f32 v26, v26, v184
v_mul_f32 v27, v27, v184
v_mul_f32 v28, v28, v184
v_mul_f32 v29, v29, v184
v_mul_f32 v30, v30, v184
v_mul_f32 v31, v31, v184
v_mul_f32 v32, v32, v184
v_mul_f32 v33, v33, v184
v_mul_f32 v34, v34, v184
v_mul_f32 v35, v35, v184
v_mul_f32 v36, v36, v184
v_mul_f32 v37, v37, v184
v_mul_f32 v38, v38, v184
v_mul_f32 v39, v39, v184
v_mul_f32 v40, v40, v184
v_mul_f32 v41, v41, v184
v_mul_f32 v42, v42, v184
v_mul_f32 v43, v43, v184
v_mul_f32 v44, v44, v184
v_mul_f32 v45, v45, v184
v_mul_f32 v46, v46, v184
v_mul_f32 v47, v47, v184
v_mul_f32 v48, v48, v184
v_mul_f32 v49, v49, v184
v_mul_f32 v50, v50, v184
v_mul_f32 v51, v51, v184
v_mul_f32 v52, v52, v184
v_mul_f32 v53, v53, v184
v_mul_f32 v54, v54, v184
v_mul_f32 v55, v55, v184
v_mul_f32 v56, v56, v184
v_mul_f32 v57, v57, v184
v_mul_f32 v58, v58, v184
v_mul_f32 v59, v59, v184
v_mul_f32 v60, v60, v184
v_mul_f32 v61, v61, v184
v_mul_f32 v62, v62, v184
v_mul_f32 v63, v63, v184
v_mul_f32 v64, v64, v184
v_mul_f32 v65, v65, v184
v_mul_f32 v66, v66, v184
v_mul_f32 v67, v67, v184
v_mul_f32 v68, v68, v184
v_mul_f32 v69, v69, v184
v_mul_f32 v70, v70, v184
v_mul_f32 v71, v71, v184
v_mul_f32 v72, v72, v184
v_mul_f32 v73, v73, v184
v_mul_f32 v74, v74, v184
v_mul_f32 v75, v75, v184
s_waitcnt lgkmcnt(0)
s_barrier
ds_read_b128 v[148:151], v202 offset:0
ds_read_b128 v[152:155], v202 offset:1024
ds_read_b128 v[156:159], v202 offset:2048
ds_read_b128 v[160:163], v202 offset:3072
ds_read_b64_tr_b16 v[84:85], v196 offset:0
ds_read_b64_tr_b16 v[86:87], v196 offset:4352
ds_read_b64_tr_b16 v[88:89], v196 offset:64
ds_read_b64_tr_b16 v[90:91], v196 offset:4416
ds_read_b64_tr_b16 v[92:93], v196 offset:128
ds_read_b64_tr_b16 v[94:95], v196 offset:4480
ds_read_b64_tr_b16 v[96:97], v196 offset:192
ds_read_b64_tr_b16 v[98:99], v196 offset:4544
ds_read_b64_tr_b16 v[100:101], v196 offset:17408
ds_read_b64_tr_b16 v[102:103], v196 offset:21760
ds_read_b64_tr_b16 v[104:105], v196 offset:17472
ds_read_b64_tr_b16 v[106:107], v196 offset:21824
ds_read_b64_tr_b16 v[108:109], v196 offset:17536
ds_read_b64_tr_b16 v[110:111], v196 offset:21888
ds_read_b64_tr_b16 v[112:113], v196 offset:17600
ds_read_b64_tr_b16 v[114:115], v196 offset:21952
ds_read_b64_tr_b16 v[116:117], v196 offset:34816
ds_read_b64_tr_b16 v[118:119], v196 offset:39168
ds_read_b64_tr_b16 v[120:121], v196 offset:34880
ds_read_b64_tr_b16 v[122:123], v196 offset:39232
ds_read_b64_tr_b16 v[124:125], v196 offset:34944
ds_read_b64_tr_b16 v[126:127], v196 offset:39296
ds_read_b64_tr_b16 v[128:129], v196 offset:35008
ds_read_b64_tr_b16 v[130:131], v196 offset:39360
ds_read_b64_tr_b16 v[132:133], v196 offset:52224
ds_read_b64_tr_b16 v[134:135], v196 offset:56576
ds_read_b64_tr_b16 v[136:137], v196 offset:52288
ds_read_b64_tr_b16 v[138:139], v196 offset:56640
ds_read_b64_tr_b16 v[140:141], v196 offset:52352
ds_read_b64_tr_b16 v[142:143], v196 offset:56704
ds_read_b64_tr_b16 v[144:145], v196 offset:52416
ds_read_b64_tr_b16 v[146:147], v196 offset:56768
s_waitcnt lgkmcnt(15)
v_mfma_f32_32x32x16_bf16 v[12:27], v[84:87], v[148:151], v[12:27]
v_mfma_f32_32x32x16_bf16 v[28:43], v[88:91], v[148:151], v[28:43]
s_add_u32 s6, s13, 2621440
buffer_load_dwordx4 a[192:195], v2, s[52:55], s6 offen nt
v_mfma_f32_32x32x16_bf16 v[44:59], v[92:95], v[148:151], v[44:59]
v_mfma_f32_32x32x16_bf16 v[60:75], v[96:99], v[148:151], v[60:75]
s_add_u32 s6, s13, 2622464
buffer_load_dwordx4 a[196:199], v2, s[52:55], s6 offen nt
s_waitcnt lgkmcnt(15)
v_mfma_f32_32x32x16_bf16 v[12:27], v[100:103], v[152:155], v[12:27]
v_mfma_f32_32x32x16_bf16 v[28:43], v[104:107], v[152:155], v[28:43]
s_add_u32 s6, s13, 2623488
buffer_load_dwordx4 a[200:203], v2, s[52:55], s6 offen nt
v_mfma_f32_32x32x16_bf16 v[44:59], v[108:111], v[152:155], v[44:59]
v_mfma_f32_32x32x16_bf16 v[60:75], v[112:115], v[152:155], v[60:75]
s_add_u32 s6, s13, 2624512
buffer_load_dwordx4 a[204:207], v2, s[52:55], s6 offen nt
s_waitcnt lgkmcnt(8)
v_mfma_f32_32x32x16_bf16 v[12:27], v[116:119], v[156:159], v[12:27]
v_mfma_f32_32x32x16_bf16 v[28:43], v[120:123], v[156:159], v[28:43]
s_add_u32 s6, s13, 2752512
buffer_load_dwordx4 a[208:211], v2, s[52:55], s6 offen nt
v_mfma_f32_32x32x16_bf16 v[44:59], v[124:127], v[156:159], v[44:59]
v_mfma_f32_32x32x16_bf16 v[60:75], v[128:131], v[156:159], v[60:75]
s_add_u32 s6, s13, 2753536
buffer_load_dwordx4 a[212:215], v2, s[52:55], s6 offen nt
s_waitcnt lgkmcnt(0)
v_mfma_f32_32x32x16_bf16 v[12:27], v[132:135], v[160:163], v[12:27]
v_mfma_f32_32x32x16_bf16 v[28:43], v[136:139], v[160:163], v[28:43]
s_add_u32 s6, s13, 2754560
buffer_load_dwordx4 a[216:219], v2, s[52:55], s6 offen nt
v_mfma_f32_32x32x16_bf16 v[44:59], v[140:143], v[160:163], v[44:59]
v_mfma_f32_32x32x16_bf16 v[60:75], v[144:147], v[160:163], v[60:75]
s_add_u32 s6, s13, 2755584
buffer_load_dwordx4 a[220:223], v2, s[52:55], s6 offen nt
ds_read_b128 v[84:87], v195 offset:0
ds_read_b128 v[88:91], v195 offset:64
ds_read_b128 v[92:95], v195 offset:128
ds_read_b128 v[96:99], v195 offset:192
ds_read_b128 v[100:103], v195 offset:256
ds_read_b128 v[104:107], v195 offset:320
ds_read_b128 v[108:111], v195 offset:384
ds_read_b128 v[112:115], v195 offset:448
ds_read_b128 v[116:119], v195 offset:512
ds_read_b128 v[120:123], v195 offset:576
ds_read_b128 v[124:127], v195 offset:640
ds_read_b128 v[128:131], v195 offset:704
ds_read_b128 v[132:135], v195 offset:768
ds_read_b128 v[136:139], v195 offset:832
ds_read_b128 v[140:143], v195 offset:896
ds_read_b128 v[144:147], v195 offset:960
s_waitcnt lgkmcnt(15)
v_mfma_f32_16x16x32_bf16 v[76:79], v[84:87], a[0:3], 0
v_mfma_f32_16x16x32_bf16 v[80:83], v[84:87], a[64:67], 0
s_waitcnt lgkmcnt(14)
v_mfma_f32_16x16x32_bf16 v[76:79], v[88:91], a[4:7], v[76:79]
v_mfma_f32_16x16x32_bf16 v[80:83], v[88:91], a[68:71], v[80:83]
s_add_u32 s6, s13, 2883584
buffer_load_dwordx4 a[224:227], v10, s[52:55], s6 offen nt
s_waitcnt lgkmcnt(13)
v_mfma_f32_16x16x32_bf16 v[76:79], v[92:95], a[8:11], v[76:79]
v_mfma_f32_16x16x32_bf16 v[80:83], v[92:95], a[72:75], v[80:83]
s_waitcnt lgkmcnt(12)
v_mfma_f32_16x16x32_bf16 v[76:79], v[96:99], a[12:15], v[76:79]
v_mfma_f32_16x16x32_bf16 v[80:83], v[96:99], a[76:79], v[80:83]
s_add_u32 s6, s13, 2884608
buffer_load_dwordx4 a[228:231], v10, s[52:55], s6 offen nt
s_waitcnt lgkmcnt(11)
v_mfma_f32_16x16x32_bf16 v[76:79], v[100:103], a[16:19], v[76:79]
v_mfma_f32_16x16x32_bf16 v[80:83], v[100:103], a[80:83], v[80:83]
s_waitcnt lgkmcnt(10)
v_mfma_f32_16x16x32_bf16 v[76:79], v[104:107], a[20:23], v[76:79]
v_mfma_f32_16x16x32_bf16 v[80:83], v[104:107], a[84:87], v[80:83]
s_add_u32 s6, s13, 2885632
buffer_load_dwordx4 a[232:235], v10, s[52:55], s6 offen nt
s_waitcnt lgkmcnt(9)
v_mfma_f32_16x16x32_bf16 v[76:79], v[108:111], a[24:27], v[76:79]
v_mfma_f32_16x16x32_bf16 v[80:83], v[108:111], a[88:91], v[80:83]
s_waitcnt lgkmcnt(8)
v_mfma_f32_16x16x32_bf16 v[76:79], v[112:115], a[28:31], v[76:79]
v_mfma_f32_16x16x32_bf16 v[80:83], v[112:115], a[92:95], v[80:83]
s_add_u32 s6, s13, 2886656
buffer_load_dwordx4 a[236:239], v10, s[52:55], s6 offen nt
s_waitcnt lgkmcnt(7)
v_mfma_f32_16x16x32_bf16 v[76:79], v[116:119], a[32:35], v[76:79]
v_mfma_f32_16x16x32_bf16 v[80:83], v[116:119], a[96:99], v[80:83]
s_waitcnt lgkmcnt(6)
v_mfma_f32_16x16x32_bf16 v[76:79], v[120:123], a[36:39], v[76:79]
v_mfma_f32_16x16x32_bf16 v[80:83], v[120:123], a[100:103], v[80:83]
s_add_u32 s6, s13, 3014656
buffer_load_dwordx4 a[240:243], v10, s[52:55], s6 offen nt
s_waitcnt lgkmcnt(5)
v_mfma_f32_16x16x32_bf16 v[76:79], v[124:127], a[40:43], v[76:79]
v_mfma_f32_16x16x32_bf16 v[80:83], v[124:127], a[104:107], v[80:83]
s_waitcnt lgkmcnt(4)
v_mfma_f32_16x16x32_bf16 v[76:79], v[128:131], a[44:47], v[76:79]
v_mfma_f32_16x16x32_bf16 v[80:83], v[128:131], a[108:111], v[80:83]
s_add_u32 s6, s13, 3015680
buffer_load_dwordx4 a[244:247], v10, s[52:55], s6 offen nt
s_waitcnt lgkmcnt(3)
v_mfma_f32_16x16x32_bf16 v[76:79], v[132:135], a[48:51], v[76:79]
v_mfma_f32_16x16x32_bf16 v[80:83], v[132:135], a[112:115], v[80:83]
s_waitcnt lgkmcnt(2)
v_mfma_f32_16x16x32_bf16 v[76:79], v[136:139], a[52:55], v[76:79]
v_mfma_f32_16x16x32_bf16 v[80:83], v[136:139], a[116:119], v[80:83]
s_add_u32 s6, s13, 3016704
buffer_load_dwordx4 a[248:251], v10, s[52:55], s6 offen nt
s_waitcnt lgkmcnt(1)
v_mfma_f32_16x16x32_bf16 v[76:79], v[140:143], a[56:59], v[76:79]
v_mfma_f32_16x16x32_bf16 v[80:83], v[140:143], a[120:123], v[80:83]
s_waitcnt lgkmcnt(0)
v_mfma_f32_16x16x32_bf16 v[76:79], v[144:147], a[60:63], v[76:79]
v_mfma_f32_16x16x32_bf16 v[80:83], v[144:147], a[124:127], v[80:83]
s_add_u32 s6, s13, 3017728
buffer_load_dwordx4 a[252:255], v10, s[52:55], s6 offen nt
s_nop 4
v_max_f32 v190, v76, v77
v_max3_f32 v190, v190, v78, v79
v_mov_b32 v192, v190
s_nop 1
v_permlane16_swap_b32 v190, v192
v_max_f32 v190, v190, v192
v_mov_b32 v192, v190
s_nop 1
v_permlane32_swap_b32 v190, v192
v_max_f32 v190, v190, v192
ds_write_b32 v198, v190 offset:0
v_max_f32 v191, v80, v81
v_max3_f32 v191, v191, v82, v83
v_mov_b32 v192, v191
s_nop 1
v_permlane16_swap_b32 v191, v192
v_max_f32 v191, v191, v192
v_mov_b32 v192, v191
s_nop 1
v_permlane32_swap_b32 v191, v192
v_max_f32 v191, v191, v192
ds_write_b32 v198, v191 offset:256
s_waitcnt lgkmcnt(0)
s_barrier
ds_read_b128 v[164:167], v199
ds_read_b128 v[168:171], v199 offset:256
ds_read_b128 v[172:175], v200
s_waitcnt vmcnt(16)
ds_write_b128 v206, a[128:131] offset:0
ds_write_b128 v206, a[132:135] offset:1088
ds_write_b128 v206, a[136:139] offset:2176
ds_write_b128 v206, a[140:143] offset:3264
ds_write_b128 v206, a[144:147] offset:4352
ds_write_b128 v206, a[148:151] offset:5440
ds_write_b128 v206, a[152:155] offset:6528
ds_write_b128 v206, a[156:159] offset:7616
ds_write_b128 v206, a[160:163] offset:8704
ds_write_b128 v206, a[164:167] offset:9792
ds_write_b128 v206, a[168:171] offset:10880
ds_write_b128 v206, a[172:175] offset:11968
ds_write_b128 v206, a[176:179] offset:13056
ds_write_b128 v206, a[180:183] offset:14144
ds_write_b128 v206, a[184:187] offset:15232
ds_write_b128 v206, a[188:191] offset:16320
s_waitcnt lgkmcnt(15)
v_max_f32 v164, v164, v165
v_max3_f32 v164, v164, v166, v167
v_mul_f32 v164, v164, v185
v_max_f32 v164, v164, v176
v_sub_f32 v182, v176, v164
v_exp_f32 v182, v182
v_mov_b32 v176, v164
v_max_f32 v168, v168, v169
v_max3_f32 v168, v168, v170, v171
v_mul_f32 v168, v168, v185
v_max_f32 v168, v168, v177
v_sub_f32 v183, v177, v168
v_exp_f32 v183, v183
v_mov_b32 v177, v168
v_max_f32 v172, v172, v173
v_max3_f32 v172, v172, v174, v175
v_mul_f32 v172, v172, v185
v_max_f32 v172, v172, v178
v_sub_f32 v184, v178, v172
v_exp_f32 v184, v184
v_mov_b32 v178, v172
v_fma_f32 v76, v76, v185, -v176
v_fma_f32 v77, v77, v185, -v176
v_fma_f32 v78, v78, v185, -v176
v_fma_f32 v79, v79, v185, -v176
v_exp_f32 v76, v76
v_exp_f32 v77, v77
v_exp_f32 v78, v78
v_exp_f32 v79, v79
v_mul_f32 v180, v180, v182
v_cvt_pk_bf16_f32 v186, v76, v77
v_cvt_pk_bf16_f32 v187, v78, v79
ds_write_b64 v201, v[186:187] offset:0
v_add_f32 v180, v180, v76
v_add_f32 v180, v180, v77
v_add_f32 v180, v180, v78
v_add_f32 v180, v180, v79
v_fma_f32 v80, v80, v185, -v177
v_fma_f32 v81, v81, v185, -v177
v_fma_f32 v82, v82, v185, -v177
v_fma_f32 v83, v83, v185, -v177
v_exp_f32 v80, v80
v_exp_f32 v81, v81
v_exp_f32 v82, v82
v_exp_f32 v83, v83
v_mul_f32 v181, v181, v183
v_cvt_pk_bf16_f32 v188, v80, v81
v_cvt_pk_bf16_f32 v189, v82, v83
ds_write_b64 v201, v[188:189] offset:512
v_add_f32 v181, v181, v80
v_add_f32 v181, v181, v81
v_add_f32 v181, v181, v82
v_add_f32 v181, v181, v83
v_mul_f32 v12, v12, v184
v_mul_f32 v13, v13, v184
v_mul_f32 v14, v14, v184
v_mul_f32 v15, v15, v184
v_mul_f32 v16, v16, v184
v_mul_f32 v17, v17, v184
v_mul_f32 v18, v18, v184
v_mul_f32 v19, v19, v184
v_mul_f32 v20, v20, v184
v_mul_f32 v21, v21, v184
v_mul_f32 v22, v22, v184
v_mul_f32 v23, v23, v184
v_mul_f32 v24, v24, v184
v_mul_f32 v25, v25, v184
v_mul_f32 v26, v26, v184
v_mul_f32 v27, v27, v184
v_mul_f32 v28, v28, v184
v_mul_f32 v29, v29, v184
v_mul_f32 v30, v30, v184
v_mul_f32 v31, v31, v184
v_mul_f32 v32, v32, v184
v_mul_f32 v33, v33, v184
v_mul_f32 v34, v34, v184
v_mul_f32 v35, v35, v184
v_mul_f32 v36, v36, v184
v_mul_f32 v37, v37, v184
v_mul_f32 v38, v38, v184
v_mul_f32 v39, v39, v184
v_mul_f32 v40, v40, v184
v_mul_f32 v41, v41, v184
v_mul_f32 v42, v42, v184
v_mul_f32 v43, v43, v184
v_mul_f32 v44, v44, v184
v_mul_f32 v45, v45, v184
v_mul_f32 v46, v46, v184
v_mul_f32 v47, v47, v184
v_mul_f32 v48, v48, v184
v_mul_f32 v49, v49, v184
v_mul_f32 v50, v50, v184
v_mul_f32 v51, v51, v184
v_mul_f32 v52, v52, v184
v_mul_f32 v53, v53, v184
v_mul_f32 v54, v54, v184
v_mul_f32 v55, v55, v184
v_mul_f32 v56, v56, v184
v_mul_f32 v57, v57, v184
v_mul_f32 v58, v58, v184
v_mul_f32 v59, v59, v184
v_mul_f32 v60, v60, v184
v_mul_f32 v61, v61, v184
v_mul_f32 v62, v62, v184
v_mul_f32 v63, v63, v184
v_mul_f32 v64, v64, v184
v_mul_f32 v65, v65, v184
v_mul_f32 v66, v66, v184
v_mul_f32 v67, v67, v184
v_mul_f32 v68, v68, v184
v_mul_f32 v69, v69, v184
v_mul_f32 v70, v70, v184
v_mul_f32 v71, v71, v184
v_mul_f32 v72, v72, v184
v_mul_f32 v73, v73, v184
v_mul_f32 v74, v74, v184
v_mul_f32 v75, v75, v184
s_waitcnt lgkmcnt(0)
s_barrier
ds_read_b128 v[148:151], v202 offset:0
ds_read_b128 v[152:155], v202 offset:1024
ds_read_b128 v[156:159], v202 offset:2048
ds_read_b128 v[160:163], v202 offset:3072
ds_read_b64_tr_b16 v[84:85], v197 offset:0
ds_read_b64_tr_b16 v[86:87], v197 offset:4352
ds_read_b64_tr_b16 v[88:89], v197 offset:64
ds_read_b64_tr_b16 v[90:91], v197 offset:4416
ds_read_b64_tr_b16 v[92:93], v197 offset:128
ds_read_b64_tr_b16 v[94:95], v197 offset:4480
ds_read_b64_tr_b16 v[96:97], v197 offset:192
ds_read_b64_tr_b16 v[98:99], v197 offset:4544
ds_read_b64_tr_b16 v[100:101], v197 offset:17408
ds_read_b64_tr_b16 v[102:103], v197 offset:21760
ds_read_b64_tr_b16 v[104:105], v197 offset:17472
ds_read_b64_tr_b16 v[106:107], v197 offset:21824
ds_read_b64_tr_b16 v[108:109], v197 offset:17536
ds_read_b64_tr_b16 v[110:111], v197 offset:21888
ds_read_b64_tr_b16 v[112:113], v197 offset:17600
ds_read_b64_tr_b16 v[114:115], v197 offset:21952
ds_read_b64_tr_b16 v[116:117], v197 offset:34816
ds_read_b64_tr_b16 v[118:119], v197 offset:39168
ds_read_b64_tr_b16 v[120:121], v197 offset:34880
ds_read_b64_tr_b16 v[122:123], v197 offset:39232
ds_read_b64_tr_b16 v[124:125], v197 offset:34944
ds_read_b64_tr_b16 v[126:127], v197 offset:39296
ds_read_b64_tr_b16 v[128:129], v197 offset:35008
ds_read_b64_tr_b16 v[130:131], v197 offset:39360
ds_read_b64_tr_b16 v[132:133], v197 offset:52224
ds_read_b64_tr_b16 v[134:135], v197 offset:56576
ds_read_b64_tr_b16 v[136:137], v197 offset:52288
ds_read_b64_tr_b16 v[138:139], v197 offset:56640
ds_read_b64_tr_b16 v[140:141], v197 offset:52352
ds_read_b64_tr_b16 v[142:143], v197 offset:56704
ds_read_b64_tr_b16 v[144:145], v197 offset:52416
ds_read_b64_tr_b16 v[146:147], v197 offset:56768
s_waitcnt lgkmcnt(15)
v_mfma_f32_32x32x16_bf16 v[12:27], v[84:87], v[148:151], v[12:27]
v_mfma_f32_32x32x16_bf16 v[28:43], v[88:91], v[148:151], v[28:43]
s_add_u32 s6, s13, 3145728
buffer_load_dwordx4 a[128:131], v2, s[52:55], s6 offen nt
v_mfma_f32_32x32x16_bf16 v[44:59], v[92:95], v[148:151], v[44:59]
v_mfma_f32_32x32x16_bf16 v[60:75], v[96:99], v[148:151], v[60:75]
s_add_u32 s6, s13, 3146752
buffer_load_dwordx4 a[132:135], v2, s[52:55], s6 offen nt
s_waitcnt lgkmcnt(15)
v_mfma_f32_32x32x16_bf16 v[12:27], v[100:103], v[152:155], v[12:27]
v_mfma_f32_32x32x16_bf16 v[28:43], v[104:107], v[152:155], v[28:43]
s_add_u32 s6, s13, 3147776
buffer_load_dwordx4 a[136:139], v2, s[52:55], s6 offen nt
v_mfma_f32_32x32x16_bf16 v[44:59], v[108:111], v[152:155], v[44:59]
v_mfma_f32_32x32x16_bf16 v[60:75], v[112:115], v[152:155], v[60:75]
s_add_u32 s6, s13, 3148800
buffer_load_dwordx4 a[140:143], v2, s[52:55], s6 offen nt
s_waitcnt lgkmcnt(8)
v_mfma_f32_32x32x16_bf16 v[12:27], v[116:119], v[156:159], v[12:27]
v_mfma_f32_32x32x16_bf16 v[28:43], v[120:123], v[156:159], v[28:43]
s_add_u32 s6, s13, 3276800
buffer_load_dwordx4 a[144:147], v2, s[52:55], s6 offen nt
v_mfma_f32_32x32x16_bf16 v[44:59], v[124:127], v[156:159], v[44:59]
v_mfma_f32_32x32x16_bf16 v[60:75], v[128:131], v[156:159], v[60:75]
s_add_u32 s6, s13, 3277824
buffer_load_dwordx4 a[148:151], v2, s[52:55], s6 offen nt
s_waitcnt lgkmcnt(0)
v_mfma_f32_32x32x16_bf16 v[12:27], v[132:135], v[160:163], v[12:27]
v_mfma_f32_32x32x16_bf16 v[28:43], v[136:139], v[160:163], v[28:43]
s_add_u32 s6, s13, 3278848
buffer_load_dwordx4 a[152:155], v2, s[52:55], s6 offen nt
v_mfma_f32_32x32x16_bf16 v[44:59], v[140:143], v[160:163], v[44:59]
v_mfma_f32_32x32x16_bf16 v[60:75], v[144:147], v[160:163], v[60:75]
s_add_u32 s6, s13, 3279872
buffer_load_dwordx4 a[156:159], v2, s[52:55], s6 offen nt
ds_read_b128 v[84:87], v194 offset:0
ds_read_b128 v[88:91], v194 offset:64
ds_read_b128 v[92:95], v194 offset:128
ds_read_b128 v[96:99], v194 offset:192
ds_read_b128 v[100:103], v194 offset:256
ds_read_b128 v[104:107], v194 offset:320
ds_read_b128 v[108:111], v194 offset:384
ds_read_b128 v[112:115], v194 offset:448
ds_read_b128 v[116:119], v194 offset:512
ds_read_b128 v[120:123], v194 offset:576
ds_read_b128 v[124:127], v194 offset:640
ds_read_b128 v[128:131], v194 offset:704
ds_read_b128 v[132:135], v194 offset:768
ds_read_b128 v[136:139], v194 offset:832
ds_read_b128 v[140:143], v194 offset:896
ds_read_b128 v[144:147], v194 offset:960
s_waitcnt lgkmcnt(15)
v_mfma_f32_16x16x32_bf16 v[76:79], v[84:87], a[0:3], 0
v_mfma_f32_16x16x32_bf16 v[80:83], v[84:87], a[64:67], 0
s_waitcnt lgkmcnt(14)
v_mfma_f32_16x16x32_bf16 v[76:79], v[88:91], a[4:7], v[76:79]
v_mfma_f32_16x16x32_bf16 v[80:83], v[88:91], a[68:71], v[80:83]
s_add_u32 s6, s13, 3407872
buffer_load_dwordx4 a[160:163], v10, s[52:55], s6 offen nt
s_waitcnt lgkmcnt(13)
v_mfma_f32_16x16x32_bf16 v[76:79], v[92:95], a[8:11], v[76:79]
v_mfma_f32_16x16x32_bf16 v[80:83], v[92:95], a[72:75], v[80:83]
s_waitcnt lgkmcnt(12)
v_mfma_f32_16x16x32_bf16 v[76:79], v[96:99], a[12:15], v[76:79]
v_mfma_f32_16x16x32_bf16 v[80:83], v[96:99], a[76:79], v[80:83]
s_add_u32 s6, s13, 3408896
buffer_load_dwordx4 a[164:167], v10, s[52:55], s6 offen nt
s_waitcnt lgkmcnt(11)
v_mfma_f32_16x16x32_bf16 v[76:79], v[100:103], a[16:19], v[76:79]
v_mfma_f32_16x16x32_bf16 v[80:83], v[100:103], a[80:83], v[80:83]
s_waitcnt lgkmcnt(10)
v_mfma_f32_16x16x32_bf16 v[76:79], v[104:107], a[20:23], v[76:79]
v_mfma_f32_16x16x32_bf16 v[80:83], v[104:107], a[84:87], v[80:83]
s_add_u32 s6, s13, 3409920
buffer_load_dwordx4 a[168:171], v10, s[52:55], s6 offen nt
s_waitcnt lgkmcnt(9)
v_mfma_f32_16x16x32_bf16 v[76:79], v[108:111], a[24:27], v[76:79]
v_mfma_f32_16x16x32_bf16 v[80:83], v[108:111], a[88:91], v[80:83]
s_waitcnt lgkmcnt(8)
v_mfma_f32_16x16x32_bf16 v[76:79], v[112:115], a[28:31], v[76:79]
v_mfma_f32_16x16x32_bf16 v[80:83], v[112:115], a[92:95], v[80:83]
s_add_u32 s6, s13, 3410944
buffer_load_dwordx4 a[172:175], v10, s[52:55], s6 offen nt
s_waitcnt lgkmcnt(7)
v_mfma_f32_16x16x32_bf16 v[76:79], v[116:119], a[32:35], v[76:79]
v_mfma_f32_16x16x32_bf16 v[80:83], v[116:119], a[96:99], v[80:83]
s_waitcnt lgkmcnt(6)
v_mfma_f32_16x16x32_bf16 v[76:79], v[120:123], a[36:39], v[76:79]
v_mfma_f32_16x16x32_bf16 v[80:83], v[120:123], a[100:103], v[80:83]
s_add_u32 s6, s13, 3538944
buffer_load_dwordx4 a[176:179], v10, s[52:55], s6 offen nt
s_waitcnt lgkmcnt(5)
v_mfma_f32_16x16x32_bf16 v[76:79], v[124:127], a[40:43], v[76:79]
v_mfma_f32_16x16x32_bf16 v[80:83], v[124:127], a[104:107], v[80:83]
s_waitcnt lgkmcnt(4)
v_mfma_f32_16x16x32_bf16 v[76:79], v[128:131], a[44:47], v[76:79]
v_mfma_f32_16x16x32_bf16 v[80:83], v[128:131], a[108:111], v[80:83]
s_add_u32 s6, s13, 3539968
buffer_load_dwordx4 a[180:183], v10, s[52:55], s6 offen nt
s_waitcnt lgkmcnt(3)
v_mfma_f32_16x16x32_bf16 v[76:79], v[132:135], a[48:51], v[76:79]
v_mfma_f32_16x16x32_bf16 v[80:83], v[132:135], a[112:115], v[80:83]
s_waitcnt lgkmcnt(2)
v_mfma_f32_16x16x32_bf16 v[76:79], v[136:139], a[52:55], v[76:79]
v_mfma_f32_16x16x32_bf16 v[80:83], v[136:139], a[116:119], v[80:83]
s_add_u32 s6, s13, 3540992
buffer_load_dwordx4 a[184:187], v10, s[52:55], s6 offen nt
s_waitcnt lgkmcnt(1)
v_mfma_f32_16x16x32_bf16 v[76:79], v[140:143], a[56:59], v[76:79]
v_mfma_f32_16x16x32_bf16 v[80:83], v[140:143], a[120:123], v[80:83]
s_waitcnt lgkmcnt(0)
v_mfma_f32_16x16x32_bf16 v[76:79], v[144:147], a[60:63], v[76:79]
v_mfma_f32_16x16x32_bf16 v[80:83], v[144:147], a[124:127], v[80:83]
s_add_u32 s6, s13, 3542016
buffer_load_dwordx4 a[188:191], v10, s[52:55], s6 offen nt
s_nop 4
v_max_f32 v190, v76, v77
v_max3_f32 v190, v190, v78, v79
v_mov_b32 v192, v190
s_nop 1
v_permlane16_swap_b32 v190, v192
v_max_f32 v190, v190, v192
v_mov_b32 v192, v190
s_nop 1
v_permlane32_swap_b32 v190, v192
v_max_f32 v190, v190, v192
ds_write_b32 v198, v190 offset:0
v_max_f32 v191, v80, v81
v_max3_f32 v191, v191, v82, v83
v_mov_b32 v192, v191
s_nop 1
v_permlane16_swap_b32 v191, v192
v_max_f32 v191, v191, v192
v_mov_b32 v192, v191
s_nop 1
v_permlane32_swap_b32 v191, v192
v_max_f32 v191, v191, v192
ds_write_b32 v198, v191 offset:256
s_waitcnt lgkmcnt(0)
s_barrier
ds_read_b128 v[164:167], v199
ds_read_b128 v[168:171], v199 offset:256
ds_read_b128 v[172:175], v200
s_waitcnt vmcnt(16)
ds_write_b128 v207, a[192:195] offset:0
ds_write_b128 v207, a[196:199] offset:1088
ds_write_b128 v207, a[200:203] offset:2176
ds_write_b128 v207, a[204:207] offset:3264
ds_write_b128 v207, a[208:211] offset:4352
ds_write_b128 v207, a[212:215] offset:5440
ds_write_b128 v207, a[216:219] offset:6528
ds_write_b128 v207, a[220:223] offset:7616
ds_write_b128 v207, a[224:227] offset:8704
ds_write_b128 v207, a[228:231] offset:9792
ds_write_b128 v207, a[232:235] offset:10880
ds_write_b128 v207, a[236:239] offset:11968
ds_write_b128 v207, a[240:243] offset:13056
ds_write_b128 v207, a[244:247] offset:14144
ds_write_b128 v207, a[248:251] offset:15232
ds_write_b128 v207, a[252:255] offset:16320
s_waitcnt lgkmcnt(15)
v_max_f32 v164, v164, v165
v_max3_f32 v164, v164, v166, v167
v_mul_f32 v164, v164, v185
v_max_f32 v164, v164, v176
v_sub_f32 v182, v176, v164
v_exp_f32 v182, v182
v_mov_b32 v176, v164
v_max_f32 v168, v168, v169
v_max3_f32 v168, v168, v170, v171
v_mul_f32 v168, v168, v185
v_max_f32 v168, v168, v177
v_sub_f32 v183, v177, v168
v_exp_f32 v183, v183
v_mov_b32 v177, v168
v_max_f32 v172, v172, v173
v_max3_f32 v172, v172, v174, v175
v_mul_f32 v172, v172, v185
v_max_f32 v172, v172, v178
v_sub_f32 v184, v178, v172
v_exp_f32 v184, v184
v_mov_b32 v178, v172
v_fma_f32 v76, v76, v185, -v176
v_fma_f32 v77, v77, v185, -v176
v_fma_f32 v78, v78, v185, -v176
v_fma_f32 v79, v79, v185, -v176
v_exp_f32 v76, v76
v_exp_f32 v77, v77
v_exp_f32 v78, v78
v_exp_f32 v79, v79
v_mul_f32 v180, v180, v182
v_cvt_pk_bf16_f32 v186, v76, v77
v_cvt_pk_bf16_f32 v187, v78, v79
ds_write_b64 v201, v[186:187] offset:0
v_add_f32 v180, v180, v76
v_add_f32 v180, v180, v77
v_add_f32 v180, v180, v78
v_add_f32 v180, v180, v79
v_fma_f32 v80, v80, v185, -v177
v_fma_f32 v81, v81, v185, -v177
v_fma_f32 v82, v82, v185, -v177
v_fma_f32 v83, v83, v185, -v177
v_exp_f32 v80, v80
v_exp_f32 v81, v81
v_exp_f32 v82, v82
v_exp_f32 v83, v83
v_mul_f32 v181, v181, v183
v_cvt_pk_bf16_f32 v188, v80, v81
v_cvt_pk_bf16_f32 v189, v82, v83
ds_write_b64 v201, v[188:189] offset:512
v_add_f32 v181, v181, v80
v_add_f32 v181, v181, v81
v_add_f32 v181, v181, v82
v_add_f32 v181, v181, v83
v_mul_f32 v12, v12, v184
v_mul_f32 v13, v13, v184
v_mul_f32 v14, v14, v184
v_mul_f32 v15, v15, v184
v_mul_f32 v16, v16, v184
v_mul_f32 v17, v17, v184
v_mul_f32 v18, v18, v184
v_mul_f32 v19, v19, v184
v_mul_f32 v20, v20, v184
v_mul_f32 v21, v21, v184
v_mul_f32 v22, v22, v184
v_mul_f32 v23, v23, v184
v_mul_f32 v24, v24, v184
v_mul_f32 v25, v25, v184
v_mul_f32 v26, v26, v184
v_mul_f32 v27, v27, v184
v_mul_f32 v28, v28, v184
v_mul_f32 v29, v29, v184
v_mul_f32 v30, v30, v184
v_mul_f32 v31, v31, v184
v_mul_f32 v32, v32, v184
v_mul_f32 v33, v33, v184
v_mul_f32 v34, v34, v184
v_mul_f32 v35, v35, v184
v_mul_f32 v36, v36, v184
v_mul_f32 v37, v37, v184
v_mul_f32 v38, v38, v184
v_mul_f32 v39, v39, v184
v_mul_f32 v40, v40, v184
v_mul_f32 v41, v41, v184
v_mul_f32 v42, v42, v184
v_mul_f32 v43, v43, v184
v_mul_f32 v44, v44, v184
v_mul_f32 v45, v45, v184
v_mul_f32 v46, v46, v184
v_mul_f32 v47, v47, v184
v_mul_f32 v48, v48, v184
v_mul_f32 v49, v49, v184
v_mul_f32 v50, v50, v184
v_mul_f32 v51, v51, v184
v_mul_f32 v52, v52, v184
v_mul_f32 v53, v53, v184
v_mul_f32 v54, v54, v184
v_mul_f32 v55, v55, v184
v_mul_f32 v56, v56, v184
v_mul_f32 v57, v57, v184
v_mul_f32 v58, v58, v184
v_mul_f32 v59, v59, v184
v_mul_f32 v60, v60, v184
v_mul_f32 v61, v61, v184
v_mul_f32 v62, v62, v184
v_mul_f32 v63, v63, v184
v_mul_f32 v64, v64, v184
v_mul_f32 v65, v65, v184
v_mul_f32 v66, v66, v184
v_mul_f32 v67, v67, v184
v_mul_f32 v68, v68, v184
v_mul_f32 v69, v69, v184
v_mul_f32 v70, v70, v184
v_mul_f32 v71, v71, v184
v_mul_f32 v72, v72, v184
v_mul_f32 v73, v73, v184
v_mul_f32 v74, v74, v184
v_mul_f32 v75, v75, v184
s_waitcnt lgkmcnt(0)
s_barrier
ds_read_b128 v[148:151], v202 offset:0
ds_read_b128 v[152:155], v202 offset:1024
ds_read_b128 v[156:159], v202 offset:2048
ds_read_b128 v[160:163], v202 offset:3072
ds_read_b64_tr_b16 v[84:85], v196 offset:0
ds_read_b64_tr_b16 v[86:87], v196 offset:4352
ds_read_b64_tr_b16 v[88:89], v196 offset:64
ds_read_b64_tr_b16 v[90:91], v196 offset:4416
ds_read_b64_tr_b16 v[92:93], v196 offset:128
ds_read_b64_tr_b16 v[94:95], v196 offset:4480
ds_read_b64_tr_b16 v[96:97], v196 offset:192
ds_read_b64_tr_b16 v[98:99], v196 offset:4544
ds_read_b64_tr_b16 v[100:101], v196 offset:17408
ds_read_b64_tr_b16 v[102:103], v196 offset:21760
ds_read_b64_tr_b16 v[104:105], v196 offset:17472
ds_read_b64_tr_b16 v[106:107], v196 offset:21824
ds_read_b64_tr_b16 v[108:109], v196 offset:17536
ds_read_b64_tr_b16 v[110:111], v196 offset:21888
ds_read_b64_tr_b16 v[112:113], v196 offset:17600
ds_read_b64_tr_b16 v[114:115], v196 offset:21952
ds_read_b64_tr_b16 v[116:117], v196 offset:34816
ds_read_b64_tr_b16 v[118:119], v196 offset:39168
ds_read_b64_tr_b16 v[120:121], v196 offset:34880
ds_read_b64_tr_b16 v[122:123], v196 offset:39232
ds_read_b64_tr_b16 v[124:125], v196 offset:34944
ds_read_b64_tr_b16 v[126:127], v196 offset:39296
ds_read_b64_tr_b16 v[128:129], v196 offset:35008
ds_read_b64_tr_b16 v[130:131], v196 offset:39360
ds_read_b64_tr_b16 v[132:133], v196 offset:52224
ds_read_b64_tr_b16 v[134:135], v196 offset:56576
ds_read_b64_tr_b16 v[136:137], v196 offset:52288
ds_read_b64_tr_b16 v[138:139], v196 offset:56640
ds_read_b64_tr_b16 v[140:141], v196 offset:52352
ds_read_b64_tr_b16 v[142:143], v196 offset:56704
ds_read_b64_tr_b16 v[144:145], v196 offset:52416
ds_read_b64_tr_b16 v[146:147], v196 offset:56768
s_waitcnt lgkmcnt(15)
v_mfma_f32_32x32x16_bf16 v[12:27], v[84:87], v[148:151], v[12:27]
v_mfma_f32_32x32x16_bf16 v[28:43], v[88:91], v[148:151], v[28:43]
s_add_u32 s6, s13, 3670016
buffer_load_dwordx4 a[192:195], v2, s[52:55], s6 offen nt
v_mfma_f32_32x32x16_bf16 v[44:59], v[92:95], v[148:151], v[44:59]
v_mfma_f32_32x32x16_bf16 v[60:75], v[96:99], v[148:151], v[60:75]
s_add_u32 s6, s13, 3671040
buffer_load_dwordx4 a[196:199], v2, s[52:55], s6 offen nt
s_waitcnt lgkmcnt(15)
v_mfma_f32_32x32x16_bf16 v[12:27], v[100:103], v[152:155], v[12:27]
v_mfma_f32_32x32x16_bf16 v[28:43], v[104:107], v[152:155], v[28:43]
s_add_u32 s6, s13, 3672064
buffer_load_dwordx4 a[200:203], v2, s[52:55], s6 offen nt
v_mfma_f32_32x32x16_bf16 v[44:59], v[108:111], v[152:155], v[44:59]
v_mfma_f32_32x32x16_bf16 v[60:75], v[112:115], v[152:155], v[60:75]
s_add_u32 s6, s13, 3673088
buffer_load_dwordx4 a[204:207], v2, s[52:55], s6 offen nt
s_waitcnt lgkmcnt(8)
v_mfma_f32_32x32x16_bf16 v[12:27], v[116:119], v[156:159], v[12:27]
v_mfma_f32_32x32x16_bf16 v[28:43], v[120:123], v[156:159], v[28:43]
s_add_u32 s6, s13, 3801088
buffer_load_dwordx4 a[208:211], v2, s[52:55], s6 offen nt
v_mfma_f32_32x32x16_bf16 v[44:59], v[124:127], v[156:159], v[44:59]
v_mfma_f32_32x32x16_bf16 v[60:75], v[128:131], v[156:159], v[60:75]
s_add_u32 s6, s13, 3802112
buffer_load_dwordx4 a[212:215], v2, s[52:55], s6 offen nt
s_waitcnt lgkmcnt(0)
v_mfma_f32_32x32x16_bf16 v[12:27], v[132:135], v[160:163], v[12:27]
v_mfma_f32_32x32x16_bf16 v[28:43], v[136:139], v[160:163], v[28:43]
s_add_u32 s6, s13, 3803136
buffer_load_dwordx4 a[216:219], v2, s[52:55], s6 offen nt
v_mfma_f32_32x32x16_bf16 v[44:59], v[140:143], v[160:163], v[44:59]
v_mfma_f32_32x32x16_bf16 v[60:75], v[144:147], v[160:163], v[60:75]
s_add_u32 s6, s13, 3804160
buffer_load_dwordx4 a[220:223], v2, s[52:55], s6 offen nt
ds_read_b128 v[84:87], v195 offset:0
ds_read_b128 v[88:91], v195 offset:64
ds_read_b128 v[92:95], v195 offset:128
ds_read_b128 v[96:99], v195 offset:192
ds_read_b128 v[100:103], v195 offset:256
ds_read_b128 v[104:107], v195 offset:320
ds_read_b128 v[108:111], v195 offset:384
ds_read_b128 v[112:115], v195 offset:448
ds_read_b128 v[116:119], v195 offset:512
ds_read_b128 v[120:123], v195 offset:576
ds_read_b128 v[124:127], v195 offset:640
ds_read_b128 v[128:131], v195 offset:704
ds_read_b128 v[132:135], v195 offset:768
ds_read_b128 v[136:139], v195 offset:832
ds_read_b128 v[140:143], v195 offset:896
ds_read_b128 v[144:147], v195 offset:960
s_waitcnt lgkmcnt(15)
v_mfma_f32_16x16x32_bf16 v[76:79], v[84:87], a[0:3], 0
v_mfma_f32_16x16x32_bf16 v[80:83], v[84:87], a[64:67], 0
s_waitcnt lgkmcnt(14)
v_mfma_f32_16x16x32_bf16 v[76:79], v[88:91], a[4:7], v[76:79]
v_mfma_f32_16x16x32_bf16 v[80:83], v[88:91], a[68:71], v[80:83]
s_add_u32 s6, s13, 3932160
buffer_load_dwordx4 a[224:227], v10, s[52:55], s6 offen nt
s_waitcnt lgkmcnt(13)
v_mfma_f32_16x16x32_bf16 v[76:79], v[92:95], a[8:11], v[76:79]
v_mfma_f32_16x16x32_bf16 v[80:83], v[92:95], a[72:75], v[80:83]
s_waitcnt lgkmcnt(12)
v_mfma_f32_16x16x32_bf16 v[76:79], v[96:99], a[12:15], v[76:79]
v_mfma_f32_16x16x32_bf16 v[80:83], v[96:99], a[76:79], v[80:83]
s_add_u32 s6, s13, 3933184
buffer_load_dwordx4 a[228:231], v10, s[52:55], s6 offen nt
s_waitcnt lgkmcnt(11)
v_mfma_f32_16x16x32_bf16 v[76:79], v[100:103], a[16:19], v[76:79]
v_mfma_f32_16x16x32_bf16 v[80:83], v[100:103], a[80:83], v[80:83]
s_waitcnt lgkmcnt(10)
v_mfma_f32_16x16x32_bf16 v[76:79], v[104:107], a[20:23], v[76:79]
v_mfma_f32_16x16x32_bf16 v[80:83], v[104:107], a[84:87], v[80:83]
s_add_u32 s6, s13, 3934208
buffer_load_dwordx4 a[232:235], v10, s[52:55], s6 offen nt
s_waitcnt lgkmcnt(9)
v_mfma_f32_16x16x32_bf16 v[76:79], v[108:111], a[24:27], v[76:79]
v_mfma_f32_16x16x32_bf16 v[80:83], v[108:111], a[88:91], v[80:83]
s_waitcnt lgkmcnt(8)
v_mfma_f32_16x16x32_bf16 v[76:79], v[112:115], a[28:31], v[76:79]
v_mfma_f32_16x16x32_bf16 v[80:83], v[112:115], a[92:95], v[80:83]
s_add_u32 s6, s13, 3935232
buffer_load_dwordx4 a[236:239], v10, s[52:55], s6 offen nt
s_waitcnt lgkmcnt(7)
v_mfma_f32_16x16x32_bf16 v[76:79], v[116:119], a[32:35], v[76:79]
v_mfma_f32_16x16x32_bf16 v[80:83], v[116:119], a[96:99], v[80:83]
s_waitcnt lgkmcnt(6)
v_mfma_f32_16x16x32_bf16 v[76:79], v[120:123], a[36:39], v[76:79]
v_mfma_f32_16x16x32_bf16 v[80:83], v[120:123], a[100:103], v[80:83]
s_add_u32 s6, s13, 4063232
buffer_load_dwordx4 a[240:243], v10, s[52:55], s6 offen nt
s_waitcnt lgkmcnt(5)
v_mfma_f32_16x16x32_bf16 v[76:79], v[124:127], a[40:43], v[76:79]
v_mfma_f32_16x16x32_bf16 v[80:83], v[124:127], a[104:107], v[80:83]
s_waitcnt lgkmcnt(4)
v_mfma_f32_16x16x32_bf16 v[76:79], v[128:131], a[44:47], v[76:79]
v_mfma_f32_16x16x32_bf16 v[80:83], v[128:131], a[108:111], v[80:83]
s_add_u32 s6, s13, 4064256
buffer_load_dwordx4 a[244:247], v10, s[52:55], s6 offen nt
s_waitcnt lgkmcnt(3)
v_mfma_f32_16x16x32_bf16 v[76:79], v[132:135], a[48:51], v[76:79]
v_mfma_f32_16x16x32_bf16 v[80:83], v[132:135], a[112:115], v[80:83]
s_waitcnt lgkmcnt(2)
v_mfma_f32_16x16x32_bf16 v[76:79], v[136:139], a[52:55], v[76:79]
v_mfma_f32_16x16x32_bf16 v[80:83], v[136:139], a[116:119], v[80:83]
s_add_u32 s6, s13, 4065280
buffer_load_dwordx4 a[248:251], v10, s[52:55], s6 offen nt
s_waitcnt lgkmcnt(1)
v_mfma_f32_16x16x32_bf16 v[76:79], v[140:143], a[56:59], v[76:79]
v_mfma_f32_16x16x32_bf16 v[80:83], v[140:143], a[120:123], v[80:83]
s_waitcnt lgkmcnt(0)
v_mfma_f32_16x16x32_bf16 v[76:79], v[144:147], a[60:63], v[76:79]
v_mfma_f32_16x16x32_bf16 v[80:83], v[144:147], a[124:127], v[80:83]
s_add_u32 s6, s13, 4066304
buffer_load_dwordx4 a[252:255], v10, s[52:55], s6 offen nt
s_nop 4
v_max_f32 v190, v76, v77
v_max3_f32 v190, v190, v78, v79
v_mov_b32 v192, v190
s_nop 1
v_permlane16_swap_b32 v190, v192
v_max_f32 v190, v190, v192
v_mov_b32 v192, v190
s_nop 1
v_permlane32_swap_b32 v190, v192
v_max_f32 v190, v190, v192
ds_write_b32 v198, v190 offset:0
v_max_f32 v191, v80, v81
v_max3_f32 v191, v191, v82, v83
v_mov_b32 v192, v191
s_nop 1
v_permlane16_swap_b32 v191, v192
v_max_f32 v191, v191, v192
v_mov_b32 v192, v191
s_nop 1
v_permlane32_swap_b32 v191, v192
v_max_f32 v191, v191, v192
ds_write_b32 v198, v191 offset:256
s_waitcnt lgkmcnt(0)
s_barrier
ds_read_b128 v[164:167], v199
ds_read_b128 v[168:171], v199 offset:256
ds_read_b128 v[172:175], v200
s_waitcnt vmcnt(16)
ds_write_b128 v206, a[128:131] offset:0
ds_write_b128 v206, a[132:135] offset:1088
ds_write_b128 v206, a[136:139] offset:2176
ds_write_b128 v206, a[140:143] offset:3264
ds_write_b128 v206, a[144:147] offset:4352
ds_write_b128 v206, a[148:151] offset:5440
ds_write_b128 v206, a[152:155] offset:6528
ds_write_b128 v206, a[156:159] offset:7616
ds_write_b128 v206, a[160:163] offset:8704
ds_write_b128 v206, a[164:167] offset:9792
ds_write_b128 v206, a[168:171] offset:10880
ds_write_b128 v206, a[172:175] offset:11968
ds_write_b128 v206, a[176:179] offset:13056
ds_write_b128 v206, a[180:183] offset:14144
ds_write_b128 v206, a[184:187] offset:15232
ds_write_b128 v206, a[188:191] offset:16320
s_waitcnt lgkmcnt(15)
v_max_f32 v164, v164, v165
v_max3_f32 v164, v164, v166, v167
v_mul_f32 v164, v164, v185
v_max_f32 v164, v164, v176
v_sub_f32 v182, v176, v164
v_exp_f32 v182, v182
v_mov_b32 v176, v164
v_max_f32 v168, v168, v169
v_max3_f32 v168, v168, v170, v171
v_mul_f32 v168, v168, v185
v_max_f32 v168, v168, v177
v_sub_f32 v183, v177, v168
v_exp_f32 v183, v183
v_mov_b32 v177, v168
v_max_f32 v172, v172, v173
v_max3_f32 v172, v172, v174, v175
v_mul_f32 v172, v172, v185
v_max_f32 v172, v172, v178
v_sub_f32 v184, v178, v172
v_exp_f32 v184, v184
v_mov_b32 v178, v172
v_fma_f32 v76, v76, v185, -v176
v_fma_f32 v77, v77, v185, -v176
v_fma_f32 v78, v78, v185, -v176
v_fma_f32 v79, v79, v185, -v176
v_exp_f32 v76, v76
v_exp_f32 v77, v77
v_exp_f32 v78, v78
v_exp_f32 v79, v79
v_mul_f32 v180, v180, v182
v_cvt_pk_bf16_f32 v186, v76, v77
v_cvt_pk_bf16_f32 v187, v78, v79
ds_write_b64 v201, v[186:187] offset:0
v_add_f32 v180, v180, v76
v_add_f32 v180, v180, v77
v_add_f32 v180, v180, v78
v_add_f32 v180, v180, v79
v_fma_f32 v80, v80, v185, -v177
v_fma_f32 v81, v81, v185, -v177
v_fma_f32 v82, v82, v185, -v177
v_fma_f32 v83, v83, v185, -v177
v_exp_f32 v80, v80
v_exp_f32 v81, v81
v_exp_f32 v82, v82
v_exp_f32 v83, v83
v_mul_f32 v181, v181, v183
v_cvt_pk_bf16_f32 v188, v80, v81
v_cvt_pk_bf16_f32 v189, v82, v83
ds_write_b64 v201, v[188:189] offset:512
v_add_f32 v181, v181, v80
v_add_f32 v181, v181, v81
v_add_f32 v181, v181, v82
v_add_f32 v181, v181, v83
v_mul_f32 v12, v12, v184
v_mul_f32 v13, v13, v184
v_mul_f32 v14, v14, v184
v_mul_f32 v15, v15, v184
v_mul_f32 v16, v16, v184
v_mul_f32 v17, v17, v184
v_mul_f32 v18, v18, v184
v_mul_f32 v19, v19, v184
v_mul_f32 v20, v20, v184
v_mul_f32 v21, v21, v184
v_mul_f32 v22, v22, v184
v_mul_f32 v23, v23, v184
v_mul_f32 v24, v24, v184
v_mul_f32 v25, v25, v184
v_mul_f32 v26, v26, v184
v_mul_f32 v27, v27, v184
v_mul_f32 v28, v28, v184
v_mul_f32 v29, v29, v184
v_mul_f32 v30, v30, v184
v_mul_f32 v31, v31, v184
v_mul_f32 v32, v32, v184
v_mul_f32 v33, v33, v184
v_mul_f32 v34, v34, v184
v_mul_f32 v35, v35, v184
v_mul_f32 v36, v36, v184
v_mul_f32 v37, v37, v184
v_mul_f32 v38, v38, v184
v_mul_f32 v39, v39, v184
v_mul_f32 v40, v40, v184
v_mul_f32 v41, v41, v184
v_mul_f32 v42, v42, v184
v_mul_f32 v43, v43, v184
v_mul_f32 v44, v44, v184
v_mul_f32 v45, v45, v184
v_mul_f32 v46, v46, v184
v_mul_f32 v47, v47, v184
v_mul_f32 v48, v48, v184
v_mul_f32 v49, v49, v184
v_mul_f32 v50, v50, v184
v_mul_f32 v51, v51, v184
v_mul_f32 v52, v52, v184
v_mul_f32 v53, v53, v184
v_mul_f32 v54, v54, v184
v_mul_f32 v55, v55, v184
v_mul_f32 v56, v56, v184
v_mul_f32 v57, v57, v184
v_mul_f32 v58, v58, v184
v_mul_f32 v59, v59, v184
v_mul_f32 v60, v60, v184
v_mul_f32 v61, v61, v184
v_mul_f32 v62, v62, v184
v_mul_f32 v63, v63, v184
v_mul_f32 v64, v64, v184
v_mul_f32 v65, v65, v184
v_mul_f32 v66, v66, v184
v_mul_f32 v67, v67, v184
v_mul_f32 v68, v68, v184
v_mul_f32 v69, v69, v184
v_mul_f32 v70, v70, v184
v_mul_f32 v71, v71, v184
v_mul_f32 v72, v72, v184
v_mul_f32 v73, v73, v184
v_mul_f32 v74, v74, v184
v_mul_f32 v75, v75, v184
s_waitcnt lgkmcnt(0)
s_barrier
ds_read_b128 v[148:151], v202 offset:0
ds_read_b128 v[152:155], v202 offset:1024
ds_read_b128 v[156:159], v202 offset:2048
ds_read_b128 v[160:163], v202 offset:3072
ds_read_b64_tr_b16 v[84:85], v197 offset:0
ds_read_b64_tr_b16 v[86:87], v197 offset:4352
ds_read_b64_tr_b16 v[88:89], v197 offset:64
ds_read_b64_tr_b16 v[90:91], v197 offset:4416
ds_read_b64_tr_b16 v[92:93], v197 offset:128
ds_read_b64_tr_b16 v[94:95], v197 offset:4480
ds_read_b64_tr_b16 v[96:97], v197 offset:192
ds_read_b64_tr_b16 v[98:99], v197 offset:4544
ds_read_b64_tr_b16 v[100:101], v197 offset:17408
ds_read_b64_tr_b16 v[102:103], v197 offset:21760
ds_read_b64_tr_b16 v[104:105], v197 offset:17472
ds_read_b64_tr_b16 v[106:107], v197 offset:21824
ds_read_b64_tr_b16 v[108:109], v197 offset:17536
ds_read_b64_tr_b16 v[110:111], v197 offset:21888
ds_read_b64_tr_b16 v[112:113], v197 offset:17600
ds_read_b64_tr_b16 v[114:115], v197 offset:21952
ds_read_b64_tr_b16 v[116:117], v197 offset:34816
ds_read_b64_tr_b16 v[118:119], v197 offset:39168
ds_read_b64_tr_b16 v[120:121], v197 offset:34880
ds_read_b64_tr_b16 v[122:123], v197 offset:39232
ds_read_b64_tr_b16 v[124:125], v197 offset:34944
ds_read_b64_tr_b16 v[126:127], v197 offset:39296
ds_read_b64_tr_b16 v[128:129], v197 offset:35008
ds_read_b64_tr_b16 v[130:131], v197 offset:39360
ds_read_b64_tr_b16 v[132:133], v197 offset:52224
ds_read_b64_tr_b16 v[134:135], v197 offset:56576
ds_read_b64_tr_b16 v[136:137], v197 offset:52288
ds_read_b64_tr_b16 v[138:139], v197 offset:56640
ds_read_b64_tr_b16 v[140:141], v197 offset:52352
ds_read_b64_tr_b16 v[142:143], v197 offset:56704
ds_read_b64_tr_b16 v[144:145], v197 offset:52416
ds_read_b64_tr_b16 v[146:147], v197 offset:56768
s_waitcnt lgkmcnt(15)
v_mfma_f32_32x32x16_bf16 v[12:27], v[84:87], v[148:151], v[12:27]
v_mfma_f32_32x32x16_bf16 v[28:43], v[88:91], v[148:151], v[28:43]
v_mfma_f32_32x32x16_bf16 v[44:59], v[92:95], v[148:151], v[44:59]
v_mfma_f32_32x32x16_bf16 v[60:75], v[96:99], v[148:151], v[60:75]
s_waitcnt lgkmcnt(15)
v_mfma_f32_32x32x16_bf16 v[12:27], v[100:103], v[152:155], v[12:27]
v_mfma_f32_32x32x16_bf16 v[28:43], v[104:107], v[152:155], v[28:43]
v_mfma_f32_32x32x16_bf16 v[44:59], v[108:111], v[152:155], v[44:59]
v_mfma_f32_32x32x16_bf16 v[60:75], v[112:115], v[152:155], v[60:75]
s_waitcnt lgkmcnt(8)
v_mfma_f32_32x32x16_bf16 v[12:27], v[116:119], v[156:159], v[12:27]
v_mfma_f32_32x32x16_bf16 v[28:43], v[120:123], v[156:159], v[28:43]
v_mfma_f32_32x32x16_bf16 v[44:59], v[124:127], v[156:159], v[44:59]
v_mfma_f32_32x32x16_bf16 v[60:75], v[128:131], v[156:159], v[60:75]
s_waitcnt lgkmcnt(0)
v_mfma_f32_32x32x16_bf16 v[12:27], v[132:135], v[160:163], v[12:27]
v_mfma_f32_32x32x16_bf16 v[28:43], v[136:139], v[160:163], v[28:43]
v_mfma_f32_32x32x16_bf16 v[44:59], v[140:143], v[160:163], v[44:59]
v_mfma_f32_32x32x16_bf16 v[60:75], v[144:147], v[160:163], v[60:75]
ds_read_b128 v[84:87], v194 offset:0
ds_read_b128 v[88:91], v194 offset:64
ds_read_b128 v[92:95], v194 offset:128
ds_read_b128 v[96:99], v194 offset:192
ds_read_b128 v[100:103], v194 offset:256
ds_read_b128 v[104:107], v194 offset:320
ds_read_b128 v[108:111], v194 offset:384
ds_read_b128 v[112:115], v194 offset:448
ds_read_b128 v[116:119], v194 offset:512
ds_read_b128 v[120:123], v194 offset:576
ds_read_b128 v[124:127], v194 offset:640
ds_read_b128 v[128:131], v194 offset:704
ds_read_b128 v[132:135], v194 offset:768
ds_read_b128 v[136:139], v194 offset:832
ds_read_b128 v[140:143], v194 offset:896
ds_read_b128 v[144:147], v194 offset:960
s_waitcnt lgkmcnt(15)
v_mfma_f32_16x16x32_bf16 v[76:79], v[84:87], a[0:3], 0
v_mfma_f32_16x16x32_bf16 v[80:83], v[84:87], a[64:67], 0
s_waitcnt lgkmcnt(14)
v_mfma_f32_16x16x32_bf16 v[76:79], v[88:91], a[4:7], v[76:79]
v_mfma_f32_16x16x32_bf16 v[80:83], v[88:91], a[68:71], v[80:83]
s_waitcnt lgkmcnt(13)
v_mfma_f32_16x16x32_bf16 v[76:79], v[92:95], a[8:11], v[76:79]
v_mfma_f32_16x16x32_bf16 v[80:83], v[92:95], a[72:75], v[80:83]
s_waitcnt lgkmcnt(12)
v_mfma_f32_16x16x32_bf16 v[76:79], v[96:99], a[12:15], v[76:79]
v_mfma_f32_16x16x32_bf16 v[80:83], v[96:99], a[76:79], v[80:83]
s_waitcnt lgkmcnt(11)
v_mfma_f32_16x16x32_bf16 v[76:79], v[100:103], a[16:19], v[76:79]
v_mfma_f32_16x16x32_bf16 v[80:83], v[100:103], a[80:83], v[80:83]
s_waitcnt lgkmcnt(10)
v_mfma_f32_16x16x32_bf16 v[76:79], v[104:107], a[20:23], v[76:79]
v_mfma_f32_16x16x32_bf16 v[80:83], v[104:107], a[84:87], v[80:83]
s_waitcnt lgkmcnt(9)
v_mfma_f32_16x16x32_bf16 v[76:79], v[108:111], a[24:27], v[76:79]
v_mfma_f32_16x16x32_bf16 v[80:83], v[108:111], a[88:91], v[80:83]
s_waitcnt lgkmcnt(8)
v_mfma_f32_16x16x32_bf16 v[76:79], v[112:115], a[28:31], v[76:79]
v_mfma_f32_16x16x32_bf16 v[80:83], v[112:115], a[92:95], v[80:83]
s_waitcnt lgkmcnt(7)
v_mfma_f32_16x16x32_bf16 v[76:79], v[116:119], a[32:35], v[76:79]
v_mfma_f32_16x16x32_bf16 v[80:83], v[116:119], a[96:99], v[80:83]
s_waitcnt lgkmcnt(6)
v_mfma_f32_16x16x32_bf16 v[76:79], v[120:123], a[36:39], v[76:79]
v_mfma_f32_16x16x32_bf16 v[80:83], v[120:123], a[100:103], v[80:83]
s_waitcnt lgkmcnt(5)
v_mfma_f32_16x16x32_bf16 v[76:79], v[124:127], a[40:43], v[76:79]
v_mfma_f32_16x16x32_bf16 v[80:83], v[124:127], a[104:107], v[80:83]
s_waitcnt lgkmcnt(4)
v_mfma_f32_16x16x32_bf16 v[76:79], v[128:131], a[44:47], v[76:79]
v_mfma_f32_16x16x32_bf16 v[80:83], v[128:131], a[108:111], v[80:83]
s_waitcnt lgkmcnt(3)
v_mfma_f32_16x16x32_bf16 v[76:79], v[132:135], a[48:51], v[76:79]
v_mfma_f32_16x16x32_bf16 v[80:83], v[132:135], a[112:115], v[80:83]
s_waitcnt lgkmcnt(2)
v_mfma_f32_16x16x32_bf16 v[76:79], v[136:139], a[52:55], v[76:79]
v_mfma_f32_16x16x32_bf16 v[80:83], v[136:139], a[116:119], v[80:83]
s_waitcnt lgkmcnt(1)
v_mfma_f32_16x16x32_bf16 v[76:79], v[140:143], a[56:59], v[76:79]
v_mfma_f32_16x16x32_bf16 v[80:83], v[140:143], a[120:123], v[80:83]
s_waitcnt lgkmcnt(0)
v_mfma_f32_16x16x32_bf16 v[76:79], v[144:147], a[60:63], v[76:79]
v_mfma_f32_16x16x32_bf16 v[80:83], v[144:147], a[124:127], v[80:83]
s_nop 6
v_max_f32 v190, v76, v77
v_max3_f32 v190, v190, v78, v79
v_mov_b32 v192, v190
s_nop 1
v_permlane16_swap_b32 v190, v192
v_max_f32 v190, v190, v192
v_mov_b32 v192, v190
s_nop 1
v_permlane32_swap_b32 v190, v192
v_max_f32 v190, v190, v192
ds_write_b32 v198, v190 offset:0
v_max_f32 v191, v80, v81
v_max3_f32 v191, v191, v82, v83
v_mov_b32 v192, v191
s_nop 1
v_permlane16_swap_b32 v191, v192
v_max_f32 v191, v191, v192
v_mov_b32 v192, v191
s_nop 1
v_permlane32_swap_b32 v191, v192
v_max_f32 v191, v191, v192
ds_write_b32 v198, v191 offset:256
s_waitcnt lgkmcnt(0)
s_barrier
ds_read_b128 v[164:167], v199
ds_read_b128 v[168:171], v199 offset:256
ds_read_b128 v[172:175], v200
s_waitcnt vmcnt(0)
ds_write_b128 v207, a[192:195] offset:0
ds_write_b128 v207, a[196:199] offset:1088
ds_write_b128 v207, a[200:203] offset:2176
ds_write_b128 v207, a[204:207] offset:3264
ds_write_b128 v207, a[208:211] offset:4352
ds_write_b128 v207, a[212:215] offset:5440
ds_write_b128 v207, a[216:219] offset:6528
ds_write_b128 v207, a[220:223] offset:7616
ds_write_b128 v207, a[224:227] offset:8704
ds_write_b128 v207, a[228:231] offset:9792
ds_write_b128 v207, a[232:235] offset:10880
ds_write_b128 v207, a[236:239] offset:11968
ds_write_b128 v207, a[240:243] offset:13056
ds_write_b128 v207, a[244:247] offset:14144
ds_write_b128 v207, a[248:251] offset:15232
ds_write_b128 v207, a[252:255] offset:16320
s_waitcnt lgkmcnt(15)
v_max_f32 v164, v164, v165
v_max3_f32 v164, v164, v166, v167
v_mul_f32 v164, v164, v185
v_max_f32 v164, v164, v176
v_sub_f32 v182, v176, v164
v_exp_f32 v182, v182
v_mov_b32 v176, v164
v_max_f32 v168, v168, v169
v_max3_f32 v168, v168, v170, v171
v_mul_f32 v168, v168, v185
v_max_f32 v168, v168, v177
v_sub_f32 v183, v177, v168
v_exp_f32 v183, v183
v_mov_b32 v177, v168
v_max_f32 v172, v172, v173
v_max3_f32 v172, v172, v174, v175
v_mul_f32 v172, v172, v185
v_max_f32 v172, v172, v178
v_sub_f32 v184, v178, v172
v_exp_f32 v184, v184
v_mov_b32 v178, v172
v_fma_f32 v76, v76, v185, -v176
v_fma_f32 v77, v77, v185, -v176
v_fma_f32 v78, v78, v185, -v176
v_fma_f32 v79, v79, v185, -v176
v_exp_f32 v76, v76
v_exp_f32 v77, v77
v_exp_f32 v78, v78
v_exp_f32 v79, v79
v_mul_f32 v180, v180, v182
v_cvt_pk_bf16_f32 v186, v76, v77
v_cvt_pk_bf16_f32 v187, v78, v79
ds_write_b64 v201, v[186:187] offset:0
v_add_f32 v180, v180, v76
v_add_f32 v180, v180, v77
v_add_f32 v180, v180, v78
v_add_f32 v180, v180, v79
v_fma_f32 v80, v80, v185, -v177
v_fma_f32 v81, v81, v185, -v177
v_fma_f32 v82, v82, v185, -v177
v_fma_f32 v83, v83, v185, -v177
v_exp_f32 v80, v80
v_exp_f32 v81, v81
v_exp_f32 v82, v82
v_exp_f32 v83, v83
v_mul_f32 v181, v181, v183
v_cvt_pk_bf16_f32 v188, v80, v81
v_cvt_pk_bf16_f32 v189, v82, v83
ds_write_b64 v201, v[188:189] offset:512
v_add_f32 v181, v181, v80
v_add_f32 v181, v181, v81
v_add_f32 v181, v181, v82
v_add_f32 v181, v181, v83
v_mul_f32 v12, v12, v184
v_mul_f32 v13, v13, v184
v_mul_f32 v14, v14, v184
v_mul_f32 v15, v15, v184
v_mul_f32 v16, v16, v184
v_mul_f32 v17, v17, v184
v_mul_f32 v18, v18, v184
v_mul_f32 v19, v19, v184
v_mul_f32 v20, v20, v184
v_mul_f32 v21, v21, v184
v_mul_f32 v22, v22, v184
v_mul_f32 v23, v23, v184
v_mul_f32 v24, v24, v184
v_mul_f32 v25, v25, v184
v_mul_f32 v26, v26, v184
v_mul_f32 v27, v27, v184
v_mul_f32 v28, v28, v184
v_mul_f32 v29, v29, v184
v_mul_f32 v30, v30, v184
v_mul_f32 v31, v31, v184
v_mul_f32 v32, v32, v184
v_mul_f32 v33, v33, v184
v_mul_f32 v34, v34, v184
v_mul_f32 v35, v35, v184
v_mul_f32 v36, v36, v184
v_mul_f32 v37, v37, v184
v_mul_f32 v38, v38, v184
v_mul_f32 v39, v39, v184
v_mul_f32 v40, v40, v184
v_mul_f32 v41, v41, v184
v_mul_f32 v42, v42, v184
v_mul_f32 v43, v43, v184
v_mul_f32 v44, v44, v184
v_mul_f32 v45, v45, v184
v_mul_f32 v46, v46, v184
v_mul_f32 v47, v47, v184
v_mul_f32 v48, v48, v184
v_mul_f32 v49, v49, v184
v_mul_f32 v50, v50, v184
v_mul_f32 v51, v51, v184
v_mul_f32 v52, v52, v184
v_mul_f32 v53, v53, v184
v_mul_f32 v54, v54, v184
v_mul_f32 v55, v55, v184
v_mul_f32 v56, v56, v184
v_mul_f32 v57, v57, v184
v_mul_f32 v58, v58, v184
v_mul_f32 v59, v59, v184
v_mul_f32 v60, v60, v184
v_mul_f32 v61, v61, v184
v_mul_f32 v62, v62, v184
v_mul_f32 v63, v63, v184
v_mul_f32 v64, v64, v184
v_mul_f32 v65, v65, v184
v_mul_f32 v66, v66, v184
v_mul_f32 v67, v67, v184
v_mul_f32 v68, v68, v184
v_mul_f32 v69, v69, v184
v_mul_f32 v70, v70, v184
v_mul_f32 v71, v71, v184
v_mul_f32 v72, v72, v184
v_mul_f32 v73, v73, v184
v_mul_f32 v74, v74, v184
v_mul_f32 v75, v75, v184
s_waitcnt lgkmcnt(0)
s_barrier
ds_read_b128 v[148:151], v202 offset:0
ds_read_b128 v[152:155], v202 offset:1024
ds_read_b128 v[156:159], v202 offset:2048
ds_read_b128 v[160:163], v202 offset:3072
ds_read_b64_tr_b16 v[84:85], v196 offset:0
ds_read_b64_tr_b16 v[86:87], v196 offset:4352
ds_read_b64_tr_b16 v[88:89], v196 offset:64
ds_read_b64_tr_b16 v[90:91], v196 offset:4416
ds_read_b64_tr_b16 v[92:93], v196 offset:128
ds_read_b64_tr_b16 v[94:95], v196 offset:4480
ds_read_b64_tr_b16 v[96:97], v196 offset:192
ds_read_b64_tr_b16 v[98:99], v196 offset:4544
ds_read_b64_tr_b16 v[100:101], v196 offset:17408
ds_read_b64_tr_b16 v[102:103], v196 offset:21760
ds_read_b64_tr_b16 v[104:105], v196 offset:17472
ds_read_b64_tr_b16 v[106:107], v196 offset:21824
ds_read_b64_tr_b16 v[108:109], v196 offset:17536
ds_read_b64_tr_b16 v[110:111], v196 offset:21888
ds_read_b64_tr_b16 v[112:113], v196 offset:17600
ds_read_b64_tr_b16 v[114:115], v196 offset:21952
ds_read_b64_tr_b16 v[116:117], v196 offset:34816
ds_read_b64_tr_b16 v[118:119], v196 offset:39168
ds_read_b64_tr_b16 v[120:121], v196 offset:34880
ds_read_b64_tr_b16 v[122:123], v196 offset:39232
ds_read_b64_tr_b16 v[124:125], v196 offset:34944
ds_read_b64_tr_b16 v[126:127], v196 offset:39296
ds_read_b64_tr_b16 v[128:129], v196 offset:35008
ds_read_b64_tr_b16 v[130:131], v196 offset:39360
ds_read_b64_tr_b16 v[132:133], v196 offset:52224
ds_read_b64_tr_b16 v[134:135], v196 offset:56576
ds_read_b64_tr_b16 v[136:137], v196 offset:52288
ds_read_b64_tr_b16 v[138:139], v196 offset:56640
ds_read_b64_tr_b16 v[140:141], v196 offset:52352
ds_read_b64_tr_b16 v[142:143], v196 offset:56704
ds_read_b64_tr_b16 v[144:145], v196 offset:52416
ds_read_b64_tr_b16 v[146:147], v196 offset:56768
s_waitcnt lgkmcnt(15)
v_mfma_f32_32x32x16_bf16 v[12:27], v[84:87], v[148:151], v[12:27]
v_mfma_f32_32x32x16_bf16 v[28:43], v[88:91], v[148:151], v[28:43]
v_mfma_f32_32x32x16_bf16 v[44:59], v[92:95], v[148:151], v[44:59]
v_mfma_f32_32x32x16_bf16 v[60:75], v[96:99], v[148:151], v[60:75]
s_waitcnt lgkmcnt(15)
v_mfma_f32_32x32x16_bf16 v[12:27], v[100:103], v[152:155], v[12:27]
v_mfma_f32_32x32x16_bf16 v[28:43], v[104:107], v[152:155], v[28:43]
v_mfma_f32_32x32x16_bf16 v[44:59], v[108:111], v[152:155], v[44:59]
v_mfma_f32_32x32x16_bf16 v[60:75], v[112:115], v[152:155], v[60:75]
s_waitcnt lgkmcnt(8)
v_mfma_f32_32x32x16_bf16 v[12:27], v[116:119], v[156:159], v[12:27]
v_mfma_f32_32x32x16_bf16 v[28:43], v[120:123], v[156:159], v[28:43]
v_mfma_f32_32x32x16_bf16 v[44:59], v[124:127], v[156:159], v[44:59]
v_mfma_f32_32x32x16_bf16 v[60:75], v[128:131], v[156:159], v[60:75]
s_waitcnt lgkmcnt(0)
v_mfma_f32_32x32x16_bf16 v[12:27], v[132:135], v[160:163], v[12:27]
v_mfma_f32_32x32x16_bf16 v[28:43], v[136:139], v[160:163], v[28:43]
v_mfma_f32_32x32x16_bf16 v[44:59], v[140:143], v[160:163], v[44:59]
v_mfma_f32_32x32x16_bf16 v[60:75], v[144:147], v[160:163], v[60:75]
ds_read_b128 v[84:87], v195 offset:0
ds_read_b128 v[88:91], v195 offset:64
ds_read_b128 v[92:95], v195 offset:128
ds_read_b128 v[96:99], v195 offset:192
ds_read_b128 v[100:103], v195 offset:256
ds_read_b128 v[104:107], v195 offset:320
ds_read_b128 v[108:111], v195 offset:384
ds_read_b128 v[112:115], v195 offset:448
ds_read_b128 v[116:119], v195 offset:512
ds_read_b128 v[120:123], v195 offset:576
ds_read_b128 v[124:127], v195 offset:640
ds_read_b128 v[128:131], v195 offset:704
ds_read_b128 v[132:135], v195 offset:768
ds_read_b128 v[136:139], v195 offset:832
ds_read_b128 v[140:143], v195 offset:896
ds_read_b128 v[144:147], v195 offset:960
s_waitcnt lgkmcnt(15)
v_mfma_f32_16x16x32_bf16 v[76:79], v[84:87], a[0:3], 0
v_mfma_f32_16x16x32_bf16 v[80:83], v[84:87], a[64:67], 0
s_waitcnt lgkmcnt(14)
v_mfma_f32_16x16x32_bf16 v[76:79], v[88:91], a[4:7], v[76:79]
v_mfma_f32_16x16x32_bf16 v[80:83], v[88:91], a[68:71], v[80:83]
s_waitcnt lgkmcnt(13)
v_mfma_f32_16x16x32_bf16 v[76:79], v[92:95], a[8:11], v[76:79]
v_mfma_f32_16x16x32_bf16 v[80:83], v[92:95], a[72:75], v[80:83]
s_waitcnt lgkmcnt(12)
v_mfma_f32_16x16x32_bf16 v[76:79], v[96:99], a[12:15], v[76:79]
v_mfma_f32_16x16x32_bf16 v[80:83], v[96:99], a[76:79], v[80:83]
s_waitcnt lgkmcnt(11)
v_mfma_f32_16x16x32_bf16 v[76:79], v[100:103], a[16:19], v[76:79]
v_mfma_f32_16x16x32_bf16 v[80:83], v[100:103], a[80:83], v[80:83]
s_waitcnt lgkmcnt(10)
v_mfma_f32_16x16x32_bf16 v[76:79], v[104:107], a[20:23], v[76:79]
v_mfma_f32_16x16x32_bf16 v[80:83], v[104:107], a[84:87], v[80:83]
s_waitcnt lgkmcnt(9)
v_mfma_f32_16x16x32_bf16 v[76:79], v[108:111], a[24:27], v[76:79]
v_mfma_f32_16x16x32_bf16 v[80:83], v[108:111], a[88:91], v[80:83]
s_waitcnt lgkmcnt(8)
v_mfma_f32_16x16x32_bf16 v[76:79], v[112:115], a[28:31], v[76:79]
v_mfma_f32_16x16x32_bf16 v[80:83], v[112:115], a[92:95], v[80:83]
s_waitcnt lgkmcnt(7)
v_mfma_f32_16x16x32_bf16 v[76:79], v[116:119], a[32:35], v[76:79]
v_mfma_f32_16x16x32_bf16 v[80:83], v[116:119], a[96:99], v[80:83]
s_waitcnt lgkmcnt(6)
v_mfma_f32_16x16x32_bf16 v[76:79], v[120:123], a[36:39], v[76:79]
v_mfma_f32_16x16x32_bf16 v[80:83], v[120:123], a[100:103], v[80:83]
s_waitcnt lgkmcnt(5)
v_mfma_f32_16x16x32_bf16 v[76:79], v[124:127], a[40:43], v[76:79]
v_mfma_f32_16x16x32_bf16 v[80:83], v[124:127], a[104:107], v[80:83]
s_waitcnt lgkmcnt(4)
v_mfma_f32_16x16x32_bf16 v[76:79], v[128:131], a[44:47], v[76:79]
v_mfma_f32_16x16x32_bf16 v[80:83], v[128:131], a[108:111], v[80:83]
s_waitcnt lgkmcnt(3)
v_mfma_f32_16x16x32_bf16 v[76:79], v[132:135], a[48:51], v[76:79]
v_mfma_f32_16x16x32_bf16 v[80:83], v[132:135], a[112:115], v[80:83]
s_waitcnt lgkmcnt(2)
v_mfma_f32_16x16x32_bf16 v[76:79], v[136:139], a[52:55], v[76:79]
v_mfma_f32_16x16x32_bf16 v[80:83], v[136:139], a[116:119], v[80:83]
s_waitcnt lgkmcnt(1)
v_mfma_f32_16x16x32_bf16 v[76:79], v[140:143], a[56:59], v[76:79]
v_mfma_f32_16x16x32_bf16 v[80:83], v[140:143], a[120:123], v[80:83]
s_waitcnt lgkmcnt(0)
v_mfma_f32_16x16x32_bf16 v[76:79], v[144:147], a[60:63], v[76:79]
v_mfma_f32_16x16x32_bf16 v[80:83], v[144:147], a[124:127], v[80:83]
s_nop 6
v_max_f32 v190, v76, v77
v_max3_f32 v190, v190, v78, v79
v_mov_b32 v192, v190
s_nop 1
v_permlane16_swap_b32 v190, v192
v_max_f32 v190, v190, v192
v_mov_b32 v192, v190
s_nop 1
v_permlane32_swap_b32 v190, v192
v_max_f32 v190, v190, v192
ds_write_b32 v198, v190 offset:0
v_max_f32 v191, v80, v81
v_max3_f32 v191, v191, v82, v83
v_mov_b32 v192, v191
s_nop 1
v_permlane16_swap_b32 v191, v192
v_max_f32 v191, v191, v192
v_mov_b32 v192, v191
s_nop 1
v_permlane32_swap_b32 v191, v192
v_max_f32 v191, v191, v192
ds_write_b32 v198, v191 offset:256
s_waitcnt lgkmcnt(0)
s_barrier
ds_read_b128 v[164:167], v199
ds_read_b128 v[168:171], v199 offset:256
ds_read_b128 v[172:175], v200
s_waitcnt lgkmcnt(0)
v_max_f32 v164, v164, v165
v_max3_f32 v164, v164, v166, v167
v_mul_f32 v164, v164, v185
v_max_f32 v164, v164, v176
v_sub_f32 v182, v176, v164
v_exp_f32 v182, v182
v_mov_b32 v176, v164
v_max_f32 v168, v168, v169
v_max3_f32 v168, v168, v170, v171
v_mul_f32 v168, v168, v185
v_max_f32 v168, v168, v177
v_sub_f32 v183, v177, v168
v_exp_f32 v183, v183
v_mov_b32 v177, v168
v_max_f32 v172, v172, v173
v_max3_f32 v172, v172, v174, v175
v_mul_f32 v172, v172, v185
v_max_f32 v172, v172, v178
v_sub_f32 v184, v178, v172
v_exp_f32 v184, v184
v_mov_b32 v178, v172
v_fma_f32 v76, v76, v185, -v176
v_fma_f32 v77, v77, v185, -v176
v_fma_f32 v78, v78, v185, -v176
v_fma_f32 v79, v79, v185, -v176
v_exp_f32 v76, v76
v_exp_f32 v77, v77
v_exp_f32 v78, v78
v_exp_f32 v79, v79
v_mul_f32 v180, v180, v182
v_cvt_pk_bf16_f32 v186, v76, v77
v_cvt_pk_bf16_f32 v187, v78, v79
ds_write_b64 v201, v[186:187] offset:0
v_add_f32 v180, v180, v76
v_add_f32 v180, v180, v77
v_add_f32 v180, v180, v78
v_add_f32 v180, v180, v79
v_fma_f32 v80, v80, v185, -v177
v_fma_f32 v81, v81, v185, -v177
v_fma_f32 v82, v82, v185, -v177
v_fma_f32 v83, v83, v185, -v177
v_exp_f32 v80, v80
v_exp_f32 v81, v81
v_exp_f32 v82, v82
v_exp_f32 v83, v83
v_mul_f32 v181, v181, v183
v_cvt_pk_bf16_f32 v188, v80, v81
v_cvt_pk_bf16_f32 v189, v82, v83
ds_write_b64 v201, v[188:189] offset:512
v_add_f32 v181, v181, v80
v_add_f32 v181, v181, v81
v_add_f32 v181, v181, v82
v_add_f32 v181, v181, v83
v_mul_f32 v12, v12, v184
v_mul_f32 v13, v13, v184
v_mul_f32 v14, v14, v184
v_mul_f32 v15, v15, v184
v_mul_f32 v16, v16, v184
v_mul_f32 v17, v17, v184
v_mul_f32 v18, v18, v184
v_mul_f32 v19, v19, v184
v_mul_f32 v20, v20, v184
v_mul_f32 v21, v21, v184
v_mul_f32 v22, v22, v184
v_mul_f32 v23, v23, v184
v_mul_f32 v24, v24, v184
v_mul_f32 v25, v25, v184
v_mul_f32 v26, v26, v184
v_mul_f32 v27, v27, v184
v_mul_f32 v28, v28, v184
v_mul_f32 v29, v29, v184
v_mul_f32 v30, v30, v184
v_mul_f32 v31, v31, v184
v_mul_f32 v32, v32, v184
v_mul_f32 v33, v33, v184
v_mul_f32 v34, v34, v184
v_mul_f32 v35, v35, v184
v_mul_f32 v36, v36, v184
v_mul_f32 v37, v37, v184
v_mul_f32 v38, v38, v184
v_mul_f32 v39, v39, v184
v_mul_f32 v40, v40, v184
v_mul_f32 v41, v41, v184
v_mul_f32 v42, v42, v184
v_mul_f32 v43, v43, v184
v_mul_f32 v44, v44, v184
v_mul_f32 v45, v45, v184
v_mul_f32 v46, v46, v184
v_mul_f32 v47, v47, v184
v_mul_f32 v48, v48, v184
v_mul_f32 v49, v49, v184
v_mul_f32 v50, v50, v184
v_mul_f32 v51, v51, v184
v_mul_f32 v52, v52, v184
v_mul_f32 v53, v53, v184
v_mul_f32 v54, v54, v184
v_mul_f32 v55, v55, v184
v_mul_f32 v56, v56, v184
v_mul_f32 v57, v57, v184
v_mul_f32 v58, v58, v184
v_mul_f32 v59, v59, v184
v_mul_f32 v60, v60, v184
v_mul_f32 v61, v61, v184
v_mul_f32 v62, v62, v184
v_mul_f32 v63, v63, v184
v_mul_f32 v64, v64, v184
v_mul_f32 v65, v65, v184
v_mul_f32 v66, v66, v184
v_mul_f32 v67, v67, v184
v_mul_f32 v68, v68, v184
v_mul_f32 v69, v69, v184
v_mul_f32 v70, v70, v184
v_mul_f32 v71, v71, v184
v_mul_f32 v72, v72, v184
v_mul_f32 v73, v73, v184
v_mul_f32 v74, v74, v184
v_mul_f32 v75, v75, v184
s_waitcnt lgkmcnt(0)
s_barrier
ds_read_b128 v[148:151], v202 offset:0
ds_read_b128 v[152:155], v202 offset:1024
ds_read_b128 v[156:159], v202 offset:2048
ds_read_b128 v[160:163], v202 offset:3072
ds_read_b64_tr_b16 v[84:85], v197 offset:0
ds_read_b64_tr_b16 v[86:87], v197 offset:4352
ds_read_b64_tr_b16 v[88:89], v197 offset:64
ds_read_b64_tr_b16 v[90:91], v197 offset:4416
ds_read_b64_tr_b16 v[92:93], v197 offset:128
ds_read_b64_tr_b16 v[94:95], v197 offset:4480
ds_read_b64_tr_b16 v[96:97], v197 offset:192
ds_read_b64_tr_b16 v[98:99], v197 offset:4544
ds_read_b64_tr_b16 v[100:101], v197 offset:17408
ds_read_b64_tr_b16 v[102:103], v197 offset:21760
ds_read_b64_tr_b16 v[104:105], v197 offset:17472
ds_read_b64_tr_b16 v[106:107], v197 offset:21824
ds_read_b64_tr_b16 v[108:109], v197 offset:17536
ds_read_b64_tr_b16 v[110:111], v197 offset:21888
ds_read_b64_tr_b16 v[112:113], v197 offset:17600
ds_read_b64_tr_b16 v[114:115], v197 offset:21952
ds_read_b64_tr_b16 v[116:117], v197 offset:34816
ds_read_b64_tr_b16 v[118:119], v197 offset:39168
ds_read_b64_tr_b16 v[120:121], v197 offset:34880
ds_read_b64_tr_b16 v[122:123], v197 offset:39232
ds_read_b64_tr_b16 v[124:125], v197 offset:34944
ds_read_b64_tr_b16 v[126:127], v197 offset:39296
ds_read_b64_tr_b16 v[128:129], v197 offset:35008
ds_read_b64_tr_b16 v[130:131], v197 offset:39360
ds_read_b64_tr_b16 v[132:133], v197 offset:52224
ds_read_b64_tr_b16 v[134:135], v197 offset:56576
ds_read_b64_tr_b16 v[136:137], v197 offset:52288
ds_read_b64_tr_b16 v[138:139], v197 offset:56640
ds_read_b64_tr_b16 v[140:141], v197 offset:52352
ds_read_b64_tr_b16 v[142:143], v197 offset:56704
ds_read_b64_tr_b16 v[144:145], v197 offset:52416
ds_read_b64_tr_b16 v[146:147], v197 offset:56768
s_waitcnt lgkmcnt(15)
v_mfma_f32_32x32x16_bf16 v[12:27], v[84:87], v[148:151], v[12:27]
v_mfma_f32_32x32x16_bf16 v[28:43], v[88:91], v[148:151], v[28:43]
v_mfma_f32_32x32x16_bf16 v[44:59], v[92:95], v[148:151], v[44:59]
v_mfma_f32_32x32x16_bf16 v[60:75], v[96:99], v[148:151], v[60:75]
s_waitcnt lgkmcnt(15)
v_mfma_f32_32x32x16_bf16 v[12:27], v[100:103], v[152:155], v[12:27]
v_mfma_f32_32x32x16_bf16 v[28:43], v[104:107], v[152:155], v[28:43]
v_mfma_f32_32x32x16_bf16 v[44:59], v[108:111], v[152:155], v[44:59]
v_mfma_f32_32x32x16_bf16 v[60:75], v[112:115], v[152:155], v[60:75]
s_waitcnt lgkmcnt(8)
v_mfma_f32_32x32x16_bf16 v[12:27], v[116:119], v[156:159], v[12:27]
v_mfma_f32_32x32x16_bf16 v[28:43], v[120:123], v[156:159], v[28:43]
v_mfma_f32_32x32x16_bf16 v[44:59], v[124:127], v[156:159], v[44:59]
v_mfma_f32_32x32x16_bf16 v[60:75], v[128:131], v[156:159], v[60:75]
s_waitcnt lgkmcnt(0)
v_mfma_f32_32x32x16_bf16 v[12:27], v[132:135], v[160:163], v[12:27]
v_mfma_f32_32x32x16_bf16 v[28:43], v[136:139], v[160:163], v[28:43]
v_mfma_f32_32x32x16_bf16 v[44:59], v[140:143], v[160:163], v[44:59]
v_mfma_f32_32x32x16_bf16 v[60:75], v[144:147], v[160:163], v[60:75]
v_mov_b32 v192, v180
s_nop 1
v_permlane16_swap_b32 v180, v192
v_add_f32 v180, v180, v192
v_mov_b32 v192, v180
s_nop 1
v_permlane32_swap_b32 v180, v192
v_add_f32 v180, v180, v192
ds_write_b32 v198, v180 offset:512
v_mov_b32 v192, v181
s_nop 1
v_permlane16_swap_b32 v181, v192
v_add_f32 v181, v181, v192
v_mov_b32 v192, v181
s_nop 1
v_permlane32_swap_b32 v181, v192
v_add_f32 v181, v181, v192
ds_write_b32 v198, v181 offset:768
v_and_b32 v5, 31, v1
v_mul_u32_u24 v5, 1040, v5
v_lshrrev_b32 v6, 5, v1
v_lshl_add_u32 v5, v6, 3, v5
s_lshl_b32 s6, s3, 8
v_add_u32 v5, s6, v5
v_cvt_pk_bf16_f32 v84, v12, v13
v_cvt_pk_bf16_f32 v85, v14, v15
ds_write_b64 v5, v[84:85] offset:0
v_cvt_pk_bf16_f32 v86, v16, v17
v_cvt_pk_bf16_f32 v87, v18, v19
ds_write_b64 v5, v[86:87] offset:16
v_cvt_pk_bf16_f32 v88, v20, v21
v_cvt_pk_bf16_f32 v89, v22, v23
ds_write_b64 v5, v[88:89] offset:32
v_cvt_pk_bf16_f32 v90, v24, v25
v_cvt_pk_bf16_f32 v91, v26, v27
ds_write_b64 v5, v[90:91] offset:48
v_cvt_pk_bf16_f32 v92, v28, v29
v_cvt_pk_bf16_f32 v93, v30, v31
ds_write_b64 v5, v[92:93] offset:64
v_cvt_pk_bf16_f32 v94, v32, v33
v_cvt_pk_bf16_f32 v95, v34, v35
ds_write_b64 v5, v[94:95] offset:80
v_cvt_pk_bf16_f32 v96, v36, v37
v_cvt_pk_bf16_f32 v97, v38, v39
ds_write_b64 v5, v[96:97] offset:96
v_cvt_pk_bf16_f32 v98, v40, v41
v_cvt_pk_bf16_f32 v99, v42, v43
ds_write_b64 v5, v[98:99] offset:112
v_cvt_pk_bf16_f32 v100, v44, v45
v_cvt_pk_bf16_f32 v101, v46, v47
ds_write_b64 v5, v[100:101] offset:128
v_cvt_pk_bf16_f32 v102, v48, v49
v_cvt_pk_bf16_f32 v103, v50, v51
ds_write_b64 v5, v[102:103] offset:144
v_cvt_pk_bf16_f32 v104, v52, v53
v_cvt_pk_bf16_f32 v105, v54, v55
ds_write_b64 v5, v[104:105] offset:160
v_cvt_pk_bf16_f32 v106, v56, v57
v_cvt_pk_bf16_f32 v107, v58, v59
ds_write_b64 v5, v[106:107] offset:176
v_cvt_pk_bf16_f32 v108, v60, v61
v_cvt_pk_bf16_f32 v109, v62, v63
ds_write_b64 v5, v[108:109] offset:192
v_cvt_pk_bf16_f32 v110, v64, v65
v_cvt_pk_bf16_f32 v111, v66, v67
ds_write_b64 v5, v[110:111] offset:208
v_cvt_pk_bf16_f32 v112, v68, v69
v_cvt_pk_bf16_f32 v113, v70, v71
ds_write_b64 v5, v[112:113] offset:224
v_cvt_pk_bf16_f32 v114, v72, v73
v_cvt_pk_bf16_f32 v115, v74, v75
ds_write_b64 v5, v[114:115] offset:240
v_mov_b32 v11, 163824
v_mov_b32 v7, 0
ds_write_b32 v11, v7
s_waitcnt lgkmcnt(0)
s_barrier
s_mul_i32 s6, s3, 8320
v_add_u32 v5, s6, v2
ds_read_b128 v[116:119], v5 offset:0
ds_read_b128 v[120:123], v5 offset:1040
ds_read_b128 v[124:127], v5 offset:2080
ds_read_b128 v[128:131], v5 offset:3120
ds_read_b128 v[132:135], v5 offset:4160
ds_read_b128 v[136:139], v5 offset:5200
ds_read_b128 v[140:143], v5 offset:6240
ds_read_b128 v[144:147], v5 offset:7280
ds_read_b128 v[164:167], v200 offset:512
s_mul_i32 s7, s3, 524288
s_lshl_b32 s6, s80, 10
s_add_u32 s7, s7, s6
s_add_u32 s7, s7, 2097152
s_waitcnt lgkmcnt(8)
s_add_u32 s6, s7, 0
buffer_store_dwordx4 v[116:119], v2, s[64:67], s6 offen sc1
s_waitcnt lgkmcnt(7)
s_add_u32 s6, s7, 98304
buffer_store_dwordx4 v[120:123], v2, s[64:67], s6 offen sc1
s_waitcnt lgkmcnt(6)
s_add_u32 s6, s7, 131072
buffer_store_dwordx4 v[124:127], v2, s[64:67], s6 offen sc1
s_waitcnt lgkmcnt(5)
s_add_u32 s6, s7, 229376
buffer_store_dwordx4 v[128:131], v2, s[64:67], s6 offen sc1
s_waitcnt lgkmcnt(4)
s_add_u32 s6, s7, 262144
buffer_store_dwordx4 v[132:135], v2, s[64:67], s6 offen sc1
s_waitcnt lgkmcnt(3)
s_add_u32 s6, s7, 360448
buffer_store_dwordx4 v[136:139], v2, s[64:67], s6 offen sc1
s_waitcnt lgkmcnt(2)
s_add_u32 s6, s7, 393216
buffer_store_dwordx4 v[140:143], v2, s[64:67], s6 offen sc1
s_waitcnt lgkmcnt(1)
s_add_u32 s6, s7, 491520
buffer_store_dwordx4 v[144:147], v2, s[64:67], s6 offen sc1
s_waitcnt lgkmcnt(0)
v_add_f32 v164, v164, v165
v_add_f32 v166, v166, v167
v_add_f32 v187, v164, v166
v_mov_b32 v186, v178
v_lshlrev_b32 v5, 8, v1
s_mul_i32 s6, s80, 8
s_add_u32 s6, s6, 262144
v_min_u32 v186, -2, v186
v_min_u32 v187, -2, v187
s_waitcnt vmcnt(0)
s_barrier
s_cmp_lg_u32 s3, 0
s_cbranch_scc1 L_nops_21
s_mov_b64 exec, 0xffffffff
buffer_store_dwordx2 v[186:187], v5, s[64:67], s6 offen sc1
s_mov_b64 exec, -1
L_nops_21:
B_final:
s_cmp_eq_u32 s3, 3
s_cbranch_scc1 H_start
s_mov_b32 s14, s9
s_lshr_b32 s7, s3, 1
s_cmp_lg_u32 s3, 1
s_cbranch_scc1 L_w1_22
s_and_b32 s7, s9, 7
s_cmp_ge_u32 s7, 2
s_cbranch_scc1 B_end
s_lshr_b32 s14, s9, 3
s_add_u32 s14, s14, 64
L_w1_22:
s_mul_i32 s15, s14, 57
s_lshr_b32 s15, s15, 10
s_mul_i32 s6, s15, 18
s_sub_u32 s80, s14, s6
s_mul_i32 s81, s15, 73728
s_lshr_b32 s81, s81, s7
s_lshl_b32 s6, s80, 6
s_add_u32 s81, s81, s6
s_mul_i32 s6, s7, 1048576
s_add_u32 s81, s81, s6
s_add_u32 s81, s81, 4194304
v_lshrrev_b32 v5, 2, v1
v_and_b32 v6, 3, v1
v_mul_u32_u24 v44, 1152, v5
v_lshl_add_u32 v44, v6, 4, v44
v_bfe_u32 v5, v1, 3, 2
v_lshl_add_u32 v5, v5, 2, v6
v_lshrrev_b32 v46, 5, v1
v_lshl_add_u32 v45, v46, 6, v5
v_lshrrev_b32 v5, 1, v6
v_mul_u32_u24 v5, 142, v5
v_add_u32 v5, v5, v6
v_lshrrev_b32 v46, 3, v1
v_lshl_add_u32 v5, v46, 1, v5
s_lshr_b32 s6, s80, 2
s_mul_i32 s6, s6, 80
s_lshl_b32 s83, s80, 4
s_add_u32 s83, s83, s6
s_mul_i32 s6, s80, 288
s_sub_u32 s6, s6, 4480
s_cmp_ge_u32 s80, 16
s_cselect_b32 s83, s6, s83
s_cselect_b64 vcc, -1, 0
v_cndmask_b32 v45, v45, v5, vcc
v_lshlrev_b32 v45, 1, v45
s_lshl_b32 s83, s83, 1
s_mul_i32 s6, s15, 2304
s_add_u32 s83, s83, s6
s_mul_i32 s6, s7, 1152
s_add_u32 s83, s83, s6
s_mul_i32 s82, s7, 12
v_mov_b32 v56, 0
v_mov_b32 v57, 0
v_mov_b32 v58, 0
v_mov_b32 v59, 0
v_mov_b32 v60, 0
v_mov_b32 v61, 0
v_mov_b32 v62, 0
v_mov_b32 v63, 0
s_mov_b32 s7, 400000
v_lshrrev_b32 v5, 3, v1
v_mul_u32_u24 v5, 4608, v5
R_slow:
buffer_load_dword v46, v5, s[64:67], s81 offen sc1
s_waitcnt vmcnt(0)
v_cmp_ne_u32 vcc, -1, v46
s_cbranch_vccnz R_pass
s_sleep 8
s_sub_u32 s7, s7, 1
s_cmp_lg_u32 s7, 1
s_cbranch_scc1 R_slow
R_pass:
s_bitcmp1_b32 s82, 0
s_cbranch_scc1 L_ld_23
s_add_u32 s6, s81, 0
buffer_load_dwordx4 v[48:51], v44, s[64:67], s6 offen sc1
L_ld_23:
s_bitcmp1_b32 s82, 1
s_cbranch_scc1 L_ld_24
s_add_u32 s6, s81, 18432
buffer_load_dwordx4 v[52:55], v44, s[64:67], s6 offen sc1
L_ld_24:
s_bitcmp1_b32 s82, 2
s_cbranch_scc1 L_ld_25
s_add_u32 s6, s81, 36864
buffer_load_dwordx4 v[56:59], v44, s[64:67], s6 offen sc1
L_ld_25:
s_bitcmp1_b32 s82, 3
s_cbranch_scc1 L_ld_26
s_add_u32 s6, s81, 55296
buffer_load_dwordx4 v[60:63], v44, s[64:67], s6 offen sc1
L_ld_26:
s_waitcnt vmcnt(0)
s_bitcmp1_b32 s82, 0
s_cbranch_scc1 L_ck_27
v_max3_u32 v46, v48, v49, v50
v_max_u32 v46, v46, v51
v_cmp_eq_u32 vcc, -1, v46
s_cbranch_vccnz L_ck_27
s_bitset1_b32 s82, 0
L_ck_27:
s_bitcmp1_b32 s82, 1
s_cbranch_scc1 L_ck_28
v_max3_u32 v46, v52, v53, v54
v_max_u32 v46, v46, v55
v_cmp_eq_u32 vcc, -1, v46
s_cbranch_vccnz L_ck_28
s_bitset1_b32 s82, 1
L_ck_28:
s_bitcmp1_b32 s82, 2
s_cbranch_scc1 L_ck_29
v_max3_u32 v46, v56, v57, v58
v_max_u32 v46, v46, v59
v_cmp_eq_u32 vcc, -1, v46
s_cbranch_vccnz L_ck_29
s_bitset1_b32 s82, 2
L_ck_29:
s_bitcmp1_b32 s82, 3
s_cbranch_scc1 L_ck_30
v_max3_u32 v46, v60, v61, v62
v_max_u32 v46, v46, v63
v_cmp_eq_u32 vcc, -1, v46
s_cbranch_vccnz L_ck_30
s_bitset1_b32 s82, 3
L_ck_30:
s_cmp_eq_u32 s82, 15
s_cbranch_scc1 R_done
s_sub_u32 s7, s7, 1
s_cmp_lg_u32 s7, 0
s_cbranch_scc1 R_pass
R_done:
v_lshlrev_b32 v12, 16, v48
v_and_b32 v13, 0xffff0000, v48
v_lshlrev_b32 v14, 16, v49
v_and_b32 v15, 0xffff0000, v49
v_lshlrev_b32 v16, 16, v50
v_and_b32 v17, 0xffff0000, v50
v_lshlrev_b32 v18, 16, v51
v_and_b32 v19, 0xffff0000, v51
v_lshlrev_b32 v20, 16, v52
v_and_b32 v21, 0xffff0000, v52
v_lshlrev_b32 v22, 16, v53
v_and_b32 v23, 0xffff0000, v53
v_lshlrev_b32 v24, 16, v54
v_and_b32 v25, 0xffff0000, v54
v_lshlrev_b32 v26, 16, v55
v_and_b32 v27, 0xffff0000, v55
v_lshlrev_b32 v28, 16, v56
v_and_b32 v29, 0xffff0000, v56
v_lshlrev_b32 v30, 16, v57
v_and_b32 v31, 0xffff0000, v57
v_lshlrev_b32 v32, 16, v58
v_and_b32 v33, 0xffff0000, v58
v_lshlrev_b32 v34, 16, v59
v_and_b32 v35, 0xffff0000, v59
v_lshlrev_b32 v36, 16, v60
v_and_b32 v37, 0xffff0000, v60
v_lshlrev_b32 v38, 16, v61
v_and_b32 v39, 0xffff0000, v61
v_lshlrev_b32 v40, 16, v62
v_and_b32 v41, 0xffff0000, v62
v_lshlrev_b32 v42, 16, v63
v_and_b32 v43, 0xffff0000, v63
v_pk_add_f32 v[12:13], v[12:13], v[28:29]
v_pk_add_f32 v[14:15], v[14:15], v[30:31]
v_pk_add_f32 v[16:17], v[16:17], v[32:33]
v_pk_add_f32 v[18:19], v[18:19], v[34:35]
v_pk_add_f32 v[20:21], v[20:21], v[36:37]
v_pk_add_f32 v[22:23], v[22:23], v[38:39]
v_pk_add_f32 v[24:25], v[24:25], v[40:41]
v_pk_add_f32 v[26:27], v[26:27], v[42:43]
v_pk_add_f32 v[12:13], v[12:13], v[20:21]
v_pk_add_f32 v[14:15], v[14:15], v[22:23]
v_pk_add_f32 v[16:17], v[16:17], v[24:25]
v_pk_add_f32 v[18:19], v[18:19], v[26:27]
s_nop 0
v_permlane32_swap_b32 v12, v16
v_permlane32_swap_b32 v13, v17
v_permlane32_swap_b32 v14, v18
v_permlane32_swap_b32 v15, v19
v_pk_add_f32 v[12:13], v[12:13], v[16:17]
v_pk_add_f32 v[14:15], v[14:15], v[18:19]
s_nop 1
v_permlane16_swap_b32 v12, v14
v_permlane16_swap_b32 v13, v15
v_pk_add_f32 v[12:13], v[12:13], v[14:15]
s_nop 1
v_add_f32_dpp v12, v12, v12 row_ror:4 row_mask:0xf bank_mask:0xf
v_add_f32_dpp v13, v13, v13 row_ror:4 row_mask:0xf bank_mask:0xf
s_nop 0
v_add_f32_dpp v46, v12, v12 row_ror:8 row_mask:0xf bank_mask:0x3
v_add_f32_dpp v46, v13, v13 row_ror:8 row_mask:0xf bank_mask:0xc
v_cvt_pk_bf16_f32 v46, v46, v46
s_mov_b32 exec_lo, 0x0f0f0f0f
s_mov_b32 exec_hi, 0x0f0f0f0f
buffer_store_short v46, v45, s[72:75], s83 offen
s_mov_b64 exec, -1
s_cmp_lg_u32 s3, 0
s_cbranch_scc1 B_fin
ds_write_b32 v11, v11
s_waitcnt lgkmcnt(0)
B_fin:
B_end:
s_endpgm
H_start:
s_lshl_b32 s6, s8, 6
s_add_u32 s6, s6, s4
s_lshl_b32 s6, s6, 20
s_add_u32 s56, s20, s6
s_addc_u32 s57, s21, 0
s_mov_b32 s58, 34603008
s_mov_b32 s59, 0x20000
v_lshlrev_b32 v16, 7, v1
v_and_b32 v17, 4095, v16
v_add_u32 v16, 4096, v16
v_lshrrev_b32 v21, 5, v1
v_mul_u32_u24 v21, 20480, v21
v_add_u32 v17, v17, v21
s_and_b32 s6, s9, 56
v_and_b32 v19, 7, v1
v_add_u32 v19, s6, v19
v_mul_u32_u24 v19, 16, v19
v_add_u32 v19, 393216, v19
s_lshr_b32 s7, s4, 2
s_mul_i32 s7, s7, 4224
v_add_u32 v19, s7, v19
s_mov_b32 s16, 43
s_mov_b32 s17, 43
s_mov_b32 s18, 43
s_mov_b32 s31, 400000
buffer_load_dwordx3 v[12:14], v19, s[64:67], 0 offen sc1
s_waitcnt vmcnt(0)
H_loop:
v_med3_i32 v12, v12, -1, 31
v_med3_i32 v13, v13, -1, 31
v_med3_i32 v14, v14, -1, 31
v_add3_u32 v20, v12, v13, v14
s_nop 1
v_add_u32_dpp v20, v20, v20 row_ror:4 row_mask:0xf bank_mask:0xf
s_nop 1
v_add_u32_dpp v20, v20, v20 row_ror:2 row_mask:0xf bank_mask:0xf
s_nop 1
v_add_u32_dpp v20, v20, v20 row_ror:1 row_mask:0xf bank_mask:0xf
v_lshlrev_b32 v20, 3, v20
s_nop 0
v_readfirstlane_b32 s28, v20
v_readlane_b32 s20, v12, s9
v_readlane_b32 s21, v13, s9
v_readlane_b32 s22, v14, s9
buffer_load_dwordx3 v[12:14], v19, s[64:67], 0 offen sc1
s_mul_i32 s6, s20, 192
s_sub_i32 s24, s28, s6
s_mul_i32 s6, s16, 24
s_add_i32 s24, s24, s6
s_add_i32 s6, s16, -15
s_cmp_ge_i32 s6, s20
s_cselect_b32 s24, s24, -1048576
s_mul_i32 s6, s21, 192
s_sub_i32 s25, s28, s6
s_mul_i32 s6, s17, 24
s_add_i32 s25, s25, s6
s_add_i32 s6, s17, -15
s_cmp_ge_i32 s6, s21
s_cselect_b32 s25, s25, -1048576
s_mul_i32 s6, s22, 192
s_sub_i32 s26, s28, s6
s_mul_i32 s6, s18, 24
s_add_i32 s26, s26, s6
s_add_i32 s6, s18, -15
s_cmp_ge_i32 s6, s22
s_cselect_b32 s26, s26, -1048576
s_cmp_ge_i32 s24, s25
s_cselect_b32 s29, 0, 1
s_max_i32 s30, s24, s25
s_cmp_ge_i32 s30, s26
s_cselect_b32 s29, s29, 2
s_max_i32 s30, s30, s26
s_cmp_eq_i32 s30, -1048576
s_cbranch_scc1 H_end
s_sub_u32 s31, s31, 1
s_cmp_eq_u32 s31, 0
s_cbranch_scc1 H_end
s_cmp_lt_i32 s30, 1416
s_cbranch_scc1 H_idle
s_cmp_eq_u32 s29, 0
s_cselect_b32 s6, s16, s6
s_subb_u32 s16, s16, 0
s_cmp_eq_u32 s29, 1
s_cselect_b32 s6, s17, s6
s_subb_u32 s17, s17, 0
s_cmp_eq_u32 s29, 2
s_cselect_b32 s6, s18, s6
s_subb_u32 s18, s18, 0
s_mul_i32 s6, s6, 24576
s_sub_u32 s6, s6, 32768
s_cmp_eq_u32 s29, 2
s_cselect_b32 s7, 33554432, 0
s_add_u32 s6, s6, s7
s_cmp_eq_u32 s29, 1
s_cselect_b64 vcc, -1, 0
s_cselect_b32 s7, 25, 13
s_lshl_b32 s7, 1, s7
s_add_u32 s7, s7, s6
v_cndmask_b32 v18, v16, v17, vcc
buffer_load_dword v22, v18, s[56:59], s6 offen
buffer_load_dword v23, v18, s[56:59], s7 offen
s_waitcnt vmcnt(2)
s_branch H_loop
H_idle:
ds_read_b32 v21, v11
s_waitcnt vmcnt(0) lgkmcnt(0)
s_sleep 4
v_cmp_eq_u32 vcc, 0, v21
s_cbranch_vccnz H_loop
H_end:
s_branch B_end
.section .rodata,"a"
.p2align 6
.amdhsa_kernel concat_heads__mha_block_cached__compressed_kv_cla__decode_kernel
  .amdhsa_next_free_vgpr 512
  .amdhsa_next_free_sgpr 102
  .amdhsa_accum_offset 256
  .amdhsa_group_segment_fixed_size 0
  .amdhsa_kernarg_size 112
  .amdhsa_user_sgpr_count 2
  .amdhsa_user_sgpr_kernarg_segment_ptr 1
  .amdhsa_system_sgpr_workgroup_id_x 1
.end_amdhsa_kernel
```

```asm
; @launch grid=(256,1,1) block=(256,1,1) lds=163840
.amdgcn_target "amdgcn-amd-amdhsa--gfx950"
.text
.globl concat_heads__mha_block_cached__compressed_kv_cla__decode_kernel
.p2align 8
.type concat_heads__mha_block_cached__compressed_kv_cla__decode_kernel,@function
concat_heads__mha_block_cached__compressed_kv_cla__decode_kernel:
s_cmp_ge_u32 s2, 256
s_cbranch_scc1 L_exit
s_load_dwordx16 s[16:31], s[0:1], 0
s_load_dwordx8 s[32:39], s[0:1], 64
s_load_dwordx4 s[40:43], s[0:1], 96
v_lshrrev_b32 v1, 6, v0
s_nop 0
v_readfirstlane_b32 s3, v1
s_and_b32 s6, s2, 7
s_bfe_u32 s7, s2, 0x20003
s_lshl_b32 s4, s6, 2
s_add_u32 s4, s4, s7
s_lshr_b32 s5, s2, 5
s_cmp_lt_u32 s5, 2
s_cbranch_scc1 B_role
A_role:
s_sub_u32 s8, s5, 2
s_cmp_ge_u32 s8, 3
s_cselect_b32 s9, 1, 0
s_cselect_b32 s6, 3, 0
s_sub_u32 s8, s8, s6
s_lshl_b32 s11, s8, 2
s_add_u32 s11, s11, s3
s_cmp_ge_u32 s11, 6
s_cselect_b32 s83, 1, 0
s_cselect_b32 s6, -1, 1
s_add_u32 s11, s11, s6
s_cmp_ge_u32 s11, 6
s_cselect_b32 s6, 6, 0
s_sub_u32 s11, s11, s6
s_lshl_b32 s10, s9, 1
s_add_u32 s10, s10, s83
v_and_b32 v1, 63, v0
v_lshlrev_b32 v2, 4, v1
s_sub_u32 s14, s11, 8
s_lshl_b32 s14, s14, 12
s_mov_b32 s13, s14
s_add_u32 s13, s13, 24576
s_min_u32 s12, s13, 2146435072
s_lshl_b32 s82, s10, 5
s_add_u32 s82, s82, s4
s_lshl_b32 s6, s82, 20
s_waitcnt lgkmcnt(0)
s_add_u32 s52, s18, s6
s_addc_u32 s53, s19, 0
s_mov_b32 s54, 1048576
s_mov_b32 s55, 0x20000
s_add_u32 s56, s20, s6
s_addc_u32 s57, s21, 0
s_mov_b32 s58, 1048576
s_mov_b32 s59, 0x20000
s_mul_i32 s6, s9, 2304
s_mul_i32 s7, s3, 288
s_add_u32 s6, s6, s7
s_sub_u32 s7, 4608, s6
s_add_u32 s44, s16, s6
s_addc_u32 s45, s17, 0
s_mov_b32 s46, s7
s_mov_b32 s47, 0x20000
s_mul_i32 s6, s3, 1179648
s_lshl_b32 s7, s4, 8
s_add_u32 s6, s6, s7
s_sub_u32 s7, 4718592, s6
s_add_u32 s48, s22, s6
s_addc_u32 s49, s23, 0
s_mov_b32 s50, s7
s_mov_b32 s51, 0x20000
v_lshrrev_b32 v5, 4, v1
v_and_b32 v6, 15, v1
v_mul_u32_u24 v3, 294912, v5
v_lshl_add_u32 v3, v6, 4, v3
v_mul_u32_u24 v4, 72, v5
v_lshrrev_b32 v6, 3, v6
v_mul_u32_u24 v6, 1152, v6
v_add_u32 v4, v4, v6
v_mov_b32 v7, 7168
s_lshr_b32 s6, s2, 3
s_sub_u32 s6, s6, 8
s_lshl_b32 s6, s6, 2
s_add_u32 s6, s6, s3
s_mul_i32 s6, s6, 49152
s_and_b32 s7, s2, 7
s_lshl_b32 s7, s7, 10
s_add_u32 s6, s6, s7
s_mov_b32 s60, s22
s_mov_b32 s61, s23
s_mov_b32 s62, 4718592
s_mov_b32 s63, 0x20000
v_min_u32 v35, 47, v1
v_lshrrev_b32 v36, 3, v35
v_lshlrev_b32 v35, 7, v35
v_mad_u32_u24 v36, v36, v7, v35
buffer_load_dword v120, v36, s[60:63], s6 offen
buffer_load_dwordx4 v[40:43], v4, s[44:47], 0 offen offset:0
buffer_load_dwordx4 v[44:47], v4, s[44:47], 0 offen offset:16
buffer_load_dwordx4 v[48:51], v4, s[44:47], 0 offen offset:32
buffer_load_dwordx4 v[52:55], v4, s[44:47], 0 offen offset:48
buffer_load_dwordx2 v[56:57], v4, s[44:47], 0 offen offset:64
s_waitcnt vmcnt(54)
buffer_load_dwordx4 v[136:139], v2, s[52:55], s12 offen offset:0 nt
buffer_load_dwordx4 v[140:143], v2, s[52:55], s12 offen offset:1024 nt
buffer_load_dwordx4 v[144:147], v2, s[52:55], s12 offen offset:2048 nt
buffer_load_dwordx4 v[148:151], v2, s[52:55], s12 offen offset:3072 nt
s_add_u32 s13, s13, 24576
s_min_u32 s12, s13, 2146435072
s_waitcnt vmcnt(54)
buffer_load_dwordx4 v[152:155], v2, s[52:55], s12 offen offset:0 nt
buffer_load_dwordx4 v[156:159], v2, s[52:55], s12 offen offset:1024 nt
buffer_load_dwordx4 v[160:163], v2, s[52:55], s12 offen offset:2048 nt
buffer_load_dwordx4 v[164:167], v2, s[52:55], s12 offen offset:3072 nt
s_add_u32 s13, s13, 24576
s_min_u32 s12, s13, 2146435072
s_cmp_lg_u32 s8, 0
s_cbranch_scc1 L_nowq_1
s_waitcnt vmcnt(20)
s_mov_b32 s6, 0
buffer_load_dwordx4 a[96:99], v3, s[48:51], s6 offen
s_mov_b32 s6, 8192
buffer_load_dwordx4 a[100:103], v3, s[48:51], s6 offen
s_mov_b32 s6, 16384
buffer_load_dwordx4 a[104:107], v3, s[48:51], s6 offen
s_mov_b32 s6, 24576
buffer_load_dwordx4 a[108:111], v3, s[48:51], s6 offen
s_mov_b32 s6, 32768
buffer_load_dwordx4 a[112:115], v3, s[48:51], s6 offen
s_mov_b32 s6, 40960
buffer_load_dwordx4 a[116:119], v3, s[48:51], s6 offen
s_mov_b32 s6, 49152
buffer_load_dwordx4 a[120:123], v3, s[48:51], s6 offen
s_mov_b32 s6, 57344
buffer_load_dwordx4 a[124:127], v3, s[48:51], s6 offen
s_mov_b32 s6, 65536
buffer_load_dwordx4 a[128:131], v3, s[48:51], s6 offen
s_mov_b32 s6, 73728
buffer_load_dwordx4 a[132:135], v3, s[48:51], s6 offen
s_mov_b32 s6, 81920
buffer_load_dwordx4 a[136:139], v3, s[48:51], s6 offen
s_mov_b32 s6, 90112
buffer_load_dwordx4 a[140:143], v3, s[48:51], s6 offen
s_mov_b32 s6, 98304
buffer_load_dwordx4 a[144:147], v3, s[48:51], s6 offen
s_mov_b32 s6, 106496
buffer_load_dwordx4 a[148:151], v3, s[48:51], s6 offen
s_mov_b32 s6, 114688
buffer_load_dwordx4 a[152:155], v3, s[48:51], s6 offen
s_mov_b32 s6, 122880
buffer_load_dwordx4 a[156:159], v3, s[48:51], s6 offen
s_mov_b32 s6, 131072
buffer_load_dwordx4 a[160:163], v3, s[48:51], s6 offen
s_mov_b32 s6, 139264
buffer_load_dwordx4 a[164:167], v3, s[48:51], s6 offen
s_mov_b32 s6, 147456
buffer_load_dwordx4 a[168:171], v3, s[48:51], s6 offen
s_mov_b32 s6, 155648
buffer_load_dwordx4 a[172:175], v3, s[48:51], s6 offen
s_mov_b32 s6, 163840
buffer_load_dwordx4 a[176:179], v3, s[48:51], s6 offen
s_mov_b32 s6, 172032
buffer_load_dwordx4 a[180:183], v3, s[48:51], s6 offen
s_mov_b32 s6, 180224
buffer_load_dwordx4 a[184:187], v3, s[48:51], s6 offen
s_mov_b32 s6, 188416
buffer_load_dwordx4 a[188:191], v3, s[48:51], s6 offen
s_mov_b32 s6, 196608
buffer_load_dwordx4 a[192:195], v3, s[48:51], s6 offen
s_mov_b32 s6, 204800
buffer_load_dwordx4 a[196:199], v3, s[48:51], s6 offen
s_mov_b32 s6, 212992
buffer_load_dwordx4 a[200:203], v3, s[48:51], s6 offen
s_mov_b32 s6, 221184
buffer_load_dwordx4 a[204:207], v3, s[48:51], s6 offen
s_mov_b32 s6, 229376
buffer_load_dwordx4 a[208:211], v3, s[48:51], s6 offen
s_mov_b32 s6, 237568
buffer_load_dwordx4 a[212:215], v3, s[48:51], s6 offen
s_mov_b32 s6, 245760
buffer_load_dwordx4 a[216:219], v3, s[48:51], s6 offen
s_mov_b32 s6, 253952
buffer_load_dwordx4 a[220:223], v3, s[48:51], s6 offen
s_mov_b32 s6, 262144
buffer_load_dwordx4 a[224:227], v3, s[48:51], s6 offen
s_mov_b32 s6, 270336
buffer_load_dwordx4 a[228:231], v3, s[48:51], s6 offen
s_mov_b32 s6, 278528
buffer_load_dwordx4 a[232:235], v3, s[48:51], s6 offen
s_mov_b32 s6, 286720
buffer_load_dwordx4 a[236:239], v3, s[48:51], s6 offen
L_nowq_1:
s_waitcnt vmcnt(54)
buffer_load_dwordx4 v[168:171], v2, s[52:55], s12 offen offset:0 nt
buffer_load_dwordx4 v[172:175], v2, s[52:55], s12 offen offset:1024 nt
buffer_load_dwordx4 v[176:179], v2, s[52:55], s12 offen offset:2048 nt
buffer_load_dwordx4 v[180:183], v2, s[52:55], s12 offen offset:3072 nt
s_add_u32 s13, s13, 24576
s_min_u32 s12, s13, 2146435072
s_waitcnt vmcnt(54)
buffer_load_dwordx4 v[184:187], v2, s[52:55], s12 offen offset:0 nt
buffer_load_dwordx4 v[188:191], v2, s[52:55], s12 offen offset:1024 nt
buffer_load_dwordx4 v[192:195], v2, s[52:55], s12 offen offset:2048 nt
buffer_load_dwordx4 v[196:199], v2, s[52:55], s12 offen offset:3072 nt
s_add_u32 s13, s13, 24576
s_min_u32 s12, s13, 2146435072
s_waitcnt vmcnt(54)
buffer_load_dwordx4 v[200:203], v2, s[52:55], s12 offen offset:0 nt
buffer_load_dwordx4 v[204:207], v2, s[52:55], s12 offen offset:1024 nt
buffer_load_dwordx4 v[208:211], v2, s[52:55], s12 offen offset:2048 nt
buffer_load_dwordx4 v[212:215], v2, s[52:55], s12 offen offset:3072 nt
s_add_u32 s13, s13, 24576
s_min_u32 s12, s13, 2146435072
s_cmp_lg_u32 s8, 1
s_cbranch_scc1 L_nowq_2
s_waitcnt vmcnt(20)
s_mov_b32 s6, 0
buffer_load_dwordx4 a[96:99], v3, s[48:51], s6 offen
s_mov_b32 s6, 8192
buffer_load_dwordx4 a[100:103], v3, s[48:51], s6 offen
s_mov_b32 s6, 16384
buffer_load_dwordx4 a[104:107], v3, s[48:51], s6 offen
s_mov_b32 s6, 24576
buffer_load_dwordx4 a[108:111], v3, s[48:51], s6 offen
s_mov_b32 s6, 32768
buffer_load_dwordx4 a[112:115], v3, s[48:51], s6 offen
s_mov_b32 s6, 40960
buffer_load_dwordx4 a[116:119], v3, s[48:51], s6 offen
s_mov_b32 s6, 49152
buffer_load_dwordx4 a[120:123], v3, s[48:51], s6 offen
s_mov_b32 s6, 57344
buffer_load_dwordx4 a[124:127], v3, s[48:51], s6 offen
s_mov_b32 s6, 65536
buffer_load_dwordx4 a[128:131], v3, s[48:51], s6 offen
s_mov_b32 s6, 73728
buffer_load_dwordx4 a[132:135], v3, s[48:51], s6 offen
s_mov_b32 s6, 81920
buffer_load_dwordx4 a[136:139], v3, s[48:51], s6 offen
s_mov_b32 s6, 90112
buffer_load_dwordx4 a[140:143], v3, s[48:51], s6 offen
s_mov_b32 s6, 98304
buffer_load_dwordx4 a[144:147], v3, s[48:51], s6 offen
s_mov_b32 s6, 106496
buffer_load_dwordx4 a[148:151], v3, s[48:51], s6 offen
s_mov_b32 s6, 114688
buffer_load_dwordx4 a[152:155], v3, s[48:51], s6 offen
s_mov_b32 s6, 122880
buffer_load_dwordx4 a[156:159], v3, s[48:51], s6 offen
s_mov_b32 s6, 131072
buffer_load_dwordx4 a[160:163], v3, s[48:51], s6 offen
s_mov_b32 s6, 139264
buffer_load_dwordx4 a[164:167], v3, s[48:51], s6 offen
s_mov_b32 s6, 147456
buffer_load_dwordx4 a[168:171], v3, s[48:51], s6 offen
s_mov_b32 s6, 155648
buffer_load_dwordx4 a[172:175], v3, s[48:51], s6 offen
s_mov_b32 s6, 163840
buffer_load_dwordx4 a[176:179], v3, s[48:51], s6 offen
s_mov_b32 s6, 172032
buffer_load_dwordx4 a[180:183], v3, s[48:51], s6 offen
s_mov_b32 s6, 180224
buffer_load_dwordx4 a[184:187], v3, s[48:51], s6 offen
s_mov_b32 s6, 188416
buffer_load_dwordx4 a[188:191], v3, s[48:51], s6 offen
s_mov_b32 s6, 196608
buffer_load_dwordx4 a[192:195], v3, s[48:51], s6 offen
s_mov_b32 s6, 204800
buffer_load_dwordx4 a[196:199], v3, s[48:51], s6 offen
s_mov_b32 s6, 212992
buffer_load_dwordx4 a[200:203], v3, s[48:51], s6 offen
s_mov_b32 s6, 221184
buffer_load_dwordx4 a[204:207], v3, s[48:51], s6 offen
s_mov_b32 s6, 229376
buffer_load_dwordx4 a[208:211], v3, s[48:51], s6 offen
s_mov_b32 s6, 237568
buffer_load_dwordx4 a[212:215], v3, s[48:51], s6 offen
s_mov_b32 s6, 245760
buffer_load_dwordx4 a[216:219], v3, s[48:51], s6 offen
s_mov_b32 s6, 253952
buffer_load_dwordx4 a[220:223], v3, s[48:51], s6 offen
s_mov_b32 s6, 262144
buffer_load_dwordx4 a[224:227], v3, s[48:51], s6 offen
s_mov_b32 s6, 270336
buffer_load_dwordx4 a[228:231], v3, s[48:51], s6 offen
s_mov_b32 s6, 278528
buffer_load_dwordx4 a[232:235], v3, s[48:51], s6 offen
s_mov_b32 s6, 286720
buffer_load_dwordx4 a[236:239], v3, s[48:51], s6 offen
L_nowq_2:
s_waitcnt vmcnt(54)
buffer_load_dwordx4 v[216:219], v2, s[52:55], s12 offen offset:0 nt
buffer_load_dwordx4 v[220:223], v2, s[52:55], s12 offen offset:1024 nt
buffer_load_dwordx4 v[224:227], v2, s[52:55], s12 offen offset:2048 nt
buffer_load_dwordx4 v[228:231], v2, s[52:55], s12 offen offset:3072 nt
s_add_u32 s13, s13, 24576
s_min_u32 s12, s13, 2146435072
s_waitcnt vmcnt(54)
buffer_load_dwordx4 v[232:235], v2, s[52:55], s12 offen offset:0 nt
buffer_load_dwordx4 v[236:239], v2, s[52:55], s12 offen offset:1024 nt
buffer_load_dwordx4 v[240:243], v2, s[52:55], s12 offen offset:2048 nt
buffer_load_dwordx4 v[244:247], v2, s[52:55], s12 offen offset:3072 nt
s_add_u32 s13, s13, 24576
s_min_u32 s12, s13, 2146435072
s_waitcnt vmcnt(54)
s_add_u32 s34, s14, 24576
s_min_u32 s34, s34, 2146435072
buffer_load_dwordx4 a[0:3], v2, s[56:59], s34 offen offset:0 nt
buffer_load_dwordx4 a[4:7], v2, s[56:59], s34 offen offset:1024 nt
buffer_load_dwordx4 a[8:11], v2, s[56:59], s34 offen offset:2048 nt
buffer_load_dwordx4 a[12:15], v2, s[56:59], s34 offen offset:3072 nt
s_cmp_lg_u32 s8, 2
s_cbranch_scc1 L_nowq_3
s_waitcnt vmcnt(20)
s_mov_b32 s6, 0
buffer_load_dwordx4 a[96:99], v3, s[48:51], s6 offen
s_mov_b32 s6, 8192
buffer_load_dwordx4 a[100:103], v3, s[48:51], s6 offen
s_mov_b32 s6, 16384
buffer_load_dwordx4 a[104:107], v3, s[48:51], s6 offen
s_mov_b32 s6, 24576
buffer_load_dwordx4 a[108:111], v3, s[48:51], s6 offen
s_mov_b32 s6, 32768
buffer_load_dwordx4 a[112:115], v3, s[48:51], s6 offen
s_mov_b32 s6, 40960
buffer_load_dwordx4 a[116:119], v3, s[48:51], s6 offen
s_mov_b32 s6, 49152
buffer_load_dwordx4 a[120:123], v3, s[48:51], s6 offen
s_mov_b32 s6, 57344
buffer_load_dwordx4 a[124:127], v3, s[48:51], s6 offen
s_mov_b32 s6, 65536
buffer_load_dwordx4 a[128:131], v3, s[48:51], s6 offen
s_mov_b32 s6, 73728
buffer_load_dwordx4 a[132:135], v3, s[48:51], s6 offen
s_mov_b32 s6, 81920
buffer_load_dwordx4 a[136:139], v3, s[48:51], s6 offen
s_mov_b32 s6, 90112
buffer_load_dwordx4 a[140:143], v3, s[48:51], s6 offen
s_mov_b32 s6, 98304
buffer_load_dwordx4 a[144:147], v3, s[48:51], s6 offen
s_mov_b32 s6, 106496
buffer_load_dwordx4 a[148:151], v3, s[48:51], s6 offen
s_mov_b32 s6, 114688
buffer_load_dwordx4 a[152:155], v3, s[48:51], s6 offen
s_mov_b32 s6, 122880
buffer_load_dwordx4 a[156:159], v3, s[48:51], s6 offen
s_mov_b32 s6, 131072
buffer_load_dwordx4 a[160:163], v3, s[48:51], s6 offen
s_mov_b32 s6, 139264
buffer_load_dwordx4 a[164:167], v3, s[48:51], s6 offen
s_mov_b32 s6, 147456
buffer_load_dwordx4 a[168:171], v3, s[48:51], s6 offen
s_mov_b32 s6, 155648
buffer_load_dwordx4 a[172:175], v3, s[48:51], s6 offen
s_mov_b32 s6, 163840
buffer_load_dwordx4 a[176:179], v3, s[48:51], s6 offen
s_mov_b32 s6, 172032
buffer_load_dwordx4 a[180:183], v3, s[48:51], s6 offen
s_mov_b32 s6, 180224
buffer_load_dwordx4 a[184:187], v3, s[48:51], s6 offen
s_mov_b32 s6, 188416
buffer_load_dwordx4 a[188:191], v3, s[48:51], s6 offen
s_mov_b32 s6, 196608
buffer_load_dwordx4 a[192:195], v3, s[48:51], s6 offen
s_mov_b32 s6, 204800
buffer_load_dwordx4 a[196:199], v3, s[48:51], s6 offen
s_mov_b32 s6, 212992
buffer_load_dwordx4 a[200:203], v3, s[48:51], s6 offen
s_mov_b32 s6, 221184
buffer_load_dwordx4 a[204:207], v3, s[48:51], s6 offen
s_mov_b32 s6, 229376
buffer_load_dwordx4 a[208:211], v3, s[48:51], s6 offen
s_mov_b32 s6, 237568
buffer_load_dwordx4 a[212:215], v3, s[48:51], s6 offen
s_mov_b32 s6, 245760
buffer_load_dwordx4 a[216:219], v3, s[48:51], s6 offen
s_mov_b32 s6, 253952
buffer_load_dwordx4 a[220:223], v3, s[48:51], s6 offen
s_mov_b32 s6, 262144
buffer_load_dwordx4 a[224:227], v3, s[48:51], s6 offen
s_mov_b32 s6, 270336
buffer_load_dwordx4 a[228:231], v3, s[48:51], s6 offen
s_mov_b32 s6, 278528
buffer_load_dwordx4 a[232:235], v3, s[48:51], s6 offen
s_mov_b32 s6, 286720
buffer_load_dwordx4 a[236:239], v3, s[48:51], s6 offen
L_nowq_3:
s_mov_b32 s64, s42
s_mov_b32 s65, s43
s_mov_b32 s66, 16777216
s_mov_b32 s67, 0x20000
s_mov_b32 s68, s40
s_mov_b32 s69, s41
s_mov_b32 s70, 256
s_mov_b32 s71, 0x20000
s_mul_i32 s6, s4, 147456
s_add_u32 s60, s24, s6
s_addc_u32 s61, s25, 0
s_mov_b32 s62, 147456
s_mov_b32 s63, 0x20000
v_and_b32 v5, 1, v1
v_lshlrev_b32 v5, 4, v5
v_mov_b32 v6, 0xffff
v_lshlrev_b32 v5, v5, v6
v_bfe_u32 v6, v1, 1, 2
v_cmp_eq_u32 vcc, 0, v6
s_nop 1
v_cndmask_b32 v8, 0, v5, vcc
v_cmp_eq_u32 vcc, 1, v6
s_nop 1
v_cndmask_b32 v9, 0, v5, vcc
v_cmp_eq_u32 vcc, 2, v6
s_nop 1
v_cndmask_b32 v10, 0, v5, vcc
v_cmp_eq_u32 vcc, 3, v6
s_nop 1
v_cndmask_b32 v11, 0, v5, vcc
v_mov_b32 v5, 0x0c0c0c0c
s_mov_b32 s6, 0x01000100
s_mov_b32 s7, 0x03020302
v_bfi_b32 v12, v8, s6, v5
v_bfi_b32 v13, v9, s6, v5
v_bfi_b32 v14, v10, s6, v5
v_bfi_b32 v15, v11, s6, v5
v_bfi_b32 v16, v8, s7, v5
v_bfi_b32 v17, v9, s7, v5
v_bfi_b32 v18, v10, s7, v5
v_bfi_b32 v19, v11, s7, v5
v_mov_b32 v7, 0x3e0293ee
v_mov_b32 v86, 0xff800000
v_lshrrev_b32 v5, 4, v1
v_lshlrev_b32 v5, 3, v5
v_bfe_u32 v6, v1, 2, 2
v_add_u32 v5, v5, v6
v_mul_u32_u24 v5, 1152, v5
s_mul_i32 s6, s3, 288
v_add_u32 v5, s6, v5
v_and_b32 v6, 3, v1
v_lshl_add_u32 v88, v6, 5, v5
v_lshl_add_u32 v89, v6, 3, v5
v_add_u32 v89, 256, v89
v_bfe_u32 v6, v1, 3, 1
v_mul_u32_u24 v6, 2176, v6
v_sub_u32 v88, v88, v6
v_lshrrev_b32 v6, 4, v1
v_mul_u32_u24 v6, 4608, v6
v_sub_u32 v88, v88, v6
v_add_u32 v90, 73728, v88
v_add_u32 v91, 73728, v89
s_mul_i32 s82, s82, 64
s_add_u32 s82, s82, 327680
s_mov_b64 s[72:73], 0
s_cmp_ge_u32 s11, 2
s_cselect_b32 s74, 0x22222222, 0
s_mov_b32 s75, s74
s_mov_b32 s76, 0x44444444
s_mov_b32 s77, s76
s_mov_b32 s78, 0x88888888
s_mov_b32 s79, s78
v_bfe_u32 v5, v1, 4, 1
s_lshl_b32 s6, s9, 7
s_lshl_b32 s7, s4, 1
s_add_u32 s6, s6, s7
s_add_u32 s6, s6, s8
v_mul_u32_u24 v6, 63, v5
v_add_u32 v6, s6, v6
v_mul_u32_u24 v92, 1152, v6
v_add_u32 v92, 4194304, v92
v_sub_u32 v6, s8, v5
v_cmp_lt_u32 vcc, 1, v6
v_mov_b32 v6, 2146435072
s_nop 0
v_cndmask_b32 v92, v92, v6, vcc
v_and_b32 v35, 15, v1
v_lshl_add_u32 v92, v35, 4, v92
s_lshl_b32 s6, s3, 5
v_add_u32 v93, s6, v92
s_lshl_b32 s6, s3, 8
v_add_u32 v92, s6, v92
s_lshl_b32 s6, s8, 2
s_add_u32 s6, s6, 0
s_cmp_ge_u32 s6, 6
s_cselect_b32 s6, 1, 0
v_cmp_eq_u32 vcc, s6, v5
s_nop 1
v_cndmask_b32 v106, 0, 1.0, vcc
s_lshl_b32 s6, s8, 2
s_add_u32 s6, s6, 1
s_cmp_ge_u32 s6, 6
s_cselect_b32 s6, 1, 0
v_cmp_eq_u32 vcc, s6, v5
s_nop 1
v_cndmask_b32 v107, 0, 1.0, vcc
s_lshl_b32 s6, s8, 2
s_add_u32 s6, s6, 2
s_cmp_ge_u32 s6, 6
s_cselect_b32 s6, 1, 0
v_cmp_eq_u32 vcc, s6, v5
s_nop 1
v_cndmask_b32 v108, 0, 1.0, vcc
s_lshl_b32 s6, s8, 2
s_add_u32 s6, s6, 3
s_cmp_ge_u32 s6, 6
s_cselect_b32 s6, 1, 0
v_cmp_eq_u32 vcc, s6, v5
s_nop 1
v_cndmask_b32 v109, 0, 1.0, vcc
v_bfe_i32 v35, v1, 3, 1
v_and_b32 v35, 0xaaaaaaaa, v35
v_or_b32 v105, 0x44444444, v35
v_and_b32 v35, 15, v1
v_lshlrev_b32 v35, 4, v35
v_lshl_add_u32 v94, v5, 3, v35
s_lshl_b32 s6, s3, 8
s_add_u32 s6, s6, 151552
v_add_u32 v94, s6, v94
v_and_b32 v35, 3, v1
v_lshlrev_b32 v35, 8, v35
v_lshrrev_b32 v36, 4, v1
v_lshl_add_u32 v95, v36, 4, v35
v_add_u32 v95, 151552, v95
s_mul_i32 s15, s3, 36864
s_mov_b32 s80, 0x0
s_mov_b32 s81, 0
s_lshl_b32 s6, s4, 1
s_add_u32 s6, s6, s9
s_mul_i32 s6, s6, 4
s_add_u32 s6, s6, s8
s_lshl_b32 s6, s6, 2
s_add_u32 s6, s6, 393216
s_lshr_b32 s7, s4, 2
s_mul_i32 s7, s7, 4224
s_add_u32 s6, s6, s7
v_mov_b32 v118, 2146435072
v_mov_b32 v117, s6
v_cmp_eq_u32 vcc, 0, v0
s_nop 1
v_cndmask_b32 v118, v118, v117, vcc
v_mov_b32 v117, 3
v_and_b32 v35, 15, v1
v_lshlrev_b32 v35, 5, v35
v_lshl_add_u32 v36, v5, 4, v35
v_lshrrev_b32 v6, 5, v1
v_lshl_add_u32 v36, v6, 9, v36
s_lshl_b32 s6, s3, 10
s_add_u32 s6, s6, 147456
v_add_u32 v36, s6, v36
s_lshl_b32 s6, s83, 9
s_add_u32 s6, s6, 147456
v_add_u32 v35, s6, v35
s_waitcnt vmcnt(35)
v_perm_b32 v60, v40, v40, v12
v_perm_b32 v61, v40, v40, v13
v_perm_b32 v62, v40, v40, v14
v_perm_b32 v63, v40, v40, v15
s_nop 1
v_mfma_f32_16x16x32_bf16 v[20:23], v[60:63], a[96:99], 0
s_add_u32 s34, s14, 49152
s_min_u32 s34, s34, 2146435072
buffer_load_dwordx4 a[16:19], v2, s[56:59], s34 offen offset:0 nt
s_waitcnt vmcnt(35)
v_perm_b32 v64, v40, v40, v16
v_perm_b32 v65, v40, v40, v17
v_perm_b32 v66, v40, v40, v18
v_perm_b32 v67, v40, v40, v19
s_nop 1
v_mfma_f32_16x16x32_bf16 v[20:23], v[64:67], a[100:103], v[20:23]
buffer_load_dwordx4 a[20:23], v2, s[56:59], s34 offen offset:1024 nt
s_waitcnt vmcnt(35)
v_perm_b32 v68, v41, v41, v12
v_perm_b32 v69, v41, v41, v13
v_perm_b32 v70, v41, v41, v14
v_perm_b32 v71, v41, v41, v15
s_nop 1
v_mfma_f32_16x16x32_bf16 v[20:23], v[68:71], a[104:107], v[20:23]
buffer_load_dwordx4 a[24:27], v2, s[56:59], s34 offen offset:2048 nt
s_waitcnt vmcnt(35)
v_perm_b32 v72, v41, v41, v16
v_perm_b32 v73, v41, v41, v17
v_perm_b32 v74, v41, v41, v18
v_perm_b32 v75, v41, v41, v19
s_nop 1
v_mfma_f32_16x16x32_bf16 v[20:23], v[72:75], a[108:111], v[20:23]
buffer_load_dwordx4 a[28:31], v2, s[56:59], s34 offen offset:3072 nt
s_waitcnt vmcnt(35)
v_perm_b32 v60, v42, v42, v12
v_perm_b32 v61, v42, v42, v13
v_perm_b32 v62, v42, v42, v14
v_perm_b32 v63, v42, v42, v15
s_nop 1
v_mfma_f32_16x16x32_bf16 v[20:23], v[60:63], a[112:115], v[20:23]
s_add_u32 s34, s14, 73728
s_min_u32 s34, s34, 2146435072
buffer_load_dwordx4 a[32:35], v2, s[56:59], s34 offen offset:0 nt
s_waitcnt vmcnt(35)
v_perm_b32 v64, v42, v42, v16
v_perm_b32 v65, v42, v42, v17
v_perm_b32 v66, v42, v42, v18
v_perm_b32 v67, v42, v42, v19
s_nop 1
v_mfma_f32_16x16x32_bf16 v[20:23], v[64:67], a[116:119], v[20:23]
buffer_load_dwordx4 a[36:39], v2, s[56:59], s34 offen offset:1024 nt
s_waitcnt vmcnt(35)
v_perm_b32 v68, v43, v43, v12
v_perm_b32 v69, v43, v43, v13
v_perm_b32 v70, v43, v43, v14
v_perm_b32 v71, v43, v43, v15
s_nop 1
v_mfma_f32_16x16x32_bf16 v[20:23], v[68:71], a[120:123], v[20:23]
buffer_load_dwordx4 a[40:43], v2, s[56:59], s34 offen offset:2048 nt
s_waitcnt vmcnt(35)
v_perm_b32 v72, v43, v43, v16
v_perm_b32 v73, v43, v43, v17
v_perm_b32 v74, v43, v43, v18
v_perm_b32 v75, v43, v43, v19
s_nop 1
v_mfma_f32_16x16x32_bf16 v[20:23], v[72:75], a[124:127], v[20:23]
buffer_load_dwordx4 a[44:47], v2, s[56:59], s34 offen offset:3072 nt
s_waitcnt vmcnt(35)
v_perm_b32 v60, v44, v44, v12
v_perm_b32 v61, v44, v44, v13
v_perm_b32 v62, v44, v44, v14
v_perm_b32 v63, v44, v44, v15
s_nop 1
v_mfma_f32_16x16x32_bf16 v[20:23], v[60:63], a[128:131], v[20:23]
s_add_u32 s34, s14, 98304
s_min_u32 s34, s34, 2146435072
buffer_load_dwordx4 a[48:51], v2, s[56:59], s34 offen offset:0 nt
s_waitcnt vmcnt(35)
v_perm_b32 v64, v44, v44, v16
v_perm_b32 v65, v44, v44, v17
v_perm_b32 v66, v44, v44, v18
v_perm_b32 v67, v44, v44, v19
s_nop 1
v_mfma_f32_16x16x32_bf16 v[20:23], v[64:67], a[132:135], v[20:23]
buffer_load_dwordx4 a[52:55], v2, s[56:59], s34 offen offset:1024 nt
s_waitcnt vmcnt(35)
v_perm_b32 v68, v45, v45, v12
v_perm_b32 v69, v45, v45, v13
v_perm_b32 v70, v45, v45, v14
v_perm_b32 v71, v45, v45, v15
s_nop 1
v_mfma_f32_16x16x32_bf16 v[20:23], v[68:71], a[136:139], v[20:23]
buffer_load_dwordx4 a[56:59], v2, s[56:59], s34 offen offset:2048 nt
s_waitcnt vmcnt(35)
v_perm_b32 v72, v45, v45, v16
v_perm_b32 v73, v45, v45, v17
v_perm_b32 v74, v45, v45, v18
v_perm_b32 v75, v45, v45, v19
s_nop 1
v_mfma_f32_16x16x32_bf16 v[20:23], v[72:75], a[140:143], v[20:23]
buffer_load_dwordx4 a[60:63], v2, s[56:59], s34 offen offset:3072 nt
s_waitcnt vmcnt(35)
v_perm_b32 v60, v46, v46, v12
v_perm_b32 v61, v46, v46, v13
v_perm_b32 v62, v46, v46, v14
v_perm_b32 v63, v46, v46, v15
s_nop 1
v_mfma_f32_16x16x32_bf16 v[20:23], v[60:63], a[144:147], v[20:23]
s_add_u32 s34, s14, 122880
s_min_u32 s34, s34, 2146435072
buffer_load_dwordx4 a[64:67], v2, s[56:59], s34 offen offset:0 nt
s_waitcnt vmcnt(35)
v_perm_b32 v64, v46, v46, v16
v_perm_b32 v65, v46, v46, v17
v_perm_b32 v66, v46, v46, v18
v_perm_b32 v67, v46, v46, v19
s_nop 1
v_mfma_f32_16x16x32_bf16 v[20:23], v[64:67], a[148:151], v[20:23]
buffer_load_dwordx4 a[68:71], v2, s[56:59], s34 offen offset:1024 nt
s_waitcnt vmcnt(35)
v_perm_b32 v68, v47, v47, v12
v_perm_b32 v69, v47, v47, v13
v_perm_b32 v70, v47, v47, v14
v_perm_b32 v71, v47, v47, v15
s_nop 1
v_mfma_f32_16x16x32_bf16 v[20:23], v[68:71], a[152:155], v[20:23]
buffer_load_dwordx4 a[72:75], v2, s[56:59], s34 offen offset:2048 nt
s_waitcnt vmcnt(35)
v_perm_b32 v72, v47, v47, v16
v_perm_b32 v73, v47, v47, v17
v_perm_b32 v74, v47, v47, v18
v_perm_b32 v75, v47, v47, v19
s_nop 1
v_mfma_f32_16x16x32_bf16 v[20:23], v[72:75], a[156:159], v[20:23]
buffer_load_dwordx4 a[76:79], v2, s[56:59], s34 offen offset:3072 nt
s_waitcnt vmcnt(35)
v_perm_b32 v60, v48, v48, v12
v_perm_b32 v61, v48, v48, v13
v_perm_b32 v62, v48, v48, v14
v_perm_b32 v63, v48, v48, v15
s_nop 1
v_mfma_f32_16x16x32_bf16 v[20:23], v[60:63], a[160:163], v[20:23]
s_add_u32 s34, s14, 147456
s_min_u32 s34, s34, 2146435072
buffer_load_dwordx4 a[80:83], v2, s[56:59], s34 offen offset:0 nt
s_waitcnt vmcnt(35)
v_perm_b32 v64, v48, v48, v16
v_perm_b32 v65, v48, v48, v17
v_perm_b32 v66, v48, v48, v18
v_perm_b32 v67, v48, v48, v19
s_nop 1
v_mfma_f32_16x16x32_bf16 v[20:23], v[64:67], a[164:167], v[20:23]
buffer_load_dwordx4 a[84:87], v2, s[56:59], s34 offen offset:1024 nt
s_waitcnt vmcnt(35)
v_perm_b32 v68, v49, v49, v12
v_perm_b32 v69, v49, v49, v13
v_perm_b32 v70, v49, v49, v14
v_perm_b32 v71, v49, v49, v15
s_nop 1
v_mfma_f32_16x16x32_bf16 v[20:23], v[68:71], a[168:171], v[20:23]
buffer_load_dwordx4 a[88:91], v2, s[56:59], s34 offen offset:2048 nt
s_waitcnt vmcnt(35)
v_perm_b32 v72, v49, v49, v16
v_perm_b32 v73, v49, v49, v17
v_perm_b32 v74, v49, v49, v18
v_perm_b32 v75, v49, v49, v19
s_nop 1
v_mfma_f32_16x16x32_bf16 v[20:23], v[72:75], a[172:175], v[20:23]
buffer_load_dwordx4 a[92:95], v2, s[56:59], s34 offen offset:3072 nt
s_waitcnt vmcnt(35)
v_perm_b32 v60, v50, v50, v12
v_perm_b32 v61, v50, v50, v13
v_perm_b32 v62, v50, v50, v14
v_perm_b32 v63, v50, v50, v15
s_nop 1
v_mfma_f32_16x16x32_bf16 v[20:23], v[60:63], a[176:179], v[20:23]
s_add_u32 s34, s14, 172032
s_min_u32 s34, s34, 2146435072
buffer_load_dwordx4 a[240:243], v2, s[56:59], s34 offen offset:0 nt
s_waitcnt vmcnt(35)
v_perm_b32 v64, v50, v50, v16
v_perm_b32 v65, v50, v50, v17
v_perm_b32 v66, v50, v50, v18
v_perm_b32 v67, v50, v50, v19
s_nop 1
v_mfma_f32_16x16x32_bf16 v[20:23], v[64:67], a[180:183], v[20:23]
buffer_load_dwordx4 a[244:247], v2, s[56:59], s34 offen offset:1024 nt
s_waitcnt vmcnt(35)
v_perm_b32 v68, v51, v51, v12
v_perm_b32 v69, v51, v51, v13
v_perm_b32 v70, v51, v51, v14
v_perm_b32 v71, v51, v51, v15
s_nop 1
v_mfma_f32_16x16x32_bf16 v[20:23], v[68:71], a[184:187], v[20:23]
buffer_load_dwordx4 a[248:251], v2, s[56:59], s34 offen offset:2048 nt
s_waitcnt vmcnt(35)
v_perm_b32 v72, v51, v51, v16
v_perm_b32 v73, v51, v51, v17
v_perm_b32 v74, v51, v51, v18
v_perm_b32 v75, v51, v51, v19
s_nop 1
v_mfma_f32_16x16x32_bf16 v[20:23], v[72:75], a[188:191], v[20:23]
buffer_load_dwordx4 a[252:255], v2, s[56:59], s34 offen offset:3072 nt
s_waitcnt vmcnt(35)
v_perm_b32 v60, v52, v52, v12
v_perm_b32 v61, v52, v52, v13
v_perm_b32 v62, v52, v52, v14
v_perm_b32 v63, v52, v52, v15
s_nop 1
v_mfma_f32_16x16x32_bf16 v[20:23], v[60:63], a[192:195], v[20:23]
s_waitcnt vmcnt(34)
v_perm_b32 v64, v52, v52, v16
v_perm_b32 v65, v52, v52, v17
v_perm_b32 v66, v52, v52, v18
v_perm_b32 v67, v52, v52, v19
s_nop 1
v_mfma_f32_16x16x32_bf16 v[20:23], v[64:67], a[196:199], v[20:23]
s_waitcnt vmcnt(33)
v_perm_b32 v68, v53, v53, v12
v_perm_b32 v69, v53, v53, v13
v_perm_b32 v70, v53, v53, v14
v_perm_b32 v71, v53, v53, v15
s_nop 1
v_mfma_f32_16x16x32_bf16 v[20:23], v[68:71], a[200:203], v[20:23]
s_waitcnt vmcnt(32)
v_perm_b32 v72, v53, v53, v16
v_perm_b32 v73, v53, v53, v17
v_perm_b32 v74, v53, v53, v18
v_perm_b32 v75, v53, v53, v19
s_nop 1
v_mfma_f32_16x16x32_bf16 v[20:23], v[72:75], a[204:207], v[20:23]
s_waitcnt vmcnt(31)
v_perm_b32 v60, v54, v54, v12
v_perm_b32 v61, v54, v54, v13
v_perm_b32 v62, v54, v54, v14
v_perm_b32 v63, v54, v54, v15
s_nop 1
v_mfma_f32_16x16x32_bf16 v[20:23], v[60:63], a[208:211], v[20:23]
s_waitcnt vmcnt(30)
v_perm_b32 v64, v54, v54, v16
v_perm_b32 v65, v54, v54, v17
v_perm_b32 v66, v54, v54, v18
v_perm_b32 v67, v54, v54, v19
s_nop 1
v_mfma_f32_16x16x32_bf16 v[20:23], v[64:67], a[212:215], v[20:23]
s_waitcnt vmcnt(29)
v_perm_b32 v68, v55, v55, v12
v_perm_b32 v69, v55, v55, v13
v_perm_b32 v70, v55, v55, v14
v_perm_b32 v71, v55, v55, v15
s_nop 1
v_mfma_f32_16x16x32_bf16 v[20:23], v[68:71], a[216:219], v[20:23]
s_waitcnt vmcnt(28)
v_perm_b32 v72, v55, v55, v16
v_perm_b32 v73, v55, v55, v17
v_perm_b32 v74, v55, v55, v18
v_perm_b32 v75, v55, v55, v19
s_nop 1
v_mfma_f32_16x16x32_bf16 v[20:23], v[72:75], a[220:223], v[20:23]
s_waitcnt vmcnt(27)
v_perm_b32 v60, v56, v56, v12
v_perm_b32 v61, v56, v56, v13
v_perm_b32 v62, v56, v56, v14
v_perm_b32 v63, v56, v56, v15
s_nop 1
v_mfma_f32_16x16x32_bf16 v[20:23], v[60:63], a[224:227], v[20:23]
s_waitcnt vmcnt(26)
v_perm_b32 v64, v56, v56, v16
v_perm_b32 v65, v56, v56, v17
v_perm_b32 v66, v56, v56, v18
v_perm_b32 v67, v56, v56, v19
s_nop 1
v_mfma_f32_16x16x32_bf16 v[20:23], v[64:67], a[228:231], v[20:23]
s_waitcnt vmcnt(25)
v_perm_b32 v68, v57, v57, v12
v_perm_b32 v69, v57, v57, v13
v_perm_b32 v70, v57, v57, v14
v_perm_b32 v71, v57, v57, v15
s_nop 1
v_mfma_f32_16x16x32_bf16 v[20:23], v[68:71], a[232:235], v[20:23]
s_waitcnt vmcnt(24)
v_perm_b32 v72, v57, v57, v16
v_perm_b32 v73, v57, v57, v17
v_perm_b32 v74, v57, v57, v18
v_perm_b32 v75, v57, v57, v19
s_nop 1
v_mfma_f32_16x16x32_bf16 v[20:23], v[72:75], a[236:239], v[20:23]
s_nop 7
ds_write_b128 v36, v[20:23]
s_waitcnt lgkmcnt(0)
s_barrier
ds_read_b128 v[40:43], v35 offset:0
ds_read_b128 v[44:47], v35 offset:16
ds_read_b128 v[48:51], v35 offset:1024
ds_read_b128 v[52:55], v35 offset:1040
ds_read_b128 v[56:59], v35 offset:2048
ds_read_b128 v[60:63], v35 offset:2064
ds_read_b128 v[64:67], v35 offset:3072
ds_read_b128 v[68:71], v35 offset:3088
v_mov_b32 v20, 0
v_mov_b32 v21, 0
v_mov_b32 v22, 0
v_mov_b32 v23, 0
s_waitcnt lgkmcnt(0)
v_add_f32 v40, v40, v48
v_add_f32 v56, v56, v64
v_add_f32 v41, v41, v49
v_add_f32 v57, v57, v65
v_add_f32 v42, v42, v50
v_add_f32 v58, v58, v66
v_add_f32 v43, v43, v51
v_add_f32 v59, v59, v67
v_add_f32 v44, v44, v52
v_add_f32 v60, v60, v68
v_add_f32 v45, v45, v53
v_add_f32 v61, v61, v69
v_add_f32 v46, v46, v54
v_add_f32 v62, v62, v70
v_add_f32 v47, v47, v55
v_add_f32 v63, v63, v71
v_add_f32 v40, v40, v56
v_add_f32 v41, v41, v57
v_add_f32 v42, v42, v58
v_add_f32 v43, v43, v59
v_add_f32 v44, v44, v60
v_add_f32 v45, v45, v61
v_add_f32 v46, v46, v62
v_add_f32 v47, v47, v63
v_cvt_pk_bf16_f32 v24, v40, v41
v_cvt_pk_bf16_f32 v25, v42, v43
v_cvt_pk_bf16_f32 v26, v44, v45
v_cvt_pk_bf16_f32 v27, v46, v47
s_add_u32 s14, s14, 196608
K_loop:
s_cmp_lg_u32 s81, 8
s_cbranch_scc1 L_c0_4
buffer_load_dword v96, off, s[68:71], 0 offset:0 sc1
L_c0_4:
s_waitcnt vmcnt(28)
v_dot2_f32_bf16 v28, v120, v24, 0
v_dot2_f32_bf16 v29, v124, v24, 0
v_dot2_f32_bf16 v30, v128, v24, 0
v_dot2_f32_bf16 v31, v132, v24, 0
v_dot2_f32_bf16 v28, v121, v25, v28
v_dot2_f32_bf16 v29, v125, v25, v29
v_dot2_f32_bf16 v30, v129, v25, v30
v_dot2_f32_bf16 v31, v133, v25, v31
v_dot2_f32_bf16 v28, v122, v26, v28
v_dot2_f32_bf16 v29, v126, v26, v29
v_dot2_f32_bf16 v30, v130, v26, v30
v_dot2_f32_bf16 v31, v134, v26, v31
v_dot2_f32_bf16 v28, v123, v27, v28
v_dot2_f32_bf16 v29, v127, v27, v29
v_dot2_f32_bf16 v30, v131, v27, v30
v_dot2_f32_bf16 v31, v135, v27, v31
buffer_load_dwordx4 v[120:123], v2, s[52:55], s12 offen offset:0 nt
buffer_load_dwordx4 v[124:127], v2, s[52:55], s12 offen offset:1024 nt
buffer_load_dwordx4 v[128:131], v2, s[52:55], s12 offen offset:2048 nt
buffer_load_dwordx4 v[132:135], v2, s[52:55], s12 offen offset:3072 nt
s_add_u32 s13, s13, 24576
s_min_u32 s12, s13, 2146435072
s_cmp_ge_u32 s80, 36
s_cbranch_scc1 L_nodma_5
s_mov_b32 m0, s15
s_nop 0
buffer_load_dwordx4 v2, s[60:63], s15 offen  lds
s_add_u32 s15, s15, 1024
L_nodma_5:
s_add_u32 s80, s80, 1
v_add_f32_dpp v32, v28, v28 row_ror:8 row_mask:0xf bank_mask:0x3
v_add_f32_dpp v33, v29, v29 row_ror:8 row_mask:0xf bank_mask:0x3
v_add_f32_dpp v32, v30, v30 row_ror:8 row_mask:0xf bank_mask:0xc
v_add_f32_dpp v33, v31, v31 row_ror:8 row_mask:0xf bank_mask:0xc
s_nop 0
v_add_f32_dpp v34, v32, v32 row_half_mirror row_mask:0xf bank_mask:0x5
v_add_f32_dpp v34, v33, v33 row_half_mirror row_mask:0xf bank_mask:0xa
s_nop 1
v_add_f32_dpp v34, v34, v34 quad_perm:[1,0,3,2] row_mask:0xf bank_mask:0xf
s_nop 1
v_add_f32_dpp v34, v34, v34 quad_perm:[2,3,0,1] row_mask:0xf bank_mask:0xf
v_cndmask_b32 v86, v86, v34, s[72:73]
s_waitcnt vmcnt(28)
v_dot2_f32_bf16 v28, v136, v24, 0
v_dot2_f32_bf16 v29, v140, v24, 0
v_dot2_f32_bf16 v30, v144, v24, 0
v_dot2_f32_bf16 v31, v148, v24, 0
v_dot2_f32_bf16 v28, v137, v25, v28
v_dot2_f32_bf16 v29, v141, v25, v29
v_dot2_f32_bf16 v30, v145, v25, v30
v_dot2_f32_bf16 v31, v149, v25, v31
v_dot2_f32_bf16 v28, v138, v26, v28
v_dot2_f32_bf16 v29, v142, v26, v29
v_dot2_f32_bf16 v30, v146, v26, v30
v_dot2_f32_bf16 v31, v150, v26, v31
v_dot2_f32_bf16 v28, v139, v27, v28
v_dot2_f32_bf16 v29, v143, v27, v29
v_dot2_f32_bf16 v30, v147, v27, v30
v_dot2_f32_bf16 v31, v151, v27, v31
buffer_load_dwordx4 v[136:139], v2, s[52:55], s12 offen offset:0 nt
buffer_load_dwordx4 v[140:143], v2, s[52:55], s12 offen offset:1024 nt
buffer_load_dwordx4 v[144:147], v2, s[52:55], s12 offen offset:2048 nt
buffer_load_dwordx4 v[148:151], v2, s[52:55], s12 offen offset:3072 nt
s_add_u32 s13, s13, 24576
s_min_u32 s12, s13, 2146435072
s_cmp_ge_u32 s80, 36
s_cbranch_scc1 L_nodma_6
s_mov_b32 m0, s15
s_nop 0
buffer_load_dwordx4 v2, s[60:63], s15 offen  lds
s_add_u32 s15, s15, 1024
L_nodma_6:
s_add_u32 s80, s80, 1
v_add_f32_dpp v32, v28, v28 row_ror:8 row_mask:0xf bank_mask:0x3
v_add_f32_dpp v33, v29, v29 row_ror:8 row_mask:0xf bank_mask:0x3
v_add_f32_dpp v32, v30, v30 row_ror:8 row_mask:0xf bank_mask:0xc
v_add_f32_dpp v33, v31, v31 row_ror:8 row_mask:0xf bank_mask:0xc
s_nop 0
v_add_f32_dpp v34, v32, v32 row_half_mirror row_mask:0xf bank_mask:0x5
v_add_f32_dpp v34, v33, v33 row_half_mirror row_mask:0xf bank_mask:0xa
s_nop 1
v_add_f32_dpp v34, v34, v34 quad_perm:[1,0,3,2] row_mask:0xf bank_mask:0xf
s_nop 1
v_add_f32_dpp v34, v34, v34 quad_perm:[2,3,0,1] row_mask:0xf bank_mask:0xf
v_cndmask_b32 v86, v86, v34, s[74:75]
s_waitcnt vmcnt(28)
v_dot2_f32_bf16 v28, v152, v24, 0
v_dot2_f32_bf16 v29, v156, v24, 0
v_dot2_f32_bf16 v30, v160, v24, 0
v_dot2_f32_bf16 v31, v164, v24, 0
v_dot2_f32_bf16 v28, v153, v25, v28
v_dot2_f32_bf16 v29, v157, v25, v29
v_dot2_f32_bf16 v30, v161, v25, v30
v_dot2_f32_bf16 v31, v165, v25, v31
v_dot2_f32_bf16 v28, v154, v26, v28
v_dot2_f32_bf16 v29, v158, v26, v29
v_dot2_f32_bf16 v30, v162, v26, v30
v_dot2_f32_bf16 v31, v166, v26, v31
v_dot2_f32_bf16 v28, v155, v27, v28
v_dot2_f32_bf16 v29, v159, v27, v29
v_dot2_f32_bf16 v30, v163, v27, v30
v_dot2_f32_bf16 v31, v167, v27, v31
buffer_load_dwordx4 v[152:155], v2, s[52:55], s12 offen offset:0 nt
buffer_load_dwordx4 v[156:159], v2, s[52:55], s12 offen offset:1024 nt
buffer_load_dwordx4 v[160:163], v2, s[52:55], s12 offen offset:2048 nt
buffer_load_dwordx4 v[164:167], v2, s[52:55], s12 offen offset:3072 nt
s_add_u32 s13, s13, 24576
s_min_u32 s12, s13, 2146435072
s_cmp_ge_u32 s80, 36
s_cbranch_scc1 L_nodma_7
s_mov_b32 m0, s15
s_nop 0
buffer_load_dwordx4 v2, s[60:63], s15 offen  lds
s_add_u32 s15, s15, 1024
L_nodma_7:
s_add_u32 s80, s80, 1
v_add_f32_dpp v32, v28, v28 row_ror:8 row_mask:0xf bank_mask:0x3
v_add_f32_dpp v33, v29, v29 row_ror:8 row_mask:0xf bank_mask:0x3
v_add_f32_dpp v32, v30, v30 row_ror:8 row_mask:0xf bank_mask:0xc
v_add_f32_dpp v33, v31, v31 row_ror:8 row_mask:0xf bank_mask:0xc
s_nop 0
v_add_f32_dpp v34, v32, v32 row_half_mirror row_mask:0xf bank_mask:0x5
v_add_f32_dpp v34, v33, v33 row_half_mirror row_mask:0xf bank_mask:0xa
s_nop 1
v_add_f32_dpp v34, v34, v34 quad_perm:[1,0,3,2] row_mask:0xf bank_mask:0xf
s_nop 1
v_add_f32_dpp v34, v34, v34 quad_perm:[2,3,0,1] row_mask:0xf bank_mask:0xf
v_cndmask_b32 v86, v86, v34, s[76:77]
s_waitcnt vmcnt(28)
v_dot2_f32_bf16 v28, v168, v24, 0
v_dot2_f32_bf16 v29, v172, v24, 0
v_dot2_f32_bf16 v30, v176, v24, 0
v_dot2_f32_bf16 v31, v180, v24, 0
v_dot2_f32_bf16 v28, v169, v25, v28
v_dot2_f32_bf16 v29, v173, v25, v29
v_dot2_f32_bf16 v30, v177, v25, v30
v_dot2_f32_bf16 v31, v181, v25, v31
v_dot2_f32_bf16 v28, v170, v26, v28
v_dot2_f32_bf16 v29, v174, v26, v29
v_dot2_f32_bf16 v30, v178, v26, v30
v_dot2_f32_bf16 v31, v182, v26, v31
v_dot2_f32_bf16 v28, v171, v27, v28
v_dot2_f32_bf16 v29, v175, v27, v29
v_dot2_f32_bf16 v30, v179, v27, v30
v_dot2_f32_bf16 v31, v183, v27, v31
buffer_load_dwordx4 v[168:171], v2, s[52:55], s12 offen offset:0 nt
buffer_load_dwordx4 v[172:175], v2, s[52:55], s12 offen offset:1024 nt
buffer_load_dwordx4 v[176:179], v2, s[52:55], s12 offen offset:2048 nt
buffer_load_dwordx4 v[180:183], v2, s[52:55], s12 offen offset:3072 nt
s_add_u32 s13, s13, 24576
s_min_u32 s12, s13, 2146435072
s_cmp_ge_u32 s80, 36
s_cbranch_scc1 L_nodma_8
s_mov_b32 m0, s15
s_nop 0
buffer_load_dwordx4 v2, s[60:63], s15 offen  lds
s_add_u32 s15, s15, 1024
L_nodma_8:
s_add_u32 s80, s80, 1
v_add_f32_dpp v32, v28, v28 row_ror:8 row_mask:0xf bank_mask:0x3
v_add_f32_dpp v33, v29, v29 row_ror:8 row_mask:0xf bank_mask:0x3
v_add_f32_dpp v32, v30, v30 row_ror:8 row_mask:0xf bank_mask:0xc
v_add_f32_dpp v33, v31, v31 row_ror:8 row_mask:0xf bank_mask:0xc
s_nop 0
v_add_f32_dpp v34, v32, v32 row_half_mirror row_mask:0xf bank_mask:0x5
v_add_f32_dpp v34, v33, v33 row_half_mirror row_mask:0xf bank_mask:0xa
s_nop 1
v_add_f32_dpp v34, v34, v34 quad_perm:[1,0,3,2] row_mask:0xf bank_mask:0xf
s_nop 1
v_add_f32_dpp v34, v34, v34 quad_perm:[2,3,0,1] row_mask:0xf bank_mask:0xf
v_cndmask_b32 v86, v86, v34, s[78:79]
s_add_u32 s81, s81, 1
s_cmp_eq_u32 s81, 11
s_cbranch_scc1 A_mid
v_mov_b32 v76, v77
v_mov_b32 v77, v78
v_mov_b32 v78, v79
v_mov_b32 v79, v80
v_mov_b32 v80, v81
v_mov_b32 v81, v82
v_mov_b32 v82, v83
v_mov_b32 v83, v84
v_mov_b32 v84, v85
v_mov_b32 v85, v86
s_lshr_b64 s[72:73], s[76:77], 2
s_lshr_b64 s[74:75], s[76:77], 1
s_cmp_eq_u32 s81, 9
s_cselect_b32 s52, s56, s52
s_cselect_b32 s53, s57, s53
s_cselect_b32 s13, s14, s13
s_min_u32 s12, s13, 2146435072
s_waitcnt vmcnt(28)
v_dot2_f32_bf16 v28, v184, v24, 0
v_dot2_f32_bf16 v29, v188, v24, 0
v_dot2_f32_bf16 v30, v192, v24, 0
v_dot2_f32_bf16 v31, v196, v24, 0
v_dot2_f32_bf16 v28, v185, v25, v28
v_dot2_f32_bf16 v29, v189, v25, v29
v_dot2_f32_bf16 v30, v193, v25, v30
v_dot2_f32_bf16 v31, v197, v25, v31
v_dot2_f32_bf16 v28, v186, v26, v28
v_dot2_f32_bf16 v29, v190, v26, v29
v_dot2_f32_bf16 v30, v194, v26, v30
v_dot2_f32_bf16 v31, v198, v26, v31
v_dot2_f32_bf16 v28, v187, v27, v28
v_dot2_f32_bf16 v29, v191, v27, v29
v_dot2_f32_bf16 v30, v195, v27, v30
v_dot2_f32_bf16 v31, v199, v27, v31
buffer_load_dwordx4 v[184:187], v2, s[52:55], s12 offen offset:0 nt
buffer_load_dwordx4 v[188:191], v2, s[52:55], s12 offen offset:1024 nt
buffer_load_dwordx4 v[192:195], v2, s[52:55], s12 offen offset:2048 nt
buffer_load_dwordx4 v[196:199], v2, s[52:55], s12 offen offset:3072 nt
s_add_u32 s13, s13, 24576
s_min_u32 s12, s13, 2146435072
s_cmp_ge_u32 s80, 36
s_cbranch_scc1 L_nodma_9
s_mov_b32 m0, s15
s_nop 0
buffer_load_dwordx4 v2, s[60:63], s15 offen  lds
s_add_u32 s15, s15, 1024
L_nodma_9:
s_add_u32 s80, s80, 1
v_add_f32_dpp v32, v28, v28 row_ror:8 row_mask:0xf bank_mask:0x3
v_add_f32_dpp v33, v29, v29 row_ror:8 row_mask:0xf bank_mask:0x3
v_add_f32_dpp v32, v30, v30 row_ror:8 row_mask:0xf bank_mask:0xc
v_add_f32_dpp v33, v31, v31 row_ror:8 row_mask:0xf bank_mask:0xc
s_nop 0
v_add_f32_dpp v34, v32, v32 row_half_mirror row_mask:0xf bank_mask:0x5
v_add_f32_dpp v34, v33, v33 row_half_mirror row_mask:0xf bank_mask:0xa
s_nop 1
v_add_f32_dpp v34, v34, v34 quad_perm:[1,0,3,2] row_mask:0xf bank_mask:0xf
s_nop 1
v_add_f32_dpp v34, v34, v34 quad_perm:[2,3,0,1] row_mask:0xf bank_mask:0xf
v_cndmask_b32 v86, v86, v34, s[72:73]
s_waitcnt vmcnt(28)
v_dot2_f32_bf16 v28, v200, v24, 0
v_dot2_f32_bf16 v29, v204, v24, 0
v_dot2_f32_bf16 v30, v208, v24, 0
v_dot2_f32_bf16 v31, v212, v24, 0
v_dot2_f32_bf16 v28, v201, v25, v28
v_dot2_f32_bf16 v29, v205, v25, v29
v_dot2_f32_bf16 v30, v209, v25, v30
v_dot2_f32_bf16 v31, v213, v25, v31
v_dot2_f32_bf16 v28, v202, v26, v28
v_dot2_f32_bf16 v29, v206, v26, v29
v_dot2_f32_bf16 v30, v210, v26, v30
v_dot2_f32_bf16 v31, v214, v26, v31
v_dot2_f32_bf16 v28, v203, v27, v28
v_dot2_f32_bf16 v29, v207, v27, v29
v_dot2_f32_bf16 v30, v211, v27, v30
v_dot2_f32_bf16 v31, v215, v27, v31
buffer_load_dwordx4 v[200:203], v2, s[52:55], s12 offen offset:0 nt
buffer_load_dwordx4 v[204:207], v2, s[52:55], s12 offen offset:1024 nt
buffer_load_dwordx4 v[208:211], v2, s[52:55], s12 offen offset:2048 nt
buffer_load_dwordx4 v[212:215], v2, s[52:55], s12 offen offset:3072 nt
s_add_u32 s13, s13, 24576
s_min_u32 s12, s13, 2146435072
s_cmp_ge_u32 s80, 36
s_cbranch_scc1 L_nodma_10
s_mov_b32 m0, s15
s_nop 0
buffer_load_dwordx4 v2, s[60:63], s15 offen  lds
s_add_u32 s15, s15, 1024
L_nodma_10:
s_add_u32 s80, s80, 1
v_add_f32_dpp v32, v28, v28 row_ror:8 row_mask:0xf bank_mask:0x3
v_add_f32_dpp v33, v29, v29 row_ror:8 row_mask:0xf bank_mask:0x3
v_add_f32_dpp v32, v30, v30 row_ror:8 row_mask:0xf bank_mask:0xc
v_add_f32_dpp v33, v31, v31 row_ror:8 row_mask:0xf bank_mask:0xc
s_nop 0
v_add_f32_dpp v34, v32, v32 row_half_mirror row_mask:0xf bank_mask:0x5
v_add_f32_dpp v34, v33, v33 row_half_mirror row_mask:0xf bank_mask:0xa
s_nop 1
v_add_f32_dpp v34, v34, v34 quad_perm:[1,0,3,2] row_mask:0xf bank_mask:0xf
s_nop 1
v_add_f32_dpp v34, v34, v34 quad_perm:[2,3,0,1] row_mask:0xf bank_mask:0xf
v_cndmask_b32 v86, v86, v34, s[74:75]
s_waitcnt vmcnt(28)
v_dot2_f32_bf16 v28, v216, v24, 0
v_dot2_f32_bf16 v29, v220, v24, 0
v_dot2_f32_bf16 v30, v224, v24, 0
v_dot2_f32_bf16 v31, v228, v24, 0
v_dot2_f32_bf16 v28, v217, v25, v28
v_dot2_f32_bf16 v29, v221, v25, v29
v_dot2_f32_bf16 v30, v225, v25, v30
v_dot2_f32_bf16 v31, v229, v25, v31
v_dot2_f32_bf16 v28, v218, v26, v28
v_dot2_f32_bf16 v29, v222, v26, v29
v_dot2_f32_bf16 v30, v226, v26, v30
v_dot2_f32_bf16 v31, v230, v26, v31
v_dot2_f32_bf16 v28, v219, v27, v28
v_dot2_f32_bf16 v29, v223, v27, v29
v_dot2_f32_bf16 v30, v227, v27, v30
v_dot2_f32_bf16 v31, v231, v27, v31
buffer_load_dwordx4 v[216:219], v2, s[52:55], s12 offen offset:0 nt
buffer_load_dwordx4 v[220:223], v2, s[52:55], s12 offen offset:1024 nt
buffer_load_dwordx4 v[224:227], v2, s[52:55], s12 offen offset:2048 nt
buffer_load_dwordx4 v[228:231], v2, s[52:55], s12 offen offset:3072 nt
s_add_u32 s13, s13, 24576
s_min_u32 s12, s13, 2146435072
s_cmp_ge_u32 s80, 36
s_cbranch_scc1 L_nodma_11
s_mov_b32 m0, s15
s_nop 0
buffer_load_dwordx4 v2, s[60:63], s15 offen  lds
s_add_u32 s15, s15, 1024
L_nodma_11:
s_add_u32 s80, s80, 1
v_add_f32_dpp v32, v28, v28 row_ror:8 row_mask:0xf bank_mask:0x3
v_add_f32_dpp v33, v29, v29 row_ror:8 row_mask:0xf bank_mask:0x3
v_add_f32_dpp v32, v30, v30 row_ror:8 row_mask:0xf bank_mask:0xc
v_add_f32_dpp v33, v31, v31 row_ror:8 row_mask:0xf bank_mask:0xc
s_nop 0
v_add_f32_dpp v34, v32, v32 row_half_mirror row_mask:0xf bank_mask:0x5
v_add_f32_dpp v34, v33, v33 row_half_mirror row_mask:0xf bank_mask:0xa
s_nop 1
v_add_f32_dpp v34, v34, v34 quad_perm:[1,0,3,2] row_mask:0xf bank_mask:0xf
s_nop 1
v_add_f32_dpp v34, v34, v34 quad_perm:[2,3,0,1] row_mask:0xf bank_mask:0xf
v_cndmask_b32 v86, v86, v34, s[76:77]
s_waitcnt vmcnt(28)
v_dot2_f32_bf16 v28, v232, v24, 0
v_dot2_f32_bf16 v29, v236, v24, 0
v_dot2_f32_bf16 v30, v240, v24, 0
v_dot2_f32_bf16 v31, v244, v24, 0
v_dot2_f32_bf16 v28, v233, v25, v28
v_dot2_f32_bf16 v29, v237, v25, v29
v_dot2_f32_bf16 v30, v241, v25, v30
v_dot2_f32_bf16 v31, v245, v25, v31
v_dot2_f32_bf16 v28, v234, v26, v28
v_dot2_f32_bf16 v29, v238, v26, v29
v_dot2_f32_bf16 v30, v242, v26, v30
v_dot2_f32_bf16 v31, v246, v26, v31
v_dot2_f32_bf16 v28, v235, v27, v28
v_dot2_f32_bf16 v29, v239, v27, v29
v_dot2_f32_bf16 v30, v243, v27, v30
v_dot2_f32_bf16 v31, v247, v27, v31
buffer_load_dwordx4 v[232:235], v2, s[52:55], s12 offen offset:0 nt
buffer_load_dwordx4 v[236:239], v2, s[52:55], s12 offen offset:1024 nt
buffer_load_dwordx4 v[240:243], v2, s[52:55], s12 offen offset:2048 nt
buffer_load_dwordx4 v[244:247], v2, s[52:55], s12 offen offset:3072 nt
s_add_u32 s13, s13, 24576
s_min_u32 s12, s13, 2146435072
s_cmp_ge_u32 s80, 36
s_cbranch_scc1 L_nodma_12
s_mov_b32 m0, s15
s_nop 0
buffer_load_dwordx4 v2, s[60:63], s15 offen  lds
s_add_u32 s15, s15, 1024
L_nodma_12:
s_add_u32 s80, s80, 1
v_add_f32_dpp v32, v28, v28 row_ror:8 row_mask:0xf bank_mask:0x3
v_add_f32_dpp v33, v29, v29 row_ror:8 row_mask:0xf bank_mask:0x3
v_add_f32_dpp v32, v30, v30 row_ror:8 row_mask:0xf bank_mask:0xc
v_add_f32_dpp v33, v31, v31 row_ror:8 row_mask:0xf bank_mask:0xc
s_nop 0
v_add_f32_dpp v34, v32, v32 row_half_mirror row_mask:0xf bank_mask:0x5
v_add_f32_dpp v34, v33, v33 row_half_mirror row_mask:0xf bank_mask:0xa
s_nop 1
v_add_f32_dpp v34, v34, v34 quad_perm:[1,0,3,2] row_mask:0xf bank_mask:0xf
s_nop 1
v_add_f32_dpp v34, v34, v34 quad_perm:[2,3,0,1] row_mask:0xf bank_mask:0xf
v_cndmask_b32 v86, v86, v34, s[78:79]
s_add_u32 s81, s81, 1
v_mov_b32 v76, v77
v_mov_b32 v77, v78
v_mov_b32 v78, v79
v_mov_b32 v79, v80
v_mov_b32 v80, v81
v_mov_b32 v81, v82
v_mov_b32 v82, v83
v_mov_b32 v83, v84
v_mov_b32 v84, v85
v_mov_b32 v85, v86
s_branch K_loop
A_mid:
v_max3_f32 v35, v76, v77, v78
v_max3_f32 v35, v35, v79, v80
v_max3_f32 v35, v35, v81, v82
v_max3_f32 v35, v35, v83, v84
v_max3_f32 v35, v35, v85, v86
s_nop 1
v_max_f32_dpp v35, v35, v35 row_ror:8 row_mask:0xf bank_mask:0xf
s_nop 1
v_max_f32_dpp v35, v35, v35 row_ror:4 row_mask:0xf bank_mask:0xf
s_nop 1
v_max_f32_dpp v35, v35, v35 row_ror:2 row_mask:0xf bank_mask:0xf
s_nop 1
v_max_f32_dpp v35, v35, v35 row_ror:1 row_mask:0xf bank_mask:0xf
v_mov_b32 v36, v35
s_nop 1
v_permlane16_swap_b32 v35, v36
v_max_f32 v35, v35, v36
v_mov_b32 v36, v35
s_nop 1
v_permlane32_swap_b32 v35, v36
v_max_f32 v35, v35, v36
v_mul_f32 v32, v35, v7
v_fma_f32 v76, v76, v7, -v32
v_fma_f32 v77, v77, v7, -v32
v_fma_f32 v78, v78, v7, -v32
v_fma_f32 v79, v79, v7, -v32
v_fma_f32 v80, v80, v7, -v32
v_fma_f32 v81, v81, v7, -v32
v_fma_f32 v82, v82, v7, -v32
v_fma_f32 v83, v83, v7, -v32
v_fma_f32 v84, v84, v7, -v32
v_fma_f32 v85, v85, v7, -v32
v_fma_f32 v86, v86, v7, -v32
v_exp_f32 v76, v76
v_exp_f32 v77, v77
v_exp_f32 v78, v78
v_exp_f32 v79, v79
v_exp_f32 v80, v80
v_exp_f32 v81, v81
v_exp_f32 v82, v82
v_exp_f32 v83, v83
v_exp_f32 v84, v84
v_exp_f32 v85, v85
v_exp_f32 v86, v86
v_add_f32 v35, v76, v77
v_add_f32 v35, v35, v78
v_add_f32 v35, v35, v79
v_add_f32 v35, v35, v80
v_add_f32 v35, v35, v81
v_add_f32 v35, v35, v82
v_add_f32 v35, v35, v83
v_add_f32 v35, v35, v84
v_add_f32 v35, v35, v85
v_add_f32 v35, v35, v86
v_cvt_pk_bf16_f32 v76, v76, v76
v_cvt_pk_bf16_f32 v77, v77, v77
v_cvt_pk_bf16_f32 v78, v78, v78
v_cvt_pk_bf16_f32 v79, v79, v79
v_cvt_pk_bf16_f32 v80, v80, v80
v_cvt_pk_bf16_f32 v81, v81, v81
v_cvt_pk_bf16_f32 v82, v82, v82
v_cvt_pk_bf16_f32 v83, v83, v83
v_cvt_pk_bf16_f32 v84, v84, v84
v_cvt_pk_bf16_f32 v85, v85, v85
v_cvt_pk_bf16_f32 v86, v86, v86
v_add_f32_dpp v35, v35, v35 row_ror:8 row_mask:0xf bank_mask:0xf
s_nop 1
v_add_f32_dpp v35, v35, v35 row_ror:4 row_mask:0xf bank_mask:0xf
s_nop 1
v_add_f32_dpp v35, v35, v35 row_ror:2 row_mask:0xf bank_mask:0xf
s_nop 1
v_add_f32_dpp v35, v35, v35 row_ror:1 row_mask:0xf bank_mask:0xf
v_mov_b32 v36, v35
s_nop 1
v_permlane16_swap_b32 v35, v36
v_add_f32 v35, v35, v36
v_mov_b32 v36, v35
s_nop 1
v_permlane32_swap_b32 v35, v36
v_add_f32 v35, v35, v36
v_min_u32 v32, -2, v32
v_min_u32 v33, -2, v35
s_mov_b32 s7, 400000
L_ens_13:
v_readfirstlane_b32 s6, v96
s_cmp_ge_u32 s6, 128
s_cbranch_scc1 L_ensd_14
s_sleep 16
buffer_load_dword v96, off, s[68:71], 0 offset:0 sc1
s_waitcnt vmcnt(0)
s_sub_u32 s7, s7, 1
s_cmp_lg_u32 s7, 0
s_cbranch_scc1 L_ens_13
L_ensd_14:
s_lshl_b32 s6, s11, 3
s_add_u32 s6, s6, s82
s_mov_b64 exec, 1
buffer_store_dwordx2 v[32:33], off, s[64:67], s6 sc1
s_mov_b64 exec, -1
s_mov_b32 s6, 0x63206320
s_mov_b32 s7, 0x63206320
s_and_b32 s15, s2, 7
s_lshl_b32 s15, s15, 3
s_lshr_b64 s[6:7], s[6:7], s15
s_and_b32 s15, s6, 255
v_and_b32_dpp v60, v78, v8 row_newbcast:0 row_mask:0xf bank_mask:0xf
v_and_b32_dpp v61, v78, v9 row_newbcast:0 row_mask:0xf bank_mask:0xf
v_and_b32_dpp v62, v78, v10 row_newbcast:0 row_mask:0xf bank_mask:0xf
v_and_b32_dpp v63, v78, v11 row_newbcast:0 row_mask:0xf bank_mask:0xf
v_and_b32_dpp v64, v78, v8 row_newbcast:4 row_mask:0xf bank_mask:0xf
v_and_b32_dpp v65, v78, v9 row_newbcast:4 row_mask:0xf bank_mask:0xf
v_and_b32_dpp v66, v78, v10 row_newbcast:4 row_mask:0xf bank_mask:0xf
v_and_b32_dpp v67, v78, v11 row_newbcast:4 row_mask:0xf bank_mask:0xf
v_and_b32_dpp v68, v78, v8 row_newbcast:8 row_mask:0xf bank_mask:0xf
v_and_b32_dpp v69, v78, v9 row_newbcast:8 row_mask:0xf bank_mask:0xf
v_and_b32_dpp v70, v78, v10 row_newbcast:8 row_mask:0xf bank_mask:0xf
v_and_b32_dpp v71, v78, v11 row_newbcast:8 row_mask:0xf bank_mask:0xf
v_and_b32_dpp v72, v78, v8 row_newbcast:12 row_mask:0xf bank_mask:0xf
v_and_b32_dpp v73, v78, v9 row_newbcast:12 row_mask:0xf bank_mask:0xf
v_and_b32_dpp v74, v78, v10 row_newbcast:12 row_mask:0xf bank_mask:0xf
v_and_b32_dpp v75, v78, v11 row_newbcast:12 row_mask:0xf bank_mask:0xf
s_waitcnt vmcnt(29)
v_mfma_f32_16x16x32_bf16 v[20:23], v[60:63], v[184:187], v[20:23]
v_mfma_f32_16x16x32_bf16 v[20:23], v[64:67], v[188:191], v[20:23]
v_mfma_f32_16x16x32_bf16 v[20:23], v[68:71], v[192:195], v[20:23]
v_mfma_f32_16x16x32_bf16 v[20:23], v[72:75], v[196:199], v[20:23]
v_add_u32 v117, 1, v117
buffer_store_dword v117, v118, s[64:67], 0 offen
buffer_load_dwordx4 v[184:187], v2, s[52:55], s12 offen offset:0 nt
buffer_load_dwordx4 v[188:191], v2, s[52:55], s12 offen offset:1024 nt
buffer_load_dwordx4 v[192:195], v2, s[52:55], s12 offen offset:2048 nt
buffer_load_dwordx4 v[196:199], v2, s[52:55], s12 offen offset:3072 nt
s_add_u32 s13, s13, 24576
s_min_u32 s12, s13, 2146435072
v_and_b32_dpp v60, v78, v8 row_newbcast:1 row_mask:0xf bank_mask:0xf
v_and_b32_dpp v61, v78, v9 row_newbcast:1 row_mask:0xf bank_mask:0xf
v_and_b32_dpp v62, v78, v10 row_newbcast:1 row_mask:0xf bank_mask:0xf
v_and_b32_dpp v63, v78, v11 row_newbcast:1 row_mask:0xf bank_mask:0xf
v_and_b32_dpp v64, v78, v8 row_newbcast:5 row_mask:0xf bank_mask:0xf
v_and_b32_dpp v65, v78, v9 row_newbcast:5 row_mask:0xf bank_mask:0xf
v_and_b32_dpp v66, v78, v10 row_newbcast:5 row_mask:0xf bank_mask:0xf
v_and_b32_dpp v67, v78, v11 row_newbcast:5 row_mask:0xf bank_mask:0xf
v_and_b32_dpp v68, v78, v8 row_newbcast:9 row_mask:0xf bank_mask:0xf
v_and_b32_dpp v69, v78, v9 row_newbcast:9 row_mask:0xf bank_mask:0xf
v_and_b32_dpp v70, v78, v10 row_newbcast:9 row_mask:0xf bank_mask:0xf
v_and_b32_dpp v71, v78, v11 row_newbcast:9 row_mask:0xf bank_mask:0xf
v_and_b32_dpp v72, v78, v8 row_newbcast:13 row_mask:0xf bank_mask:0xf
v_and_b32_dpp v73, v78, v9 row_newbcast:13 row_mask:0xf bank_mask:0xf
v_and_b32_dpp v74, v78, v10 row_newbcast:13 row_mask:0xf bank_mask:0xf
v_and_b32_dpp v75, v78, v11 row_newbcast:13 row_mask:0xf bank_mask:0xf
s_waitcnt vmcnt(30)
v_mfma_f32_16x16x32_bf16 v[20:23], v[60:63], v[200:203], v[20:23]
v_mfma_f32_16x16x32_bf16 v[20:23], v[64:67], v[204:207], v[20:23]
v_mfma_f32_16x16x32_bf16 v[20:23], v[68:71], v[208:211], v[20:23]
v_mfma_f32_16x16x32_bf16 v[20:23], v[72:75], v[212:215], v[20:23]
v_add_u32 v117, 1, v117
buffer_store_dword v117, v118, s[64:67], 0 offen
buffer_load_dwordx4 v[200:203], v2, s[52:55], s12 offen offset:0 nt
buffer_load_dwordx4 v[204:207], v2, s[52:55], s12 offen offset:1024 nt
buffer_load_dwordx4 v[208:211], v2, s[52:55], s12 offen offset:2048 nt
buffer_load_dwordx4 v[212:215], v2, s[52:55], s12 offen offset:3072 nt
s_add_u32 s13, s13, 24576
s_min_u32 s12, s13, 2146435072
v_and_b32_dpp v60, v76, v8 row_newbcast:1 row_mask:0xf bank_mask:0xf
v_and_b32_dpp v61, v76, v9 row_newbcast:1 row_mask:0xf bank_mask:0xf
v_and_b32_dpp v62, v76, v10 row_newbcast:1 row_mask:0xf bank_mask:0xf
v_and_b32_dpp v63, v76, v11 row_newbcast:1 row_mask:0xf bank_mask:0xf
v_and_b32_dpp v64, v76, v8 row_newbcast:5 row_mask:0xf bank_mask:0xf
v_and_b32_dpp v65, v76, v9 row_newbcast:5 row_mask:0xf bank_mask:0xf
v_and_b32_dpp v66, v76, v10 row_newbcast:5 row_mask:0xf bank_mask:0xf
v_and_b32_dpp v67, v76, v11 row_newbcast:5 row_mask:0xf bank_mask:0xf
v_and_b32_dpp v68, v76, v8 row_newbcast:9 row_mask:0xf bank_mask:0xf
v_and_b32_dpp v69, v76, v9 row_newbcast:9 row_mask:0xf bank_mask:0xf
v_and_b32_dpp v70, v76, v10 row_newbcast:9 row_mask:0xf bank_mask:0xf
v_and_b32_dpp v71, v76, v11 row_newbcast:9 row_mask:0xf bank_mask:0xf
v_and_b32_dpp v72, v76, v8 row_newbcast:13 row_mask:0xf bank_mask:0xf
v_and_b32_dpp v73, v76, v9 row_newbcast:13 row_mask:0xf bank_mask:0xf
v_and_b32_dpp v74, v76, v10 row_newbcast:13 row_mask:0xf bank_mask:0xf
v_and_b32_dpp v75, v76, v11 row_newbcast:13 row_mask:0xf bank_mask:0xf
v_mfma_f32_16x16x32_bf16 v[20:23], v[60:63], a[0:3], v[20:23]
v_mfma_f32_16x16x32_bf16 v[20:23], v[64:67], a[4:7], v[20:23]
v_mfma_f32_16x16x32_bf16 v[20:23], v[68:71], a[8:11], v[20:23]
v_mfma_f32_16x16x32_bf16 v[20:23], v[72:75], a[12:15], v[20:23]
s_nop 3
v_and_b32_dpp v60, v78, v8 row_newbcast:2 row_mask:0xf bank_mask:0xf
v_and_b32_dpp v61, v78, v9 row_newbcast:2 row_mask:0xf bank_mask:0xf
v_and_b32_dpp v62, v78, v10 row_newbcast:2 row_mask:0xf bank_mask:0xf
v_and_b32_dpp v63, v78, v11 row_newbcast:2 row_mask:0xf bank_mask:0xf
v_and_b32_dpp v64, v78, v8 row_newbcast:6 row_mask:0xf bank_mask:0xf
v_and_b32_dpp v65, v78, v9 row_newbcast:6 row_mask:0xf bank_mask:0xf
v_and_b32_dpp v66, v78, v10 row_newbcast:6 row_mask:0xf bank_mask:0xf
v_and_b32_dpp v67, v78, v11 row_newbcast:6 row_mask:0xf bank_mask:0xf
v_and_b32_dpp v68, v78, v8 row_newbcast:10 row_mask:0xf bank_mask:0xf
v_and_b32_dpp v69, v78, v9 row_newbcast:10 row_mask:0xf bank_mask:0xf
v_and_b32_dpp v70, v78, v10 row_newbcast:10 row_mask:0xf bank_mask:0xf
v_and_b32_dpp v71, v78, v11 row_newbcast:10 row_mask:0xf bank_mask:0xf
v_and_b32_dpp v72, v78, v8 row_newbcast:14 row_mask:0xf bank_mask:0xf
v_and_b32_dpp v73, v78, v9 row_newbcast:14 row_mask:0xf bank_mask:0xf
v_and_b32_dpp v74, v78, v10 row_newbcast:14 row_mask:0xf bank_mask:0xf
v_and_b32_dpp v75, v78, v11 row_newbcast:14 row_mask:0xf bank_mask:0xf
s_waitcnt vmcnt(31)
v_mfma_f32_16x16x32_bf16 v[20:23], v[60:63], v[216:219], v[20:23]
v_mfma_f32_16x16x32_bf16 v[20:23], v[64:67], v[220:223], v[20:23]
v_mfma_f32_16x16x32_bf16 v[20:23], v[68:71], v[224:227], v[20:23]
v_mfma_f32_16x16x32_bf16 v[20:23], v[72:75], v[228:231], v[20:23]
v_add_u32 v117, 1, v117
buffer_store_dword v117, v118, s[64:67], 0 offen
buffer_load_dwordx4 v[216:219], v2, s[52:55], s12 offen offset:0 nt
buffer_load_dwordx4 v[220:223], v2, s[52:55], s12 offen offset:1024 nt
buffer_load_dwordx4 v[224:227], v2, s[52:55], s12 offen offset:2048 nt
buffer_load_dwordx4 v[228:231], v2, s[52:55], s12 offen offset:3072 nt
s_add_u32 s13, s13, 24576
s_min_u32 s12, s13, 2146435072
v_and_b32_dpp v60, v78, v8 row_newbcast:3 row_mask:0xf bank_mask:0xf
v_and_b32_dpp v61, v78, v9 row_newbcast:3 row_mask:0xf bank_mask:0xf
v_and_b32_dpp v62, v78, v10 row_newbcast:3 row_mask:0xf bank_mask:0xf
v_and_b32_dpp v63, v78, v11 row_newbcast:3 row_mask:0xf bank_mask:0xf
v_and_b32_dpp v64, v78, v8 row_newbcast:7 row_mask:0xf bank_mask:0xf
v_and_b32_dpp v65, v78, v9 row_newbcast:7 row_mask:0xf bank_mask:0xf
v_and_b32_dpp v66, v78, v10 row_newbcast:7 row_mask:0xf bank_mask:0xf
v_and_b32_dpp v67, v78, v11 row_newbcast:7 row_mask:0xf bank_mask:0xf
v_and_b32_dpp v68, v78, v8 row_newbcast:11 row_mask:0xf bank_mask:0xf
v_and_b32_dpp v69, v78, v9 row_newbcast:11 row_mask:0xf bank_mask:0xf
v_and_b32_dpp v70, v78, v10 row_newbcast:11 row_mask:0xf bank_mask:0xf
v_and_b32_dpp v71, v78, v11 row_newbcast:11 row_mask:0xf bank_mask:0xf
v_and_b32_dpp v72, v78, v8 row_newbcast:15 row_mask:0xf bank_mask:0xf
v_and_b32_dpp v73, v78, v9 row_newbcast:15 row_mask:0xf bank_mask:0xf
v_and_b32_dpp v74, v78, v10 row_newbcast:15 row_mask:0xf bank_mask:0xf
v_and_b32_dpp v75, v78, v11 row_newbcast:15 row_mask:0xf bank_mask:0xf
s_waitcnt vmcnt(32)
v_mfma_f32_16x16x32_bf16 v[20:23], v[60:63], v[232:235], v[20:23]
v_mfma_f32_16x16x32_bf16 v[20:23], v[64:67], v[236:239], v[20:23]
v_mfma_f32_16x16x32_bf16 v[20:23], v[68:71], v[240:243], v[20:23]
v_mfma_f32_16x16x32_bf16 v[20:23], v[72:75], v[244:247], v[20:23]
v_add_u32 v117, 1, v117
buffer_store_dword v117, v118, s[64:67], 0 offen
buffer_load_dwordx4 v[232:235], v2, s[52:55], s12 offen offset:0 nt
buffer_load_dwordx4 v[236:239], v2, s[52:55], s12 offen offset:1024 nt
buffer_load_dwordx4 v[240:243], v2, s[52:55], s12 offen offset:2048 nt
buffer_load_dwordx4 v[244:247], v2, s[52:55], s12 offen offset:3072 nt
s_add_u32 s13, s13, 24576
s_min_u32 s12, s13, 2146435072
s_barrier
ds_read_b64_tr_b16 a[96:97], v88 offset:0
ds_read_b64_tr_b16 a[98:99], v88 offset:2304
ds_read_b64_tr_b16 a[100:101], v88 offset:18432
ds_read_b64_tr_b16 a[102:103], v88 offset:20736
v_and_b32_dpp v60, v79, v8 row_newbcast:0 row_mask:0xf bank_mask:0xf
v_and_b32_dpp v61, v79, v9 row_newbcast:0 row_mask:0xf bank_mask:0xf
v_and_b32_dpp v62, v79, v10 row_newbcast:0 row_mask:0xf bank_mask:0xf
v_and_b32_dpp v63, v79, v11 row_newbcast:0 row_mask:0xf bank_mask:0xf
v_and_b32_dpp v64, v79, v8 row_newbcast:4 row_mask:0xf bank_mask:0xf
v_and_b32_dpp v65, v79, v9 row_newbcast:4 row_mask:0xf bank_mask:0xf
v_and_b32_dpp v66, v79, v10 row_newbcast:4 row_mask:0xf bank_mask:0xf
v_and_b32_dpp v67, v79, v11 row_newbcast:4 row_mask:0xf bank_mask:0xf
v_and_b32_dpp v68, v79, v8 row_newbcast:8 row_mask:0xf bank_mask:0xf
v_and_b32_dpp v69, v79, v9 row_newbcast:8 row_mask:0xf bank_mask:0xf
v_and_b32_dpp v70, v79, v10 row_newbcast:8 row_mask:0xf bank_mask:0xf
v_and_b32_dpp v71, v79, v11 row_newbcast:8 row_mask:0xf bank_mask:0xf
v_and_b32_dpp v72, v79, v8 row_newbcast:12 row_mask:0xf bank_mask:0xf
v_and_b32_dpp v73, v79, v9 row_newbcast:12 row_mask:0xf bank_mask:0xf
v_and_b32_dpp v74, v79, v10 row_newbcast:12 row_mask:0xf bank_mask:0xf
v_and_b32_dpp v75, v79, v11 row_newbcast:12 row_mask:0xf bank_mask:0xf
s_waitcnt vmcnt(33)
v_mfma_f32_16x16x32_bf16 v[20:23], v[60:63], v[120:123], v[20:23]
v_mfma_f32_16x16x32_bf16 v[20:23], v[64:67], v[124:127], v[20:23]
v_mfma_f32_16x16x32_bf16 v[20:23], v[68:71], v[128:131], v[20:23]
v_mfma_f32_16x16x32_bf16 v[20:23], v[72:75], v[132:135], v[20:23]
v_add_u32 v117, 1, v117
buffer_store_dword v117, v118, s[64:67], 0 offen
buffer_load_dwordx4 v[120:123], v2, s[52:55], s12 offen offset:0 nt
buffer_load_dwordx4 v[124:127], v2, s[52:55], s12 offen offset:1024 nt
buffer_load_dwordx4 v[128:131], v2, s[52:55], s12 offen offset:2048 nt
buffer_load_dwordx4 v[132:135], v2, s[52:55], s12 offen offset:3072 nt
s_add_u32 s13, s13, 24576
s_min_u32 s12, s13, 2146435072
ds_read_b64_tr_b16 a[104:105], v88 offset:36864
ds_read_b64_tr_b16 a[106:107], v88 offset:39168
ds_read_b64_tr_b16 a[108:109], v88 offset:55296
ds_read_b64_tr_b16 a[110:111], v88 offset:57600
v_and_b32_dpp v60, v79, v8 row_newbcast:1 row_mask:0xf bank_mask:0xf
v_and_b32_dpp v61, v79, v9 row_newbcast:1 row_mask:0xf bank_mask:0xf
v_and_b32_dpp v62, v79, v10 row_newbcast:1 row_mask:0xf bank_mask:0xf
v_and_b32_dpp v63, v79, v11 row_newbcast:1 row_mask:0xf bank_mask:0xf
v_and_b32_dpp v64, v79, v8 row_newbcast:5 row_mask:0xf bank_mask:0xf
v_and_b32_dpp v65, v79, v9 row_newbcast:5 row_mask:0xf bank_mask:0xf
v_and_b32_dpp v66, v79, v10 row_newbcast:5 row_mask:0xf bank_mask:0xf
v_and_b32_dpp v67, v79, v11 row_newbcast:5 row_mask:0xf bank_mask:0xf
v_and_b32_dpp v68, v79, v8 row_newbcast:9 row_mask:0xf bank_mask:0xf
v_and_b32_dpp v69, v79, v9 row_newbcast:9 row_mask:0xf bank_mask:0xf
v_and_b32_dpp v70, v79, v10 row_newbcast:9 row_mask:0xf bank_mask:0xf
v_and_b32_dpp v71, v79, v11 row_newbcast:9 row_mask:0xf bank_mask:0xf
v_and_b32_dpp v72, v79, v8 row_newbcast:13 row_mask:0xf bank_mask:0xf
v_and_b32_dpp v73, v79, v9 row_newbcast:13 row_mask:0xf bank_mask:0xf
v_and_b32_dpp v74, v79, v10 row_newbcast:13 row_mask:0xf bank_mask:0xf
v_and_b32_dpp v75, v79, v11 row_newbcast:13 row_mask:0xf bank_mask:0xf
s_waitcnt vmcnt(34)
v_mfma_f32_16x16x32_bf16 v[20:23], v[60:63], v[136:139], v[20:23]
v_mfma_f32_16x16x32_bf16 v[20:23], v[64:67], v[140:143], v[20:23]
v_mfma_f32_16x16x32_bf16 v[20:23], v[68:71], v[144:147], v[20:23]
v_mfma_f32_16x16x32_bf16 v[20:23], v[72:75], v[148:151], v[20:23]
v_add_u32 v117, 1, v117
buffer_store_dword v117, v118, s[64:67], 0 offen
buffer_load_dwordx4 v[136:139], v2, s[52:55], s12 offen offset:0 nt
buffer_load_dwordx4 v[140:143], v2, s[52:55], s12 offen offset:1024 nt
buffer_load_dwordx4 v[144:147], v2, s[52:55], s12 offen offset:2048 nt
buffer_load_dwordx4 v[148:151], v2, s[52:55], s12 offen offset:3072 nt
s_add_u32 s13, s13, 24576
s_min_u32 s12, s13, 2146435072
ds_read_b64_tr_b16 a[112:113], v90 offset:0
ds_read_b64_tr_b16 a[114:115], v90 offset:2304
ds_read_b64_tr_b16 a[116:117], v90 offset:18432
ds_read_b64_tr_b16 a[118:119], v90 offset:20736
v_and_b32_dpp v60, v76, v8 row_newbcast:2 row_mask:0xf bank_mask:0xf
v_and_b32_dpp v61, v76, v9 row_newbcast:2 row_mask:0xf bank_mask:0xf
v_and_b32_dpp v62, v76, v10 row_newbcast:2 row_mask:0xf bank_mask:0xf
v_and_b32_dpp v63, v76, v11 row_newbcast:2 row_mask:0xf bank_mask:0xf
v_and_b32_dpp v64, v76, v8 row_newbcast:6 row_mask:0xf bank_mask:0xf
v_and_b32_dpp v65, v76, v9 row_newbcast:6 row_mask:0xf bank_mask:0xf
v_and_b32_dpp v66, v76, v10 row_newbcast:6 row_mask:0xf bank_mask:0xf
v_and_b32_dpp v67, v76, v11 row_newbcast:6 row_mask:0xf bank_mask:0xf
v_and_b32_dpp v68, v76, v8 row_newbcast:10 row_mask:0xf bank_mask:0xf
v_and_b32_dpp v69, v76, v9 row_newbcast:10 row_mask:0xf bank_mask:0xf
v_and_b32_dpp v70, v76, v10 row_newbcast:10 row_mask:0xf bank_mask:0xf
v_and_b32_dpp v71, v76, v11 row_newbcast:10 row_mask:0xf bank_mask:0xf
v_and_b32_dpp v72, v76, v8 row_newbcast:14 row_mask:0xf bank_mask:0xf
v_and_b32_dpp v73, v76, v9 row_newbcast:14 row_mask:0xf bank_mask:0xf
v_and_b32_dpp v74, v76, v10 row_newbcast:14 row_mask:0xf bank_mask:0xf
v_and_b32_dpp v75, v76, v11 row_newbcast:14 row_mask:0xf bank_mask:0xf
v_mfma_f32_16x16x32_bf16 v[20:23], v[60:63], a[16:19], v[20:23]
v_mfma_f32_16x16x32_bf16 v[20:23], v[64:67], a[20:23], v[20:23]
v_mfma_f32_16x16x32_bf16 v[20:23], v[68:71], a[24:27], v[20:23]
v_mfma_f32_16x16x32_bf16 v[20:23], v[72:75], a[28:31], v[20:23]
s_nop 3
v_and_b32_dpp v60, v79, v8 row_newbcast:2 row_mask:0xf bank_mask:0xf
v_and_b32_dpp v61, v79, v9 row_newbcast:2 row_mask:0xf bank_mask:0xf
v_and_b32_dpp v62, v79, v10 row_newbcast:2 row_mask:0xf bank_mask:0xf
v_and_b32_dpp v63, v79, v11 row_newbcast:2 row_mask:0xf bank_mask:0xf
v_and_b32_dpp v64, v79, v8 row_newbcast:6 row_mask:0xf bank_mask:0xf
v_and_b32_dpp v65, v79, v9 row_newbcast:6 row_mask:0xf bank_mask:0xf
v_and_b32_dpp v66, v79, v10 row_newbcast:6 row_mask:0xf bank_mask:0xf
v_and_b32_dpp v67, v79, v11 row_newbcast:6 row_mask:0xf bank_mask:0xf
v_and_b32_dpp v68, v79, v8 row_newbcast:10 row_mask:0xf bank_mask:0xf
v_and_b32_dpp v69, v79, v9 row_newbcast:10 row_mask:0xf bank_mask:0xf
v_and_b32_dpp v70, v79, v10 row_newbcast:10 row_mask:0xf bank_mask:0xf
v_and_b32_dpp v71, v79, v11 row_newbcast:10 row_mask:0xf bank_mask:0xf
v_and_b32_dpp v72, v79, v8 row_newbcast:14 row_mask:0xf bank_mask:0xf
v_and_b32_dpp v73, v79, v9 row_newbcast:14 row_mask:0xf bank_mask:0xf
v_and_b32_dpp v74, v79, v10 row_newbcast:14 row_mask:0xf bank_mask:0xf
v_and_b32_dpp v75, v79, v11 row_newbcast:14 row_mask:0xf bank_mask:0xf
s_waitcnt vmcnt(35)
v_mfma_f32_16x16x32_bf16 v[20:23], v[60:63], v[152:155], v[20:23]
v_mfma_f32_16x16x32_bf16 v[20:23], v[64:67], v[156:159], v[20:23]
v_mfma_f32_16x16x32_bf16 v[20:23], v[68:71], v[160:163], v[20:23]
v_mfma_f32_16x16x32_bf16 v[20:23], v[72:75], v[164:167], v[20:23]
v_add_u32 v117, 1, v117
buffer_store_dword v117, v118, s[64:67], 0 offen
buffer_load_dwordx4 v[152:155], v2, s[52:55], s12 offen offset:0 nt
buffer_load_dwordx4 v[156:159], v2, s[52:55], s12 offen offset:1024 nt
buffer_load_dwordx4 v[160:163], v2, s[52:55], s12 offen offset:2048 nt
buffer_load_dwordx4 v[164:167], v2, s[52:55], s12 offen offset:3072 nt
s_add_u32 s13, s13, 24576
s_min_u32 s12, s13, 2146435072
ds_read_b64_tr_b16 a[120:121], v90 offset:36864
ds_read_b64_tr_b16 a[122:123], v90 offset:39168
ds_read_b64_tr_b16 a[124:125], v90 offset:55296
ds_read_b64_tr_b16 a[126:127], v90 offset:57600
v_and_b32_dpp v60, v79, v8 row_newbcast:3 row_mask:0xf bank_mask:0xf
v_and_b32_dpp v61, v79, v9 row_newbcast:3 row_mask:0xf bank_mask:0xf
v_and_b32_dpp v62, v79, v10 row_newbcast:3 row_mask:0xf bank_mask:0xf
v_and_b32_dpp v63, v79, v11 row_newbcast:3 row_mask:0xf bank_mask:0xf
v_and_b32_dpp v64, v79, v8 row_newbcast:7 row_mask:0xf bank_mask:0xf
v_and_b32_dpp v65, v79, v9 row_newbcast:7 row_mask:0xf bank_mask:0xf
v_and_b32_dpp v66, v79, v10 row_newbcast:7 row_mask:0xf bank_mask:0xf
v_and_b32_dpp v67, v79, v11 row_newbcast:7 row_mask:0xf bank_mask:0xf
v_and_b32_dpp v68, v79, v8 row_newbcast:11 row_mask:0xf bank_mask:0xf
v_and_b32_dpp v69, v79, v9 row_newbcast:11 row_mask:0xf bank_mask:0xf
v_and_b32_dpp v70, v79, v10 row_newbcast:11 row_mask:0xf bank_mask:0xf
v_and_b32_dpp v71, v79, v11 row_newbcast:11 row_mask:0xf bank_mask:0xf
v_and_b32_dpp v72, v79, v8 row_newbcast:15 row_mask:0xf bank_mask:0xf
v_and_b32_dpp v73, v79, v9 row_newbcast:15 row_mask:0xf bank_mask:0xf
v_and_b32_dpp v74, v79, v10 row_newbcast:15 row_mask:0xf bank_mask:0xf
v_and_b32_dpp v75, v79, v11 row_newbcast:15 row_mask:0xf bank_mask:0xf
s_waitcnt vmcnt(36)
v_mfma_f32_16x16x32_bf16 v[20:23], v[60:63], v[168:171], v[20:23]
v_mfma_f32_16x16x32_bf16 v[20:23], v[64:67], v[172:175], v[20:23]
v_mfma_f32_16x16x32_bf16 v[20:23], v[68:71], v[176:179], v[20:23]
v_mfma_f32_16x16x32_bf16 v[20:23], v[72:75], v[180:183], v[20:23]
v_add_u32 v117, 1, v117
buffer_store_dword v117, v118, s[64:67], 0 offen
buffer_load_dwordx4 v[168:171], v2, s[52:55], s12 offen offset:0 nt
buffer_load_dwordx4 v[172:175], v2, s[52:55], s12 offen offset:1024 nt
buffer_load_dwordx4 v[176:179], v2, s[52:55], s12 offen offset:2048 nt
buffer_load_dwordx4 v[180:183], v2, s[52:55], s12 offen offset:3072 nt
s_add_u32 s13, s13, 24576
s_min_u32 s12, s13, 2146435072
ds_read_b64_tr_b16 a[128:129], v88 offset:8
ds_read_b64_tr_b16 a[130:131], v88 offset:2312
ds_read_b64_tr_b16 a[132:133], v88 offset:18440
ds_read_b64_tr_b16 a[134:135], v88 offset:20744
v_and_b32_dpp v60, v80, v8 row_newbcast:0 row_mask:0xf bank_mask:0xf
v_and_b32_dpp v61, v80, v9 row_newbcast:0 row_mask:0xf bank_mask:0xf
v_and_b32_dpp v62, v80, v10 row_newbcast:0 row_mask:0xf bank_mask:0xf
v_and_b32_dpp v63, v80, v11 row_newbcast:0 row_mask:0xf bank_mask:0xf
v_and_b32_dpp v64, v80, v8 row_newbcast:4 row_mask:0xf bank_mask:0xf
v_and_b32_dpp v65, v80, v9 row_newbcast:4 row_mask:0xf bank_mask:0xf
v_and_b32_dpp v66, v80, v10 row_newbcast:4 row_mask:0xf bank_mask:0xf
v_and_b32_dpp v67, v80, v11 row_newbcast:4 row_mask:0xf bank_mask:0xf
v_and_b32_dpp v68, v80, v8 row_newbcast:8 row_mask:0xf bank_mask:0xf
v_and_b32_dpp v69, v80, v9 row_newbcast:8 row_mask:0xf bank_mask:0xf
v_and_b32_dpp v70, v80, v10 row_newbcast:8 row_mask:0xf bank_mask:0xf
v_and_b32_dpp v71, v80, v11 row_newbcast:8 row_mask:0xf bank_mask:0xf
v_and_b32_dpp v72, v80, v8 row_newbcast:12 row_mask:0xf bank_mask:0xf
v_and_b32_dpp v73, v80, v9 row_newbcast:12 row_mask:0xf bank_mask:0xf
v_and_b32_dpp v74, v80, v10 row_newbcast:12 row_mask:0xf bank_mask:0xf
v_and_b32_dpp v75, v80, v11 row_newbcast:12 row_mask:0xf bank_mask:0xf
s_waitcnt vmcnt(35)
v_mfma_f32_16x16x32_bf16 v[20:23], v[60:63], v[184:187], v[20:23]
v_mfma_f32_16x16x32_bf16 v[20:23], v[64:67], v[188:191], v[20:23]
v_mfma_f32_16x16x32_bf16 v[20:23], v[68:71], v[192:195], v[20:23]
v_mfma_f32_16x16x32_bf16 v[20:23], v[72:75], v[196:199], v[20:23]
v_add_u32 v117, 1, v117
buffer_store_dword v117, v118, s[64:67], 0 offen
buffer_load_dwordx4 v[184:187], v2, s[52:55], s12 offen offset:0 nt
buffer_load_dwordx4 v[188:191], v2, s[52:55], s12 offen offset:1024 nt
buffer_load_dwordx4 v[192:195], v2, s[52:55], s12 offen offset:2048 nt
buffer_load_dwordx4 v[196:199], v2, s[52:55], s12 offen offset:3072 nt
s_add_u32 s13, s13, 24576
s_min_u32 s12, s13, 2146435072
ds_read_b64_tr_b16 a[136:137], v88 offset:36872
ds_read_b64_tr_b16 a[138:139], v88 offset:39176
ds_read_b64_tr_b16 a[140:141], v88 offset:55304
ds_read_b64_tr_b16 a[142:143], v88 offset:57608
v_and_b32_dpp v60, v80, v8 row_newbcast:1 row_mask:0xf bank_mask:0xf
v_and_b32_dpp v61, v80, v9 row_newbcast:1 row_mask:0xf bank_mask:0xf
v_and_b32_dpp v62, v80, v10 row_newbcast:1 row_mask:0xf bank_mask:0xf
v_and_b32_dpp v63, v80, v11 row_newbcast:1 row_mask:0xf bank_mask:0xf
v_and_b32_dpp v64, v80, v8 row_newbcast:5 row_mask:0xf bank_mask:0xf
v_and_b32_dpp v65, v80, v9 row_newbcast:5 row_mask:0xf bank_mask:0xf
v_and_b32_dpp v66, v80, v10 row_newbcast:5 row_mask:0xf bank_mask:0xf
v_and_b32_dpp v67, v80, v11 row_newbcast:5 row_mask:0xf bank_mask:0xf
v_and_b32_dpp v68, v80, v8 row_newbcast:9 row_mask:0xf bank_mask:0xf
v_and_b32_dpp v69, v80, v9 row_newbcast:9 row_mask:0xf bank_mask:0xf
v_and_b32_dpp v70, v80, v10 row_newbcast:9 row_mask:0xf bank_mask:0xf
v_and_b32_dpp v71, v80, v11 row_newbcast:9 row_mask:0xf bank_mask:0xf
v_and_b32_dpp v72, v80, v8 row_newbcast:13 row_mask:0xf bank_mask:0xf
v_and_b32_dpp v73, v80, v9 row_newbcast:13 row_mask:0xf bank_mask:0xf
v_and_b32_dpp v74, v80, v10 row_newbcast:13 row_mask:0xf bank_mask:0xf
v_and_b32_dpp v75, v80, v11 row_newbcast:13 row_mask:0xf bank_mask:0xf
s_waitcnt vmcnt(35)
v_mfma_f32_16x16x32_bf16 v[20:23], v[60:63], v[200:203], v[20:23]
v_mfma_f32_16x16x32_bf16 v[20:23], v[64:67], v[204:207], v[20:23]
v_mfma_f32_16x16x32_bf16 v[20:23], v[68:71], v[208:211], v[20:23]
v_mfma_f32_16x16x32_bf16 v[20:23], v[72:75], v[212:215], v[20:23]
v_add_u32 v117, 1, v117
buffer_store_dword v117, v118, s[64:67], 0 offen
buffer_load_dwordx4 v[200:203], v2, s[52:55], s12 offen offset:0 nt
buffer_load_dwordx4 v[204:207], v2, s[52:55], s12 offen offset:1024 nt
buffer_load_dwordx4 v[208:211], v2, s[52:55], s12 offen offset:2048 nt
buffer_load_dwordx4 v[212:215], v2, s[52:55], s12 offen offset:3072 nt
s_add_u32 s13, s13, 24576
s_min_u32 s12, s13, 2146435072
ds_read_b64_tr_b16 a[144:145], v90 offset:8
ds_read_b64_tr_b16 a[146:147], v90 offset:2312
ds_read_b64_tr_b16 a[148:149], v90 offset:18440
ds_read_b64_tr_b16 a[150:151], v90 offset:20744
v_and_b32_dpp v60, v76, v8 row_newbcast:3 row_mask:0xf bank_mask:0xf
v_and_b32_dpp v61, v76, v9 row_newbcast:3 row_mask:0xf bank_mask:0xf
v_and_b32_dpp v62, v76, v10 row_newbcast:3 row_mask:0xf bank_mask:0xf
v_and_b32_dpp v63, v76, v11 row_newbcast:3 row_mask:0xf bank_mask:0xf
v_and_b32_dpp v64, v76, v8 row_newbcast:7 row_mask:0xf bank_mask:0xf
v_and_b32_dpp v65, v76, v9 row_newbcast:7 row_mask:0xf bank_mask:0xf
v_and_b32_dpp v66, v76, v10 row_newbcast:7 row_mask:0xf bank_mask:0xf
v_and_b32_dpp v67, v76, v11 row_newbcast:7 row_mask:0xf bank_mask:0xf
v_and_b32_dpp v68, v76, v8 row_newbcast:11 row_mask:0xf bank_mask:0xf
v_and_b32_dpp v69, v76, v9 row_newbcast:11 row_mask:0xf bank_mask:0xf
v_and_b32_dpp v70, v76, v10 row_newbcast:11 row_mask:0xf bank_mask:0xf
v_and_b32_dpp v71, v76, v11 row_newbcast:11 row_mask:0xf bank_mask:0xf
v_and_b32_dpp v72, v76, v8 row_newbcast:15 row_mask:0xf bank_mask:0xf
v_and_b32_dpp v73, v76, v9 row_newbcast:15 row_mask:0xf bank_mask:0xf
v_and_b32_dpp v74, v76, v10 row_newbcast:15 row_mask:0xf bank_mask:0xf
v_and_b32_dpp v75, v76, v11 row_newbcast:15 row_mask:0xf bank_mask:0xf
v_mfma_f32_16x16x32_bf16 v[20:23], v[60:63], a[32:35], v[20:23]
v_mfma_f32_16x16x32_bf16 v[20:23], v[64:67], a[36:39], v[20:23]
v_mfma_f32_16x16x32_bf16 v[20:23], v[68:71], a[40:43], v[20:23]
v_mfma_f32_16x16x32_bf16 v[20:23], v[72:75], a[44:47], v[20:23]
s_nop 3
v_and_b32_dpp v60, v80, v8 row_newbcast:2 row_mask:0xf bank_mask:0xf
v_and_b32_dpp v61, v80, v9 row_newbcast:2 row_mask:0xf bank_mask:0xf
v_and_b32_dpp v62, v80, v10 row_newbcast:2 row_mask:0xf bank_mask:0xf
v_and_b32_dpp v63, v80, v11 row_newbcast:2 row_mask:0xf bank_mask:0xf
v_and_b32_dpp v64, v80, v8 row_newbcast:6 row_mask:0xf bank_mask:0xf
v_and_b32_dpp v65, v80, v9 row_newbcast:6 row_mask:0xf bank_mask:0xf
v_and_b32_dpp v66, v80, v10 row_newbcast:6 row_mask:0xf bank_mask:0xf
v_and_b32_dpp v67, v80, v11 row_newbcast:6 row_mask:0xf bank_mask:0xf
v_and_b32_dpp v68, v80, v8 row_newbcast:10 row_mask:0xf bank_mask:0xf
v_and_b32_dpp v69, v80, v9 row_newbcast:10 row_mask:0xf bank_mask:0xf
v_and_b32_dpp v70, v80, v10 row_newbcast:10 row_mask:0xf bank_mask:0xf
v_and_b32_dpp v71, v80, v11 row_newbcast:10 row_mask:0xf bank_mask:0xf
v_and_b32_dpp v72, v80, v8 row_newbcast:14 row_mask:0xf bank_mask:0xf
v_and_b32_dpp v73, v80, v9 row_newbcast:14 row_mask:0xf bank_mask:0xf
v_and_b32_dpp v74, v80, v10 row_newbcast:14 row_mask:0xf bank_mask:0xf
v_and_b32_dpp v75, v80, v11 row_newbcast:14 row_mask:0xf bank_mask:0xf
s_waitcnt vmcnt(35)
v_mfma_f32_16x16x32_bf16 v[20:23], v[60:63], v[216:219], v[20:23]
v_mfma_f32_16x16x32_bf16 v[20:23], v[64:67], v[220:223], v[20:23]
v_mfma_f32_16x16x32_bf16 v[20:23], v[68:71], v[224:227], v[20:23]
v_mfma_f32_16x16x32_bf16 v[20:23], v[72:75], v[228:231], v[20:23]
v_add_u32 v117, 1, v117
buffer_store_dword v117, v118, s[64:67], 0 offen
buffer_load_dwordx4 v[216:219], v2, s[52:55], s12 offen offset:0 nt
buffer_load_dwordx4 v[220:223], v2, s[52:55], s12 offen offset:1024 nt
buffer_load_dwordx4 v[224:227], v2, s[52:55], s12 offen offset:2048 nt
buffer_load_dwordx4 v[228:231], v2, s[52:55], s12 offen offset:3072 nt
s_add_u32 s13, s13, 24576
s_min_u32 s12, s13, 2146435072
ds_read_b64_tr_b16 a[152:153], v90 offset:36872
ds_read_b64_tr_b16 a[154:155], v90 offset:39176
ds_read_b64_tr_b16 a[156:157], v90 offset:55304
ds_read_b64_tr_b16 a[158:159], v90 offset:57608
v_and_b32_dpp v60, v80, v8 row_newbcast:3 row_mask:0xf bank_mask:0xf
v_and_b32_dpp v61, v80, v9 row_newbcast:3 row_mask:0xf bank_mask:0xf
v_and_b32_dpp v62, v80, v10 row_newbcast:3 row_mask:0xf bank_mask:0xf
v_and_b32_dpp v63, v80, v11 row_newbcast:3 row_mask:0xf bank_mask:0xf
v_and_b32_dpp v64, v80, v8 row_newbcast:7 row_mask:0xf bank_mask:0xf
v_and_b32_dpp v65, v80, v9 row_newbcast:7 row_mask:0xf bank_mask:0xf
v_and_b32_dpp v66, v80, v10 row_newbcast:7 row_mask:0xf bank_mask:0xf
v_and_b32_dpp v67, v80, v11 row_newbcast:7 row_mask:0xf bank_mask:0xf
v_and_b32_dpp v68, v80, v8 row_newbcast:11 row_mask:0xf bank_mask:0xf
v_and_b32_dpp v69, v80, v9 row_newbcast:11 row_mask:0xf bank_mask:0xf
v_and_b32_dpp v70, v80, v10 row_newbcast:11 row_mask:0xf bank_mask:0xf
v_and_b32_dpp v71, v80, v11 row_newbcast:11 row_mask:0xf bank_mask:0xf
v_and_b32_dpp v72, v80, v8 row_newbcast:15 row_mask:0xf bank_mask:0xf
v_and_b32_dpp v73, v80, v9 row_newbcast:15 row_mask:0xf bank_mask:0xf
v_and_b32_dpp v74, v80, v10 row_newbcast:15 row_mask:0xf bank_mask:0xf
v_and_b32_dpp v75, v80, v11 row_newbcast:15 row_mask:0xf bank_mask:0xf
s_waitcnt vmcnt(35)
v_mfma_f32_16x16x32_bf16 v[20:23], v[60:63], v[232:235], v[20:23]
v_mfma_f32_16x16x32_bf16 v[20:23], v[64:67], v[236:239], v[20:23]
v_mfma_f32_16x16x32_bf16 v[20:23], v[68:71], v[240:243], v[20:23]
v_mfma_f32_16x16x32_bf16 v[20:23], v[72:75], v[244:247], v[20:23]
v_add_u32 v117, 1, v117
buffer_store_dword v117, v118, s[64:67], 0 offen
buffer_load_dwordx4 v[232:235], v2, s[52:55], s12 offen offset:0 nt
buffer_load_dwordx4 v[236:239], v2, s[52:55], s12 offen offset:1024 nt
buffer_load_dwordx4 v[240:243], v2, s[52:55], s12 offen offset:2048 nt
buffer_load_dwordx4 v[244:247], v2, s[52:55], s12 offen offset:3072 nt
s_add_u32 s13, s13, 24576
s_min_u32 s12, s13, 2146435072
ds_read_b64_tr_b16 a[160:161], v88 offset:16
ds_read_b64_tr_b16 a[162:163], v88 offset:2320
ds_read_b64_tr_b16 a[164:165], v88 offset:18448
ds_read_b64_tr_b16 a[166:167], v88 offset:20752
v_and_b32_dpp v60, v81, v8 row_newbcast:0 row_mask:0xf bank_mask:0xf
v_and_b32_dpp v61, v81, v9 row_newbcast:0 row_mask:0xf bank_mask:0xf
v_and_b32_dpp v62, v81, v10 row_newbcast:0 row_mask:0xf bank_mask:0xf
v_and_b32_dpp v63, v81, v11 row_newbcast:0 row_mask:0xf bank_mask:0xf
v_and_b32_dpp v64, v81, v8 row_newbcast:4 row_mask:0xf bank_mask:0xf
v_and_b32_dpp v65, v81, v9 row_newbcast:4 row_mask:0xf bank_mask:0xf
v_and_b32_dpp v66, v81, v10 row_newbcast:4 row_mask:0xf bank_mask:0xf
v_and_b32_dpp v67, v81, v11 row_newbcast:4 row_mask:0xf bank_mask:0xf
v_and_b32_dpp v68, v81, v8 row_newbcast:8 row_mask:0xf bank_mask:0xf
v_and_b32_dpp v69, v81, v9 row_newbcast:8 row_mask:0xf bank_mask:0xf
v_and_b32_dpp v70, v81, v10 row_newbcast:8 row_mask:0xf bank_mask:0xf
v_and_b32_dpp v71, v81, v11 row_newbcast:8 row_mask:0xf bank_mask:0xf
v_and_b32_dpp v72, v81, v8 row_newbcast:12 row_mask:0xf bank_mask:0xf
v_and_b32_dpp v73, v81, v9 row_newbcast:12 row_mask:0xf bank_mask:0xf
v_and_b32_dpp v74, v81, v10 row_newbcast:12 row_mask:0xf bank_mask:0xf
v_and_b32_dpp v75, v81, v11 row_newbcast:12 row_mask:0xf bank_mask:0xf
s_waitcnt vmcnt(35)
v_mfma_f32_16x16x32_bf16 v[20:23], v[60:63], v[120:123], v[20:23]
v_mfma_f32_16x16x32_bf16 v[20:23], v[64:67], v[124:127], v[20:23]
v_mfma_f32_16x16x32_bf16 v[20:23], v[68:71], v[128:131], v[20:23]
v_mfma_f32_16x16x32_bf16 v[20:23], v[72:75], v[132:135], v[20:23]
v_add_u32 v117, 1, v117
buffer_store_dword v117, v118, s[64:67], 0 offen
buffer_load_dwordx4 v[120:123], v2, s[52:55], s12 offen offset:0 nt
buffer_load_dwordx4 v[124:127], v2, s[52:55], s12 offen offset:1024 nt
buffer_load_dwordx4 v[128:131], v2, s[52:55], s12 offen offset:2048 nt
buffer_load_dwordx4 v[132:135], v2, s[52:55], s12 offen offset:3072 nt
s_add_u32 s13, s13, 24576
s_min_u32 s12, s13, 2146435072
ds_read_b64_tr_b16 a[168:169], v88 offset:36880
ds_read_b64_tr_b16 a[170:171], v88 offset:39184
ds_read_b64_tr_b16 a[172:173], v88 offset:55312
ds_read_b64_tr_b16 a[174:175], v88 offset:57616
v_and_b32_dpp v60, v81, v8 row_newbcast:1 row_mask:0xf bank_mask:0xf
v_and_b32_dpp v61, v81, v9 row_newbcast:1 row_mask:0xf bank_mask:0xf
v_and_b32_dpp v62, v81, v10 row_newbcast:1 row_mask:0xf bank_mask:0xf
v_and_b32_dpp v63, v81, v11 row_newbcast:1 row_mask:0xf bank_mask:0xf
v_and_b32_dpp v64, v81, v8 row_newbcast:5 row_mask:0xf bank_mask:0xf
v_and_b32_dpp v65, v81, v9 row_newbcast:5 row_mask:0xf bank_mask:0xf
v_and_b32_dpp v66, v81, v10 row_newbcast:5 row_mask:0xf bank_mask:0xf
v_and_b32_dpp v67, v81, v11 row_newbcast:5 row_mask:0xf bank_mask:0xf
v_and_b32_dpp v68, v81, v8 row_newbcast:9 row_mask:0xf bank_mask:0xf
v_and_b32_dpp v69, v81, v9 row_newbcast:9 row_mask:0xf bank_mask:0xf
v_and_b32_dpp v70, v81, v10 row_newbcast:9 row_mask:0xf bank_mask:0xf
v_and_b32_dpp v71, v81, v11 row_newbcast:9 row_mask:0xf bank_mask:0xf
v_and_b32_dpp v72, v81, v8 row_newbcast:13 row_mask:0xf bank_mask:0xf
v_and_b32_dpp v73, v81, v9 row_newbcast:13 row_mask:0xf bank_mask:0xf
v_and_b32_dpp v74, v81, v10 row_newbcast:13 row_mask:0xf bank_mask:0xf
v_and_b32_dpp v75, v81, v11 row_newbcast:13 row_mask:0xf bank_mask:0xf
s_waitcnt vmcnt(35)
v_mfma_f32_16x16x32_bf16 v[20:23], v[60:63], v[136:139], v[20:23]
v_mfma_f32_16x16x32_bf16 v[20:23], v[64:67], v[140:143], v[20:23]
v_mfma_f32_16x16x32_bf16 v[20:23], v[68:71], v[144:147], v[20:23]
v_mfma_f32_16x16x32_bf16 v[20:23], v[72:75], v[148:151], v[20:23]
v_add_u32 v117, 1, v117
buffer_store_dword v117, v118, s[64:67], 0 offen
buffer_load_dwordx4 v[136:139], v2, s[52:55], s12 offen offset:0 nt
buffer_load_dwordx4 v[140:143], v2, s[52:55], s12 offen offset:1024 nt
buffer_load_dwordx4 v[144:147], v2, s[52:55], s12 offen offset:2048 nt
buffer_load_dwordx4 v[148:151], v2, s[52:55], s12 offen offset:3072 nt
s_add_u32 s13, s13, 24576
s_min_u32 s12, s13, 2146435072
ds_read_b64_tr_b16 a[176:177], v90 offset:16
ds_read_b64_tr_b16 a[178:179], v90 offset:2320
ds_read_b64_tr_b16 a[180:181], v90 offset:18448
ds_read_b64_tr_b16 a[182:183], v90 offset:20752
v_and_b32_dpp v60, v77, v8 row_newbcast:0 row_mask:0xf bank_mask:0xf
v_and_b32_dpp v61, v77, v9 row_newbcast:0 row_mask:0xf bank_mask:0xf
v_and_b32_dpp v62, v77, v10 row_newbcast:0 row_mask:0xf bank_mask:0xf
v_and_b32_dpp v63, v77, v11 row_newbcast:0 row_mask:0xf bank_mask:0xf
v_and_b32_dpp v64, v77, v8 row_newbcast:4 row_mask:0xf bank_mask:0xf
v_and_b32_dpp v65, v77, v9 row_newbcast:4 row_mask:0xf bank_mask:0xf
v_and_b32_dpp v66, v77, v10 row_newbcast:4 row_mask:0xf bank_mask:0xf
v_and_b32_dpp v67, v77, v11 row_newbcast:4 row_mask:0xf bank_mask:0xf
v_and_b32_dpp v68, v77, v8 row_newbcast:8 row_mask:0xf bank_mask:0xf
v_and_b32_dpp v69, v77, v9 row_newbcast:8 row_mask:0xf bank_mask:0xf
v_and_b32_dpp v70, v77, v10 row_newbcast:8 row_mask:0xf bank_mask:0xf
v_and_b32_dpp v71, v77, v11 row_newbcast:8 row_mask:0xf bank_mask:0xf
v_and_b32_dpp v72, v77, v8 row_newbcast:12 row_mask:0xf bank_mask:0xf
v_and_b32_dpp v73, v77, v9 row_newbcast:12 row_mask:0xf bank_mask:0xf
v_and_b32_dpp v74, v77, v10 row_newbcast:12 row_mask:0xf bank_mask:0xf
v_and_b32_dpp v75, v77, v11 row_newbcast:12 row_mask:0xf bank_mask:0xf
v_mfma_f32_16x16x32_bf16 v[20:23], v[60:63], a[48:51], v[20:23]
v_mfma_f32_16x16x32_bf16 v[20:23], v[64:67], a[52:55], v[20:23]
v_mfma_f32_16x16x32_bf16 v[20:23], v[68:71], a[56:59], v[20:23]
v_mfma_f32_16x16x32_bf16 v[20:23], v[72:75], a[60:63], v[20:23]
s_nop 3
v_and_b32_dpp v60, v81, v8 row_newbcast:2 row_mask:0xf bank_mask:0xf
v_and_b32_dpp v61, v81, v9 row_newbcast:2 row_mask:0xf bank_mask:0xf
v_and_b32_dpp v62, v81, v10 row_newbcast:2 row_mask:0xf bank_mask:0xf
v_and_b32_dpp v63, v81, v11 row_newbcast:2 row_mask:0xf bank_mask:0xf
v_and_b32_dpp v64, v81, v8 row_newbcast:6 row_mask:0xf bank_mask:0xf
v_and_b32_dpp v65, v81, v9 row_newbcast:6 row_mask:0xf bank_mask:0xf
v_and_b32_dpp v66, v81, v10 row_newbcast:6 row_mask:0xf bank_mask:0xf
v_and_b32_dpp v67, v81, v11 row_newbcast:6 row_mask:0xf bank_mask:0xf
v_and_b32_dpp v68, v81, v8 row_newbcast:10 row_mask:0xf bank_mask:0xf
v_and_b32_dpp v69, v81, v9 row_newbcast:10 row_mask:0xf bank_mask:0xf
v_and_b32_dpp v70, v81, v10 row_newbcast:10 row_mask:0xf bank_mask:0xf
v_and_b32_dpp v71, v81, v11 row_newbcast:10 row_mask:0xf bank_mask:0xf
v_and_b32_dpp v72, v81, v8 row_newbcast:14 row_mask:0xf bank_mask:0xf
v_and_b32_dpp v73, v81, v9 row_newbcast:14 row_mask:0xf bank_mask:0xf
v_and_b32_dpp v74, v81, v10 row_newbcast:14 row_mask:0xf bank_mask:0xf
v_and_b32_dpp v75, v81, v11 row_newbcast:14 row_mask:0xf bank_mask:0xf
s_waitcnt vmcnt(35)
v_mfma_f32_16x16x32_bf16 v[20:23], v[60:63], v[152:155], v[20:23]
v_mfma_f32_16x16x32_bf16 v[20:23], v[64:67], v[156:159], v[20:23]
v_mfma_f32_16x16x32_bf16 v[20:23], v[68:71], v[160:163], v[20:23]
v_mfma_f32_16x16x32_bf16 v[20:23], v[72:75], v[164:167], v[20:23]
v_add_u32 v117, 1, v117
buffer_store_dword v117, v118, s[64:67], 0 offen
buffer_load_dwordx4 v[152:155], v2, s[52:55], s12 offen offset:0 nt
buffer_load_dwordx4 v[156:159], v2, s[52:55], s12 offen offset:1024 nt
buffer_load_dwordx4 v[160:163], v2, s[52:55], s12 offen offset:2048 nt
buffer_load_dwordx4 v[164:167], v2, s[52:55], s12 offen offset:3072 nt
s_add_u32 s13, s13, 24576
s_min_u32 s12, s13, 2146435072
ds_read_b64_tr_b16 a[184:185], v90 offset:36880
ds_read_b64_tr_b16 a[186:187], v90 offset:39184
ds_read_b64_tr_b16 a[188:189], v90 offset:55312
ds_read_b64_tr_b16 a[190:191], v90 offset:57616
v_and_b32_dpp v60, v81, v8 row_newbcast:3 row_mask:0xf bank_mask:0xf
v_and_b32_dpp v61, v81, v9 row_newbcast:3 row_mask:0xf bank_mask:0xf
v_and_b32_dpp v62, v81, v10 row_newbcast:3 row_mask:0xf bank_mask:0xf
v_and_b32_dpp v63, v81, v11 row_newbcast:3 row_mask:0xf bank_mask:0xf
v_and_b32_dpp v64, v81, v8 row_newbcast:7 row_mask:0xf bank_mask:0xf
v_and_b32_dpp v65, v81, v9 row_newbcast:7 row_mask:0xf bank_mask:0xf
v_and_b32_dpp v66, v81, v10 row_newbcast:7 row_mask:0xf bank_mask:0xf
v_and_b32_dpp v67, v81, v11 row_newbcast:7 row_mask:0xf bank_mask:0xf
v_and_b32_dpp v68, v81, v8 row_newbcast:11 row_mask:0xf bank_mask:0xf
v_and_b32_dpp v69, v81, v9 row_newbcast:11 row_mask:0xf bank_mask:0xf
v_and_b32_dpp v70, v81, v10 row_newbcast:11 row_mask:0xf bank_mask:0xf
v_and_b32_dpp v71, v81, v11 row_newbcast:11 row_mask:0xf bank_mask:0xf
v_and_b32_dpp v72, v81, v8 row_newbcast:15 row_mask:0xf bank_mask:0xf
v_and_b32_dpp v73, v81, v9 row_newbcast:15 row_mask:0xf bank_mask:0xf
v_and_b32_dpp v74, v81, v10 row_newbcast:15 row_mask:0xf bank_mask:0xf
v_and_b32_dpp v75, v81, v11 row_newbcast:15 row_mask:0xf bank_mask:0xf
s_waitcnt vmcnt(35)
v_mfma_f32_16x16x32_bf16 v[20:23], v[60:63], v[168:171], v[20:23]
v_mfma_f32_16x16x32_bf16 v[20:23], v[64:67], v[172:175], v[20:23]
v_mfma_f32_16x16x32_bf16 v[20:23], v[68:71], v[176:179], v[20:23]
v_mfma_f32_16x16x32_bf16 v[20:23], v[72:75], v[180:183], v[20:23]
v_add_u32 v117, 1, v117
buffer_store_dword v117, v118, s[64:67], 0 offen
buffer_load_dwordx4 v[168:171], v2, s[52:55], s12 offen offset:0 nt
buffer_load_dwordx4 v[172:175], v2, s[52:55], s12 offen offset:1024 nt
buffer_load_dwordx4 v[176:179], v2, s[52:55], s12 offen offset:2048 nt
buffer_load_dwordx4 v[180:183], v2, s[52:55], s12 offen offset:3072 nt
s_add_u32 s13, s13, 24576
s_min_u32 s12, s13, 2146435072
ds_read_b64_tr_b16 a[192:193], v88 offset:24
ds_read_b64_tr_b16 a[194:195], v88 offset:2328
ds_read_b64_tr_b16 a[196:197], v88 offset:18456
ds_read_b64_tr_b16 a[198:199], v88 offset:20760
v_and_b32_dpp v60, v82, v8 row_newbcast:0 row_mask:0xf bank_mask:0xf
v_and_b32_dpp v61, v82, v9 row_newbcast:0 row_mask:0xf bank_mask:0xf
v_and_b32_dpp v62, v82, v10 row_newbcast:0 row_mask:0xf bank_mask:0xf
v_and_b32_dpp v63, v82, v11 row_newbcast:0 row_mask:0xf bank_mask:0xf
v_and_b32_dpp v64, v82, v8 row_newbcast:4 row_mask:0xf bank_mask:0xf
v_and_b32_dpp v65, v82, v9 row_newbcast:4 row_mask:0xf bank_mask:0xf
v_and_b32_dpp v66, v82, v10 row_newbcast:4 row_mask:0xf bank_mask:0xf
v_and_b32_dpp v67, v82, v11 row_newbcast:4 row_mask:0xf bank_mask:0xf
v_and_b32_dpp v68, v82, v8 row_newbcast:8 row_mask:0xf bank_mask:0xf
v_and_b32_dpp v69, v82, v9 row_newbcast:8 row_mask:0xf bank_mask:0xf
v_and_b32_dpp v70, v82, v10 row_newbcast:8 row_mask:0xf bank_mask:0xf
v_and_b32_dpp v71, v82, v11 row_newbcast:8 row_mask:0xf bank_mask:0xf
v_and_b32_dpp v72, v82, v8 row_newbcast:12 row_mask:0xf bank_mask:0xf
v_and_b32_dpp v73, v82, v9 row_newbcast:12 row_mask:0xf bank_mask:0xf
v_and_b32_dpp v74, v82, v10 row_newbcast:12 row_mask:0xf bank_mask:0xf
v_and_b32_dpp v75, v82, v11 row_newbcast:12 row_mask:0xf bank_mask:0xf
s_waitcnt vmcnt(35)
v_mfma_f32_16x16x32_bf16 v[20:23], v[60:63], v[184:187], v[20:23]
v_mfma_f32_16x16x32_bf16 v[20:23], v[64:67], v[188:191], v[20:23]
v_mfma_f32_16x16x32_bf16 v[20:23], v[68:71], v[192:195], v[20:23]
v_mfma_f32_16x16x32_bf16 v[20:23], v[72:75], v[196:199], v[20:23]
v_add_u32 v117, 1, v117
buffer_store_dword v117, v118, s[64:67], 0 offen
s_cmp_le_u32 s15, 32
s_cbranch_scc0 L_thr_15
s_waitcnt vmcnt(7)
L_thr_15:
buffer_load_dwordx4 v[184:187], v2, s[52:55], s12 offen offset:0 nt
buffer_load_dwordx4 v[188:191], v2, s[52:55], s12 offen offset:1024 nt
s_cbranch_scc0 L_thr_16
s_waitcnt vmcnt(7)
L_thr_16:
buffer_load_dwordx4 v[192:195], v2, s[52:55], s12 offen offset:2048 nt
buffer_load_dwordx4 v[196:199], v2, s[52:55], s12 offen offset:3072 nt
s_add_u32 s13, s13, 24576
s_min_u32 s12, s13, 2146435072
ds_read_b64_tr_b16 a[200:201], v88 offset:36888
ds_read_b64_tr_b16 a[202:203], v88 offset:39192
ds_read_b64_tr_b16 a[204:205], v88 offset:55320
ds_read_b64_tr_b16 a[206:207], v88 offset:57624
v_and_b32_dpp v60, v82, v8 row_newbcast:1 row_mask:0xf bank_mask:0xf
v_and_b32_dpp v61, v82, v9 row_newbcast:1 row_mask:0xf bank_mask:0xf
v_and_b32_dpp v62, v82, v10 row_newbcast:1 row_mask:0xf bank_mask:0xf
v_and_b32_dpp v63, v82, v11 row_newbcast:1 row_mask:0xf bank_mask:0xf
v_and_b32_dpp v64, v82, v8 row_newbcast:5 row_mask:0xf bank_mask:0xf
v_and_b32_dpp v65, v82, v9 row_newbcast:5 row_mask:0xf bank_mask:0xf
v_and_b32_dpp v66, v82, v10 row_newbcast:5 row_mask:0xf bank_mask:0xf
v_and_b32_dpp v67, v82, v11 row_newbcast:5 row_mask:0xf bank_mask:0xf
v_and_b32_dpp v68, v82, v8 row_newbcast:9 row_mask:0xf bank_mask:0xf
v_and_b32_dpp v69, v82, v9 row_newbcast:9 row_mask:0xf bank_mask:0xf
v_and_b32_dpp v70, v82, v10 row_newbcast:9 row_mask:0xf bank_mask:0xf
v_and_b32_dpp v71, v82, v11 row_newbcast:9 row_mask:0xf bank_mask:0xf
v_and_b32_dpp v72, v82, v8 row_newbcast:13 row_mask:0xf bank_mask:0xf
v_and_b32_dpp v73, v82, v9 row_newbcast:13 row_mask:0xf bank_mask:0xf
v_and_b32_dpp v74, v82, v10 row_newbcast:13 row_mask:0xf bank_mask:0xf
v_and_b32_dpp v75, v82, v11 row_newbcast:13 row_mask:0xf bank_mask:0xf
s_waitcnt vmcnt(35)
v_mfma_f32_16x16x32_bf16 v[20:23], v[60:63], v[200:203], v[20:23]
v_mfma_f32_16x16x32_bf16 v[20:23], v[64:67], v[204:207], v[20:23]
v_mfma_f32_16x16x32_bf16 v[20:23], v[68:71], v[208:211], v[20:23]
v_mfma_f32_16x16x32_bf16 v[20:23], v[72:75], v[212:215], v[20:23]
v_add_u32 v117, 1, v117
buffer_store_dword v117, v118, s[64:67], 0 offen
s_cmp_le_u32 s15, 33
s_cbranch_scc0 L_thr_17
s_waitcnt vmcnt(7)
L_thr_17:
buffer_load_dwordx4 v[200:203], v2, s[52:55], s12 offen offset:0 nt
buffer_load_dwordx4 v[204:207], v2, s[52:55], s12 offen offset:1024 nt
s_cbranch_scc0 L_thr_18
s_waitcnt vmcnt(7)
L_thr_18:
buffer_load_dwordx4 v[208:211], v2, s[52:55], s12 offen offset:2048 nt
buffer_load_dwordx4 v[212:215], v2, s[52:55], s12 offen offset:3072 nt
s_add_u32 s13, s13, 24576
s_min_u32 s12, s13, 2146435072
ds_read_b64_tr_b16 a[208:209], v90 offset:24
ds_read_b64_tr_b16 a[210:211], v90 offset:2328
ds_read_b64_tr_b16 a[212:213], v90 offset:18456
ds_read_b64_tr_b16 a[214:215], v90 offset:20760
v_and_b32_dpp v60, v77, v8 row_newbcast:1 row_mask:0xf bank_mask:0xf
v_and_b32_dpp v61, v77, v9 row_newbcast:1 row_mask:0xf bank_mask:0xf
v_and_b32_dpp v62, v77, v10 row_newbcast:1 row_mask:0xf bank_mask:0xf
v_and_b32_dpp v63, v77, v11 row_newbcast:1 row_mask:0xf bank_mask:0xf
v_and_b32_dpp v64, v77, v8 row_newbcast:5 row_mask:0xf bank_mask:0xf
v_and_b32_dpp v65, v77, v9 row_newbcast:5 row_mask:0xf bank_mask:0xf
v_and_b32_dpp v66, v77, v10 row_newbcast:5 row_mask:0xf bank_mask:0xf
v_and_b32_dpp v67, v77, v11 row_newbcast:5 row_mask:0xf bank_mask:0xf
v_and_b32_dpp v68, v77, v8 row_newbcast:9 row_mask:0xf bank_mask:0xf
v_and_b32_dpp v69, v77, v9 row_newbcast:9 row_mask:0xf bank_mask:0xf
v_and_b32_dpp v70, v77, v10 row_newbcast:9 row_mask:0xf bank_mask:0xf
v_and_b32_dpp v71, v77, v11 row_newbcast:9 row_mask:0xf bank_mask:0xf
v_and_b32_dpp v72, v77, v8 row_newbcast:13 row_mask:0xf bank_mask:0xf
v_and_b32_dpp v73, v77, v9 row_newbcast:13 row_mask:0xf bank_mask:0xf
v_and_b32_dpp v74, v77, v10 row_newbcast:13 row_mask:0xf bank_mask:0xf
v_and_b32_dpp v75, v77, v11 row_newbcast:13 row_mask:0xf bank_mask:0xf
v_mfma_f32_16x16x32_bf16 v[20:23], v[60:63], a[64:67], v[20:23]
v_mfma_f32_16x16x32_bf16 v[20:23], v[64:67], a[68:71], v[20:23]
v_mfma_f32_16x16x32_bf16 v[20:23], v[68:71], a[72:75], v[20:23]
v_mfma_f32_16x16x32_bf16 v[20:23], v[72:75], a[76:79], v[20:23]
s_nop 3
v_and_b32_dpp v60, v82, v8 row_newbcast:2 row_mask:0xf bank_mask:0xf
v_and_b32_dpp v61, v82, v9 row_newbcast:2 row_mask:0xf bank_mask:0xf
v_and_b32_dpp v62, v82, v10 row_newbcast:2 row_mask:0xf bank_mask:0xf
v_and_b32_dpp v63, v82, v11 row_newbcast:2 row_mask:0xf bank_mask:0xf
v_and_b32_dpp v64, v82, v8 row_newbcast:6 row_mask:0xf bank_mask:0xf
v_and_b32_dpp v65, v82, v9 row_newbcast:6 row_mask:0xf bank_mask:0xf
v_and_b32_dpp v66, v82, v10 row_newbcast:6 row_mask:0xf bank_mask:0xf
v_and_b32_dpp v67, v82, v11 row_newbcast:6 row_mask:0xf bank_mask:0xf
v_and_b32_dpp v68, v82, v8 row_newbcast:10 row_mask:0xf bank_mask:0xf
v_and_b32_dpp v69, v82, v9 row_newbcast:10 row_mask:0xf bank_mask:0xf
v_and_b32_dpp v70, v82, v10 row_newbcast:10 row_mask:0xf bank_mask:0xf
v_and_b32_dpp v71, v82, v11 row_newbcast:10 row_mask:0xf bank_mask:0xf
v_and_b32_dpp v72, v82, v8 row_newbcast:14 row_mask:0xf bank_mask:0xf
v_and_b32_dpp v73, v82, v9 row_newbcast:14 row_mask:0xf bank_mask:0xf
v_and_b32_dpp v74, v82, v10 row_newbcast:14 row_mask:0xf bank_mask:0xf
v_and_b32_dpp v75, v82, v11 row_newbcast:14 row_mask:0xf bank_mask:0xf
s_waitcnt vmcnt(35)
v_mfma_f32_16x16x32_bf16 v[20:23], v[60:63], v[216:219], v[20:23]
v_mfma_f32_16x16x32_bf16 v[20:23], v[64:67], v[220:223], v[20:23]
v_mfma_f32_16x16x32_bf16 v[20:23], v[68:71], v[224:227], v[20:23]
v_mfma_f32_16x16x32_bf16 v[20:23], v[72:75], v[228:231], v[20:23]
v_add_u32 v117, 1, v117
buffer_store_dword v117, v118, s[64:67], 0 offen
s_cmp_le_u32 s15, 34
s_cbranch_scc0 L_thr_19
s_waitcnt vmcnt(7)
L_thr_19:
buffer_load_dwordx4 v[216:219], v2, s[52:55], s12 offen offset:0 nt
buffer_load_dwordx4 v[220:223], v2, s[52:55], s12 offen offset:1024 nt
s_cbranch_scc0 L_thr_20
s_waitcnt vmcnt(7)
L_thr_20:
buffer_load_dwordx4 v[224:227], v2, s[52:55], s12 offen offset:2048 nt
buffer_load_dwordx4 v[228:231], v2, s[52:55], s12 offen offset:3072 nt
s_add_u32 s13, s13, 24576
s_min_u32 s12, s13, 2146435072
ds_read_b64_tr_b16 a[216:217], v90 offset:36888
ds_read_b64_tr_b16 a[218:219], v90 offset:39192
ds_read_b64_tr_b16 a[220:221], v90 offset:55320
ds_read_b64_tr_b16 a[222:223], v90 offset:57624
v_and_b32_dpp v60, v82, v8 row_newbcast:3 row_mask:0xf bank_mask:0xf
v_and_b32_dpp v61, v82, v9 row_newbcast:3 row_mask:0xf bank_mask:0xf
v_and_b32_dpp v62, v82, v10 row_newbcast:3 row_mask:0xf bank_mask:0xf
v_and_b32_dpp v63, v82, v11 row_newbcast:3 row_mask:0xf bank_mask:0xf
v_and_b32_dpp v64, v82, v8 row_newbcast:7 row_mask:0xf bank_mask:0xf
v_and_b32_dpp v65, v82, v9 row_newbcast:7 row_mask:0xf bank_mask:0xf
v_and_b32_dpp v66, v82, v10 row_newbcast:7 row_mask:0xf bank_mask:0xf
v_and_b32_dpp v67, v82, v11 row_newbcast:7 row_mask:0xf bank_mask:0xf
v_and_b32_dpp v68, v82, v8 row_newbcast:11 row_mask:0xf bank_mask:0xf
v_and_b32_dpp v69, v82, v9 row_newbcast:11 row_mask:0xf bank_mask:0xf
v_and_b32_dpp v70, v82, v10 row_newbcast:11 row_mask:0xf bank_mask:0xf
v_and_b32_dpp v71, v82, v11 row_newbcast:11 row_mask:0xf bank_mask:0xf
v_and_b32_dpp v72, v82, v8 row_newbcast:15 row_mask:0xf bank_mask:0xf
v_and_b32_dpp v73, v82, v9 row_newbcast:15 row_mask:0xf bank_mask:0xf
v_and_b32_dpp v74, v82, v10 row_newbcast:15 row_mask:0xf bank_mask:0xf
v_and_b32_dpp v75, v82, v11 row_newbcast:15 row_mask:0xf bank_mask:0xf
s_waitcnt vmcnt(35)
v_mfma_f32_16x16x32_bf16 v[20:23], v[60:63], v[232:235], v[20:23]
v_mfma_f32_16x16x32_bf16 v[20:23], v[64:67], v[236:239], v[20:23]
v_mfma_f32_16x16x32_bf16 v[20:23], v[68:71], v[240:243], v[20:23]
v_mfma_f32_16x16x32_bf16 v[20:23], v[72:75], v[244:247], v[20:23]
v_add_u32 v117, 1, v117
buffer_store_dword v117, v118, s[64:67], 0 offen
s_cmp_le_u32 s15, 35
s_cbranch_scc0 L_thr_21
s_waitcnt vmcnt(7)
L_thr_21:
buffer_load_dwordx4 v[232:235], v2, s[52:55], s12 offen offset:0 nt
buffer_load_dwordx4 v[236:239], v2, s[52:55], s12 offen offset:1024 nt
s_cbranch_scc0 L_thr_22
s_waitcnt vmcnt(7)
L_thr_22:
buffer_load_dwordx4 v[240:243], v2, s[52:55], s12 offen offset:2048 nt
buffer_load_dwordx4 v[244:247], v2, s[52:55], s12 offen offset:3072 nt
s_add_u32 s13, s13, 24576
s_min_u32 s12, s13, 2146435072
ds_read_b64_tr_b16 a[224:225], v89 offset:0
ds_read_b64_tr_b16 a[226:227], v89 offset:4608
ds_read_b64_tr_b16 a[228:229], v89 offset:36864
ds_read_b64_tr_b16 a[230:231], v89 offset:41472
buffer_load_dwordx4 v[40:43], off, s[64:67], s82 offset:0 sc1
buffer_load_dwordx4 v[44:47], off, s[64:67], s82 offset:16 sc1
buffer_load_dwordx4 v[48:51], off, s[64:67], s82 offset:32 sc1
v_and_b32_dpp v60, v83, v8 row_newbcast:0 row_mask:0xf bank_mask:0xf
v_and_b32_dpp v61, v83, v9 row_newbcast:0 row_mask:0xf bank_mask:0xf
v_and_b32_dpp v62, v83, v10 row_newbcast:0 row_mask:0xf bank_mask:0xf
v_and_b32_dpp v63, v83, v11 row_newbcast:0 row_mask:0xf bank_mask:0xf
v_and_b32_dpp v64, v83, v8 row_newbcast:4 row_mask:0xf bank_mask:0xf
v_and_b32_dpp v65, v83, v9 row_newbcast:4 row_mask:0xf bank_mask:0xf
v_and_b32_dpp v66, v83, v10 row_newbcast:4 row_mask:0xf bank_mask:0xf
v_and_b32_dpp v67, v83, v11 row_newbcast:4 row_mask:0xf bank_mask:0xf
v_and_b32_dpp v68, v83, v8 row_newbcast:8 row_mask:0xf bank_mask:0xf
v_and_b32_dpp v69, v83, v9 row_newbcast:8 row_mask:0xf bank_mask:0xf
v_and_b32_dpp v70, v83, v10 row_newbcast:8 row_mask:0xf bank_mask:0xf
v_and_b32_dpp v71, v83, v11 row_newbcast:8 row_mask:0xf bank_mask:0xf
v_and_b32_dpp v72, v83, v8 row_newbcast:12 row_mask:0xf bank_mask:0xf
v_and_b32_dpp v73, v83, v9 row_newbcast:12 row_mask:0xf bank_mask:0xf
v_and_b32_dpp v74, v83, v10 row_newbcast:12 row_mask:0xf bank_mask:0xf
v_and_b32_dpp v75, v83, v11 row_newbcast:12 row_mask:0xf bank_mask:0xf
s_waitcnt vmcnt(38)
v_mfma_f32_16x16x32_bf16 v[20:23], v[60:63], v[120:123], v[20:23]
v_mfma_f32_16x16x32_bf16 v[20:23], v[64:67], v[124:127], v[20:23]
v_mfma_f32_16x16x32_bf16 v[20:23], v[68:71], v[128:131], v[20:23]
v_mfma_f32_16x16x32_bf16 v[20:23], v[72:75], v[132:135], v[20:23]
v_add_u32 v117, 1, v117
buffer_store_dword v117, v118, s[64:67], 0 offen
s_cmp_le_u32 s15, 36
s_cbranch_scc0 L_thr_23
s_waitcnt vmcnt(7)
L_thr_23:
buffer_load_dwordx4 v[120:123], v2, s[52:55], s12 offen offset:0 nt
buffer_load_dwordx4 v[124:127], v2, s[52:55], s12 offen offset:1024 nt
s_cbranch_scc0 L_thr_24
s_waitcnt vmcnt(7)
L_thr_24:
buffer_load_dwordx4 v[128:131], v2, s[52:55], s12 offen offset:2048 nt
buffer_load_dwordx4 v[132:135], v2, s[52:55], s12 offen offset:3072 nt
s_add_u32 s13, s13, 24576
s_min_u32 s12, s13, 2146435072
ds_read_b64_tr_b16 a[232:233], v91 offset:0
ds_read_b64_tr_b16 a[234:235], v91 offset:4608
ds_read_b64_tr_b16 a[236:237], v91 offset:36864
ds_read_b64_tr_b16 a[238:239], v91 offset:41472
v_and_b32_dpp v60, v83, v8 row_newbcast:1 row_mask:0xf bank_mask:0xf
v_and_b32_dpp v61, v83, v9 row_newbcast:1 row_mask:0xf bank_mask:0xf
v_and_b32_dpp v62, v83, v10 row_newbcast:1 row_mask:0xf bank_mask:0xf
v_and_b32_dpp v63, v83, v11 row_newbcast:1 row_mask:0xf bank_mask:0xf
v_and_b32_dpp v64, v83, v8 row_newbcast:5 row_mask:0xf bank_mask:0xf
v_and_b32_dpp v65, v83, v9 row_newbcast:5 row_mask:0xf bank_mask:0xf
v_and_b32_dpp v66, v83, v10 row_newbcast:5 row_mask:0xf bank_mask:0xf
v_and_b32_dpp v67, v83, v11 row_newbcast:5 row_mask:0xf bank_mask:0xf
v_and_b32_dpp v68, v83, v8 row_newbcast:9 row_mask:0xf bank_mask:0xf
v_and_b32_dpp v69, v83, v9 row_newbcast:9 row_mask:0xf bank_mask:0xf
v_and_b32_dpp v70, v83, v10 row_newbcast:9 row_mask:0xf bank_mask:0xf
v_and_b32_dpp v71, v83, v11 row_newbcast:9 row_mask:0xf bank_mask:0xf
v_and_b32_dpp v72, v83, v8 row_newbcast:13 row_mask:0xf bank_mask:0xf
v_and_b32_dpp v73, v83, v9 row_newbcast:13 row_mask:0xf bank_mask:0xf
v_and_b32_dpp v74, v83, v10 row_newbcast:13 row_mask:0xf bank_mask:0xf
v_and_b32_dpp v75, v83, v11 row_newbcast:13 row_mask:0xf bank_mask:0xf
s_waitcnt vmcnt(38)
v_mfma_f32_16x16x32_bf16 v[20:23], v[60:63], v[136:139], v[20:23]
v_mfma_f32_16x16x32_bf16 v[20:23], v[64:67], v[140:143], v[20:23]
v_mfma_f32_16x16x32_bf16 v[20:23], v[68:71], v[144:147], v[20:23]
v_mfma_f32_16x16x32_bf16 v[20:23], v[72:75], v[148:151], v[20:23]
s_nop 3
v_and_b32_dpp v60, v83, v8 row_newbcast:2 row_mask:0xf bank_mask:0xf
v_and_b32_dpp v61, v83, v9 row_newbcast:2 row_mask:0xf bank_mask:0xf
v_and_b32_dpp v62, v83, v10 row_newbcast:2 row_mask:0xf bank_mask:0xf
v_and_b32_dpp v63, v83, v11 row_newbcast:2 row_mask:0xf bank_mask:0xf
v_and_b32_dpp v64, v83, v8 row_newbcast:6 row_mask:0xf bank_mask:0xf
v_and_b32_dpp v65, v83, v9 row_newbcast:6 row_mask:0xf bank_mask:0xf
v_and_b32_dpp v66, v83, v10 row_newbcast:6 row_mask:0xf bank_mask:0xf
v_and_b32_dpp v67, v83, v11 row_newbcast:6 row_mask:0xf bank_mask:0xf
v_and_b32_dpp v68, v83, v8 row_newbcast:10 row_mask:0xf bank_mask:0xf
v_and_b32_dpp v69, v83, v9 row_newbcast:10 row_mask:0xf bank_mask:0xf
v_and_b32_dpp v70, v83, v10 row_newbcast:10 row_mask:0xf bank_mask:0xf
v_and_b32_dpp v71, v83, v11 row_newbcast:10 row_mask:0xf bank_mask:0xf
v_and_b32_dpp v72, v83, v8 row_newbcast:14 row_mask:0xf bank_mask:0xf
v_and_b32_dpp v73, v83, v9 row_newbcast:14 row_mask:0xf bank_mask:0xf
v_and_b32_dpp v74, v83, v10 row_newbcast:14 row_mask:0xf bank_mask:0xf
v_and_b32_dpp v75, v83, v11 row_newbcast:14 row_mask:0xf bank_mask:0xf
s_waitcnt vmcnt(33)
v_mfma_f32_16x16x32_bf16 v[20:23], v[60:63], v[152:155], v[20:23]
v_mfma_f32_16x16x32_bf16 v[20:23], v[64:67], v[156:159], v[20:23]
v_mfma_f32_16x16x32_bf16 v[20:23], v[68:71], v[160:163], v[20:23]
v_mfma_f32_16x16x32_bf16 v[20:23], v[72:75], v[164:167], v[20:23]
v_add_u32 v117, 1, v117
buffer_store_dword v117, v118, s[64:67], 0 offen
s_cmp_le_u32 s15, 37
s_cbranch_scc0 L_thr_25
s_waitcnt vmcnt(7)
L_thr_25:
buffer_load_dwordx4 v[136:139], v2, s[52:55], s12 offen offset:0 nt
buffer_load_dwordx4 v[140:143], v2, s[52:55], s12 offen offset:1024 nt
s_cbranch_scc0 L_thr_26
s_waitcnt vmcnt(7)
L_thr_26:
buffer_load_dwordx4 v[144:147], v2, s[52:55], s12 offen offset:2048 nt
buffer_load_dwordx4 v[148:151], v2, s[52:55], s12 offen offset:3072 nt
s_add_u32 s13, s13, 24576
s_min_u32 s12, s13, 2146435072
v_and_b32_dpp v60, v77, v8 row_newbcast:2 row_mask:0xf bank_mask:0xf
v_and_b32_dpp v61, v77, v9 row_newbcast:2 row_mask:0xf bank_mask:0xf
v_and_b32_dpp v62, v77, v10 row_newbcast:2 row_mask:0xf bank_mask:0xf
v_and_b32_dpp v63, v77, v11 row_newbcast:2 row_mask:0xf bank_mask:0xf
v_and_b32_dpp v64, v77, v8 row_newbcast:6 row_mask:0xf bank_mask:0xf
v_and_b32_dpp v65, v77, v9 row_newbcast:6 row_mask:0xf bank_mask:0xf
v_and_b32_dpp v66, v77, v10 row_newbcast:6 row_mask:0xf bank_mask:0xf
v_and_b32_dpp v67, v77, v11 row_newbcast:6 row_mask:0xf bank_mask:0xf
v_and_b32_dpp v68, v77, v8 row_newbcast:10 row_mask:0xf bank_mask:0xf
v_and_b32_dpp v69, v77, v9 row_newbcast:10 row_mask:0xf bank_mask:0xf
v_and_b32_dpp v70, v77, v10 row_newbcast:10 row_mask:0xf bank_mask:0xf
v_and_b32_dpp v71, v77, v11 row_newbcast:10 row_mask:0xf bank_mask:0xf
v_and_b32_dpp v72, v77, v8 row_newbcast:14 row_mask:0xf bank_mask:0xf
v_and_b32_dpp v73, v77, v9 row_newbcast:14 row_mask:0xf bank_mask:0xf
v_and_b32_dpp v74, v77, v10 row_newbcast:14 row_mask:0xf bank_mask:0xf
v_and_b32_dpp v75, v77, v11 row_newbcast:14 row_mask:0xf bank_mask:0xf
v_mfma_f32_16x16x32_bf16 v[20:23], v[60:63], a[80:83], v[20:23]
v_mfma_f32_16x16x32_bf16 v[20:23], v[64:67], a[84:87], v[20:23]
v_mfma_f32_16x16x32_bf16 v[20:23], v[68:71], a[88:91], v[20:23]
v_mfma_f32_16x16x32_bf16 v[20:23], v[72:75], a[92:95], v[20:23]
s_nop 3
v_and_b32_dpp v60, v83, v8 row_newbcast:3 row_mask:0xf bank_mask:0xf
v_and_b32_dpp v61, v83, v9 row_newbcast:3 row_mask:0xf bank_mask:0xf
v_and_b32_dpp v62, v83, v10 row_newbcast:3 row_mask:0xf bank_mask:0xf
v_and_b32_dpp v63, v83, v11 row_newbcast:3 row_mask:0xf bank_mask:0xf
v_and_b32_dpp v64, v83, v8 row_newbcast:7 row_mask:0xf bank_mask:0xf
v_and_b32_dpp v65, v83, v9 row_newbcast:7 row_mask:0xf bank_mask:0xf
v_and_b32_dpp v66, v83, v10 row_newbcast:7 row_mask:0xf bank_mask:0xf
v_and_b32_dpp v67, v83, v11 row_newbcast:7 row_mask:0xf bank_mask:0xf
v_and_b32_dpp v68, v83, v8 row_newbcast:11 row_mask:0xf bank_mask:0xf
v_and_b32_dpp v69, v83, v9 row_newbcast:11 row_mask:0xf bank_mask:0xf
v_and_b32_dpp v70, v83, v10 row_newbcast:11 row_mask:0xf bank_mask:0xf
v_and_b32_dpp v71, v83, v11 row_newbcast:11 row_mask:0xf bank_mask:0xf
v_and_b32_dpp v72, v83, v8 row_newbcast:15 row_mask:0xf bank_mask:0xf
v_and_b32_dpp v73, v83, v9 row_newbcast:15 row_mask:0xf bank_mask:0xf
v_and_b32_dpp v74, v83, v10 row_newbcast:15 row_mask:0xf bank_mask:0xf
v_and_b32_dpp v75, v83, v11 row_newbcast:15 row_mask:0xf bank_mask:0xf
s_waitcnt vmcnt(33)
v_mfma_f32_16x16x32_bf16 v[20:23], v[60:63], v[168:171], v[20:23]
v_mfma_f32_16x16x32_bf16 v[20:23], v[64:67], v[172:175], v[20:23]
v_mfma_f32_16x16x32_bf16 v[20:23], v[68:71], v[176:179], v[20:23]
v_mfma_f32_16x16x32_bf16 v[20:23], v[72:75], v[180:183], v[20:23]
s_nop 3
v_and_b32_dpp v60, v84, v8 row_newbcast:0 row_mask:0xf bank_mask:0xf
v_and_b32_dpp v61, v84, v9 row_newbcast:0 row_mask:0xf bank_mask:0xf
v_and_b32_dpp v62, v84, v10 row_newbcast:0 row_mask:0xf bank_mask:0xf
v_and_b32_dpp v63, v84, v11 row_newbcast:0 row_mask:0xf bank_mask:0xf
v_and_b32_dpp v64, v84, v8 row_newbcast:4 row_mask:0xf bank_mask:0xf
v_and_b32_dpp v65, v84, v9 row_newbcast:4 row_mask:0xf bank_mask:0xf
v_and_b32_dpp v66, v84, v10 row_newbcast:4 row_mask:0xf bank_mask:0xf
v_and_b32_dpp v67, v84, v11 row_newbcast:4 row_mask:0xf bank_mask:0xf
v_and_b32_dpp v68, v84, v8 row_newbcast:8 row_mask:0xf bank_mask:0xf
v_and_b32_dpp v69, v84, v9 row_newbcast:8 row_mask:0xf bank_mask:0xf
v_and_b32_dpp v70, v84, v10 row_newbcast:8 row_mask:0xf bank_mask:0xf
v_and_b32_dpp v71, v84, v11 row_newbcast:8 row_mask:0xf bank_mask:0xf
v_and_b32_dpp v72, v84, v8 row_newbcast:12 row_mask:0xf bank_mask:0xf
v_and_b32_dpp v73, v84, v9 row_newbcast:12 row_mask:0xf bank_mask:0xf
v_and_b32_dpp v74, v84, v10 row_newbcast:12 row_mask:0xf bank_mask:0xf
v_and_b32_dpp v75, v84, v11 row_newbcast:12 row_mask:0xf bank_mask:0xf
s_waitcnt vmcnt(28)
v_mfma_f32_16x16x32_bf16 v[20:23], v[60:63], v[184:187], v[20:23]
v_mfma_f32_16x16x32_bf16 v[20:23], v[64:67], v[188:191], v[20:23]
v_mfma_f32_16x16x32_bf16 v[20:23], v[68:71], v[192:195], v[20:23]
v_mfma_f32_16x16x32_bf16 v[20:23], v[72:75], v[196:199], v[20:23]
v_add_u32 v117, 1, v117
buffer_store_dword v117, v118, s[64:67], 0 offen
s_cmp_le_u32 s15, 38
s_cbranch_scc0 L_thr_27
s_waitcnt vmcnt(7)
L_thr_27:
buffer_load_dwordx4 v[152:155], v2, s[52:55], s12 offen offset:0 nt
buffer_load_dwordx4 v[156:159], v2, s[52:55], s12 offen offset:1024 nt
s_cbranch_scc0 L_thr_28
s_waitcnt vmcnt(7)
L_thr_28:
buffer_load_dwordx4 v[160:163], v2, s[52:55], s12 offen offset:2048 nt
buffer_load_dwordx4 v[164:167], v2, s[52:55], s12 offen offset:3072 nt
s_add_u32 s13, s13, 24576
s_min_u32 s12, s13, 2146435072
v_and_b32_dpp v60, v84, v8 row_newbcast:1 row_mask:0xf bank_mask:0xf
v_and_b32_dpp v61, v84, v9 row_newbcast:1 row_mask:0xf bank_mask:0xf
v_and_b32_dpp v62, v84, v10 row_newbcast:1 row_mask:0xf bank_mask:0xf
v_and_b32_dpp v63, v84, v11 row_newbcast:1 row_mask:0xf bank_mask:0xf
v_and_b32_dpp v64, v84, v8 row_newbcast:5 row_mask:0xf bank_mask:0xf
v_and_b32_dpp v65, v84, v9 row_newbcast:5 row_mask:0xf bank_mask:0xf
v_and_b32_dpp v66, v84, v10 row_newbcast:5 row_mask:0xf bank_mask:0xf
v_and_b32_dpp v67, v84, v11 row_newbcast:5 row_mask:0xf bank_mask:0xf
v_and_b32_dpp v68, v84, v8 row_newbcast:9 row_mask:0xf bank_mask:0xf
v_and_b32_dpp v69, v84, v9 row_newbcast:9 row_mask:0xf bank_mask:0xf
v_and_b32_dpp v70, v84, v10 row_newbcast:9 row_mask:0xf bank_mask:0xf
v_and_b32_dpp v71, v84, v11 row_newbcast:9 row_mask:0xf bank_mask:0xf
v_and_b32_dpp v72, v84, v8 row_newbcast:13 row_mask:0xf bank_mask:0xf
v_and_b32_dpp v73, v84, v9 row_newbcast:13 row_mask:0xf bank_mask:0xf
v_and_b32_dpp v74, v84, v10 row_newbcast:13 row_mask:0xf bank_mask:0xf
v_and_b32_dpp v75, v84, v11 row_newbcast:13 row_mask:0xf bank_mask:0xf
s_waitcnt vmcnt(28)
v_mfma_f32_16x16x32_bf16 v[20:23], v[60:63], v[200:203], v[20:23]
v_mfma_f32_16x16x32_bf16 v[20:23], v[64:67], v[204:207], v[20:23]
v_mfma_f32_16x16x32_bf16 v[20:23], v[68:71], v[208:211], v[20:23]
v_mfma_f32_16x16x32_bf16 v[20:23], v[72:75], v[212:215], v[20:23]
s_nop 3
v_and_b32_dpp v60, v84, v8 row_newbcast:2 row_mask:0xf bank_mask:0xf
v_and_b32_dpp v61, v84, v9 row_newbcast:2 row_mask:0xf bank_mask:0xf
v_and_b32_dpp v62, v84, v10 row_newbcast:2 row_mask:0xf bank_mask:0xf
v_and_b32_dpp v63, v84, v11 row_newbcast:2 row_mask:0xf bank_mask:0xf
v_and_b32_dpp v64, v84, v8 row_newbcast:6 row_mask:0xf bank_mask:0xf
v_and_b32_dpp v65, v84, v9 row_newbcast:6 row_mask:0xf bank_mask:0xf
v_and_b32_dpp v66, v84, v10 row_newbcast:6 row_mask:0xf bank_mask:0xf
v_and_b32_dpp v67, v84, v11 row_newbcast:6 row_mask:0xf bank_mask:0xf
v_and_b32_dpp v68, v84, v8 row_newbcast:10 row_mask:0xf bank_mask:0xf
v_and_b32_dpp v69, v84, v9 row_newbcast:10 row_mask:0xf bank_mask:0xf
v_and_b32_dpp v70, v84, v10 row_newbcast:10 row_mask:0xf bank_mask:0xf
v_and_b32_dpp v71, v84, v11 row_newbcast:10 row_mask:0xf bank_mask:0xf
v_and_b32_dpp v72, v84, v8 row_newbcast:14 row_mask:0xf bank_mask:0xf
v_and_b32_dpp v73, v84, v9 row_newbcast:14 row_mask:0xf bank_mask:0xf
v_and_b32_dpp v74, v84, v10 row_newbcast:14 row_mask:0xf bank_mask:0xf
v_and_b32_dpp v75, v84, v11 row_newbcast:14 row_mask:0xf bank_mask:0xf
s_waitcnt vmcnt(23)
v_mfma_f32_16x16x32_bf16 v[20:23], v[60:63], v[216:219], v[20:23]
v_mfma_f32_16x16x32_bf16 v[20:23], v[64:67], v[220:223], v[20:23]
v_mfma_f32_16x16x32_bf16 v[20:23], v[68:71], v[224:227], v[20:23]
v_mfma_f32_16x16x32_bf16 v[20:23], v[72:75], v[228:231], v[20:23]
v_add_u32 v117, 1, v117
buffer_store_dword v117, v118, s[64:67], 0 offen
s_cmp_le_u32 s15, 39
s_cbranch_scc0 L_thr_29
s_waitcnt vmcnt(7)
L_thr_29:
buffer_load_dwordx4 v[168:171], v2, s[52:55], s12 offen offset:0 nt
buffer_load_dwordx4 v[172:175], v2, s[52:55], s12 offen offset:1024 nt
s_cbranch_scc0 L_thr_30
s_waitcnt vmcnt(7)
L_thr_30:
buffer_load_dwordx4 v[176:179], v2, s[52:55], s12 offen offset:2048 nt
buffer_load_dwordx4 v[180:183], v2, s[52:55], s12 offen offset:3072 nt
s_add_u32 s13, s13, 24576
s_min_u32 s12, s13, 2146435072
v_and_b32_dpp v60, v84, v8 row_newbcast:3 row_mask:0xf bank_mask:0xf
v_and_b32_dpp v61, v84, v9 row_newbcast:3 row_mask:0xf bank_mask:0xf
v_and_b32_dpp v62, v84, v10 row_newbcast:3 row_mask:0xf bank_mask:0xf
v_and_b32_dpp v63, v84, v11 row_newbcast:3 row_mask:0xf bank_mask:0xf
v_and_b32_dpp v64, v84, v8 row_newbcast:7 row_mask:0xf bank_mask:0xf
v_and_b32_dpp v65, v84, v9 row_newbcast:7 row_mask:0xf bank_mask:0xf
v_and_b32_dpp v66, v84, v10 row_newbcast:7 row_mask:0xf bank_mask:0xf
v_and_b32_dpp v67, v84, v11 row_newbcast:7 row_mask:0xf bank_mask:0xf
v_and_b32_dpp v68, v84, v8 row_newbcast:11 row_mask:0xf bank_mask:0xf
v_and_b32_dpp v69, v84, v9 row_newbcast:11 row_mask:0xf bank_mask:0xf
v_and_b32_dpp v70, v84, v10 row_newbcast:11 row_mask:0xf bank_mask:0xf
v_and_b32_dpp v71, v84, v11 row_newbcast:11 row_mask:0xf bank_mask:0xf
v_and_b32_dpp v72, v84, v8 row_newbcast:15 row_mask:0xf bank_mask:0xf
v_and_b32_dpp v73, v84, v9 row_newbcast:15 row_mask:0xf bank_mask:0xf
v_and_b32_dpp v74, v84, v10 row_newbcast:15 row_mask:0xf bank_mask:0xf
v_and_b32_dpp v75, v84, v11 row_newbcast:15 row_mask:0xf bank_mask:0xf
s_waitcnt vmcnt(23)
v_mfma_f32_16x16x32_bf16 v[20:23], v[60:63], v[232:235], v[20:23]
v_mfma_f32_16x16x32_bf16 v[20:23], v[64:67], v[236:239], v[20:23]
v_mfma_f32_16x16x32_bf16 v[20:23], v[68:71], v[240:243], v[20:23]
v_mfma_f32_16x16x32_bf16 v[20:23], v[72:75], v[244:247], v[20:23]
s_nop 3
v_and_b32_dpp v60, v85, v8 row_newbcast:0 row_mask:0xf bank_mask:0xf
v_and_b32_dpp v61, v85, v9 row_newbcast:0 row_mask:0xf bank_mask:0xf
v_and_b32_dpp v62, v85, v10 row_newbcast:0 row_mask:0xf bank_mask:0xf
v_and_b32_dpp v63, v85, v11 row_newbcast:0 row_mask:0xf bank_mask:0xf
v_and_b32_dpp v64, v85, v8 row_newbcast:4 row_mask:0xf bank_mask:0xf
v_and_b32_dpp v65, v85, v9 row_newbcast:4 row_mask:0xf bank_mask:0xf
v_and_b32_dpp v66, v85, v10 row_newbcast:4 row_mask:0xf bank_mask:0xf
v_and_b32_dpp v67, v85, v11 row_newbcast:4 row_mask:0xf bank_mask:0xf
v_and_b32_dpp v68, v85, v8 row_newbcast:8 row_mask:0xf bank_mask:0xf
v_and_b32_dpp v69, v85, v9 row_newbcast:8 row_mask:0xf bank_mask:0xf
v_and_b32_dpp v70, v85, v10 row_newbcast:8 row_mask:0xf bank_mask:0xf
v_and_b32_dpp v71, v85, v11 row_newbcast:8 row_mask:0xf bank_mask:0xf
v_and_b32_dpp v72, v85, v8 row_newbcast:12 row_mask:0xf bank_mask:0xf
v_and_b32_dpp v73, v85, v9 row_newbcast:12 row_mask:0xf bank_mask:0xf
v_and_b32_dpp v74, v85, v10 row_newbcast:12 row_mask:0xf bank_mask:0xf
v_and_b32_dpp v75, v85, v11 row_newbcast:12 row_mask:0xf bank_mask:0xf
s_waitcnt vmcnt(15)
v_mfma_f32_16x16x32_bf16 v[20:23], v[60:63], v[120:123], v[20:23]
v_mfma_f32_16x16x32_bf16 v[20:23], v[64:67], v[124:127], v[20:23]
v_mfma_f32_16x16x32_bf16 v[20:23], v[68:71], v[128:131], v[20:23]
v_mfma_f32_16x16x32_bf16 v[20:23], v[72:75], v[132:135], v[20:23]
v_add_u32 v117, 1, v117
buffer_store_dword v117, v118, s[64:67], 0 offen
s_cmp_le_u32 s15, 40
s_cbranch_scc0 L_thr_31
s_waitcnt vmcnt(7)
L_thr_31:
buffer_load_dwordx4 v[184:187], v2, s[52:55], s12 offen offset:0 nt
buffer_load_dwordx4 v[188:191], v2, s[52:55], s12 offen offset:1024 nt
s_cbranch_scc0 L_thr_32
s_waitcnt vmcnt(7)
L_thr_32:
buffer_load_dwordx4 v[192:195], v2, s[52:55], s12 offen offset:2048 nt
buffer_load_dwordx4 v[196:199], v2, s[52:55], s12 offen offset:3072 nt
s_add_u32 s13, s13, 24576
s_min_u32 s12, s13, 2146435072
s_mov_b32 s7, 400000
A_ev2_chk:
v_max3_u32 v35, v40, v41, v42
v_max3_u32 v35, v35, v43, v44
v_max3_u32 v35, v35, v45, v46
v_max3_u32 v35, v35, v47, v48
v_max3_u32 v35, v35, v49, v50
v_max_u32 v35, v35, v51
v_cmp_eq_u32 vcc, -1, v35
s_cbranch_vccz A_ev2_ok
buffer_load_dwordx4 v[40:43], off, s[64:67], s82 offset:0 sc1
buffer_load_dwordx4 v[44:47], off, s[64:67], s82 offset:16 sc1
buffer_load_dwordx4 v[48:51], off, s[64:67], s82 offset:32 sc1
s_waitcnt vmcnt(0)
s_sub_u32 s7, s7, 1
s_cmp_lg_u32 s7, 0
s_cbranch_scc1 A_ev2_chk
A_ev2_ok:
v_max3_f32 v35, v40, v42, v44
v_max3_f32 v36, v46, v48, v50
v_max_f32 v35, v35, v36
v_sub_f32 v40, v40, v35
v_sub_f32 v42, v42, v35
v_sub_f32 v44, v44, v35
v_sub_f32 v46, v46, v35
v_sub_f32 v48, v48, v35
v_sub_f32 v50, v50, v35
v_sub_f32 v37, v32, v35
v_exp_f32 v40, v40
v_exp_f32 v42, v42
v_exp_f32 v44, v44
v_exp_f32 v46, v46
v_exp_f32 v48, v48
v_exp_f32 v50, v50
v_exp_f32 v37, v37
v_mul_f32 v35, v40, v41
v_fma_f32 v35, v42, v43, v35
v_fma_f32 v35, v44, v45, v35
v_fma_f32 v35, v46, v47, v35
v_fma_f32 v35, v48, v49, v35
v_fma_f32 v35, v50, v51, v35
v_rcp_f32 v35, v35
s_nop 0
v_mul_f32 v37, v37, v35
v_and_b32_dpp v60, v85, v8 row_newbcast:1 row_mask:0xf bank_mask:0xf
v_and_b32_dpp v61, v85, v9 row_newbcast:1 row_mask:0xf bank_mask:0xf
v_and_b32_dpp v62, v85, v10 row_newbcast:1 row_mask:0xf bank_mask:0xf
v_and_b32_dpp v63, v85, v11 row_newbcast:1 row_mask:0xf bank_mask:0xf
v_and_b32_dpp v64, v85, v8 row_newbcast:5 row_mask:0xf bank_mask:0xf
v_and_b32_dpp v65, v85, v9 row_newbcast:5 row_mask:0xf bank_mask:0xf
v_and_b32_dpp v66, v85, v10 row_newbcast:5 row_mask:0xf bank_mask:0xf
v_and_b32_dpp v67, v85, v11 row_newbcast:5 row_mask:0xf bank_mask:0xf
v_and_b32_dpp v68, v85, v8 row_newbcast:9 row_mask:0xf bank_mask:0xf
v_and_b32_dpp v69, v85, v9 row_newbcast:9 row_mask:0xf bank_mask:0xf
v_and_b32_dpp v70, v85, v10 row_newbcast:9 row_mask:0xf bank_mask:0xf
v_and_b32_dpp v71, v85, v11 row_newbcast:9 row_mask:0xf bank_mask:0xf
v_and_b32_dpp v72, v85, v8 row_newbcast:13 row_mask:0xf bank_mask:0xf
v_and_b32_dpp v73, v85, v9 row_newbcast:13 row_mask:0xf bank_mask:0xf
v_and_b32_dpp v74, v85, v10 row_newbcast:13 row_mask:0xf bank_mask:0xf
v_and_b32_dpp v75, v85, v11 row_newbcast:13 row_mask:0xf bank_mask:0xf
s_waitcnt vmcnt(15)
v_mfma_f32_16x16x32_bf16 v[20:23], v[60:63], v[136:139], v[20:23]
v_mfma_f32_16x16x32_bf16 v[20:23], v[64:67], v[140:143], v[20:23]
v_mfma_f32_16x16x32_bf16 v[20:23], v[68:71], v[144:147], v[20:23]
v_mfma_f32_16x16x32_bf16 v[20:23], v[72:75], v[148:151], v[20:23]
v_add_u32 v117, 1, v117
buffer_store_dword v117, v118, s[64:67], 0 offen
s_cmp_le_u32 s15, 41
s_cbranch_scc0 L_thr_33
s_waitcnt vmcnt(7)
L_thr_33:
buffer_load_dwordx4 v[200:203], v2, s[52:55], s12 offen offset:0 nt
buffer_load_dwordx4 v[204:207], v2, s[52:55], s12 offen offset:1024 nt
s_cbranch_scc0 L_thr_34
s_waitcnt vmcnt(7)
L_thr_34:
buffer_load_dwordx4 v[208:211], v2, s[52:55], s12 offen offset:2048 nt
buffer_load_dwordx4 v[212:215], v2, s[52:55], s12 offen offset:3072 nt
s_add_u32 s13, s13, 24576
s_min_u32 s12, s13, 2146435072
v_and_b32_dpp v60, v77, v8 row_newbcast:3 row_mask:0xf bank_mask:0xf
v_and_b32_dpp v61, v77, v9 row_newbcast:3 row_mask:0xf bank_mask:0xf
v_and_b32_dpp v62, v77, v10 row_newbcast:3 row_mask:0xf bank_mask:0xf
v_and_b32_dpp v63, v77, v11 row_newbcast:3 row_mask:0xf bank_mask:0xf
v_and_b32_dpp v64, v77, v8 row_newbcast:7 row_mask:0xf bank_mask:0xf
v_and_b32_dpp v65, v77, v9 row_newbcast:7 row_mask:0xf bank_mask:0xf
v_and_b32_dpp v66, v77, v10 row_newbcast:7 row_mask:0xf bank_mask:0xf
v_and_b32_dpp v67, v77, v11 row_newbcast:7 row_mask:0xf bank_mask:0xf
v_and_b32_dpp v68, v77, v8 row_newbcast:11 row_mask:0xf bank_mask:0xf
v_and_b32_dpp v69, v77, v9 row_newbcast:11 row_mask:0xf bank_mask:0xf
v_and_b32_dpp v70, v77, v10 row_newbcast:11 row_mask:0xf bank_mask:0xf
v_and_b32_dpp v71, v77, v11 row_newbcast:11 row_mask:0xf bank_mask:0xf
v_and_b32_dpp v72, v77, v8 row_newbcast:15 row_mask:0xf bank_mask:0xf
v_and_b32_dpp v73, v77, v9 row_newbcast:15 row_mask:0xf bank_mask:0xf
v_and_b32_dpp v74, v77, v10 row_newbcast:15 row_mask:0xf bank_mask:0xf
v_and_b32_dpp v75, v77, v11 row_newbcast:15 row_mask:0xf bank_mask:0xf
v_mfma_f32_16x16x32_bf16 v[20:23], v[60:63], a[240:243], v[20:23]
v_mfma_f32_16x16x32_bf16 v[20:23], v[64:67], a[244:247], v[20:23]
v_mfma_f32_16x16x32_bf16 v[20:23], v[68:71], a[248:251], v[20:23]
v_mfma_f32_16x16x32_bf16 v[20:23], v[72:75], a[252:255], v[20:23]
s_nop 3
v_and_b32_dpp v60, v85, v8 row_newbcast:2 row_mask:0xf bank_mask:0xf
v_and_b32_dpp v61, v85, v9 row_newbcast:2 row_mask:0xf bank_mask:0xf
v_and_b32_dpp v62, v85, v10 row_newbcast:2 row_mask:0xf bank_mask:0xf
v_and_b32_dpp v63, v85, v11 row_newbcast:2 row_mask:0xf bank_mask:0xf
v_and_b32_dpp v64, v85, v8 row_newbcast:6 row_mask:0xf bank_mask:0xf
v_and_b32_dpp v65, v85, v9 row_newbcast:6 row_mask:0xf bank_mask:0xf
v_and_b32_dpp v66, v85, v10 row_newbcast:6 row_mask:0xf bank_mask:0xf
v_and_b32_dpp v67, v85, v11 row_newbcast:6 row_mask:0xf bank_mask:0xf
v_and_b32_dpp v68, v85, v8 row_newbcast:10 row_mask:0xf bank_mask:0xf
v_and_b32_dpp v69, v85, v9 row_newbcast:10 row_mask:0xf bank_mask:0xf
v_and_b32_dpp v70, v85, v10 row_newbcast:10 row_mask:0xf bank_mask:0xf
v_and_b32_dpp v71, v85, v11 row_newbcast:10 row_mask:0xf bank_mask:0xf
v_and_b32_dpp v72, v85, v8 row_newbcast:14 row_mask:0xf bank_mask:0xf
v_and_b32_dpp v73, v85, v9 row_newbcast:14 row_mask:0xf bank_mask:0xf
v_and_b32_dpp v74, v85, v10 row_newbcast:14 row_mask:0xf bank_mask:0xf
v_and_b32_dpp v75, v85, v11 row_newbcast:14 row_mask:0xf bank_mask:0xf
s_waitcnt vmcnt(15)
v_mfma_f32_16x16x32_bf16 v[20:23], v[60:63], v[152:155], v[20:23]
v_mfma_f32_16x16x32_bf16 v[20:23], v[64:67], v[156:159], v[20:23]
v_mfma_f32_16x16x32_bf16 v[20:23], v[68:71], v[160:163], v[20:23]
v_mfma_f32_16x16x32_bf16 v[20:23], v[72:75], v[164:167], v[20:23]
v_add_u32 v117, 1, v117
buffer_store_dword v117, v118, s[64:67], 0 offen
buffer_load_dwordx4 v[216:219], v2, s[52:55], s12 offen offset:0 nt
buffer_load_dwordx4 v[220:223], v2, s[52:55], s12 offen offset:1024 nt
buffer_load_dwordx4 v[224:227], v2, s[52:55], s12 offen offset:2048 nt
buffer_load_dwordx4 v[228:231], v2, s[52:55], s12 offen offset:3072 nt
s_add_u32 s13, s13, 24576
s_min_u32 s12, s13, 2146435072
v_and_b32_dpp v60, v85, v8 row_newbcast:3 row_mask:0xf bank_mask:0xf
v_and_b32_dpp v61, v85, v9 row_newbcast:3 row_mask:0xf bank_mask:0xf
v_and_b32_dpp v62, v85, v10 row_newbcast:3 row_mask:0xf bank_mask:0xf
v_and_b32_dpp v63, v85, v11 row_newbcast:3 row_mask:0xf bank_mask:0xf
v_and_b32_dpp v64, v85, v8 row_newbcast:7 row_mask:0xf bank_mask:0xf
v_and_b32_dpp v65, v85, v9 row_newbcast:7 row_mask:0xf bank_mask:0xf
v_and_b32_dpp v66, v85, v10 row_newbcast:7 row_mask:0xf bank_mask:0xf
v_and_b32_dpp v67, v85, v11 row_newbcast:7 row_mask:0xf bank_mask:0xf
v_and_b32_dpp v68, v85, v8 row_newbcast:11 row_mask:0xf bank_mask:0xf
v_and_b32_dpp v69, v85, v9 row_newbcast:11 row_mask:0xf bank_mask:0xf
v_and_b32_dpp v70, v85, v10 row_newbcast:11 row_mask:0xf bank_mask:0xf
v_and_b32_dpp v71, v85, v11 row_newbcast:11 row_mask:0xf bank_mask:0xf
v_and_b32_dpp v72, v85, v8 row_newbcast:15 row_mask:0xf bank_mask:0xf
v_and_b32_dpp v73, v85, v9 row_newbcast:15 row_mask:0xf bank_mask:0xf
v_and_b32_dpp v74, v85, v10 row_newbcast:15 row_mask:0xf bank_mask:0xf
v_and_b32_dpp v75, v85, v11 row_newbcast:15 row_mask:0xf bank_mask:0xf
s_waitcnt vmcnt(15)
v_mfma_f32_16x16x32_bf16 v[20:23], v[60:63], v[168:171], v[20:23]
v_mfma_f32_16x16x32_bf16 v[20:23], v[64:67], v[172:175], v[20:23]
v_mfma_f32_16x16x32_bf16 v[20:23], v[68:71], v[176:179], v[20:23]
v_mfma_f32_16x16x32_bf16 v[20:23], v[72:75], v[180:183], v[20:23]
v_add_u32 v117, 1, v117
buffer_store_dword v117, v118, s[64:67], 0 offen
buffer_load_dwordx4 v[232:235], v2, s[52:55], s12 offen offset:0 nt
buffer_load_dwordx4 v[236:239], v2, s[52:55], s12 offen offset:1024 nt
buffer_load_dwordx4 v[240:243], v2, s[52:55], s12 offen offset:2048 nt
buffer_load_dwordx4 v[244:247], v2, s[52:55], s12 offen offset:3072 nt
s_add_u32 s13, s13, 24576
s_min_u32 s12, s13, 2146435072
v_mov_b32 v40, 0
v_mov_b32 v41, 0
v_mov_b32 v42, 0
v_mov_b32 v43, 0
v_mov_b32 v44, 0
v_mov_b32 v45, 0
v_mov_b32 v46, 0
v_mov_b32 v47, 0
v_mov_b32 v48, 0
v_mov_b32 v49, 0
v_mov_b32 v50, 0
v_mov_b32 v51, 0
v_mov_b32 v52, 0
v_mov_b32 v53, 0
v_mov_b32 v54, 0
v_mov_b32 v55, 0
v_and_b32_dpp v120, v86, v8 row_newbcast:0 row_mask:0xf bank_mask:0xf
v_and_b32_dpp v121, v86, v9 row_newbcast:0 row_mask:0xf bank_mask:0xf
v_and_b32_dpp v122, v86, v10 row_newbcast:0 row_mask:0xf bank_mask:0xf
v_and_b32_dpp v123, v86, v11 row_newbcast:0 row_mask:0xf bank_mask:0xf
v_and_b32_dpp v124, v86, v8 row_newbcast:4 row_mask:0xf bank_mask:0xf
v_and_b32_dpp v125, v86, v9 row_newbcast:4 row_mask:0xf bank_mask:0xf
v_and_b32_dpp v126, v86, v10 row_newbcast:4 row_mask:0xf bank_mask:0xf
v_and_b32_dpp v127, v86, v11 row_newbcast:4 row_mask:0xf bank_mask:0xf
v_and_b32_dpp v128, v86, v8 row_newbcast:8 row_mask:0xf bank_mask:0xf
v_and_b32_dpp v129, v86, v9 row_newbcast:8 row_mask:0xf bank_mask:0xf
v_and_b32_dpp v130, v86, v10 row_newbcast:8 row_mask:0xf bank_mask:0xf
v_and_b32_dpp v131, v86, v11 row_newbcast:8 row_mask:0xf bank_mask:0xf
v_and_b32_dpp v132, v86, v8 row_newbcast:12 row_mask:0xf bank_mask:0xf
v_and_b32_dpp v133, v86, v9 row_newbcast:12 row_mask:0xf bank_mask:0xf
v_and_b32_dpp v134, v86, v10 row_newbcast:12 row_mask:0xf bank_mask:0xf
v_and_b32_dpp v135, v86, v11 row_newbcast:12 row_mask:0xf bank_mask:0xf
v_and_b32_dpp v136, v86, v8 row_newbcast:1 row_mask:0xf bank_mask:0xf
v_and_b32_dpp v137, v86, v9 row_newbcast:1 row_mask:0xf bank_mask:0xf
v_and_b32_dpp v138, v86, v10 row_newbcast:1 row_mask:0xf bank_mask:0xf
v_and_b32_dpp v139, v86, v11 row_newbcast:1 row_mask:0xf bank_mask:0xf
v_and_b32_dpp v140, v86, v8 row_newbcast:5 row_mask:0xf bank_mask:0xf
v_and_b32_dpp v141, v86, v9 row_newbcast:5 row_mask:0xf bank_mask:0xf
v_and_b32_dpp v142, v86, v10 row_newbcast:5 row_mask:0xf bank_mask:0xf
v_and_b32_dpp v143, v86, v11 row_newbcast:5 row_mask:0xf bank_mask:0xf
v_and_b32_dpp v144, v86, v8 row_newbcast:9 row_mask:0xf bank_mask:0xf
v_and_b32_dpp v145, v86, v9 row_newbcast:9 row_mask:0xf bank_mask:0xf
v_and_b32_dpp v146, v86, v10 row_newbcast:9 row_mask:0xf bank_mask:0xf
v_and_b32_dpp v147, v86, v11 row_newbcast:9 row_mask:0xf bank_mask:0xf
v_and_b32_dpp v148, v86, v8 row_newbcast:13 row_mask:0xf bank_mask:0xf
v_and_b32_dpp v149, v86, v9 row_newbcast:13 row_mask:0xf bank_mask:0xf
v_and_b32_dpp v150, v86, v10 row_newbcast:13 row_mask:0xf bank_mask:0xf
v_and_b32_dpp v151, v86, v11 row_newbcast:13 row_mask:0xf bank_mask:0xf
v_and_b32_dpp v152, v86, v8 row_newbcast:2 row_mask:0xf bank_mask:0xf
v_and_b32_dpp v153, v86, v9 row_newbcast:2 row_mask:0xf bank_mask:0xf
v_and_b32_dpp v154, v86, v10 row_newbcast:2 row_mask:0xf bank_mask:0xf
v_and_b32_dpp v155, v86, v11 row_newbcast:2 row_mask:0xf bank_mask:0xf
v_and_b32_dpp v156, v86, v8 row_newbcast:6 row_mask:0xf bank_mask:0xf
v_and_b32_dpp v157, v86, v9 row_newbcast:6 row_mask:0xf bank_mask:0xf
v_and_b32_dpp v158, v86, v10 row_newbcast:6 row_mask:0xf bank_mask:0xf
v_and_b32_dpp v159, v86, v11 row_newbcast:6 row_mask:0xf bank_mask:0xf
v_and_b32_dpp v160, v86, v8 row_newbcast:10 row_mask:0xf bank_mask:0xf
v_and_b32_dpp v161, v86, v9 row_newbcast:10 row_mask:0xf bank_mask:0xf
v_and_b32_dpp v162, v86, v10 row_newbcast:10 row_mask:0xf bank_mask:0xf
v_and_b32_dpp v163, v86, v11 row_newbcast:10 row_mask:0xf bank_mask:0xf
v_and_b32_dpp v164, v86, v8 row_newbcast:14 row_mask:0xf bank_mask:0xf
v_and_b32_dpp v165, v86, v9 row_newbcast:14 row_mask:0xf bank_mask:0xf
v_and_b32_dpp v166, v86, v10 row_newbcast:14 row_mask:0xf bank_mask:0xf
v_and_b32_dpp v167, v86, v11 row_newbcast:14 row_mask:0xf bank_mask:0xf
v_and_b32_dpp v168, v86, v8 row_newbcast:3 row_mask:0xf bank_mask:0xf
v_and_b32_dpp v169, v86, v9 row_newbcast:3 row_mask:0xf bank_mask:0xf
v_and_b32_dpp v170, v86, v10 row_newbcast:3 row_mask:0xf bank_mask:0xf
v_and_b32_dpp v171, v86, v11 row_newbcast:3 row_mask:0xf bank_mask:0xf
v_and_b32_dpp v172, v86, v8 row_newbcast:7 row_mask:0xf bank_mask:0xf
v_and_b32_dpp v173, v86, v9 row_newbcast:7 row_mask:0xf bank_mask:0xf
v_and_b32_dpp v174, v86, v10 row_newbcast:7 row_mask:0xf bank_mask:0xf
v_and_b32_dpp v175, v86, v11 row_newbcast:7 row_mask:0xf bank_mask:0xf
v_and_b32_dpp v176, v86, v8 row_newbcast:11 row_mask:0xf bank_mask:0xf
v_and_b32_dpp v177, v86, v9 row_newbcast:11 row_mask:0xf bank_mask:0xf
v_and_b32_dpp v178, v86, v10 row_newbcast:11 row_mask:0xf bank_mask:0xf
v_and_b32_dpp v179, v86, v11 row_newbcast:11 row_mask:0xf bank_mask:0xf
v_and_b32_dpp v180, v86, v8 row_newbcast:15 row_mask:0xf bank_mask:0xf
v_and_b32_dpp v181, v86, v9 row_newbcast:15 row_mask:0xf bank_mask:0xf
v_and_b32_dpp v182, v86, v10 row_newbcast:15 row_mask:0xf bank_mask:0xf
v_and_b32_dpp v183, v86, v11 row_newbcast:15 row_mask:0xf bank_mask:0xf
s_waitcnt vmcnt(15)
v_mfma_f32_16x16x32_bf16 v[20:23], v[120:123], v[184:187], v[20:23]
v_mfma_f32_16x16x32_bf16 v[20:23], v[124:127], v[188:191], v[20:23]
v_mfma_f32_16x16x32_bf16 v[20:23], v[128:131], v[192:195], v[20:23]
v_mfma_f32_16x16x32_bf16 v[20:23], v[132:135], v[196:199], v[20:23]
s_waitcnt vmcnt(10)
v_mfma_f32_16x16x32_bf16 v[20:23], v[136:139], v[200:203], v[20:23]
v_mfma_f32_16x16x32_bf16 v[20:23], v[140:143], v[204:207], v[20:23]
v_mfma_f32_16x16x32_bf16 v[20:23], v[144:147], v[208:211], v[20:23]
v_mfma_f32_16x16x32_bf16 v[20:23], v[148:151], v[212:215], v[20:23]
s_waitcnt vmcnt(5)
v_mfma_f32_16x16x32_bf16 v[20:23], v[152:155], v[216:219], v[20:23]
v_mfma_f32_16x16x32_bf16 v[20:23], v[156:159], v[220:223], v[20:23]
v_mfma_f32_16x16x32_bf16 v[20:23], v[160:163], v[224:227], v[20:23]
v_mfma_f32_16x16x32_bf16 v[20:23], v[164:167], v[228:231], v[20:23]
s_waitcnt vmcnt(3)
v_mfma_f32_16x16x32_bf16 v[20:23], v[168:171], v[232:235], v[20:23]
s_waitcnt vmcnt(2)
v_mfma_f32_16x16x32_bf16 v[20:23], v[172:175], v[236:239], v[20:23]
s_waitcnt vmcnt(1)
v_mfma_f32_16x16x32_bf16 v[20:23], v[176:179], v[240:243], v[20:23]
s_waitcnt vmcnt(0)
v_mfma_f32_16x16x32_bf16 v[20:23], v[180:183], v[244:247], v[20:23]
A_tail:
s_nop 7
v_mul_f32 v20, v20, v37
v_mul_f32 v21, v21, v37
v_mul_f32 v22, v22, v37
v_mul_f32 v23, v23, v37
v_cvt_pk_bf16_f32 v28, v20, v21
v_cvt_pk_bf16_f32 v29, v22, v23
ds_write_b64 v94, v[28:29]
s_waitcnt lgkmcnt(0)
s_barrier
ds_read_b128 a[0:3], v95 offset:0
ds_read_b128 a[4:7], v95 offset:64
ds_read_b128 a[8:11], v95 offset:128
ds_read_b128 a[12:15], v95 offset:192
s_waitcnt lgkmcnt(3)
v_mfma_f32_16x16x32_bf16 v[72:75], a[0:3], a[224:227], 0
s_waitcnt lgkmcnt(2)
v_mfma_f32_16x16x32_bf16 v[72:75], a[4:7], a[228:231], v[72:75]
s_waitcnt lgkmcnt(1)
v_mfma_f32_16x16x32_bf16 v[72:75], a[8:11], a[232:235], v[72:75]
s_waitcnt lgkmcnt(0)
v_mfma_f32_16x16x32_bf16 v[72:75], a[12:15], a[236:239], v[72:75]
v_smfmac_f32_16x16x64_bf16 v[40:43], a[0:3], a[96:103], v105
v_smfmac_f32_16x16x64_bf16 v[40:43], a[4:7], a[104:111], v105
v_smfmac_f32_16x16x64_bf16 v[40:43], a[8:11], a[112:119], v105
v_smfmac_f32_16x16x64_bf16 v[40:43], a[12:15], a[120:127], v105
v_smfmac_f32_16x16x64_bf16 v[44:47], a[0:3], a[128:135], v105
v_smfmac_f32_16x16x64_bf16 v[44:47], a[4:7], a[136:143], v105
v_smfmac_f32_16x16x64_bf16 v[44:47], a[8:11], a[144:151], v105
v_smfmac_f32_16x16x64_bf16 v[44:47], a[12:15], a[152:159], v105
v_pk_mul_f32 v[102:103], v[106:107], v[72:73]
v_pk_fma_f32 v[102:103], v[108:109], v[74:75], v[102:103]
v_smfmac_f32_16x16x64_bf16 v[48:51], a[0:3], a[160:167], v105
v_add_f32 v114, v102, v103
v_pk_mul_f32 v[102:103], v[106:107], v[40:41]
v_smfmac_f32_16x16x64_bf16 v[48:51], a[4:7], a[168:175], v105
v_pk_fma_f32 v[102:103], v[108:109], v[42:43], v[102:103]
v_mov_b32_dpp v29, v114 row_shl:2 row_mask:0xf bank_mask:0xf
v_smfmac_f32_16x16x64_bf16 v[48:51], a[8:11], a[176:183], v105
v_cvt_pk_bf16_f32 v28, v114, v29
v_min_u32 v28, -2, v28
v_smfmac_f32_16x16x64_bf16 v[48:51], a[12:15], a[184:191], v105
v_add_f32 v98, v102, v103
v_pk_mul_f32 v[102:103], v[106:107], v[44:45]
v_smfmac_f32_16x16x64_bf16 v[52:55], a[0:3], a[192:199], v105
v_mov_b32_dpp v29, v28 row_shl:4 row_mask:0xf bank_mask:0xf
v_mov_b32_dpp v30, v28 row_shl:8 row_mask:0xf bank_mask:0xf
v_smfmac_f32_16x16x64_bf16 v[52:55], a[4:7], a[200:207], v105
v_mov_b32_dpp v31, v28 row_shl:12 row_mask:0xf bank_mask:0xf
s_mov_b64 exec, 0x00030003
buffer_store_dwordx4 v[28:31], v93, s[64:67], 0 offen offset:1024 sc1
s_mov_b64 exec, -1
v_smfmac_f32_16x16x64_bf16 v[52:55], a[8:11], a[208:215], v105
v_pk_fma_f32 v[102:103], v[108:109], v[46:47], v[102:103]
v_add_f32 v99, v102, v103
v_smfmac_f32_16x16x64_bf16 v[52:55], a[12:15], a[216:223], v105
v_cvt_pk_bf16_f32 v110, v98, v99
v_min_u32 v110, -2, v110
v_pk_mul_f32 v[102:103], v[106:107], v[48:49]
v_pk_fma_f32 v[102:103], v[108:109], v[50:51], v[102:103]
v_add_f32 v100, v102, v103
v_permlane32_swap_b32 v110, v112
s_nop 1
v_pk_mul_f32 v[102:103], v[106:107], v[52:53]
v_pk_fma_f32 v[102:103], v[108:109], v[54:55], v[102:103]
v_add_f32 v101, v102, v103
v_cvt_pk_bf16_f32 v111, v100, v101
v_min_u32 v111, -2, v111
s_nop 1
v_permlane32_swap_b32 v111, v113
s_mov_b64 exec, 0xffffffff
buffer_store_dwordx4 v[110:113], v92, s[64:67], 0 offen sc1
s_mov_b64 exec, -1
s_endpgm
L_exit:
s_endpgm
B_role:
s_mov_b32 s8, s5
s_lshl_b32 s9, s4, 1
s_add_u32 s9, s9, s8
v_and_b32 v1, 63, v0
v_lshlrev_b32 v2, 4, v1
v_lshrrev_b32 v9, 4, v1
v_and_b32 v8, 15, v1
s_cmp_eq_u32 s8, 1
s_cbranch_scc1 D_role
v_mul_u32_u24 v3, 294912, v9
v_lshl_add_u32 v3, v8, 4, v3
v_mul_u32_u24 v4, 72, v9
v_lshrrev_b32 v6, 3, v8
v_mul_u32_u24 v6, 1152, v6
v_add_u32 v4, v4, v6
v_lshlrev_b32 v238, 17, v9
v_lshl_add_u32 v238, v8, 4, v238
s_waitcnt lgkmcnt(0)
s_mul_i32 s6, s3, 288
s_sub_u32 s7, 4608, s6
s_add_u32 s44, s26, s6
s_addc_u32 s45, s27, 0
s_mov_b32 s46, s7
s_mov_b32 s47, 0x20000
s_mul_i32 s6, s3, 1179648
s_lshl_b32 s7, s4, 8
s_add_u32 s6, s6, s7
s_sub_u32 s7, 4718592, s6
s_add_u32 s48, s30, s6
s_addc_u32 s49, s31, 0
s_mov_b32 s50, s7
s_mov_b32 s51, 0x20000
buffer_load_dwordx4 v[24:27], v4, s[44:47], 0 offen offset:0
buffer_load_dwordx4 v[28:31], v4, s[44:47], 0 offen offset:16
buffer_load_dwordx4 v[32:35], v4, s[44:47], 0 offen offset:32
buffer_load_dwordx4 v[36:39], v4, s[44:47], 0 offen offset:48
buffer_load_dwordx2 v[40:41], v4, s[44:47], 0 offen offset:64
buffer_load_dwordx4 v[44:47], v4, s[44:47], 0 offen offset:2304
buffer_load_dwordx4 v[48:51], v4, s[44:47], 0 offen offset:2320
buffer_load_dwordx4 v[52:55], v4, s[44:47], 0 offen offset:2336
buffer_load_dwordx4 v[56:59], v4, s[44:47], 0 offen offset:2352
buffer_load_dwordx2 v[60:61], v4, s[44:47], 0 offen offset:2368
s_mov_b32 s6, 0
buffer_load_dwordx4 a[96:99], v3, s[48:51], s6 offen nt
s_mov_b32 s6, 8192
buffer_load_dwordx4 a[100:103], v3, s[48:51], s6 offen nt
s_mov_b32 s6, 16384
buffer_load_dwordx4 a[104:107], v3, s[48:51], s6 offen nt
s_mov_b32 s6, 24576
buffer_load_dwordx4 a[108:111], v3, s[48:51], s6 offen nt
s_mov_b32 s6, 32768
buffer_load_dwordx4 a[112:115], v3, s[48:51], s6 offen nt
s_mov_b32 s6, 40960
buffer_load_dwordx4 a[116:119], v3, s[48:51], s6 offen nt
s_mov_b32 s6, 49152
buffer_load_dwordx4 a[120:123], v3, s[48:51], s6 offen nt
s_mov_b32 s6, 57344
buffer_load_dwordx4 a[124:127], v3, s[48:51], s6 offen nt
s_mov_b32 s6, 65536
buffer_load_dwordx4 a[128:131], v3, s[48:51], s6 offen nt
s_mov_b32 s6, 73728
buffer_load_dwordx4 a[132:135], v3, s[48:51], s6 offen nt
s_mov_b32 s6, 81920
buffer_load_dwordx4 a[136:139], v3, s[48:51], s6 offen nt
s_mov_b32 s6, 90112
buffer_load_dwordx4 a[140:143], v3, s[48:51], s6 offen nt
s_mov_b32 s6, 98304
buffer_load_dwordx4 a[144:147], v3, s[48:51], s6 offen nt
s_mov_b32 s6, 106496
buffer_load_dwordx4 a[148:151], v3, s[48:51], s6 offen nt
s_mov_b32 s6, 114688
buffer_load_dwordx4 a[152:155], v3, s[48:51], s6 offen nt
s_mov_b32 s6, 122880
buffer_load_dwordx4 a[156:159], v3, s[48:51], s6 offen nt
s_mov_b32 s6, 131072
buffer_load_dwordx4 a[160:163], v3, s[48:51], s6 offen nt
s_mov_b32 s6, 139264
buffer_load_dwordx4 a[164:167], v3, s[48:51], s6 offen nt
s_mov_b32 s6, 147456
buffer_load_dwordx4 a[168:171], v3, s[48:51], s6 offen nt
s_mov_b32 s6, 155648
buffer_load_dwordx4 a[172:175], v3, s[48:51], s6 offen nt
s_mov_b32 s6, 163840
buffer_load_dwordx4 a[176:179], v3, s[48:51], s6 offen nt
s_mov_b32 s6, 172032
buffer_load_dwordx4 a[180:183], v3, s[48:51], s6 offen nt
s_mov_b32 s6, 180224
buffer_load_dwordx4 a[184:187], v3, s[48:51], s6 offen nt
s_mov_b32 s6, 188416
buffer_load_dwordx4 a[188:191], v3, s[48:51], s6 offen nt
s_mov_b32 s6, 196608
buffer_load_dwordx4 a[192:195], v3, s[48:51], s6 offen nt
s_mov_b32 s6, 204800
buffer_load_dwordx4 a[196:199], v3, s[48:51], s6 offen nt
s_mov_b32 s6, 212992
buffer_load_dwordx4 a[200:203], v3, s[48:51], s6 offen nt
s_mov_b32 s6, 221184
buffer_load_dwordx4 a[204:207], v3, s[48:51], s6 offen nt
s_mov_b32 s6, 229376
buffer_load_dwordx4 a[208:211], v3, s[48:51], s6 offen nt
s_mov_b32 s6, 237568
buffer_load_dwordx4 a[212:215], v3, s[48:51], s6 offen nt
s_mov_b32 s6, 245760
buffer_load_dwordx4 a[216:219], v3, s[48:51], s6 offen nt
s_mov_b32 s6, 253952
buffer_load_dwordx4 a[220:223], v3, s[48:51], s6 offen nt
s_mov_b32 s6, 262144
buffer_load_dwordx4 a[224:227], v3, s[48:51], s6 offen nt
s_mov_b32 s6, 270336
buffer_load_dwordx4 a[228:231], v3, s[48:51], s6 offen nt
s_mov_b32 s6, 278528
buffer_load_dwordx4 a[232:235], v3, s[48:51], s6 offen nt
s_mov_b32 s6, 286720
buffer_load_dwordx4 a[236:239], v3, s[48:51], s6 offen nt
s_lshl_b32 s6, s3, 20
s_lshl_b32 s7, s4, 8
s_add_u32 s6, s6, s7
s_sub_u32 s7, 4194304, s6
s_add_u32 s76, s32, s6
s_addc_u32 s77, s33, 0
s_mov_b32 s78, s7
s_mov_b32 s79, 0x20000
s_add_u32 s52, s34, s6
s_addc_u32 s53, s35, 0
s_mov_b32 s54, s7
s_mov_b32 s55, 0x20000
s_mov_b32 s6, 0
buffer_load_dwordx4 v[88:91], v238, s[76:79], s6 offen nt
s_mov_b32 s6, 8192
buffer_load_dwordx4 v[92:95], v238, s[76:79], s6 offen nt
s_mov_b32 s6, 16384
buffer_load_dwordx4 v[96:99], v238, s[76:79], s6 offen nt
s_mov_b32 s6, 24576
buffer_load_dwordx4 v[100:103], v238, s[76:79], s6 offen nt
s_mov_b32 s6, 32768
buffer_load_dwordx4 v[104:107], v238, s[76:79], s6 offen nt
s_mov_b32 s6, 40960
buffer_load_dwordx4 v[108:111], v238, s[76:79], s6 offen nt
s_mov_b32 s6, 49152
buffer_load_dwordx4 v[112:115], v238, s[76:79], s6 offen nt
s_mov_b32 s6, 57344
buffer_load_dwordx4 v[116:119], v238, s[76:79], s6 offen nt
s_mov_b32 s6, 65536
buffer_load_dwordx4 v[120:123], v238, s[76:79], s6 offen nt
s_mov_b32 s6, 73728
buffer_load_dwordx4 v[124:127], v238, s[76:79], s6 offen nt
s_mov_b32 s6, 81920
buffer_load_dwordx4 v[128:131], v238, s[76:79], s6 offen nt
s_mov_b32 s6, 90112
buffer_load_dwordx4 v[132:135], v238, s[76:79], s6 offen nt
s_mov_b32 s64, s42
s_mov_b32 s65, s43
s_mov_b32 s66, 16777216
s_mov_b32 s67, 0x20000
s_mov_b32 s68, s40
s_mov_b32 s69, s41
s_mov_b32 s70, 256
s_mov_b32 s71, 0x20000
s_mov_b32 s72, s38
s_mov_b32 s73, s39
s_mov_b32 s74, 9216
s_mov_b32 s75, 0x20000
s_mul_i32 s6, s4, 147456
s_add_u32 s60, s36, s6
s_addc_u32 s61, s37, 0
s_mov_b32 s62, 147456
s_mov_b32 s63, 0x20000
v_and_b32 v5, 1, v1
v_lshlrev_b32 v5, 4, v5
v_mov_b32 v6, 0xffff
v_lshlrev_b32 v5, v5, v6
v_bfe_u32 v6, v1, 1, 2
v_cmp_eq_u32 vcc, 0, v6
s_nop 1
v_cndmask_b32 v12, 0, v5, vcc
v_cmp_eq_u32 vcc, 1, v6
s_nop 1
v_cndmask_b32 v13, 0, v5, vcc
v_cmp_eq_u32 vcc, 2, v6
s_nop 1
v_cndmask_b32 v14, 0, v5, vcc
v_cmp_eq_u32 vcc, 3, v6
s_nop 1
v_cndmask_b32 v15, 0, v5, vcc
v_mov_b32 v5, 0x0c0c0c0c
s_mov_b32 s6, 0x01000100
s_mov_b32 s7, 0x03020302
v_bfi_b32 v16, v12, s6, v5
v_bfi_b32 v17, v13, s6, v5
v_bfi_b32 v18, v14, s6, v5
v_bfi_b32 v19, v15, s6, v5
v_bfi_b32 v20, v12, s7, v5
v_bfi_b32 v21, v13, s7, v5
v_bfi_b32 v22, v14, s7, v5
v_bfi_b32 v23, v15, s7, v5
v_lshrrev_b32 v5, 4, v1
v_lshlrev_b32 v5, 3, v5
v_bfe_u32 v6, v1, 2, 2
v_add_u32 v5, v5, v6
v_mul_u32_u24 v5, 1152, v5
s_mul_i32 s6, s3, 288
v_add_u32 v5, s6, v5
v_and_b32 v6, 3, v1
v_lshl_add_u32 v240, v6, 5, v5
v_lshl_add_u32 v241, v6, 3, v5
v_add_u32 v241, 256, v241
v_add_u32 v242, 73728, v240
v_add_u32 v243, 73728, v241
s_mul_i32 s12, s3, 36864
s_waitcnt vmcnt(47)
v_perm_b32 v64, v24, v24, v16
v_perm_b32 v65, v24, v24, v17
v_perm_b32 v66, v24, v24, v18
v_perm_b32 v67, v24, v24, v19
s_nop 1
v_mfma_f32_16x16x32_bf16 v[80:83], v[64:67], a[96:99], 0
v_perm_b32 v68, v44, v44, v16
v_perm_b32 v69, v44, v44, v17
v_perm_b32 v70, v44, v44, v18
v_perm_b32 v71, v44, v44, v19
s_nop 1
v_mfma_f32_16x16x32_bf16 v[84:87], v[68:71], a[96:99], 0
s_mov_b32 s6, 98304
buffer_load_dwordx4 v[136:139], v238, s[76:79], s6 offen nt
s_waitcnt vmcnt(47)
v_perm_b32 v72, v24, v24, v20
v_perm_b32 v73, v24, v24, v21
v_perm_b32 v74, v24, v24, v22
v_perm_b32 v75, v24, v24, v23
s_nop 1
v_mfma_f32_16x16x32_bf16 v[80:83], v[72:75], a[100:103], v[80:83]
v_perm_b32 v76, v44, v44, v20
v_perm_b32 v77, v44, v44, v21
v_perm_b32 v78, v44, v44, v22
v_perm_b32 v79, v44, v44, v23
s_nop 1
v_mfma_f32_16x16x32_bf16 v[84:87], v[76:79], a[100:103], v[84:87]
s_mov_b32 s6, 106496
buffer_load_dwordx4 v[140:143], v238, s[76:79], s6 offen nt
s_waitcnt vmcnt(47)
v_perm_b32 v64, v25, v25, v16
v_perm_b32 v65, v25, v25, v17
v_perm_b32 v66, v25, v25, v18
v_perm_b32 v67, v25, v25, v19
s_nop 1
v_mfma_f32_16x16x32_bf16 v[80:83], v[64:67], a[104:107], v[80:83]
v_perm_b32 v68, v45, v45, v16
v_perm_b32 v69, v45, v45, v17
v_perm_b32 v70, v45, v45, v18
v_perm_b32 v71, v45, v45, v19
s_nop 1
v_mfma_f32_16x16x32_bf16 v[84:87], v[68:71], a[104:107], v[84:87]
s_mov_b32 s6, 114688
buffer_load_dwordx4 v[144:147], v238, s[76:79], s6 offen nt
s_waitcnt vmcnt(47)
v_perm_b32 v72, v25, v25, v20
v_perm_b32 v73, v25, v25, v21
v_perm_b32 v74, v25, v25, v22
v_perm_b32 v75, v25, v25, v23
s_nop 1
v_mfma_f32_16x16x32_bf16 v[80:83], v[72:75], a[108:111], v[80:83]
v_perm_b32 v76, v45, v45, v20
v_perm_b32 v77, v45, v45, v21
v_perm_b32 v78, v45, v45, v22
v_perm_b32 v79, v45, v45, v23
s_nop 1
v_mfma_f32_16x16x32_bf16 v[84:87], v[76:79], a[108:111], v[84:87]
s_mov_b32 s6, 122880
buffer_load_dwordx4 v[148:151], v238, s[76:79], s6 offen nt
s_waitcnt vmcnt(47)
v_perm_b32 v64, v26, v26, v16
v_perm_b32 v65, v26, v26, v17
v_perm_b32 v66, v26, v26, v18
v_perm_b32 v67, v26, v26, v19
s_nop 1
v_mfma_f32_16x16x32_bf16 v[80:83], v[64:67], a[112:115], v[80:83]
v_perm_b32 v68, v46, v46, v16
v_perm_b32 v69, v46, v46, v17
v_perm_b32 v70, v46, v46, v18
v_perm_b32 v71, v46, v46, v19
s_nop 1
v_mfma_f32_16x16x32_bf16 v[84:87], v[68:71], a[112:115], v[84:87]
s_mov_b32 s6, 524288
buffer_load_dwordx4 v[152:155], v238, s[76:79], s6 offen nt
s_waitcnt vmcnt(47)
v_perm_b32 v72, v26, v26, v20
v_perm_b32 v73, v26, v26, v21
v_perm_b32 v74, v26, v26, v22
v_perm_b32 v75, v26, v26, v23
s_nop 1
v_mfma_f32_16x16x32_bf16 v[80:83], v[72:75], a[116:119], v[80:83]
v_perm_b32 v76, v46, v46, v20
v_perm_b32 v77, v46, v46, v21
v_perm_b32 v78, v46, v46, v22
v_perm_b32 v79, v46, v46, v23
s_nop 1
v_mfma_f32_16x16x32_bf16 v[84:87], v[76:79], a[116:119], v[84:87]
s_mov_b32 s6, 532480
buffer_load_dwordx4 v[156:159], v238, s[76:79], s6 offen nt
s_waitcnt vmcnt(47)
v_perm_b32 v64, v27, v27, v16
v_perm_b32 v65, v27, v27, v17
v_perm_b32 v66, v27, v27, v18
v_perm_b32 v67, v27, v27, v19
s_nop 1
v_mfma_f32_16x16x32_bf16 v[80:83], v[64:67], a[120:123], v[80:83]
v_perm_b32 v68, v47, v47, v16
v_perm_b32 v69, v47, v47, v17
v_perm_b32 v70, v47, v47, v18
v_perm_b32 v71, v47, v47, v19
s_nop 1
v_mfma_f32_16x16x32_bf16 v[84:87], v[68:71], a[120:123], v[84:87]
s_mov_b32 s6, 540672
buffer_load_dwordx4 v[160:163], v238, s[76:79], s6 offen nt
s_waitcnt vmcnt(47)
v_perm_b32 v72, v27, v27, v20
v_perm_b32 v73, v27, v27, v21
v_perm_b32 v74, v27, v27, v22
v_perm_b32 v75, v27, v27, v23
s_nop 1
v_mfma_f32_16x16x32_bf16 v[80:83], v[72:75], a[124:127], v[80:83]
v_perm_b32 v76, v47, v47, v20
v_perm_b32 v77, v47, v47, v21
v_perm_b32 v78, v47, v47, v22
v_perm_b32 v79, v47, v47, v23
s_nop 1
v_mfma_f32_16x16x32_bf16 v[84:87], v[76:79], a[124:127], v[84:87]
s_mov_b32 s6, 548864
buffer_load_dwordx4 v[164:167], v238, s[76:79], s6 offen nt
s_waitcnt vmcnt(47)
v_perm_b32 v64, v28, v28, v16
v_perm_b32 v65, v28, v28, v17
v_perm_b32 v66, v28, v28, v18
v_perm_b32 v67, v28, v28, v19
s_nop 1
v_mfma_f32_16x16x32_bf16 v[80:83], v[64:67], a[128:131], v[80:83]
v_perm_b32 v68, v48, v48, v16
v_perm_b32 v69, v48, v48, v17
v_perm_b32 v70, v48, v48, v18
v_perm_b32 v71, v48, v48, v19
s_nop 1
v_mfma_f32_16x16x32_bf16 v[84:87], v[68:71], a[128:131], v[84:87]
s_mov_b32 s6, 557056
buffer_load_dwordx4 v[168:171], v238, s[76:79], s6 offen nt
s_waitcnt vmcnt(47)
v_perm_b32 v72, v28, v28, v20
v_perm_b32 v73, v28, v28, v21
v_perm_b32 v74, v28, v28, v22
v_perm_b32 v75, v28, v28, v23
s_nop 1
v_mfma_f32_16x16x32_bf16 v[80:83], v[72:75], a[132:135], v[80:83]
v_perm_b32 v76, v48, v48, v20
v_perm_b32 v77, v48, v48, v21
v_perm_b32 v78, v48, v48, v22
v_perm_b32 v79, v48, v48, v23
s_nop 1
v_mfma_f32_16x16x32_bf16 v[84:87], v[76:79], a[132:135], v[84:87]
s_mov_b32 s6, 565248
buffer_load_dwordx4 v[172:175], v238, s[76:79], s6 offen nt
s_waitcnt vmcnt(47)
v_perm_b32 v64, v29, v29, v16
v_perm_b32 v65, v29, v29, v17
v_perm_b32 v66, v29, v29, v18
v_perm_b32 v67, v29, v29, v19
s_nop 1
v_mfma_f32_16x16x32_bf16 v[80:83], v[64:67], a[136:139], v[80:83]
v_perm_b32 v68, v49, v49, v16
v_perm_b32 v69, v49, v49, v17
v_perm_b32 v70, v49, v49, v18
v_perm_b32 v71, v49, v49, v19
s_nop 1
v_mfma_f32_16x16x32_bf16 v[84:87], v[68:71], a[136:139], v[84:87]
s_mov_b32 s6, 573440
buffer_load_dwordx4 v[176:179], v238, s[76:79], s6 offen nt
s_waitcnt vmcnt(47)
v_perm_b32 v72, v29, v29, v20
v_perm_b32 v73, v29, v29, v21
v_perm_b32 v74, v29, v29, v22
v_perm_b32 v75, v29, v29, v23
s_nop 1
v_mfma_f32_16x16x32_bf16 v[80:83], v[72:75], a[140:143], v[80:83]
v_perm_b32 v76, v49, v49, v20
v_perm_b32 v77, v49, v49, v21
v_perm_b32 v78, v49, v49, v22
v_perm_b32 v79, v49, v49, v23
s_nop 1
v_mfma_f32_16x16x32_bf16 v[84:87], v[76:79], a[140:143], v[84:87]
s_mov_b32 s6, 581632
buffer_load_dwordx4 v[180:183], v238, s[76:79], s6 offen nt
s_waitcnt vmcnt(47)
v_perm_b32 v64, v30, v30, v16
v_perm_b32 v65, v30, v30, v17
v_perm_b32 v66, v30, v30, v18
v_perm_b32 v67, v30, v30, v19
s_nop 1
v_mfma_f32_16x16x32_bf16 v[80:83], v[64:67], a[144:147], v[80:83]
v_perm_b32 v68, v50, v50, v16
v_perm_b32 v69, v50, v50, v17
v_perm_b32 v70, v50, v50, v18
v_perm_b32 v71, v50, v50, v19
s_nop 1
v_mfma_f32_16x16x32_bf16 v[84:87], v[68:71], a[144:147], v[84:87]
s_mov_b32 s6, 589824
buffer_load_dwordx4 v[184:187], v238, s[76:79], s6 offen nt
s_waitcnt vmcnt(47)
v_perm_b32 v72, v30, v30, v20
v_perm_b32 v73, v30, v30, v21
v_perm_b32 v74, v30, v30, v22
v_perm_b32 v75, v30, v30, v23
s_nop 1
v_mfma_f32_16x16x32_bf16 v[80:83], v[72:75], a[148:151], v[80:83]
v_perm_b32 v76, v50, v50, v20
v_perm_b32 v77, v50, v50, v21
v_perm_b32 v78, v50, v50, v22
v_perm_b32 v79, v50, v50, v23
s_nop 1
v_mfma_f32_16x16x32_bf16 v[84:87], v[76:79], a[148:151], v[84:87]
s_mov_b32 s6, 598016
buffer_load_dwordx4 v[188:191], v238, s[76:79], s6 offen nt
s_waitcnt vmcnt(47)
v_perm_b32 v64, v31, v31, v16
v_perm_b32 v65, v31, v31, v17
v_perm_b32 v66, v31, v31, v18
v_perm_b32 v67, v31, v31, v19
s_nop 1
v_mfma_f32_16x16x32_bf16 v[80:83], v[64:67], a[152:155], v[80:83]
v_perm_b32 v68, v51, v51, v16
v_perm_b32 v69, v51, v51, v17
v_perm_b32 v70, v51, v51, v18
v_perm_b32 v71, v51, v51, v19
s_nop 1
v_mfma_f32_16x16x32_bf16 v[84:87], v[68:71], a[152:155], v[84:87]
s_mov_b32 s6, 606208
buffer_load_dwordx4 v[192:195], v238, s[76:79], s6 offen nt
s_waitcnt vmcnt(47)
v_perm_b32 v72, v31, v31, v20
v_perm_b32 v73, v31, v31, v21
v_perm_b32 v74, v31, v31, v22
v_perm_b32 v75, v31, v31, v23
s_nop 1
v_mfma_f32_16x16x32_bf16 v[80:83], v[72:75], a[156:159], v[80:83]
v_perm_b32 v76, v51, v51, v20
v_perm_b32 v77, v51, v51, v21
v_perm_b32 v78, v51, v51, v22
v_perm_b32 v79, v51, v51, v23
s_nop 1
v_mfma_f32_16x16x32_bf16 v[84:87], v[76:79], a[156:159], v[84:87]
s_mov_b32 s6, 614400
buffer_load_dwordx4 v[196:199], v238, s[76:79], s6 offen nt
s_waitcnt vmcnt(47)
v_perm_b32 v64, v32, v32, v16
v_perm_b32 v65, v32, v32, v17
v_perm_b32 v66, v32, v32, v18
v_perm_b32 v67, v32, v32, v19
s_nop 1
v_mfma_f32_16x16x32_bf16 v[80:83], v[64:67], a[160:163], v[80:83]
v_perm_b32 v68, v52, v52, v16
v_perm_b32 v69, v52, v52, v17
v_perm_b32 v70, v52, v52, v18
v_perm_b32 v71, v52, v52, v19
s_nop 1
v_mfma_f32_16x16x32_bf16 v[84:87], v[68:71], a[160:163], v[84:87]
s_mov_b32 s6, 622592
buffer_load_dwordx4 v[200:203], v238, s[76:79], s6 offen nt
s_waitcnt vmcnt(47)
v_perm_b32 v72, v32, v32, v20
v_perm_b32 v73, v32, v32, v21
v_perm_b32 v74, v32, v32, v22
v_perm_b32 v75, v32, v32, v23
s_nop 1
v_mfma_f32_16x16x32_bf16 v[80:83], v[72:75], a[164:167], v[80:83]
v_perm_b32 v76, v52, v52, v20
v_perm_b32 v77, v52, v52, v21
v_perm_b32 v78, v52, v52, v22
v_perm_b32 v79, v52, v52, v23
s_nop 1
v_mfma_f32_16x16x32_bf16 v[84:87], v[76:79], a[164:167], v[84:87]
s_mov_b32 s6, 630784
buffer_load_dwordx4 v[204:207], v238, s[76:79], s6 offen nt
s_waitcnt vmcnt(47)
v_perm_b32 v64, v33, v33, v16
v_perm_b32 v65, v33, v33, v17
v_perm_b32 v66, v33, v33, v18
v_perm_b32 v67, v33, v33, v19
s_nop 1
v_mfma_f32_16x16x32_bf16 v[80:83], v[64:67], a[168:171], v[80:83]
v_perm_b32 v68, v53, v53, v16
v_perm_b32 v69, v53, v53, v17
v_perm_b32 v70, v53, v53, v18
v_perm_b32 v71, v53, v53, v19
s_nop 1
v_mfma_f32_16x16x32_bf16 v[84:87], v[68:71], a[168:171], v[84:87]
s_mov_b32 s6, 638976
buffer_load_dwordx4 v[208:211], v238, s[76:79], s6 offen nt
s_waitcnt vmcnt(47)
v_perm_b32 v72, v33, v33, v20
v_perm_b32 v73, v33, v33, v21
v_perm_b32 v74, v33, v33, v22
v_perm_b32 v75, v33, v33, v23
s_nop 1
v_mfma_f32_16x16x32_bf16 v[80:83], v[72:75], a[172:175], v[80:83]
v_perm_b32 v76, v53, v53, v20
v_perm_b32 v77, v53, v53, v21
v_perm_b32 v78, v53, v53, v22
v_perm_b32 v79, v53, v53, v23
s_nop 1
v_mfma_f32_16x16x32_bf16 v[84:87], v[76:79], a[172:175], v[84:87]
s_mov_b32 s6, 647168
buffer_load_dwordx4 v[212:215], v238, s[76:79], s6 offen nt
s_waitcnt vmcnt(47)
v_perm_b32 v64, v34, v34, v16
v_perm_b32 v65, v34, v34, v17
v_perm_b32 v66, v34, v34, v18
v_perm_b32 v67, v34, v34, v19
s_nop 1
v_mfma_f32_16x16x32_bf16 v[80:83], v[64:67], a[176:179], v[80:83]
v_perm_b32 v68, v54, v54, v16
v_perm_b32 v69, v54, v54, v17
v_perm_b32 v70, v54, v54, v18
v_perm_b32 v71, v54, v54, v19
s_nop 1
v_mfma_f32_16x16x32_bf16 v[84:87], v[68:71], a[176:179], v[84:87]
buffer_load_dword v11, off, s[68:71], 0 offset:0 sc1
s_waitcnt vmcnt(47)
v_perm_b32 v72, v34, v34, v20
v_perm_b32 v73, v34, v34, v21
v_perm_b32 v74, v34, v34, v22
v_perm_b32 v75, v34, v34, v23
s_nop 1
v_mfma_f32_16x16x32_bf16 v[80:83], v[72:75], a[180:183], v[80:83]
v_perm_b32 v76, v54, v54, v20
v_perm_b32 v77, v54, v54, v21
v_perm_b32 v78, v54, v54, v22
v_perm_b32 v79, v54, v54, v23
s_nop 1
v_mfma_f32_16x16x32_bf16 v[84:87], v[76:79], a[180:183], v[84:87]
s_waitcnt vmcnt(46)
v_perm_b32 v64, v35, v35, v16
v_perm_b32 v65, v35, v35, v17
v_perm_b32 v66, v35, v35, v18
v_perm_b32 v67, v35, v35, v19
s_nop 1
v_mfma_f32_16x16x32_bf16 v[80:83], v[64:67], a[184:187], v[80:83]
v_perm_b32 v68, v55, v55, v16
v_perm_b32 v69, v55, v55, v17
v_perm_b32 v70, v55, v55, v18
v_perm_b32 v71, v55, v55, v19
s_nop 1
v_mfma_f32_16x16x32_bf16 v[84:87], v[68:71], a[184:187], v[84:87]
s_waitcnt vmcnt(45)
v_perm_b32 v72, v35, v35, v20
v_perm_b32 v73, v35, v35, v21
v_perm_b32 v74, v35, v35, v22
v_perm_b32 v75, v35, v35, v23
s_nop 1
v_mfma_f32_16x16x32_bf16 v[80:83], v[72:75], a[188:191], v[80:83]
v_perm_b32 v76, v55, v55, v20
v_perm_b32 v77, v55, v55, v21
v_perm_b32 v78, v55, v55, v22
v_perm_b32 v79, v55, v55, v23
s_nop 1
v_mfma_f32_16x16x32_bf16 v[84:87], v[76:79], a[188:191], v[84:87]
s_waitcnt vmcnt(44)
v_perm_b32 v64, v36, v36, v16
v_perm_b32 v65, v36, v36, v17
v_perm_b32 v66, v36, v36, v18
v_perm_b32 v67, v36, v36, v19
s_nop 1
v_mfma_f32_16x16x32_bf16 v[80:83], v[64:67], a[192:195], v[80:83]
v_perm_b32 v68, v56, v56, v16
v_perm_b32 v69, v56, v56, v17
v_perm_b32 v70, v56, v56, v18
v_perm_b32 v71, v56, v56, v19
s_nop 1
v_mfma_f32_16x16x32_bf16 v[84:87], v[68:71], a[192:195], v[84:87]
s_waitcnt vmcnt(43)
v_perm_b32 v72, v36, v36, v20
v_perm_b32 v73, v36, v36, v21
v_perm_b32 v74, v36, v36, v22
v_perm_b32 v75, v36, v36, v23
s_nop 1
v_mfma_f32_16x16x32_bf16 v[80:83], v[72:75], a[196:199], v[80:83]
v_perm_b32 v76, v56, v56, v20
v_perm_b32 v77, v56, v56, v21
v_perm_b32 v78, v56, v56, v22
v_perm_b32 v79, v56, v56, v23
s_nop 1
v_mfma_f32_16x16x32_bf16 v[84:87], v[76:79], a[196:199], v[84:87]
s_waitcnt vmcnt(42)
v_perm_b32 v64, v37, v37, v16
v_perm_b32 v65, v37, v37, v17
v_perm_b32 v66, v37, v37, v18
v_perm_b32 v67, v37, v37, v19
s_nop 1
v_mfma_f32_16x16x32_bf16 v[80:83], v[64:67], a[200:203], v[80:83]
v_perm_b32 v68, v57, v57, v16
v_perm_b32 v69, v57, v57, v17
v_perm_b32 v70, v57, v57, v18
v_perm_b32 v71, v57, v57, v19
s_nop 1
v_mfma_f32_16x16x32_bf16 v[84:87], v[68:71], a[200:203], v[84:87]
s_waitcnt vmcnt(41)
v_perm_b32 v72, v37, v37, v20
v_perm_b32 v73, v37, v37, v21
v_perm_b32 v74, v37, v37, v22
v_perm_b32 v75, v37, v37, v23
s_nop 1
v_mfma_f32_16x16x32_bf16 v[80:83], v[72:75], a[204:207], v[80:83]
v_perm_b32 v76, v57, v57, v20
v_perm_b32 v77, v57, v57, v21
v_perm_b32 v78, v57, v57, v22
v_perm_b32 v79, v57, v57, v23
s_nop 1
v_mfma_f32_16x16x32_bf16 v[84:87], v[76:79], a[204:207], v[84:87]
s_waitcnt vmcnt(40)
v_perm_b32 v64, v38, v38, v16
v_perm_b32 v65, v38, v38, v17
v_perm_b32 v66, v38, v38, v18
v_perm_b32 v67, v38, v38, v19
s_nop 1
v_mfma_f32_16x16x32_bf16 v[80:83], v[64:67], a[208:211], v[80:83]
v_perm_b32 v68, v58, v58, v16
v_perm_b32 v69, v58, v58, v17
v_perm_b32 v70, v58, v58, v18
v_perm_b32 v71, v58, v58, v19
s_nop 1
v_mfma_f32_16x16x32_bf16 v[84:87], v[68:71], a[208:211], v[84:87]
s_waitcnt vmcnt(39)
v_perm_b32 v72, v38, v38, v20
v_perm_b32 v73, v38, v38, v21
v_perm_b32 v74, v38, v38, v22
v_perm_b32 v75, v38, v38, v23
s_nop 1
v_mfma_f32_16x16x32_bf16 v[80:83], v[72:75], a[212:215], v[80:83]
v_perm_b32 v76, v58, v58, v20
v_perm_b32 v77, v58, v58, v21
v_perm_b32 v78, v58, v58, v22
v_perm_b32 v79, v58, v58, v23
s_nop 1
v_mfma_f32_16x16x32_bf16 v[84:87], v[76:79], a[212:215], v[84:87]
s_waitcnt vmcnt(38)
v_perm_b32 v64, v39, v39, v16
v_perm_b32 v65, v39, v39, v17
v_perm_b32 v66, v39, v39, v18
v_perm_b32 v67, v39, v39, v19
s_nop 1
v_mfma_f32_16x16x32_bf16 v[80:83], v[64:67], a[216:219], v[80:83]
v_perm_b32 v68, v59, v59, v16
v_perm_b32 v69, v59, v59, v17
v_perm_b32 v70, v59, v59, v18
v_perm_b32 v71, v59, v59, v19
s_nop 1
v_mfma_f32_16x16x32_bf16 v[84:87], v[68:71], a[216:219], v[84:87]
s_waitcnt vmcnt(37)
v_perm_b32 v72, v39, v39, v20
v_perm_b32 v73, v39, v39, v21
v_perm_b32 v74, v39, v39, v22
v_perm_b32 v75, v39, v39, v23
s_nop 1
v_mfma_f32_16x16x32_bf16 v[80:83], v[72:75], a[220:223], v[80:83]
v_perm_b32 v76, v59, v59, v20
v_perm_b32 v77, v59, v59, v21
v_perm_b32 v78, v59, v59, v22
v_perm_b32 v79, v59, v59, v23
s_nop 1
v_mfma_f32_16x16x32_bf16 v[84:87], v[76:79], a[220:223], v[84:87]
s_waitcnt vmcnt(36)
v_perm_b32 v64, v40, v40, v16
v_perm_b32 v65, v40, v40, v17
v_perm_b32 v66, v40, v40, v18
v_perm_b32 v67, v40, v40, v19
s_nop 1
v_mfma_f32_16x16x32_bf16 v[80:83], v[64:67], a[224:227], v[80:83]
v_perm_b32 v68, v60, v60, v16
v_perm_b32 v69, v60, v60, v17
v_perm_b32 v70, v60, v60, v18
v_perm_b32 v71, v60, v60, v19
s_nop 1
v_mfma_f32_16x16x32_bf16 v[84:87], v[68:71], a[224:227], v[84:87]
s_waitcnt vmcnt(35)
v_perm_b32 v72, v40, v40, v20
v_perm_b32 v73, v40, v40, v21
v_perm_b32 v74, v40, v40, v22
v_perm_b32 v75, v40, v40, v23
s_nop 1
v_mfma_f32_16x16x32_bf16 v[80:83], v[72:75], a[228:231], v[80:83]
v_perm_b32 v76, v60, v60, v20
v_perm_b32 v77, v60, v60, v21
v_perm_b32 v78, v60, v60, v22
v_perm_b32 v79, v60, v60, v23
s_nop 1
v_mfma_f32_16x16x32_bf16 v[84:87], v[76:79], a[228:231], v[84:87]
s_waitcnt vmcnt(34)
v_perm_b32 v64, v41, v41, v16
v_perm_b32 v65, v41, v41, v17
v_perm_b32 v66, v41, v41, v18
v_perm_b32 v67, v41, v41, v19
s_nop 1
v_mfma_f32_16x16x32_bf16 v[80:83], v[64:67], a[232:235], v[80:83]
v_perm_b32 v68, v61, v61, v16
v_perm_b32 v69, v61, v61, v17
v_perm_b32 v70, v61, v61, v18
v_perm_b32 v71, v61, v61, v19
s_nop 1
v_mfma_f32_16x16x32_bf16 v[84:87], v[68:71], a[232:235], v[84:87]
s_waitcnt vmcnt(33)
v_perm_b32 v72, v41, v41, v20
v_perm_b32 v73, v41, v41, v21
v_perm_b32 v74, v41, v41, v22
v_perm_b32 v75, v41, v41, v23
s_nop 1
v_mfma_f32_16x16x32_bf16 v[80:83], v[72:75], a[236:239], v[80:83]
v_perm_b32 v76, v61, v61, v20
v_perm_b32 v77, v61, v61, v21
v_perm_b32 v78, v61, v61, v22
v_perm_b32 v79, v61, v61, v23
s_nop 1
v_mfma_f32_16x16x32_bf16 v[84:87], v[76:79], a[236:239], v[84:87]
v_lshlrev_b32 v5, 5, v8
v_and_b32 v6, 1, v9
v_lshl_add_u32 v6, v6, 4, v5
v_lshrrev_b32 v7, 5, v1
v_lshl_add_u32 v6, v7, 9, v6
s_lshl_b32 s6, s3, 11
s_add_u32 s6, s6, 147456
v_add_u32 v6, s6, v6
ds_write_b128 v6, v[80:83]
ds_write_b128 v6, v[84:87] offset:1024
v_add_u32 v5, 147456, v5
s_waitcnt lgkmcnt(0)
s_barrier
ds_read_b128 v[24:27], v5 offset:0
ds_read_b128 v[28:31], v5 offset:16
ds_read_b128 v[32:35], v5 offset:2048
ds_read_b128 v[36:39], v5 offset:2064
ds_read_b128 v[40:43], v5 offset:4096
ds_read_b128 v[44:47], v5 offset:4112
ds_read_b128 v[48:51], v5 offset:6144
ds_read_b128 v[52:55], v5 offset:6160
s_waitcnt lgkmcnt(0)
v_add_f32 v24, v24, v32
v_add_f32 v40, v40, v48
v_add_f32 v25, v25, v33
v_add_f32 v41, v41, v49
v_add_f32 v26, v26, v34
v_add_f32 v42, v42, v50
v_add_f32 v27, v27, v35
v_add_f32 v43, v43, v51
v_add_f32 v28, v28, v36
v_add_f32 v44, v44, v52
v_add_f32 v29, v29, v37
v_add_f32 v45, v45, v53
v_add_f32 v30, v30, v38
v_add_f32 v46, v46, v54
v_add_f32 v31, v31, v39
v_add_f32 v47, v47, v55
v_add_f32 v24, v24, v40
v_add_f32 v25, v25, v41
v_add_f32 v26, v26, v42
v_add_f32 v27, v27, v43
v_add_f32 v28, v28, v44
v_add_f32 v29, v29, v45
v_add_f32 v30, v30, v46
v_add_f32 v31, v31, v47
v_cvt_pk_bf16_f32 v216, v24, v25
v_cvt_pk_bf16_f32 v217, v26, v27
v_cvt_pk_bf16_f32 v218, v28, v29
v_cvt_pk_bf16_f32 v219, v30, v31
ds_read_b128 v[24:27], v5 offset:512
ds_read_b128 v[28:31], v5 offset:528
ds_read_b128 v[32:35], v5 offset:2560
ds_read_b128 v[36:39], v5 offset:2576
ds_read_b128 v[40:43], v5 offset:4608
ds_read_b128 v[44:47], v5 offset:4624
ds_read_b128 v[48:51], v5 offset:6656
ds_read_b128 v[52:55], v5 offset:6672
s_waitcnt lgkmcnt(0)
v_add_f32 v24, v24, v32
v_add_f32 v40, v40, v48
v_add_f32 v25, v25, v33
v_add_f32 v41, v41, v49
v_add_f32 v26, v26, v34
v_add_f32 v42, v42, v50
v_add_f32 v27, v27, v35
v_add_f32 v43, v43, v51
v_add_f32 v28, v28, v36
v_add_f32 v44, v44, v52
v_add_f32 v29, v29, v37
v_add_f32 v45, v45, v53
v_add_f32 v30, v30, v38
v_add_f32 v46, v46, v54
v_add_f32 v31, v31, v39
v_add_f32 v47, v47, v55
v_add_f32 v24, v24, v40
v_add_f32 v25, v25, v41
v_add_f32 v26, v26, v42
v_add_f32 v27, v27, v43
v_add_f32 v28, v28, v44
v_add_f32 v29, v29, v45
v_add_f32 v30, v30, v46
v_add_f32 v31, v31, v47
v_cvt_pk_bf16_f32 v220, v24, v25
v_cvt_pk_bf16_f32 v221, v26, v27
v_cvt_pk_bf16_f32 v222, v28, v29
v_cvt_pk_bf16_f32 v223, v30, v31
ds_read_b128 v[24:27], v5 offset:1024
ds_read_b128 v[28:31], v5 offset:1040
ds_read_b128 v[32:35], v5 offset:3072
ds_read_b128 v[36:39], v5 offset:3088
ds_read_b128 v[40:43], v5 offset:5120
ds_read_b128 v[44:47], v5 offset:5136
ds_read_b128 v[48:51], v5 offset:7168
ds_read_b128 v[52:55], v5 offset:7184
s_waitcnt lgkmcnt(0)
v_add_f32 v24, v24, v32
v_add_f32 v40, v40, v48
v_add_f32 v25, v25, v33
v_add_f32 v41, v41, v49
v_add_f32 v26, v26, v34
v_add_f32 v42, v42, v50
v_add_f32 v27, v27, v35
v_add_f32 v43, v43, v51
v_add_f32 v28, v28, v36
v_add_f32 v44, v44, v52
v_add_f32 v29, v29, v37
v_add_f32 v45, v45, v53
v_add_f32 v30, v30, v38
v_add_f32 v46, v46, v54
v_add_f32 v31, v31, v39
v_add_f32 v47, v47, v55
v_add_f32 v24, v24, v40
v_add_f32 v25, v25, v41
v_add_f32 v26, v26, v42
v_add_f32 v27, v27, v43
v_add_f32 v28, v28, v44
v_add_f32 v29, v29, v45
v_add_f32 v30, v30, v46
v_add_f32 v31, v31, v47
v_cvt_pk_bf16_f32 v224, v24, v25
v_cvt_pk_bf16_f32 v225, v26, v27
v_cvt_pk_bf16_f32 v226, v28, v29
v_cvt_pk_bf16_f32 v227, v30, v31
ds_read_b128 v[24:27], v5 offset:1536
ds_read_b128 v[28:31], v5 offset:1552
ds_read_b128 v[32:35], v5 offset:3584
ds_read_b128 v[36:39], v5 offset:3600
ds_read_b128 v[40:43], v5 offset:5632
ds_read_b128 v[44:47], v5 offset:5648
ds_read_b128 v[48:51], v5 offset:7680
ds_read_b128 v[52:55], v5 offset:7696
s_waitcnt lgkmcnt(0)
v_add_f32 v24, v24, v32
v_add_f32 v40, v40, v48
v_add_f32 v25, v25, v33
v_add_f32 v41, v41, v49
v_add_f32 v26, v26, v34
v_add_f32 v42, v42, v50
v_add_f32 v27, v27, v35
v_add_f32 v43, v43, v51
v_add_f32 v28, v28, v36
v_add_f32 v44, v44, v52
v_add_f32 v29, v29, v37
v_add_f32 v45, v45, v53
v_add_f32 v30, v30, v38
v_add_f32 v46, v46, v54
v_add_f32 v31, v31, v39
v_add_f32 v47, v47, v55
v_add_f32 v24, v24, v40
v_add_f32 v25, v25, v41
v_add_f32 v26, v26, v42
v_add_f32 v27, v27, v43
v_add_f32 v28, v28, v44
v_add_f32 v29, v29, v45
v_add_f32 v30, v30, v46
v_add_f32 v31, v31, v47
v_cvt_pk_bf16_f32 v228, v24, v25
v_cvt_pk_bf16_f32 v229, v26, v27
v_cvt_pk_bf16_f32 v230, v28, v29
v_cvt_pk_bf16_f32 v231, v30, v31
v_bfe_u32 v5, v1, 2, 2
v_mul_u32_u24 v5, 32768, v5
v_lshl_add_u32 v5, v9, 5, v5
v_and_b32 v6, 1, v1
v_lshl_add_u32 v5, v6, 4, v5
v_bfe_u32 v7, v1, 1, 1
v_lshl_add_u32 v5, v7, 7, v5
s_waitcnt vmcnt(32)
v_dot2_f32_bf16 v232, v88, v216, 0
v_dot2_f32_bf16 v233, v88, v220, 0
v_dot2_f32_bf16 v234, v88, v224, 0
v_dot2_f32_bf16 v235, v88, v228, 0
v_dot2_f32_bf16 v232, v89, v217, v232
v_dot2_f32_bf16 v233, v89, v221, v233
v_dot2_f32_bf16 v234, v89, v225, v234
v_dot2_f32_bf16 v235, v89, v229, v235
v_dot2_f32_bf16 v232, v90, v218, v232
v_dot2_f32_bf16 v233, v90, v222, v233
v_dot2_f32_bf16 v234, v90, v226, v234
v_dot2_f32_bf16 v235, v90, v230, v235
v_dot2_f32_bf16 v232, v91, v219, v232
v_dot2_f32_bf16 v233, v91, v223, v233
v_dot2_f32_bf16 v234, v91, v227, v234
v_dot2_f32_bf16 v235, v91, v231, v235
v_add_f32_dpp v236, v232, v232 row_ror:8 row_mask:0xf bank_mask:0x3
v_add_f32_dpp v237, v233, v233 row_ror:8 row_mask:0xf bank_mask:0x3
v_add_f32_dpp v236, v234, v234 row_ror:8 row_mask:0xf bank_mask:0xc
v_add_f32_dpp v237, v235, v235 row_ror:8 row_mask:0xf bank_mask:0xc
s_nop 0
v_add_f32_dpp v64, v236, v236 row_half_mirror row_mask:0xf bank_mask:0x5
v_add_f32_dpp v64, v237, v237 row_half_mirror row_mask:0xf bank_mask:0xa
s_nop 1
v_add_f32_dpp v64, v64, v64 quad_perm:[1,0,3,2] row_mask:0xf bank_mask:0xf
s_nop 1
v_add_f32_dpp v64, v64, v64 quad_perm:[2,3,0,1] row_mask:0xf bank_mask:0xf
s_waitcnt vmcnt(31)
v_dot2_f32_bf16 v232, v92, v216, 0
v_dot2_f32_bf16 v233, v92, v220, 0
v_dot2_f32_bf16 v234, v92, v224, 0
v_dot2_f32_bf16 v235, v92, v228, 0
v_dot2_f32_bf16 v232, v93, v217, v232
v_dot2_f32_bf16 v233, v93, v221, v233
v_dot2_f32_bf16 v234, v93, v225, v234
v_dot2_f32_bf16 v235, v93, v229, v235
v_dot2_f32_bf16 v232, v94, v218, v232
v_dot2_f32_bf16 v233, v94, v222, v233
v_dot2_f32_bf16 v234, v94, v226, v234
v_dot2_f32_bf16 v235, v94, v230, v235
v_dot2_f32_bf16 v232, v95, v219, v232
v_dot2_f32_bf16 v233, v95, v223, v233
v_dot2_f32_bf16 v234, v95, v227, v234
v_dot2_f32_bf16 v235, v95, v231, v235
v_add_f32_dpp v236, v232, v232 row_ror:8 row_mask:0xf bank_mask:0x3
v_add_f32_dpp v237, v233, v233 row_ror:8 row_mask:0xf bank_mask:0x3
v_add_f32_dpp v236, v234, v234 row_ror:8 row_mask:0xf bank_mask:0xc
v_add_f32_dpp v237, v235, v235 row_ror:8 row_mask:0xf bank_mask:0xc
s_nop 0
v_add_f32_dpp v65, v236, v236 row_half_mirror row_mask:0xf bank_mask:0x5
v_add_f32_dpp v65, v237, v237 row_half_mirror row_mask:0xf bank_mask:0xa
s_nop 1
v_add_f32_dpp v65, v65, v65 quad_perm:[1,0,3,2] row_mask:0xf bank_mask:0xf
s_nop 1
v_add_f32_dpp v65, v65, v65 quad_perm:[2,3,0,1] row_mask:0xf bank_mask:0xf
s_waitcnt vmcnt(30)
v_dot2_f32_bf16 v232, v96, v216, 0
v_dot2_f32_bf16 v233, v96, v220, 0
v_dot2_f32_bf16 v234, v96, v224, 0
v_dot2_f32_bf16 v235, v96, v228, 0
v_dot2_f32_bf16 v232, v97, v217, v232
v_dot2_f32_bf16 v233, v97, v221, v233
v_dot2_f32_bf16 v234, v97, v225, v234
v_dot2_f32_bf16 v235, v97, v229, v235
v_dot2_f32_bf16 v232, v98, v218, v232
v_dot2_f32_bf16 v233, v98, v222, v233
v_dot2_f32_bf16 v234, v98, v226, v234
v_dot2_f32_bf16 v235, v98, v230, v235
v_dot2_f32_bf16 v232, v99, v219, v232
v_dot2_f32_bf16 v233, v99, v223, v233
v_dot2_f32_bf16 v234, v99, v227, v234
v_dot2_f32_bf16 v235, v99, v231, v235
v_add_f32_dpp v236, v232, v232 row_ror:8 row_mask:0xf bank_mask:0x3
v_add_f32_dpp v237, v233, v233 row_ror:8 row_mask:0xf bank_mask:0x3
v_add_f32_dpp v236, v234, v234 row_ror:8 row_mask:0xf bank_mask:0xc
v_add_f32_dpp v237, v235, v235 row_ror:8 row_mask:0xf bank_mask:0xc
s_nop 0
v_add_f32_dpp v66, v236, v236 row_half_mirror row_mask:0xf bank_mask:0x5
v_add_f32_dpp v66, v237, v237 row_half_mirror row_mask:0xf bank_mask:0xa
s_nop 1
v_add_f32_dpp v66, v66, v66 quad_perm:[1,0,3,2] row_mask:0xf bank_mask:0xf
s_nop 1
v_add_f32_dpp v66, v66, v66 quad_perm:[2,3,0,1] row_mask:0xf bank_mask:0xf
s_waitcnt vmcnt(29)
v_dot2_f32_bf16 v232, v100, v216, 0
v_dot2_f32_bf16 v233, v100, v220, 0
v_dot2_f32_bf16 v234, v100, v224, 0
v_dot2_f32_bf16 v235, v100, v228, 0
v_dot2_f32_bf16 v232, v101, v217, v232
v_dot2_f32_bf16 v233, v101, v221, v233
v_dot2_f32_bf16 v234, v101, v225, v234
v_dot2_f32_bf16 v235, v101, v229, v235
v_dot2_f32_bf16 v232, v102, v218, v232
v_dot2_f32_bf16 v233, v102, v222, v233
v_dot2_f32_bf16 v234, v102, v226, v234
v_dot2_f32_bf16 v235, v102, v230, v235
v_dot2_f32_bf16 v232, v103, v219, v232
v_dot2_f32_bf16 v233, v103, v223, v233
v_dot2_f32_bf16 v234, v103, v227, v234
v_dot2_f32_bf16 v235, v103, v231, v235
v_add_f32_dpp v236, v232, v232 row_ror:8 row_mask:0xf bank_mask:0x3
v_add_f32_dpp v237, v233, v233 row_ror:8 row_mask:0xf bank_mask:0x3
v_add_f32_dpp v236, v234, v234 row_ror:8 row_mask:0xf bank_mask:0xc
v_add_f32_dpp v237, v235, v235 row_ror:8 row_mask:0xf bank_mask:0xc
s_nop 0
v_add_f32_dpp v67, v236, v236 row_half_mirror row_mask:0xf bank_mask:0x5
v_add_f32_dpp v67, v237, v237 row_half_mirror row_mask:0xf bank_mask:0xa
s_nop 1
v_add_f32_dpp v67, v67, v67 quad_perm:[1,0,3,2] row_mask:0xf bank_mask:0xf
s_nop 1
v_add_f32_dpp v67, v67, v67 quad_perm:[2,3,0,1] row_mask:0xf bank_mask:0xf
s_waitcnt vmcnt(28)
v_dot2_f32_bf16 v232, v104, v216, 0
v_dot2_f32_bf16 v233, v104, v220, 0
v_dot2_f32_bf16 v234, v104, v224, 0
v_dot2_f32_bf16 v235, v104, v228, 0
v_dot2_f32_bf16 v232, v105, v217, v232
v_dot2_f32_bf16 v233, v105, v221, v233
v_dot2_f32_bf16 v234, v105, v225, v234
v_dot2_f32_bf16 v235, v105, v229, v235
v_dot2_f32_bf16 v232, v106, v218, v232
v_dot2_f32_bf16 v233, v106, v222, v233
v_dot2_f32_bf16 v234, v106, v226, v234
v_dot2_f32_bf16 v235, v106, v230, v235
v_dot2_f32_bf16 v232, v107, v219, v232
v_dot2_f32_bf16 v233, v107, v223, v233
v_dot2_f32_bf16 v234, v107, v227, v234
v_dot2_f32_bf16 v235, v107, v231, v235
v_add_f32_dpp v236, v232, v232 row_ror:8 row_mask:0xf bank_mask:0x3
v_add_f32_dpp v237, v233, v233 row_ror:8 row_mask:0xf bank_mask:0x3
v_add_f32_dpp v236, v234, v234 row_ror:8 row_mask:0xf bank_mask:0xc
v_add_f32_dpp v237, v235, v235 row_ror:8 row_mask:0xf bank_mask:0xc
s_nop 0
v_add_f32_dpp v68, v236, v236 row_half_mirror row_mask:0xf bank_mask:0x5
v_add_f32_dpp v68, v237, v237 row_half_mirror row_mask:0xf bank_mask:0xa
s_nop 1
v_add_f32_dpp v68, v68, v68 quad_perm:[1,0,3,2] row_mask:0xf bank_mask:0xf
s_nop 1
v_add_f32_dpp v68, v68, v68 quad_perm:[2,3,0,1] row_mask:0xf bank_mask:0xf
s_waitcnt vmcnt(27)
v_dot2_f32_bf16 v232, v108, v216, 0
v_dot2_f32_bf16 v233, v108, v220, 0
v_dot2_f32_bf16 v234, v108, v224, 0
v_dot2_f32_bf16 v235, v108, v228, 0
v_dot2_f32_bf16 v232, v109, v217, v232
v_dot2_f32_bf16 v233, v109, v221, v233
v_dot2_f32_bf16 v234, v109, v225, v234
v_dot2_f32_bf16 v235, v109, v229, v235
v_dot2_f32_bf16 v232, v110, v218, v232
v_dot2_f32_bf16 v233, v110, v222, v233
v_dot2_f32_bf16 v234, v110, v226, v234
v_dot2_f32_bf16 v235, v110, v230, v235
v_dot2_f32_bf16 v232, v111, v219, v232
v_dot2_f32_bf16 v233, v111, v223, v233
v_dot2_f32_bf16 v234, v111, v227, v234
v_dot2_f32_bf16 v235, v111, v231, v235
v_add_f32_dpp v236, v232, v232 row_ror:8 row_mask:0xf bank_mask:0x3
v_add_f32_dpp v237, v233, v233 row_ror:8 row_mask:0xf bank_mask:0x3
v_add_f32_dpp v236, v234, v234 row_ror:8 row_mask:0xf bank_mask:0xc
v_add_f32_dpp v237, v235, v235 row_ror:8 row_mask:0xf bank_mask:0xc
s_nop 0
v_add_f32_dpp v69, v236, v236 row_half_mirror row_mask:0xf bank_mask:0x5
v_add_f32_dpp v69, v237, v237 row_half_mirror row_mask:0xf bank_mask:0xa
s_nop 1
v_add_f32_dpp v69, v69, v69 quad_perm:[1,0,3,2] row_mask:0xf bank_mask:0xf
s_nop 1
v_add_f32_dpp v69, v69, v69 quad_perm:[2,3,0,1] row_mask:0xf bank_mask:0xf
s_waitcnt vmcnt(26)
v_dot2_f32_bf16 v232, v112, v216, 0
v_dot2_f32_bf16 v233, v112, v220, 0
v_dot2_f32_bf16 v234, v112, v224, 0
v_dot2_f32_bf16 v235, v112, v228, 0
v_dot2_f32_bf16 v232, v113, v217, v232
v_dot2_f32_bf16 v233, v113, v221, v233
v_dot2_f32_bf16 v234, v113, v225, v234
v_dot2_f32_bf16 v235, v113, v229, v235
v_dot2_f32_bf16 v232, v114, v218, v232
v_dot2_f32_bf16 v233, v114, v222, v233
v_dot2_f32_bf16 v234, v114, v226, v234
v_dot2_f32_bf16 v235, v114, v230, v235
v_dot2_f32_bf16 v232, v115, v219, v232
v_dot2_f32_bf16 v233, v115, v223, v233
v_dot2_f32_bf16 v234, v115, v227, v234
v_dot2_f32_bf16 v235, v115, v231, v235
v_add_f32_dpp v236, v232, v232 row_ror:8 row_mask:0xf bank_mask:0x3
v_add_f32_dpp v237, v233, v233 row_ror:8 row_mask:0xf bank_mask:0x3
v_add_f32_dpp v236, v234, v234 row_ror:8 row_mask:0xf bank_mask:0xc
v_add_f32_dpp v237, v235, v235 row_ror:8 row_mask:0xf bank_mask:0xc
s_nop 0
v_add_f32_dpp v70, v236, v236 row_half_mirror row_mask:0xf bank_mask:0x5
v_add_f32_dpp v70, v237, v237 row_half_mirror row_mask:0xf bank_mask:0xa
s_nop 1
v_add_f32_dpp v70, v70, v70 quad_perm:[1,0,3,2] row_mask:0xf bank_mask:0xf
s_nop 1
v_add_f32_dpp v70, v70, v70 quad_perm:[2,3,0,1] row_mask:0xf bank_mask:0xf
s_waitcnt vmcnt(25)
v_dot2_f32_bf16 v232, v116, v216, 0
v_dot2_f32_bf16 v233, v116, v220, 0
v_dot2_f32_bf16 v234, v116, v224, 0
v_dot2_f32_bf16 v235, v116, v228, 0
v_dot2_f32_bf16 v232, v117, v217, v232
v_dot2_f32_bf16 v233, v117, v221, v233
v_dot2_f32_bf16 v234, v117, v225, v234
v_dot2_f32_bf16 v235, v117, v229, v235
v_dot2_f32_bf16 v232, v118, v218, v232
v_dot2_f32_bf16 v233, v118, v222, v233
v_dot2_f32_bf16 v234, v118, v226, v234
v_dot2_f32_bf16 v235, v118, v230, v235
v_dot2_f32_bf16 v232, v119, v219, v232
v_dot2_f32_bf16 v233, v119, v223, v233
v_dot2_f32_bf16 v234, v119, v227, v234
v_dot2_f32_bf16 v235, v119, v231, v235
v_add_f32_dpp v236, v232, v232 row_ror:8 row_mask:0xf bank_mask:0x3
v_add_f32_dpp v237, v233, v233 row_ror:8 row_mask:0xf bank_mask:0x3
v_add_f32_dpp v236, v234, v234 row_ror:8 row_mask:0xf bank_mask:0xc
v_add_f32_dpp v237, v235, v235 row_ror:8 row_mask:0xf bank_mask:0xc
s_nop 0
v_add_f32_dpp v71, v236, v236 row_half_mirror row_mask:0xf bank_mask:0x5
v_add_f32_dpp v71, v237, v237 row_half_mirror row_mask:0xf bank_mask:0xa
s_nop 1
v_add_f32_dpp v71, v71, v71 quad_perm:[1,0,3,2] row_mask:0xf bank_mask:0xf
s_nop 1
v_add_f32_dpp v71, v71, v71 quad_perm:[2,3,0,1] row_mask:0xf bank_mask:0xf
s_waitcnt vmcnt(24)
v_dot2_f32_bf16 v232, v120, v216, 0
v_dot2_f32_bf16 v233, v120, v220, 0
v_dot2_f32_bf16 v234, v120, v224, 0
v_dot2_f32_bf16 v235, v120, v228, 0
v_dot2_f32_bf16 v232, v121, v217, v232
v_dot2_f32_bf16 v233, v121, v221, v233
v_dot2_f32_bf16 v234, v121, v225, v234
v_dot2_f32_bf16 v235, v121, v229, v235
v_dot2_f32_bf16 v232, v122, v218, v232
v_dot2_f32_bf16 v233, v122, v222, v233
v_dot2_f32_bf16 v234, v122, v226, v234
v_dot2_f32_bf16 v235, v122, v230, v235
v_dot2_f32_bf16 v232, v123, v219, v232
v_dot2_f32_bf16 v233, v123, v223, v233
v_dot2_f32_bf16 v234, v123, v227, v234
v_dot2_f32_bf16 v235, v123, v231, v235
v_add_f32_dpp v236, v232, v232 row_ror:8 row_mask:0xf bank_mask:0x3
v_add_f32_dpp v237, v233, v233 row_ror:8 row_mask:0xf bank_mask:0x3
v_add_f32_dpp v236, v234, v234 row_ror:8 row_mask:0xf bank_mask:0xc
v_add_f32_dpp v237, v235, v235 row_ror:8 row_mask:0xf bank_mask:0xc
s_nop 0
v_add_f32_dpp v72, v236, v236 row_half_mirror row_mask:0xf bank_mask:0x5
v_add_f32_dpp v72, v237, v237 row_half_mirror row_mask:0xf bank_mask:0xa
s_nop 1
v_add_f32_dpp v72, v72, v72 quad_perm:[1,0,3,2] row_mask:0xf bank_mask:0xf
s_nop 1
v_add_f32_dpp v72, v72, v72 quad_perm:[2,3,0,1] row_mask:0xf bank_mask:0xf
s_waitcnt vmcnt(23)
v_dot2_f32_bf16 v232, v124, v216, 0
v_dot2_f32_bf16 v233, v124, v220, 0
v_dot2_f32_bf16 v234, v124, v224, 0
v_dot2_f32_bf16 v235, v124, v228, 0
v_dot2_f32_bf16 v232, v125, v217, v232
v_dot2_f32_bf16 v233, v125, v221, v233
v_dot2_f32_bf16 v234, v125, v225, v234
v_dot2_f32_bf16 v235, v125, v229, v235
v_dot2_f32_bf16 v232, v126, v218, v232
v_dot2_f32_bf16 v233, v126, v222, v233
v_dot2_f32_bf16 v234, v126, v226, v234
v_dot2_f32_bf16 v235, v126, v230, v235
v_dot2_f32_bf16 v232, v127, v219, v232
v_dot2_f32_bf16 v233, v127, v223, v233
v_dot2_f32_bf16 v234, v127, v227, v234
v_dot2_f32_bf16 v235, v127, v231, v235
v_add_f32_dpp v236, v232, v232 row_ror:8 row_mask:0xf bank_mask:0x3
v_add_f32_dpp v237, v233, v233 row_ror:8 row_mask:0xf bank_mask:0x3
v_add_f32_dpp v236, v234, v234 row_ror:8 row_mask:0xf bank_mask:0xc
v_add_f32_dpp v237, v235, v235 row_ror:8 row_mask:0xf bank_mask:0xc
s_nop 0
v_add_f32_dpp v73, v236, v236 row_half_mirror row_mask:0xf bank_mask:0x5
v_add_f32_dpp v73, v237, v237 row_half_mirror row_mask:0xf bank_mask:0xa
s_nop 1
v_add_f32_dpp v73, v73, v73 quad_perm:[1,0,3,2] row_mask:0xf bank_mask:0xf
s_nop 1
v_add_f32_dpp v73, v73, v73 quad_perm:[2,3,0,1] row_mask:0xf bank_mask:0xf
s_waitcnt vmcnt(22)
v_dot2_f32_bf16 v232, v128, v216, 0
v_dot2_f32_bf16 v233, v128, v220, 0
v_dot2_f32_bf16 v234, v128, v224, 0
v_dot2_f32_bf16 v235, v128, v228, 0
v_dot2_f32_bf16 v232, v129, v217, v232
v_dot2_f32_bf16 v233, v129, v221, v233
v_dot2_f32_bf16 v234, v129, v225, v234
v_dot2_f32_bf16 v235, v129, v229, v235
v_dot2_f32_bf16 v232, v130, v218, v232
v_dot2_f32_bf16 v233, v130, v222, v233
v_dot2_f32_bf16 v234, v130, v226, v234
v_dot2_f32_bf16 v235, v130, v230, v235
v_dot2_f32_bf16 v232, v131, v219, v232
v_dot2_f32_bf16 v233, v131, v223, v233
v_dot2_f32_bf16 v234, v131, v227, v234
v_dot2_f32_bf16 v235, v131, v231, v235
v_add_f32_dpp v236, v232, v232 row_ror:8 row_mask:0xf bank_mask:0x3
v_add_f32_dpp v237, v233, v233 row_ror:8 row_mask:0xf bank_mask:0x3
v_add_f32_dpp v236, v234, v234 row_ror:8 row_mask:0xf bank_mask:0xc
v_add_f32_dpp v237, v235, v235 row_ror:8 row_mask:0xf bank_mask:0xc
s_nop 0
v_add_f32_dpp v74, v236, v236 row_half_mirror row_mask:0xf bank_mask:0x5
v_add_f32_dpp v74, v237, v237 row_half_mirror row_mask:0xf bank_mask:0xa
s_nop 1
v_add_f32_dpp v74, v74, v74 quad_perm:[1,0,3,2] row_mask:0xf bank_mask:0xf
s_nop 1
v_add_f32_dpp v74, v74, v74 quad_perm:[2,3,0,1] row_mask:0xf bank_mask:0xf
s_waitcnt vmcnt(21)
v_dot2_f32_bf16 v232, v132, v216, 0
v_dot2_f32_bf16 v233, v132, v220, 0
v_dot2_f32_bf16 v234, v132, v224, 0
v_dot2_f32_bf16 v235, v132, v228, 0
v_dot2_f32_bf16 v232, v133, v217, v232
v_dot2_f32_bf16 v233, v133, v221, v233
v_dot2_f32_bf16 v234, v133, v225, v234
v_dot2_f32_bf16 v235, v133, v229, v235
v_dot2_f32_bf16 v232, v134, v218, v232
v_dot2_f32_bf16 v233, v134, v222, v233
v_dot2_f32_bf16 v234, v134, v226, v234
v_dot2_f32_bf16 v235, v134, v230, v235
v_dot2_f32_bf16 v232, v135, v219, v232
v_dot2_f32_bf16 v233, v135, v223, v233
v_dot2_f32_bf16 v234, v135, v227, v234
v_dot2_f32_bf16 v235, v135, v231, v235
v_add_f32_dpp v236, v232, v232 row_ror:8 row_mask:0xf bank_mask:0x3
v_add_f32_dpp v237, v233, v233 row_ror:8 row_mask:0xf bank_mask:0x3
v_add_f32_dpp v236, v234, v234 row_ror:8 row_mask:0xf bank_mask:0xc
v_add_f32_dpp v237, v235, v235 row_ror:8 row_mask:0xf bank_mask:0xc
s_nop 0
v_add_f32_dpp v75, v236, v236 row_half_mirror row_mask:0xf bank_mask:0x5
v_add_f32_dpp v75, v237, v237 row_half_mirror row_mask:0xf bank_mask:0xa
s_nop 1
v_add_f32_dpp v75, v75, v75 quad_perm:[1,0,3,2] row_mask:0xf bank_mask:0xf
s_nop 1
v_add_f32_dpp v75, v75, v75 quad_perm:[2,3,0,1] row_mask:0xf bank_mask:0xf
s_waitcnt vmcnt(20)
v_dot2_f32_bf16 v232, v136, v216, 0
v_dot2_f32_bf16 v233, v136, v220, 0
v_dot2_f32_bf16 v234, v136, v224, 0
v_dot2_f32_bf16 v235, v136, v228, 0
v_dot2_f32_bf16 v232, v137, v217, v232
v_dot2_f32_bf16 v233, v137, v221, v233
v_dot2_f32_bf16 v234, v137, v225, v234
v_dot2_f32_bf16 v235, v137, v229, v235
v_dot2_f32_bf16 v232, v138, v218, v232
v_dot2_f32_bf16 v233, v138, v222, v233
v_dot2_f32_bf16 v234, v138, v226, v234
v_dot2_f32_bf16 v235, v138, v230, v235
v_dot2_f32_bf16 v232, v139, v219, v232
v_dot2_f32_bf16 v233, v139, v223, v233
v_dot2_f32_bf16 v234, v139, v227, v234
v_dot2_f32_bf16 v235, v139, v231, v235
v_add_f32_dpp v236, v232, v232 row_ror:8 row_mask:0xf bank_mask:0x3
v_add_f32_dpp v237, v233, v233 row_ror:8 row_mask:0xf bank_mask:0x3
v_add_f32_dpp v236, v234, v234 row_ror:8 row_mask:0xf bank_mask:0xc
v_add_f32_dpp v237, v235, v235 row_ror:8 row_mask:0xf bank_mask:0xc
s_nop 0
v_add_f32_dpp v76, v236, v236 row_half_mirror row_mask:0xf bank_mask:0x5
v_add_f32_dpp v76, v237, v237 row_half_mirror row_mask:0xf bank_mask:0xa
s_nop 1
v_add_f32_dpp v76, v76, v76 quad_perm:[1,0,3,2] row_mask:0xf bank_mask:0xf
s_nop 1
v_add_f32_dpp v76, v76, v76 quad_perm:[2,3,0,1] row_mask:0xf bank_mask:0xf
s_waitcnt vmcnt(19)
v_dot2_f32_bf16 v232, v140, v216, 0
v_dot2_f32_bf16 v233, v140, v220, 0
v_dot2_f32_bf16 v234, v140, v224, 0
v_dot2_f32_bf16 v235, v140, v228, 0
v_dot2_f32_bf16 v232, v141, v217, v232
v_dot2_f32_bf16 v233, v141, v221, v233
v_dot2_f32_bf16 v234, v141, v225, v234
v_dot2_f32_bf16 v235, v141, v229, v235
v_dot2_f32_bf16 v232, v142, v218, v232
v_dot2_f32_bf16 v233, v142, v222, v233
v_dot2_f32_bf16 v234, v142, v226, v234
v_dot2_f32_bf16 v235, v142, v230, v235
v_dot2_f32_bf16 v232, v143, v219, v232
v_dot2_f32_bf16 v233, v143, v223, v233
v_dot2_f32_bf16 v234, v143, v227, v234
v_dot2_f32_bf16 v235, v143, v231, v235
v_add_f32_dpp v236, v232, v232 row_ror:8 row_mask:0xf bank_mask:0x3
v_add_f32_dpp v237, v233, v233 row_ror:8 row_mask:0xf bank_mask:0x3
v_add_f32_dpp v236, v234, v234 row_ror:8 row_mask:0xf bank_mask:0xc
v_add_f32_dpp v237, v235, v235 row_ror:8 row_mask:0xf bank_mask:0xc
s_nop 0
v_add_f32_dpp v77, v236, v236 row_half_mirror row_mask:0xf bank_mask:0x5
v_add_f32_dpp v77, v237, v237 row_half_mirror row_mask:0xf bank_mask:0xa
s_nop 1
v_add_f32_dpp v77, v77, v77 quad_perm:[1,0,3,2] row_mask:0xf bank_mask:0xf
s_nop 1
v_add_f32_dpp v77, v77, v77 quad_perm:[2,3,0,1] row_mask:0xf bank_mask:0xf
s_waitcnt vmcnt(18)
v_dot2_f32_bf16 v232, v144, v216, 0
v_dot2_f32_bf16 v233, v144, v220, 0
v_dot2_f32_bf16 v234, v144, v224, 0
v_dot2_f32_bf16 v235, v144, v228, 0
v_dot2_f32_bf16 v232, v145, v217, v232
v_dot2_f32_bf16 v233, v145, v221, v233
v_dot2_f32_bf16 v234, v145, v225, v234
v_dot2_f32_bf16 v235, v145, v229, v235
v_dot2_f32_bf16 v232, v146, v218, v232
v_dot2_f32_bf16 v233, v146, v222, v233
v_dot2_f32_bf16 v234, v146, v226, v234
v_dot2_f32_bf16 v235, v146, v230, v235
v_dot2_f32_bf16 v232, v147, v219, v232
v_dot2_f32_bf16 v233, v147, v223, v233
v_dot2_f32_bf16 v234, v147, v227, v234
v_dot2_f32_bf16 v235, v147, v231, v235
v_add_f32_dpp v236, v232, v232 row_ror:8 row_mask:0xf bank_mask:0x3
v_add_f32_dpp v237, v233, v233 row_ror:8 row_mask:0xf bank_mask:0x3
v_add_f32_dpp v236, v234, v234 row_ror:8 row_mask:0xf bank_mask:0xc
v_add_f32_dpp v237, v235, v235 row_ror:8 row_mask:0xf bank_mask:0xc
s_nop 0
v_add_f32_dpp v78, v236, v236 row_half_mirror row_mask:0xf bank_mask:0x5
v_add_f32_dpp v78, v237, v237 row_half_mirror row_mask:0xf bank_mask:0xa
s_nop 1
v_add_f32_dpp v78, v78, v78 quad_perm:[1,0,3,2] row_mask:0xf bank_mask:0xf
s_nop 1
v_add_f32_dpp v78, v78, v78 quad_perm:[2,3,0,1] row_mask:0xf bank_mask:0xf
s_waitcnt vmcnt(17)
v_dot2_f32_bf16 v232, v148, v216, 0
v_dot2_f32_bf16 v233, v148, v220, 0
v_dot2_f32_bf16 v234, v148, v224, 0
v_dot2_f32_bf16 v235, v148, v228, 0
v_dot2_f32_bf16 v232, v149, v217, v232
v_dot2_f32_bf16 v233, v149, v221, v233
v_dot2_f32_bf16 v234, v149, v225, v234
v_dot2_f32_bf16 v235, v149, v229, v235
v_dot2_f32_bf16 v232, v150, v218, v232
v_dot2_f32_bf16 v233, v150, v222, v233
v_dot2_f32_bf16 v234, v150, v226, v234
v_dot2_f32_bf16 v235, v150, v230, v235
v_dot2_f32_bf16 v232, v151, v219, v232
v_dot2_f32_bf16 v233, v151, v223, v233
v_dot2_f32_bf16 v234, v151, v227, v234
v_dot2_f32_bf16 v235, v151, v231, v235
v_add_f32_dpp v236, v232, v232 row_ror:8 row_mask:0xf bank_mask:0x3
v_add_f32_dpp v237, v233, v233 row_ror:8 row_mask:0xf bank_mask:0x3
v_add_f32_dpp v236, v234, v234 row_ror:8 row_mask:0xf bank_mask:0xc
v_add_f32_dpp v237, v235, v235 row_ror:8 row_mask:0xf bank_mask:0xc
s_nop 0
v_add_f32_dpp v79, v236, v236 row_half_mirror row_mask:0xf bank_mask:0x5
v_add_f32_dpp v79, v237, v237 row_half_mirror row_mask:0xf bank_mask:0xa
s_nop 1
v_add_f32_dpp v79, v79, v79 quad_perm:[1,0,3,2] row_mask:0xf bank_mask:0xf
s_nop 1
v_add_f32_dpp v79, v79, v79 quad_perm:[2,3,0,1] row_mask:0xf bank_mask:0xf
v_cvt_pk_bf16_f32 v24, v64, v65
v_cvt_pk_bf16_f32 v25, v66, v67
v_cvt_pk_bf16_f32 v26, v68, v69
v_cvt_pk_bf16_f32 v27, v70, v71
v_cvt_pk_bf16_f32 v28, v72, v73
v_cvt_pk_bf16_f32 v29, v74, v75
v_cvt_pk_bf16_f32 v30, v76, v77
v_cvt_pk_bf16_f32 v31, v78, v79
v_cmp_eq_u32 vcc, 1, v6
s_nop 1
v_cndmask_b32 v244, v24, v28, vcc
v_cndmask_b32 v245, v25, v29, vcc
v_cndmask_b32 v246, v26, v30, vcc
v_cndmask_b32 v247, v27, v31, vcc
s_waitcnt vmcnt(16)
v_dot2_f32_bf16 v232, v152, v216, 0
v_dot2_f32_bf16 v233, v152, v220, 0
v_dot2_f32_bf16 v234, v152, v224, 0
v_dot2_f32_bf16 v235, v152, v228, 0
v_dot2_f32_bf16 v232, v153, v217, v232
v_dot2_f32_bf16 v233, v153, v221, v233
v_dot2_f32_bf16 v234, v153, v225, v234
v_dot2_f32_bf16 v235, v153, v229, v235
v_dot2_f32_bf16 v232, v154, v218, v232
v_dot2_f32_bf16 v233, v154, v222, v233
v_dot2_f32_bf16 v234, v154, v226, v234
v_dot2_f32_bf16 v235, v154, v230, v235
v_dot2_f32_bf16 v232, v155, v219, v232
v_dot2_f32_bf16 v233, v155, v223, v233
v_dot2_f32_bf16 v234, v155, v227, v234
v_dot2_f32_bf16 v235, v155, v231, v235
v_add_f32_dpp v236, v232, v232 row_ror:8 row_mask:0xf bank_mask:0x3
v_add_f32_dpp v237, v233, v233 row_ror:8 row_mask:0xf bank_mask:0x3
v_add_f32_dpp v236, v234, v234 row_ror:8 row_mask:0xf bank_mask:0xc
v_add_f32_dpp v237, v235, v235 row_ror:8 row_mask:0xf bank_mask:0xc
s_nop 0
v_add_f32_dpp v64, v236, v236 row_half_mirror row_mask:0xf bank_mask:0x5
v_add_f32_dpp v64, v237, v237 row_half_mirror row_mask:0xf bank_mask:0xa
s_nop 1
v_add_f32_dpp v64, v64, v64 quad_perm:[1,0,3,2] row_mask:0xf bank_mask:0xf
s_nop 1
v_add_f32_dpp v64, v64, v64 quad_perm:[2,3,0,1] row_mask:0xf bank_mask:0xf
s_waitcnt vmcnt(15)
v_dot2_f32_bf16 v232, v156, v216, 0
v_dot2_f32_bf16 v233, v156, v220, 0
v_dot2_f32_bf16 v234, v156, v224, 0
v_dot2_f32_bf16 v235, v156, v228, 0
v_dot2_f32_bf16 v232, v157, v217, v232
v_dot2_f32_bf16 v233, v157, v221, v233
v_dot2_f32_bf16 v234, v157, v225, v234
v_dot2_f32_bf16 v235, v157, v229, v235
v_dot2_f32_bf16 v232, v158, v218, v232
v_dot2_f32_bf16 v233, v158, v222, v233
v_dot2_f32_bf16 v234, v158, v226, v234
v_dot2_f32_bf16 v235, v158, v230, v235
v_dot2_f32_bf16 v232, v159, v219, v232
v_dot2_f32_bf16 v233, v159, v223, v233
v_dot2_f32_bf16 v234, v159, v227, v234
v_dot2_f32_bf16 v235, v159, v231, v235
v_add_f32_dpp v236, v232, v232 row_ror:8 row_mask:0xf bank_mask:0x3
v_add_f32_dpp v237, v233, v233 row_ror:8 row_mask:0xf bank_mask:0x3
v_add_f32_dpp v236, v234, v234 row_ror:8 row_mask:0xf bank_mask:0xc
v_add_f32_dpp v237, v235, v235 row_ror:8 row_mask:0xf bank_mask:0xc
s_nop 0
v_add_f32_dpp v65, v236, v236 row_half_mirror row_mask:0xf bank_mask:0x5
v_add_f32_dpp v65, v237, v237 row_half_mirror row_mask:0xf bank_mask:0xa
s_nop 1
v_add_f32_dpp v65, v65, v65 quad_perm:[1,0,3,2] row_mask:0xf bank_mask:0xf
s_nop 1
v_add_f32_dpp v65, v65, v65 quad_perm:[2,3,0,1] row_mask:0xf bank_mask:0xf
s_waitcnt vmcnt(14)
v_dot2_f32_bf16 v232, v160, v216, 0
v_dot2_f32_bf16 v233, v160, v220, 0
v_dot2_f32_bf16 v234, v160, v224, 0
v_dot2_f32_bf16 v235, v160, v228, 0
v_dot2_f32_bf16 v232, v161, v217, v232
v_dot2_f32_bf16 v233, v161, v221, v233
v_dot2_f32_bf16 v234, v161, v225, v234
v_dot2_f32_bf16 v235, v161, v229, v235
v_dot2_f32_bf16 v232, v162, v218, v232
v_dot2_f32_bf16 v233, v162, v222, v233
v_dot2_f32_bf16 v234, v162, v226, v234
v_dot2_f32_bf16 v235, v162, v230, v235
v_dot2_f32_bf16 v232, v163, v219, v232
v_dot2_f32_bf16 v233, v163, v223, v233
v_dot2_f32_bf16 v234, v163, v227, v234
v_dot2_f32_bf16 v235, v163, v231, v235
v_add_f32_dpp v236, v232, v232 row_ror:8 row_mask:0xf bank_mask:0x3
v_add_f32_dpp v237, v233, v233 row_ror:8 row_mask:0xf bank_mask:0x3
v_add_f32_dpp v236, v234, v234 row_ror:8 row_mask:0xf bank_mask:0xc
v_add_f32_dpp v237, v235, v235 row_ror:8 row_mask:0xf bank_mask:0xc
s_nop 0
v_add_f32_dpp v66, v236, v236 row_half_mirror row_mask:0xf bank_mask:0x5
v_add_f32_dpp v66, v237, v237 row_half_mirror row_mask:0xf bank_mask:0xa
s_nop 1
v_add_f32_dpp v66, v66, v66 quad_perm:[1,0,3,2] row_mask:0xf bank_mask:0xf
s_nop 1
v_add_f32_dpp v66, v66, v66 quad_perm:[2,3,0,1] row_mask:0xf bank_mask:0xf
s_waitcnt vmcnt(13)
v_dot2_f32_bf16 v232, v164, v216, 0
v_dot2_f32_bf16 v233, v164, v220, 0
v_dot2_f32_bf16 v234, v164, v224, 0
v_dot2_f32_bf16 v235, v164, v228, 0
v_dot2_f32_bf16 v232, v165, v217, v232
v_dot2_f32_bf16 v233, v165, v221, v233
v_dot2_f32_bf16 v234, v165, v225, v234
v_dot2_f32_bf16 v235, v165, v229, v235
v_dot2_f32_bf16 v232, v166, v218, v232
v_dot2_f32_bf16 v233, v166, v222, v233
v_dot2_f32_bf16 v234, v166, v226, v234
v_dot2_f32_bf16 v235, v166, v230, v235
v_dot2_f32_bf16 v232, v167, v219, v232
v_dot2_f32_bf16 v233, v167, v223, v233
v_dot2_f32_bf16 v234, v167, v227, v234
v_dot2_f32_bf16 v235, v167, v231, v235
v_add_f32_dpp v236, v232, v232 row_ror:8 row_mask:0xf bank_mask:0x3
v_add_f32_dpp v237, v233, v233 row_ror:8 row_mask:0xf bank_mask:0x3
v_add_f32_dpp v236, v234, v234 row_ror:8 row_mask:0xf bank_mask:0xc
v_add_f32_dpp v237, v235, v235 row_ror:8 row_mask:0xf bank_mask:0xc
s_nop 0
v_add_f32_dpp v67, v236, v236 row_half_mirror row_mask:0xf bank_mask:0x5
v_add_f32_dpp v67, v237, v237 row_half_mirror row_mask:0xf bank_mask:0xa
s_nop 1
v_add_f32_dpp v67, v67, v67 quad_perm:[1,0,3,2] row_mask:0xf bank_mask:0xf
s_nop 1
v_add_f32_dpp v67, v67, v67 quad_perm:[2,3,0,1] row_mask:0xf bank_mask:0xf
s_waitcnt vmcnt(12)
v_dot2_f32_bf16 v232, v168, v216, 0
v_dot2_f32_bf16 v233, v168, v220, 0
v_dot2_f32_bf16 v234, v168, v224, 0
v_dot2_f32_bf16 v235, v168, v228, 0
v_dot2_f32_bf16 v232, v169, v217, v232
v_dot2_f32_bf16 v233, v169, v221, v233
v_dot2_f32_bf16 v234, v169, v225, v234
v_dot2_f32_bf16 v235, v169, v229, v235
v_dot2_f32_bf16 v232, v170, v218, v232
v_dot2_f32_bf16 v233, v170, v222, v233
v_dot2_f32_bf16 v234, v170, v226, v234
v_dot2_f32_bf16 v235, v170, v230, v235
v_dot2_f32_bf16 v232, v171, v219, v232
v_dot2_f32_bf16 v233, v171, v223, v233
v_dot2_f32_bf16 v234, v171, v227, v234
v_dot2_f32_bf16 v235, v171, v231, v235
v_add_f32_dpp v236, v232, v232 row_ror:8 row_mask:0xf bank_mask:0x3
v_add_f32_dpp v237, v233, v233 row_ror:8 row_mask:0xf bank_mask:0x3
v_add_f32_dpp v236, v234, v234 row_ror:8 row_mask:0xf bank_mask:0xc
v_add_f32_dpp v237, v235, v235 row_ror:8 row_mask:0xf bank_mask:0xc
s_nop 0
v_add_f32_dpp v68, v236, v236 row_half_mirror row_mask:0xf bank_mask:0x5
v_add_f32_dpp v68, v237, v237 row_half_mirror row_mask:0xf bank_mask:0xa
s_nop 1
v_add_f32_dpp v68, v68, v68 quad_perm:[1,0,3,2] row_mask:0xf bank_mask:0xf
s_nop 1
v_add_f32_dpp v68, v68, v68 quad_perm:[2,3,0,1] row_mask:0xf bank_mask:0xf
s_waitcnt vmcnt(11)
v_dot2_f32_bf16 v232, v172, v216, 0
v_dot2_f32_bf16 v233, v172, v220, 0
v_dot2_f32_bf16 v234, v172, v224, 0
v_dot2_f32_bf16 v235, v172, v228, 0
v_dot2_f32_bf16 v232, v173, v217, v232
v_dot2_f32_bf16 v233, v173, v221, v233
v_dot2_f32_bf16 v234, v173, v225, v234
v_dot2_f32_bf16 v235, v173, v229, v235
v_dot2_f32_bf16 v232, v174, v218, v232
v_dot2_f32_bf16 v233, v174, v222, v233
v_dot2_f32_bf16 v234, v174, v226, v234
v_dot2_f32_bf16 v235, v174, v230, v235
v_dot2_f32_bf16 v232, v175, v219, v232
v_dot2_f32_bf16 v233, v175, v223, v233
v_dot2_f32_bf16 v234, v175, v227, v234
v_dot2_f32_bf16 v235, v175, v231, v235
v_add_f32_dpp v236, v232, v232 row_ror:8 row_mask:0xf bank_mask:0x3
v_add_f32_dpp v237, v233, v233 row_ror:8 row_mask:0xf bank_mask:0x3
v_add_f32_dpp v236, v234, v234 row_ror:8 row_mask:0xf bank_mask:0xc
v_add_f32_dpp v237, v235, v235 row_ror:8 row_mask:0xf bank_mask:0xc
s_nop 0
v_add_f32_dpp v69, v236, v236 row_half_mirror row_mask:0xf bank_mask:0x5
v_add_f32_dpp v69, v237, v237 row_half_mirror row_mask:0xf bank_mask:0xa
s_nop 1
v_add_f32_dpp v69, v69, v69 quad_perm:[1,0,3,2] row_mask:0xf bank_mask:0xf
s_nop 1
v_add_f32_dpp v69, v69, v69 quad_perm:[2,3,0,1] row_mask:0xf bank_mask:0xf
s_waitcnt vmcnt(10)
v_dot2_f32_bf16 v232, v176, v216, 0
v_dot2_f32_bf16 v233, v176, v220, 0
v_dot2_f32_bf16 v234, v176, v224, 0
v_dot2_f32_bf16 v235, v176, v228, 0
v_dot2_f32_bf16 v232, v177, v217, v232
v_dot2_f32_bf16 v233, v177, v221, v233
v_dot2_f32_bf16 v234, v177, v225, v234
v_dot2_f32_bf16 v235, v177, v229, v235
v_dot2_f32_bf16 v232, v178, v218, v232
v_dot2_f32_bf16 v233, v178, v222, v233
v_dot2_f32_bf16 v234, v178, v226, v234
v_dot2_f32_bf16 v235, v178, v230, v235
v_dot2_f32_bf16 v232, v179, v219, v232
v_dot2_f32_bf16 v233, v179, v223, v233
v_dot2_f32_bf16 v234, v179, v227, v234
v_dot2_f32_bf16 v235, v179, v231, v235
v_add_f32_dpp v236, v232, v232 row_ror:8 row_mask:0xf bank_mask:0x3
v_add_f32_dpp v237, v233, v233 row_ror:8 row_mask:0xf bank_mask:0x3
v_add_f32_dpp v236, v234, v234 row_ror:8 row_mask:0xf bank_mask:0xc
v_add_f32_dpp v237, v235, v235 row_ror:8 row_mask:0xf bank_mask:0xc
s_nop 0
v_add_f32_dpp v70, v236, v236 row_half_mirror row_mask:0xf bank_mask:0x5
v_add_f32_dpp v70, v237, v237 row_half_mirror row_mask:0xf bank_mask:0xa
s_nop 1
v_add_f32_dpp v70, v70, v70 quad_perm:[1,0,3,2] row_mask:0xf bank_mask:0xf
s_nop 1
v_add_f32_dpp v70, v70, v70 quad_perm:[2,3,0,1] row_mask:0xf bank_mask:0xf
s_waitcnt vmcnt(9)
v_dot2_f32_bf16 v232, v180, v216, 0
v_dot2_f32_bf16 v233, v180, v220, 0
v_dot2_f32_bf16 v234, v180, v224, 0
v_dot2_f32_bf16 v235, v180, v228, 0
v_dot2_f32_bf16 v232, v181, v217, v232
v_dot2_f32_bf16 v233, v181, v221, v233
v_dot2_f32_bf16 v234, v181, v225, v234
v_dot2_f32_bf16 v235, v181, v229, v235
v_dot2_f32_bf16 v232, v182, v218, v232
v_dot2_f32_bf16 v233, v182, v222, v233
v_dot2_f32_bf16 v234, v182, v226, v234
v_dot2_f32_bf16 v235, v182, v230, v235
v_dot2_f32_bf16 v232, v183, v219, v232
v_dot2_f32_bf16 v233, v183, v223, v233
v_dot2_f32_bf16 v234, v183, v227, v234
v_dot2_f32_bf16 v235, v183, v231, v235
v_add_f32_dpp v236, v232, v232 row_ror:8 row_mask:0xf bank_mask:0x3
v_add_f32_dpp v237, v233, v233 row_ror:8 row_mask:0xf bank_mask:0x3
v_add_f32_dpp v236, v234, v234 row_ror:8 row_mask:0xf bank_mask:0xc
v_add_f32_dpp v237, v235, v235 row_ror:8 row_mask:0xf bank_mask:0xc
s_nop 0
v_add_f32_dpp v71, v236, v236 row_half_mirror row_mask:0xf bank_mask:0x5
v_add_f32_dpp v71, v237, v237 row_half_mirror row_mask:0xf bank_mask:0xa
s_nop 1
v_add_f32_dpp v71, v71, v71 quad_perm:[1,0,3,2] row_mask:0xf bank_mask:0xf
s_nop 1
v_add_f32_dpp v71, v71, v71 quad_perm:[2,3,0,1] row_mask:0xf bank_mask:0xf
s_waitcnt vmcnt(8)
v_dot2_f32_bf16 v232, v184, v216, 0
v_dot2_f32_bf16 v233, v184, v220, 0
v_dot2_f32_bf16 v234, v184, v224, 0
v_dot2_f32_bf16 v235, v184, v228, 0
v_dot2_f32_bf16 v232, v185, v217, v232
v_dot2_f32_bf16 v233, v185, v221, v233
v_dot2_f32_bf16 v234, v185, v225, v234
v_dot2_f32_bf16 v235, v185, v229, v235
v_dot2_f32_bf16 v232, v186, v218, v232
v_dot2_f32_bf16 v233, v186, v222, v233
v_dot2_f32_bf16 v234, v186, v226, v234
v_dot2_f32_bf16 v235, v186, v230, v235
v_dot2_f32_bf16 v232, v187, v219, v232
v_dot2_f32_bf16 v233, v187, v223, v233
v_dot2_f32_bf16 v234, v187, v227, v234
v_dot2_f32_bf16 v235, v187, v231, v235
v_add_f32_dpp v236, v232, v232 row_ror:8 row_mask:0xf bank_mask:0x3
v_add_f32_dpp v237, v233, v233 row_ror:8 row_mask:0xf bank_mask:0x3
v_add_f32_dpp v236, v234, v234 row_ror:8 row_mask:0xf bank_mask:0xc
v_add_f32_dpp v237, v235, v235 row_ror:8 row_mask:0xf bank_mask:0xc
s_nop 0
v_add_f32_dpp v72, v236, v236 row_half_mirror row_mask:0xf bank_mask:0x5
v_add_f32_dpp v72, v237, v237 row_half_mirror row_mask:0xf bank_mask:0xa
s_nop 1
v_add_f32_dpp v72, v72, v72 quad_perm:[1,0,3,2] row_mask:0xf bank_mask:0xf
s_nop 1
v_add_f32_dpp v72, v72, v72 quad_perm:[2,3,0,1] row_mask:0xf bank_mask:0xf
s_waitcnt vmcnt(7)
v_dot2_f32_bf16 v232, v188, v216, 0
v_dot2_f32_bf16 v233, v188, v220, 0
v_dot2_f32_bf16 v234, v188, v224, 0
v_dot2_f32_bf16 v235, v188, v228, 0
v_dot2_f32_bf16 v232, v189, v217, v232
v_dot2_f32_bf16 v233, v189, v221, v233
v_dot2_f32_bf16 v234, v189, v225, v234
v_dot2_f32_bf16 v235, v189, v229, v235
v_dot2_f32_bf16 v232, v190, v218, v232
v_dot2_f32_bf16 v233, v190, v222, v233
v_dot2_f32_bf16 v234, v190, v226, v234
v_dot2_f32_bf16 v235, v190, v230, v235
v_dot2_f32_bf16 v232, v191, v219, v232
v_dot2_f32_bf16 v233, v191, v223, v233
v_dot2_f32_bf16 v234, v191, v227, v234
v_dot2_f32_bf16 v235, v191, v231, v235
v_add_f32_dpp v236, v232, v232 row_ror:8 row_mask:0xf bank_mask:0x3
v_add_f32_dpp v237, v233, v233 row_ror:8 row_mask:0xf bank_mask:0x3
v_add_f32_dpp v236, v234, v234 row_ror:8 row_mask:0xf bank_mask:0xc
v_add_f32_dpp v237, v235, v235 row_ror:8 row_mask:0xf bank_mask:0xc
s_nop 0
v_add_f32_dpp v73, v236, v236 row_half_mirror row_mask:0xf bank_mask:0x5
v_add_f32_dpp v73, v237, v237 row_half_mirror row_mask:0xf bank_mask:0xa
s_nop 1
v_add_f32_dpp v73, v73, v73 quad_perm:[1,0,3,2] row_mask:0xf bank_mask:0xf
s_nop 1
v_add_f32_dpp v73, v73, v73 quad_perm:[2,3,0,1] row_mask:0xf bank_mask:0xf
s_waitcnt vmcnt(6)
v_dot2_f32_bf16 v232, v192, v216, 0
v_dot2_f32_bf16 v233, v192, v220, 0
v_dot2_f32_bf16 v234, v192, v224, 0
v_dot2_f32_bf16 v235, v192, v228, 0
v_dot2_f32_bf16 v232, v193, v217, v232
v_dot2_f32_bf16 v233, v193, v221, v233
v_dot2_f32_bf16 v234, v193, v225, v234
v_dot2_f32_bf16 v235, v193, v229, v235
v_dot2_f32_bf16 v232, v194, v218, v232
v_dot2_f32_bf16 v233, v194, v222, v233
v_dot2_f32_bf16 v234, v194, v226, v234
v_dot2_f32_bf16 v235, v194, v230, v235
v_dot2_f32_bf16 v232, v195, v219, v232
v_dot2_f32_bf16 v233, v195, v223, v233
v_dot2_f32_bf16 v234, v195, v227, v234
v_dot2_f32_bf16 v235, v195, v231, v235
v_add_f32_dpp v236, v232, v232 row_ror:8 row_mask:0xf bank_mask:0x3
v_add_f32_dpp v237, v233, v233 row_ror:8 row_mask:0xf bank_mask:0x3
v_add_f32_dpp v236, v234, v234 row_ror:8 row_mask:0xf bank_mask:0xc
v_add_f32_dpp v237, v235, v235 row_ror:8 row_mask:0xf bank_mask:0xc
s_nop 0
v_add_f32_dpp v74, v236, v236 row_half_mirror row_mask:0xf bank_mask:0x5
v_add_f32_dpp v74, v237, v237 row_half_mirror row_mask:0xf bank_mask:0xa
s_nop 1
v_add_f32_dpp v74, v74, v74 quad_perm:[1,0,3,2] row_mask:0xf bank_mask:0xf
s_nop 1
v_add_f32_dpp v74, v74, v74 quad_perm:[2,3,0,1] row_mask:0xf bank_mask:0xf
s_waitcnt vmcnt(5)
v_dot2_f32_bf16 v232, v196, v216, 0
v_dot2_f32_bf16 v233, v196, v220, 0
v_dot2_f32_bf16 v234, v196, v224, 0
v_dot2_f32_bf16 v235, v196, v228, 0
v_dot2_f32_bf16 v232, v197, v217, v232
v_dot2_f32_bf16 v233, v197, v221, v233
v_dot2_f32_bf16 v234, v197, v225, v234
v_dot2_f32_bf16 v235, v197, v229, v235
v_dot2_f32_bf16 v232, v198, v218, v232
v_dot2_f32_bf16 v233, v198, v222, v233
v_dot2_f32_bf16 v234, v198, v226, v234
v_dot2_f32_bf16 v235, v198, v230, v235
v_dot2_f32_bf16 v232, v199, v219, v232
v_dot2_f32_bf16 v233, v199, v223, v233
v_dot2_f32_bf16 v234, v199, v227, v234
v_dot2_f32_bf16 v235, v199, v231, v235
v_add_f32_dpp v236, v232, v232 row_ror:8 row_mask:0xf bank_mask:0x3
v_add_f32_dpp v237, v233, v233 row_ror:8 row_mask:0xf bank_mask:0x3
v_add_f32_dpp v236, v234, v234 row_ror:8 row_mask:0xf bank_mask:0xc
v_add_f32_dpp v237, v235, v235 row_ror:8 row_mask:0xf bank_mask:0xc
s_nop 0
v_add_f32_dpp v75, v236, v236 row_half_mirror row_mask:0xf bank_mask:0x5
v_add_f32_dpp v75, v237, v237 row_half_mirror row_mask:0xf bank_mask:0xa
s_nop 1
v_add_f32_dpp v75, v75, v75 quad_perm:[1,0,3,2] row_mask:0xf bank_mask:0xf
s_nop 1
v_add_f32_dpp v75, v75, v75 quad_perm:[2,3,0,1] row_mask:0xf bank_mask:0xf
s_waitcnt vmcnt(4)
v_dot2_f32_bf16 v232, v200, v216, 0
v_dot2_f32_bf16 v233, v200, v220, 0
v_dot2_f32_bf16 v234, v200, v224, 0
v_dot2_f32_bf16 v235, v200, v228, 0
v_dot2_f32_bf16 v232, v201, v217, v232
v_dot2_f32_bf16 v233, v201, v221, v233
v_dot2_f32_bf16 v234, v201, v225, v234
v_dot2_f32_bf16 v235, v201, v229, v235
v_dot2_f32_bf16 v232, v202, v218, v232
v_dot2_f32_bf16 v233, v202, v222, v233
v_dot2_f32_bf16 v234, v202, v226, v234
v_dot2_f32_bf16 v235, v202, v230, v235
v_dot2_f32_bf16 v232, v203, v219, v232
v_dot2_f32_bf16 v233, v203, v223, v233
v_dot2_f32_bf16 v234, v203, v227, v234
v_dot2_f32_bf16 v235, v203, v231, v235
v_add_f32_dpp v236, v232, v232 row_ror:8 row_mask:0xf bank_mask:0x3
v_add_f32_dpp v237, v233, v233 row_ror:8 row_mask:0xf bank_mask:0x3
v_add_f32_dpp v236, v234, v234 row_ror:8 row_mask:0xf bank_mask:0xc
v_add_f32_dpp v237, v235, v235 row_ror:8 row_mask:0xf bank_mask:0xc
s_nop 0
v_add_f32_dpp v76, v236, v236 row_half_mirror row_mask:0xf bank_mask:0x5
v_add_f32_dpp v76, v237, v237 row_half_mirror row_mask:0xf bank_mask:0xa
s_nop 1
v_add_f32_dpp v76, v76, v76 quad_perm:[1,0,3,2] row_mask:0xf bank_mask:0xf
s_nop 1
v_add_f32_dpp v76, v76, v76 quad_perm:[2,3,0,1] row_mask:0xf bank_mask:0xf
s_waitcnt vmcnt(3)
v_dot2_f32_bf16 v232, v204, v216, 0
v_dot2_f32_bf16 v233, v204, v220, 0
v_dot2_f32_bf16 v234, v204, v224, 0
v_dot2_f32_bf16 v235, v204, v228, 0
v_dot2_f32_bf16 v232, v205, v217, v232
v_dot2_f32_bf16 v233, v205, v221, v233
v_dot2_f32_bf16 v234, v205, v225, v234
v_dot2_f32_bf16 v235, v205, v229, v235
v_dot2_f32_bf16 v232, v206, v218, v232
v_dot2_f32_bf16 v233, v206, v222, v233
v_dot2_f32_bf16 v234, v206, v226, v234
v_dot2_f32_bf16 v235, v206, v230, v235
v_dot2_f32_bf16 v232, v207, v219, v232
v_dot2_f32_bf16 v233, v207, v223, v233
v_dot2_f32_bf16 v234, v207, v227, v234
v_dot2_f32_bf16 v235, v207, v231, v235
v_add_f32_dpp v236, v232, v232 row_ror:8 row_mask:0xf bank_mask:0x3
v_add_f32_dpp v237, v233, v233 row_ror:8 row_mask:0xf bank_mask:0x3
v_add_f32_dpp v236, v234, v234 row_ror:8 row_mask:0xf bank_mask:0xc
v_add_f32_dpp v237, v235, v235 row_ror:8 row_mask:0xf bank_mask:0xc
s_nop 0
v_add_f32_dpp v77, v236, v236 row_half_mirror row_mask:0xf bank_mask:0x5
v_add_f32_dpp v77, v237, v237 row_half_mirror row_mask:0xf bank_mask:0xa
s_nop 1
v_add_f32_dpp v77, v77, v77 quad_perm:[1,0,3,2] row_mask:0xf bank_mask:0xf
s_nop 1
v_add_f32_dpp v77, v77, v77 quad_perm:[2,3,0,1] row_mask:0xf bank_mask:0xf
s_waitcnt vmcnt(2)
v_dot2_f32_bf16 v232, v208, v216, 0
v_dot2_f32_bf16 v233, v208, v220, 0
v_dot2_f32_bf16 v234, v208, v224, 0
v_dot2_f32_bf16 v235, v208, v228, 0
v_dot2_f32_bf16 v232, v209, v217, v232
v_dot2_f32_bf16 v233, v209, v221, v233
v_dot2_f32_bf16 v234, v209, v225, v234
v_dot2_f32_bf16 v235, v209, v229, v235
v_dot2_f32_bf16 v232, v210, v218, v232
v_dot2_f32_bf16 v233, v210, v222, v233
v_dot2_f32_bf16 v234, v210, v226, v234
v_dot2_f32_bf16 v235, v210, v230, v235
v_dot2_f32_bf16 v232, v211, v219, v232
v_dot2_f32_bf16 v233, v211, v223, v233
v_dot2_f32_bf16 v234, v211, v227, v234
v_dot2_f32_bf16 v235, v211, v231, v235
v_add_f32_dpp v236, v232, v232 row_ror:8 row_mask:0xf bank_mask:0x3
v_add_f32_dpp v237, v233, v233 row_ror:8 row_mask:0xf bank_mask:0x3
v_add_f32_dpp v236, v234, v234 row_ror:8 row_mask:0xf bank_mask:0xc
v_add_f32_dpp v237, v235, v235 row_ror:8 row_mask:0xf bank_mask:0xc
s_nop 0
v_add_f32_dpp v78, v236, v236 row_half_mirror row_mask:0xf bank_mask:0x5
v_add_f32_dpp v78, v237, v237 row_half_mirror row_mask:0xf bank_mask:0xa
s_nop 1
v_add_f32_dpp v78, v78, v78 quad_perm:[1,0,3,2] row_mask:0xf bank_mask:0xf
s_nop 1
v_add_f32_dpp v78, v78, v78 quad_perm:[2,3,0,1] row_mask:0xf bank_mask:0xf
s_waitcnt vmcnt(1)
v_dot2_f32_bf16 v232, v212, v216, 0
v_dot2_f32_bf16 v233, v212, v220, 0
v_dot2_f32_bf16 v234, v212, v224, 0
v_dot2_f32_bf16 v235, v212, v228, 0
v_dot2_f32_bf16 v232, v213, v217, v232
v_dot2_f32_bf16 v233, v213, v221, v233
v_dot2_f32_bf16 v234, v213, v225, v234
v_dot2_f32_bf16 v235, v213, v229, v235
v_dot2_f32_bf16 v232, v214, v218, v232
v_dot2_f32_bf16 v233, v214, v222, v233
v_dot2_f32_bf16 v234, v214, v226, v234
v_dot2_f32_bf16 v235, v214, v230, v235
v_dot2_f32_bf16 v232, v215, v219, v232
v_dot2_f32_bf16 v233, v215, v223, v233
v_dot2_f32_bf16 v234, v215, v227, v234
v_dot2_f32_bf16 v235, v215, v231, v235
v_add_f32_dpp v236, v232, v232 row_ror:8 row_mask:0xf bank_mask:0x3
v_add_f32_dpp v237, v233, v233 row_ror:8 row_mask:0xf bank_mask:0x3
v_add_f32_dpp v236, v234, v234 row_ror:8 row_mask:0xf bank_mask:0xc
v_add_f32_dpp v237, v235, v235 row_ror:8 row_mask:0xf bank_mask:0xc
s_nop 0
v_add_f32_dpp v79, v236, v236 row_half_mirror row_mask:0xf bank_mask:0x5
v_add_f32_dpp v79, v237, v237 row_half_mirror row_mask:0xf bank_mask:0xa
s_nop 1
v_add_f32_dpp v79, v79, v79 quad_perm:[1,0,3,2] row_mask:0xf bank_mask:0xf
s_nop 1
v_add_f32_dpp v79, v79, v79 quad_perm:[2,3,0,1] row_mask:0xf bank_mask:0xf
v_cvt_pk_bf16_f32 v24, v64, v65
v_cvt_pk_bf16_f32 v25, v66, v67
v_cvt_pk_bf16_f32 v26, v68, v69
v_cvt_pk_bf16_f32 v27, v70, v71
v_cvt_pk_bf16_f32 v28, v72, v73
v_cvt_pk_bf16_f32 v29, v74, v75
v_cvt_pk_bf16_f32 v30, v76, v77
v_cvt_pk_bf16_f32 v31, v78, v79
v_cmp_eq_u32 vcc, 1, v6
s_nop 1
v_cndmask_b32 v248, v24, v28, vcc
v_cndmask_b32 v249, v25, v29, vcc
v_cndmask_b32 v250, v26, v30, vcc
v_cndmask_b32 v251, v27, v31, vcc
v_cmp_eq_u32 vcc, 1, v7
s_nop 1
v_cndmask_b32 v244, v244, v248, vcc
v_cndmask_b32 v245, v245, v249, vcc
v_cndmask_b32 v246, v246, v250, vcc
v_cndmask_b32 v247, v247, v251, vcc
v_min_u32 v244, -2, v244
v_min_u32 v245, -2, v245
v_min_u32 v246, -2, v246
v_min_u32 v247, -2, v247
s_waitcnt vmcnt(0)
s_mov_b32 s7, 400000
L_ens_35:
v_readfirstlane_b32 s6, v11
s_cmp_ge_u32 s6, 128
s_cbranch_scc1 L_ensd_36
s_sleep 16
buffer_load_dword v11, off, s[68:71], 0 offset:0 sc1
s_waitcnt vmcnt(0)
s_sub_u32 s7, s7, 1
s_cmp_lg_u32 s7, 0
s_cbranch_scc1 L_ens_35
L_ensd_36:
s_lshl_b32 s6, s4, 10
s_lshl_b32 s7, s3, 8
s_add_u32 s6, s6, s7
s_add_u32 s6, s6, 0
buffer_store_dwordx4 v[244:247], v5, s[64:67], s6 offen sc1
s_mov_b32 m0, s12
s_nop 0
buffer_load_dwordx4 v2, s[60:63], s12 offen offset:0 nt lds
buffer_load_dwordx4 v2, s[60:63], s12 offen offset:1024 nt lds
s_waitcnt vmcnt(2)
buffer_load_dwordx4 v2, s[60:63], s12 offen offset:2048 nt lds
s_waitcnt vmcnt(2)
buffer_load_dwordx4 v2, s[60:63], s12 offen offset:3072 nt lds
s_add_u32 s12, s12, 4096
s_mov_b32 m0, s12
s_waitcnt vmcnt(2)
buffer_load_dwordx4 v2, s[60:63], s12 offen offset:0 nt lds
s_waitcnt vmcnt(2)
buffer_load_dwordx4 v2, s[60:63], s12 offen offset:1024 nt lds
s_waitcnt vmcnt(2)
buffer_load_dwordx4 v2, s[60:63], s12 offen offset:2048 nt lds
s_waitcnt vmcnt(2)
buffer_load_dwordx4 v2, s[60:63], s12 offen offset:3072 nt lds
s_add_u32 s12, s12, 4096
s_mov_b32 m0, s12
s_waitcnt vmcnt(2)
buffer_load_dwordx4 v2, s[60:63], s12 offen offset:0 nt lds
s_waitcnt vmcnt(2)
buffer_load_dwordx4 v2, s[60:63], s12 offen offset:1024 nt lds
s_waitcnt vmcnt(2)
buffer_load_dwordx4 v2, s[60:63], s12 offen offset:2048 nt lds
s_waitcnt vmcnt(2)
buffer_load_dwordx4 v2, s[60:63], s12 offen offset:3072 nt lds
s_add_u32 s12, s12, 4096
s_mov_b32 m0, s12
s_waitcnt vmcnt(2)
buffer_load_dwordx4 v2, s[60:63], s12 offen offset:0 nt lds
s_waitcnt vmcnt(2)
buffer_load_dwordx4 v2, s[60:63], s12 offen offset:1024 nt lds
s_waitcnt vmcnt(2)
buffer_load_dwordx4 v2, s[60:63], s12 offen offset:2048 nt lds
s_waitcnt vmcnt(2)
buffer_load_dwordx4 v2, s[60:63], s12 offen offset:3072 nt lds
s_add_u32 s12, s12, 4096
s_mov_b32 m0, s12
s_waitcnt vmcnt(2)
buffer_load_dwordx4 v2, s[60:63], s12 offen offset:0 nt lds
s_waitcnt vmcnt(2)
buffer_load_dwordx4 v2, s[60:63], s12 offen offset:1024 nt lds
s_waitcnt vmcnt(2)
buffer_load_dwordx4 v2, s[60:63], s12 offen offset:2048 nt lds
s_waitcnt vmcnt(2)
buffer_load_dwordx4 v2, s[60:63], s12 offen offset:3072 nt lds
s_add_u32 s12, s12, 4096
s_mov_b32 m0, s12
s_waitcnt vmcnt(2)
buffer_load_dwordx4 v2, s[60:63], s12 offen offset:0 nt lds
s_waitcnt vmcnt(2)
buffer_load_dwordx4 v2, s[60:63], s12 offen offset:1024 nt lds
s_waitcnt vmcnt(2)
buffer_load_dwordx4 v2, s[60:63], s12 offen offset:2048 nt lds
s_waitcnt vmcnt(2)
buffer_load_dwordx4 v2, s[60:63], s12 offen offset:3072 nt lds
s_add_u32 s12, s12, 4096
s_mov_b32 m0, s12
s_waitcnt vmcnt(2)
buffer_load_dwordx4 v2, s[60:63], s12 offen offset:0 nt lds
s_waitcnt vmcnt(2)
buffer_load_dwordx4 v2, s[60:63], s12 offen offset:1024 nt lds
s_waitcnt vmcnt(2)
buffer_load_dwordx4 v2, s[60:63], s12 offen offset:2048 nt lds
s_waitcnt vmcnt(2)
buffer_load_dwordx4 v2, s[60:63], s12 offen offset:3072 nt lds
s_add_u32 s12, s12, 4096
s_mov_b32 m0, s12
s_waitcnt vmcnt(2)
buffer_load_dwordx4 v2, s[60:63], s12 offen offset:0 nt lds
s_waitcnt vmcnt(2)
buffer_load_dwordx4 v2, s[60:63], s12 offen offset:1024 nt lds
s_waitcnt vmcnt(2)
buffer_load_dwordx4 v2, s[60:63], s12 offen offset:2048 nt lds
s_waitcnt vmcnt(2)
buffer_load_dwordx4 v2, s[60:63], s12 offen offset:3072 nt lds
s_add_u32 s12, s12, 4096
s_mov_b32 m0, s12
s_waitcnt vmcnt(2)
buffer_load_dwordx4 v2, s[60:63], s12 offen offset:0 nt lds
s_waitcnt vmcnt(2)
buffer_load_dwordx4 v2, s[60:63], s12 offen offset:1024 nt lds
s_waitcnt vmcnt(2)
buffer_load_dwordx4 v2, s[60:63], s12 offen offset:2048 nt lds
s_waitcnt vmcnt(2)
buffer_load_dwordx4 v2, s[60:63], s12 offen offset:3072 nt lds
v_lshlrev_b32 v238, 18, v9
v_lshl_add_u32 v238, v8, 4, v238
s_mov_b32 s6, 0
s_waitcnt vmcnt(2)
buffer_load_dwordx4 v[88:91], v238, s[52:55], s6 offen nt
s_mov_b32 s6, 8192
s_waitcnt vmcnt(2)
buffer_load_dwordx4 v[92:95], v238, s[52:55], s6 offen nt
s_mov_b32 s6, 16384
s_waitcnt vmcnt(2)
buffer_load_dwordx4 v[96:99], v238, s[52:55], s6 offen nt
s_mov_b32 s6, 24576
s_waitcnt vmcnt(2)
buffer_load_dwordx4 v[100:103], v238, s[52:55], s6 offen nt
s_mov_b32 s6, 32768
s_waitcnt vmcnt(2)
buffer_load_dwordx4 v[104:107], v238, s[52:55], s6 offen nt
s_mov_b32 s6, 40960
s_waitcnt vmcnt(2)
buffer_load_dwordx4 v[108:111], v238, s[52:55], s6 offen nt
s_mov_b32 s6, 49152
s_waitcnt vmcnt(2)
buffer_load_dwordx4 v[112:115], v238, s[52:55], s6 offen nt
s_mov_b32 s6, 57344
s_waitcnt vmcnt(2)
buffer_load_dwordx4 v[116:119], v238, s[52:55], s6 offen nt
s_mov_b32 s6, 65536
s_waitcnt vmcnt(2)
buffer_load_dwordx4 v[120:123], v238, s[52:55], s6 offen nt
s_mov_b32 s6, 73728
s_waitcnt vmcnt(2)
buffer_load_dwordx4 v[124:127], v238, s[52:55], s6 offen nt
s_mov_b32 s6, 81920
s_waitcnt vmcnt(2)
buffer_load_dwordx4 v[128:131], v238, s[52:55], s6 offen nt
s_mov_b32 s6, 90112
s_waitcnt vmcnt(2)
buffer_load_dwordx4 v[132:135], v238, s[52:55], s6 offen nt
s_mov_b32 s6, 98304
s_waitcnt vmcnt(2)
buffer_load_dwordx4 v[136:139], v238, s[52:55], s6 offen nt
s_mov_b32 s6, 106496
s_waitcnt vmcnt(2)
buffer_load_dwordx4 v[140:143], v238, s[52:55], s6 offen nt
s_mov_b32 s6, 114688
s_waitcnt vmcnt(2)
buffer_load_dwordx4 v[144:147], v238, s[52:55], s6 offen nt
s_mov_b32 s6, 122880
s_waitcnt vmcnt(2)
buffer_load_dwordx4 v[148:151], v238, s[52:55], s6 offen nt
s_mov_b32 s6, 131072
s_waitcnt vmcnt(2)
buffer_load_dwordx4 v[152:155], v238, s[52:55], s6 offen nt
s_mov_b32 s6, 139264
s_waitcnt vmcnt(2)
buffer_load_dwordx4 v[156:159], v238, s[52:55], s6 offen nt
s_mov_b32 s6, 147456
s_waitcnt vmcnt(2)
buffer_load_dwordx4 v[160:163], v238, s[52:55], s6 offen nt
s_mov_b32 s6, 155648
s_waitcnt vmcnt(2)
buffer_load_dwordx4 v[164:167], v238, s[52:55], s6 offen nt
s_mov_b32 s6, 163840
s_waitcnt vmcnt(2)
buffer_load_dwordx4 v[168:171], v238, s[52:55], s6 offen nt
s_mov_b32 s6, 172032
s_waitcnt vmcnt(2)
buffer_load_dwordx4 v[172:175], v238, s[52:55], s6 offen nt
s_mov_b32 s6, 180224
s_waitcnt vmcnt(2)
buffer_load_dwordx4 v[176:179], v238, s[52:55], s6 offen nt
s_mov_b32 s6, 188416
s_waitcnt vmcnt(2)
buffer_load_dwordx4 v[180:183], v238, s[52:55], s6 offen nt
s_mov_b32 s6, 196608
s_waitcnt vmcnt(2)
buffer_load_dwordx4 v[184:187], v238, s[52:55], s6 offen nt
s_mov_b32 s6, 204800
s_waitcnt vmcnt(2)
buffer_load_dwordx4 v[188:191], v238, s[52:55], s6 offen nt
s_mov_b32 s6, 212992
s_waitcnt vmcnt(2)
buffer_load_dwordx4 v[192:195], v238, s[52:55], s6 offen nt
s_mov_b32 s6, 221184
s_waitcnt vmcnt(2)
buffer_load_dwordx4 v[196:199], v238, s[52:55], s6 offen nt
s_mov_b32 s6, 229376
s_waitcnt vmcnt(2)
buffer_load_dwordx4 v[200:203], v238, s[52:55], s6 offen nt
s_mov_b32 s6, 237568
s_waitcnt vmcnt(2)
buffer_load_dwordx4 v[204:207], v238, s[52:55], s6 offen nt
s_mov_b32 s6, 245760
s_waitcnt vmcnt(2)
buffer_load_dwordx4 v[208:211], v238, s[52:55], s6 offen nt
s_mov_b32 s6, 253952
s_waitcnt vmcnt(2)
buffer_load_dwordx4 v[212:215], v238, s[52:55], s6 offen nt
v_mov_b32 v11, 163824
v_mov_b32 v7, 0
ds_write_b32 v11, v7
s_waitcnt lgkmcnt(0)
s_barrier
ds_read_b64_tr_b16 a[96:97], v240 offset:0
ds_read_b64_tr_b16 a[98:99], v240 offset:4608
ds_read_b64_tr_b16 a[100:101], v240 offset:36864
ds_read_b64_tr_b16 a[102:103], v240 offset:41472
ds_read_b64_tr_b16 a[104:105], v242 offset:0
ds_read_b64_tr_b16 a[106:107], v242 offset:4608
ds_read_b64_tr_b16 a[108:109], v242 offset:36864
ds_read_b64_tr_b16 a[110:111], v242 offset:41472
ds_read_b64_tr_b16 a[112:113], v240 offset:8
ds_read_b64_tr_b16 a[114:115], v240 offset:4616
ds_read_b64_tr_b16 a[116:117], v240 offset:36872
ds_read_b64_tr_b16 a[118:119], v240 offset:41480
ds_read_b64_tr_b16 a[120:121], v242 offset:8
ds_read_b64_tr_b16 a[122:123], v242 offset:4616
ds_read_b64_tr_b16 a[124:125], v242 offset:36872
ds_read_b64_tr_b16 a[126:127], v242 offset:41480
ds_read_b64_tr_b16 a[128:129], v240 offset:16
ds_read_b64_tr_b16 a[130:131], v240 offset:4624
ds_read_b64_tr_b16 a[132:133], v240 offset:36880
ds_read_b64_tr_b16 a[134:135], v240 offset:41488
ds_read_b64_tr_b16 a[136:137], v242 offset:16
ds_read_b64_tr_b16 a[138:139], v242 offset:4624
ds_read_b64_tr_b16 a[140:141], v242 offset:36880
ds_read_b64_tr_b16 a[142:143], v242 offset:41488
ds_read_b64_tr_b16 a[144:145], v240 offset:24
ds_read_b64_tr_b16 a[146:147], v240 offset:4632
ds_read_b64_tr_b16 a[148:149], v240 offset:36888
ds_read_b64_tr_b16 a[150:151], v240 offset:41496
ds_read_b64_tr_b16 a[152:153], v242 offset:24
ds_read_b64_tr_b16 a[154:155], v242 offset:4632
ds_read_b64_tr_b16 a[156:157], v242 offset:36888
ds_read_b64_tr_b16 a[158:159], v242 offset:41496
ds_read_b64_tr_b16 a[160:161], v240 offset:128
ds_read_b64_tr_b16 a[162:163], v240 offset:4736
ds_read_b64_tr_b16 a[164:165], v240 offset:36992
ds_read_b64_tr_b16 a[166:167], v240 offset:41600
ds_read_b64_tr_b16 a[168:169], v242 offset:128
ds_read_b64_tr_b16 a[170:171], v242 offset:4736
ds_read_b64_tr_b16 a[172:173], v242 offset:36992
ds_read_b64_tr_b16 a[174:175], v242 offset:41600
ds_read_b64_tr_b16 a[176:177], v240 offset:136
ds_read_b64_tr_b16 a[178:179], v240 offset:4744
ds_read_b64_tr_b16 a[180:181], v240 offset:37000
ds_read_b64_tr_b16 a[182:183], v240 offset:41608
ds_read_b64_tr_b16 a[184:185], v242 offset:136
ds_read_b64_tr_b16 a[186:187], v242 offset:4744
ds_read_b64_tr_b16 a[188:189], v242 offset:37000
ds_read_b64_tr_b16 a[190:191], v242 offset:41608
ds_read_b64_tr_b16 a[192:193], v240 offset:144
ds_read_b64_tr_b16 a[194:195], v240 offset:4752
ds_read_b64_tr_b16 a[196:197], v240 offset:37008
ds_read_b64_tr_b16 a[198:199], v240 offset:41616
ds_read_b64_tr_b16 a[200:201], v242 offset:144
ds_read_b64_tr_b16 a[202:203], v242 offset:4752
ds_read_b64_tr_b16 a[204:205], v242 offset:37008
ds_read_b64_tr_b16 a[206:207], v242 offset:41616
ds_read_b64_tr_b16 a[208:209], v240 offset:152
ds_read_b64_tr_b16 a[210:211], v240 offset:4760
ds_read_b64_tr_b16 a[212:213], v240 offset:37016
ds_read_b64_tr_b16 a[214:215], v240 offset:41624
ds_read_b64_tr_b16 a[216:217], v242 offset:152
ds_read_b64_tr_b16 a[218:219], v242 offset:4760
ds_read_b64_tr_b16 a[220:221], v242 offset:37016
ds_read_b64_tr_b16 a[222:223], v242 offset:41624
ds_read_b64_tr_b16 a[224:225], v241 offset:0
ds_read_b64_tr_b16 a[226:227], v241 offset:4608
ds_read_b64_tr_b16 a[228:229], v241 offset:36864
ds_read_b64_tr_b16 a[230:231], v241 offset:41472
ds_read_b64_tr_b16 a[232:233], v243 offset:0
ds_read_b64_tr_b16 a[234:235], v243 offset:4608
ds_read_b64_tr_b16 a[236:237], v243 offset:36864
ds_read_b64_tr_b16 a[238:239], v243 offset:41472
v_and_b32 v6, 7, v1
v_mul_u32_u24 v6, 8, v6
s_lshl_b32 s6, s4, 8
s_mul_i32 s7, s3, 64
s_add_u32 s6, s6, s7
s_add_u32 s15, s6, 262144
s_mov_b32 s7, 400000
P_poll:
buffer_load_dwordx2 v[232:233], v6, s[64:67], s15 offen sc1
s_waitcnt vmcnt(0)
v_max_u32 v234, v232, v233
v_cmp_eq_u32 vcc, -1, v234
s_cbranch_vccz P_ok
s_sleep 16
s_sub_u32 s7, s7, 1
s_cmp_lg_u32 s7, 0
s_cbranch_scc1 P_poll
P_ok:
s_lshr_b32 s6, s4, 3
s_mul_i32 s6, s6, 524288
s_bitcmp1_b32 s4, 0
s_cselect_b32 s7, 98304, 0
s_add_u32 s6, s6, s7
s_bitcmp1_b32 s4, 1
s_cselect_b32 s7, 131072, 0
s_add_u32 s6, s6, s7
s_bitcmp1_b32 s4, 2
s_cselect_b32 s7, 262144, 0
s_add_u32 s6, s6, s7
s_lshl_b32 s7, s3, 13
s_add_u32 s6, s6, s7
s_add_u32 s6, s6, 2097152
buffer_load_dwordx4 v[24:27], v2, s[64:67], s6 offen offset:0 sc1
buffer_load_dwordx4 v[28:31], v2, s[64:67], s6 offen offset:1024 sc1
buffer_load_dwordx4 v[32:35], v2, s[64:67], s6 offen offset:2048 sc1
buffer_load_dwordx4 v[36:39], v2, s[64:67], s6 offen offset:3072 sc1
s_add_u32 s6, s6, 4096
buffer_load_dwordx4 v[40:43], v2, s[64:67], s6 offen offset:0 sc1
buffer_load_dwordx4 v[44:47], v2, s[64:67], s6 offen offset:1024 sc1
buffer_load_dwordx4 v[48:51], v2, s[64:67], s6 offen offset:2048 sc1
buffer_load_dwordx4 v[52:55], v2, s[64:67], s6 offen offset:3072 sc1
v_mov_b32 v234, v232
s_nop 1
v_max_f32_dpp v234, v234, v234 row_ror:4 row_mask:0xf bank_mask:0xf
s_nop 1
v_max_f32_dpp v234, v234, v234 row_ror:2 row_mask:0xf bank_mask:0xf
s_nop 1
v_max_f32_dpp v234, v234, v234 row_ror:1 row_mask:0xf bank_mask:0xf
v_sub_f32 v232, v232, v234
v_exp_f32 v232, v232
s_nop 0
v_mul_f32 v235, v232, v233
s_nop 1
v_add_f32_dpp v235, v235, v235 row_ror:4 row_mask:0xf bank_mask:0xf
s_nop 1
v_add_f32_dpp v235, v235, v235 row_ror:2 row_mask:0xf bank_mask:0xf
s_nop 1
v_add_f32_dpp v235, v235, v235 row_ror:1 row_mask:0xf bank_mask:0xf
v_rcp_f32 v235, v235
s_nop 0
v_mul_f32 v232, v232, v235
s_nop 0
v_readlane_b32 s26, v232, 0
v_readlane_b32 s27, v232, 1
v_readlane_b32 s28, v232, 2
v_readlane_b32 s29, v232, 3
v_readlane_b32 s30, v232, 4
v_readlane_b32 s31, v232, 5
v_readlane_b32 s32, v232, 6
v_readlane_b32 s33, v232, 7
s_mul_i32 s6, s3, 1040
s_add_u32 s6, s6, 147456
v_add_u32 v5, s6, v2
v_lshrrev_b32 v6, 3, v8
v_mul_u32_u24 v6, 1040, v6
v_lshl_add_u32 v6, v9, 6, v6
s_lshl_b32 s6, s3, 8
s_add_u32 s6, s6, 147456
v_add_u32 v6, s6, v6
s_waitcnt vmcnt(7)
v_lshlrev_b32 v244, 16, v24
v_and_b32 v245, 0xffff0000, v24
v_lshlrev_b32 v246, 16, v25
v_and_b32 v247, 0xffff0000, v25
v_lshlrev_b32 v248, 16, v26
v_and_b32 v249, 0xffff0000, v26
v_lshlrev_b32 v250, 16, v27
v_and_b32 v251, 0xffff0000, v27
v_mul_f32 v216, s26, v244
v_mul_f32 v217, s26, v245
v_mul_f32 v218, s26, v246
v_mul_f32 v219, s26, v247
v_mul_f32 v220, s26, v248
v_mul_f32 v221, s26, v249
v_mul_f32 v222, s26, v250
v_mul_f32 v223, s26, v251
s_waitcnt vmcnt(6)
v_lshlrev_b32 v244, 16, v28
v_and_b32 v245, 0xffff0000, v28
v_lshlrev_b32 v246, 16, v29
v_and_b32 v247, 0xffff0000, v29
v_lshlrev_b32 v248, 16, v30
v_and_b32 v249, 0xffff0000, v30
v_lshlrev_b32 v250, 16, v31
v_and_b32 v251, 0xffff0000, v31
v_fma_f32 v216, v244, s27, v216
v_fma_f32 v217, v245, s27, v217
v_fma_f32 v218, v246, s27, v218
v_fma_f32 v219, v247, s27, v219
v_fma_f32 v220, v248, s27, v220
v_fma_f32 v221, v249, s27, v221
v_fma_f32 v222, v250, s27, v222
v_fma_f32 v223, v251, s27, v223
s_waitcnt vmcnt(5)
v_lshlrev_b32 v244, 16, v32
v_and_b32 v245, 0xffff0000, v32
v_lshlrev_b32 v246, 16, v33
v_and_b32 v247, 0xffff0000, v33
v_lshlrev_b32 v248, 16, v34
v_and_b32 v249, 0xffff0000, v34
v_lshlrev_b32 v250, 16, v35
v_and_b32 v251, 0xffff0000, v35
v_fma_f32 v216, v244, s28, v216
v_fma_f32 v217, v245, s28, v217
v_fma_f32 v218, v246, s28, v218
v_fma_f32 v219, v247, s28, v219
v_fma_f32 v220, v248, s28, v220
v_fma_f32 v221, v249, s28, v221
v_fma_f32 v222, v250, s28, v222
v_fma_f32 v223, v251, s28, v223
s_waitcnt vmcnt(4)
v_lshlrev_b32 v244, 16, v36
v_and_b32 v245, 0xffff0000, v36
v_lshlrev_b32 v246, 16, v37
v_and_b32 v247, 0xffff0000, v37
v_lshlrev_b32 v248, 16, v38
v_and_b32 v249, 0xffff0000, v38
v_lshlrev_b32 v250, 16, v39
v_and_b32 v251, 0xffff0000, v39
v_fma_f32 v216, v244, s29, v216
v_fma_f32 v217, v245, s29, v217
v_fma_f32 v218, v246, s29, v218
v_fma_f32 v219, v247, s29, v219
v_fma_f32 v220, v248, s29, v220
v_fma_f32 v221, v249, s29, v221
v_fma_f32 v222, v250, s29, v222
v_fma_f32 v223, v251, s29, v223
s_waitcnt vmcnt(3)
v_lshlrev_b32 v244, 16, v40
v_and_b32 v245, 0xffff0000, v40
v_lshlrev_b32 v246, 16, v41
v_and_b32 v247, 0xffff0000, v41
v_lshlrev_b32 v248, 16, v42
v_and_b32 v249, 0xffff0000, v42
v_lshlrev_b32 v250, 16, v43
v_and_b32 v251, 0xffff0000, v43
v_fma_f32 v216, v244, s30, v216
v_fma_f32 v217, v245, s30, v217
v_fma_f32 v218, v246, s30, v218
v_fma_f32 v219, v247, s30, v219
v_fma_f32 v220, v248, s30, v220
v_fma_f32 v221, v249, s30, v221
v_fma_f32 v222, v250, s30, v222
v_fma_f32 v223, v251, s30, v223
s_waitcnt vmcnt(2)
v_lshlrev_b32 v244, 16, v44
v_and_b32 v245, 0xffff0000, v44
v_lshlrev_b32 v246, 16, v45
v_and_b32 v247, 0xffff0000, v45
v_lshlrev_b32 v248, 16, v46
v_and_b32 v249, 0xffff0000, v46
v_lshlrev_b32 v250, 16, v47
v_and_b32 v251, 0xffff0000, v47
v_fma_f32 v216, v244, s31, v216
v_fma_f32 v217, v245, s31, v217
v_fma_f32 v218, v246, s31, v218
v_fma_f32 v219, v247, s31, v219
v_fma_f32 v220, v248, s31, v220
v_fma_f32 v221, v249, s31, v221
v_fma_f32 v222, v250, s31, v222
v_fma_f32 v223, v251, s31, v223
s_waitcnt vmcnt(1)
v_lshlrev_b32 v244, 16, v48
v_and_b32 v245, 0xffff0000, v48
v_lshlrev_b32 v246, 16, v49
v_and_b32 v247, 0xffff0000, v49
v_lshlrev_b32 v248, 16, v50
v_and_b32 v249, 0xffff0000, v50
v_lshlrev_b32 v250, 16, v51
v_and_b32 v251, 0xffff0000, v51
v_fma_f32 v216, v244, s32, v216
v_fma_f32 v217, v245, s32, v217
v_fma_f32 v218, v246, s32, v218
v_fma_f32 v219, v247, s32, v219
v_fma_f32 v220, v248, s32, v220
v_fma_f32 v221, v249, s32, v221
v_fma_f32 v222, v250, s32, v222
v_fma_f32 v223, v251, s32, v223
s_waitcnt vmcnt(0)
v_lshlrev_b32 v244, 16, v52
v_and_b32 v245, 0xffff0000, v52
v_lshlrev_b32 v246, 16, v53
v_and_b32 v247, 0xffff0000, v53
v_lshlrev_b32 v248, 16, v54
v_and_b32 v249, 0xffff0000, v54
v_lshlrev_b32 v250, 16, v55
v_and_b32 v251, 0xffff0000, v55
v_fma_f32 v216, v244, s33, v216
v_fma_f32 v217, v245, s33, v217
v_fma_f32 v218, v246, s33, v218
v_fma_f32 v219, v247, s33, v219
v_fma_f32 v220, v248, s33, v220
v_fma_f32 v221, v249, s33, v221
v_fma_f32 v222, v250, s33, v222
v_fma_f32 v223, v251, s33, v223
v_cvt_pk_bf16_f32 v224, v216, v217
v_cvt_pk_bf16_f32 v225, v218, v219
v_cvt_pk_bf16_f32 v226, v220, v221
v_cvt_pk_bf16_f32 v227, v222, v223
ds_write_b128 v5, v[224:227]
s_waitcnt lgkmcnt(0)
s_barrier
ds_read_b128 v[24:27], v6 offset:0
ds_read_b128 v[44:47], v6 offset:2080
ds_read_b128 v[28:31], v6 offset:16
ds_read_b128 v[48:51], v6 offset:2096
ds_read_b128 v[32:35], v6 offset:32
ds_read_b128 v[52:55], v6 offset:2112
ds_read_b128 v[36:39], v6 offset:48
ds_read_b128 v[56:59], v6 offset:2128
v_lshrrev_b32 v5, 5, v1
v_mul_u32_u24 v5, 1088, v5
v_lshl_add_u32 v5, v8, 4, v5
v_and_b32 v7, 1, v9
v_lshl_add_u32 v5, v7, 3, v5
s_mul_i32 s6, s3, 272
s_add_u32 s6, s6, 155648
v_add_u32 v5, s6, v5
v_mul_u32_u24 v7, 272, v8
v_lshl_add_u32 v7, v9, 4, v7
v_add_u32 v7, 155648, v7
s_waitcnt lgkmcnt(0)
v_perm_b32 v64, v24, v24, v16
v_perm_b32 v65, v24, v24, v17
v_perm_b32 v66, v24, v24, v18
v_perm_b32 v67, v24, v24, v19
s_nop 1
v_mfma_f32_16x16x32_bf16 v[80:83], v[64:67], v[88:91], 0
v_perm_b32 v68, v44, v44, v16
v_perm_b32 v69, v44, v44, v17
v_perm_b32 v70, v44, v44, v18
v_perm_b32 v71, v44, v44, v19
s_nop 1
v_mfma_f32_16x16x32_bf16 v[84:87], v[68:71], v[88:91], 0
v_perm_b32 v72, v24, v24, v20
v_perm_b32 v73, v24, v24, v21
v_perm_b32 v74, v24, v24, v22
v_perm_b32 v75, v24, v24, v23
s_nop 1
v_mfma_f32_16x16x32_bf16 v[80:83], v[72:75], v[92:95], v[80:83]
v_perm_b32 v76, v44, v44, v20
v_perm_b32 v77, v44, v44, v21
v_perm_b32 v78, v44, v44, v22
v_perm_b32 v79, v44, v44, v23
s_nop 1
v_mfma_f32_16x16x32_bf16 v[84:87], v[76:79], v[92:95], v[84:87]
v_perm_b32 v64, v25, v25, v16
v_perm_b32 v65, v25, v25, v17
v_perm_b32 v66, v25, v25, v18
v_perm_b32 v67, v25, v25, v19
s_nop 1
v_mfma_f32_16x16x32_bf16 v[80:83], v[64:67], v[96:99], v[80:83]
v_perm_b32 v68, v45, v45, v16
v_perm_b32 v69, v45, v45, v17
v_perm_b32 v70, v45, v45, v18
v_perm_b32 v71, v45, v45, v19
s_nop 1
v_mfma_f32_16x16x32_bf16 v[84:87], v[68:71], v[96:99], v[84:87]
v_perm_b32 v72, v25, v25, v20
v_perm_b32 v73, v25, v25, v21
v_perm_b32 v74, v25, v25, v22
v_perm_b32 v75, v25, v25, v23
s_nop 1
v_mfma_f32_16x16x32_bf16 v[80:83], v[72:75], v[100:103], v[80:83]
v_perm_b32 v76, v45, v45, v20
v_perm_b32 v77, v45, v45, v21
v_perm_b32 v78, v45, v45, v22
v_perm_b32 v79, v45, v45, v23
s_nop 1
v_mfma_f32_16x16x32_bf16 v[84:87], v[76:79], v[100:103], v[84:87]
v_perm_b32 v64, v26, v26, v16
v_perm_b32 v65, v26, v26, v17
v_perm_b32 v66, v26, v26, v18
v_perm_b32 v67, v26, v26, v19
s_nop 1
v_mfma_f32_16x16x32_bf16 v[80:83], v[64:67], v[104:107], v[80:83]
v_perm_b32 v68, v46, v46, v16
v_perm_b32 v69, v46, v46, v17
v_perm_b32 v70, v46, v46, v18
v_perm_b32 v71, v46, v46, v19
s_nop 1
v_mfma_f32_16x16x32_bf16 v[84:87], v[68:71], v[104:107], v[84:87]
v_perm_b32 v72, v26, v26, v20
v_perm_b32 v73, v26, v26, v21
v_perm_b32 v74, v26, v26, v22
v_perm_b32 v75, v26, v26, v23
s_nop 1
v_mfma_f32_16x16x32_bf16 v[80:83], v[72:75], v[108:111], v[80:83]
v_perm_b32 v76, v46, v46, v20
v_perm_b32 v77, v46, v46, v21
v_perm_b32 v78, v46, v46, v22
v_perm_b32 v79, v46, v46, v23
s_nop 1
v_mfma_f32_16x16x32_bf16 v[84:87], v[76:79], v[108:111], v[84:87]
v_perm_b32 v64, v27, v27, v16
v_perm_b32 v65, v27, v27, v17
v_perm_b32 v66, v27, v27, v18
v_perm_b32 v67, v27, v27, v19
s_nop 1
v_mfma_f32_16x16x32_bf16 v[80:83], v[64:67], v[112:115], v[80:83]
v_perm_b32 v68, v47, v47, v16
v_perm_b32 v69, v47, v47, v17
v_perm_b32 v70, v47, v47, v18
v_perm_b32 v71, v47, v47, v19
s_nop 1
v_mfma_f32_16x16x32_bf16 v[84:87], v[68:71], v[112:115], v[84:87]
v_perm_b32 v72, v27, v27, v20
v_perm_b32 v73, v27, v27, v21
v_perm_b32 v74, v27, v27, v22
v_perm_b32 v75, v27, v27, v23
s_nop 1
v_mfma_f32_16x16x32_bf16 v[80:83], v[72:75], v[116:119], v[80:83]
v_perm_b32 v76, v47, v47, v20
v_perm_b32 v77, v47, v47, v21
v_perm_b32 v78, v47, v47, v22
v_perm_b32 v79, v47, v47, v23
s_nop 1
v_mfma_f32_16x16x32_bf16 v[84:87], v[76:79], v[116:119], v[84:87]
v_perm_b32 v64, v28, v28, v16
v_perm_b32 v65, v28, v28, v17
v_perm_b32 v66, v28, v28, v18
v_perm_b32 v67, v28, v28, v19
s_nop 1
v_mfma_f32_16x16x32_bf16 v[80:83], v[64:67], v[120:123], v[80:83]
v_perm_b32 v68, v48, v48, v16
v_perm_b32 v69, v48, v48, v17
v_perm_b32 v70, v48, v48, v18
v_perm_b32 v71, v48, v48, v19
s_nop 1
v_mfma_f32_16x16x32_bf16 v[84:87], v[68:71], v[120:123], v[84:87]
v_perm_b32 v72, v28, v28, v20
v_perm_b32 v73, v28, v28, v21
v_perm_b32 v74, v28, v28, v22
v_perm_b32 v75, v28, v28, v23
s_nop 1
v_mfma_f32_16x16x32_bf16 v[80:83], v[72:75], v[124:127], v[80:83]
v_perm_b32 v76, v48, v48, v20
v_perm_b32 v77, v48, v48, v21
v_perm_b32 v78, v48, v48, v22
v_perm_b32 v79, v48, v48, v23
s_nop 1
v_mfma_f32_16x16x32_bf16 v[84:87], v[76:79], v[124:127], v[84:87]
v_perm_b32 v64, v29, v29, v16
v_perm_b32 v65, v29, v29, v17
v_perm_b32 v66, v29, v29, v18
v_perm_b32 v67, v29, v29, v19
s_nop 1
v_mfma_f32_16x16x32_bf16 v[80:83], v[64:67], v[128:131], v[80:83]
v_perm_b32 v68, v49, v49, v16
v_perm_b32 v69, v49, v49, v17
v_perm_b32 v70, v49, v49, v18
v_perm_b32 v71, v49, v49, v19
s_nop 1
v_mfma_f32_16x16x32_bf16 v[84:87], v[68:71], v[128:131], v[84:87]
v_perm_b32 v72, v29, v29, v20
v_perm_b32 v73, v29, v29, v21
v_perm_b32 v74, v29, v29, v22
v_perm_b32 v75, v29, v29, v23
s_nop 1
v_mfma_f32_16x16x32_bf16 v[80:83], v[72:75], v[132:135], v[80:83]
v_perm_b32 v76, v49, v49, v20
v_perm_b32 v77, v49, v49, v21
v_perm_b32 v78, v49, v49, v22
v_perm_b32 v79, v49, v49, v23
s_nop 1
v_mfma_f32_16x16x32_bf16 v[84:87], v[76:79], v[132:135], v[84:87]
v_perm_b32 v64, v30, v30, v16
v_perm_b32 v65, v30, v30, v17
v_perm_b32 v66, v30, v30, v18
v_perm_b32 v67, v30, v30, v19
s_nop 1
v_mfma_f32_16x16x32_bf16 v[80:83], v[64:67], v[136:139], v[80:83]
v_perm_b32 v68, v50, v50, v16
v_perm_b32 v69, v50, v50, v17
v_perm_b32 v70, v50, v50, v18
v_perm_b32 v71, v50, v50, v19
s_nop 1
v_mfma_f32_16x16x32_bf16 v[84:87], v[68:71], v[136:139], v[84:87]
v_perm_b32 v72, v30, v30, v20
v_perm_b32 v73, v30, v30, v21
v_perm_b32 v74, v30, v30, v22
v_perm_b32 v75, v30, v30, v23
s_nop 1
v_mfma_f32_16x16x32_bf16 v[80:83], v[72:75], v[140:143], v[80:83]
v_perm_b32 v76, v50, v50, v20
v_perm_b32 v77, v50, v50, v21
v_perm_b32 v78, v50, v50, v22
v_perm_b32 v79, v50, v50, v23
s_nop 1
v_mfma_f32_16x16x32_bf16 v[84:87], v[76:79], v[140:143], v[84:87]
v_perm_b32 v64, v31, v31, v16
v_perm_b32 v65, v31, v31, v17
v_perm_b32 v66, v31, v31, v18
v_perm_b32 v67, v31, v31, v19
s_nop 1
v_mfma_f32_16x16x32_bf16 v[80:83], v[64:67], v[144:147], v[80:83]
v_perm_b32 v68, v51, v51, v16
v_perm_b32 v69, v51, v51, v17
v_perm_b32 v70, v51, v51, v18
v_perm_b32 v71, v51, v51, v19
s_nop 1
v_mfma_f32_16x16x32_bf16 v[84:87], v[68:71], v[144:147], v[84:87]
v_perm_b32 v72, v31, v31, v20
v_perm_b32 v73, v31, v31, v21
v_perm_b32 v74, v31, v31, v22
v_perm_b32 v75, v31, v31, v23
s_nop 1
v_mfma_f32_16x16x32_bf16 v[80:83], v[72:75], v[148:151], v[80:83]
v_perm_b32 v76, v51, v51, v20
v_perm_b32 v77, v51, v51, v21
v_perm_b32 v78, v51, v51, v22
v_perm_b32 v79, v51, v51, v23
s_nop 1
v_mfma_f32_16x16x32_bf16 v[84:87], v[76:79], v[148:151], v[84:87]
v_perm_b32 v64, v32, v32, v16
v_perm_b32 v65, v32, v32, v17
v_perm_b32 v66, v32, v32, v18
v_perm_b32 v67, v32, v32, v19
s_nop 1
v_mfma_f32_16x16x32_bf16 v[80:83], v[64:67], v[152:155], v[80:83]
v_perm_b32 v68, v52, v52, v16
v_perm_b32 v69, v52, v52, v17
v_perm_b32 v70, v52, v52, v18
v_perm_b32 v71, v52, v52, v19
s_nop 1
v_mfma_f32_16x16x32_bf16 v[84:87], v[68:71], v[152:155], v[84:87]
v_perm_b32 v72, v32, v32, v20
v_perm_b32 v73, v32, v32, v21
v_perm_b32 v74, v32, v32, v22
v_perm_b32 v75, v32, v32, v23
s_nop 1
v_mfma_f32_16x16x32_bf16 v[80:83], v[72:75], v[156:159], v[80:83]
v_perm_b32 v76, v52, v52, v20
v_perm_b32 v77, v52, v52, v21
v_perm_b32 v78, v52, v52, v22
v_perm_b32 v79, v52, v52, v23
s_nop 1
v_mfma_f32_16x16x32_bf16 v[84:87], v[76:79], v[156:159], v[84:87]
v_perm_b32 v64, v33, v33, v16
v_perm_b32 v65, v33, v33, v17
v_perm_b32 v66, v33, v33, v18
v_perm_b32 v67, v33, v33, v19
s_nop 1
v_mfma_f32_16x16x32_bf16 v[80:83], v[64:67], v[160:163], v[80:83]
v_perm_b32 v68, v53, v53, v16
v_perm_b32 v69, v53, v53, v17
v_perm_b32 v70, v53, v53, v18
v_perm_b32 v71, v53, v53, v19
s_nop 1
v_mfma_f32_16x16x32_bf16 v[84:87], v[68:71], v[160:163], v[84:87]
v_perm_b32 v72, v33, v33, v20
v_perm_b32 v73, v33, v33, v21
v_perm_b32 v74, v33, v33, v22
v_perm_b32 v75, v33, v33, v23
s_nop 1
v_mfma_f32_16x16x32_bf16 v[80:83], v[72:75], v[164:167], v[80:83]
v_perm_b32 v76, v53, v53, v20
v_perm_b32 v77, v53, v53, v21
v_perm_b32 v78, v53, v53, v22
v_perm_b32 v79, v53, v53, v23
s_nop 1
v_mfma_f32_16x16x32_bf16 v[84:87], v[76:79], v[164:167], v[84:87]
v_perm_b32 v64, v34, v34, v16
v_perm_b32 v65, v34, v34, v17
v_perm_b32 v66, v34, v34, v18
v_perm_b32 v67, v34, v34, v19
s_nop 1
v_mfma_f32_16x16x32_bf16 v[80:83], v[64:67], v[168:171], v[80:83]
v_perm_b32 v68, v54, v54, v16
v_perm_b32 v69, v54, v54, v17
v_perm_b32 v70, v54, v54, v18
v_perm_b32 v71, v54, v54, v19
s_nop 1
v_mfma_f32_16x16x32_bf16 v[84:87], v[68:71], v[168:171], v[84:87]
v_perm_b32 v72, v34, v34, v20
v_perm_b32 v73, v34, v34, v21
v_perm_b32 v74, v34, v34, v22
v_perm_b32 v75, v34, v34, v23
s_nop 1
v_mfma_f32_16x16x32_bf16 v[80:83], v[72:75], v[172:175], v[80:83]
v_perm_b32 v76, v54, v54, v20
v_perm_b32 v77, v54, v54, v21
v_perm_b32 v78, v54, v54, v22
v_perm_b32 v79, v54, v54, v23
s_nop 1
v_mfma_f32_16x16x32_bf16 v[84:87], v[76:79], v[172:175], v[84:87]
v_perm_b32 v64, v35, v35, v16
v_perm_b32 v65, v35, v35, v17
v_perm_b32 v66, v35, v35, v18
v_perm_b32 v67, v35, v35, v19
s_nop 1
v_mfma_f32_16x16x32_bf16 v[80:83], v[64:67], v[176:179], v[80:83]
v_perm_b32 v68, v55, v55, v16
v_perm_b32 v69, v55, v55, v17
v_perm_b32 v70, v55, v55, v18
v_perm_b32 v71, v55, v55, v19
s_nop 1
v_mfma_f32_16x16x32_bf16 v[84:87], v[68:71], v[176:179], v[84:87]
v_perm_b32 v72, v35, v35, v20
v_perm_b32 v73, v35, v35, v21
v_perm_b32 v74, v35, v35, v22
v_perm_b32 v75, v35, v35, v23
s_nop 1
v_mfma_f32_16x16x32_bf16 v[80:83], v[72:75], v[180:183], v[80:83]
v_perm_b32 v76, v55, v55, v20
v_perm_b32 v77, v55, v55, v21
v_perm_b32 v78, v55, v55, v22
v_perm_b32 v79, v55, v55, v23
s_nop 1
v_mfma_f32_16x16x32_bf16 v[84:87], v[76:79], v[180:183], v[84:87]
v_perm_b32 v64, v36, v36, v16
v_perm_b32 v65, v36, v36, v17
v_perm_b32 v66, v36, v36, v18
v_perm_b32 v67, v36, v36, v19
s_nop 1
v_mfma_f32_16x16x32_bf16 v[80:83], v[64:67], v[184:187], v[80:83]
v_perm_b32 v68, v56, v56, v16
v_perm_b32 v69, v56, v56, v17
v_perm_b32 v70, v56, v56, v18
v_perm_b32 v71, v56, v56, v19
s_nop 1
v_mfma_f32_16x16x32_bf16 v[84:87], v[68:71], v[184:187], v[84:87]
v_perm_b32 v72, v36, v36, v20
v_perm_b32 v73, v36, v36, v21
v_perm_b32 v74, v36, v36, v22
v_perm_b32 v75, v36, v36, v23
s_nop 1
v_mfma_f32_16x16x32_bf16 v[80:83], v[72:75], v[188:191], v[80:83]
v_perm_b32 v76, v56, v56, v20
v_perm_b32 v77, v56, v56, v21
v_perm_b32 v78, v56, v56, v22
v_perm_b32 v79, v56, v56, v23
s_nop 1
v_mfma_f32_16x16x32_bf16 v[84:87], v[76:79], v[188:191], v[84:87]
v_perm_b32 v64, v37, v37, v16
v_perm_b32 v65, v37, v37, v17
v_perm_b32 v66, v37, v37, v18
v_perm_b32 v67, v37, v37, v19
s_nop 1
v_mfma_f32_16x16x32_bf16 v[80:83], v[64:67], v[192:195], v[80:83]
v_perm_b32 v68, v57, v57, v16
v_perm_b32 v69, v57, v57, v17
v_perm_b32 v70, v57, v57, v18
v_perm_b32 v71, v57, v57, v19
s_nop 1
v_mfma_f32_16x16x32_bf16 v[84:87], v[68:71], v[192:195], v[84:87]
v_perm_b32 v72, v37, v37, v20
v_perm_b32 v73, v37, v37, v21
v_perm_b32 v74, v37, v37, v22
v_perm_b32 v75, v37, v37, v23
s_nop 1
v_mfma_f32_16x16x32_bf16 v[80:83], v[72:75], v[196:199], v[80:83]
v_perm_b32 v76, v57, v57, v20
v_perm_b32 v77, v57, v57, v21
v_perm_b32 v78, v57, v57, v22
v_perm_b32 v79, v57, v57, v23
s_nop 1
v_mfma_f32_16x16x32_bf16 v[84:87], v[76:79], v[196:199], v[84:87]
v_perm_b32 v64, v38, v38, v16
v_perm_b32 v65, v38, v38, v17
v_perm_b32 v66, v38, v38, v18
v_perm_b32 v67, v38, v38, v19
s_nop 1
v_mfma_f32_16x16x32_bf16 v[80:83], v[64:67], v[200:203], v[80:83]
v_perm_b32 v68, v58, v58, v16
v_perm_b32 v69, v58, v58, v17
v_perm_b32 v70, v58, v58, v18
v_perm_b32 v71, v58, v58, v19
s_nop 1
v_mfma_f32_16x16x32_bf16 v[84:87], v[68:71], v[200:203], v[84:87]
v_perm_b32 v72, v38, v38, v20
v_perm_b32 v73, v38, v38, v21
v_perm_b32 v74, v38, v38, v22
v_perm_b32 v75, v38, v38, v23
s_nop 1
v_mfma_f32_16x16x32_bf16 v[80:83], v[72:75], v[204:207], v[80:83]
v_perm_b32 v76, v58, v58, v20
v_perm_b32 v77, v58, v58, v21
v_perm_b32 v78, v58, v58, v22
v_perm_b32 v79, v58, v58, v23
s_nop 1
v_mfma_f32_16x16x32_bf16 v[84:87], v[76:79], v[204:207], v[84:87]
v_perm_b32 v64, v39, v39, v16
v_perm_b32 v65, v39, v39, v17
v_perm_b32 v66, v39, v39, v18
v_perm_b32 v67, v39, v39, v19
s_nop 1
v_mfma_f32_16x16x32_bf16 v[80:83], v[64:67], v[208:211], v[80:83]
v_perm_b32 v68, v59, v59, v16
v_perm_b32 v69, v59, v59, v17
v_perm_b32 v70, v59, v59, v18
v_perm_b32 v71, v59, v59, v19
s_nop 1
v_mfma_f32_16x16x32_bf16 v[84:87], v[68:71], v[208:211], v[84:87]
v_perm_b32 v72, v39, v39, v20
v_perm_b32 v73, v39, v39, v21
v_perm_b32 v74, v39, v39, v22
v_perm_b32 v75, v39, v39, v23
s_nop 1
v_mfma_f32_16x16x32_bf16 v[80:83], v[72:75], v[212:215], v[80:83]
v_perm_b32 v76, v59, v59, v20
v_perm_b32 v77, v59, v59, v21
v_perm_b32 v78, v59, v59, v22
v_perm_b32 v79, v59, v59, v23
s_nop 1
v_mfma_f32_16x16x32_bf16 v[84:87], v[76:79], v[212:215], v[84:87]
s_nop 0
v_cvt_pk_bf16_f32 v244, v80, v81
v_cvt_pk_bf16_f32 v245, v82, v83
ds_write_b64 v5, v[244:245] offset:0
s_nop 3
v_cvt_pk_bf16_f32 v246, v84, v85
v_cvt_pk_bf16_f32 v247, v86, v87
ds_write_b64 v5, v[246:247] offset:2176
s_waitcnt lgkmcnt(0)
s_barrier
ds_read_b128 v[64:67], v7 offset:0
ds_read_b128 v[68:71], v7 offset:64
ds_read_b128 v[72:75], v7 offset:128
ds_read_b128 v[76:79], v7 offset:192
v_mul_u32_u24 v5, 36864, v9
v_lshl_add_u32 v5, v8, 4, v5
s_mul_i32 s6, s4, 1152
s_add_u32 s6, s6, 5242880
s_lshl_b32 s7, s3, 5
v_add_u32 v6, s7, v5
s_lshl_b32 s7, s3, 8
v_add_u32 v5, s7, v5
s_waitcnt lgkmcnt(0)
v_mfma_f32_16x16x32_bf16 v[24:27], v[64:67], a[96:99], 0
v_mfma_f32_16x16x32_bf16 v[24:27], v[68:71], a[100:103], v[24:27]
v_mfma_f32_16x16x32_bf16 v[24:27], v[72:75], a[104:107], v[24:27]
v_mfma_f32_16x16x32_bf16 v[24:27], v[76:79], a[108:111], v[24:27]
v_mfma_f32_16x16x32_bf16 v[28:31], v[64:67], a[112:115], 0
v_mfma_f32_16x16x32_bf16 v[28:31], v[68:71], a[116:119], v[28:31]
v_mfma_f32_16x16x32_bf16 v[28:31], v[72:75], a[120:123], v[28:31]
v_mfma_f32_16x16x32_bf16 v[28:31], v[76:79], a[124:127], v[28:31]
v_mfma_f32_16x16x32_bf16 v[32:35], v[64:67], a[128:131], 0
v_mfma_f32_16x16x32_bf16 v[32:35], v[68:71], a[132:135], v[32:35]
v_mfma_f32_16x16x32_bf16 v[32:35], v[72:75], a[136:139], v[32:35]
v_mfma_f32_16x16x32_bf16 v[32:35], v[76:79], a[140:143], v[32:35]
v_mfma_f32_16x16x32_bf16 v[36:39], v[64:67], a[144:147], 0
v_mfma_f32_16x16x32_bf16 v[36:39], v[68:71], a[148:151], v[36:39]
v_mfma_f32_16x16x32_bf16 v[36:39], v[72:75], a[152:155], v[36:39]
v_mfma_f32_16x16x32_bf16 v[36:39], v[76:79], a[156:159], v[36:39]
v_mfma_f32_16x16x32_bf16 v[40:43], v[64:67], a[160:163], 0
v_mfma_f32_16x16x32_bf16 v[40:43], v[68:71], a[164:167], v[40:43]
v_mfma_f32_16x16x32_bf16 v[40:43], v[72:75], a[168:171], v[40:43]
v_mfma_f32_16x16x32_bf16 v[40:43], v[76:79], a[172:175], v[40:43]
v_mfma_f32_16x16x32_bf16 v[44:47], v[64:67], a[176:179], 0
v_mfma_f32_16x16x32_bf16 v[44:47], v[68:71], a[180:183], v[44:47]
v_mfma_f32_16x16x32_bf16 v[44:47], v[72:75], a[184:187], v[44:47]
v_mfma_f32_16x16x32_bf16 v[44:47], v[76:79], a[188:191], v[44:47]
v_mfma_f32_16x16x32_bf16 v[48:51], v[64:67], a[192:195], 0
v_mfma_f32_16x16x32_bf16 v[48:51], v[68:71], a[196:199], v[48:51]
v_mfma_f32_16x16x32_bf16 v[48:51], v[72:75], a[200:203], v[48:51]
v_mfma_f32_16x16x32_bf16 v[48:51], v[76:79], a[204:207], v[48:51]
v_mfma_f32_16x16x32_bf16 v[52:55], v[64:67], a[208:211], 0
v_mfma_f32_16x16x32_bf16 v[52:55], v[68:71], a[212:215], v[52:55]
v_mfma_f32_16x16x32_bf16 v[52:55], v[72:75], a[216:219], v[52:55]
v_mfma_f32_16x16x32_bf16 v[52:55], v[76:79], a[220:223], v[52:55]
v_mfma_f32_16x16x32_bf16 v[56:59], v[64:67], a[224:227], 0
v_mfma_f32_16x16x32_bf16 v[56:59], v[68:71], a[228:231], v[56:59]
v_mfma_f32_16x16x32_bf16 v[56:59], v[72:75], a[232:235], v[56:59]
v_mfma_f32_16x16x32_bf16 v[56:59], v[76:79], a[236:239], v[56:59]
v_add_f32 v24, v24, v25
v_add_f32 v26, v26, v27
v_add_f32 v216, v24, v26
v_min_u32 v216, -2, v216
v_add_f32 v28, v28, v29
v_add_f32 v30, v30, v31
v_add_f32 v217, v28, v30
v_min_u32 v217, -2, v217
v_add_f32 v32, v32, v33
v_add_f32 v34, v34, v35
v_add_f32 v218, v32, v34
v_min_u32 v218, -2, v218
v_add_f32 v36, v36, v37
v_add_f32 v38, v38, v39
v_add_f32 v219, v36, v38
v_min_u32 v219, -2, v219
v_add_f32 v40, v40, v41
v_add_f32 v42, v42, v43
v_add_f32 v220, v40, v42
v_min_u32 v220, -2, v220
v_add_f32 v44, v44, v45
v_add_f32 v46, v46, v47
v_add_f32 v221, v44, v46
v_min_u32 v221, -2, v221
v_add_f32 v48, v48, v49
v_add_f32 v50, v50, v51
v_add_f32 v222, v48, v50
v_min_u32 v222, -2, v222
v_add_f32 v52, v52, v53
v_add_f32 v54, v54, v55
v_add_f32 v223, v52, v54
v_min_u32 v223, -2, v223
v_add_f32 v56, v56, v57
v_add_f32 v58, v58, v59
v_add_f32 v224, v56, v58
v_min_u32 v224, -2, v224
v_cvt_pk_bf16_f32 v216, v216, v217
v_min_u32 v216, -2, v216
v_cvt_pk_bf16_f32 v217, v218, v219
v_min_u32 v217, -2, v217
v_cvt_pk_bf16_f32 v218, v220, v221
v_min_u32 v218, -2, v218
v_cvt_pk_bf16_f32 v219, v222, v223
v_min_u32 v219, -2, v219
buffer_store_dwordx4 v[216:219], v5, s[64:67], s6 offen sc1
v_mov_b32_dpp v229, v224 row_shl:2 row_mask:0xf bank_mask:0xf
v_cvt_pk_bf16_f32 v228, v224, v229
v_min_u32 v228, -2, v228
s_nop 1
v_mov_b32_dpp v229, v228 row_shl:4 row_mask:0xf bank_mask:0xf
v_mov_b32_dpp v230, v228 row_shl:8 row_mask:0xf bank_mask:0xf
v_mov_b32_dpp v231, v228 row_shl:12 row_mask:0xf bank_mask:0xf
s_mov_b32 exec_lo, 0x00030003
s_mov_b32 exec_hi, 196611
buffer_store_dwordx4 v[228:231], v6, s[64:67], s6 offen offset:1024 sc1
s_mov_b64 exec, -1
s_nop 1
s_branch B_final
D_role:
s_lshr_b32 s10, s4, 3
s_lshr_b32 s80, s4, 0
s_and_b32 s11, s80, 7
v_xor_b32 v10, 32, v2
v_mov_b32 v76, -1
v_mov_b32 v77, -1
v_mov_b32 v78, -1
v_mov_b32 v79, -1
s_waitcnt lgkmcnt(0)
s_mov_b32 s64, s42
s_mov_b32 s65, s43
s_mov_b32 s66, 16777216
s_mov_b32 s67, 0x20000
s_lshl_b32 s6, s10, 22
s_add_u32 s52, s28, s6
s_addc_u32 s53, s29, 0
s_mov_b32 s54, 4194304
s_mov_b32 s55, 0x20000
s_cmp_eq_u32 s3, 3
s_cbranch_scc1 L_clr3_37
s_mul_i32 s6, s4, 9216
s_mul_i32 s7, s3, 4608
s_add_u32 s6, s6, s7
s_add_u32 s6, s6, 4194304
s_mul_i32 s7, s4, 4608
s_add_u32 s7, s7, 5242880
s_cmp_eq_u32 s3, 2
s_cselect_b32 s6, s7, s6
buffer_store_dwordx4 v[76:79], v2, s[64:67], s6 offen offset:0 sc1
buffer_store_dwordx4 v[76:79], v2, s[64:67], s6 offen offset:1024 sc1
buffer_store_dwordx4 v[76:79], v2, s[64:67], s6 offen offset:2048 sc1
buffer_store_dwordx4 v[76:79], v2, s[64:67], s6 offen offset:3072 sc1
s_add_u32 s6, s6, 4096
s_mov_b64 exec, 0xffffffff
buffer_store_dwordx4 v[76:79], v2, s[64:67], s6 offen offset:0 sc1
s_mov_b64 exec, -1
s_branch L_clrd_38
L_clr3_37:
s_mul_i32 s6, s4, 4096
s_add_u32 s6, s6, 0
buffer_store_dwordx4 v[76:79], v2, s[64:67], s6 offen offset:0 sc1
buffer_store_dwordx4 v[76:79], v2, s[64:67], s6 offen offset:1024 sc1
buffer_store_dwordx4 v[76:79], v2, s[64:67], s6 offen offset:2048 sc1
buffer_store_dwordx4 v[76:79], v2, s[64:67], s6 offen offset:3072 sc1
s_mov_b64 exec, 0xffff
s_mul_i32 s6, s4, 256
s_mul_i32 s7, s4, 256
s_add_u32 s7, s7, 327680
s_add_u32 s6, s6, 262144
v_lshrrev_b32 v6, 2, v1
v_mul_u32_u24 v6, 0, v6
v_add_u32 v6, v6, v2
buffer_store_dwordx4 v[76:79], v2, s[64:67], s6 offen sc1
buffer_store_dwordx4 v[76:79], v6, s[64:67], s7 offen sc1
s_mov_b64 exec, 3
s_mul_i32 s6, s4, 32
s_add_u32 s6, s6, 393216
s_lshr_b32 s7, s4, 2
s_mul_i32 s7, s7, 4224
s_add_u32 s6, s6, s7
v_mul_u32_u24 v5, 16, v1
buffer_store_dwordx4 v[76:79], v5, s[64:67], s6 offen sc1
s_mov_b64 exec, -1
L_clrd_38:
s_mov_b32 s68, s40
s_mov_b32 s69, s41
s_mov_b32 s70, 256
s_mov_b32 s71, 0x20000
s_mov_b32 s72, s38
s_mov_b32 s73, s39
s_mov_b32 s74, 9216
s_mov_b32 s75, 0x20000
s_mul_i32 s12, s3, 17408
s_lshl_b32 s13, s11, 2
s_add_u32 s13, s13, s3
s_lshl_b32 s13, s13, 12
s_add_u32 m0, s12, 0
s_add_u32 s6, s13, 0
buffer_load_dwordx4 v2, s[52:55], s6 offen nt lds
s_add_u32 m0, s12, 1088
s_add_u32 s6, s13, 1024
buffer_load_dwordx4 v2, s[52:55], s6 offen nt lds
s_add_u32 m0, s12, 2176
s_add_u32 s6, s13, 2048
buffer_load_dwordx4 v2, s[52:55], s6 offen nt lds
s_add_u32 m0, s12, 3264
s_add_u32 s6, s13, 3072
buffer_load_dwordx4 v2, s[52:55], s6 offen nt lds
s_add_u32 m0, s12, 4352
s_add_u32 s6, s13, 131072
buffer_load_dwordx4 v2, s[52:55], s6 offen nt lds
s_add_u32 m0, s12, 5440
s_add_u32 s6, s13, 132096
buffer_load_dwordx4 v2, s[52:55], s6 offen nt lds
s_add_u32 m0, s12, 6528
s_add_u32 s6, s13, 133120
buffer_load_dwordx4 v2, s[52:55], s6 offen nt lds
s_add_u32 m0, s12, 7616
s_add_u32 s6, s13, 134144
buffer_load_dwordx4 v2, s[52:55], s6 offen nt lds
s_waitcnt vmcnt(8)
v_mov_b32 v7, 1
s_mov_b64 exec, 1
buffer_atomic_add v7, off, s[68:71], 0 offset:0
s_mov_b64 exec, -1
s_add_u32 m0, s12, 8704
s_add_u32 s6, s13, 262144
s_waitcnt vmcnt(3)
buffer_load_dwordx4 v10, s[52:55], s6 offen nt lds
s_add_u32 m0, s12, 9792
s_add_u32 s6, s13, 263168
s_waitcnt vmcnt(3)
buffer_load_dwordx4 v10, s[52:55], s6 offen nt lds
s_add_u32 m0, s12, 10880
s_add_u32 s6, s13, 264192
s_waitcnt vmcnt(3)
buffer_load_dwordx4 v10, s[52:55], s6 offen nt lds
s_add_u32 m0, s12, 11968
s_add_u32 s6, s13, 265216
s_waitcnt vmcnt(3)
buffer_load_dwordx4 v10, s[52:55], s6 offen nt lds
s_add_u32 m0, s12, 13056
s_add_u32 s6, s13, 393216
s_waitcnt vmcnt(3)
buffer_load_dwordx4 v10, s[52:55], s6 offen nt lds
s_add_u32 m0, s12, 14144
s_add_u32 s6, s13, 394240
s_waitcnt vmcnt(3)
buffer_load_dwordx4 v10, s[52:55], s6 offen nt lds
s_add_u32 m0, s12, 15232
s_add_u32 s6, s13, 395264
s_waitcnt vmcnt(3)
buffer_load_dwordx4 v10, s[52:55], s6 offen nt lds
s_add_u32 m0, s12, 16320
s_add_u32 s6, s13, 396288
s_waitcnt vmcnt(3)
buffer_load_dwordx4 v10, s[52:55], s6 offen nt lds
s_add_u32 m0, s12, 69632
s_add_u32 s6, s13, 524288
s_waitcnt vmcnt(3)
buffer_load_dwordx4 v2, s[52:55], s6 offen nt lds
s_add_u32 m0, s12, 70720
s_add_u32 s6, s13, 525312
s_waitcnt vmcnt(3)
buffer_load_dwordx4 v2, s[52:55], s6 offen nt lds
s_add_u32 m0, s12, 71808
s_add_u32 s6, s13, 526336
s_waitcnt vmcnt(3)
buffer_load_dwordx4 v2, s[52:55], s6 offen nt lds
s_add_u32 m0, s12, 72896
s_add_u32 s6, s13, 527360
s_waitcnt vmcnt(3)
buffer_load_dwordx4 v2, s[52:55], s6 offen nt lds
s_add_u32 m0, s12, 73984
s_add_u32 s6, s13, 655360
s_waitcnt vmcnt(3)
buffer_load_dwordx4 v2, s[52:55], s6 offen nt lds
s_add_u32 m0, s12, 75072
s_add_u32 s6, s13, 656384
s_waitcnt vmcnt(3)
buffer_load_dwordx4 v2, s[52:55], s6 offen nt lds
s_add_u32 m0, s12, 76160
s_add_u32 s6, s13, 657408
s_waitcnt vmcnt(3)
buffer_load_dwordx4 v2, s[52:55], s6 offen nt lds
s_add_u32 m0, s12, 77248
s_add_u32 s6, s13, 658432
s_waitcnt vmcnt(3)
buffer_load_dwordx4 v2, s[52:55], s6 offen nt lds
s_add_u32 m0, s12, 78336
s_add_u32 s6, s13, 786432
s_waitcnt vmcnt(3)
buffer_load_dwordx4 v10, s[52:55], s6 offen nt lds
s_add_u32 m0, s12, 79424
s_add_u32 s6, s13, 787456
s_waitcnt vmcnt(3)
buffer_load_dwordx4 v10, s[52:55], s6 offen nt lds
s_add_u32 m0, s12, 80512
s_add_u32 s6, s13, 788480
s_waitcnt vmcnt(3)
buffer_load_dwordx4 v10, s[52:55], s6 offen nt lds
s_add_u32 m0, s12, 81600
s_add_u32 s6, s13, 789504
s_waitcnt vmcnt(3)
buffer_load_dwordx4 v10, s[52:55], s6 offen nt lds
s_add_u32 m0, s12, 82688
s_add_u32 s6, s13, 917504
s_waitcnt vmcnt(3)
buffer_load_dwordx4 v10, s[52:55], s6 offen nt lds
s_add_u32 m0, s12, 83776
s_add_u32 s6, s13, 918528
s_waitcnt vmcnt(3)
buffer_load_dwordx4 v10, s[52:55], s6 offen nt lds
s_add_u32 m0, s12, 84864
s_add_u32 s6, s13, 919552
s_waitcnt vmcnt(3)
buffer_load_dwordx4 v10, s[52:55], s6 offen nt lds
s_add_u32 m0, s12, 85952
s_add_u32 s6, s13, 920576
s_waitcnt vmcnt(3)
buffer_load_dwordx4 v10, s[52:55], s6 offen nt lds
s_add_u32 s6, s13, 1048576
s_waitcnt vmcnt(3)
buffer_load_dwordx4 a[128:131], v2, s[52:55], s6 offen nt
s_add_u32 s6, s13, 1049600
s_waitcnt vmcnt(3)
buffer_load_dwordx4 a[132:135], v2, s[52:55], s6 offen nt
s_add_u32 s6, s13, 1050624
s_waitcnt vmcnt(3)
buffer_load_dwordx4 a[136:139], v2, s[52:55], s6 offen nt
s_add_u32 s6, s13, 1051648
s_waitcnt vmcnt(3)
buffer_load_dwordx4 a[140:143], v2, s[52:55], s6 offen nt
s_add_u32 s6, s13, 1179648
s_waitcnt vmcnt(3)
buffer_load_dwordx4 a[144:147], v2, s[52:55], s6 offen nt
s_add_u32 s6, s13, 1180672
s_waitcnt vmcnt(3)
buffer_load_dwordx4 a[148:151], v2, s[52:55], s6 offen nt
s_add_u32 s6, s13, 1181696
s_waitcnt vmcnt(3)
buffer_load_dwordx4 a[152:155], v2, s[52:55], s6 offen nt
s_add_u32 s6, s13, 1182720
s_waitcnt vmcnt(3)
buffer_load_dwordx4 a[156:159], v2, s[52:55], s6 offen nt
s_add_u32 s6, s13, 1310720
s_waitcnt vmcnt(3)
buffer_load_dwordx4 a[160:163], v10, s[52:55], s6 offen nt
s_add_u32 s6, s13, 1311744
s_waitcnt vmcnt(3)
buffer_load_dwordx4 a[164:167], v10, s[52:55], s6 offen nt
s_add_u32 s6, s13, 1312768
s_waitcnt vmcnt(3)
buffer_load_dwordx4 a[168:171], v10, s[52:55], s6 offen nt
s_add_u32 s6, s13, 1313792
s_waitcnt vmcnt(3)
buffer_load_dwordx4 a[172:175], v10, s[52:55], s6 offen nt
s_add_u32 s6, s13, 1441792
s_waitcnt vmcnt(3)
buffer_load_dwordx4 a[176:179], v10, s[52:55], s6 offen nt
s_add_u32 s6, s13, 1442816
s_waitcnt vmcnt(3)
buffer_load_dwordx4 a[180:183], v10, s[52:55], s6 offen nt
s_add_u32 s6, s13, 1443840
s_waitcnt vmcnt(3)
buffer_load_dwordx4 a[184:187], v10, s[52:55], s6 offen nt
s_add_u32 s6, s13, 1444864
s_waitcnt vmcnt(3)
buffer_load_dwordx4 a[188:191], v10, s[52:55], s6 offen nt
s_add_u32 s6, s13, 1572864
s_waitcnt vmcnt(3)
buffer_load_dwordx4 a[192:195], v2, s[52:55], s6 offen nt
s_add_u32 s6, s13, 1573888
s_waitcnt vmcnt(3)
buffer_load_dwordx4 a[196:199], v2, s[52:55], s6 offen nt
s_add_u32 s6, s13, 1574912
s_waitcnt vmcnt(3)
buffer_load_dwordx4 a[200:203], v2, s[52:55], s6 offen nt
s_add_u32 s6, s13, 1575936
s_waitcnt vmcnt(3)
buffer_load_dwordx4 a[204:207], v2, s[52:55], s6 offen nt
s_add_u32 s6, s13, 1703936
s_waitcnt vmcnt(3)
buffer_load_dwordx4 a[208:211], v2, s[52:55], s6 offen nt
s_add_u32 s6, s13, 1704960
s_waitcnt vmcnt(3)
buffer_load_dwordx4 a[212:215], v2, s[52:55], s6 offen nt
s_add_u32 s6, s13, 1705984
s_waitcnt vmcnt(3)
buffer_load_dwordx4 a[216:219], v2, s[52:55], s6 offen nt
s_add_u32 s6, s13, 1707008
s_waitcnt vmcnt(3)
buffer_load_dwordx4 a[220:223], v2, s[52:55], s6 offen nt
s_add_u32 s6, s13, 1835008
s_waitcnt vmcnt(3)
buffer_load_dwordx4 a[224:227], v10, s[52:55], s6 offen nt
s_add_u32 s6, s13, 1836032
s_waitcnt vmcnt(3)
buffer_load_dwordx4 a[228:231], v10, s[52:55], s6 offen nt
s_add_u32 s6, s13, 1837056
s_waitcnt vmcnt(3)
buffer_load_dwordx4 a[232:235], v10, s[52:55], s6 offen nt
s_add_u32 s6, s13, 1838080
s_waitcnt vmcnt(3)
buffer_load_dwordx4 a[236:239], v10, s[52:55], s6 offen nt
s_add_u32 s6, s13, 1966080
s_waitcnt vmcnt(3)
buffer_load_dwordx4 a[240:243], v10, s[52:55], s6 offen nt
s_add_u32 s6, s13, 1967104
s_waitcnt vmcnt(3)
buffer_load_dwordx4 a[244:247], v10, s[52:55], s6 offen nt
s_add_u32 s6, s13, 1968128
s_waitcnt vmcnt(3)
buffer_load_dwordx4 a[248:251], v10, s[52:55], s6 offen nt
s_add_u32 s6, s13, 1969152
s_waitcnt vmcnt(3)
buffer_load_dwordx4 a[252:255], v10, s[52:55], s6 offen nt
buffer_load_dword v11, off, s[68:71], 0 offset:0 sc1
s_lshl_b32 s14, s10, 3
s_add_u32 s14, s14, s3
s_mul_i32 s14, s14, 4096
s_add_u32 s14, s14, 0
s_add_u32 s15, s14, 16384
s_lshl_b32 s6, s3, 4
v_add_u32 v5, s6, v8
v_mul_u32_u24 v5, 1088, v5
v_lshrrev_b32 v6, 3, v8
v_lshlrev_b32 v6, 1, v6
v_xor_b32 v6, v6, v9
v_lshl_add_u32 v194, v6, 4, v5
v_add_u32 v195, 69632, v194
v_lshrrev_b32 v5, 5, v1
v_lshlrev_b32 v5, 3, v5
v_bfe_u32 v6, v1, 2, 2
v_add_u32 v5, v5, v6
v_mul_u32_u24 v5, 1088, v5
v_lshrrev_b32 v6, 1, v9
v_xor_b32 v6, v6, v9
v_and_b32 v6, 1, v6
v_lshl_add_u32 v5, v6, 5, v5
v_and_b32 v6, 3, v1
v_lshl_add_u32 v5, v6, 3, v5
s_lshl_b32 s6, s3, 8
v_add_u32 v196, s6, v5
v_add_u32 v197, 69632, v196
v_lshlrev_b32 v199, 4, v8
v_add_u32 v199, 160256, v199
s_lshl_b32 s6, s3, 2
v_add_u32 v198, s6, v199
v_and_b32 v5, 31, v1
v_lshlrev_b32 v200, 4, v5
v_add_u32 v200, 160256, v200
v_lshlrev_b32 v202, 5, v5
v_lshrrev_b32 v6, 5, v1
v_lshl_add_u32 v202, v6, 4, v202
v_add_u32 v202, 156160, v202
v_lshlrev_b32 v201, 5, v8
v_lshl_add_u32 v201, v9, 3, v201
s_lshl_b32 s6, s3, 10
s_add_u32 s6, s6, 156160
v_add_u32 v201, s6, v201
v_mul_u32_u24 v203, 1056, v8
v_lshl_add_u32 v203, v9, 4, v203
v_add_u32 v203, 139264, v203
s_mul_i32 s6, s3, 4224
s_add_u32 s6, s6, 139264
v_add_u32 v204, s6, v2
v_add_u32 v206, s12, v2
v_add_u32 v207, 69632, v206
v_mov_b32 v185, 0x3e0293ee
v_mov_b32 v176, 0xff800000
v_mov_b32 v177, 0xff800000
v_mov_b32 v178, 0xff800000
v_mov_b32 v180, 0
v_mov_b32 v181, 0
s_waitcnt vmcnt(0)
s_mov_b32 s7, 400000
L_ens_39:
v_readfirstlane_b32 s6, v11
s_cmp_ge_u32 s6, 128
s_cbranch_scc1 L_ensd_40
s_sleep 16
buffer_load_dword v11, off, s[68:71], 0 offset:0 sc1
s_waitcnt vmcnt(0)
s_sub_u32 s7, s7, 1
s_cmp_lg_u32 s7, 0
s_cbranch_scc1 L_ens_39
L_ensd_40:
s_mov_b32 s7, 400000
v_and_b32 v5, 3, v1
v_bfe_u32 v6, v1, 2, 1
v_mul_u32_u24 v6, 16384, v6
v_lshl_add_u32 v5, v5, 10, v6
Q_slow:
buffer_load_dword v192, v5, s[64:67], s14 offen offset:768 sc1
s_waitcnt vmcnt(0)
v_cmp_eq_u32 vcc, -1, v192
s_cbranch_vccz Q_chk
s_sleep 8
s_sub_u32 s7, s7, 1
s_cmp_lg_u32 s7, 1
s_cbranch_scc1 Q_slow
Q_chk:
buffer_load_dwordx4 v[84:87], v2, s[64:67], s14 offen offset:0 sc1
buffer_load_dwordx4 v[88:91], v2, s[64:67], s14 offen offset:1024 sc1
buffer_load_dwordx4 v[92:95], v2, s[64:67], s14 offen offset:2048 sc1
buffer_load_dwordx4 v[96:99], v2, s[64:67], s14 offen offset:3072 sc1
buffer_load_dwordx4 v[100:103], v2, s[64:67], s15 offen offset:0 sc1
buffer_load_dwordx4 v[104:107], v2, s[64:67], s15 offen offset:1024 sc1
buffer_load_dwordx4 v[108:111], v2, s[64:67], s15 offen offset:2048 sc1
buffer_load_dwordx4 v[112:115], v2, s[64:67], s15 offen offset:3072 sc1
s_waitcnt vmcnt(0)
v_max3_u32 v192, v84, v85, v86
v_max3_u32 v192, v192, v87, v88
v_max3_u32 v192, v192, v89, v90
v_max3_u32 v192, v192, v91, v92
v_max3_u32 v192, v192, v93, v94
v_max3_u32 v192, v192, v95, v96
v_max3_u32 v192, v192, v97, v98
v_max3_u32 v192, v192, v99, v100
v_max3_u32 v192, v192, v101, v102
v_max3_u32 v192, v192, v103, v104
v_max3_u32 v192, v192, v105, v106
v_max3_u32 v192, v192, v107, v108
v_max3_u32 v192, v192, v109, v110
v_max3_u32 v192, v192, v111, v112
v_max3_u32 v192, v192, v113, v114
v_max_u32 v192, v192, v115
v_cmp_eq_u32 vcc, -1, v192
s_cbranch_vccz Q_ok
s_sleep 16
s_sub_u32 s7, s7, 1
s_cmp_lg_u32 s7, 0
s_cbranch_scc1 Q_chk
Q_ok:
ds_write_b128 v204, v[84:87] offset:0
ds_write_b128 v204, v[88:91] offset:1056
ds_write_b128 v204, v[92:95] offset:2112
ds_write_b128 v204, v[96:99] offset:3168
s_waitcnt lgkmcnt(0)
s_barrier
ds_read_b128 a[0:3], v203 offset:0
ds_read_b128 a[4:7], v203 offset:64
ds_read_b128 a[8:11], v203 offset:128
ds_read_b128 a[12:15], v203 offset:192
ds_read_b128 a[16:19], v203 offset:256
ds_read_b128 a[20:23], v203 offset:320
ds_read_b128 a[24:27], v203 offset:384
ds_read_b128 a[28:31], v203 offset:448
ds_read_b128 a[32:35], v203 offset:512
ds_read_b128 a[36:39], v203 offset:576
ds_read_b128 a[40:43], v203 offset:640
ds_read_b128 a[44:47], v203 offset:704
ds_read_b128 a[48:51], v203 offset:768
ds_read_b128 a[52:55], v203 offset:832
ds_read_b128 a[56:59], v203 offset:896
ds_read_b128 a[60:63], v203 offset:960
s_waitcnt lgkmcnt(0)
s_barrier
ds_write_b128 v204, v[100:103] offset:0
ds_write_b128 v204, v[104:107] offset:1056
ds_write_b128 v204, v[108:111] offset:2112
ds_write_b128 v204, v[112:115] offset:3168
s_waitcnt lgkmcnt(0)
s_barrier
ds_read_b128 a[64:67], v203 offset:0
ds_read_b128 a[68:71], v203 offset:64
ds_read_b128 a[72:75], v203 offset:128
ds_read_b128 a[76:79], v203 offset:192
ds_read_b128 a[80:83], v203 offset:256
ds_read_b128 a[84:87], v203 offset:320
ds_read_b128 a[88:91], v203 offset:384
ds_read_b128 a[92:95], v203 offset:448
ds_read_b128 a[96:99], v203 offset:512
ds_read_b128 a[100:103], v203 offset:576
ds_read_b128 a[104:107], v203 offset:640
ds_read_b128 a[108:111], v203 offset:704
ds_read_b128 a[112:115], v203 offset:768
ds_read_b128 a[116:119], v203 offset:832
ds_read_b128 a[120:123], v203 offset:896
ds_read_b128 a[124:127], v203 offset:960
s_waitcnt lgkmcnt(0)
s_mov_b32 s81, 4
ds_read_b128 v[84:87], v194 offset:0
ds_read_b128 v[88:91], v194 offset:64
ds_read_b128 v[92:95], v194 offset:128
ds_read_b128 v[96:99], v194 offset:192
ds_read_b128 v[100:103], v194 offset:256
ds_read_b128 v[104:107], v194 offset:320
ds_read_b128 v[108:111], v194 offset:384
ds_read_b128 v[112:115], v194 offset:448
ds_read_b128 v[116:119], v194 offset:512
ds_read_b128 v[120:123], v194 offset:576
ds_read_b128 v[124:127], v194 offset:640
ds_read_b128 v[128:131], v194 offset:704
ds_read_b128 v[132:135], v194 offset:768
ds_read_b128 v[136:139], v194 offset:832
ds_read_b128 v[140:143], v194 offset:896
ds_read_b128 v[144:147], v194 offset:960
s_waitcnt lgkmcnt(15)
v_mfma_f32_16x16x32_bf16 v[76:79], v[84:87], a[0:3], 0
v_mfma_f32_16x16x32_bf16 v[80:83], v[84:87], a[64:67], 0
s_waitcnt lgkmcnt(14)
v_mfma_f32_16x16x32_bf16 v[76:79], v[88:91], a[4:7], v[76:79]
v_mfma_f32_16x16x32_bf16 v[80:83], v[88:91], a[68:71], v[80:83]
s_waitcnt lgkmcnt(13)
v_mfma_f32_16x16x32_bf16 v[76:79], v[92:95], a[8:11], v[76:79]
v_mfma_f32_16x16x32_bf16 v[80:83], v[92:95], a[72:75], v[80:83]
s_waitcnt lgkmcnt(12)
v_mfma_f32_16x16x32_bf16 v[76:79], v[96:99], a[12:15], v[76:79]
v_mfma_f32_16x16x32_bf16 v[80:83], v[96:99], a[76:79], v[80:83]
s_waitcnt lgkmcnt(11)
v_mfma_f32_16x16x32_bf16 v[76:79], v[100:103], a[16:19], v[76:79]
v_mfma_f32_16x16x32_bf16 v[80:83], v[100:103], a[80:83], v[80:83]
s_waitcnt lgkmcnt(10)
v_mfma_f32_16x16x32_bf16 v[76:79], v[104:107], a[20:23], v[76:79]
v_mfma_f32_16x16x32_bf16 v[80:83], v[104:107], a[84:87], v[80:83]
s_waitcnt lgkmcnt(9)
v_mfma_f32_16x16x32_bf16 v[76:79], v[108:111], a[24:27], v[76:79]
v_mfma_f32_16x16x32_bf16 v[80:83], v[108:111], a[88:91], v[80:83]
s_waitcnt lgkmcnt(8)
v_mfma_f32_16x16x32_bf16 v[76:79], v[112:115], a[28:31], v[76:79]
v_mfma_f32_16x16x32_bf16 v[80:83], v[112:115], a[92:95], v[80:83]
s_waitcnt lgkmcnt(7)
v_mfma_f32_16x16x32_bf16 v[76:79], v[116:119], a[32:35], v[76:79]
v_mfma_f32_16x16x32_bf16 v[80:83], v[116:119], a[96:99], v[80:83]
s_waitcnt lgkmcnt(6)
v_mfma_f32_16x16x32_bf16 v[76:79], v[120:123], a[36:39], v[76:79]
v_mfma_f32_16x16x32_bf16 v[80:83], v[120:123], a[100:103], v[80:83]
s_waitcnt lgkmcnt(5)
v_mfma_f32_16x16x32_bf16 v[76:79], v[124:127], a[40:43], v[76:79]
v_mfma_f32_16x16x32_bf16 v[80:83], v[124:127], a[104:107], v[80:83]
s_waitcnt lgkmcnt(4)
v_mfma_f32_16x16x32_bf16 v[76:79], v[128:131], a[44:47], v[76:79]
v_mfma_f32_16x16x32_bf16 v[80:83], v[128:131], a[108:111], v[80:83]
s_waitcnt lgkmcnt(3)
v_mfma_f32_16x16x32_bf16 v[76:79], v[132:135], a[48:51], v[76:79]
v_mfma_f32_16x16x32_bf16 v[80:83], v[132:135], a[112:115], v[80:83]
s_waitcnt lgkmcnt(2)
v_mfma_f32_16x16x32_bf16 v[76:79], v[136:139], a[52:55], v[76:79]
v_mfma_f32_16x16x32_bf16 v[80:83], v[136:139], a[116:119], v[80:83]
s_waitcnt lgkmcnt(1)
v_mfma_f32_16x16x32_bf16 v[76:79], v[140:143], a[56:59], v[76:79]
v_mfma_f32_16x16x32_bf16 v[80:83], v[140:143], a[120:123], v[80:83]
s_waitcnt lgkmcnt(0)
v_mfma_f32_16x16x32_bf16 v[76:79], v[144:147], a[60:63], v[76:79]
v_mfma_f32_16x16x32_bf16 v[80:83], v[144:147], a[124:127], v[80:83]
s_nop 6
v_max_f32 v190, v76, v77
v_max3_f32 v190, v190, v78, v79
v_mov_b32 v192, v190
s_nop 1
v_permlane16_swap_b32 v190, v192
v_max_f32 v190, v190, v192
v_mov_b32 v192, v190
s_nop 1
v_permlane32_swap_b32 v190, v192
v_max_f32 v190, v190, v192
ds_write_b32 v198, v190 offset:0
v_max_f32 v191, v80, v81
v_max3_f32 v191, v191, v82, v83
v_mov_b32 v192, v191
s_nop 1
v_permlane16_swap_b32 v191, v192
v_max_f32 v191, v191, v192
v_mov_b32 v192, v191
s_nop 1
v_permlane32_swap_b32 v191, v192
v_max_f32 v191, v191, v192
ds_write_b32 v198, v191 offset:256
s_waitcnt lgkmcnt(0)
s_barrier
ds_read_b128 v[164:167], v199
ds_read_b128 v[168:171], v199 offset:256
ds_read_b128 v[172:175], v200
s_waitcnt lgkmcnt(0)
v_max_f32 v164, v164, v165
v_max3_f32 v164, v164, v166, v167
v_mul_f32 v164, v164, v185
v_max_f32 v164, v164, v176
v_sub_f32 v182, v176, v164
v_exp_f32 v182, v182
v_mov_b32 v176, v164
v_max_f32 v168, v168, v169
v_max3_f32 v168, v168, v170, v171
v_mul_f32 v168, v168, v185
v_max_f32 v168, v168, v177
v_sub_f32 v183, v177, v168
v_exp_f32 v183, v183
v_mov_b32 v177, v168
v_max_f32 v172, v172, v173
v_max3_f32 v172, v172, v174, v175
v_mul_f32 v172, v172, v185
v_max_f32 v172, v172, v178
v_sub_f32 v184, v178, v172
v_exp_f32 v184, v184
v_mov_b32 v178, v172
v_fma_f32 v76, v76, v185, -v176
v_fma_f32 v77, v77, v185, -v176
v_fma_f32 v78, v78, v185, -v176
v_fma_f32 v79, v79, v185, -v176
v_exp_f32 v76, v76
v_exp_f32 v77, v77
v_exp_f32 v78, v78
v_exp_f32 v79, v79
v_mul_f32 v180, v180, v182
v_cvt_pk_bf16_f32 v186, v76, v77
v_cvt_pk_bf16_f32 v187, v78, v79
ds_write_b64 v201, v[186:187] offset:0
v_add_f32 v180, v180, v76
v_add_f32 v180, v180, v77
v_add_f32 v180, v180, v78
v_add_f32 v180, v180, v79
v_fma_f32 v80, v80, v185, -v177
v_fma_f32 v81, v81, v185, -v177
v_fma_f32 v82, v82, v185, -v177
v_fma_f32 v83, v83, v185, -v177
v_exp_f32 v80, v80
v_exp_f32 v81, v81
v_exp_f32 v82, v82
v_exp_f32 v83, v83
v_mul_f32 v181, v181, v183
v_cvt_pk_bf16_f32 v188, v80, v81
v_cvt_pk_bf16_f32 v189, v82, v83
ds_write_b64 v201, v[188:189] offset:512
v_add_f32 v181, v181, v80
v_add_f32 v181, v181, v81
v_add_f32 v181, v181, v82
v_add_f32 v181, v181, v83
s_waitcnt lgkmcnt(0)
s_barrier
ds_read_b128 v[148:151], v202 offset:0
ds_read_b128 v[152:155], v202 offset:1024
ds_read_b128 v[156:159], v202 offset:2048
ds_read_b128 v[160:163], v202 offset:3072
ds_read_b64_tr_b16 v[84:85], v196 offset:0
ds_read_b64_tr_b16 v[86:87], v196 offset:4352
ds_read_b64_tr_b16 v[88:89], v196 offset:64
ds_read_b64_tr_b16 v[90:91], v196 offset:4416
ds_read_b64_tr_b16 v[92:93], v196 offset:128
ds_read_b64_tr_b16 v[94:95], v196 offset:4480
ds_read_b64_tr_b16 v[96:97], v196 offset:192
ds_read_b64_tr_b16 v[98:99], v196 offset:4544
ds_read_b64_tr_b16 v[100:101], v196 offset:17408
ds_read_b64_tr_b16 v[102:103], v196 offset:21760
ds_read_b64_tr_b16 v[104:105], v196 offset:17472
ds_read_b64_tr_b16 v[106:107], v196 offset:21824
ds_read_b64_tr_b16 v[108:109], v196 offset:17536
ds_read_b64_tr_b16 v[110:111], v196 offset:21888
ds_read_b64_tr_b16 v[112:113], v196 offset:17600
ds_read_b64_tr_b16 v[114:115], v196 offset:21952
ds_read_b64_tr_b16 v[116:117], v196 offset:34816
ds_read_b64_tr_b16 v[118:119], v196 offset:39168
ds_read_b64_tr_b16 v[120:121], v196 offset:34880
ds_read_b64_tr_b16 v[122:123], v196 offset:39232
ds_read_b64_tr_b16 v[124:125], v196 offset:34944
ds_read_b64_tr_b16 v[126:127], v196 offset:39296
ds_read_b64_tr_b16 v[128:129], v196 offset:35008
ds_read_b64_tr_b16 v[130:131], v196 offset:39360
ds_read_b64_tr_b16 v[132:133], v196 offset:52224
ds_read_b64_tr_b16 v[134:135], v196 offset:56576
ds_read_b64_tr_b16 v[136:137], v196 offset:52288
ds_read_b64_tr_b16 v[138:139], v196 offset:56640
ds_read_b64_tr_b16 v[140:141], v196 offset:52352
ds_read_b64_tr_b16 v[142:143], v196 offset:56704
ds_read_b64_tr_b16 v[144:145], v196 offset:52416
ds_read_b64_tr_b16 v[146:147], v196 offset:56768
s_waitcnt lgkmcnt(15)
v_mfma_f32_32x32x16_bf16 v[12:27], v[84:87], v[148:151], 0
v_mfma_f32_32x32x16_bf16 v[28:43], v[88:91], v[148:151], 0
v_mfma_f32_32x32x16_bf16 v[44:59], v[92:95], v[148:151], 0
v_mfma_f32_32x32x16_bf16 v[60:75], v[96:99], v[148:151], 0
s_waitcnt lgkmcnt(15)
v_mfma_f32_32x32x16_bf16 v[12:27], v[100:103], v[152:155], v[12:27]
v_mfma_f32_32x32x16_bf16 v[28:43], v[104:107], v[152:155], v[28:43]
v_mfma_f32_32x32x16_bf16 v[44:59], v[108:111], v[152:155], v[44:59]
v_mfma_f32_32x32x16_bf16 v[60:75], v[112:115], v[152:155], v[60:75]
s_waitcnt lgkmcnt(8)
v_mfma_f32_32x32x16_bf16 v[12:27], v[116:119], v[156:159], v[12:27]
v_mfma_f32_32x32x16_bf16 v[28:43], v[120:123], v[156:159], v[28:43]
v_mfma_f32_32x32x16_bf16 v[44:59], v[124:127], v[156:159], v[44:59]
v_mfma_f32_32x32x16_bf16 v[60:75], v[128:131], v[156:159], v[60:75]
s_waitcnt lgkmcnt(0)
v_mfma_f32_32x32x16_bf16 v[12:27], v[132:135], v[160:163], v[12:27]
v_mfma_f32_32x32x16_bf16 v[28:43], v[136:139], v[160:163], v[28:43]
v_mfma_f32_32x32x16_bf16 v[44:59], v[140:143], v[160:163], v[44:59]
v_mfma_f32_32x32x16_bf16 v[60:75], v[144:147], v[160:163], v[60:75]
ds_read_b128 v[84:87], v195 offset:0
ds_read_b128 v[88:91], v195 offset:64
ds_read_b128 v[92:95], v195 offset:128
ds_read_b128 v[96:99], v195 offset:192
ds_read_b128 v[100:103], v195 offset:256
ds_read_b128 v[104:107], v195 offset:320
ds_read_b128 v[108:111], v195 offset:384
ds_read_b128 v[112:115], v195 offset:448
ds_read_b128 v[116:119], v195 offset:512
ds_read_b128 v[120:123], v195 offset:576
ds_read_b128 v[124:127], v195 offset:640
ds_read_b128 v[128:131], v195 offset:704
ds_read_b128 v[132:135], v195 offset:768
ds_read_b128 v[136:139], v195 offset:832
ds_read_b128 v[140:143], v195 offset:896
ds_read_b128 v[144:147], v195 offset:960
s_waitcnt lgkmcnt(15)
v_mfma_f32_16x16x32_bf16 v[76:79], v[84:87], a[0:3], 0
v_mfma_f32_16x16x32_bf16 v[80:83], v[84:87], a[64:67], 0
s_waitcnt lgkmcnt(14)
v_mfma_f32_16x16x32_bf16 v[76:79], v[88:91], a[4:7], v[76:79]
v_mfma_f32_16x16x32_bf16 v[80:83], v[88:91], a[68:71], v[80:83]
s_waitcnt lgkmcnt(13)
v_mfma_f32_16x16x32_bf16 v[76:79], v[92:95], a[8:11], v[76:79]
v_mfma_f32_16x16x32_bf16 v[80:83], v[92:95], a[72:75], v[80:83]
s_waitcnt lgkmcnt(12)
v_mfma_f32_16x16x32_bf16 v[76:79], v[96:99], a[12:15], v[76:79]
v_mfma_f32_16x16x32_bf16 v[80:83], v[96:99], a[76:79], v[80:83]
s_waitcnt lgkmcnt(11)
v_mfma_f32_16x16x32_bf16 v[76:79], v[100:103], a[16:19], v[76:79]
v_mfma_f32_16x16x32_bf16 v[80:83], v[100:103], a[80:83], v[80:83]
s_waitcnt lgkmcnt(10)
v_mfma_f32_16x16x32_bf16 v[76:79], v[104:107], a[20:23], v[76:79]
v_mfma_f32_16x16x32_bf16 v[80:83], v[104:107], a[84:87], v[80:83]
s_waitcnt lgkmcnt(9)
v_mfma_f32_16x16x32_bf16 v[76:79], v[108:111], a[24:27], v[76:79]
v_mfma_f32_16x16x32_bf16 v[80:83], v[108:111], a[88:91], v[80:83]
s_waitcnt lgkmcnt(8)
v_mfma_f32_16x16x32_bf16 v[76:79], v[112:115], a[28:31], v[76:79]
v_mfma_f32_16x16x32_bf16 v[80:83], v[112:115], a[92:95], v[80:83]
s_waitcnt lgkmcnt(7)
v_mfma_f32_16x16x32_bf16 v[76:79], v[116:119], a[32:35], v[76:79]
v_mfma_f32_16x16x32_bf16 v[80:83], v[116:119], a[96:99], v[80:83]
s_waitcnt lgkmcnt(6)
v_mfma_f32_16x16x32_bf16 v[76:79], v[120:123], a[36:39], v[76:79]
v_mfma_f32_16x16x32_bf16 v[80:83], v[120:123], a[100:103], v[80:83]
s_waitcnt lgkmcnt(5)
v_mfma_f32_16x16x32_bf16 v[76:79], v[124:127], a[40:43], v[76:79]
v_mfma_f32_16x16x32_bf16 v[80:83], v[124:127], a[104:107], v[80:83]
s_waitcnt lgkmcnt(4)
v_mfma_f32_16x16x32_bf16 v[76:79], v[128:131], a[44:47], v[76:79]
v_mfma_f32_16x16x32_bf16 v[80:83], v[128:131], a[108:111], v[80:83]
s_waitcnt lgkmcnt(3)
v_mfma_f32_16x16x32_bf16 v[76:79], v[132:135], a[48:51], v[76:79]
v_mfma_f32_16x16x32_bf16 v[80:83], v[132:135], a[112:115], v[80:83]
s_waitcnt lgkmcnt(2)
v_mfma_f32_16x16x32_bf16 v[76:79], v[136:139], a[52:55], v[76:79]
v_mfma_f32_16x16x32_bf16 v[80:83], v[136:139], a[116:119], v[80:83]
s_waitcnt lgkmcnt(1)
v_mfma_f32_16x16x32_bf16 v[76:79], v[140:143], a[56:59], v[76:79]
v_mfma_f32_16x16x32_bf16 v[80:83], v[140:143], a[120:123], v[80:83]
s_waitcnt lgkmcnt(0)
v_mfma_f32_16x16x32_bf16 v[76:79], v[144:147], a[60:63], v[76:79]
v_mfma_f32_16x16x32_bf16 v[80:83], v[144:147], a[124:127], v[80:83]
s_nop 6
v_max_f32 v190, v76, v77
v_max3_f32 v190, v190, v78, v79
v_mov_b32 v192, v190
s_nop 1
v_permlane16_swap_b32 v190, v192
v_max_f32 v190, v190, v192
v_mov_b32 v192, v190
s_nop 1
v_permlane32_swap_b32 v190, v192
v_max_f32 v190, v190, v192
ds_write_b32 v198, v190 offset:0
v_max_f32 v191, v80, v81
v_max3_f32 v191, v191, v82, v83
v_mov_b32 v192, v191
s_nop 1
v_permlane16_swap_b32 v191, v192
v_max_f32 v191, v191, v192
v_mov_b32 v192, v191
s_nop 1
v_permlane32_swap_b32 v191, v192
v_max_f32 v191, v191, v192
ds_write_b32 v198, v191 offset:256
s_waitcnt lgkmcnt(0)
s_barrier
ds_read_b128 v[164:167], v199
ds_read_b128 v[168:171], v199 offset:256
ds_read_b128 v[172:175], v200
ds_write_b128 v206, a[128:131] offset:0
ds_write_b128 v206, a[132:135] offset:1088
ds_write_b128 v206, a[136:139] offset:2176
ds_write_b128 v206, a[140:143] offset:3264
ds_write_b128 v206, a[144:147] offset:4352
ds_write_b128 v206, a[148:151] offset:5440
ds_write_b128 v206, a[152:155] offset:6528
ds_write_b128 v206, a[156:159] offset:7616
ds_write_b128 v206, a[160:163] offset:8704
ds_write_b128 v206, a[164:167] offset:9792
ds_write_b128 v206, a[168:171] offset:10880
ds_write_b128 v206, a[172:175] offset:11968
ds_write_b128 v206, a[176:179] offset:13056
ds_write_b128 v206, a[180:183] offset:14144
ds_write_b128 v206, a[184:187] offset:15232
ds_write_b128 v206, a[188:191] offset:16320
s_waitcnt lgkmcnt(15)
v_max_f32 v164, v164, v165
v_max3_f32 v164, v164, v166, v167
v_mul_f32 v164, v164, v185
v_max_f32 v164, v164, v176
v_sub_f32 v182, v176, v164
v_exp_f32 v182, v182
v_mov_b32 v176, v164
v_max_f32 v168, v168, v169
v_max3_f32 v168, v168, v170, v171
v_mul_f32 v168, v168, v185
v_max_f32 v168, v168, v177
v_sub_f32 v183, v177, v168
v_exp_f32 v183, v183
v_mov_b32 v177, v168
v_max_f32 v172, v172, v173
v_max3_f32 v172, v172, v174, v175
v_mul_f32 v172, v172, v185
v_max_f32 v172, v172, v178
v_sub_f32 v184, v178, v172
v_exp_f32 v184, v184
v_mov_b32 v178, v172
v_fma_f32 v76, v76, v185, -v176
v_fma_f32 v77, v77, v185, -v176
v_fma_f32 v78, v78, v185, -v176
v_fma_f32 v79, v79, v185, -v176
v_exp_f32 v76, v76
v_exp_f32 v77, v77
v_exp_f32 v78, v78
v_exp_f32 v79, v79
v_mul_f32 v180, v180, v182
v_cvt_pk_bf16_f32 v186, v76, v77
v_cvt_pk_bf16_f32 v187, v78, v79
ds_write_b64 v201, v[186:187] offset:0
v_add_f32 v180, v180, v76
v_add_f32 v180, v180, v77
v_add_f32 v180, v180, v78
v_add_f32 v180, v180, v79
v_fma_f32 v80, v80, v185, -v177
v_fma_f32 v81, v81, v185, -v177
v_fma_f32 v82, v82, v185, -v177
v_fma_f32 v83, v83, v185, -v177
v_exp_f32 v80, v80
v_exp_f32 v81, v81
v_exp_f32 v82, v82
v_exp_f32 v83, v83
v_mul_f32 v181, v181, v183
v_cvt_pk_bf16_f32 v188, v80, v81
v_cvt_pk_bf16_f32 v189, v82, v83
ds_write_b64 v201, v[188:189] offset:512
v_add_f32 v181, v181, v80
v_add_f32 v181, v181, v81
v_add_f32 v181, v181, v82
v_add_f32 v181, v181, v83
v_mul_f32 v12, v12, v184
v_mul_f32 v13, v13, v184
v_mul_f32 v14, v14, v184
v_mul_f32 v15, v15, v184
v_mul_f32 v16, v16, v184
v_mul_f32 v17, v17, v184
v_mul_f32 v18, v18, v184
v_mul_f32 v19, v19, v184
v_mul_f32 v20, v20, v184
v_mul_f32 v21, v21, v184
v_mul_f32 v22, v22, v184
v_mul_f32 v23, v23, v184
v_mul_f32 v24, v24, v184
v_mul_f32 v25, v25, v184
v_mul_f32 v26, v26, v184
v_mul_f32 v27, v27, v184
v_mul_f32 v28, v28, v184
v_mul_f32 v29, v29, v184
v_mul_f32 v30, v30, v184
v_mul_f32 v31, v31, v184
v_mul_f32 v32, v32, v184
v_mul_f32 v33, v33, v184
v_mul_f32 v34, v34, v184
v_mul_f32 v35, v35, v184
v_mul_f32 v36, v36, v184
v_mul_f32 v37, v37, v184
v_mul_f32 v38, v38, v184
v_mul_f32 v39, v39, v184
v_mul_f32 v40, v40, v184
v_mul_f32 v41, v41, v184
v_mul_f32 v42, v42, v184
v_mul_f32 v43, v43, v184
v_mul_f32 v44, v44, v184
v_mul_f32 v45, v45, v184
v_mul_f32 v46, v46, v184
v_mul_f32 v47, v47, v184
v_mul_f32 v48, v48, v184
v_mul_f32 v49, v49, v184
v_mul_f32 v50, v50, v184
v_mul_f32 v51, v51, v184
v_mul_f32 v52, v52, v184
v_mul_f32 v53, v53, v184
v_mul_f32 v54, v54, v184
v_mul_f32 v55, v55, v184
v_mul_f32 v56, v56, v184
v_mul_f32 v57, v57, v184
v_mul_f32 v58, v58, v184
v_mul_f32 v59, v59, v184
v_mul_f32 v60, v60, v184
v_mul_f32 v61, v61, v184
v_mul_f32 v62, v62, v184
v_mul_f32 v63, v63, v184
v_mul_f32 v64, v64, v184
v_mul_f32 v65, v65, v184
v_mul_f32 v66, v66, v184
v_mul_f32 v67, v67, v184
v_mul_f32 v68, v68, v184
v_mul_f32 v69, v69, v184
v_mul_f32 v70, v70, v184
v_mul_f32 v71, v71, v184
v_mul_f32 v72, v72, v184
v_mul_f32 v73, v73, v184
v_mul_f32 v74, v74, v184
v_mul_f32 v75, v75, v184
s_waitcnt lgkmcnt(0)
s_barrier
ds_read_b128 v[148:151], v202 offset:0
ds_read_b128 v[152:155], v202 offset:1024
ds_read_b128 v[156:159], v202 offset:2048
ds_read_b128 v[160:163], v202 offset:3072
ds_read_b64_tr_b16 v[84:85], v197 offset:0
ds_read_b64_tr_b16 v[86:87], v197 offset:4352
ds_read_b64_tr_b16 v[88:89], v197 offset:64
ds_read_b64_tr_b16 v[90:91], v197 offset:4416
ds_read_b64_tr_b16 v[92:93], v197 offset:128
ds_read_b64_tr_b16 v[94:95], v197 offset:4480
ds_read_b64_tr_b16 v[96:97], v197 offset:192
ds_read_b64_tr_b16 v[98:99], v197 offset:4544
ds_read_b64_tr_b16 v[100:101], v197 offset:17408
ds_read_b64_tr_b16 v[102:103], v197 offset:21760
ds_read_b64_tr_b16 v[104:105], v197 offset:17472
ds_read_b64_tr_b16 v[106:107], v197 offset:21824
ds_read_b64_tr_b16 v[108:109], v197 offset:17536
ds_read_b64_tr_b16 v[110:111], v197 offset:21888
ds_read_b64_tr_b16 v[112:113], v197 offset:17600
ds_read_b64_tr_b16 v[114:115], v197 offset:21952
ds_read_b64_tr_b16 v[116:117], v197 offset:34816
ds_read_b64_tr_b16 v[118:119], v197 offset:39168
ds_read_b64_tr_b16 v[120:121], v197 offset:34880
ds_read_b64_tr_b16 v[122:123], v197 offset:39232
ds_read_b64_tr_b16 v[124:125], v197 offset:34944
ds_read_b64_tr_b16 v[126:127], v197 offset:39296
ds_read_b64_tr_b16 v[128:129], v197 offset:35008
ds_read_b64_tr_b16 v[130:131], v197 offset:39360
ds_read_b64_tr_b16 v[132:133], v197 offset:52224
ds_read_b64_tr_b16 v[134:135], v197 offset:56576
ds_read_b64_tr_b16 v[136:137], v197 offset:52288
ds_read_b64_tr_b16 v[138:139], v197 offset:56640
ds_read_b64_tr_b16 v[140:141], v197 offset:52352
ds_read_b64_tr_b16 v[142:143], v197 offset:56704
ds_read_b64_tr_b16 v[144:145], v197 offset:52416
ds_read_b64_tr_b16 v[146:147], v197 offset:56768
s_waitcnt lgkmcnt(15)
v_mfma_f32_32x32x16_bf16 v[12:27], v[84:87], v[148:151], v[12:27]
v_mfma_f32_32x32x16_bf16 v[28:43], v[88:91], v[148:151], v[28:43]
s_add_u32 s6, s13, 2097152
buffer_load_dwordx4 a[128:131], v2, s[52:55], s6 offen nt
v_mfma_f32_32x32x16_bf16 v[44:59], v[92:95], v[148:151], v[44:59]
v_mfma_f32_32x32x16_bf16 v[60:75], v[96:99], v[148:151], v[60:75]
s_add_u32 s6, s13, 2098176
buffer_load_dwordx4 a[132:135], v2, s[52:55], s6 offen nt
s_waitcnt lgkmcnt(15)
v_mfma_f32_32x32x16_bf16 v[12:27], v[100:103], v[152:155], v[12:27]
v_mfma_f32_32x32x16_bf16 v[28:43], v[104:107], v[152:155], v[28:43]
s_add_u32 s6, s13, 2099200
buffer_load_dwordx4 a[136:139], v2, s[52:55], s6 offen nt
v_mfma_f32_32x32x16_bf16 v[44:59], v[108:111], v[152:155], v[44:59]
v_mfma_f32_32x32x16_bf16 v[60:75], v[112:115], v[152:155], v[60:75]
s_add_u32 s6, s13, 2100224
buffer_load_dwordx4 a[140:143], v2, s[52:55], s6 offen nt
s_waitcnt lgkmcnt(8)
v_mfma_f32_32x32x16_bf16 v[12:27], v[116:119], v[156:159], v[12:27]
v_mfma_f32_32x32x16_bf16 v[28:43], v[120:123], v[156:159], v[28:43]
s_add_u32 s6, s13, 2228224
buffer_load_dwordx4 a[144:147], v2, s[52:55], s6 offen nt
v_mfma_f32_32x32x16_bf16 v[44:59], v[124:127], v[156:159], v[44:59]
v_mfma_f32_32x32x16_bf16 v[60:75], v[128:131], v[156:159], v[60:75]
s_add_u32 s6, s13, 2229248
buffer_load_dwordx4 a[148:151], v2, s[52:55], s6 offen nt
s_waitcnt lgkmcnt(0)
v_mfma_f32_32x32x16_bf16 v[12:27], v[132:135], v[160:163], v[12:27]
v_mfma_f32_32x32x16_bf16 v[28:43], v[136:139], v[160:163], v[28:43]
s_add_u32 s6, s13, 2230272
buffer_load_dwordx4 a[152:155], v2, s[52:55], s6 offen nt
v_mfma_f32_32x32x16_bf16 v[44:59], v[140:143], v[160:163], v[44:59]
v_mfma_f32_32x32x16_bf16 v[60:75], v[144:147], v[160:163], v[60:75]
s_add_u32 s6, s13, 2231296
buffer_load_dwordx4 a[156:159], v2, s[52:55], s6 offen nt
ds_read_b128 v[84:87], v194 offset:0
ds_read_b128 v[88:91], v194 offset:64
ds_read_b128 v[92:95], v194 offset:128
ds_read_b128 v[96:99], v194 offset:192
ds_read_b128 v[100:103], v194 offset:256
ds_read_b128 v[104:107], v194 offset:320
ds_read_b128 v[108:111], v194 offset:384
ds_read_b128 v[112:115], v194 offset:448
ds_read_b128 v[116:119], v194 offset:512
ds_read_b128 v[120:123], v194 offset:576
ds_read_b128 v[124:127], v194 offset:640
ds_read_b128 v[128:131], v194 offset:704
ds_read_b128 v[132:135], v194 offset:768
ds_read_b128 v[136:139], v194 offset:832
ds_read_b128 v[140:143], v194 offset:896
ds_read_b128 v[144:147], v194 offset:960
s_waitcnt lgkmcnt(15)
v_mfma_f32_16x16x32_bf16 v[76:79], v[84:87], a[0:3], 0
v_mfma_f32_16x16x32_bf16 v[80:83], v[84:87], a[64:67], 0
s_waitcnt lgkmcnt(14)
v_mfma_f32_16x16x32_bf16 v[76:79], v[88:91], a[4:7], v[76:79]
v_mfma_f32_16x16x32_bf16 v[80:83], v[88:91], a[68:71], v[80:83]
s_add_u32 s6, s13, 2359296
buffer_load_dwordx4 a[160:163], v10, s[52:55], s6 offen nt
s_waitcnt lgkmcnt(13)
v_mfma_f32_16x16x32_bf16 v[76:79], v[92:95], a[8:11], v[76:79]
v_mfma_f32_16x16x32_bf16 v[80:83], v[92:95], a[72:75], v[80:83]
s_waitcnt lgkmcnt(12)
v_mfma_f32_16x16x32_bf16 v[76:79], v[96:99], a[12:15], v[76:79]
v_mfma_f32_16x16x32_bf16 v[80:83], v[96:99], a[76:79], v[80:83]
s_add_u32 s6, s13, 2360320
buffer_load_dwordx4 a[164:167], v10, s[52:55], s6 offen nt
s_waitcnt lgkmcnt(11)
v_mfma_f32_16x16x32_bf16 v[76:79], v[100:103], a[16:19], v[76:79]
v_mfma_f32_16x16x32_bf16 v[80:83], v[100:103], a[80:83], v[80:83]
s_waitcnt lgkmcnt(10)
v_mfma_f32_16x16x32_bf16 v[76:79], v[104:107], a[20:23], v[76:79]
v_mfma_f32_16x16x32_bf16 v[80:83], v[104:107], a[84:87], v[80:83]
s_add_u32 s6, s13, 2361344
buffer_load_dwordx4 a[168:171], v10, s[52:55], s6 offen nt
s_waitcnt lgkmcnt(9)
v_mfma_f32_16x16x32_bf16 v[76:79], v[108:111], a[24:27], v[76:79]
v_mfma_f32_16x16x32_bf16 v[80:83], v[108:111], a[88:91], v[80:83]
s_waitcnt lgkmcnt(8)
v_mfma_f32_16x16x32_bf16 v[76:79], v[112:115], a[28:31], v[76:79]
v_mfma_f32_16x16x32_bf16 v[80:83], v[112:115], a[92:95], v[80:83]
s_add_u32 s6, s13, 2362368
buffer_load_dwordx4 a[172:175], v10, s[52:55], s6 offen nt
s_waitcnt lgkmcnt(7)
v_mfma_f32_16x16x32_bf16 v[76:79], v[116:119], a[32:35], v[76:79]
v_mfma_f32_16x16x32_bf16 v[80:83], v[116:119], a[96:99], v[80:83]
s_waitcnt lgkmcnt(6)
v_mfma_f32_16x16x32_bf16 v[76:79], v[120:123], a[36:39], v[76:79]
v_mfma_f32_16x16x32_bf16 v[80:83], v[120:123], a[100:103], v[80:83]
s_add_u32 s6, s13, 2490368
buffer_load_dwordx4 a[176:179], v10, s[52:55], s6 offen nt
s_waitcnt lgkmcnt(5)
v_mfma_f32_16x16x32_bf16 v[76:79], v[124:127], a[40:43], v[76:79]
v_mfma_f32_16x16x32_bf16 v[80:83], v[124:127], a[104:107], v[80:83]
s_waitcnt lgkmcnt(4)
v_mfma_f32_16x16x32_bf16 v[76:79], v[128:131], a[44:47], v[76:79]
v_mfma_f32_16x16x32_bf16 v[80:83], v[128:131], a[108:111], v[80:83]
s_add_u32 s6, s13, 2491392
buffer_load_dwordx4 a[180:183], v10, s[52:55], s6 offen nt
s_waitcnt lgkmcnt(3)
v_mfma_f32_16x16x32_bf16 v[76:79], v[132:135], a[48:51], v[76:79]
v_mfma_f32_16x16x32_bf16 v[80:83], v[132:135], a[112:115], v[80:83]
s_waitcnt lgkmcnt(2)
v_mfma_f32_16x16x32_bf16 v[76:79], v[136:139], a[52:55], v[76:79]
v_mfma_f32_16x16x32_bf16 v[80:83], v[136:139], a[116:119], v[80:83]
s_add_u32 s6, s13, 2492416
buffer_load_dwordx4 a[184:187], v10, s[52:55], s6 offen nt
s_waitcnt lgkmcnt(1)
v_mfma_f32_16x16x32_bf16 v[76:79], v[140:143], a[56:59], v[76:79]
v_mfma_f32_16x16x32_bf16 v[80:83], v[140:143], a[120:123], v[80:83]
s_waitcnt lgkmcnt(0)
v_mfma_f32_16x16x32_bf16 v[76:79], v[144:147], a[60:63], v[76:79]
v_mfma_f32_16x16x32_bf16 v[80:83], v[144:147], a[124:127], v[80:83]
s_add_u32 s6, s13, 2493440
buffer_load_dwordx4 a[188:191], v10, s[52:55], s6 offen nt
s_nop 4
v_max_f32 v190, v76, v77
v_max3_f32 v190, v190, v78, v79
v_mov_b32 v192, v190
s_nop 1
v_permlane16_swap_b32 v190, v192
v_max_f32 v190, v190, v192
v_mov_b32 v192, v190
s_nop 1
v_permlane32_swap_b32 v190, v192
v_max_f32 v190, v190, v192
ds_write_b32 v198, v190 offset:0
v_max_f32 v191, v80, v81
v_max3_f32 v191, v191, v82, v83
v_mov_b32 v192, v191
s_nop 1
v_permlane16_swap_b32 v191, v192
v_max_f32 v191, v191, v192
v_mov_b32 v192, v191
s_nop 1
v_permlane32_swap_b32 v191, v192
v_max_f32 v191, v191, v192
ds_write_b32 v198, v191 offset:256
s_waitcnt lgkmcnt(0)
s_barrier
ds_read_b128 v[164:167], v199
ds_read_b128 v[168:171], v199 offset:256
ds_read_b128 v[172:175], v200
ds_write_b128 v207, a[192:195] offset:0
ds_write_b128 v207, a[196:199] offset:1088
ds_write_b128 v207, a[200:203] offset:2176
ds_write_b128 v207, a[204:207] offset:3264
ds_write_b128 v207, a[208:211] offset:4352
ds_write_b128 v207, a[212:215] offset:5440
ds_write_b128 v207, a[216:219] offset:6528
ds_write_b128 v207, a[220:223] offset:7616
ds_write_b128 v207, a[224:227] offset:8704
ds_write_b128 v207, a[228:231] offset:9792
ds_write_b128 v207, a[232:235] offset:10880
ds_write_b128 v207, a[236:239] offset:11968
ds_write_b128 v207, a[240:243] offset:13056
ds_write_b128 v207, a[244:247] offset:14144
ds_write_b128 v207, a[248:251] offset:15232
ds_write_b128 v207, a[252:255] offset:16320
s_waitcnt lgkmcnt(15)
v_max_f32 v164, v164, v165
v_max3_f32 v164, v164, v166, v167
v_mul_f32 v164, v164, v185
v_max_f32 v164, v164, v176
v_sub_f32 v182, v176, v164
v_exp_f32 v182, v182
v_mov_b32 v176, v164
v_max_f32 v168, v168, v169
v_max3_f32 v168, v168, v170, v171
v_mul_f32 v168, v168, v185
v_max_f32 v168, v168, v177
v_sub_f32 v183, v177, v168
v_exp_f32 v183, v183
v_mov_b32 v177, v168
v_max_f32 v172, v172, v173
v_max3_f32 v172, v172, v174, v175
v_mul_f32 v172, v172, v185
v_max_f32 v172, v172, v178
v_sub_f32 v184, v178, v172
v_exp_f32 v184, v184
v_mov_b32 v178, v172
v_fma_f32 v76, v76, v185, -v176
v_fma_f32 v77, v77, v185, -v176
v_fma_f32 v78, v78, v185, -v176
v_fma_f32 v79, v79, v185, -v176
v_exp_f32 v76, v76
v_exp_f32 v77, v77
v_exp_f32 v78, v78
v_exp_f32 v79, v79
v_mul_f32 v180, v180, v182
v_cvt_pk_bf16_f32 v186, v76, v77
v_cvt_pk_bf16_f32 v187, v78, v79
ds_write_b64 v201, v[186:187] offset:0
v_add_f32 v180, v180, v76
v_add_f32 v180, v180, v77
v_add_f32 v180, v180, v78
v_add_f32 v180, v180, v79
v_fma_f32 v80, v80, v185, -v177
v_fma_f32 v81, v81, v185, -v177
v_fma_f32 v82, v82, v185, -v177
v_fma_f32 v83, v83, v185, -v177
v_exp_f32 v80, v80
v_exp_f32 v81, v81
v_exp_f32 v82, v82
v_exp_f32 v83, v83
v_mul_f32 v181, v181, v183
v_cvt_pk_bf16_f32 v188, v80, v81
v_cvt_pk_bf16_f32 v189, v82, v83
ds_write_b64 v201, v[188:189] offset:512
v_add_f32 v181, v181, v80
v_add_f32 v181, v181, v81
v_add_f32 v181, v181, v82
v_add_f32 v181, v181, v83
v_mul_f32 v12, v12, v184
v_mul_f32 v13, v13, v184
v_mul_f32 v14, v14, v184
v_mul_f32 v15, v15, v184
v_mul_f32 v16, v16, v184
v_mul_f32 v17, v17, v184
v_mul_f32 v18, v18, v184
v_mul_f32 v19, v19, v184
v_mul_f32 v20, v20, v184
v_mul_f32 v21, v21, v184
v_mul_f32 v22, v22, v184
v_mul_f32 v23, v23, v184
v_mul_f32 v24, v24, v184
v_mul_f32 v25, v25, v184
v_mul_f32 v26, v26, v184
v_mul_f32 v27, v27, v184
v_mul_f32 v28, v28, v184
v_mul_f32 v29, v29, v184
v_mul_f32 v30, v30, v184
v_mul_f32 v31, v31, v184
v_mul_f32 v32, v32, v184
v_mul_f32 v33, v33, v184
v_mul_f32 v34, v34, v184
v_mul_f32 v35, v35, v184
v_mul_f32 v36, v36, v184
v_mul_f32 v37, v37, v184
v_mul_f32 v38, v38, v184
v_mul_f32 v39, v39, v184
v_mul_f32 v40, v40, v184
v_mul_f32 v41, v41, v184
v_mul_f32 v42, v42, v184
v_mul_f32 v43, v43, v184
v_mul_f32 v44, v44, v184
v_mul_f32 v45, v45, v184
v_mul_f32 v46, v46, v184
v_mul_f32 v47, v47, v184
v_mul_f32 v48, v48, v184
v_mul_f32 v49, v49, v184
v_mul_f32 v50, v50, v184
v_mul_f32 v51, v51, v184
v_mul_f32 v52, v52, v184
v_mul_f32 v53, v53, v184
v_mul_f32 v54, v54, v184
v_mul_f32 v55, v55, v184
v_mul_f32 v56, v56, v184
v_mul_f32 v57, v57, v184
v_mul_f32 v58, v58, v184
v_mul_f32 v59, v59, v184
v_mul_f32 v60, v60, v184
v_mul_f32 v61, v61, v184
v_mul_f32 v62, v62, v184
v_mul_f32 v63, v63, v184
v_mul_f32 v64, v64, v184
v_mul_f32 v65, v65, v184
v_mul_f32 v66, v66, v184
v_mul_f32 v67, v67, v184
v_mul_f32 v68, v68, v184
v_mul_f32 v69, v69, v184
v_mul_f32 v70, v70, v184
v_mul_f32 v71, v71, v184
v_mul_f32 v72, v72, v184
v_mul_f32 v73, v73, v184
v_mul_f32 v74, v74, v184
v_mul_f32 v75, v75, v184
s_waitcnt lgkmcnt(0)
s_barrier
ds_read_b128 v[148:151], v202 offset:0
ds_read_b128 v[152:155], v202 offset:1024
ds_read_b128 v[156:159], v202 offset:2048
ds_read_b128 v[160:163], v202 offset:3072
ds_read_b64_tr_b16 v[84:85], v196 offset:0
ds_read_b64_tr_b16 v[86:87], v196 offset:4352
ds_read_b64_tr_b16 v[88:89], v196 offset:64
ds_read_b64_tr_b16 v[90:91], v196 offset:4416
ds_read_b64_tr_b16 v[92:93], v196 offset:128
ds_read_b64_tr_b16 v[94:95], v196 offset:4480
ds_read_b64_tr_b16 v[96:97], v196 offset:192
ds_read_b64_tr_b16 v[98:99], v196 offset:4544
ds_read_b64_tr_b16 v[100:101], v196 offset:17408
ds_read_b64_tr_b16 v[102:103], v196 offset:21760
ds_read_b64_tr_b16 v[104:105], v196 offset:17472
ds_read_b64_tr_b16 v[106:107], v196 offset:21824
ds_read_b64_tr_b16 v[108:109], v196 offset:17536
ds_read_b64_tr_b16 v[110:111], v196 offset:21888
ds_read_b64_tr_b16 v[112:113], v196 offset:17600
ds_read_b64_tr_b16 v[114:115], v196 offset:21952
ds_read_b64_tr_b16 v[116:117], v196 offset:34816
ds_read_b64_tr_b16 v[118:119], v196 offset:39168
ds_read_b64_tr_b16 v[120:121], v196 offset:34880
ds_read_b64_tr_b16 v[122:123], v196 offset:39232
ds_read_b64_tr_b16 v[124:125], v196 offset:34944
ds_read_b64_tr_b16 v[126:127], v196 offset:39296
ds_read_b64_tr_b16 v[128:129], v196 offset:35008
ds_read_b64_tr_b16 v[130:131], v196 offset:39360
ds_read_b64_tr_b16 v[132:133], v196 offset:52224
ds_read_b64_tr_b16 v[134:135], v196 offset:56576
ds_read_b64_tr_b16 v[136:137], v196 offset:52288
ds_read_b64_tr_b16 v[138:139], v196 offset:56640
ds_read_b64_tr_b16 v[140:141], v196 offset:52352
ds_read_b64_tr_b16 v[142:143], v196 offset:56704
ds_read_b64_tr_b16 v[144:145], v196 offset:52416
ds_read_b64_tr_b16 v[146:147], v196 offset:56768
s_waitcnt lgkmcnt(15)
v_mfma_f32_32x32x16_bf16 v[12:27], v[84:87], v[148:151], v[12:27]
v_mfma_f32_32x32x16_bf16 v[28:43], v[88:91], v[148:151], v[28:43]
s_add_u32 s6, s13, 2621440
buffer_load_dwordx4 a[192:195], v2, s[52:55], s6 offen nt
v_mfma_f32_32x32x16_bf16 v[44:59], v[92:95], v[148:151], v[44:59]
v_mfma_f32_32x32x16_bf16 v[60:75], v[96:99], v[148:151], v[60:75]
s_add_u32 s6, s13, 2622464
buffer_load_dwordx4 a[196:199], v2, s[52:55], s6 offen nt
s_waitcnt lgkmcnt(15)
v_mfma_f32_32x32x16_bf16 v[12:27], v[100:103], v[152:155], v[12:27]
v_mfma_f32_32x32x16_bf16 v[28:43], v[104:107], v[152:155], v[28:43]
s_add_u32 s6, s13, 2623488
buffer_load_dwordx4 a[200:203], v2, s[52:55], s6 offen nt
v_mfma_f32_32x32x16_bf16 v[44:59], v[108:111], v[152:155], v[44:59]
v_mfma_f32_32x32x16_bf16 v[60:75], v[112:115], v[152:155], v[60:75]
s_add_u32 s6, s13, 2624512
buffer_load_dwordx4 a[204:207], v2, s[52:55], s6 offen nt
s_waitcnt lgkmcnt(8)
v_mfma_f32_32x32x16_bf16 v[12:27], v[116:119], v[156:159], v[12:27]
v_mfma_f32_32x32x16_bf16 v[28:43], v[120:123], v[156:159], v[28:43]
s_add_u32 s6, s13, 2752512
buffer_load_dwordx4 a[208:211], v2, s[52:55], s6 offen nt
v_mfma_f32_32x32x16_bf16 v[44:59], v[124:127], v[156:159], v[44:59]
v_mfma_f32_32x32x16_bf16 v[60:75], v[128:131], v[156:159], v[60:75]
s_add_u32 s6, s13, 2753536
buffer_load_dwordx4 a[212:215], v2, s[52:55], s6 offen nt
s_waitcnt lgkmcnt(0)
v_mfma_f32_32x32x16_bf16 v[12:27], v[132:135], v[160:163], v[12:27]
v_mfma_f32_32x32x16_bf16 v[28:43], v[136:139], v[160:163], v[28:43]
s_add_u32 s6, s13, 2754560
buffer_load_dwordx4 a[216:219], v2, s[52:55], s6 offen nt
v_mfma_f32_32x32x16_bf16 v[44:59], v[140:143], v[160:163], v[44:59]
v_mfma_f32_32x32x16_bf16 v[60:75], v[144:147], v[160:163], v[60:75]
s_add_u32 s6, s13, 2755584
buffer_load_dwordx4 a[220:223], v2, s[52:55], s6 offen nt
ds_read_b128 v[84:87], v195 offset:0
ds_read_b128 v[88:91], v195 offset:64
ds_read_b128 v[92:95], v195 offset:128
ds_read_b128 v[96:99], v195 offset:192
ds_read_b128 v[100:103], v195 offset:256
ds_read_b128 v[104:107], v195 offset:320
ds_read_b128 v[108:111], v195 offset:384
ds_read_b128 v[112:115], v195 offset:448
ds_read_b128 v[116:119], v195 offset:512
ds_read_b128 v[120:123], v195 offset:576
ds_read_b128 v[124:127], v195 offset:640
ds_read_b128 v[128:131], v195 offset:704
ds_read_b128 v[132:135], v195 offset:768
ds_read_b128 v[136:139], v195 offset:832
ds_read_b128 v[140:143], v195 offset:896
ds_read_b128 v[144:147], v195 offset:960
s_waitcnt lgkmcnt(15)
v_mfma_f32_16x16x32_bf16 v[76:79], v[84:87], a[0:3], 0
v_mfma_f32_16x16x32_bf16 v[80:83], v[84:87], a[64:67], 0
s_waitcnt lgkmcnt(14)
v_mfma_f32_16x16x32_bf16 v[76:79], v[88:91], a[4:7], v[76:79]
v_mfma_f32_16x16x32_bf16 v[80:83], v[88:91], a[68:71], v[80:83]
s_add_u32 s6, s13, 2883584
buffer_load_dwordx4 a[224:227], v10, s[52:55], s6 offen nt
s_waitcnt lgkmcnt(13)
v_mfma_f32_16x16x32_bf16 v[76:79], v[92:95], a[8:11], v[76:79]
v_mfma_f32_16x16x32_bf16 v[80:83], v[92:95], a[72:75], v[80:83]
s_waitcnt lgkmcnt(12)
v_mfma_f32_16x16x32_bf16 v[76:79], v[96:99], a[12:15], v[76:79]
v_mfma_f32_16x16x32_bf16 v[80:83], v[96:99], a[76:79], v[80:83]
s_add_u32 s6, s13, 2884608
buffer_load_dwordx4 a[228:231], v10, s[52:55], s6 offen nt
s_waitcnt lgkmcnt(11)
v_mfma_f32_16x16x32_bf16 v[76:79], v[100:103], a[16:19], v[76:79]
v_mfma_f32_16x16x32_bf16 v[80:83], v[100:103], a[80:83], v[80:83]
s_waitcnt lgkmcnt(10)
v_mfma_f32_16x16x32_bf16 v[76:79], v[104:107], a[20:23], v[76:79]
v_mfma_f32_16x16x32_bf16 v[80:83], v[104:107], a[84:87], v[80:83]
s_add_u32 s6, s13, 2885632
buffer_load_dwordx4 a[232:235], v10, s[52:55], s6 offen nt
s_waitcnt lgkmcnt(9)
v_mfma_f32_16x16x32_bf16 v[76:79], v[108:111], a[24:27], v[76:79]
v_mfma_f32_16x16x32_bf16 v[80:83], v[108:111], a[88:91], v[80:83]
s_waitcnt lgkmcnt(8)
v_mfma_f32_16x16x32_bf16 v[76:79], v[112:115], a[28:31], v[76:79]
v_mfma_f32_16x16x32_bf16 v[80:83], v[112:115], a[92:95], v[80:83]
s_add_u32 s6, s13, 2886656
buffer_load_dwordx4 a[236:239], v10, s[52:55], s6 offen nt
s_waitcnt lgkmcnt(7)
v_mfma_f32_16x16x32_bf16 v[76:79], v[116:119], a[32:35], v[76:79]
v_mfma_f32_16x16x32_bf16 v[80:83], v[116:119], a[96:99], v[80:83]
s_waitcnt lgkmcnt(6)
v_mfma_f32_16x16x32_bf16 v[76:79], v[120:123], a[36:39], v[76:79]
v_mfma_f32_16x16x32_bf16 v[80:83], v[120:123], a[100:103], v[80:83]
s_add_u32 s6, s13, 3014656
buffer_load_dwordx4 a[240:243], v10, s[52:55], s6 offen nt
s_waitcnt lgkmcnt(5)
v_mfma_f32_16x16x32_bf16 v[76:79], v[124:127], a[40:43], v[76:79]
v_mfma_f32_16x16x32_bf16 v[80:83], v[124:127], a[104:107], v[80:83]
s_waitcnt lgkmcnt(4)
v_mfma_f32_16x16x32_bf16 v[76:79], v[128:131], a[44:47], v[76:79]
v_mfma_f32_16x16x32_bf16 v[80:83], v[128:131], a[108:111], v[80:83]
s_add_u32 s6, s13, 3015680
buffer_load_dwordx4 a[244:247], v10, s[52:55], s6 offen nt
s_waitcnt lgkmcnt(3)
v_mfma_f32_16x16x32_bf16 v[76:79], v[132:135], a[48:51], v[76:79]
v_mfma_f32_16x16x32_bf16 v[80:83], v[132:135], a[112:115], v[80:83]
s_waitcnt lgkmcnt(2)
v_mfma_f32_16x16x32_bf16 v[76:79], v[136:139], a[52:55], v[76:79]
v_mfma_f32_16x16x32_bf16 v[80:83], v[136:139], a[116:119], v[80:83]
s_add_u32 s6, s13, 3016704
buffer_load_dwordx4 a[248:251], v10, s[52:55], s6 offen nt
s_waitcnt lgkmcnt(1)
v_mfma_f32_16x16x32_bf16 v[76:79], v[140:143], a[56:59], v[76:79]
v_mfma_f32_16x16x32_bf16 v[80:83], v[140:143], a[120:123], v[80:83]
s_waitcnt lgkmcnt(0)
v_mfma_f32_16x16x32_bf16 v[76:79], v[144:147], a[60:63], v[76:79]
v_mfma_f32_16x16x32_bf16 v[80:83], v[144:147], a[124:127], v[80:83]
s_add_u32 s6, s13, 3017728
buffer_load_dwordx4 a[252:255], v10, s[52:55], s6 offen nt
s_nop 4
v_max_f32 v190, v76, v77
v_max3_f32 v190, v190, v78, v79
v_mov_b32 v192, v190
s_nop 1
v_permlane16_swap_b32 v190, v192
v_max_f32 v190, v190, v192
v_mov_b32 v192, v190
s_nop 1
v_permlane32_swap_b32 v190, v192
v_max_f32 v190, v190, v192
ds_write_b32 v198, v190 offset:0
v_max_f32 v191, v80, v81
v_max3_f32 v191, v191, v82, v83
v_mov_b32 v192, v191
s_nop 1
v_permlane16_swap_b32 v191, v192
v_max_f32 v191, v191, v192
v_mov_b32 v192, v191
s_nop 1
v_permlane32_swap_b32 v191, v192
v_max_f32 v191, v191, v192
ds_write_b32 v198, v191 offset:256
s_waitcnt lgkmcnt(0)
s_barrier
ds_read_b128 v[164:167], v199
ds_read_b128 v[168:171], v199 offset:256
ds_read_b128 v[172:175], v200
s_waitcnt vmcnt(16)
ds_write_b128 v206, a[128:131] offset:0
ds_write_b128 v206, a[132:135] offset:1088
ds_write_b128 v206, a[136:139] offset:2176
ds_write_b128 v206, a[140:143] offset:3264
ds_write_b128 v206, a[144:147] offset:4352
ds_write_b128 v206, a[148:151] offset:5440
ds_write_b128 v206, a[152:155] offset:6528
ds_write_b128 v206, a[156:159] offset:7616
ds_write_b128 v206, a[160:163] offset:8704
ds_write_b128 v206, a[164:167] offset:9792
ds_write_b128 v206, a[168:171] offset:10880
ds_write_b128 v206, a[172:175] offset:11968
ds_write_b128 v206, a[176:179] offset:13056
ds_write_b128 v206, a[180:183] offset:14144
ds_write_b128 v206, a[184:187] offset:15232
ds_write_b128 v206, a[188:191] offset:16320
s_waitcnt lgkmcnt(15)
v_max_f32 v164, v164, v165
v_max3_f32 v164, v164, v166, v167
v_mul_f32 v164, v164, v185
v_max_f32 v164, v164, v176
v_sub_f32 v182, v176, v164
v_exp_f32 v182, v182
v_mov_b32 v176, v164
v_max_f32 v168, v168, v169
v_max3_f32 v168, v168, v170, v171
v_mul_f32 v168, v168, v185
v_max_f32 v168, v168, v177
v_sub_f32 v183, v177, v168
v_exp_f32 v183, v183
v_mov_b32 v177, v168
v_max_f32 v172, v172, v173
v_max3_f32 v172, v172, v174, v175
v_mul_f32 v172, v172, v185
v_max_f32 v172, v172, v178
v_sub_f32 v184, v178, v172
v_exp_f32 v184, v184
v_mov_b32 v178, v172
v_fma_f32 v76, v76, v185, -v176
v_fma_f32 v77, v77, v185, -v176
v_fma_f32 v78, v78, v185, -v176
v_fma_f32 v79, v79, v185, -v176
v_exp_f32 v76, v76
v_exp_f32 v77, v77
v_exp_f32 v78, v78
v_exp_f32 v79, v79
v_mul_f32 v180, v180, v182
v_cvt_pk_bf16_f32 v186, v76, v77
v_cvt_pk_bf16_f32 v187, v78, v79
ds_write_b64 v201, v[186:187] offset:0
v_add_f32 v180, v180, v76
v_add_f32 v180, v180, v77
v_add_f32 v180, v180, v78
v_add_f32 v180, v180, v79
v_fma_f32 v80, v80, v185, -v177
v_fma_f32 v81, v81, v185, -v177
v_fma_f32 v82, v82, v185, -v177
v_fma_f32 v83, v83, v185, -v177
v_exp_f32 v80, v80
v_exp_f32 v81, v81
v_exp_f32 v82, v82
v_exp_f32 v83, v83
v_mul_f32 v181, v181, v183
v_cvt_pk_bf16_f32 v188, v80, v81
v_cvt_pk_bf16_f32 v189, v82, v83
ds_write_b64 v201, v[188:189] offset:512
v_add_f32 v181, v181, v80
v_add_f32 v181, v181, v81
v_add_f32 v181, v181, v82
v_add_f32 v181, v181, v83
v_mul_f32 v12, v12, v184
v_mul_f32 v13, v13, v184
v_mul_f32 v14, v14, v184
v_mul_f32 v15, v15, v184
v_mul_f32 v16, v16, v184
v_mul_f32 v17, v17, v184
v_mul_f32 v18, v18, v184
v_mul_f32 v19, v19, v184
v_mul_f32 v20, v20, v184
v_mul_f32 v21, v21, v184
v_mul_f32 v22, v22, v184
v_mul_f32 v23, v23, v184
v_mul_f32 v24, v24, v184
v_mul_f32 v25, v25, v184
v_mul_f32 v26, v26, v184
v_mul_f32 v27, v27, v184
v_mul_f32 v28, v28, v184
v_mul_f32 v29, v29, v184
v_mul_f32 v30, v30, v184
v_mul_f32 v31, v31, v184
v_mul_f32 v32, v32, v184
v_mul_f32 v33, v33, v184
v_mul_f32 v34, v34, v184
v_mul_f32 v35, v35, v184
v_mul_f32 v36, v36, v184
v_mul_f32 v37, v37, v184
v_mul_f32 v38, v38, v184
v_mul_f32 v39, v39, v184
v_mul_f32 v40, v40, v184
v_mul_f32 v41, v41, v184
v_mul_f32 v42, v42, v184
v_mul_f32 v43, v43, v184
v_mul_f32 v44, v44, v184
v_mul_f32 v45, v45, v184
v_mul_f32 v46, v46, v184
v_mul_f32 v47, v47, v184
v_mul_f32 v48, v48, v184
v_mul_f32 v49, v49, v184
v_mul_f32 v50, v50, v184
v_mul_f32 v51, v51, v184
v_mul_f32 v52, v52, v184
v_mul_f32 v53, v53, v184
v_mul_f32 v54, v54, v184
v_mul_f32 v55, v55, v184
v_mul_f32 v56, v56, v184
v_mul_f32 v57, v57, v184
v_mul_f32 v58, v58, v184
v_mul_f32 v59, v59, v184
v_mul_f32 v60, v60, v184
v_mul_f32 v61, v61, v184
v_mul_f32 v62, v62, v184
v_mul_f32 v63, v63, v184
v_mul_f32 v64, v64, v184
v_mul_f32 v65, v65, v184
v_mul_f32 v66, v66, v184
v_mul_f32 v67, v67, v184
v_mul_f32 v68, v68, v184
v_mul_f32 v69, v69, v184
v_mul_f32 v70, v70, v184
v_mul_f32 v71, v71, v184
v_mul_f32 v72, v72, v184
v_mul_f32 v73, v73, v184
v_mul_f32 v74, v74, v184
v_mul_f32 v75, v75, v184
s_waitcnt lgkmcnt(0)
s_barrier
ds_read_b128 v[148:151], v202 offset:0
ds_read_b128 v[152:155], v202 offset:1024
ds_read_b128 v[156:159], v202 offset:2048
ds_read_b128 v[160:163], v202 offset:3072
ds_read_b64_tr_b16 v[84:85], v197 offset:0
ds_read_b64_tr_b16 v[86:87], v197 offset:4352
ds_read_b64_tr_b16 v[88:89], v197 offset:64
ds_read_b64_tr_b16 v[90:91], v197 offset:4416
ds_read_b64_tr_b16 v[92:93], v197 offset:128
ds_read_b64_tr_b16 v[94:95], v197 offset:4480
ds_read_b64_tr_b16 v[96:97], v197 offset:192
ds_read_b64_tr_b16 v[98:99], v197 offset:4544
ds_read_b64_tr_b16 v[100:101], v197 offset:17408
ds_read_b64_tr_b16 v[102:103], v197 offset:21760
ds_read_b64_tr_b16 v[104:105], v197 offset:17472
ds_read_b64_tr_b16 v[106:107], v197 offset:21824
ds_read_b64_tr_b16 v[108:109], v197 offset:17536
ds_read_b64_tr_b16 v[110:111], v197 offset:21888
ds_read_b64_tr_b16 v[112:113], v197 offset:17600
ds_read_b64_tr_b16 v[114:115], v197 offset:21952
ds_read_b64_tr_b16 v[116:117], v197 offset:34816
ds_read_b64_tr_b16 v[118:119], v197 offset:39168
ds_read_b64_tr_b16 v[120:121], v197 offset:34880
ds_read_b64_tr_b16 v[122:123], v197 offset:39232
ds_read_b64_tr_b16 v[124:125], v197 offset:34944
ds_read_b64_tr_b16 v[126:127], v197 offset:39296
ds_read_b64_tr_b16 v[128:129], v197 offset:35008
ds_read_b64_tr_b16 v[130:131], v197 offset:39360
ds_read_b64_tr_b16 v[132:133], v197 offset:52224
ds_read_b64_tr_b16 v[134:135], v197 offset:56576
ds_read_b64_tr_b16 v[136:137], v197 offset:52288
ds_read_b64_tr_b16 v[138:139], v197 offset:56640
ds_read_b64_tr_b16 v[140:141], v197 offset:52352
ds_read_b64_tr_b16 v[142:143], v197 offset:56704
ds_read_b64_tr_b16 v[144:145], v197 offset:52416
ds_read_b64_tr_b16 v[146:147], v197 offset:56768
s_waitcnt lgkmcnt(15)
v_mfma_f32_32x32x16_bf16 v[12:27], v[84:87], v[148:151], v[12:27]
v_mfma_f32_32x32x16_bf16 v[28:43], v[88:91], v[148:151], v[28:43]
s_add_u32 s6, s13, 3145728
buffer_load_dwordx4 a[128:131], v2, s[52:55], s6 offen nt
v_mfma_f32_32x32x16_bf16 v[44:59], v[92:95], v[148:151], v[44:59]
v_mfma_f32_32x32x16_bf16 v[60:75], v[96:99], v[148:151], v[60:75]
s_add_u32 s6, s13, 3146752
buffer_load_dwordx4 a[132:135], v2, s[52:55], s6 offen nt
s_waitcnt lgkmcnt(15)
v_mfma_f32_32x32x16_bf16 v[12:27], v[100:103], v[152:155], v[12:27]
v_mfma_f32_32x32x16_bf16 v[28:43], v[104:107], v[152:155], v[28:43]
s_add_u32 s6, s13, 3147776
buffer_load_dwordx4 a[136:139], v2, s[52:55], s6 offen nt
v_mfma_f32_32x32x16_bf16 v[44:59], v[108:111], v[152:155], v[44:59]
v_mfma_f32_32x32x16_bf16 v[60:75], v[112:115], v[152:155], v[60:75]
s_add_u32 s6, s13, 3148800
buffer_load_dwordx4 a[140:143], v2, s[52:55], s6 offen nt
s_waitcnt lgkmcnt(8)
v_mfma_f32_32x32x16_bf16 v[12:27], v[116:119], v[156:159], v[12:27]
v_mfma_f32_32x32x16_bf16 v[28:43], v[120:123], v[156:159], v[28:43]
s_add_u32 s6, s13, 3276800
buffer_load_dwordx4 a[144:147], v2, s[52:55], s6 offen nt
v_mfma_f32_32x32x16_bf16 v[44:59], v[124:127], v[156:159], v[44:59]
v_mfma_f32_32x32x16_bf16 v[60:75], v[128:131], v[156:159], v[60:75]
s_add_u32 s6, s13, 3277824
buffer_load_dwordx4 a[148:151], v2, s[52:55], s6 offen nt
s_waitcnt lgkmcnt(0)
v_mfma_f32_32x32x16_bf16 v[12:27], v[132:135], v[160:163], v[12:27]
v_mfma_f32_32x32x16_bf16 v[28:43], v[136:139], v[160:163], v[28:43]
s_add_u32 s6, s13, 3278848
buffer_load_dwordx4 a[152:155], v2, s[52:55], s6 offen nt
v_mfma_f32_32x32x16_bf16 v[44:59], v[140:143], v[160:163], v[44:59]
v_mfma_f32_32x32x16_bf16 v[60:75], v[144:147], v[160:163], v[60:75]
s_add_u32 s6, s13, 3279872
buffer_load_dwordx4 a[156:159], v2, s[52:55], s6 offen nt
ds_read_b128 v[84:87], v194 offset:0
ds_read_b128 v[88:91], v194 offset:64
ds_read_b128 v[92:95], v194 offset:128
ds_read_b128 v[96:99], v194 offset:192
ds_read_b128 v[100:103], v194 offset:256
ds_read_b128 v[104:107], v194 offset:320
ds_read_b128 v[108:111], v194 offset:384
ds_read_b128 v[112:115], v194 offset:448
ds_read_b128 v[116:119], v194 offset:512
ds_read_b128 v[120:123], v194 offset:576
ds_read_b128 v[124:127], v194 offset:640
ds_read_b128 v[128:131], v194 offset:704
ds_read_b128 v[132:135], v194 offset:768
ds_read_b128 v[136:139], v194 offset:832
ds_read_b128 v[140:143], v194 offset:896
ds_read_b128 v[144:147], v194 offset:960
s_waitcnt lgkmcnt(15)
v_mfma_f32_16x16x32_bf16 v[76:79], v[84:87], a[0:3], 0
v_mfma_f32_16x16x32_bf16 v[80:83], v[84:87], a[64:67], 0
s_waitcnt lgkmcnt(14)
v_mfma_f32_16x16x32_bf16 v[76:79], v[88:91], a[4:7], v[76:79]
v_mfma_f32_16x16x32_bf16 v[80:83], v[88:91], a[68:71], v[80:83]
s_add_u32 s6, s13, 3407872
buffer_load_dwordx4 a[160:163], v10, s[52:55], s6 offen nt
s_waitcnt lgkmcnt(13)
v_mfma_f32_16x16x32_bf16 v[76:79], v[92:95], a[8:11], v[76:79]
v_mfma_f32_16x16x32_bf16 v[80:83], v[92:95], a[72:75], v[80:83]
s_waitcnt lgkmcnt(12)
v_mfma_f32_16x16x32_bf16 v[76:79], v[96:99], a[12:15], v[76:79]
v_mfma_f32_16x16x32_bf16 v[80:83], v[96:99], a[76:79], v[80:83]
s_add_u32 s6, s13, 3408896
buffer_load_dwordx4 a[164:167], v10, s[52:55], s6 offen nt
s_waitcnt lgkmcnt(11)
v_mfma_f32_16x16x32_bf16 v[76:79], v[100:103], a[16:19], v[76:79]
v_mfma_f32_16x16x32_bf16 v[80:83], v[100:103], a[80:83], v[80:83]
s_waitcnt lgkmcnt(10)
v_mfma_f32_16x16x32_bf16 v[76:79], v[104:107], a[20:23], v[76:79]
v_mfma_f32_16x16x32_bf16 v[80:83], v[104:107], a[84:87], v[80:83]
s_add_u32 s6, s13, 3409920
buffer_load_dwordx4 a[168:171], v10, s[52:55], s6 offen nt
s_waitcnt lgkmcnt(9)
v_mfma_f32_16x16x32_bf16 v[76:79], v[108:111], a[24:27], v[76:79]
v_mfma_f32_16x16x32_bf16 v[80:83], v[108:111], a[88:91], v[80:83]
s_waitcnt lgkmcnt(8)
v_mfma_f32_16x16x32_bf16 v[76:79], v[112:115], a[28:31], v[76:79]
v_mfma_f32_16x16x32_bf16 v[80:83], v[112:115], a[92:95], v[80:83]
s_add_u32 s6, s13, 3410944
buffer_load_dwordx4 a[172:175], v10, s[52:55], s6 offen nt
s_waitcnt lgkmcnt(7)
v_mfma_f32_16x16x32_bf16 v[76:79], v[116:119], a[32:35], v[76:79]
v_mfma_f32_16x16x32_bf16 v[80:83], v[116:119], a[96:99], v[80:83]
s_waitcnt lgkmcnt(6)
v_mfma_f32_16x16x32_bf16 v[76:79], v[120:123], a[36:39], v[76:79]
v_mfma_f32_16x16x32_bf16 v[80:83], v[120:123], a[100:103], v[80:83]
s_add_u32 s6, s13, 3538944
buffer_load_dwordx4 a[176:179], v10, s[52:55], s6 offen nt
s_waitcnt lgkmcnt(5)
v_mfma_f32_16x16x32_bf16 v[76:79], v[124:127], a[40:43], v[76:79]
v_mfma_f32_16x16x32_bf16 v[80:83], v[124:127], a[104:107], v[80:83]
s_waitcnt lgkmcnt(4)
v_mfma_f32_16x16x32_bf16 v[76:79], v[128:131], a[44:47], v[76:79]
v_mfma_f32_16x16x32_bf16 v[80:83], v[128:131], a[108:111], v[80:83]
s_add_u32 s6, s13, 3539968
buffer_load_dwordx4 a[180:183], v10, s[52:55], s6 offen nt
s_waitcnt lgkmcnt(3)
v_mfma_f32_16x16x32_bf16 v[76:79], v[132:135], a[48:51], v[76:79]
v_mfma_f32_16x16x32_bf16 v[80:83], v[132:135], a[112:115], v[80:83]
s_waitcnt lgkmcnt(2)
v_mfma_f32_16x16x32_bf16 v[76:79], v[136:139], a[52:55], v[76:79]
v_mfma_f32_16x16x32_bf16 v[80:83], v[136:139], a[116:119], v[80:83]
s_add_u32 s6, s13, 3540992
buffer_load_dwordx4 a[184:187], v10, s[52:55], s6 offen nt
s_waitcnt lgkmcnt(1)
v_mfma_f32_16x16x32_bf16 v[76:79], v[140:143], a[56:59], v[76:79]
v_mfma_f32_16x16x32_bf16 v[80:83], v[140:143], a[120:123], v[80:83]
s_waitcnt lgkmcnt(0)
v_mfma_f32_16x16x32_bf16 v[76:79], v[144:147], a[60:63], v[76:79]
v_mfma_f32_16x16x32_bf16 v[80:83], v[144:147], a[124:127], v[80:83]
s_add_u32 s6, s13, 3542016
buffer_load_dwordx4 a[188:191], v10, s[52:55], s6 offen nt
s_nop 4
v_max_f32 v190, v76, v77
v_max3_f32 v190, v190, v78, v79
v_mov_b32 v192, v190
s_nop 1
v_permlane16_swap_b32 v190, v192
v_max_f32 v190, v190, v192
v_mov_b32 v192, v190
s_nop 1
v_permlane32_swap_b32 v190, v192
v_max_f32 v190, v190, v192
ds_write_b32 v198, v190 offset:0
v_max_f32 v191, v80, v81
v_max3_f32 v191, v191, v82, v83
v_mov_b32 v192, v191
s_nop 1
v_permlane16_swap_b32 v191, v192
v_max_f32 v191, v191, v192
v_mov_b32 v192, v191
s_nop 1
v_permlane32_swap_b32 v191, v192
v_max_f32 v191, v191, v192
ds_write_b32 v198, v191 offset:256
s_waitcnt lgkmcnt(0)
s_barrier
ds_read_b128 v[164:167], v199
ds_read_b128 v[168:171], v199 offset:256
ds_read_b128 v[172:175], v200
s_waitcnt vmcnt(16)
ds_write_b128 v207, a[192:195] offset:0
ds_write_b128 v207, a[196:199] offset:1088
ds_write_b128 v207, a[200:203] offset:2176
ds_write_b128 v207, a[204:207] offset:3264
ds_write_b128 v207, a[208:211] offset:4352
ds_write_b128 v207, a[212:215] offset:5440
ds_write_b128 v207, a[216:219] offset:6528
ds_write_b128 v207, a[220:223] offset:7616
ds_write_b128 v207, a[224:227] offset:8704
ds_write_b128 v207, a[228:231] offset:9792
ds_write_b128 v207, a[232:235] offset:10880
ds_write_b128 v207, a[236:239] offset:11968
ds_write_b128 v207, a[240:243] offset:13056
ds_write_b128 v207, a[244:247] offset:14144
ds_write_b128 v207, a[248:251] offset:15232
ds_write_b128 v207, a[252:255] offset:16320
s_waitcnt lgkmcnt(15)
v_max_f32 v164, v164, v165
v_max3_f32 v164, v164, v166, v167
v_mul_f32 v164, v164, v185
v_max_f32 v164, v164, v176
v_sub_f32 v182, v176, v164
v_exp_f32 v182, v182
v_mov_b32 v176, v164
v_max_f32 v168, v168, v169
v_max3_f32 v168, v168, v170, v171
v_mul_f32 v168, v168, v185
v_max_f32 v168, v168, v177
v_sub_f32 v183, v177, v168
v_exp_f32 v183, v183
v_mov_b32 v177, v168
v_max_f32 v172, v172, v173
v_max3_f32 v172, v172, v174, v175
v_mul_f32 v172, v172, v185
v_max_f32 v172, v172, v178
v_sub_f32 v184, v178, v172
v_exp_f32 v184, v184
v_mov_b32 v178, v172
v_fma_f32 v76, v76, v185, -v176
v_fma_f32 v77, v77, v185, -v176
v_fma_f32 v78, v78, v185, -v176
v_fma_f32 v79, v79, v185, -v176
v_exp_f32 v76, v76
v_exp_f32 v77, v77
v_exp_f32 v78, v78
v_exp_f32 v79, v79
v_mul_f32 v180, v180, v182
v_cvt_pk_bf16_f32 v186, v76, v77
v_cvt_pk_bf16_f32 v187, v78, v79
ds_write_b64 v201, v[186:187] offset:0
v_add_f32 v180, v180, v76
v_add_f32 v180, v180, v77
v_add_f32 v180, v180, v78
v_add_f32 v180, v180, v79
v_fma_f32 v80, v80, v185, -v177
v_fma_f32 v81, v81, v185, -v177
v_fma_f32 v82, v82, v185, -v177
v_fma_f32 v83, v83, v185, -v177
v_exp_f32 v80, v80
v_exp_f32 v81, v81
v_exp_f32 v82, v82
v_exp_f32 v83, v83
v_mul_f32 v181, v181, v183
v_cvt_pk_bf16_f32 v188, v80, v81
v_cvt_pk_bf16_f32 v189, v82, v83
ds_write_b64 v201, v[188:189] offset:512
v_add_f32 v181, v181, v80
v_add_f32 v181, v181, v81
v_add_f32 v181, v181, v82
v_add_f32 v181, v181, v83
v_mul_f32 v12, v12, v184
v_mul_f32 v13, v13, v184
v_mul_f32 v14, v14, v184
v_mul_f32 v15, v15, v184
v_mul_f32 v16, v16, v184
v_mul_f32 v17, v17, v184
v_mul_f32 v18, v18, v184
v_mul_f32 v19, v19, v184
v_mul_f32 v20, v20, v184
v_mul_f32 v21, v21, v184
v_mul_f32 v22, v22, v184
v_mul_f32 v23, v23, v184
v_mul_f32 v24, v24, v184
v_mul_f32 v25, v25, v184
v_mul_f32 v26, v26, v184
v_mul_f32 v27, v27, v184
v_mul_f32 v28, v28, v184
v_mul_f32 v29, v29, v184
v_mul_f32 v30, v30, v184
v_mul_f32 v31, v31, v184
v_mul_f32 v32, v32, v184
v_mul_f32 v33, v33, v184
v_mul_f32 v34, v34, v184
v_mul_f32 v35, v35, v184
v_mul_f32 v36, v36, v184
v_mul_f32 v37, v37, v184
v_mul_f32 v38, v38, v184
v_mul_f32 v39, v39, v184
v_mul_f32 v40, v40, v184
v_mul_f32 v41, v41, v184
v_mul_f32 v42, v42, v184
v_mul_f32 v43, v43, v184
v_mul_f32 v44, v44, v184
v_mul_f32 v45, v45, v184
v_mul_f32 v46, v46, v184
v_mul_f32 v47, v47, v184
v_mul_f32 v48, v48, v184
v_mul_f32 v49, v49, v184
v_mul_f32 v50, v50, v184
v_mul_f32 v51, v51, v184
v_mul_f32 v52, v52, v184
v_mul_f32 v53, v53, v184
v_mul_f32 v54, v54, v184
v_mul_f32 v55, v55, v184
v_mul_f32 v56, v56, v184
v_mul_f32 v57, v57, v184
v_mul_f32 v58, v58, v184
v_mul_f32 v59, v59, v184
v_mul_f32 v60, v60, v184
v_mul_f32 v61, v61, v184
v_mul_f32 v62, v62, v184
v_mul_f32 v63, v63, v184
v_mul_f32 v64, v64, v184
v_mul_f32 v65, v65, v184
v_mul_f32 v66, v66, v184
v_mul_f32 v67, v67, v184
v_mul_f32 v68, v68, v184
v_mul_f32 v69, v69, v184
v_mul_f32 v70, v70, v184
v_mul_f32 v71, v71, v184
v_mul_f32 v72, v72, v184
v_mul_f32 v73, v73, v184
v_mul_f32 v74, v74, v184
v_mul_f32 v75, v75, v184
s_waitcnt lgkmcnt(0)
s_barrier
ds_read_b128 v[148:151], v202 offset:0
ds_read_b128 v[152:155], v202 offset:1024
ds_read_b128 v[156:159], v202 offset:2048
ds_read_b128 v[160:163], v202 offset:3072
ds_read_b64_tr_b16 v[84:85], v196 offset:0
ds_read_b64_tr_b16 v[86:87], v196 offset:4352
ds_read_b64_tr_b16 v[88:89], v196 offset:64
ds_read_b64_tr_b16 v[90:91], v196 offset:4416
ds_read_b64_tr_b16 v[92:93], v196 offset:128
ds_read_b64_tr_b16 v[94:95], v196 offset:4480
ds_read_b64_tr_b16 v[96:97], v196 offset:192
ds_read_b64_tr_b16 v[98:99], v196 offset:4544
ds_read_b64_tr_b16 v[100:101], v196 offset:17408
ds_read_b64_tr_b16 v[102:103], v196 offset:21760
ds_read_b64_tr_b16 v[104:105], v196 offset:17472
ds_read_b64_tr_b16 v[106:107], v196 offset:21824
ds_read_b64_tr_b16 v[108:109], v196 offset:17536
ds_read_b64_tr_b16 v[110:111], v196 offset:21888
ds_read_b64_tr_b16 v[112:113], v196 offset:17600
ds_read_b64_tr_b16 v[114:115], v196 offset:21952
ds_read_b64_tr_b16 v[116:117], v196 offset:34816
ds_read_b64_tr_b16 v[118:119], v196 offset:39168
ds_read_b64_tr_b16 v[120:121], v196 offset:34880
ds_read_b64_tr_b16 v[122:123], v196 offset:39232
ds_read_b64_tr_b16 v[124:125], v196 offset:34944
ds_read_b64_tr_b16 v[126:127], v196 offset:39296
ds_read_b64_tr_b16 v[128:129], v196 offset:35008
ds_read_b64_tr_b16 v[130:131], v196 offset:39360
ds_read_b64_tr_b16 v[132:133], v196 offset:52224
ds_read_b64_tr_b16 v[134:135], v196 offset:56576
ds_read_b64_tr_b16 v[136:137], v196 offset:52288
ds_read_b64_tr_b16 v[138:139], v196 offset:56640
ds_read_b64_tr_b16 v[140:141], v196 offset:52352
ds_read_b64_tr_b16 v[142:143], v196 offset:56704
ds_read_b64_tr_b16 v[144:145], v196 offset:52416
ds_read_b64_tr_b16 v[146:147], v196 offset:56768
s_waitcnt lgkmcnt(15)
v_mfma_f32_32x32x16_bf16 v[12:27], v[84:87], v[148:151], v[12:27]
v_mfma_f32_32x32x16_bf16 v[28:43], v[88:91], v[148:151], v[28:43]
s_add_u32 s6, s13, 3670016
buffer_load_dwordx4 a[192:195], v2, s[52:55], s6 offen nt
v_mfma_f32_32x32x16_bf16 v[44:59], v[92:95], v[148:151], v[44:59]
v_mfma_f32_32x32x16_bf16 v[60:75], v[96:99], v[148:151], v[60:75]
s_add_u32 s6, s13, 3671040
buffer_load_dwordx4 a[196:199], v2, s[52:55], s6 offen nt
s_waitcnt lgkmcnt(15)
v_mfma_f32_32x32x16_bf16 v[12:27], v[100:103], v[152:155], v[12:27]
v_mfma_f32_32x32x16_bf16 v[28:43], v[104:107], v[152:155], v[28:43]
s_add_u32 s6, s13, 3672064
buffer_load_dwordx4 a[200:203], v2, s[52:55], s6 offen nt
v_mfma_f32_32x32x16_bf16 v[44:59], v[108:111], v[152:155], v[44:59]
v_mfma_f32_32x32x16_bf16 v[60:75], v[112:115], v[152:155], v[60:75]
s_add_u32 s6, s13, 3673088
buffer_load_dwordx4 a[204:207], v2, s[52:55], s6 offen nt
s_waitcnt lgkmcnt(8)
v_mfma_f32_32x32x16_bf16 v[12:27], v[116:119], v[156:159], v[12:27]
v_mfma_f32_32x32x16_bf16 v[28:43], v[120:123], v[156:159], v[28:43]
s_add_u32 s6, s13, 3801088
buffer_load_dwordx4 a[208:211], v2, s[52:55], s6 offen nt
v_mfma_f32_32x32x16_bf16 v[44:59], v[124:127], v[156:159], v[44:59]
v_mfma_f32_32x32x16_bf16 v[60:75], v[128:131], v[156:159], v[60:75]
s_add_u32 s6, s13, 3802112
buffer_load_dwordx4 a[212:215], v2, s[52:55], s6 offen nt
s_waitcnt lgkmcnt(0)
v_mfma_f32_32x32x16_bf16 v[12:27], v[132:135], v[160:163], v[12:27]
v_mfma_f32_32x32x16_bf16 v[28:43], v[136:139], v[160:163], v[28:43]
s_add_u32 s6, s13, 3803136
buffer_load_dwordx4 a[216:219], v2, s[52:55], s6 offen nt
v_mfma_f32_32x32x16_bf16 v[44:59], v[140:143], v[160:163], v[44:59]
v_mfma_f32_32x32x16_bf16 v[60:75], v[144:147], v[160:163], v[60:75]
s_add_u32 s6, s13, 3804160
buffer_load_dwordx4 a[220:223], v2, s[52:55], s6 offen nt
ds_read_b128 v[84:87], v195 offset:0
ds_read_b128 v[88:91], v195 offset:64
ds_read_b128 v[92:95], v195 offset:128
ds_read_b128 v[96:99], v195 offset:192
ds_read_b128 v[100:103], v195 offset:256
ds_read_b128 v[104:107], v195 offset:320
ds_read_b128 v[108:111], v195 offset:384
ds_read_b128 v[112:115], v195 offset:448
ds_read_b128 v[116:119], v195 offset:512
ds_read_b128 v[120:123], v195 offset:576
ds_read_b128 v[124:127], v195 offset:640
ds_read_b128 v[128:131], v195 offset:704
ds_read_b128 v[132:135], v195 offset:768
ds_read_b128 v[136:139], v195 offset:832
ds_read_b128 v[140:143], v195 offset:896
ds_read_b128 v[144:147], v195 offset:960
s_waitcnt lgkmcnt(15)
v_mfma_f32_16x16x32_bf16 v[76:79], v[84:87], a[0:3], 0
v_mfma_f32_16x16x32_bf16 v[80:83], v[84:87], a[64:67], 0
s_waitcnt lgkmcnt(14)
v_mfma_f32_16x16x32_bf16 v[76:79], v[88:91], a[4:7], v[76:79]
v_mfma_f32_16x16x32_bf16 v[80:83], v[88:91], a[68:71], v[80:83]
s_add_u32 s6, s13, 3932160
buffer_load_dwordx4 a[224:227], v10, s[52:55], s6 offen nt
s_waitcnt lgkmcnt(13)
v_mfma_f32_16x16x32_bf16 v[76:79], v[92:95], a[8:11], v[76:79]
v_mfma_f32_16x16x32_bf16 v[80:83], v[92:95], a[72:75], v[80:83]
s_waitcnt lgkmcnt(12)
v_mfma_f32_16x16x32_bf16 v[76:79], v[96:99], a[12:15], v[76:79]
v_mfma_f32_16x16x32_bf16 v[80:83], v[96:99], a[76:79], v[80:83]
s_add_u32 s6, s13, 3933184
buffer_load_dwordx4 a[228:231], v10, s[52:55], s6 offen nt
s_waitcnt lgkmcnt(11)
v_mfma_f32_16x16x32_bf16 v[76:79], v[100:103], a[16:19], v[76:79]
v_mfma_f32_16x16x32_bf16 v[80:83], v[100:103], a[80:83], v[80:83]
s_waitcnt lgkmcnt(10)
v_mfma_f32_16x16x32_bf16 v[76:79], v[104:107], a[20:23], v[76:79]
v_mfma_f32_16x16x32_bf16 v[80:83], v[104:107], a[84:87], v[80:83]
s_add_u32 s6, s13, 3934208
buffer_load_dwordx4 a[232:235], v10, s[52:55], s6 offen nt
s_waitcnt lgkmcnt(9)
v_mfma_f32_16x16x32_bf16 v[76:79], v[108:111], a[24:27], v[76:79]
v_mfma_f32_16x16x32_bf16 v[80:83], v[108:111], a[88:91], v[80:83]
s_waitcnt lgkmcnt(8)
v_mfma_f32_16x16x32_bf16 v[76:79], v[112:115], a[28:31], v[76:79]
v_mfma_f32_16x16x32_bf16 v[80:83], v[112:115], a[92:95], v[80:83]
s_add_u32 s6, s13, 3935232
buffer_load_dwordx4 a[236:239], v10, s[52:55], s6 offen nt
s_waitcnt lgkmcnt(7)
v_mfma_f32_16x16x32_bf16 v[76:79], v[116:119], a[32:35], v[76:79]
v_mfma_f32_16x16x32_bf16 v[80:83], v[116:119], a[96:99], v[80:83]
s_waitcnt lgkmcnt(6)
v_mfma_f32_16x16x32_bf16 v[76:79], v[120:123], a[36:39], v[76:79]
v_mfma_f32_16x16x32_bf16 v[80:83], v[120:123], a[100:103], v[80:83]
s_add_u32 s6, s13, 4063232
buffer_load_dwordx4 a[240:243], v10, s[52:55], s6 offen nt
s_waitcnt lgkmcnt(5)
v_mfma_f32_16x16x32_bf16 v[76:79], v[124:127], a[40:43], v[76:79]
v_mfma_f32_16x16x32_bf16 v[80:83], v[124:127], a[104:107], v[80:83]
s_waitcnt lgkmcnt(4)
v_mfma_f32_16x16x32_bf16 v[76:79], v[128:131], a[44:47], v[76:79]
v_mfma_f32_16x16x32_bf16 v[80:83], v[128:131], a[108:111], v[80:83]
s_add_u32 s6, s13, 4064256
buffer_load_dwordx4 a[244:247], v10, s[52:55], s6 offen nt
s_waitcnt lgkmcnt(3)
v_mfma_f32_16x16x32_bf16 v[76:79], v[132:135], a[48:51], v[76:79]
v_mfma_f32_16x16x32_bf16 v[80:83], v[132:135], a[112:115], v[80:83]
s_waitcnt lgkmcnt(2)
v_mfma_f32_16x16x32_bf16 v[76:79], v[136:139], a[52:55], v[76:79]
v_mfma_f32_16x16x32_bf16 v[80:83], v[136:139], a[116:119], v[80:83]
s_add_u32 s6, s13, 4065280
buffer_load_dwordx4 a[248:251], v10, s[52:55], s6 offen nt
s_waitcnt lgkmcnt(1)
v_mfma_f32_16x16x32_bf16 v[76:79], v[140:143], a[56:59], v[76:79]
v_mfma_f32_16x16x32_bf16 v[80:83], v[140:143], a[120:123], v[80:83]
s_waitcnt lgkmcnt(0)
v_mfma_f32_16x16x32_bf16 v[76:79], v[144:147], a[60:63], v[76:79]
v_mfma_f32_16x16x32_bf16 v[80:83], v[144:147], a[124:127], v[80:83]
s_add_u32 s6, s13, 4066304
buffer_load_dwordx4 a[252:255], v10, s[52:55], s6 offen nt
s_nop 4
v_max_f32 v190, v76, v77
v_max3_f32 v190, v190, v78, v79
v_mov_b32 v192, v190
s_nop 1
v_permlane16_swap_b32 v190, v192
v_max_f32 v190, v190, v192
v_mov_b32 v192, v190
s_nop 1
v_permlane32_swap_b32 v190, v192
v_max_f32 v190, v190, v192
ds_write_b32 v198, v190 offset:0
v_max_f32 v191, v80, v81
v_max3_f32 v191, v191, v82, v83
v_mov_b32 v192, v191
s_nop 1
v_permlane16_swap_b32 v191, v192
v_max_f32 v191, v191, v192
v_mov_b32 v192, v191
s_nop 1
v_permlane32_swap_b32 v191, v192
v_max_f32 v191, v191, v192
ds_write_b32 v198, v191 offset:256
s_waitcnt lgkmcnt(0)
s_barrier
ds_read_b128 v[164:167], v199
ds_read_b128 v[168:171], v199 offset:256
ds_read_b128 v[172:175], v200
s_waitcnt vmcnt(16)
ds_write_b128 v206, a[128:131] offset:0
ds_write_b128 v206, a[132:135] offset:1088
ds_write_b128 v206, a[136:139] offset:2176
ds_write_b128 v206, a[140:143] offset:3264
ds_write_b128 v206, a[144:147] offset:4352
ds_write_b128 v206, a[148:151] offset:5440
ds_write_b128 v206, a[152:155] offset:6528
ds_write_b128 v206, a[156:159] offset:7616
ds_write_b128 v206, a[160:163] offset:8704
ds_write_b128 v206, a[164:167] offset:9792
ds_write_b128 v206, a[168:171] offset:10880
ds_write_b128 v206, a[172:175] offset:11968
ds_write_b128 v206, a[176:179] offset:13056
ds_write_b128 v206, a[180:183] offset:14144
ds_write_b128 v206, a[184:187] offset:15232
ds_write_b128 v206, a[188:191] offset:16320
s_waitcnt lgkmcnt(15)
v_max_f32 v164, v164, v165
v_max3_f32 v164, v164, v166, v167
v_mul_f32 v164, v164, v185
v_max_f32 v164, v164, v176
v_sub_f32 v182, v176, v164
v_exp_f32 v182, v182
v_mov_b32 v176, v164
v_max_f32 v168, v168, v169
v_max3_f32 v168, v168, v170, v171
v_mul_f32 v168, v168, v185
v_max_f32 v168, v168, v177
v_sub_f32 v183, v177, v168
v_exp_f32 v183, v183
v_mov_b32 v177, v168
v_max_f32 v172, v172, v173
v_max3_f32 v172, v172, v174, v175
v_mul_f32 v172, v172, v185
v_max_f32 v172, v172, v178
v_sub_f32 v184, v178, v172
v_exp_f32 v184, v184
v_mov_b32 v178, v172
v_fma_f32 v76, v76, v185, -v176
v_fma_f32 v77, v77, v185, -v176
v_fma_f32 v78, v78, v185, -v176
v_fma_f32 v79, v79, v185, -v176
v_exp_f32 v76, v76
v_exp_f32 v77, v77
v_exp_f32 v78, v78
v_exp_f32 v79, v79
v_mul_f32 v180, v180, v182
v_cvt_pk_bf16_f32 v186, v76, v77
v_cvt_pk_bf16_f32 v187, v78, v79
ds_write_b64 v201, v[186:187] offset:0
v_add_f32 v180, v180, v76
v_add_f32 v180, v180, v77
v_add_f32 v180, v180, v78
v_add_f32 v180, v180, v79
v_fma_f32 v80, v80, v185, -v177
v_fma_f32 v81, v81, v185, -v177
v_fma_f32 v82, v82, v185, -v177
v_fma_f32 v83, v83, v185, -v177
v_exp_f32 v80, v80
v_exp_f32 v81, v81
v_exp_f32 v82, v82
v_exp_f32 v83, v83
v_mul_f32 v181, v181, v183
v_cvt_pk_bf16_f32 v188, v80, v81
v_cvt_pk_bf16_f32 v189, v82, v83
ds_write_b64 v201, v[188:189] offset:512
v_add_f32 v181, v181, v80
v_add_f32 v181, v181, v81
v_add_f32 v181, v181, v82
v_add_f32 v181, v181, v83
v_mul_f32 v12, v12, v184
v_mul_f32 v13, v13, v184
v_mul_f32 v14, v14, v184
v_mul_f32 v15, v15, v184
v_mul_f32 v16, v16, v184
v_mul_f32 v17, v17, v184
v_mul_f32 v18, v18, v184
v_mul_f32 v19, v19, v184
v_mul_f32 v20, v20, v184
v_mul_f32 v21, v21, v184
v_mul_f32 v22, v22, v184
v_mul_f32 v23, v23, v184
v_mul_f32 v24, v24, v184
v_mul_f32 v25, v25, v184
v_mul_f32 v26, v26, v184
v_mul_f32 v27, v27, v184
v_mul_f32 v28, v28, v184
v_mul_f32 v29, v29, v184
v_mul_f32 v30, v30, v184
v_mul_f32 v31, v31, v184
v_mul_f32 v32, v32, v184
v_mul_f32 v33, v33, v184
v_mul_f32 v34, v34, v184
v_mul_f32 v35, v35, v184
v_mul_f32 v36, v36, v184
v_mul_f32 v37, v37, v184
v_mul_f32 v38, v38, v184
v_mul_f32 v39, v39, v184
v_mul_f32 v40, v40, v184
v_mul_f32 v41, v41, v184
v_mul_f32 v42, v42, v184
v_mul_f32 v43, v43, v184
v_mul_f32 v44, v44, v184
v_mul_f32 v45, v45, v184
v_mul_f32 v46, v46, v184
v_mul_f32 v47, v47, v184
v_mul_f32 v48, v48, v184
v_mul_f32 v49, v49, v184
v_mul_f32 v50, v50, v184
v_mul_f32 v51, v51, v184
v_mul_f32 v52, v52, v184
v_mul_f32 v53, v53, v184
v_mul_f32 v54, v54, v184
v_mul_f32 v55, v55, v184
v_mul_f32 v56, v56, v184
v_mul_f32 v57, v57, v184
v_mul_f32 v58, v58, v184
v_mul_f32 v59, v59, v184
v_mul_f32 v60, v60, v184
v_mul_f32 v61, v61, v184
v_mul_f32 v62, v62, v184
v_mul_f32 v63, v63, v184
v_mul_f32 v64, v64, v184
v_mul_f32 v65, v65, v184
v_mul_f32 v66, v66, v184
v_mul_f32 v67, v67, v184
v_mul_f32 v68, v68, v184
v_mul_f32 v69, v69, v184
v_mul_f32 v70, v70, v184
v_mul_f32 v71, v71, v184
v_mul_f32 v72, v72, v184
v_mul_f32 v73, v73, v184
v_mul_f32 v74, v74, v184
v_mul_f32 v75, v75, v184
s_waitcnt lgkmcnt(0)
s_barrier
ds_read_b128 v[148:151], v202 offset:0
ds_read_b128 v[152:155], v202 offset:1024
ds_read_b128 v[156:159], v202 offset:2048
ds_read_b128 v[160:163], v202 offset:3072
ds_read_b64_tr_b16 v[84:85], v197 offset:0
ds_read_b64_tr_b16 v[86:87], v197 offset:4352
ds_read_b64_tr_b16 v[88:89], v197 offset:64
ds_read_b64_tr_b16 v[90:91], v197 offset:4416
ds_read_b64_tr_b16 v[92:93], v197 offset:128
ds_read_b64_tr_b16 v[94:95], v197 offset:4480
ds_read_b64_tr_b16 v[96:97], v197 offset:192
ds_read_b64_tr_b16 v[98:99], v197 offset:4544
ds_read_b64_tr_b16 v[100:101], v197 offset:17408
ds_read_b64_tr_b16 v[102:103], v197 offset:21760
ds_read_b64_tr_b16 v[104:105], v197 offset:17472
ds_read_b64_tr_b16 v[106:107], v197 offset:21824
ds_read_b64_tr_b16 v[108:109], v197 offset:17536
ds_read_b64_tr_b16 v[110:111], v197 offset:21888
ds_read_b64_tr_b16 v[112:113], v197 offset:17600
ds_read_b64_tr_b16 v[114:115], v197 offset:21952
ds_read_b64_tr_b16 v[116:117], v197 offset:34816
ds_read_b64_tr_b16 v[118:119], v197 offset:39168
ds_read_b64_tr_b16 v[120:121], v197 offset:34880
ds_read_b64_tr_b16 v[122:123], v197 offset:39232
ds_read_b64_tr_b16 v[124:125], v197 offset:34944
ds_read_b64_tr_b16 v[126:127], v197 offset:39296
ds_read_b64_tr_b16 v[128:129], v197 offset:35008
ds_read_b64_tr_b16 v[130:131], v197 offset:39360
ds_read_b64_tr_b16 v[132:133], v197 offset:52224
ds_read_b64_tr_b16 v[134:135], v197 offset:56576
ds_read_b64_tr_b16 v[136:137], v197 offset:52288
ds_read_b64_tr_b16 v[138:139], v197 offset:56640
ds_read_b64_tr_b16 v[140:141], v197 offset:52352
ds_read_b64_tr_b16 v[142:143], v197 offset:56704
ds_read_b64_tr_b16 v[144:145], v197 offset:52416
ds_read_b64_tr_b16 v[146:147], v197 offset:56768
s_waitcnt lgkmcnt(15)
v_mfma_f32_32x32x16_bf16 v[12:27], v[84:87], v[148:151], v[12:27]
v_mfma_f32_32x32x16_bf16 v[28:43], v[88:91], v[148:151], v[28:43]
v_mfma_f32_32x32x16_bf16 v[44:59], v[92:95], v[148:151], v[44:59]
v_mfma_f32_32x32x16_bf16 v[60:75], v[96:99], v[148:151], v[60:75]
s_waitcnt lgkmcnt(15)
v_mfma_f32_32x32x16_bf16 v[12:27], v[100:103], v[152:155], v[12:27]
v_mfma_f32_32x32x16_bf16 v[28:43], v[104:107], v[152:155], v[28:43]
v_mfma_f32_32x32x16_bf16 v[44:59], v[108:111], v[152:155], v[44:59]
v_mfma_f32_32x32x16_bf16 v[60:75], v[112:115], v[152:155], v[60:75]
s_waitcnt lgkmcnt(8)
v_mfma_f32_32x32x16_bf16 v[12:27], v[116:119], v[156:159], v[12:27]
v_mfma_f32_32x32x16_bf16 v[28:43], v[120:123], v[156:159], v[28:43]
v_mfma_f32_32x32x16_bf16 v[44:59], v[124:127], v[156:159], v[44:59]
v_mfma_f32_32x32x16_bf16 v[60:75], v[128:131], v[156:159], v[60:75]
s_waitcnt lgkmcnt(0)
v_mfma_f32_32x32x16_bf16 v[12:27], v[132:135], v[160:163], v[12:27]
v_mfma_f32_32x32x16_bf16 v[28:43], v[136:139], v[160:163], v[28:43]
v_mfma_f32_32x32x16_bf16 v[44:59], v[140:143], v[160:163], v[44:59]
v_mfma_f32_32x32x16_bf16 v[60:75], v[144:147], v[160:163], v[60:75]
ds_read_b128 v[84:87], v194 offset:0
ds_read_b128 v[88:91], v194 offset:64
ds_read_b128 v[92:95], v194 offset:128
ds_read_b128 v[96:99], v194 offset:192
ds_read_b128 v[100:103], v194 offset:256
ds_read_b128 v[104:107], v194 offset:320
ds_read_b128 v[108:111], v194 offset:384
ds_read_b128 v[112:115], v194 offset:448
ds_read_b128 v[116:119], v194 offset:512
ds_read_b128 v[120:123], v194 offset:576
ds_read_b128 v[124:127], v194 offset:640
ds_read_b128 v[128:131], v194 offset:704
ds_read_b128 v[132:135], v194 offset:768
ds_read_b128 v[136:139], v194 offset:832
ds_read_b128 v[140:143], v194 offset:896
ds_read_b128 v[144:147], v194 offset:960
s_waitcnt lgkmcnt(15)
v_mfma_f32_16x16x32_bf16 v[76:79], v[84:87], a[0:3], 0
v_mfma_f32_16x16x32_bf16 v[80:83], v[84:87], a[64:67], 0
s_waitcnt lgkmcnt(14)
v_mfma_f32_16x16x32_bf16 v[76:79], v[88:91], a[4:7], v[76:79]
v_mfma_f32_16x16x32_bf16 v[80:83], v[88:91], a[68:71], v[80:83]
s_waitcnt lgkmcnt(13)
v_mfma_f32_16x16x32_bf16 v[76:79], v[92:95], a[8:11], v[76:79]
v_mfma_f32_16x16x32_bf16 v[80:83], v[92:95], a[72:75], v[80:83]
s_waitcnt lgkmcnt(12)
v_mfma_f32_16x16x32_bf16 v[76:79], v[96:99], a[12:15], v[76:79]
v_mfma_f32_16x16x32_bf16 v[80:83], v[96:99], a[76:79], v[80:83]
s_waitcnt lgkmcnt(11)
v_mfma_f32_16x16x32_bf16 v[76:79], v[100:103], a[16:19], v[76:79]
v_mfma_f32_16x16x32_bf16 v[80:83], v[100:103], a[80:83], v[80:83]
s_waitcnt lgkmcnt(10)
v_mfma_f32_16x16x32_bf16 v[76:79], v[104:107], a[20:23], v[76:79]
v_mfma_f32_16x16x32_bf16 v[80:83], v[104:107], a[84:87], v[80:83]
s_waitcnt lgkmcnt(9)
v_mfma_f32_16x16x32_bf16 v[76:79], v[108:111], a[24:27], v[76:79]
v_mfma_f32_16x16x32_bf16 v[80:83], v[108:111], a[88:91], v[80:83]
s_waitcnt lgkmcnt(8)
v_mfma_f32_16x16x32_bf16 v[76:79], v[112:115], a[28:31], v[76:79]
v_mfma_f32_16x16x32_bf16 v[80:83], v[112:115], a[92:95], v[80:83]
s_waitcnt lgkmcnt(7)
v_mfma_f32_16x16x32_bf16 v[76:79], v[116:119], a[32:35], v[76:79]
v_mfma_f32_16x16x32_bf16 v[80:83], v[116:119], a[96:99], v[80:83]
s_waitcnt lgkmcnt(6)
v_mfma_f32_16x16x32_bf16 v[76:79], v[120:123], a[36:39], v[76:79]
v_mfma_f32_16x16x32_bf16 v[80:83], v[120:123], a[100:103], v[80:83]
s_waitcnt lgkmcnt(5)
v_mfma_f32_16x16x32_bf16 v[76:79], v[124:127], a[40:43], v[76:79]
v_mfma_f32_16x16x32_bf16 v[80:83], v[124:127], a[104:107], v[80:83]
s_waitcnt lgkmcnt(4)
v_mfma_f32_16x16x32_bf16 v[76:79], v[128:131], a[44:47], v[76:79]
v_mfma_f32_16x16x32_bf16 v[80:83], v[128:131], a[108:111], v[80:83]
s_waitcnt lgkmcnt(3)
v_mfma_f32_16x16x32_bf16 v[76:79], v[132:135], a[48:51], v[76:79]
v_mfma_f32_16x16x32_bf16 v[80:83], v[132:135], a[112:115], v[80:83]
s_waitcnt lgkmcnt(2)
v_mfma_f32_16x16x32_bf16 v[76:79], v[136:139], a[52:55], v[76:79]
v_mfma_f32_16x16x32_bf16 v[80:83], v[136:139], a[116:119], v[80:83]
s_waitcnt lgkmcnt(1)
v_mfma_f32_16x16x32_bf16 v[76:79], v[140:143], a[56:59], v[76:79]
v_mfma_f32_16x16x32_bf16 v[80:83], v[140:143], a[120:123], v[80:83]
s_waitcnt lgkmcnt(0)
v_mfma_f32_16x16x32_bf16 v[76:79], v[144:147], a[60:63], v[76:79]
v_mfma_f32_16x16x32_bf16 v[80:83], v[144:147], a[124:127], v[80:83]
s_nop 6
v_max_f32 v190, v76, v77
v_max3_f32 v190, v190, v78, v79
v_mov_b32 v192, v190
s_nop 1
v_permlane16_swap_b32 v190, v192
v_max_f32 v190, v190, v192
v_mov_b32 v192, v190
s_nop 1
v_permlane32_swap_b32 v190, v192
v_max_f32 v190, v190, v192
ds_write_b32 v198, v190 offset:0
v_max_f32 v191, v80, v81
v_max3_f32 v191, v191, v82, v83
v_mov_b32 v192, v191
s_nop 1
v_permlane16_swap_b32 v191, v192
v_max_f32 v191, v191, v192
v_mov_b32 v192, v191
s_nop 1
v_permlane32_swap_b32 v191, v192
v_max_f32 v191, v191, v192
ds_write_b32 v198, v191 offset:256
s_waitcnt lgkmcnt(0)
s_barrier
ds_read_b128 v[164:167], v199
ds_read_b128 v[168:171], v199 offset:256
ds_read_b128 v[172:175], v200
s_waitcnt vmcnt(0)
ds_write_b128 v207, a[192:195] offset:0
ds_write_b128 v207, a[196:199] offset:1088
ds_write_b128 v207, a[200:203] offset:2176
ds_write_b128 v207, a[204:207] offset:3264
ds_write_b128 v207, a[208:211] offset:4352
ds_write_b128 v207, a[212:215] offset:5440
ds_write_b128 v207, a[216:219] offset:6528
ds_write_b128 v207, a[220:223] offset:7616
ds_write_b128 v207, a[224:227] offset:8704
ds_write_b128 v207, a[228:231] offset:9792
ds_write_b128 v207, a[232:235] offset:10880
ds_write_b128 v207, a[236:239] offset:11968
ds_write_b128 v207, a[240:243] offset:13056
ds_write_b128 v207, a[244:247] offset:14144
ds_write_b128 v207, a[248:251] offset:15232
ds_write_b128 v207, a[252:255] offset:16320
s_waitcnt lgkmcnt(15)
v_max_f32 v164, v164, v165
v_max3_f32 v164, v164, v166, v167
v_mul_f32 v164, v164, v185
v_max_f32 v164, v164, v176
v_sub_f32 v182, v176, v164
v_exp_f32 v182, v182
v_mov_b32 v176, v164
v_max_f32 v168, v168, v169
v_max3_f32 v168, v168, v170, v171
v_mul_f32 v168, v168, v185
v_max_f32 v168, v168, v177
v_sub_f32 v183, v177, v168
v_exp_f32 v183, v183
v_mov_b32 v177, v168
v_max_f32 v172, v172, v173
v_max3_f32 v172, v172, v174, v175
v_mul_f32 v172, v172, v185
v_max_f32 v172, v172, v178
v_sub_f32 v184, v178, v172
v_exp_f32 v184, v184
v_mov_b32 v178, v172
v_fma_f32 v76, v76, v185, -v176
v_fma_f32 v77, v77, v185, -v176
v_fma_f32 v78, v78, v185, -v176
v_fma_f32 v79, v79, v185, -v176
v_exp_f32 v76, v76
v_exp_f32 v77, v77
v_exp_f32 v78, v78
v_exp_f32 v79, v79
v_mul_f32 v180, v180, v182
v_cvt_pk_bf16_f32 v186, v76, v77
v_cvt_pk_bf16_f32 v187, v78, v79
ds_write_b64 v201, v[186:187] offset:0
v_add_f32 v180, v180, v76
v_add_f32 v180, v180, v77
v_add_f32 v180, v180, v78
v_add_f32 v180, v180, v79
v_fma_f32 v80, v80, v185, -v177
v_fma_f32 v81, v81, v185, -v177
v_fma_f32 v82, v82, v185, -v177
v_fma_f32 v83, v83, v185, -v177
v_exp_f32 v80, v80
v_exp_f32 v81, v81
v_exp_f32 v82, v82
v_exp_f32 v83, v83
v_mul_f32 v181, v181, v183
v_cvt_pk_bf16_f32 v188, v80, v81
v_cvt_pk_bf16_f32 v189, v82, v83
ds_write_b64 v201, v[188:189] offset:512
v_add_f32 v181, v181, v80
v_add_f32 v181, v181, v81
v_add_f32 v181, v181, v82
v_add_f32 v181, v181, v83
v_mul_f32 v12, v12, v184
v_mul_f32 v13, v13, v184
v_mul_f32 v14, v14, v184
v_mul_f32 v15, v15, v184
v_mul_f32 v16, v16, v184
v_mul_f32 v17, v17, v184
v_mul_f32 v18, v18, v184
v_mul_f32 v19, v19, v184
v_mul_f32 v20, v20, v184
v_mul_f32 v21, v21, v184
v_mul_f32 v22, v22, v184
v_mul_f32 v23, v23, v184
v_mul_f32 v24, v24, v184
v_mul_f32 v25, v25, v184
v_mul_f32 v26, v26, v184
v_mul_f32 v27, v27, v184
v_mul_f32 v28, v28, v184
v_mul_f32 v29, v29, v184
v_mul_f32 v30, v30, v184
v_mul_f32 v31, v31, v184
v_mul_f32 v32, v32, v184
v_mul_f32 v33, v33, v184
v_mul_f32 v34, v34, v184
v_mul_f32 v35, v35, v184
v_mul_f32 v36, v36, v184
v_mul_f32 v37, v37, v184
v_mul_f32 v38, v38, v184
v_mul_f32 v39, v39, v184
v_mul_f32 v40, v40, v184
v_mul_f32 v41, v41, v184
v_mul_f32 v42, v42, v184
v_mul_f32 v43, v43, v184
v_mul_f32 v44, v44, v184
v_mul_f32 v45, v45, v184
v_mul_f32 v46, v46, v184
v_mul_f32 v47, v47, v184
v_mul_f32 v48, v48, v184
v_mul_f32 v49, v49, v184
v_mul_f32 v50, v50, v184
v_mul_f32 v51, v51, v184
v_mul_f32 v52, v52, v184
v_mul_f32 v53, v53, v184
v_mul_f32 v54, v54, v184
v_mul_f32 v55, v55, v184
v_mul_f32 v56, v56, v184
v_mul_f32 v57, v57, v184
v_mul_f32 v58, v58, v184
v_mul_f32 v59, v59, v184
v_mul_f32 v60, v60, v184
v_mul_f32 v61, v61, v184
v_mul_f32 v62, v62, v184
v_mul_f32 v63, v63, v184
v_mul_f32 v64, v64, v184
v_mul_f32 v65, v65, v184
v_mul_f32 v66, v66, v184
v_mul_f32 v67, v67, v184
v_mul_f32 v68, v68, v184
v_mul_f32 v69, v69, v184
v_mul_f32 v70, v70, v184
v_mul_f32 v71, v71, v184
v_mul_f32 v72, v72, v184
v_mul_f32 v73, v73, v184
v_mul_f32 v74, v74, v184
v_mul_f32 v75, v75, v184
s_waitcnt lgkmcnt(0)
s_barrier
ds_read_b128 v[148:151], v202 offset:0
ds_read_b128 v[152:155], v202 offset:1024
ds_read_b128 v[156:159], v202 offset:2048
ds_read_b128 v[160:163], v202 offset:3072
ds_read_b64_tr_b16 v[84:85], v196 offset:0
ds_read_b64_tr_b16 v[86:87], v196 offset:4352
ds_read_b64_tr_b16 v[88:89], v196 offset:64
ds_read_b64_tr_b16 v[90:91], v196 offset:4416
ds_read_b64_tr_b16 v[92:93], v196 offset:128
ds_read_b64_tr_b16 v[94:95], v196 offset:4480
ds_read_b64_tr_b16 v[96:97], v196 offset:192
ds_read_b64_tr_b16 v[98:99], v196 offset:4544
ds_read_b64_tr_b16 v[100:101], v196 offset:17408
ds_read_b64_tr_b16 v[102:103], v196 offset:21760
ds_read_b64_tr_b16 v[104:105], v196 offset:17472
ds_read_b64_tr_b16 v[106:107], v196 offset:21824
ds_read_b64_tr_b16 v[108:109], v196 offset:17536
ds_read_b64_tr_b16 v[110:111], v196 offset:21888
ds_read_b64_tr_b16 v[112:113], v196 offset:17600
ds_read_b64_tr_b16 v[114:115], v196 offset:21952
ds_read_b64_tr_b16 v[116:117], v196 offset:34816
ds_read_b64_tr_b16 v[118:119], v196 offset:39168
ds_read_b64_tr_b16 v[120:121], v196 offset:34880
ds_read_b64_tr_b16 v[122:123], v196 offset:39232
ds_read_b64_tr_b16 v[124:125], v196 offset:34944
ds_read_b64_tr_b16 v[126:127], v196 offset:39296
ds_read_b64_tr_b16 v[128:129], v196 offset:35008
ds_read_b64_tr_b16 v[130:131], v196 offset:39360
ds_read_b64_tr_b16 v[132:133], v196 offset:52224
ds_read_b64_tr_b16 v[134:135], v196 offset:56576
ds_read_b64_tr_b16 v[136:137], v196 offset:52288
ds_read_b64_tr_b16 v[138:139], v196 offset:56640
ds_read_b64_tr_b16 v[140:141], v196 offset:52352
ds_read_b64_tr_b16 v[142:143], v196 offset:56704
ds_read_b64_tr_b16 v[144:145], v196 offset:52416
ds_read_b64_tr_b16 v[146:147], v196 offset:56768
s_waitcnt lgkmcnt(15)
v_mfma_f32_32x32x16_bf16 v[12:27], v[84:87], v[148:151], v[12:27]
v_mfma_f32_32x32x16_bf16 v[28:43], v[88:91], v[148:151], v[28:43]
v_mfma_f32_32x32x16_bf16 v[44:59], v[92:95], v[148:151], v[44:59]
v_mfma_f32_32x32x16_bf16 v[60:75], v[96:99], v[148:151], v[60:75]
s_waitcnt lgkmcnt(15)
v_mfma_f32_32x32x16_bf16 v[12:27], v[100:103], v[152:155], v[12:27]
v_mfma_f32_32x32x16_bf16 v[28:43], v[104:107], v[152:155], v[28:43]
v_mfma_f32_32x32x16_bf16 v[44:59], v[108:111], v[152:155], v[44:59]
v_mfma_f32_32x32x16_bf16 v[60:75], v[112:115], v[152:155], v[60:75]
s_waitcnt lgkmcnt(8)
v_mfma_f32_32x32x16_bf16 v[12:27], v[116:119], v[156:159], v[12:27]
v_mfma_f32_32x32x16_bf16 v[28:43], v[120:123], v[156:159], v[28:43]
v_mfma_f32_32x32x16_bf16 v[44:59], v[124:127], v[156:159], v[44:59]
v_mfma_f32_32x32x16_bf16 v[60:75], v[128:131], v[156:159], v[60:75]
s_waitcnt lgkmcnt(0)
v_mfma_f32_32x32x16_bf16 v[12:27], v[132:135], v[160:163], v[12:27]
v_mfma_f32_32x32x16_bf16 v[28:43], v[136:139], v[160:163], v[28:43]
v_mfma_f32_32x32x16_bf16 v[44:59], v[140:143], v[160:163], v[44:59]
v_mfma_f32_32x32x16_bf16 v[60:75], v[144:147], v[160:163], v[60:75]
ds_read_b128 v[84:87], v195 offset:0
ds_read_b128 v[88:91], v195 offset:64
ds_read_b128 v[92:95], v195 offset:128
ds_read_b128 v[96:99], v195 offset:192
ds_read_b128 v[100:103], v195 offset:256
ds_read_b128 v[104:107], v195 offset:320
ds_read_b128 v[108:111], v195 offset:384
ds_read_b128 v[112:115], v195 offset:448
ds_read_b128 v[116:119], v195 offset:512
ds_read_b128 v[120:123], v195 offset:576
ds_read_b128 v[124:127], v195 offset:640
ds_read_b128 v[128:131], v195 offset:704
ds_read_b128 v[132:135], v195 offset:768
ds_read_b128 v[136:139], v195 offset:832
ds_read_b128 v[140:143], v195 offset:896
ds_read_b128 v[144:147], v195 offset:960
s_waitcnt lgkmcnt(15)
v_mfma_f32_16x16x32_bf16 v[76:79], v[84:87], a[0:3], 0
v_mfma_f32_16x16x32_bf16 v[80:83], v[84:87], a[64:67], 0
s_waitcnt lgkmcnt(14)
v_mfma_f32_16x16x32_bf16 v[76:79], v[88:91], a[4:7], v[76:79]
v_mfma_f32_16x16x32_bf16 v[80:83], v[88:91], a[68:71], v[80:83]
s_waitcnt lgkmcnt(13)
v_mfma_f32_16x16x32_bf16 v[76:79], v[92:95], a[8:11], v[76:79]
v_mfma_f32_16x16x32_bf16 v[80:83], v[92:95], a[72:75], v[80:83]
s_waitcnt lgkmcnt(12)
v_mfma_f32_16x16x32_bf16 v[76:79], v[96:99], a[12:15], v[76:79]
v_mfma_f32_16x16x32_bf16 v[80:83], v[96:99], a[76:79], v[80:83]
s_waitcnt lgkmcnt(11)
v_mfma_f32_16x16x32_bf16 v[76:79], v[100:103], a[16:19], v[76:79]
v_mfma_f32_16x16x32_bf16 v[80:83], v[100:103], a[80:83], v[80:83]
s_waitcnt lgkmcnt(10)
v_mfma_f32_16x16x32_bf16 v[76:79], v[104:107], a[20:23], v[76:79]
v_mfma_f32_16x16x32_bf16 v[80:83], v[104:107], a[84:87], v[80:83]
s_waitcnt lgkmcnt(9)
v_mfma_f32_16x16x32_bf16 v[76:79], v[108:111], a[24:27], v[76:79]
v_mfma_f32_16x16x32_bf16 v[80:83], v[108:111], a[88:91], v[80:83]
s_waitcnt lgkmcnt(8)
v_mfma_f32_16x16x32_bf16 v[76:79], v[112:115], a[28:31], v[76:79]
v_mfma_f32_16x16x32_bf16 v[80:83], v[112:115], a[92:95], v[80:83]
s_waitcnt lgkmcnt(7)
v_mfma_f32_16x16x32_bf16 v[76:79], v[116:119], a[32:35], v[76:79]
v_mfma_f32_16x16x32_bf16 v[80:83], v[116:119], a[96:99], v[80:83]
s_waitcnt lgkmcnt(6)
v_mfma_f32_16x16x32_bf16 v[76:79], v[120:123], a[36:39], v[76:79]
v_mfma_f32_16x16x32_bf16 v[80:83], v[120:123], a[100:103], v[80:83]
s_waitcnt lgkmcnt(5)
v_mfma_f32_16x16x32_bf16 v[76:79], v[124:127], a[40:43], v[76:79]
v_mfma_f32_16x16x32_bf16 v[80:83], v[124:127], a[104:107], v[80:83]
s_waitcnt lgkmcnt(4)
v_mfma_f32_16x16x32_bf16 v[76:79], v[128:131], a[44:47], v[76:79]
v_mfma_f32_16x16x32_bf16 v[80:83], v[128:131], a[108:111], v[80:83]
s_waitcnt lgkmcnt(3)
v_mfma_f32_16x16x32_bf16 v[76:79], v[132:135], a[48:51], v[76:79]
v_mfma_f32_16x16x32_bf16 v[80:83], v[132:135], a[112:115], v[80:83]
s_waitcnt lgkmcnt(2)
v_mfma_f32_16x16x32_bf16 v[76:79], v[136:139], a[52:55], v[76:79]
v_mfma_f32_16x16x32_bf16 v[80:83], v[136:139], a[116:119], v[80:83]
s_waitcnt lgkmcnt(1)
v_mfma_f32_16x16x32_bf16 v[76:79], v[140:143], a[56:59], v[76:79]
v_mfma_f32_16x16x32_bf16 v[80:83], v[140:143], a[120:123], v[80:83]
s_waitcnt lgkmcnt(0)
v_mfma_f32_16x16x32_bf16 v[76:79], v[144:147], a[60:63], v[76:79]
v_mfma_f32_16x16x32_bf16 v[80:83], v[144:147], a[124:127], v[80:83]
s_nop 6
v_max_f32 v190, v76, v77
v_max3_f32 v190, v190, v78, v79
v_mov_b32 v192, v190
s_nop 1
v_permlane16_swap_b32 v190, v192
v_max_f32 v190, v190, v192
v_mov_b32 v192, v190
s_nop 1
v_permlane32_swap_b32 v190, v192
v_max_f32 v190, v190, v192
ds_write_b32 v198, v190 offset:0
v_max_f32 v191, v80, v81
v_max3_f32 v191, v191, v82, v83
v_mov_b32 v192, v191
s_nop 1
v_permlane16_swap_b32 v191, v192
v_max_f32 v191, v191, v192
v_mov_b32 v192, v191
s_nop 1
v_permlane32_swap_b32 v191, v192
v_max_f32 v191, v191, v192
ds_write_b32 v198, v191 offset:256
s_waitcnt lgkmcnt(0)
s_barrier
ds_read_b128 v[164:167], v199
ds_read_b128 v[168:171], v199 offset:256
ds_read_b128 v[172:175], v200
s_waitcnt lgkmcnt(0)
v_max_f32 v164, v164, v165
v_max3_f32 v164, v164, v166, v167
v_mul_f32 v164, v164, v185
v_max_f32 v164, v164, v176
v_sub_f32 v182, v176, v164
v_exp_f32 v182, v182
v_mov_b32 v176, v164
v_max_f32 v168, v168, v169
v_max3_f32 v168, v168, v170, v171
v_mul_f32 v168, v168, v185
v_max_f32 v168, v168, v177
v_sub_f32 v183, v177, v168
v_exp_f32 v183, v183
v_mov_b32 v177, v168
v_max_f32 v172, v172, v173
v_max3_f32 v172, v172, v174, v175
v_mul_f32 v172, v172, v185
v_max_f32 v172, v172, v178
v_sub_f32 v184, v178, v172
v_exp_f32 v184, v184
v_mov_b32 v178, v172
v_fma_f32 v76, v76, v185, -v176
v_fma_f32 v77, v77, v185, -v176
v_fma_f32 v78, v78, v185, -v176
v_fma_f32 v79, v79, v185, -v176
v_exp_f32 v76, v76
v_exp_f32 v77, v77
v_exp_f32 v78, v78
v_exp_f32 v79, v79
v_mul_f32 v180, v180, v182
v_cvt_pk_bf16_f32 v186, v76, v77
v_cvt_pk_bf16_f32 v187, v78, v79
ds_write_b64 v201, v[186:187] offset:0
v_add_f32 v180, v180, v76
v_add_f32 v180, v180, v77
v_add_f32 v180, v180, v78
v_add_f32 v180, v180, v79
v_fma_f32 v80, v80, v185, -v177
v_fma_f32 v81, v81, v185, -v177
v_fma_f32 v82, v82, v185, -v177
v_fma_f32 v83, v83, v185, -v177
v_exp_f32 v80, v80
v_exp_f32 v81, v81
v_exp_f32 v82, v82
v_exp_f32 v83, v83
v_mul_f32 v181, v181, v183
v_cvt_pk_bf16_f32 v188, v80, v81
v_cvt_pk_bf16_f32 v189, v82, v83
ds_write_b64 v201, v[188:189] offset:512
v_add_f32 v181, v181, v80
v_add_f32 v181, v181, v81
v_add_f32 v181, v181, v82
v_add_f32 v181, v181, v83
v_mul_f32 v12, v12, v184
v_mul_f32 v13, v13, v184
v_mul_f32 v14, v14, v184
v_mul_f32 v15, v15, v184
v_mul_f32 v16, v16, v184
v_mul_f32 v17, v17, v184
v_mul_f32 v18, v18, v184
v_mul_f32 v19, v19, v184
v_mul_f32 v20, v20, v184
v_mul_f32 v21, v21, v184
v_mul_f32 v22, v22, v184
v_mul_f32 v23, v23, v184
v_mul_f32 v24, v24, v184
v_mul_f32 v25, v25, v184
v_mul_f32 v26, v26, v184
v_mul_f32 v27, v27, v184
v_mul_f32 v28, v28, v184
v_mul_f32 v29, v29, v184
v_mul_f32 v30, v30, v184
v_mul_f32 v31, v31, v184
v_mul_f32 v32, v32, v184
v_mul_f32 v33, v33, v184
v_mul_f32 v34, v34, v184
v_mul_f32 v35, v35, v184
v_mul_f32 v36, v36, v184
v_mul_f32 v37, v37, v184
v_mul_f32 v38, v38, v184
v_mul_f32 v39, v39, v184
v_mul_f32 v40, v40, v184
v_mul_f32 v41, v41, v184
v_mul_f32 v42, v42, v184
v_mul_f32 v43, v43, v184
v_mul_f32 v44, v44, v184
v_mul_f32 v45, v45, v184
v_mul_f32 v46, v46, v184
v_mul_f32 v47, v47, v184
v_mul_f32 v48, v48, v184
v_mul_f32 v49, v49, v184
v_mul_f32 v50, v50, v184
v_mul_f32 v51, v51, v184
v_mul_f32 v52, v52, v184
v_mul_f32 v53, v53, v184
v_mul_f32 v54, v54, v184
v_mul_f32 v55, v55, v184
v_mul_f32 v56, v56, v184
v_mul_f32 v57, v57, v184
v_mul_f32 v58, v58, v184
v_mul_f32 v59, v59, v184
v_mul_f32 v60, v60, v184
v_mul_f32 v61, v61, v184
v_mul_f32 v62, v62, v184
v_mul_f32 v63, v63, v184
v_mul_f32 v64, v64, v184
v_mul_f32 v65, v65, v184
v_mul_f32 v66, v66, v184
v_mul_f32 v67, v67, v184
v_mul_f32 v68, v68, v184
v_mul_f32 v69, v69, v184
v_mul_f32 v70, v70, v184
v_mul_f32 v71, v71, v184
v_mul_f32 v72, v72, v184
v_mul_f32 v73, v73, v184
v_mul_f32 v74, v74, v184
v_mul_f32 v75, v75, v184
s_waitcnt lgkmcnt(0)
s_barrier
ds_read_b128 v[148:151], v202 offset:0
ds_read_b128 v[152:155], v202 offset:1024
ds_read_b128 v[156:159], v202 offset:2048
ds_read_b128 v[160:163], v202 offset:3072
ds_read_b64_tr_b16 v[84:85], v197 offset:0
ds_read_b64_tr_b16 v[86:87], v197 offset:4352
ds_read_b64_tr_b16 v[88:89], v197 offset:64
ds_read_b64_tr_b16 v[90:91], v197 offset:4416
ds_read_b64_tr_b16 v[92:93], v197 offset:128
ds_read_b64_tr_b16 v[94:95], v197 offset:4480
ds_read_b64_tr_b16 v[96:97], v197 offset:192
ds_read_b64_tr_b16 v[98:99], v197 offset:4544
ds_read_b64_tr_b16 v[100:101], v197 offset:17408
ds_read_b64_tr_b16 v[102:103], v197 offset:21760
ds_read_b64_tr_b16 v[104:105], v197 offset:17472
ds_read_b64_tr_b16 v[106:107], v197 offset:21824
ds_read_b64_tr_b16 v[108:109], v197 offset:17536
ds_read_b64_tr_b16 v[110:111], v197 offset:21888
ds_read_b64_tr_b16 v[112:113], v197 offset:17600
ds_read_b64_tr_b16 v[114:115], v197 offset:21952
ds_read_b64_tr_b16 v[116:117], v197 offset:34816
ds_read_b64_tr_b16 v[118:119], v197 offset:39168
ds_read_b64_tr_b16 v[120:121], v197 offset:34880
ds_read_b64_tr_b16 v[122:123], v197 offset:39232
ds_read_b64_tr_b16 v[124:125], v197 offset:34944
ds_read_b64_tr_b16 v[126:127], v197 offset:39296
ds_read_b64_tr_b16 v[128:129], v197 offset:35008
ds_read_b64_tr_b16 v[130:131], v197 offset:39360
ds_read_b64_tr_b16 v[132:133], v197 offset:52224
ds_read_b64_tr_b16 v[134:135], v197 offset:56576
ds_read_b64_tr_b16 v[136:137], v197 offset:52288
ds_read_b64_tr_b16 v[138:139], v197 offset:56640
ds_read_b64_tr_b16 v[140:141], v197 offset:52352
ds_read_b64_tr_b16 v[142:143], v197 offset:56704
ds_read_b64_tr_b16 v[144:145], v197 offset:52416
ds_read_b64_tr_b16 v[146:147], v197 offset:56768
s_waitcnt lgkmcnt(15)
v_mfma_f32_32x32x16_bf16 v[12:27], v[84:87], v[148:151], v[12:27]
v_mfma_f32_32x32x16_bf16 v[28:43], v[88:91], v[148:151], v[28:43]
v_mfma_f32_32x32x16_bf16 v[44:59], v[92:95], v[148:151], v[44:59]
v_mfma_f32_32x32x16_bf16 v[60:75], v[96:99], v[148:151], v[60:75]
s_waitcnt lgkmcnt(15)
v_mfma_f32_32x32x16_bf16 v[12:27], v[100:103], v[152:155], v[12:27]
v_mfma_f32_32x32x16_bf16 v[28:43], v[104:107], v[152:155], v[28:43]
v_mfma_f32_32x32x16_bf16 v[44:59], v[108:111], v[152:155], v[44:59]
v_mfma_f32_32x32x16_bf16 v[60:75], v[112:115], v[152:155], v[60:75]
s_waitcnt lgkmcnt(8)
v_mfma_f32_32x32x16_bf16 v[12:27], v[116:119], v[156:159], v[12:27]
v_mfma_f32_32x32x16_bf16 v[28:43], v[120:123], v[156:159], v[28:43]
v_mfma_f32_32x32x16_bf16 v[44:59], v[124:127], v[156:159], v[44:59]
v_mfma_f32_32x32x16_bf16 v[60:75], v[128:131], v[156:159], v[60:75]
s_waitcnt lgkmcnt(0)
v_mfma_f32_32x32x16_bf16 v[12:27], v[132:135], v[160:163], v[12:27]
v_mfma_f32_32x32x16_bf16 v[28:43], v[136:139], v[160:163], v[28:43]
v_mfma_f32_32x32x16_bf16 v[44:59], v[140:143], v[160:163], v[44:59]
v_mfma_f32_32x32x16_bf16 v[60:75], v[144:147], v[160:163], v[60:75]
v_mov_b32 v192, v180
s_nop 1
v_permlane16_swap_b32 v180, v192
v_add_f32 v180, v180, v192
v_mov_b32 v192, v180
s_nop 1
v_permlane32_swap_b32 v180, v192
v_add_f32 v180, v180, v192
ds_write_b32 v198, v180 offset:512
v_mov_b32 v192, v181
s_nop 1
v_permlane16_swap_b32 v181, v192
v_add_f32 v181, v181, v192
v_mov_b32 v192, v181
s_nop 1
v_permlane32_swap_b32 v181, v192
v_add_f32 v181, v181, v192
ds_write_b32 v198, v181 offset:768
v_and_b32 v5, 31, v1
v_mul_u32_u24 v5, 1040, v5
v_lshrrev_b32 v6, 5, v1
v_lshl_add_u32 v5, v6, 3, v5
s_lshl_b32 s6, s3, 8
v_add_u32 v5, s6, v5
v_cvt_pk_bf16_f32 v84, v12, v13
v_cvt_pk_bf16_f32 v85, v14, v15
ds_write_b64 v5, v[84:85] offset:0
v_cvt_pk_bf16_f32 v86, v16, v17
v_cvt_pk_bf16_f32 v87, v18, v19
ds_write_b64 v5, v[86:87] offset:16
v_cvt_pk_bf16_f32 v88, v20, v21
v_cvt_pk_bf16_f32 v89, v22, v23
ds_write_b64 v5, v[88:89] offset:32
v_cvt_pk_bf16_f32 v90, v24, v25
v_cvt_pk_bf16_f32 v91, v26, v27
ds_write_b64 v5, v[90:91] offset:48
v_cvt_pk_bf16_f32 v92, v28, v29
v_cvt_pk_bf16_f32 v93, v30, v31
ds_write_b64 v5, v[92:93] offset:64
v_cvt_pk_bf16_f32 v94, v32, v33
v_cvt_pk_bf16_f32 v95, v34, v35
ds_write_b64 v5, v[94:95] offset:80
v_cvt_pk_bf16_f32 v96, v36, v37
v_cvt_pk_bf16_f32 v97, v38, v39
ds_write_b64 v5, v[96:97] offset:96
v_cvt_pk_bf16_f32 v98, v40, v41
v_cvt_pk_bf16_f32 v99, v42, v43
ds_write_b64 v5, v[98:99] offset:112
v_cvt_pk_bf16_f32 v100, v44, v45
v_cvt_pk_bf16_f32 v101, v46, v47
ds_write_b64 v5, v[100:101] offset:128
v_cvt_pk_bf16_f32 v102, v48, v49
v_cvt_pk_bf16_f32 v103, v50, v51
ds_write_b64 v5, v[102:103] offset:144
v_cvt_pk_bf16_f32 v104, v52, v53
v_cvt_pk_bf16_f32 v105, v54, v55
ds_write_b64 v5, v[104:105] offset:160
v_cvt_pk_bf16_f32 v106, v56, v57
v_cvt_pk_bf16_f32 v107, v58, v59
ds_write_b64 v5, v[106:107] offset:176
v_cvt_pk_bf16_f32 v108, v60, v61
v_cvt_pk_bf16_f32 v109, v62, v63
ds_write_b64 v5, v[108:109] offset:192
v_cvt_pk_bf16_f32 v110, v64, v65
v_cvt_pk_bf16_f32 v111, v66, v67
ds_write_b64 v5, v[110:111] offset:208
v_cvt_pk_bf16_f32 v112, v68, v69
v_cvt_pk_bf16_f32 v113, v70, v71
ds_write_b64 v5, v[112:113] offset:224
v_cvt_pk_bf16_f32 v114, v72, v73
v_cvt_pk_bf16_f32 v115, v74, v75
ds_write_b64 v5, v[114:115] offset:240
v_mov_b32 v11, 163824
v_mov_b32 v7, 0
ds_write_b32 v11, v7
s_waitcnt lgkmcnt(0)
s_barrier
s_mul_i32 s6, s3, 8320
v_add_u32 v5, s6, v2
ds_read_b128 v[116:119], v5 offset:0
ds_read_b128 v[120:123], v5 offset:1040
ds_read_b128 v[124:127], v5 offset:2080
ds_read_b128 v[128:131], v5 offset:3120
ds_read_b128 v[132:135], v5 offset:4160
ds_read_b128 v[136:139], v5 offset:5200
ds_read_b128 v[140:143], v5 offset:6240
ds_read_b128 v[144:147], v5 offset:7280
ds_read_b128 v[164:167], v200 offset:512
s_mul_i32 s7, s3, 524288
s_lshl_b32 s6, s80, 10
s_add_u32 s7, s7, s6
s_add_u32 s7, s7, 2097152
s_waitcnt lgkmcnt(8)
s_add_u32 s6, s7, 0
buffer_store_dwordx4 v[116:119], v2, s[64:67], s6 offen sc1
s_waitcnt lgkmcnt(7)
s_add_u32 s6, s7, 98304
buffer_store_dwordx4 v[120:123], v2, s[64:67], s6 offen sc1
s_waitcnt lgkmcnt(6)
s_add_u32 s6, s7, 131072
buffer_store_dwordx4 v[124:127], v2, s[64:67], s6 offen sc1
s_waitcnt lgkmcnt(5)
s_add_u32 s6, s7, 229376
buffer_store_dwordx4 v[128:131], v2, s[64:67], s6 offen sc1
s_waitcnt lgkmcnt(4)
s_add_u32 s6, s7, 262144
buffer_store_dwordx4 v[132:135], v2, s[64:67], s6 offen sc1
s_waitcnt lgkmcnt(3)
s_add_u32 s6, s7, 360448
buffer_store_dwordx4 v[136:139], v2, s[64:67], s6 offen sc1
s_waitcnt lgkmcnt(2)
s_add_u32 s6, s7, 393216
buffer_store_dwordx4 v[140:143], v2, s[64:67], s6 offen sc1
s_waitcnt lgkmcnt(1)
s_add_u32 s6, s7, 491520
buffer_store_dwordx4 v[144:147], v2, s[64:67], s6 offen sc1
s_waitcnt lgkmcnt(0)
v_add_f32 v164, v164, v165
v_add_f32 v166, v166, v167
v_add_f32 v187, v164, v166
v_mov_b32 v186, v178
v_lshlrev_b32 v5, 8, v1
s_mul_i32 s6, s80, 8
s_add_u32 s6, s6, 262144
v_min_u32 v186, -2, v186
v_min_u32 v187, -2, v187
s_waitcnt vmcnt(0)
s_barrier
s_cmp_lg_u32 s3, 0
s_cbranch_scc1 L_nops_41
s_mov_b64 exec, 0xffffffff
buffer_store_dwordx2 v[186:187], v5, s[64:67], s6 offen sc1
s_mov_b64 exec, -1
L_nops_41:
B_final:
s_cmp_eq_u32 s3, 3
s_cbranch_scc1 H_start
s_mov_b32 s14, s9
s_lshr_b32 s7, s3, 1
s_cmp_lg_u32 s3, 1
s_cbranch_scc1 L_w1_42
s_and_b32 s7, s9, 7
s_cmp_ge_u32 s7, 2
s_cbranch_scc1 B_end
s_lshr_b32 s14, s9, 3
s_add_u32 s14, s14, 64
L_w1_42:
s_mul_i32 s15, s14, 57
s_lshr_b32 s15, s15, 10
s_mul_i32 s6, s15, 18
s_sub_u32 s80, s14, s6
s_mul_i32 s81, s15, 73728
s_lshr_b32 s81, s81, s7
s_lshl_b32 s6, s80, 6
s_add_u32 s81, s81, s6
s_mul_i32 s6, s7, 1048576
s_add_u32 s81, s81, s6
s_add_u32 s81, s81, 4194304
v_lshrrev_b32 v5, 2, v1
v_and_b32 v6, 3, v1
v_mul_u32_u24 v44, 1152, v5
v_lshl_add_u32 v44, v6, 4, v44
v_bfe_u32 v5, v1, 2, 2
v_lshl_add_u32 v5, v5, 2, v6
v_lshrrev_b32 v46, 4, v1
v_lshl_add_u32 v45, v46, 6, v5
v_lshrrev_b32 v5, 1, v6
v_mul_u32_u24 v5, 142, v5
v_add_u32 v5, v5, v6
v_lshrrev_b32 v46, 2, v1
v_lshl_add_u32 v5, v46, 1, v5
s_lshr_b32 s6, s80, 2
s_mul_i32 s6, s6, 80
s_lshl_b32 s83, s80, 4
s_add_u32 s83, s83, s6
s_mul_i32 s6, s80, 288
s_sub_u32 s6, s6, 4480
s_cmp_ge_u32 s80, 16
s_cselect_b32 s83, s6, s83
s_cselect_b64 vcc, -1, 0
v_cndmask_b32 v45, v45, v5, vcc
v_lshlrev_b32 v45, 1, v45
s_lshl_b32 s83, s83, 1
s_mul_i32 s6, s15, 2304
s_add_u32 s83, s83, s6
s_mul_i32 s6, s7, 1152
s_add_u32 s83, s83, s6
v_and_b32 v6, 1, v1
v_lshlrev_b32 v6, 4, v6
v_mov_b32 v46, 0x3f80
v_lshlrev_b32 v46, v6, v46
v_bfe_u32 v6, v1, 1, 3
v_cmp_eq_u32 vcc, 0, v6
s_nop 1
v_cndmask_b32 v20, 0, v46, vcc
v_cmp_eq_u32 vcc, 1, v6
s_nop 1
v_cndmask_b32 v21, 0, v46, vcc
v_cmp_eq_u32 vcc, 2, v6
s_nop 1
v_cndmask_b32 v22, 0, v46, vcc
v_cmp_eq_u32 vcc, 3, v6
s_nop 1
v_cndmask_b32 v23, 0, v46, vcc
s_sub_u32 s6, s7, 1
s_mov_b32 s16, -1
s_mov_b32 s17, -1
s_mov_b32 s18, -1
s_mov_b32 s19, -1
s_mov_b32 s20, s6
s_mov_b32 s21, s6
s_mov_b32 s22, s6
s_mov_b32 s23, s6
v_mov_b32 v48, -1
v_mov_b32 v49, -1
v_mov_b32 v50, -1
v_mov_b32 v51, -1
v_mov_b32 v52, -1
v_mov_b32 v53, -1
v_mov_b32 v54, -1
v_mov_b32 v55, -1
v_mov_b32 v56, s6
v_mov_b32 v57, s6
v_mov_b32 v58, s6
v_mov_b32 v59, s6
v_mov_b32 v60, s6
v_mov_b32 v61, s6
v_mov_b32 v62, s6
v_mov_b32 v63, s6
v_mov_b32 v64, -1
v_mov_b32 v65, -1
v_mov_b32 v66, -1
v_mov_b32 v67, -1
v_mov_b32 v68, -1
v_mov_b32 v69, -1
v_mov_b32 v70, -1
v_mov_b32 v71, -1
v_mov_b32 v72, -1
v_mov_b32 v73, -1
v_mov_b32 v74, -1
v_mov_b32 v75, -1
v_mov_b32 v76, -1
v_mov_b32 v77, -1
v_mov_b32 v78, -1
v_mov_b32 v79, -1
v_mov_b32 v80, -1
v_mov_b32 v81, -1
v_mov_b32 v82, -1
v_mov_b32 v83, -1
v_mov_b32 v84, -1
v_mov_b32 v85, -1
v_mov_b32 v86, -1
v_mov_b32 v87, -1
v_mov_b32 v88, -1
v_mov_b32 v89, -1
v_mov_b32 v90, -1
v_mov_b32 v91, -1
v_mov_b32 v92, -1
v_mov_b32 v93, -1
v_mov_b32 v94, -1
v_mov_b32 v95, -1
s_add_u32 s24, s81, 0
s_add_u32 s25, s81, 18432
s_add_u32 s26, s81, 36864
s_add_u32 s27, s81, 55296
s_mov_b32 s7, 400000
v_lshrrev_b32 v5, 3, v1
v_mul_u32_u24 v5, 4608, v5
R_slow:
buffer_load_dword v46, v5, s[64:67], s81 offen sc1
s_waitcnt vmcnt(0)
v_cmp_ne_u32 vcc, -1, v46
s_cbranch_vccnz R_pass
s_sleep 8
s_sub_u32 s7, s7, 1
s_cmp_lg_u32 s7, 1
s_cbranch_scc1 R_slow
R_pass:
s_mov_b64 exec, s[16:17]
s_cbranch_execz L_ld_43
buffer_load_dwordx4 v[64:67], v44, s[64:67], s24 offen sc1
L_ld_43:
s_mov_b64 exec, s[18:19]
s_cbranch_execz L_ld_44
buffer_load_dwordx4 v[68:71], v44, s[64:67], s25 offen sc1
L_ld_44:
s_mov_b64 exec, s[20:21]
s_cbranch_execz L_ld_45
buffer_load_dwordx4 v[72:75], v44, s[64:67], s26 offen sc1
L_ld_45:
s_mov_b64 exec, s[22:23]
s_cbranch_execz L_ld_46
buffer_load_dwordx4 v[76:79], v44, s[64:67], s27 offen sc1
L_ld_46:
s_mov_b64 exec, -1
s_waitcnt vmcnt(0)
s_cmp_eq_u64 s[16:17], 0
s_cbranch_scc1 L_ck_47
v_min_u32 v48, v48, v64
v_min_u32 v49, v49, v65
v_min_u32 v50, v50, v66
v_min_u32 v51, v51, v67
v_max3_u32 v46, v48, v49, v50
v_max_u32 v46, v46, v51
v_cmp_eq_u32 s[16:17], -1, v46
L_ck_47:
s_cmp_eq_u64 s[18:19], 0
s_cbranch_scc1 L_ck_48
v_min_u32 v52, v52, v68
v_min_u32 v53, v53, v69
v_min_u32 v54, v54, v70
v_min_u32 v55, v55, v71
v_max3_u32 v46, v52, v53, v54
v_max_u32 v46, v46, v55
v_cmp_eq_u32 s[18:19], -1, v46
L_ck_48:
s_cmp_eq_u64 s[20:21], 0
s_cbranch_scc1 L_ck_49
v_min_u32 v56, v56, v72
v_min_u32 v57, v57, v73
v_min_u32 v58, v58, v74
v_min_u32 v59, v59, v75
v_max3_u32 v46, v56, v57, v58
v_max_u32 v46, v46, v59
v_cmp_eq_u32 s[20:21], -1, v46
L_ck_49:
s_cmp_eq_u64 s[22:23], 0
s_cbranch_scc1 L_ck_50
v_min_u32 v60, v60, v76
v_min_u32 v61, v61, v77
v_min_u32 v62, v62, v78
v_min_u32 v63, v63, v79
v_max3_u32 v46, v60, v61, v62
v_max_u32 v46, v46, v63
v_cmp_eq_u32 s[22:23], -1, v46
L_ck_50:
s_or_b64 s[28:29], s[16:17], s[18:19]
s_or_b64 s[30:31], s[20:21], s[22:23]
s_or_b64 s[28:29], s[28:29], s[30:31]
s_cbranch_scc0 R_done
s_bcnt1_i32_b64 s6, s[16:17]
s_bcnt1_i32_b64 s28, s[18:19]
s_add_u32 s6, s6, s28
s_bcnt1_i32_b64 s28, s[20:21]
s_add_u32 s6, s6, s28
s_bcnt1_i32_b64 s28, s[22:23]
s_add_u32 s6, s6, s28
s_cmp_le_u32 s6, 48
s_cbranch_scc1 R_fast
s_sub_u32 s7, s7, 1
s_cmp_gt_u32 s7, 1
s_cbranch_scc1 R_pass
R_fast:
s_or_b64 exec, s[16:17], 1
buffer_load_dwordx4 v[64:67], v44, s[64:67], s24 offen sc1
s_or_b64 exec, s[18:19], 1
buffer_load_dwordx4 v[68:71], v44, s[64:67], s25 offen sc1
s_or_b64 exec, s[20:21], 1
buffer_load_dwordx4 v[72:75], v44, s[64:67], s26 offen sc1
s_or_b64 exec, s[22:23], 1
buffer_load_dwordx4 v[76:79], v44, s[64:67], s27 offen sc1
s_mov_b64 exec, -1
s_sleep 9
s_or_b64 exec, s[16:17], 1
buffer_load_dwordx4 v[80:83], v44, s[64:67], s24 offen sc1
s_or_b64 exec, s[18:19], 1
buffer_load_dwordx4 v[84:87], v44, s[64:67], s25 offen sc1
s_or_b64 exec, s[20:21], 1
buffer_load_dwordx4 v[88:91], v44, s[64:67], s26 offen sc1
s_or_b64 exec, s[22:23], 1
buffer_load_dwordx4 v[92:95], v44, s[64:67], s27 offen sc1
s_mov_b64 exec, -1
R_loop:
s_waitcnt vmcnt(4)
s_cmp_eq_u64 s[16:17], 0
s_cbranch_scc1 L_ck_51
v_min_u32 v48, v48, v64
v_min_u32 v49, v49, v65
v_min_u32 v50, v50, v66
v_min_u32 v51, v51, v67
v_max3_u32 v46, v48, v49, v50
v_max_u32 v46, v46, v51
v_cmp_eq_u32 s[16:17], -1, v46
L_ck_51:
s_cmp_eq_u64 s[18:19], 0
s_cbranch_scc1 L_ck_52
v_min_u32 v52, v52, v68
v_min_u32 v53, v53, v69
v_min_u32 v54, v54, v70
v_min_u32 v55, v55, v71
v_max3_u32 v46, v52, v53, v54
v_max_u32 v46, v46, v55
v_cmp_eq_u32 s[18:19], -1, v46
L_ck_52:
s_cmp_eq_u64 s[20:21], 0
s_cbranch_scc1 L_ck_53
v_min_u32 v56, v56, v72
v_min_u32 v57, v57, v73
v_min_u32 v58, v58, v74
v_min_u32 v59, v59, v75
v_max3_u32 v46, v56, v57, v58
v_max_u32 v46, v46, v59
v_cmp_eq_u32 s[20:21], -1, v46
L_ck_53:
s_cmp_eq_u64 s[22:23], 0
s_cbranch_scc1 L_ck_54
v_min_u32 v60, v60, v76
v_min_u32 v61, v61, v77
v_min_u32 v62, v62, v78
v_min_u32 v63, v63, v79
v_max3_u32 v46, v60, v61, v62
v_max_u32 v46, v46, v63
v_cmp_eq_u32 s[22:23], -1, v46
L_ck_54:
s_or_b64 s[28:29], s[16:17], s[18:19]
s_or_b64 s[30:31], s[20:21], s[22:23]
s_or_b64 s[28:29], s[28:29], s[30:31]
s_cbranch_scc0 R_done
s_or_b64 exec, s[16:17], 1
buffer_load_dwordx4 v[64:67], v44, s[64:67], s24 offen sc1
s_or_b64 exec, s[18:19], 1
buffer_load_dwordx4 v[68:71], v44, s[64:67], s25 offen sc1
s_or_b64 exec, s[20:21], 1
buffer_load_dwordx4 v[72:75], v44, s[64:67], s26 offen sc1
s_or_b64 exec, s[22:23], 1
buffer_load_dwordx4 v[76:79], v44, s[64:67], s27 offen sc1
s_mov_b64 exec, -1
s_waitcnt vmcnt(4)
s_cmp_eq_u64 s[16:17], 0
s_cbranch_scc1 L_ck_55
v_min_u32 v48, v48, v80
v_min_u32 v49, v49, v81
v_min_u32 v50, v50, v82
v_min_u32 v51, v51, v83
v_max3_u32 v46, v48, v49, v50
v_max_u32 v46, v46, v51
v_cmp_eq_u32 s[16:17], -1, v46
L_ck_55:
s_cmp_eq_u64 s[18:19], 0
s_cbranch_scc1 L_ck_56
v_min_u32 v52, v52, v84
v_min_u32 v53, v53, v85
v_min_u32 v54, v54, v86
v_min_u32 v55, v55, v87
v_max3_u32 v46, v52, v53, v54
v_max_u32 v46, v46, v55
v_cmp_eq_u32 s[18:19], -1, v46
L_ck_56:
s_cmp_eq_u64 s[20:21], 0
s_cbranch_scc1 L_ck_57
v_min_u32 v56, v56, v88
v_min_u32 v57, v57, v89
v_min_u32 v58, v58, v90
v_min_u32 v59, v59, v91
v_max3_u32 v46, v56, v57, v58
v_max_u32 v46, v46, v59
v_cmp_eq_u32 s[20:21], -1, v46
L_ck_57:
s_cmp_eq_u64 s[22:23], 0
s_cbranch_scc1 L_ck_58
v_min_u32 v60, v60, v92
v_min_u32 v61, v61, v93
v_min_u32 v62, v62, v94
v_min_u32 v63, v63, v95
v_max3_u32 v46, v60, v61, v62
v_max_u32 v46, v46, v63
v_cmp_eq_u32 s[22:23], -1, v46
L_ck_58:
s_or_b64 s[28:29], s[16:17], s[18:19]
s_or_b64 s[30:31], s[20:21], s[22:23]
s_or_b64 s[28:29], s[28:29], s[30:31]
s_cbranch_scc0 R_done
s_or_b64 exec, s[16:17], 1
buffer_load_dwordx4 v[80:83], v44, s[64:67], s24 offen sc1
s_or_b64 exec, s[18:19], 1
buffer_load_dwordx4 v[84:87], v44, s[64:67], s25 offen sc1
s_or_b64 exec, s[20:21], 1
buffer_load_dwordx4 v[88:91], v44, s[64:67], s26 offen sc1
s_or_b64 exec, s[22:23], 1
buffer_load_dwordx4 v[92:95], v44, s[64:67], s27 offen sc1
s_mov_b64 exec, -1
s_sub_u32 s7, s7, 1
s_cmp_gt_i32 s7, 0
s_cbranch_scc1 R_loop
R_done:
v_mfma_f32_16x16x32_bf16 v[12:15], v[20:23], v[48:51], 0
v_mfma_f32_16x16x32_bf16 v[12:15], v[20:23], v[52:55], v[12:15]
v_mfma_f32_16x16x32_bf16 v[12:15], v[20:23], v[56:59], v[12:15]
v_mfma_f32_16x16x32_bf16 v[12:15], v[20:23], v[60:63], v[12:15]
s_nop 7
v_add_f32_dpp v16, v12, v12 row_ror:8 row_mask:0xf bank_mask:0x3
v_add_f32_dpp v17, v13, v13 row_ror:8 row_mask:0xf bank_mask:0x3
v_add_f32_dpp v16, v14, v14 row_ror:8 row_mask:0xf bank_mask:0xc
v_add_f32_dpp v17, v15, v15 row_ror:8 row_mask:0xf bank_mask:0xc
s_nop 0
v_add_f32_dpp v46, v16, v16 row_shl:4 row_mask:0xf bank_mask:0x5
v_add_f32_dpp v46, v17, v17 row_shr:4 row_mask:0xf bank_mask:0xa
s_mov_b64 exec, 0xffffffff
v_cvt_pk_bf16_f32 v46, v46, v46
buffer_store_short v46, v45, s[72:75], s83 offen
s_mov_b64 exec, -1
s_cmp_lg_u32 s3, 0
s_cbranch_scc1 B_fin
ds_write_b32 v11, v11
s_waitcnt lgkmcnt(0)
B_fin:
B_end:
s_endpgm
H_start:
s_lshl_b32 s6, s8, 6
s_add_u32 s6, s6, s4
s_lshl_b32 s6, s6, 20
s_add_u32 s56, s20, s6
s_addc_u32 s57, s21, 0
s_mov_b32 s58, 34603008
s_mov_b32 s59, 0x20000
v_lshlrev_b32 v16, 7, v1
v_and_b32 v17, 4095, v16
v_add_u32 v16, 4096, v16
v_lshrrev_b32 v21, 5, v1
v_mul_u32_u24 v21, 20480, v21
v_add_u32 v17, v17, v21
s_and_b32 s6, s9, 56
v_and_b32 v19, 7, v1
v_add_u32 v19, s6, v19
v_mul_u32_u24 v19, 16, v19
v_add_u32 v19, 393216, v19
s_lshr_b32 s7, s4, 2
s_mul_i32 s7, s7, 4224
v_add_u32 v19, s7, v19
s_mov_b32 s16, 43
s_mov_b32 s17, 43
s_mov_b32 s18, 43
s_mov_b32 s31, 400000
buffer_load_dwordx3 v[12:14], v19, s[64:67], 0 offen sc1
s_waitcnt vmcnt(0)
H_loop:
v_med3_i32 v12, v12, -1, 31
v_med3_i32 v13, v13, -1, 31
v_med3_i32 v14, v14, -1, 31
v_add3_u32 v20, v12, v13, v14
s_nop 1
v_add_u32_dpp v20, v20, v20 row_ror:4 row_mask:0xf bank_mask:0xf
s_nop 1
v_add_u32_dpp v20, v20, v20 row_ror:2 row_mask:0xf bank_mask:0xf
s_nop 1
v_add_u32_dpp v20, v20, v20 row_ror:1 row_mask:0xf bank_mask:0xf
v_lshlrev_b32 v20, 3, v20
s_nop 0
v_readfirstlane_b32 s28, v20
v_readlane_b32 s20, v12, s9
v_readlane_b32 s21, v13, s9
v_readlane_b32 s22, v14, s9
buffer_load_dwordx3 v[12:14], v19, s[64:67], 0 offen sc1
s_mul_i32 s6, s20, 192
s_sub_i32 s24, s28, s6
s_mul_i32 s6, s16, 24
s_add_i32 s24, s24, s6
s_add_i32 s6, s16, -15
s_cmp_ge_i32 s6, s20
s_cselect_b32 s24, s24, -1048576
s_mul_i32 s6, s21, 192
s_sub_i32 s25, s28, s6
s_mul_i32 s6, s17, 24
s_add_i32 s25, s25, s6
s_add_i32 s6, s17, -15
s_cmp_ge_i32 s6, s21
s_cselect_b32 s25, s25, -1048576
s_mul_i32 s6, s22, 192
s_sub_i32 s26, s28, s6
s_mul_i32 s6, s18, 24
s_add_i32 s26, s26, s6
s_add_i32 s6, s18, -15
s_cmp_ge_i32 s6, s22
s_cselect_b32 s26, s26, -1048576
s_cmp_ge_i32 s24, s25
s_cselect_b32 s29, 0, 1
s_max_i32 s30, s24, s25
s_cmp_ge_i32 s30, s26
s_cselect_b32 s29, s29, 2
s_max_i32 s30, s30, s26
s_cmp_eq_i32 s30, -1048576
s_cbranch_scc1 H_end
s_sub_u32 s31, s31, 1
s_cmp_eq_u32 s31, 0
s_cbranch_scc1 H_end
s_cmp_lt_i32 s30, 1416
s_cbranch_scc1 H_idle
s_cmp_eq_u32 s29, 0
s_cselect_b32 s6, s16, s6
s_subb_u32 s16, s16, 0
s_cmp_eq_u32 s29, 1
s_cselect_b32 s6, s17, s6
s_subb_u32 s17, s17, 0
s_cmp_eq_u32 s29, 2
s_cselect_b32 s6, s18, s6
s_subb_u32 s18, s18, 0
s_mul_i32 s6, s6, 24576
s_sub_u32 s6, s6, 32768
s_cmp_eq_u32 s29, 2
s_cselect_b32 s7, 33554432, 0
s_add_u32 s6, s6, s7
s_cmp_eq_u32 s29, 1
s_cselect_b64 vcc, -1, 0
s_cselect_b32 s7, 25, 13
s_lshl_b32 s7, 1, s7
s_add_u32 s7, s7, s6
v_cndmask_b32 v18, v16, v17, vcc
buffer_load_dword v22, v18, s[56:59], s6 offen
buffer_load_dword v23, v18, s[56:59], s7 offen
s_waitcnt vmcnt(2)
s_branch H_loop
H_idle:
ds_read_b32 v21, v11
s_waitcnt vmcnt(0) lgkmcnt(0)
s_sleep 4
v_cmp_eq_u32 vcc, 0, v21
s_cbranch_vccnz H_loop
H_end:
s_branch B_end
.section .rodata,"a"
.p2align 6
.amdhsa_kernel concat_heads__mha_block_cached__compressed_kv_cla__decode_kernel
  .amdhsa_next_free_vgpr 512
  .amdhsa_next_free_sgpr 102
  .amdhsa_accum_offset 256
  .amdhsa_group_segment_fixed_size 0
  .amdhsa_kernarg_size 112
  .amdhsa_user_sgpr_count 2
  .amdhsa_user_sgpr_kernarg_segment_ptr 1
  .amdhsa_system_sgpr_workgroup_id_x 1
.end_amdhsa_kernel
```

```asm
; @launch grid=(256,1,1) block=(256,1,1) lds=163840
.amdgcn_target "amdgcn-amd-amdhsa--gfx950"
.text
.globl concat_heads__mha_block_cached__compressed_kv_cla__decode_kernel
.p2align 8
.type concat_heads__mha_block_cached__compressed_kv_cla__decode_kernel,@function
concat_heads__mha_block_cached__compressed_kv_cla__decode_kernel:
s_cmp_ge_u32 s2, 256
s_cbranch_scc1 L_exit
s_load_dwordx16 s[16:31], s[0:1], 0
s_load_dwordx8 s[32:39], s[0:1], 64
s_load_dwordx4 s[40:43], s[0:1], 96
v_lshrrev_b32 v1, 6, v0
s_nop 0
v_readfirstlane_b32 s3, v1
s_and_b32 s6, s2, 7
s_bfe_u32 s7, s2, 0x20003
s_lshl_b32 s4, s6, 2
s_add_u32 s4, s4, s7
s_lshr_b32 s5, s2, 5
s_cmp_lt_u32 s5, 2
s_cbranch_scc1 B_role
A_role:
s_sub_u32 s8, s5, 2
s_cmp_ge_u32 s8, 3
s_cselect_b32 s9, 1, 0
s_cselect_b32 s6, 3, 0
s_sub_u32 s8, s8, s6
s_lshl_b32 s11, s8, 2
s_add_u32 s11, s11, s3
s_cmp_ge_u32 s11, 6
s_cselect_b32 s83, 1, 0
s_cselect_b32 s6, -1, 1
s_add_u32 s11, s11, s6
s_cmp_ge_u32 s11, 6
s_cselect_b32 s6, 6, 0
s_sub_u32 s11, s11, s6
s_lshl_b32 s10, s9, 1
s_add_u32 s10, s10, s83
v_and_b32 v1, 63, v0
v_lshlrev_b32 v2, 4, v1
s_sub_u32 s14, s11, 8
s_lshl_b32 s14, s14, 12
s_mov_b32 s13, s14
s_add_u32 s13, s13, 24576
s_min_u32 s12, s13, 2146435072
s_lshl_b32 s82, s10, 5
s_add_u32 s82, s82, s4
s_lshl_b32 s72, s82, 20
s_mov_b32 s54, 1048576
s_mov_b32 s55, 0x20000
s_waitcnt lgkmcnt(0)
s_add_u32 s52, s18, s72
s_addc_u32 s53, s19, 0
buffer_load_dwordx4 v[136:139], v2, s[52:55], s12 offen offset:0 nt
buffer_load_dwordx4 v[140:143], v2, s[52:55], s12 offen offset:1024 nt
buffer_load_dwordx4 v[144:147], v2, s[52:55], s12 offen offset:2048 nt
buffer_load_dwordx4 v[148:151], v2, s[52:55], s12 offen offset:3072 nt
s_add_u32 s13, s13, 24576
s_min_u32 s12, s13, 2146435072
buffer_load_dwordx4 v[152:155], v2, s[52:55], s12 offen offset:0 nt
buffer_load_dwordx4 v[156:159], v2, s[52:55], s12 offen offset:1024 nt
buffer_load_dwordx4 v[160:163], v2, s[52:55], s12 offen offset:2048 nt
buffer_load_dwordx4 v[164:167], v2, s[52:55], s12 offen offset:3072 nt
s_add_u32 s13, s13, 24576
s_min_u32 s12, s13, 2146435072
s_lshr_b32 s6, s2, 3
s_sub_u32 s6, s6, 8
s_lshl_b32 s6, s6, 2
s_add_u32 s6, s6, s3
s_mul_i32 s6, s6, 49152
s_and_b32 s7, s2, 7
s_lshl_b32 s7, s7, 10
s_add_u32 s75, s6, s7
s_mov_b32 s62, 4718592
s_mov_b32 s63, 0x20000
v_min_u32 v35, 47, v1
v_lshrrev_b32 v36, 3, v35
v_mul_u32_u24 v36, 7168, v36
v_lshl_add_u32 v36, v35, 7, v36
s_mov_b64 s[60:61], s[22:23]
buffer_load_dword v120, v36, s[60:63], s75 offen
s_mov_b32 s58, 1048576
s_mov_b32 s59, 0x20000
s_mul_i32 s6, s9, 2304
s_mul_i32 s7, s3, 288
s_add_u32 s73, s6, s7
s_sub_u32 s46, 4608, s73
s_mov_b32 s47, 0x20000
s_mul_i32 s6, s3, 1179648
s_lshl_b32 s7, s4, 8
s_add_u32 s74, s6, s7
s_sub_u32 s50, 4718592, s74
s_mov_b32 s51, 0x20000
v_lshrrev_b32 v5, 4, v1
v_and_b32 v6, 15, v1
v_mul_u32_u24 v3, 294912, v5
v_lshl_add_u32 v3, v6, 4, v3
v_mul_u32_u24 v4, 72, v5
v_lshrrev_b32 v6, 3, v6
v_mul_u32_u24 v6, 1152, v6
v_add_u32 v4, v4, v6
s_add_u32 s44, s16, s73
s_addc_u32 s45, s17, 0
buffer_load_dwordx4 v[40:43], v4, s[44:47], 0 offen offset:0
buffer_load_dwordx4 v[44:47], v4, s[44:47], 0 offen offset:16
buffer_load_dwordx4 v[48:51], v4, s[44:47], 0 offen offset:32
buffer_load_dwordx4 v[52:55], v4, s[44:47], 0 offen offset:48
buffer_load_dwordx2 v[56:57], v4, s[44:47], 0 offen offset:64
s_add_u32 s56, s20, s72
s_addc_u32 s57, s21, 0
s_add_u32 s48, s22, s74
s_addc_u32 s49, s23, 0
s_cmp_lg_u32 s8, 0
s_cbranch_scc1 L_nowq_1
s_waitcnt vmcnt(20)
s_mov_b32 s6, 0
buffer_load_dwordx4 a[96:99], v3, s[48:51], s6 offen
s_mov_b32 s6, 8192
buffer_load_dwordx4 a[100:103], v3, s[48:51], s6 offen
s_mov_b32 s6, 16384
buffer_load_dwordx4 a[104:107], v3, s[48:51], s6 offen
s_mov_b32 s6, 24576
buffer_load_dwordx4 a[108:111], v3, s[48:51], s6 offen
s_mov_b32 s6, 32768
buffer_load_dwordx4 a[112:115], v3, s[48:51], s6 offen
s_mov_b32 s6, 40960
buffer_load_dwordx4 a[116:119], v3, s[48:51], s6 offen
s_mov_b32 s6, 49152
buffer_load_dwordx4 a[120:123], v3, s[48:51], s6 offen
s_mov_b32 s6, 57344
buffer_load_dwordx4 a[124:127], v3, s[48:51], s6 offen
s_mov_b32 s6, 65536
buffer_load_dwordx4 a[128:131], v3, s[48:51], s6 offen
s_mov_b32 s6, 73728
buffer_load_dwordx4 a[132:135], v3, s[48:51], s6 offen
s_mov_b32 s6, 81920
buffer_load_dwordx4 a[136:139], v3, s[48:51], s6 offen
s_mov_b32 s6, 90112
buffer_load_dwordx4 a[140:143], v3, s[48:51], s6 offen
s_mov_b32 s6, 98304
buffer_load_dwordx4 a[144:147], v3, s[48:51], s6 offen
s_mov_b32 s6, 106496
buffer_load_dwordx4 a[148:151], v3, s[48:51], s6 offen
s_mov_b32 s6, 114688
buffer_load_dwordx4 a[152:155], v3, s[48:51], s6 offen
s_mov_b32 s6, 122880
buffer_load_dwordx4 a[156:159], v3, s[48:51], s6 offen
s_mov_b32 s6, 131072
buffer_load_dwordx4 a[160:163], v3, s[48:51], s6 offen
s_mov_b32 s6, 139264
buffer_load_dwordx4 a[164:167], v3, s[48:51], s6 offen
s_mov_b32 s6, 147456
buffer_load_dwordx4 a[168:171], v3, s[48:51], s6 offen
s_mov_b32 s6, 155648
buffer_load_dwordx4 a[172:175], v3, s[48:51], s6 offen
s_mov_b32 s6, 163840
buffer_load_dwordx4 a[176:179], v3, s[48:51], s6 offen
s_mov_b32 s6, 172032
buffer_load_dwordx4 a[180:183], v3, s[48:51], s6 offen
s_mov_b32 s6, 180224
buffer_load_dwordx4 a[184:187], v3, s[48:51], s6 offen
s_mov_b32 s6, 188416
buffer_load_dwordx4 a[188:191], v3, s[48:51], s6 offen
s_mov_b32 s6, 196608
buffer_load_dwordx4 a[192:195], v3, s[48:51], s6 offen
s_mov_b32 s6, 204800
buffer_load_dwordx4 a[196:199], v3, s[48:51], s6 offen
s_mov_b32 s6, 212992
buffer_load_dwordx4 a[200:203], v3, s[48:51], s6 offen
s_mov_b32 s6, 221184
buffer_load_dwordx4 a[204:207], v3, s[48:51], s6 offen
s_mov_b32 s6, 229376
buffer_load_dwordx4 a[208:211], v3, s[48:51], s6 offen
s_mov_b32 s6, 237568
buffer_load_dwordx4 a[212:215], v3, s[48:51], s6 offen
s_mov_b32 s6, 245760
buffer_load_dwordx4 a[216:219], v3, s[48:51], s6 offen
s_mov_b32 s6, 253952
buffer_load_dwordx4 a[220:223], v3, s[48:51], s6 offen
s_mov_b32 s6, 262144
buffer_load_dwordx4 a[224:227], v3, s[48:51], s6 offen
s_mov_b32 s6, 270336
buffer_load_dwordx4 a[228:231], v3, s[48:51], s6 offen
s_mov_b32 s6, 278528
buffer_load_dwordx4 a[232:235], v3, s[48:51], s6 offen
s_mov_b32 s6, 286720
buffer_load_dwordx4 a[236:239], v3, s[48:51], s6 offen
L_nowq_1:
s_waitcnt vmcnt(54)
buffer_load_dwordx4 v[168:171], v2, s[52:55], s12 offen offset:0 nt
buffer_load_dwordx4 v[172:175], v2, s[52:55], s12 offen offset:1024 nt
buffer_load_dwordx4 v[176:179], v2, s[52:55], s12 offen offset:2048 nt
buffer_load_dwordx4 v[180:183], v2, s[52:55], s12 offen offset:3072 nt
s_add_u32 s13, s13, 24576
s_min_u32 s12, s13, 2146435072
s_waitcnt vmcnt(54)
buffer_load_dwordx4 v[184:187], v2, s[52:55], s12 offen offset:0 nt
buffer_load_dwordx4 v[188:191], v2, s[52:55], s12 offen offset:1024 nt
buffer_load_dwordx4 v[192:195], v2, s[52:55], s12 offen offset:2048 nt
buffer_load_dwordx4 v[196:199], v2, s[52:55], s12 offen offset:3072 nt
s_add_u32 s13, s13, 24576
s_min_u32 s12, s13, 2146435072
s_waitcnt vmcnt(54)
buffer_load_dwordx4 v[200:203], v2, s[52:55], s12 offen offset:0 nt
buffer_load_dwordx4 v[204:207], v2, s[52:55], s12 offen offset:1024 nt
buffer_load_dwordx4 v[208:211], v2, s[52:55], s12 offen offset:2048 nt
buffer_load_dwordx4 v[212:215], v2, s[52:55], s12 offen offset:3072 nt
s_add_u32 s13, s13, 24576
s_min_u32 s12, s13, 2146435072
s_cmp_lg_u32 s8, 1
s_cbranch_scc1 L_nowq_2
s_waitcnt vmcnt(20)
s_mov_b32 s6, 0
buffer_load_dwordx4 a[96:99], v3, s[48:51], s6 offen
s_mov_b32 s6, 8192
buffer_load_dwordx4 a[100:103], v3, s[48:51], s6 offen
s_mov_b32 s6, 16384
buffer_load_dwordx4 a[104:107], v3, s[48:51], s6 offen
s_mov_b32 s6, 24576
buffer_load_dwordx4 a[108:111], v3, s[48:51], s6 offen
s_mov_b32 s6, 32768
buffer_load_dwordx4 a[112:115], v3, s[48:51], s6 offen
s_mov_b32 s6, 40960
buffer_load_dwordx4 a[116:119], v3, s[48:51], s6 offen
s_mov_b32 s6, 49152
buffer_load_dwordx4 a[120:123], v3, s[48:51], s6 offen
s_mov_b32 s6, 57344
buffer_load_dwordx4 a[124:127], v3, s[48:51], s6 offen
s_mov_b32 s6, 65536
buffer_load_dwordx4 a[128:131], v3, s[48:51], s6 offen
s_mov_b32 s6, 73728
buffer_load_dwordx4 a[132:135], v3, s[48:51], s6 offen
s_mov_b32 s6, 81920
buffer_load_dwordx4 a[136:139], v3, s[48:51], s6 offen
s_mov_b32 s6, 90112
buffer_load_dwordx4 a[140:143], v3, s[48:51], s6 offen
s_mov_b32 s6, 98304
buffer_load_dwordx4 a[144:147], v3, s[48:51], s6 offen
s_mov_b32 s6, 106496
buffer_load_dwordx4 a[148:151], v3, s[48:51], s6 offen
s_mov_b32 s6, 114688
buffer_load_dwordx4 a[152:155], v3, s[48:51], s6 offen
s_mov_b32 s6, 122880
buffer_load_dwordx4 a[156:159], v3, s[48:51], s6 offen
s_mov_b32 s6, 131072
buffer_load_dwordx4 a[160:163], v3, s[48:51], s6 offen
s_mov_b32 s6, 139264
buffer_load_dwordx4 a[164:167], v3, s[48:51], s6 offen
s_mov_b32 s6, 147456
buffer_load_dwordx4 a[168:171], v3, s[48:51], s6 offen
s_mov_b32 s6, 155648
buffer_load_dwordx4 a[172:175], v3, s[48:51], s6 offen
s_mov_b32 s6, 163840
buffer_load_dwordx4 a[176:179], v3, s[48:51], s6 offen
s_mov_b32 s6, 172032
buffer_load_dwordx4 a[180:183], v3, s[48:51], s6 offen
s_mov_b32 s6, 180224
buffer_load_dwordx4 a[184:187], v3, s[48:51], s6 offen
s_mov_b32 s6, 188416
buffer_load_dwordx4 a[188:191], v3, s[48:51], s6 offen
s_mov_b32 s6, 196608
buffer_load_dwordx4 a[192:195], v3, s[48:51], s6 offen
s_mov_b32 s6, 204800
buffer_load_dwordx4 a[196:199], v3, s[48:51], s6 offen
s_mov_b32 s6, 212992
buffer_load_dwordx4 a[200:203], v3, s[48:51], s6 offen
s_mov_b32 s6, 221184
buffer_load_dwordx4 a[204:207], v3, s[48:51], s6 offen
s_mov_b32 s6, 229376
buffer_load_dwordx4 a[208:211], v3, s[48:51], s6 offen
s_mov_b32 s6, 237568
buffer_load_dwordx4 a[212:215], v3, s[48:51], s6 offen
s_mov_b32 s6, 245760
buffer_load_dwordx4 a[216:219], v3, s[48:51], s6 offen
s_mov_b32 s6, 253952
buffer_load_dwordx4 a[220:223], v3, s[48:51], s6 offen
s_mov_b32 s6, 262144
buffer_load_dwordx4 a[224:227], v3, s[48:51], s6 offen
s_mov_b32 s6, 270336
buffer_load_dwordx4 a[228:231], v3, s[48:51], s6 offen
s_mov_b32 s6, 278528
buffer_load_dwordx4 a[232:235], v3, s[48:51], s6 offen
s_mov_b32 s6, 286720
buffer_load_dwordx4 a[236:239], v3, s[48:51], s6 offen
L_nowq_2:
s_waitcnt vmcnt(54)
buffer_load_dwordx4 v[216:219], v2, s[52:55], s12 offen offset:0 nt
buffer_load_dwordx4 v[220:223], v2, s[52:55], s12 offen offset:1024 nt
buffer_load_dwordx4 v[224:227], v2, s[52:55], s12 offen offset:2048 nt
buffer_load_dwordx4 v[228:231], v2, s[52:55], s12 offen offset:3072 nt
s_add_u32 s13, s13, 24576
s_min_u32 s12, s13, 2146435072
s_waitcnt vmcnt(54)
buffer_load_dwordx4 v[232:235], v2, s[52:55], s12 offen offset:0 nt
buffer_load_dwordx4 v[236:239], v2, s[52:55], s12 offen offset:1024 nt
buffer_load_dwordx4 v[240:243], v2, s[52:55], s12 offen offset:2048 nt
buffer_load_dwordx4 v[244:247], v2, s[52:55], s12 offen offset:3072 nt
s_add_u32 s13, s13, 24576
s_min_u32 s12, s13, 2146435072
s_waitcnt vmcnt(54)
s_add_u32 s34, s14, 24576
s_min_u32 s34, s34, 2146435072
buffer_load_dwordx4 a[0:3], v2, s[56:59], s34 offen offset:0 nt
buffer_load_dwordx4 a[4:7], v2, s[56:59], s34 offen offset:1024 nt
buffer_load_dwordx4 a[8:11], v2, s[56:59], s34 offen offset:2048 nt
buffer_load_dwordx4 a[12:15], v2, s[56:59], s34 offen offset:3072 nt
s_cmp_lg_u32 s8, 2
s_cbranch_scc1 L_nowq_3
s_waitcnt vmcnt(20)
s_mov_b32 s6, 0
buffer_load_dwordx4 a[96:99], v3, s[48:51], s6 offen
s_mov_b32 s6, 8192
buffer_load_dwordx4 a[100:103], v3, s[48:51], s6 offen
s_mov_b32 s6, 16384
buffer_load_dwordx4 a[104:107], v3, s[48:51], s6 offen
s_mov_b32 s6, 24576
buffer_load_dwordx4 a[108:111], v3, s[48:51], s6 offen
s_mov_b32 s6, 32768
buffer_load_dwordx4 a[112:115], v3, s[48:51], s6 offen
s_mov_b32 s6, 40960
buffer_load_dwordx4 a[116:119], v3, s[48:51], s6 offen
s_mov_b32 s6, 49152
buffer_load_dwordx4 a[120:123], v3, s[48:51], s6 offen
s_mov_b32 s6, 57344
buffer_load_dwordx4 a[124:127], v3, s[48:51], s6 offen
s_mov_b32 s6, 65536
buffer_load_dwordx4 a[128:131], v3, s[48:51], s6 offen
s_mov_b32 s6, 73728
buffer_load_dwordx4 a[132:135], v3, s[48:51], s6 offen
s_mov_b32 s6, 81920
buffer_load_dwordx4 a[136:139], v3, s[48:51], s6 offen
s_mov_b32 s6, 90112
buffer_load_dwordx4 a[140:143], v3, s[48:51], s6 offen
s_mov_b32 s6, 98304
buffer_load_dwordx4 a[144:147], v3, s[48:51], s6 offen
s_mov_b32 s6, 106496
buffer_load_dwordx4 a[148:151], v3, s[48:51], s6 offen
s_mov_b32 s6, 114688
buffer_load_dwordx4 a[152:155], v3, s[48:51], s6 offen
s_mov_b32 s6, 122880
buffer_load_dwordx4 a[156:159], v3, s[48:51], s6 offen
s_mov_b32 s6, 131072
buffer_load_dwordx4 a[160:163], v3, s[48:51], s6 offen
s_mov_b32 s6, 139264
buffer_load_dwordx4 a[164:167], v3, s[48:51], s6 offen
s_mov_b32 s6, 147456
buffer_load_dwordx4 a[168:171], v3, s[48:51], s6 offen
s_mov_b32 s6, 155648
buffer_load_dwordx4 a[172:175], v3, s[48:51], s6 offen
s_mov_b32 s6, 163840
buffer_load_dwordx4 a[176:179], v3, s[48:51], s6 offen
s_mov_b32 s6, 172032
buffer_load_dwordx4 a[180:183], v3, s[48:51], s6 offen
s_mov_b32 s6, 180224
buffer_load_dwordx4 a[184:187], v3, s[48:51], s6 offen
s_mov_b32 s6, 188416
buffer_load_dwordx4 a[188:191], v3, s[48:51], s6 offen
s_mov_b32 s6, 196608
buffer_load_dwordx4 a[192:195], v3, s[48:51], s6 offen
s_mov_b32 s6, 204800
buffer_load_dwordx4 a[196:199], v3, s[48:51], s6 offen
s_mov_b32 s6, 212992
buffer_load_dwordx4 a[200:203], v3, s[48:51], s6 offen
s_mov_b32 s6, 221184
buffer_load_dwordx4 a[204:207], v3, s[48:51], s6 offen
s_mov_b32 s6, 229376
buffer_load_dwordx4 a[208:211], v3, s[48:51], s6 offen
s_mov_b32 s6, 237568
buffer_load_dwordx4 a[212:215], v3, s[48:51], s6 offen
s_mov_b32 s6, 245760
buffer_load_dwordx4 a[216:219], v3, s[48:51], s6 offen
s_mov_b32 s6, 253952
buffer_load_dwordx4 a[220:223], v3, s[48:51], s6 offen
s_mov_b32 s6, 262144
buffer_load_dwordx4 a[224:227], v3, s[48:51], s6 offen
s_mov_b32 s6, 270336
buffer_load_dwordx4 a[228:231], v3, s[48:51], s6 offen
s_mov_b32 s6, 278528
buffer_load_dwordx4 a[232:235], v3, s[48:51], s6 offen
s_mov_b32 s6, 286720
buffer_load_dwordx4 a[236:239], v3, s[48:51], s6 offen
L_nowq_3:
s_mov_b32 s64, s42
s_mov_b32 s65, s43
s_mov_b32 s66, 16777216
s_mov_b32 s67, 0x20000
s_mov_b32 s68, s40
s_mov_b32 s69, s41
s_mov_b32 s70, 256
s_mov_b32 s71, 0x20000
s_mul_i32 s6, s4, 147456
s_add_u32 s60, s24, s6
s_addc_u32 s61, s25, 0
s_mov_b32 s62, 147456
s_mov_b32 s63, 0x20000
v_and_b32 v5, 1, v1
v_lshlrev_b32 v5, 4, v5
v_mov_b32 v6, 0xffff
v_lshlrev_b32 v5, v5, v6
v_bfe_u32 v6, v1, 1, 2
v_cmp_eq_u32 vcc, 0, v6
s_nop 1
v_cndmask_b32 v8, 0, v5, vcc
v_cmp_eq_u32 vcc, 1, v6
s_nop 1
v_cndmask_b32 v9, 0, v5, vcc
v_cmp_eq_u32 vcc, 2, v6
s_nop 1
v_cndmask_b32 v10, 0, v5, vcc
v_cmp_eq_u32 vcc, 3, v6
s_nop 1
v_cndmask_b32 v11, 0, v5, vcc
v_mov_b32 v5, 0x0c0c0c0c
s_mov_b32 s6, 0x01000100
s_mov_b32 s7, 0x03020302
v_bfi_b32 v12, v8, s6, v5
v_bfi_b32 v13, v9, s6, v5
v_bfi_b32 v14, v10, s6, v5
v_bfi_b32 v15, v11, s6, v5
v_bfi_b32 v16, v8, s7, v5
v_bfi_b32 v17, v9, s7, v5
v_bfi_b32 v18, v10, s7, v5
v_bfi_b32 v19, v11, s7, v5
v_mov_b32 v7, 0x3e0293ee
v_mov_b32 v86, 0xff800000
v_lshrrev_b32 v5, 4, v1
v_lshlrev_b32 v5, 3, v5
v_bfe_u32 v6, v1, 2, 2
v_add_u32 v5, v5, v6
v_mul_u32_u24 v5, 1152, v5
s_mul_i32 s6, s3, 288
v_add_u32 v5, s6, v5
v_and_b32 v6, 3, v1
v_lshl_add_u32 v88, v6, 5, v5
v_lshl_add_u32 v89, v6, 3, v5
v_add_u32 v89, 256, v89
v_bfe_u32 v6, v1, 3, 1
v_mul_u32_u24 v6, 2176, v6
v_sub_u32 v88, v88, v6
v_lshrrev_b32 v6, 4, v1
v_mul_u32_u24 v6, 4608, v6
v_sub_u32 v88, v88, v6
v_add_u32 v90, 73728, v88
v_add_u32 v91, 73728, v89
s_mul_i32 s82, s82, 64
s_add_u32 s82, s82, 327680
s_mov_b64 s[72:73], 0
s_cmp_ge_u32 s11, 2
s_cselect_b32 s74, 0x22222222, 0
s_mov_b32 s75, s74
s_mov_b32 s76, 0x44444444
s_mov_b32 s77, s76
s_mov_b32 s78, 0x88888888
s_mov_b32 s79, s78
v_bfe_u32 v5, v1, 4, 1
s_lshl_b32 s6, s9, 7
s_lshl_b32 s7, s4, 1
s_add_u32 s6, s6, s7
s_add_u32 s6, s6, s8
v_mul_u32_u24 v6, 63, v5
v_add_u32 v6, s6, v6
v_mul_u32_u24 v92, 1152, v6
v_add_u32 v92, 4194304, v92
v_sub_u32 v6, s8, v5
v_cmp_lt_u32 vcc, 1, v6
v_mov_b32 v6, 2146435072
s_nop 0
v_cndmask_b32 v92, v92, v6, vcc
v_and_b32 v35, 15, v1
v_lshl_add_u32 v92, v35, 4, v92
s_lshl_b32 s6, s3, 5
v_add_u32 v93, s6, v92
s_lshl_b32 s6, s3, 8
v_add_u32 v92, s6, v92
s_lshl_b32 s6, s8, 2
s_add_u32 s6, s6, 0
s_cmp_ge_u32 s6, 6
s_cselect_b32 s6, 1, 0
v_cmp_eq_u32 vcc, s6, v5
s_nop 1
v_cndmask_b32 v106, 0, 1.0, vcc
s_lshl_b32 s6, s8, 2
s_add_u32 s6, s6, 1
s_cmp_ge_u32 s6, 6
s_cselect_b32 s6, 1, 0
v_cmp_eq_u32 vcc, s6, v5
s_nop 1
v_cndmask_b32 v107, 0, 1.0, vcc
s_lshl_b32 s6, s8, 2
s_add_u32 s6, s6, 2
s_cmp_ge_u32 s6, 6
s_cselect_b32 s6, 1, 0
v_cmp_eq_u32 vcc, s6, v5
s_nop 1
v_cndmask_b32 v108, 0, 1.0, vcc
s_lshl_b32 s6, s8, 2
s_add_u32 s6, s6, 3
s_cmp_ge_u32 s6, 6
s_cselect_b32 s6, 1, 0
v_cmp_eq_u32 vcc, s6, v5
s_nop 1
v_cndmask_b32 v109, 0, 1.0, vcc
v_bfe_i32 v35, v1, 3, 1
v_and_b32 v35, 0xaaaaaaaa, v35
v_or_b32 v105, 0x44444444, v35
v_and_b32 v35, 15, v1
v_lshlrev_b32 v35, 4, v35
v_lshl_add_u32 v94, v5, 3, v35
s_lshl_b32 s6, s3, 8
s_add_u32 s6, s6, 151552
v_add_u32 v94, s6, v94
v_and_b32 v35, 3, v1
v_lshlrev_b32 v35, 8, v35
v_lshrrev_b32 v36, 4, v1
v_lshl_add_u32 v95, v36, 4, v35
v_add_u32 v95, 151552, v95
s_mul_i32 s15, s3, 36864
s_mov_b32 s80, 0x0
s_mov_b32 s81, 0
s_lshl_b32 s6, s4, 1
s_add_u32 s6, s6, s9
s_mul_i32 s6, s6, 4
s_add_u32 s6, s6, s8
s_lshl_b32 s6, s6, 2
s_add_u32 s6, s6, 393216
s_lshr_b32 s7, s4, 2
s_mul_i32 s7, s7, 4224
s_add_u32 s6, s6, s7
v_mov_b32 v118, 2146435072
v_mov_b32 v117, s6
v_cmp_eq_u32 vcc, 0, v0
s_nop 1
v_cndmask_b32 v118, v118, v117, vcc
v_mov_b32 v117, 3
v_and_b32 v35, 15, v1
v_lshlrev_b32 v35, 5, v35
v_lshl_add_u32 v36, v5, 4, v35
v_lshrrev_b32 v6, 5, v1
v_lshl_add_u32 v36, v6, 9, v36
s_lshl_b32 s6, s3, 10
s_add_u32 s6, s6, 147456
v_add_u32 v36, s6, v36
s_lshl_b32 s6, s83, 9
s_add_u32 s6, s6, 147456
v_add_u32 v35, s6, v35
s_waitcnt vmcnt(35)
v_perm_b32 v60, v40, v40, v12
v_perm_b32 v61, v40, v40, v13
v_perm_b32 v62, v40, v40, v14
v_perm_b32 v63, v40, v40, v15
s_nop 1
v_mfma_f32_16x16x32_bf16 v[20:23], v[60:63], a[96:99], 0
s_add_u32 s34, s14, 49152
s_min_u32 s34, s34, 2146435072
buffer_load_dwordx4 a[16:19], v2, s[56:59], s34 offen offset:0 nt
s_waitcnt vmcnt(35)
v_perm_b32 v64, v40, v40, v16
v_perm_b32 v65, v40, v40, v17
v_perm_b32 v66, v40, v40, v18
v_perm_b32 v67, v40, v40, v19
s_nop 1
v_mfma_f32_16x16x32_bf16 v[20:23], v[64:67], a[100:103], v[20:23]
buffer_load_dwordx4 a[20:23], v2, s[56:59], s34 offen offset:1024 nt
s_waitcnt vmcnt(35)
v_perm_b32 v68, v41, v41, v12
v_perm_b32 v69, v41, v41, v13
v_perm_b32 v70, v41, v41, v14
v_perm_b32 v71, v41, v41, v15
s_nop 1
v_mfma_f32_16x16x32_bf16 v[20:23], v[68:71], a[104:107], v[20:23]
buffer_load_dwordx4 a[24:27], v2, s[56:59], s34 offen offset:2048 nt
s_waitcnt vmcnt(35)
v_perm_b32 v72, v41, v41, v16
v_perm_b32 v73, v41, v41, v17
v_perm_b32 v74, v41, v41, v18
v_perm_b32 v75, v41, v41, v19
s_nop 1
v_mfma_f32_16x16x32_bf16 v[20:23], v[72:75], a[108:111], v[20:23]
buffer_load_dwordx4 a[28:31], v2, s[56:59], s34 offen offset:3072 nt
s_waitcnt vmcnt(35)
v_perm_b32 v60, v42, v42, v12
v_perm_b32 v61, v42, v42, v13
v_perm_b32 v62, v42, v42, v14
v_perm_b32 v63, v42, v42, v15
s_nop 1
v_mfma_f32_16x16x32_bf16 v[20:23], v[60:63], a[112:115], v[20:23]
s_add_u32 s34, s14, 73728
s_min_u32 s34, s34, 2146435072
buffer_load_dwordx4 a[32:35], v2, s[56:59], s34 offen offset:0 nt
s_waitcnt vmcnt(35)
v_perm_b32 v64, v42, v42, v16
v_perm_b32 v65, v42, v42, v17
v_perm_b32 v66, v42, v42, v18
v_perm_b32 v67, v42, v42, v19
s_nop 1
v_mfma_f32_16x16x32_bf16 v[20:23], v[64:67], a[116:119], v[20:23]
buffer_load_dwordx4 a[36:39], v2, s[56:59], s34 offen offset:1024 nt
s_waitcnt vmcnt(35)
v_perm_b32 v68, v43, v43, v12
v_perm_b32 v69, v43, v43, v13
v_perm_b32 v70, v43, v43, v14
v_perm_b32 v71, v43, v43, v15
s_nop 1
v_mfma_f32_16x16x32_bf16 v[20:23], v[68:71], a[120:123], v[20:23]
buffer_load_dwordx4 a[40:43], v2, s[56:59], s34 offen offset:2048 nt
s_waitcnt vmcnt(35)
v_perm_b32 v72, v43, v43, v16
v_perm_b32 v73, v43, v43, v17
v_perm_b32 v74, v43, v43, v18
v_perm_b32 v75, v43, v43, v19
s_nop 1
v_mfma_f32_16x16x32_bf16 v[20:23], v[72:75], a[124:127], v[20:23]
buffer_load_dwordx4 a[44:47], v2, s[56:59], s34 offen offset:3072 nt
s_waitcnt vmcnt(35)
v_perm_b32 v60, v44, v44, v12
v_perm_b32 v61, v44, v44, v13
v_perm_b32 v62, v44, v44, v14
v_perm_b32 v63, v44, v44, v15
s_nop 1
v_mfma_f32_16x16x32_bf16 v[20:23], v[60:63], a[128:131], v[20:23]
s_add_u32 s34, s14, 98304
s_min_u32 s34, s34, 2146435072
buffer_load_dwordx4 a[48:51], v2, s[56:59], s34 offen offset:0 nt
s_waitcnt vmcnt(35)
v_perm_b32 v64, v44, v44, v16
v_perm_b32 v65, v44, v44, v17
v_perm_b32 v66, v44, v44, v18
v_perm_b32 v67, v44, v44, v19
s_nop 1
v_mfma_f32_16x16x32_bf16 v[20:23], v[64:67], a[132:135], v[20:23]
buffer_load_dwordx4 a[52:55], v2, s[56:59], s34 offen offset:1024 nt
s_waitcnt vmcnt(35)
v_perm_b32 v68, v45, v45, v12
v_perm_b32 v69, v45, v45, v13
v_perm_b32 v70, v45, v45, v14
v_perm_b32 v71, v45, v45, v15
s_nop 1
v_mfma_f32_16x16x32_bf16 v[20:23], v[68:71], a[136:139], v[20:23]
buffer_load_dwordx4 a[56:59], v2, s[56:59], s34 offen offset:2048 nt
s_waitcnt vmcnt(35)
v_perm_b32 v72, v45, v45, v16
v_perm_b32 v73, v45, v45, v17
v_perm_b32 v74, v45, v45, v18
v_perm_b32 v75, v45, v45, v19
s_nop 1
v_mfma_f32_16x16x32_bf16 v[20:23], v[72:75], a[140:143], v[20:23]
buffer_load_dwordx4 a[60:63], v2, s[56:59], s34 offen offset:3072 nt
s_waitcnt vmcnt(35)
v_perm_b32 v60, v46, v46, v12
v_perm_b32 v61, v46, v46, v13
v_perm_b32 v62, v46, v46, v14
v_perm_b32 v63, v46, v46, v15
s_nop 1
v_mfma_f32_16x16x32_bf16 v[20:23], v[60:63], a[144:147], v[20:23]
s_add_u32 s34, s14, 122880
s_min_u32 s34, s34, 2146435072
buffer_load_dwordx4 a[64:67], v2, s[56:59], s34 offen offset:0 nt
s_waitcnt vmcnt(35)
v_perm_b32 v64, v46, v46, v16
v_perm_b32 v65, v46, v46, v17
v_perm_b32 v66, v46, v46, v18
v_perm_b32 v67, v46, v46, v19
s_nop 1
v_mfma_f32_16x16x32_bf16 v[20:23], v[64:67], a[148:151], v[20:23]
buffer_load_dwordx4 a[68:71], v2, s[56:59], s34 offen offset:1024 nt
s_waitcnt vmcnt(35)
v_perm_b32 v68, v47, v47, v12
v_perm_b32 v69, v47, v47, v13
v_perm_b32 v70, v47, v47, v14
v_perm_b32 v71, v47, v47, v15
s_nop 1
v_mfma_f32_16x16x32_bf16 v[20:23], v[68:71], a[152:155], v[20:23]
buffer_load_dwordx4 a[72:75], v2, s[56:59], s34 offen offset:2048 nt
s_waitcnt vmcnt(35)
v_perm_b32 v72, v47, v47, v16
v_perm_b32 v73, v47, v47, v17
v_perm_b32 v74, v47, v47, v18
v_perm_b32 v75, v47, v47, v19
s_nop 1
v_mfma_f32_16x16x32_bf16 v[20:23], v[72:75], a[156:159], v[20:23]
buffer_load_dwordx4 a[76:79], v2, s[56:59], s34 offen offset:3072 nt
s_waitcnt vmcnt(35)
v_perm_b32 v60, v48, v48, v12
v_perm_b32 v61, v48, v48, v13
v_perm_b32 v62, v48, v48, v14
v_perm_b32 v63, v48, v48, v15
s_nop 1
v_mfma_f32_16x16x32_bf16 v[20:23], v[60:63], a[160:163], v[20:23]
s_add_u32 s34, s14, 147456
s_min_u32 s34, s34, 2146435072
buffer_load_dwordx4 a[80:83], v2, s[56:59], s34 offen offset:0 nt
s_waitcnt vmcnt(35)
v_perm_b32 v64, v48, v48, v16
v_perm_b32 v65, v48, v48, v17
v_perm_b32 v66, v48, v48, v18
v_perm_b32 v67, v48, v48, v19
s_nop 1
v_mfma_f32_16x16x32_bf16 v[20:23], v[64:67], a[164:167], v[20:23]
buffer_load_dwordx4 a[84:87], v2, s[56:59], s34 offen offset:1024 nt
s_waitcnt vmcnt(35)
v_perm_b32 v68, v49, v49, v12
v_perm_b32 v69, v49, v49, v13
v_perm_b32 v70, v49, v49, v14
v_perm_b32 v71, v49, v49, v15
s_nop 1
v_mfma_f32_16x16x32_bf16 v[20:23], v[68:71], a[168:171], v[20:23]
buffer_load_dwordx4 a[88:91], v2, s[56:59], s34 offen offset:2048 nt
s_waitcnt vmcnt(35)
v_perm_b32 v72, v49, v49, v16
v_perm_b32 v73, v49, v49, v17
v_perm_b32 v74, v49, v49, v18
v_perm_b32 v75, v49, v49, v19
s_nop 1
v_mfma_f32_16x16x32_bf16 v[20:23], v[72:75], a[172:175], v[20:23]
buffer_load_dwordx4 a[92:95], v2, s[56:59], s34 offen offset:3072 nt
s_waitcnt vmcnt(35)
v_perm_b32 v60, v50, v50, v12
v_perm_b32 v61, v50, v50, v13
v_perm_b32 v62, v50, v50, v14
v_perm_b32 v63, v50, v50, v15
s_nop 1
v_mfma_f32_16x16x32_bf16 v[20:23], v[60:63], a[176:179], v[20:23]
s_add_u32 s34, s14, 172032
s_min_u32 s34, s34, 2146435072
buffer_load_dwordx4 a[240:243], v2, s[56:59], s34 offen offset:0 nt
s_waitcnt vmcnt(35)
v_perm_b32 v64, v50, v50, v16
v_perm_b32 v65, v50, v50, v17
v_perm_b32 v66, v50, v50, v18
v_perm_b32 v67, v50, v50, v19
s_nop 1
v_mfma_f32_16x16x32_bf16 v[20:23], v[64:67], a[180:183], v[20:23]
buffer_load_dwordx4 a[244:247], v2, s[56:59], s34 offen offset:1024 nt
s_waitcnt vmcnt(35)
v_perm_b32 v68, v51, v51, v12
v_perm_b32 v69, v51, v51, v13
v_perm_b32 v70, v51, v51, v14
v_perm_b32 v71, v51, v51, v15
s_nop 1
v_mfma_f32_16x16x32_bf16 v[20:23], v[68:71], a[184:187], v[20:23]
buffer_load_dwordx4 a[248:251], v2, s[56:59], s34 offen offset:2048 nt
s_waitcnt vmcnt(35)
v_perm_b32 v72, v51, v51, v16
v_perm_b32 v73, v51, v51, v17
v_perm_b32 v74, v51, v51, v18
v_perm_b32 v75, v51, v51, v19
s_nop 1
v_mfma_f32_16x16x32_bf16 v[20:23], v[72:75], a[188:191], v[20:23]
buffer_load_dwordx4 a[252:255], v2, s[56:59], s34 offen offset:3072 nt
s_waitcnt vmcnt(35)
v_perm_b32 v60, v52, v52, v12
v_perm_b32 v61, v52, v52, v13
v_perm_b32 v62, v52, v52, v14
v_perm_b32 v63, v52, v52, v15
s_nop 1
v_mfma_f32_16x16x32_bf16 v[20:23], v[60:63], a[192:195], v[20:23]
s_waitcnt vmcnt(34)
v_perm_b32 v64, v52, v52, v16
v_perm_b32 v65, v52, v52, v17
v_perm_b32 v66, v52, v52, v18
v_perm_b32 v67, v52, v52, v19
s_nop 1
v_mfma_f32_16x16x32_bf16 v[20:23], v[64:67], a[196:199], v[20:23]
s_waitcnt vmcnt(33)
v_perm_b32 v68, v53, v53, v12
v_perm_b32 v69, v53, v53, v13
v_perm_b32 v70, v53, v53, v14
v_perm_b32 v71, v53, v53, v15
s_nop 1
v_mfma_f32_16x16x32_bf16 v[20:23], v[68:71], a[200:203], v[20:23]
s_waitcnt vmcnt(32)
v_perm_b32 v72, v53, v53, v16
v_perm_b32 v73, v53, v53, v17
v_perm_b32 v74, v53, v53, v18
v_perm_b32 v75, v53, v53, v19
s_nop 1
v_mfma_f32_16x16x32_bf16 v[20:23], v[72:75], a[204:207], v[20:23]
s_waitcnt vmcnt(31)
v_perm_b32 v60, v54, v54, v12
v_perm_b32 v61, v54, v54, v13
v_perm_b32 v62, v54, v54, v14
v_perm_b32 v63, v54, v54, v15
s_nop 1
v_mfma_f32_16x16x32_bf16 v[20:23], v[60:63], a[208:211], v[20:23]
s_waitcnt vmcnt(30)
v_perm_b32 v64, v54, v54, v16
v_perm_b32 v65, v54, v54, v17
v_perm_b32 v66, v54, v54, v18
v_perm_b32 v67, v54, v54, v19
s_nop 1
v_mfma_f32_16x16x32_bf16 v[20:23], v[64:67], a[212:215], v[20:23]
s_waitcnt vmcnt(29)
v_perm_b32 v68, v55, v55, v12
v_perm_b32 v69, v55, v55, v13
v_perm_b32 v70, v55, v55, v14
v_perm_b32 v71, v55, v55, v15
s_nop 1
v_mfma_f32_16x16x32_bf16 v[20:23], v[68:71], a[216:219], v[20:23]
s_waitcnt vmcnt(28)
v_perm_b32 v72, v55, v55, v16
v_perm_b32 v73, v55, v55, v17
v_perm_b32 v74, v55, v55, v18
v_perm_b32 v75, v55, v55, v19
s_nop 1
v_mfma_f32_16x16x32_bf16 v[20:23], v[72:75], a[220:223], v[20:23]
s_waitcnt vmcnt(27)
v_perm_b32 v60, v56, v56, v12
v_perm_b32 v61, v56, v56, v13
v_perm_b32 v62, v56, v56, v14
v_perm_b32 v63, v56, v56, v15
s_nop 1
v_mfma_f32_16x16x32_bf16 v[20:23], v[60:63], a[224:227], v[20:23]
s_waitcnt vmcnt(26)
v_perm_b32 v64, v56, v56, v16
v_perm_b32 v65, v56, v56, v17
v_perm_b32 v66, v56, v56, v18
v_perm_b32 v67, v56, v56, v19
s_nop 1
v_mfma_f32_16x16x32_bf16 v[20:23], v[64:67], a[228:231], v[20:23]
s_waitcnt vmcnt(25)
v_perm_b32 v68, v57, v57, v12
v_perm_b32 v69, v57, v57, v13
v_perm_b32 v70, v57, v57, v14
v_perm_b32 v71, v57, v57, v15
s_nop 1
v_mfma_f32_16x16x32_bf16 v[20:23], v[68:71], a[232:235], v[20:23]
s_waitcnt vmcnt(24)
v_perm_b32 v72, v57, v57, v16
v_perm_b32 v73, v57, v57, v17
v_perm_b32 v74, v57, v57, v18
v_perm_b32 v75, v57, v57, v19
s_nop 1
v_mfma_f32_16x16x32_bf16 v[20:23], v[72:75], a[236:239], v[20:23]
s_nop 7
ds_write_b128 v36, v[20:23]
s_waitcnt lgkmcnt(0)
s_barrier
ds_read_b128 v[40:43], v35 offset:0
ds_read_b128 v[44:47], v35 offset:16
ds_read_b128 v[48:51], v35 offset:1024
ds_read_b128 v[52:55], v35 offset:1040
ds_read_b128 v[56:59], v35 offset:2048
ds_read_b128 v[60:63], v35 offset:2064
ds_read_b128 v[64:67], v35 offset:3072
ds_read_b128 v[68:71], v35 offset:3088
v_mov_b32 v20, 0
v_mov_b32 v21, 0
v_mov_b32 v22, 0
v_mov_b32 v23, 0
s_waitcnt lgkmcnt(0)
v_add_f32 v40, v40, v48
v_add_f32 v56, v56, v64
v_add_f32 v41, v41, v49
v_add_f32 v57, v57, v65
v_add_f32 v42, v42, v50
v_add_f32 v58, v58, v66
v_add_f32 v43, v43, v51
v_add_f32 v59, v59, v67
v_add_f32 v44, v44, v52
v_add_f32 v60, v60, v68
v_add_f32 v45, v45, v53
v_add_f32 v61, v61, v69
v_add_f32 v46, v46, v54
v_add_f32 v62, v62, v70
v_add_f32 v47, v47, v55
v_add_f32 v63, v63, v71
v_add_f32 v40, v40, v56
v_add_f32 v41, v41, v57
v_add_f32 v42, v42, v58
v_add_f32 v43, v43, v59
v_add_f32 v44, v44, v60
v_add_f32 v45, v45, v61
v_add_f32 v46, v46, v62
v_add_f32 v47, v47, v63
v_cvt_pk_bf16_f32 v24, v40, v41
v_cvt_pk_bf16_f32 v25, v42, v43
v_cvt_pk_bf16_f32 v26, v44, v45
v_cvt_pk_bf16_f32 v27, v46, v47
s_add_u32 s14, s14, 196608
K_loop:
s_cmp_lg_u32 s81, 8
s_cbranch_scc1 L_c0_4
buffer_load_dword v96, off, s[68:71], 0 offset:0 sc1
L_c0_4:
s_waitcnt vmcnt(28)
v_dot2_f32_bf16 v28, v120, v24, 0
v_dot2_f32_bf16 v29, v124, v24, 0
v_dot2_f32_bf16 v30, v128, v24, 0
v_dot2_f32_bf16 v31, v132, v24, 0
v_dot2_f32_bf16 v28, v121, v25, v28
v_dot2_f32_bf16 v29, v125, v25, v29
v_dot2_f32_bf16 v30, v129, v25, v30
v_dot2_f32_bf16 v31, v133, v25, v31
v_dot2_f32_bf16 v28, v122, v26, v28
v_dot2_f32_bf16 v29, v126, v26, v29
v_dot2_f32_bf16 v30, v130, v26, v30
v_dot2_f32_bf16 v31, v134, v26, v31
v_dot2_f32_bf16 v28, v123, v27, v28
v_dot2_f32_bf16 v29, v127, v27, v29
v_dot2_f32_bf16 v30, v131, v27, v30
v_dot2_f32_bf16 v31, v135, v27, v31
buffer_load_dwordx4 v[120:123], v2, s[52:55], s12 offen offset:0 nt
buffer_load_dwordx4 v[124:127], v2, s[52:55], s12 offen offset:1024 nt
buffer_load_dwordx4 v[128:131], v2, s[52:55], s12 offen offset:2048 nt
buffer_load_dwordx4 v[132:135], v2, s[52:55], s12 offen offset:3072 nt
s_add_u32 s13, s13, 24576
s_min_u32 s12, s13, 2146435072
s_cmp_ge_u32 s80, 36
s_cbranch_scc1 L_nodma_5
s_mov_b32 m0, s15
s_nop 0
buffer_load_dwordx4 v2, s[60:63], s15 offen  lds
s_add_u32 s15, s15, 1024
L_nodma_5:
s_add_u32 s80, s80, 1
v_add_f32_dpp v32, v28, v28 row_ror:8 row_mask:0xf bank_mask:0x3
v_add_f32_dpp v33, v29, v29 row_ror:8 row_mask:0xf bank_mask:0x3
v_add_f32_dpp v32, v30, v30 row_ror:8 row_mask:0xf bank_mask:0xc
v_add_f32_dpp v33, v31, v31 row_ror:8 row_mask:0xf bank_mask:0xc
s_nop 0
v_add_f32_dpp v34, v32, v32 row_half_mirror row_mask:0xf bank_mask:0x5
v_add_f32_dpp v34, v33, v33 row_half_mirror row_mask:0xf bank_mask:0xa
s_nop 1
v_add_f32_dpp v34, v34, v34 quad_perm:[1,0,3,2] row_mask:0xf bank_mask:0xf
s_nop 1
v_add_f32_dpp v34, v34, v34 quad_perm:[2,3,0,1] row_mask:0xf bank_mask:0xf
v_cndmask_b32 v86, v86, v34, s[72:73]
s_waitcnt vmcnt(28)
v_dot2_f32_bf16 v28, v136, v24, 0
v_dot2_f32_bf16 v29, v140, v24, 0
v_dot2_f32_bf16 v30, v144, v24, 0
v_dot2_f32_bf16 v31, v148, v24, 0
v_dot2_f32_bf16 v28, v137, v25, v28
v_dot2_f32_bf16 v29, v141, v25, v29
v_dot2_f32_bf16 v30, v145, v25, v30
v_dot2_f32_bf16 v31, v149, v25, v31
v_dot2_f32_bf16 v28, v138, v26, v28
v_dot2_f32_bf16 v29, v142, v26, v29
v_dot2_f32_bf16 v30, v146, v26, v30
v_dot2_f32_bf16 v31, v150, v26, v31
v_dot2_f32_bf16 v28, v139, v27, v28
v_dot2_f32_bf16 v29, v143, v27, v29
v_dot2_f32_bf16 v30, v147, v27, v30
v_dot2_f32_bf16 v31, v151, v27, v31
buffer_load_dwordx4 v[136:139], v2, s[52:55], s12 offen offset:0 nt
buffer_load_dwordx4 v[140:143], v2, s[52:55], s12 offen offset:1024 nt
buffer_load_dwordx4 v[144:147], v2, s[52:55], s12 offen offset:2048 nt
buffer_load_dwordx4 v[148:151], v2, s[52:55], s12 offen offset:3072 nt
s_add_u32 s13, s13, 24576
s_min_u32 s12, s13, 2146435072
s_cmp_ge_u32 s80, 36
s_cbranch_scc1 L_nodma_6
s_mov_b32 m0, s15
s_nop 0
buffer_load_dwordx4 v2, s[60:63], s15 offen  lds
s_add_u32 s15, s15, 1024
L_nodma_6:
s_add_u32 s80, s80, 1
v_add_f32_dpp v32, v28, v28 row_ror:8 row_mask:0xf bank_mask:0x3
v_add_f32_dpp v33, v29, v29 row_ror:8 row_mask:0xf bank_mask:0x3
v_add_f32_dpp v32, v30, v30 row_ror:8 row_mask:0xf bank_mask:0xc
v_add_f32_dpp v33, v31, v31 row_ror:8 row_mask:0xf bank_mask:0xc
s_nop 0
v_add_f32_dpp v34, v32, v32 row_half_mirror row_mask:0xf bank_mask:0x5
v_add_f32_dpp v34, v33, v33 row_half_mirror row_mask:0xf bank_mask:0xa
s_nop 1
v_add_f32_dpp v34, v34, v34 quad_perm:[1,0,3,2] row_mask:0xf bank_mask:0xf
s_nop 1
v_add_f32_dpp v34, v34, v34 quad_perm:[2,3,0,1] row_mask:0xf bank_mask:0xf
v_cndmask_b32 v86, v86, v34, s[74:75]
s_waitcnt vmcnt(28)
v_dot2_f32_bf16 v28, v152, v24, 0
v_dot2_f32_bf16 v29, v156, v24, 0
v_dot2_f32_bf16 v30, v160, v24, 0
v_dot2_f32_bf16 v31, v164, v24, 0
v_dot2_f32_bf16 v28, v153, v25, v28
v_dot2_f32_bf16 v29, v157, v25, v29
v_dot2_f32_bf16 v30, v161, v25, v30
v_dot2_f32_bf16 v31, v165, v25, v31
v_dot2_f32_bf16 v28, v154, v26, v28
v_dot2_f32_bf16 v29, v158, v26, v29
v_dot2_f32_bf16 v30, v162, v26, v30
v_dot2_f32_bf16 v31, v166, v26, v31
v_dot2_f32_bf16 v28, v155, v27, v28
v_dot2_f32_bf16 v29, v159, v27, v29
v_dot2_f32_bf16 v30, v163, v27, v30
v_dot2_f32_bf16 v31, v167, v27, v31
buffer_load_dwordx4 v[152:155], v2, s[52:55], s12 offen offset:0 nt
buffer_load_dwordx4 v[156:159], v2, s[52:55], s12 offen offset:1024 nt
buffer_load_dwordx4 v[160:163], v2, s[52:55], s12 offen offset:2048 nt
buffer_load_dwordx4 v[164:167], v2, s[52:55], s12 offen offset:3072 nt
s_add_u32 s13, s13, 24576
s_min_u32 s12, s13, 2146435072
s_cmp_ge_u32 s80, 36
s_cbranch_scc1 L_nodma_7
s_mov_b32 m0, s15
s_nop 0
buffer_load_dwordx4 v2, s[60:63], s15 offen  lds
s_add_u32 s15, s15, 1024
L_nodma_7:
s_add_u32 s80, s80, 1
v_add_f32_dpp v32, v28, v28 row_ror:8 row_mask:0xf bank_mask:0x3
v_add_f32_dpp v33, v29, v29 row_ror:8 row_mask:0xf bank_mask:0x3
v_add_f32_dpp v32, v30, v30 row_ror:8 row_mask:0xf bank_mask:0xc
v_add_f32_dpp v33, v31, v31 row_ror:8 row_mask:0xf bank_mask:0xc
s_nop 0
v_add_f32_dpp v34, v32, v32 row_half_mirror row_mask:0xf bank_mask:0x5
v_add_f32_dpp v34, v33, v33 row_half_mirror row_mask:0xf bank_mask:0xa
s_nop 1
v_add_f32_dpp v34, v34, v34 quad_perm:[1,0,3,2] row_mask:0xf bank_mask:0xf
s_nop 1
v_add_f32_dpp v34, v34, v34 quad_perm:[2,3,0,1] row_mask:0xf bank_mask:0xf
v_cndmask_b32 v86, v86, v34, s[76:77]
s_waitcnt vmcnt(28)
v_dot2_f32_bf16 v28, v168, v24, 0
v_dot2_f32_bf16 v29, v172, v24, 0
v_dot2_f32_bf16 v30, v176, v24, 0
v_dot2_f32_bf16 v31, v180, v24, 0
v_dot2_f32_bf16 v28, v169, v25, v28
v_dot2_f32_bf16 v29, v173, v25, v29
v_dot2_f32_bf16 v30, v177, v25, v30
v_dot2_f32_bf16 v31, v181, v25, v31
v_dot2_f32_bf16 v28, v170, v26, v28
v_dot2_f32_bf16 v29, v174, v26, v29
v_dot2_f32_bf16 v30, v178, v26, v30
v_dot2_f32_bf16 v31, v182, v26, v31
v_dot2_f32_bf16 v28, v171, v27, v28
v_dot2_f32_bf16 v29, v175, v27, v29
v_dot2_f32_bf16 v30, v179, v27, v30
v_dot2_f32_bf16 v31, v183, v27, v31
buffer_load_dwordx4 v[168:171], v2, s[52:55], s12 offen offset:0 nt
buffer_load_dwordx4 v[172:175], v2, s[52:55], s12 offen offset:1024 nt
buffer_load_dwordx4 v[176:179], v2, s[52:55], s12 offen offset:2048 nt
buffer_load_dwordx4 v[180:183], v2, s[52:55], s12 offen offset:3072 nt
s_add_u32 s13, s13, 24576
s_min_u32 s12, s13, 2146435072
s_cmp_ge_u32 s80, 36
s_cbranch_scc1 L_nodma_8
s_mov_b32 m0, s15
s_nop 0
buffer_load_dwordx4 v2, s[60:63], s15 offen  lds
s_add_u32 s15, s15, 1024
L_nodma_8:
s_add_u32 s80, s80, 1
v_add_f32_dpp v32, v28, v28 row_ror:8 row_mask:0xf bank_mask:0x3
v_add_f32_dpp v33, v29, v29 row_ror:8 row_mask:0xf bank_mask:0x3
v_add_f32_dpp v32, v30, v30 row_ror:8 row_mask:0xf bank_mask:0xc
v_add_f32_dpp v33, v31, v31 row_ror:8 row_mask:0xf bank_mask:0xc
s_nop 0
v_add_f32_dpp v34, v32, v32 row_half_mirror row_mask:0xf bank_mask:0x5
v_add_f32_dpp v34, v33, v33 row_half_mirror row_mask:0xf bank_mask:0xa
s_nop 1
v_add_f32_dpp v34, v34, v34 quad_perm:[1,0,3,2] row_mask:0xf bank_mask:0xf
s_nop 1
v_add_f32_dpp v34, v34, v34 quad_perm:[2,3,0,1] row_mask:0xf bank_mask:0xf
v_cndmask_b32 v86, v86, v34, s[78:79]
s_add_u32 s81, s81, 1
s_cmp_eq_u32 s81, 11
s_cbranch_scc1 A_mid
v_mov_b32 v76, v77
v_mov_b32 v77, v78
v_mov_b32 v78, v79
v_mov_b32 v79, v80
v_mov_b32 v80, v81
v_mov_b32 v81, v82
v_mov_b32 v82, v83
v_mov_b32 v83, v84
v_mov_b32 v84, v85
v_mov_b32 v85, v86
s_lshr_b64 s[72:73], s[76:77], 2
s_lshr_b64 s[74:75], s[76:77], 1
s_cmp_eq_u32 s81, 9
s_cselect_b32 s52, s56, s52
s_cselect_b32 s53, s57, s53
s_cselect_b32 s13, s14, s13
s_min_u32 s12, s13, 2146435072
s_waitcnt vmcnt(28)
v_dot2_f32_bf16 v28, v184, v24, 0
v_dot2_f32_bf16 v29, v188, v24, 0
v_dot2_f32_bf16 v30, v192, v24, 0
v_dot2_f32_bf16 v31, v196, v24, 0
v_dot2_f32_bf16 v28, v185, v25, v28
v_dot2_f32_bf16 v29, v189, v25, v29
v_dot2_f32_bf16 v30, v193, v25, v30
v_dot2_f32_bf16 v31, v197, v25, v31
v_dot2_f32_bf16 v28, v186, v26, v28
v_dot2_f32_bf16 v29, v190, v26, v29
v_dot2_f32_bf16 v30, v194, v26, v30
v_dot2_f32_bf16 v31, v198, v26, v31
v_dot2_f32_bf16 v28, v187, v27, v28
v_dot2_f32_bf16 v29, v191, v27, v29
v_dot2_f32_bf16 v30, v195, v27, v30
v_dot2_f32_bf16 v31, v199, v27, v31
buffer_load_dwordx4 v[184:187], v2, s[52:55], s12 offen offset:0 nt
buffer_load_dwordx4 v[188:191], v2, s[52:55], s12 offen offset:1024 nt
buffer_load_dwordx4 v[192:195], v2, s[52:55], s12 offen offset:2048 nt
buffer_load_dwordx4 v[196:199], v2, s[52:55], s12 offen offset:3072 nt
s_add_u32 s13, s13, 24576
s_min_u32 s12, s13, 2146435072
s_cmp_ge_u32 s80, 36
s_cbranch_scc1 L_nodma_9
s_mov_b32 m0, s15
s_nop 0
buffer_load_dwordx4 v2, s[60:63], s15 offen  lds
s_add_u32 s15, s15, 1024
L_nodma_9:
s_add_u32 s80, s80, 1
v_add_f32_dpp v32, v28, v28 row_ror:8 row_mask:0xf bank_mask:0x3
v_add_f32_dpp v33, v29, v29 row_ror:8 row_mask:0xf bank_mask:0x3
v_add_f32_dpp v32, v30, v30 row_ror:8 row_mask:0xf bank_mask:0xc
v_add_f32_dpp v33, v31, v31 row_ror:8 row_mask:0xf bank_mask:0xc
s_nop 0
v_add_f32_dpp v34, v32, v32 row_half_mirror row_mask:0xf bank_mask:0x5
v_add_f32_dpp v34, v33, v33 row_half_mirror row_mask:0xf bank_mask:0xa
s_nop 1
v_add_f32_dpp v34, v34, v34 quad_perm:[1,0,3,2] row_mask:0xf bank_mask:0xf
s_nop 1
v_add_f32_dpp v34, v34, v34 quad_perm:[2,3,0,1] row_mask:0xf bank_mask:0xf
v_cndmask_b32 v86, v86, v34, s[72:73]
s_waitcnt vmcnt(28)
v_dot2_f32_bf16 v28, v200, v24, 0
v_dot2_f32_bf16 v29, v204, v24, 0
v_dot2_f32_bf16 v30, v208, v24, 0
v_dot2_f32_bf16 v31, v212, v24, 0
v_dot2_f32_bf16 v28, v201, v25, v28
v_dot2_f32_bf16 v29, v205, v25, v29
v_dot2_f32_bf16 v30, v209, v25, v30
v_dot2_f32_bf16 v31, v213, v25, v31
v_dot2_f32_bf16 v28, v202, v26, v28
v_dot2_f32_bf16 v29, v206, v26, v29
v_dot2_f32_bf16 v30, v210, v26, v30
v_dot2_f32_bf16 v31, v214, v26, v31
v_dot2_f32_bf16 v28, v203, v27, v28
v_dot2_f32_bf16 v29, v207, v27, v29
v_dot2_f32_bf16 v30, v211, v27, v30
v_dot2_f32_bf16 v31, v215, v27, v31
buffer_load_dwordx4 v[200:203], v2, s[52:55], s12 offen offset:0 nt
buffer_load_dwordx4 v[204:207], v2, s[52:55], s12 offen offset:1024 nt
buffer_load_dwordx4 v[208:211], v2, s[52:55], s12 offen offset:2048 nt
buffer_load_dwordx4 v[212:215], v2, s[52:55], s12 offen offset:3072 nt
s_add_u32 s13, s13, 24576
s_min_u32 s12, s13, 2146435072
s_cmp_ge_u32 s80, 36
s_cbranch_scc1 L_nodma_10
s_mov_b32 m0, s15
s_nop 0
buffer_load_dwordx4 v2, s[60:63], s15 offen  lds
s_add_u32 s15, s15, 1024
L_nodma_10:
s_add_u32 s80, s80, 1
v_add_f32_dpp v32, v28, v28 row_ror:8 row_mask:0xf bank_mask:0x3
v_add_f32_dpp v33, v29, v29 row_ror:8 row_mask:0xf bank_mask:0x3
v_add_f32_dpp v32, v30, v30 row_ror:8 row_mask:0xf bank_mask:0xc
v_add_f32_dpp v33, v31, v31 row_ror:8 row_mask:0xf bank_mask:0xc
s_nop 0
v_add_f32_dpp v34, v32, v32 row_half_mirror row_mask:0xf bank_mask:0x5
v_add_f32_dpp v34, v33, v33 row_half_mirror row_mask:0xf bank_mask:0xa
s_nop 1
v_add_f32_dpp v34, v34, v34 quad_perm:[1,0,3,2] row_mask:0xf bank_mask:0xf
s_nop 1
v_add_f32_dpp v34, v34, v34 quad_perm:[2,3,0,1] row_mask:0xf bank_mask:0xf
v_cndmask_b32 v86, v86, v34, s[74:75]
s_waitcnt vmcnt(28)
v_dot2_f32_bf16 v28, v216, v24, 0
v_dot2_f32_bf16 v29, v220, v24, 0
v_dot2_f32_bf16 v30, v224, v24, 0
v_dot2_f32_bf16 v31, v228, v24, 0
v_dot2_f32_bf16 v28, v217, v25, v28
v_dot2_f32_bf16 v29, v221, v25, v29
v_dot2_f32_bf16 v30, v225, v25, v30
v_dot2_f32_bf16 v31, v229, v25, v31
v_dot2_f32_bf16 v28, v218, v26, v28
v_dot2_f32_bf16 v29, v222, v26, v29
v_dot2_f32_bf16 v30, v226, v26, v30
v_dot2_f32_bf16 v31, v230, v26, v31
v_dot2_f32_bf16 v28, v219, v27, v28
v_dot2_f32_bf16 v29, v223, v27, v29
v_dot2_f32_bf16 v30, v227, v27, v30
v_dot2_f32_bf16 v31, v231, v27, v31
buffer_load_dwordx4 v[216:219], v2, s[52:55], s12 offen offset:0 nt
buffer_load_dwordx4 v[220:223], v2, s[52:55], s12 offen offset:1024 nt
buffer_load_dwordx4 v[224:227], v2, s[52:55], s12 offen offset:2048 nt
buffer_load_dwordx4 v[228:231], v2, s[52:55], s12 offen offset:3072 nt
s_add_u32 s13, s13, 24576
s_min_u32 s12, s13, 2146435072
s_cmp_ge_u32 s80, 36
s_cbranch_scc1 L_nodma_11
s_mov_b32 m0, s15
s_nop 0
buffer_load_dwordx4 v2, s[60:63], s15 offen  lds
s_add_u32 s15, s15, 1024
L_nodma_11:
s_add_u32 s80, s80, 1
v_add_f32_dpp v32, v28, v28 row_ror:8 row_mask:0xf bank_mask:0x3
v_add_f32_dpp v33, v29, v29 row_ror:8 row_mask:0xf bank_mask:0x3
v_add_f32_dpp v32, v30, v30 row_ror:8 row_mask:0xf bank_mask:0xc
v_add_f32_dpp v33, v31, v31 row_ror:8 row_mask:0xf bank_mask:0xc
s_nop 0
v_add_f32_dpp v34, v32, v32 row_half_mirror row_mask:0xf bank_mask:0x5
v_add_f32_dpp v34, v33, v33 row_half_mirror row_mask:0xf bank_mask:0xa
s_nop 1
v_add_f32_dpp v34, v34, v34 quad_perm:[1,0,3,2] row_mask:0xf bank_mask:0xf
s_nop 1
v_add_f32_dpp v34, v34, v34 quad_perm:[2,3,0,1] row_mask:0xf bank_mask:0xf
v_cndmask_b32 v86, v86, v34, s[76:77]
s_waitcnt vmcnt(28)
v_dot2_f32_bf16 v28, v232, v24, 0
v_dot2_f32_bf16 v29, v236, v24, 0
v_dot2_f32_bf16 v30, v240, v24, 0
v_dot2_f32_bf16 v31, v244, v24, 0
v_dot2_f32_bf16 v28, v233, v25, v28
v_dot2_f32_bf16 v29, v237, v25, v29
v_dot2_f32_bf16 v30, v241, v25, v30
v_dot2_f32_bf16 v31, v245, v25, v31
v_dot2_f32_bf16 v28, v234, v26, v28
v_dot2_f32_bf16 v29, v238, v26, v29
v_dot2_f32_bf16 v30, v242, v26, v30
v_dot2_f32_bf16 v31, v246, v26, v31
v_dot2_f32_bf16 v28, v235, v27, v28
v_dot2_f32_bf16 v29, v239, v27, v29
v_dot2_f32_bf16 v30, v243, v27, v30
v_dot2_f32_bf16 v31, v247, v27, v31
buffer_load_dwordx4 v[232:235], v2, s[52:55], s12 offen offset:0 nt
buffer_load_dwordx4 v[236:239], v2, s[52:55], s12 offen offset:1024 nt
buffer_load_dwordx4 v[240:243], v2, s[52:55], s12 offen offset:2048 nt
buffer_load_dwordx4 v[244:247], v2, s[52:55], s12 offen offset:3072 nt
s_add_u32 s13, s13, 24576
s_min_u32 s12, s13, 2146435072
s_cmp_ge_u32 s80, 36
s_cbranch_scc1 L_nodma_12
s_mov_b32 m0, s15
s_nop 0
buffer_load_dwordx4 v2, s[60:63], s15 offen  lds
s_add_u32 s15, s15, 1024
L_nodma_12:
s_add_u32 s80, s80, 1
v_add_f32_dpp v32, v28, v28 row_ror:8 row_mask:0xf bank_mask:0x3
v_add_f32_dpp v33, v29, v29 row_ror:8 row_mask:0xf bank_mask:0x3
v_add_f32_dpp v32, v30, v30 row_ror:8 row_mask:0xf bank_mask:0xc
v_add_f32_dpp v33, v31, v31 row_ror:8 row_mask:0xf bank_mask:0xc
s_nop 0
v_add_f32_dpp v34, v32, v32 row_half_mirror row_mask:0xf bank_mask:0x5
v_add_f32_dpp v34, v33, v33 row_half_mirror row_mask:0xf bank_mask:0xa
s_nop 1
v_add_f32_dpp v34, v34, v34 quad_perm:[1,0,3,2] row_mask:0xf bank_mask:0xf
s_nop 1
v_add_f32_dpp v34, v34, v34 quad_perm:[2,3,0,1] row_mask:0xf bank_mask:0xf
v_cndmask_b32 v86, v86, v34, s[78:79]
s_add_u32 s81, s81, 1
v_mov_b32 v76, v77
v_mov_b32 v77, v78
v_mov_b32 v78, v79
v_mov_b32 v79, v80
v_mov_b32 v80, v81
v_mov_b32 v81, v82
v_mov_b32 v82, v83
v_mov_b32 v83, v84
v_mov_b32 v84, v85
v_mov_b32 v85, v86
s_branch K_loop
A_mid:
v_max3_f32 v35, v76, v77, v78
v_max3_f32 v35, v35, v79, v80
v_max3_f32 v35, v35, v81, v82
v_max3_f32 v35, v35, v83, v84
v_max3_f32 v35, v35, v85, v86
s_nop 1
v_max_f32_dpp v35, v35, v35 row_ror:8 row_mask:0xf bank_mask:0xf
s_nop 1
v_max_f32_dpp v35, v35, v35 row_ror:4 row_mask:0xf bank_mask:0xf
s_nop 1
v_max_f32_dpp v35, v35, v35 row_ror:2 row_mask:0xf bank_mask:0xf
s_nop 1
v_max_f32_dpp v35, v35, v35 row_ror:1 row_mask:0xf bank_mask:0xf
v_mov_b32 v36, v35
s_nop 1
v_permlane16_swap_b32 v35, v36
v_max_f32 v35, v35, v36
v_mov_b32 v36, v35
s_nop 1
v_permlane32_swap_b32 v35, v36
v_max_f32 v35, v35, v36
v_mul_f32 v32, v35, v7
v_fma_f32 v76, v76, v7, -v32
v_fma_f32 v77, v77, v7, -v32
v_fma_f32 v78, v78, v7, -v32
v_fma_f32 v79, v79, v7, -v32
v_fma_f32 v80, v80, v7, -v32
v_fma_f32 v81, v81, v7, -v32
v_fma_f32 v82, v82, v7, -v32
v_fma_f32 v83, v83, v7, -v32
v_fma_f32 v84, v84, v7, -v32
v_fma_f32 v85, v85, v7, -v32
v_fma_f32 v86, v86, v7, -v32
v_exp_f32 v76, v76
v_exp_f32 v77, v77
v_exp_f32 v78, v78
v_exp_f32 v79, v79
v_exp_f32 v80, v80
v_exp_f32 v81, v81
v_exp_f32 v82, v82
v_exp_f32 v83, v83
v_exp_f32 v84, v84
v_exp_f32 v85, v85
v_exp_f32 v86, v86
v_add_f32 v35, v76, v77
v_add_f32 v35, v35, v78
v_add_f32 v35, v35, v79
v_add_f32 v35, v35, v80
v_add_f32 v35, v35, v81
v_add_f32 v35, v35, v82
v_add_f32 v35, v35, v83
v_add_f32 v35, v35, v84
v_add_f32 v35, v35, v85
v_add_f32 v35, v35, v86
v_cvt_pk_bf16_f32 v76, v76, v76
v_cvt_pk_bf16_f32 v77, v77, v77
v_cvt_pk_bf16_f32 v78, v78, v78
v_cvt_pk_bf16_f32 v79, v79, v79
v_cvt_pk_bf16_f32 v80, v80, v80
v_cvt_pk_bf16_f32 v81, v81, v81
v_cvt_pk_bf16_f32 v82, v82, v82
v_cvt_pk_bf16_f32 v83, v83, v83
v_cvt_pk_bf16_f32 v84, v84, v84
v_cvt_pk_bf16_f32 v85, v85, v85
v_cvt_pk_bf16_f32 v86, v86, v86
v_add_f32_dpp v35, v35, v35 row_ror:8 row_mask:0xf bank_mask:0xf
s_nop 1
v_add_f32_dpp v35, v35, v35 row_ror:4 row_mask:0xf bank_mask:0xf
s_nop 1
v_add_f32_dpp v35, v35, v35 row_ror:2 row_mask:0xf bank_mask:0xf
s_nop 1
v_add_f32_dpp v35, v35, v35 row_ror:1 row_mask:0xf bank_mask:0xf
v_mov_b32 v36, v35
s_nop 1
v_permlane16_swap_b32 v35, v36
v_add_f32 v35, v35, v36
v_mov_b32 v36, v35
s_nop 1
v_permlane32_swap_b32 v35, v36
v_add_f32 v35, v35, v36
v_min_u32 v32, -2, v32
v_min_u32 v33, -2, v35
s_mov_b32 s7, 400000
L_ens_13:
v_readfirstlane_b32 s6, v96
s_cmp_ge_u32 s6, 32
s_cbranch_scc1 L_ensd_14
s_sleep 16
buffer_load_dword v96, off, s[68:71], 0 offset:0 sc1
s_waitcnt vmcnt(0)
s_sub_u32 s7, s7, 1
s_cmp_lg_u32 s7, 0
s_cbranch_scc1 L_ens_13
L_ensd_14:
s_lshl_b32 s6, s11, 3
s_add_u32 s6, s6, s82
s_mov_b64 exec, 1
buffer_store_dwordx2 v[32:33], off, s[64:67], s6 sc1
s_mov_b64 exec, -1
s_mov_b32 s6, 0x63206320
s_mov_b32 s7, 0x63206320
s_and_b32 s15, s2, 7
s_lshl_b32 s15, s15, 3
s_lshr_b64 s[6:7], s[6:7], s15
s_and_b32 s15, s6, 255
v_and_b32_dpp v60, v78, v8 row_newbcast:0 row_mask:0xf bank_mask:0xf
v_and_b32_dpp v61, v78, v9 row_newbcast:0 row_mask:0xf bank_mask:0xf
v_and_b32_dpp v62, v78, v10 row_newbcast:0 row_mask:0xf bank_mask:0xf
v_and_b32_dpp v63, v78, v11 row_newbcast:0 row_mask:0xf bank_mask:0xf
v_and_b32_dpp v64, v78, v8 row_newbcast:4 row_mask:0xf bank_mask:0xf
v_and_b32_dpp v65, v78, v9 row_newbcast:4 row_mask:0xf bank_mask:0xf
v_and_b32_dpp v66, v78, v10 row_newbcast:4 row_mask:0xf bank_mask:0xf
v_and_b32_dpp v67, v78, v11 row_newbcast:4 row_mask:0xf bank_mask:0xf
v_and_b32_dpp v68, v78, v8 row_newbcast:8 row_mask:0xf bank_mask:0xf
v_and_b32_dpp v69, v78, v9 row_newbcast:8 row_mask:0xf bank_mask:0xf
v_and_b32_dpp v70, v78, v10 row_newbcast:8 row_mask:0xf bank_mask:0xf
v_and_b32_dpp v71, v78, v11 row_newbcast:8 row_mask:0xf bank_mask:0xf
v_and_b32_dpp v72, v78, v8 row_newbcast:12 row_mask:0xf bank_mask:0xf
v_and_b32_dpp v73, v78, v9 row_newbcast:12 row_mask:0xf bank_mask:0xf
v_and_b32_dpp v74, v78, v10 row_newbcast:12 row_mask:0xf bank_mask:0xf
v_and_b32_dpp v75, v78, v11 row_newbcast:12 row_mask:0xf bank_mask:0xf
s_waitcnt vmcnt(29)
v_mfma_f32_16x16x32_bf16 v[20:23], v[60:63], v[184:187], v[20:23]
v_mfma_f32_16x16x32_bf16 v[20:23], v[64:67], v[188:191], v[20:23]
v_mfma_f32_16x16x32_bf16 v[20:23], v[68:71], v[192:195], v[20:23]
v_mfma_f32_16x16x32_bf16 v[20:23], v[72:75], v[196:199], v[20:23]
v_add_u32 v117, 1, v117
buffer_store_dword v117, v118, s[64:67], 0 offen
buffer_load_dwordx4 v[184:187], v2, s[52:55], s12 offen offset:0 nt
buffer_load_dwordx4 v[188:191], v2, s[52:55], s12 offen offset:1024 nt
buffer_load_dwordx4 v[192:195], v2, s[52:55], s12 offen offset:2048 nt
buffer_load_dwordx4 v[196:199], v2, s[52:55], s12 offen offset:3072 nt
s_add_u32 s13, s13, 24576
s_min_u32 s12, s13, 2146435072
v_and_b32_dpp v60, v78, v8 row_newbcast:1 row_mask:0xf bank_mask:0xf
v_and_b32_dpp v61, v78, v9 row_newbcast:1 row_mask:0xf bank_mask:0xf
v_and_b32_dpp v62, v78, v10 row_newbcast:1 row_mask:0xf bank_mask:0xf
v_and_b32_dpp v63, v78, v11 row_newbcast:1 row_mask:0xf bank_mask:0xf
v_and_b32_dpp v64, v78, v8 row_newbcast:5 row_mask:0xf bank_mask:0xf
v_and_b32_dpp v65, v78, v9 row_newbcast:5 row_mask:0xf bank_mask:0xf
v_and_b32_dpp v66, v78, v10 row_newbcast:5 row_mask:0xf bank_mask:0xf
v_and_b32_dpp v67, v78, v11 row_newbcast:5 row_mask:0xf bank_mask:0xf
v_and_b32_dpp v68, v78, v8 row_newbcast:9 row_mask:0xf bank_mask:0xf
v_and_b32_dpp v69, v78, v9 row_newbcast:9 row_mask:0xf bank_mask:0xf
v_and_b32_dpp v70, v78, v10 row_newbcast:9 row_mask:0xf bank_mask:0xf
v_and_b32_dpp v71, v78, v11 row_newbcast:9 row_mask:0xf bank_mask:0xf
v_and_b32_dpp v72, v78, v8 row_newbcast:13 row_mask:0xf bank_mask:0xf
v_and_b32_dpp v73, v78, v9 row_newbcast:13 row_mask:0xf bank_mask:0xf
v_and_b32_dpp v74, v78, v10 row_newbcast:13 row_mask:0xf bank_mask:0xf
v_and_b32_dpp v75, v78, v11 row_newbcast:13 row_mask:0xf bank_mask:0xf
s_waitcnt vmcnt(30)
v_mfma_f32_16x16x32_bf16 v[20:23], v[60:63], v[200:203], v[20:23]
v_mfma_f32_16x16x32_bf16 v[20:23], v[64:67], v[204:207], v[20:23]
v_mfma_f32_16x16x32_bf16 v[20:23], v[68:71], v[208:211], v[20:23]
v_mfma_f32_16x16x32_bf16 v[20:23], v[72:75], v[212:215], v[20:23]
v_add_u32 v117, 1, v117
buffer_store_dword v117, v118, s[64:67], 0 offen
buffer_load_dwordx4 v[200:203], v2, s[52:55], s12 offen offset:0 nt
buffer_load_dwordx4 v[204:207], v2, s[52:55], s12 offen offset:1024 nt
buffer_load_dwordx4 v[208:211], v2, s[52:55], s12 offen offset:2048 nt
buffer_load_dwordx4 v[212:215], v2, s[52:55], s12 offen offset:3072 nt
s_add_u32 s13, s13, 24576
s_min_u32 s12, s13, 2146435072
v_and_b32_dpp v60, v76, v8 row_newbcast:1 row_mask:0xf bank_mask:0xf
v_and_b32_dpp v61, v76, v9 row_newbcast:1 row_mask:0xf bank_mask:0xf
v_and_b32_dpp v62, v76, v10 row_newbcast:1 row_mask:0xf bank_mask:0xf
v_and_b32_dpp v63, v76, v11 row_newbcast:1 row_mask:0xf bank_mask:0xf
v_and_b32_dpp v64, v76, v8 row_newbcast:5 row_mask:0xf bank_mask:0xf
v_and_b32_dpp v65, v76, v9 row_newbcast:5 row_mask:0xf bank_mask:0xf
v_and_b32_dpp v66, v76, v10 row_newbcast:5 row_mask:0xf bank_mask:0xf
v_and_b32_dpp v67, v76, v11 row_newbcast:5 row_mask:0xf bank_mask:0xf
v_and_b32_dpp v68, v76, v8 row_newbcast:9 row_mask:0xf bank_mask:0xf
v_and_b32_dpp v69, v76, v9 row_newbcast:9 row_mask:0xf bank_mask:0xf
v_and_b32_dpp v70, v76, v10 row_newbcast:9 row_mask:0xf bank_mask:0xf
v_and_b32_dpp v71, v76, v11 row_newbcast:9 row_mask:0xf bank_mask:0xf
v_and_b32_dpp v72, v76, v8 row_newbcast:13 row_mask:0xf bank_mask:0xf
v_and_b32_dpp v73, v76, v9 row_newbcast:13 row_mask:0xf bank_mask:0xf
v_and_b32_dpp v74, v76, v10 row_newbcast:13 row_mask:0xf bank_mask:0xf
v_and_b32_dpp v75, v76, v11 row_newbcast:13 row_mask:0xf bank_mask:0xf
v_mfma_f32_16x16x32_bf16 v[20:23], v[60:63], a[0:3], v[20:23]
v_mfma_f32_16x16x32_bf16 v[20:23], v[64:67], a[4:7], v[20:23]
v_mfma_f32_16x16x32_bf16 v[20:23], v[68:71], a[8:11], v[20:23]
v_mfma_f32_16x16x32_bf16 v[20:23], v[72:75], a[12:15], v[20:23]
s_nop 3
v_and_b32_dpp v60, v78, v8 row_newbcast:2 row_mask:0xf bank_mask:0xf
v_and_b32_dpp v61, v78, v9 row_newbcast:2 row_mask:0xf bank_mask:0xf
v_and_b32_dpp v62, v78, v10 row_newbcast:2 row_mask:0xf bank_mask:0xf
v_and_b32_dpp v63, v78, v11 row_newbcast:2 row_mask:0xf bank_mask:0xf
v_and_b32_dpp v64, v78, v8 row_newbcast:6 row_mask:0xf bank_mask:0xf
v_and_b32_dpp v65, v78, v9 row_newbcast:6 row_mask:0xf bank_mask:0xf
v_and_b32_dpp v66, v78, v10 row_newbcast:6 row_mask:0xf bank_mask:0xf
v_and_b32_dpp v67, v78, v11 row_newbcast:6 row_mask:0xf bank_mask:0xf
v_and_b32_dpp v68, v78, v8 row_newbcast:10 row_mask:0xf bank_mask:0xf
v_and_b32_dpp v69, v78, v9 row_newbcast:10 row_mask:0xf bank_mask:0xf
v_and_b32_dpp v70, v78, v10 row_newbcast:10 row_mask:0xf bank_mask:0xf
v_and_b32_dpp v71, v78, v11 row_newbcast:10 row_mask:0xf bank_mask:0xf
v_and_b32_dpp v72, v78, v8 row_newbcast:14 row_mask:0xf bank_mask:0xf
v_and_b32_dpp v73, v78, v9 row_newbcast:14 row_mask:0xf bank_mask:0xf
v_and_b32_dpp v74, v78, v10 row_newbcast:14 row_mask:0xf bank_mask:0xf
v_and_b32_dpp v75, v78, v11 row_newbcast:14 row_mask:0xf bank_mask:0xf
s_waitcnt vmcnt(31)
v_mfma_f32_16x16x32_bf16 v[20:23], v[60:63], v[216:219], v[20:23]
v_mfma_f32_16x16x32_bf16 v[20:23], v[64:67], v[220:223], v[20:23]
v_mfma_f32_16x16x32_bf16 v[20:23], v[68:71], v[224:227], v[20:23]
v_mfma_f32_16x16x32_bf16 v[20:23], v[72:75], v[228:231], v[20:23]
v_add_u32 v117, 1, v117
buffer_store_dword v117, v118, s[64:67], 0 offen
buffer_load_dwordx4 v[216:219], v2, s[52:55], s12 offen offset:0 nt
buffer_load_dwordx4 v[220:223], v2, s[52:55], s12 offen offset:1024 nt
buffer_load_dwordx4 v[224:227], v2, s[52:55], s12 offen offset:2048 nt
buffer_load_dwordx4 v[228:231], v2, s[52:55], s12 offen offset:3072 nt
s_add_u32 s13, s13, 24576
s_min_u32 s12, s13, 2146435072
v_and_b32_dpp v60, v78, v8 row_newbcast:3 row_mask:0xf bank_mask:0xf
v_and_b32_dpp v61, v78, v9 row_newbcast:3 row_mask:0xf bank_mask:0xf
v_and_b32_dpp v62, v78, v10 row_newbcast:3 row_mask:0xf bank_mask:0xf
v_and_b32_dpp v63, v78, v11 row_newbcast:3 row_mask:0xf bank_mask:0xf
v_and_b32_dpp v64, v78, v8 row_newbcast:7 row_mask:0xf bank_mask:0xf
v_and_b32_dpp v65, v78, v9 row_newbcast:7 row_mask:0xf bank_mask:0xf
v_and_b32_dpp v66, v78, v10 row_newbcast:7 row_mask:0xf bank_mask:0xf
v_and_b32_dpp v67, v78, v11 row_newbcast:7 row_mask:0xf bank_mask:0xf
v_and_b32_dpp v68, v78, v8 row_newbcast:11 row_mask:0xf bank_mask:0xf
v_and_b32_dpp v69, v78, v9 row_newbcast:11 row_mask:0xf bank_mask:0xf
v_and_b32_dpp v70, v78, v10 row_newbcast:11 row_mask:0xf bank_mask:0xf
v_and_b32_dpp v71, v78, v11 row_newbcast:11 row_mask:0xf bank_mask:0xf
v_and_b32_dpp v72, v78, v8 row_newbcast:15 row_mask:0xf bank_mask:0xf
v_and_b32_dpp v73, v78, v9 row_newbcast:15 row_mask:0xf bank_mask:0xf
v_and_b32_dpp v74, v78, v10 row_newbcast:15 row_mask:0xf bank_mask:0xf
v_and_b32_dpp v75, v78, v11 row_newbcast:15 row_mask:0xf bank_mask:0xf
s_waitcnt vmcnt(32)
v_mfma_f32_16x16x32_bf16 v[20:23], v[60:63], v[232:235], v[20:23]
v_mfma_f32_16x16x32_bf16 v[20:23], v[64:67], v[236:239], v[20:23]
v_mfma_f32_16x16x32_bf16 v[20:23], v[68:71], v[240:243], v[20:23]
v_mfma_f32_16x16x32_bf16 v[20:23], v[72:75], v[244:247], v[20:23]
v_add_u32 v117, 1, v117
buffer_store_dword v117, v118, s[64:67], 0 offen
buffer_load_dwordx4 v[232:235], v2, s[52:55], s12 offen offset:0 nt
buffer_load_dwordx4 v[236:239], v2, s[52:55], s12 offen offset:1024 nt
buffer_load_dwordx4 v[240:243], v2, s[52:55], s12 offen offset:2048 nt
buffer_load_dwordx4 v[244:247], v2, s[52:55], s12 offen offset:3072 nt
s_add_u32 s13, s13, 24576
s_min_u32 s12, s13, 2146435072
s_barrier
ds_read_b64_tr_b16 a[96:97], v88 offset:0
ds_read_b64_tr_b16 a[98:99], v88 offset:2304
ds_read_b64_tr_b16 a[100:101], v88 offset:18432
ds_read_b64_tr_b16 a[102:103], v88 offset:20736
v_and_b32_dpp v60, v79, v8 row_newbcast:0 row_mask:0xf bank_mask:0xf
v_and_b32_dpp v61, v79, v9 row_newbcast:0 row_mask:0xf bank_mask:0xf
v_and_b32_dpp v62, v79, v10 row_newbcast:0 row_mask:0xf bank_mask:0xf
v_and_b32_dpp v63, v79, v11 row_newbcast:0 row_mask:0xf bank_mask:0xf
v_and_b32_dpp v64, v79, v8 row_newbcast:4 row_mask:0xf bank_mask:0xf
v_and_b32_dpp v65, v79, v9 row_newbcast:4 row_mask:0xf bank_mask:0xf
v_and_b32_dpp v66, v79, v10 row_newbcast:4 row_mask:0xf bank_mask:0xf
v_and_b32_dpp v67, v79, v11 row_newbcast:4 row_mask:0xf bank_mask:0xf
v_and_b32_dpp v68, v79, v8 row_newbcast:8 row_mask:0xf bank_mask:0xf
v_and_b32_dpp v69, v79, v9 row_newbcast:8 row_mask:0xf bank_mask:0xf
v_and_b32_dpp v70, v79, v10 row_newbcast:8 row_mask:0xf bank_mask:0xf
v_and_b32_dpp v71, v79, v11 row_newbcast:8 row_mask:0xf bank_mask:0xf
v_and_b32_dpp v72, v79, v8 row_newbcast:12 row_mask:0xf bank_mask:0xf
v_and_b32_dpp v73, v79, v9 row_newbcast:12 row_mask:0xf bank_mask:0xf
v_and_b32_dpp v74, v79, v10 row_newbcast:12 row_mask:0xf bank_mask:0xf
v_and_b32_dpp v75, v79, v11 row_newbcast:12 row_mask:0xf bank_mask:0xf
s_waitcnt vmcnt(33)
v_mfma_f32_16x16x32_bf16 v[20:23], v[60:63], v[120:123], v[20:23]
v_mfma_f32_16x16x32_bf16 v[20:23], v[64:67], v[124:127], v[20:23]
v_mfma_f32_16x16x32_bf16 v[20:23], v[68:71], v[128:131], v[20:23]
v_mfma_f32_16x16x32_bf16 v[20:23], v[72:75], v[132:135], v[20:23]
v_add_u32 v117, 1, v117
buffer_store_dword v117, v118, s[64:67], 0 offen
buffer_load_dwordx4 v[120:123], v2, s[52:55], s12 offen offset:0 nt
buffer_load_dwordx4 v[124:127], v2, s[52:55], s12 offen offset:1024 nt
buffer_load_dwordx4 v[128:131], v2, s[52:55], s12 offen offset:2048 nt
buffer_load_dwordx4 v[132:135], v2, s[52:55], s12 offen offset:3072 nt
s_add_u32 s13, s13, 24576
s_min_u32 s12, s13, 2146435072
ds_read_b64_tr_b16 a[104:105], v88 offset:36864
ds_read_b64_tr_b16 a[106:107], v88 offset:39168
ds_read_b64_tr_b16 a[108:109], v88 offset:55296
ds_read_b64_tr_b16 a[110:111], v88 offset:57600
v_and_b32_dpp v60, v79, v8 row_newbcast:1 row_mask:0xf bank_mask:0xf
v_and_b32_dpp v61, v79, v9 row_newbcast:1 row_mask:0xf bank_mask:0xf
v_and_b32_dpp v62, v79, v10 row_newbcast:1 row_mask:0xf bank_mask:0xf
v_and_b32_dpp v63, v79, v11 row_newbcast:1 row_mask:0xf bank_mask:0xf
v_and_b32_dpp v64, v79, v8 row_newbcast:5 row_mask:0xf bank_mask:0xf
v_and_b32_dpp v65, v79, v9 row_newbcast:5 row_mask:0xf bank_mask:0xf
v_and_b32_dpp v66, v79, v10 row_newbcast:5 row_mask:0xf bank_mask:0xf
v_and_b32_dpp v67, v79, v11 row_newbcast:5 row_mask:0xf bank_mask:0xf
v_and_b32_dpp v68, v79, v8 row_newbcast:9 row_mask:0xf bank_mask:0xf
v_and_b32_dpp v69, v79, v9 row_newbcast:9 row_mask:0xf bank_mask:0xf
v_and_b32_dpp v70, v79, v10 row_newbcast:9 row_mask:0xf bank_mask:0xf
v_and_b32_dpp v71, v79, v11 row_newbcast:9 row_mask:0xf bank_mask:0xf
v_and_b32_dpp v72, v79, v8 row_newbcast:13 row_mask:0xf bank_mask:0xf
v_and_b32_dpp v73, v79, v9 row_newbcast:13 row_mask:0xf bank_mask:0xf
v_and_b32_dpp v74, v79, v10 row_newbcast:13 row_mask:0xf bank_mask:0xf
v_and_b32_dpp v75, v79, v11 row_newbcast:13 row_mask:0xf bank_mask:0xf
s_waitcnt vmcnt(34)
v_mfma_f32_16x16x32_bf16 v[20:23], v[60:63], v[136:139], v[20:23]
v_mfma_f32_16x16x32_bf16 v[20:23], v[64:67], v[140:143], v[20:23]
v_mfma_f32_16x16x32_bf16 v[20:23], v[68:71], v[144:147], v[20:23]
v_mfma_f32_16x16x32_bf16 v[20:23], v[72:75], v[148:151], v[20:23]
v_add_u32 v117, 1, v117
buffer_store_dword v117, v118, s[64:67], 0 offen
buffer_load_dwordx4 v[136:139], v2, s[52:55], s12 offen offset:0 nt
buffer_load_dwordx4 v[140:143], v2, s[52:55], s12 offen offset:1024 nt
buffer_load_dwordx4 v[144:147], v2, s[52:55], s12 offen offset:2048 nt
buffer_load_dwordx4 v[148:151], v2, s[52:55], s12 offen offset:3072 nt
s_add_u32 s13, s13, 24576
s_min_u32 s12, s13, 2146435072
ds_read_b64_tr_b16 a[112:113], v90 offset:0
ds_read_b64_tr_b16 a[114:115], v90 offset:2304
ds_read_b64_tr_b16 a[116:117], v90 offset:18432
ds_read_b64_tr_b16 a[118:119], v90 offset:20736
v_and_b32_dpp v60, v76, v8 row_newbcast:2 row_mask:0xf bank_mask:0xf
v_and_b32_dpp v61, v76, v9 row_newbcast:2 row_mask:0xf bank_mask:0xf
v_and_b32_dpp v62, v76, v10 row_newbcast:2 row_mask:0xf bank_mask:0xf
v_and_b32_dpp v63, v76, v11 row_newbcast:2 row_mask:0xf bank_mask:0xf
v_and_b32_dpp v64, v76, v8 row_newbcast:6 row_mask:0xf bank_mask:0xf
v_and_b32_dpp v65, v76, v9 row_newbcast:6 row_mask:0xf bank_mask:0xf
v_and_b32_dpp v66, v76, v10 row_newbcast:6 row_mask:0xf bank_mask:0xf
v_and_b32_dpp v67, v76, v11 row_newbcast:6 row_mask:0xf bank_mask:0xf
v_and_b32_dpp v68, v76, v8 row_newbcast:10 row_mask:0xf bank_mask:0xf
v_and_b32_dpp v69, v76, v9 row_newbcast:10 row_mask:0xf bank_mask:0xf
v_and_b32_dpp v70, v76, v10 row_newbcast:10 row_mask:0xf bank_mask:0xf
v_and_b32_dpp v71, v76, v11 row_newbcast:10 row_mask:0xf bank_mask:0xf
v_and_b32_dpp v72, v76, v8 row_newbcast:14 row_mask:0xf bank_mask:0xf
v_and_b32_dpp v73, v76, v9 row_newbcast:14 row_mask:0xf bank_mask:0xf
v_and_b32_dpp v74, v76, v10 row_newbcast:14 row_mask:0xf bank_mask:0xf
v_and_b32_dpp v75, v76, v11 row_newbcast:14 row_mask:0xf bank_mask:0xf
v_mfma_f32_16x16x32_bf16 v[20:23], v[60:63], a[16:19], v[20:23]
v_mfma_f32_16x16x32_bf16 v[20:23], v[64:67], a[20:23], v[20:23]
v_mfma_f32_16x16x32_bf16 v[20:23], v[68:71], a[24:27], v[20:23]
v_mfma_f32_16x16x32_bf16 v[20:23], v[72:75], a[28:31], v[20:23]
s_nop 3
v_and_b32_dpp v60, v79, v8 row_newbcast:2 row_mask:0xf bank_mask:0xf
v_and_b32_dpp v61, v79, v9 row_newbcast:2 row_mask:0xf bank_mask:0xf
v_and_b32_dpp v62, v79, v10 row_newbcast:2 row_mask:0xf bank_mask:0xf
v_and_b32_dpp v63, v79, v11 row_newbcast:2 row_mask:0xf bank_mask:0xf
v_and_b32_dpp v64, v79, v8 row_newbcast:6 row_mask:0xf bank_mask:0xf
v_and_b32_dpp v65, v79, v9 row_newbcast:6 row_mask:0xf bank_mask:0xf
v_and_b32_dpp v66, v79, v10 row_newbcast:6 row_mask:0xf bank_mask:0xf
v_and_b32_dpp v67, v79, v11 row_newbcast:6 row_mask:0xf bank_mask:0xf
v_and_b32_dpp v68, v79, v8 row_newbcast:10 row_mask:0xf bank_mask:0xf
v_and_b32_dpp v69, v79, v9 row_newbcast:10 row_mask:0xf bank_mask:0xf
v_and_b32_dpp v70, v79, v10 row_newbcast:10 row_mask:0xf bank_mask:0xf
v_and_b32_dpp v71, v79, v11 row_newbcast:10 row_mask:0xf bank_mask:0xf
v_and_b32_dpp v72, v79, v8 row_newbcast:14 row_mask:0xf bank_mask:0xf
v_and_b32_dpp v73, v79, v9 row_newbcast:14 row_mask:0xf bank_mask:0xf
v_and_b32_dpp v74, v79, v10 row_newbcast:14 row_mask:0xf bank_mask:0xf
v_and_b32_dpp v75, v79, v11 row_newbcast:14 row_mask:0xf bank_mask:0xf
s_waitcnt vmcnt(35)
v_mfma_f32_16x16x32_bf16 v[20:23], v[60:63], v[152:155], v[20:23]
v_mfma_f32_16x16x32_bf16 v[20:23], v[64:67], v[156:159], v[20:23]
v_mfma_f32_16x16x32_bf16 v[20:23], v[68:71], v[160:163], v[20:23]
v_mfma_f32_16x16x32_bf16 v[20:23], v[72:75], v[164:167], v[20:23]
v_add_u32 v117, 1, v117
buffer_store_dword v117, v118, s[64:67], 0 offen
buffer_load_dwordx4 v[152:155], v2, s[52:55], s12 offen offset:0 nt
buffer_load_dwordx4 v[156:159], v2, s[52:55], s12 offen offset:1024 nt
buffer_load_dwordx4 v[160:163], v2, s[52:55], s12 offen offset:2048 nt
buffer_load_dwordx4 v[164:167], v2, s[52:55], s12 offen offset:3072 nt
s_add_u32 s13, s13, 24576
s_min_u32 s12, s13, 2146435072
ds_read_b64_tr_b16 a[120:121], v90 offset:36864
ds_read_b64_tr_b16 a[122:123], v90 offset:39168
ds_read_b64_tr_b16 a[124:125], v90 offset:55296
ds_read_b64_tr_b16 a[126:127], v90 offset:57600
v_and_b32_dpp v60, v79, v8 row_newbcast:3 row_mask:0xf bank_mask:0xf
v_and_b32_dpp v61, v79, v9 row_newbcast:3 row_mask:0xf bank_mask:0xf
v_and_b32_dpp v62, v79, v10 row_newbcast:3 row_mask:0xf bank_mask:0xf
v_and_b32_dpp v63, v79, v11 row_newbcast:3 row_mask:0xf bank_mask:0xf
v_and_b32_dpp v64, v79, v8 row_newbcast:7 row_mask:0xf bank_mask:0xf
v_and_b32_dpp v65, v79, v9 row_newbcast:7 row_mask:0xf bank_mask:0xf
v_and_b32_dpp v66, v79, v10 row_newbcast:7 row_mask:0xf bank_mask:0xf
v_and_b32_dpp v67, v79, v11 row_newbcast:7 row_mask:0xf bank_mask:0xf
v_and_b32_dpp v68, v79, v8 row_newbcast:11 row_mask:0xf bank_mask:0xf
v_and_b32_dpp v69, v79, v9 row_newbcast:11 row_mask:0xf bank_mask:0xf
v_and_b32_dpp v70, v79, v10 row_newbcast:11 row_mask:0xf bank_mask:0xf
v_and_b32_dpp v71, v79, v11 row_newbcast:11 row_mask:0xf bank_mask:0xf
v_and_b32_dpp v72, v79, v8 row_newbcast:15 row_mask:0xf bank_mask:0xf
v_and_b32_dpp v73, v79, v9 row_newbcast:15 row_mask:0xf bank_mask:0xf
v_and_b32_dpp v74, v79, v10 row_newbcast:15 row_mask:0xf bank_mask:0xf
v_and_b32_dpp v75, v79, v11 row_newbcast:15 row_mask:0xf bank_mask:0xf
s_waitcnt vmcnt(36)
v_mfma_f32_16x16x32_bf16 v[20:23], v[60:63], v[168:171], v[20:23]
v_mfma_f32_16x16x32_bf16 v[20:23], v[64:67], v[172:175], v[20:23]
v_mfma_f32_16x16x32_bf16 v[20:23], v[68:71], v[176:179], v[20:23]
v_mfma_f32_16x16x32_bf16 v[20:23], v[72:75], v[180:183], v[20:23]
v_add_u32 v117, 1, v117
buffer_store_dword v117, v118, s[64:67], 0 offen
buffer_load_dwordx4 v[168:171], v2, s[52:55], s12 offen offset:0 nt
buffer_load_dwordx4 v[172:175], v2, s[52:55], s12 offen offset:1024 nt
buffer_load_dwordx4 v[176:179], v2, s[52:55], s12 offen offset:2048 nt
buffer_load_dwordx4 v[180:183], v2, s[52:55], s12 offen offset:3072 nt
s_add_u32 s13, s13, 24576
s_min_u32 s12, s13, 2146435072
ds_read_b64_tr_b16 a[128:129], v88 offset:8
ds_read_b64_tr_b16 a[130:131], v88 offset:2312
ds_read_b64_tr_b16 a[132:133], v88 offset:18440
ds_read_b64_tr_b16 a[134:135], v88 offset:20744
v_and_b32_dpp v60, v80, v8 row_newbcast:0 row_mask:0xf bank_mask:0xf
v_and_b32_dpp v61, v80, v9 row_newbcast:0 row_mask:0xf bank_mask:0xf
v_and_b32_dpp v62, v80, v10 row_newbcast:0 row_mask:0xf bank_mask:0xf
v_and_b32_dpp v63, v80, v11 row_newbcast:0 row_mask:0xf bank_mask:0xf
v_and_b32_dpp v64, v80, v8 row_newbcast:4 row_mask:0xf bank_mask:0xf
v_and_b32_dpp v65, v80, v9 row_newbcast:4 row_mask:0xf bank_mask:0xf
v_and_b32_dpp v66, v80, v10 row_newbcast:4 row_mask:0xf bank_mask:0xf
v_and_b32_dpp v67, v80, v11 row_newbcast:4 row_mask:0xf bank_mask:0xf
v_and_b32_dpp v68, v80, v8 row_newbcast:8 row_mask:0xf bank_mask:0xf
v_and_b32_dpp v69, v80, v9 row_newbcast:8 row_mask:0xf bank_mask:0xf
v_and_b32_dpp v70, v80, v10 row_newbcast:8 row_mask:0xf bank_mask:0xf
v_and_b32_dpp v71, v80, v11 row_newbcast:8 row_mask:0xf bank_mask:0xf
v_and_b32_dpp v72, v80, v8 row_newbcast:12 row_mask:0xf bank_mask:0xf
v_and_b32_dpp v73, v80, v9 row_newbcast:12 row_mask:0xf bank_mask:0xf
v_and_b32_dpp v74, v80, v10 row_newbcast:12 row_mask:0xf bank_mask:0xf
v_and_b32_dpp v75, v80, v11 row_newbcast:12 row_mask:0xf bank_mask:0xf
s_waitcnt vmcnt(35)
v_mfma_f32_16x16x32_bf16 v[20:23], v[60:63], v[184:187], v[20:23]
v_mfma_f32_16x16x32_bf16 v[20:23], v[64:67], v[188:191], v[20:23]
v_mfma_f32_16x16x32_bf16 v[20:23], v[68:71], v[192:195], v[20:23]
v_mfma_f32_16x16x32_bf16 v[20:23], v[72:75], v[196:199], v[20:23]
v_add_u32 v117, 1, v117
buffer_store_dword v117, v118, s[64:67], 0 offen
buffer_load_dwordx4 v[184:187], v2, s[52:55], s12 offen offset:0 nt
buffer_load_dwordx4 v[188:191], v2, s[52:55], s12 offen offset:1024 nt
buffer_load_dwordx4 v[192:195], v2, s[52:55], s12 offen offset:2048 nt
buffer_load_dwordx4 v[196:199], v2, s[52:55], s12 offen offset:3072 nt
s_add_u32 s13, s13, 24576
s_min_u32 s12, s13, 2146435072
ds_read_b64_tr_b16 a[136:137], v88 offset:36872
ds_read_b64_tr_b16 a[138:139], v88 offset:39176
ds_read_b64_tr_b16 a[140:141], v88 offset:55304
ds_read_b64_tr_b16 a[142:143], v88 offset:57608
v_and_b32_dpp v60, v80, v8 row_newbcast:1 row_mask:0xf bank_mask:0xf
v_and_b32_dpp v61, v80, v9 row_newbcast:1 row_mask:0xf bank_mask:0xf
v_and_b32_dpp v62, v80, v10 row_newbcast:1 row_mask:0xf bank_mask:0xf
v_and_b32_dpp v63, v80, v11 row_newbcast:1 row_mask:0xf bank_mask:0xf
v_and_b32_dpp v64, v80, v8 row_newbcast:5 row_mask:0xf bank_mask:0xf
v_and_b32_dpp v65, v80, v9 row_newbcast:5 row_mask:0xf bank_mask:0xf
v_and_b32_dpp v66, v80, v10 row_newbcast:5 row_mask:0xf bank_mask:0xf
v_and_b32_dpp v67, v80, v11 row_newbcast:5 row_mask:0xf bank_mask:0xf
v_and_b32_dpp v68, v80, v8 row_newbcast:9 row_mask:0xf bank_mask:0xf
v_and_b32_dpp v69, v80, v9 row_newbcast:9 row_mask:0xf bank_mask:0xf
v_and_b32_dpp v70, v80, v10 row_newbcast:9 row_mask:0xf bank_mask:0xf
v_and_b32_dpp v71, v80, v11 row_newbcast:9 row_mask:0xf bank_mask:0xf
v_and_b32_dpp v72, v80, v8 row_newbcast:13 row_mask:0xf bank_mask:0xf
v_and_b32_dpp v73, v80, v9 row_newbcast:13 row_mask:0xf bank_mask:0xf
v_and_b32_dpp v74, v80, v10 row_newbcast:13 row_mask:0xf bank_mask:0xf
v_and_b32_dpp v75, v80, v11 row_newbcast:13 row_mask:0xf bank_mask:0xf
s_waitcnt vmcnt(35)
v_mfma_f32_16x16x32_bf16 v[20:23], v[60:63], v[200:203], v[20:23]
v_mfma_f32_16x16x32_bf16 v[20:23], v[64:67], v[204:207], v[20:23]
v_mfma_f32_16x16x32_bf16 v[20:23], v[68:71], v[208:211], v[20:23]
v_mfma_f32_16x16x32_bf16 v[20:23], v[72:75], v[212:215], v[20:23]
v_add_u32 v117, 1, v117
buffer_store_dword v117, v118, s[64:67], 0 offen
buffer_load_dwordx4 v[200:203], v2, s[52:55], s12 offen offset:0 nt
buffer_load_dwordx4 v[204:207], v2, s[52:55], s12 offen offset:1024 nt
buffer_load_dwordx4 v[208:211], v2, s[52:55], s12 offen offset:2048 nt
buffer_load_dwordx4 v[212:215], v2, s[52:55], s12 offen offset:3072 nt
s_add_u32 s13, s13, 24576
s_min_u32 s12, s13, 2146435072
ds_read_b64_tr_b16 a[144:145], v90 offset:8
ds_read_b64_tr_b16 a[146:147], v90 offset:2312
ds_read_b64_tr_b16 a[148:149], v90 offset:18440
ds_read_b64_tr_b16 a[150:151], v90 offset:20744
v_and_b32_dpp v60, v76, v8 row_newbcast:3 row_mask:0xf bank_mask:0xf
v_and_b32_dpp v61, v76, v9 row_newbcast:3 row_mask:0xf bank_mask:0xf
v_and_b32_dpp v62, v76, v10 row_newbcast:3 row_mask:0xf bank_mask:0xf
v_and_b32_dpp v63, v76, v11 row_newbcast:3 row_mask:0xf bank_mask:0xf
v_and_b32_dpp v64, v76, v8 row_newbcast:7 row_mask:0xf bank_mask:0xf
v_and_b32_dpp v65, v76, v9 row_newbcast:7 row_mask:0xf bank_mask:0xf
v_and_b32_dpp v66, v76, v10 row_newbcast:7 row_mask:0xf bank_mask:0xf
v_and_b32_dpp v67, v76, v11 row_newbcast:7 row_mask:0xf bank_mask:0xf
v_and_b32_dpp v68, v76, v8 row_newbcast:11 row_mask:0xf bank_mask:0xf
v_and_b32_dpp v69, v76, v9 row_newbcast:11 row_mask:0xf bank_mask:0xf
v_and_b32_dpp v70, v76, v10 row_newbcast:11 row_mask:0xf bank_mask:0xf
v_and_b32_dpp v71, v76, v11 row_newbcast:11 row_mask:0xf bank_mask:0xf
v_and_b32_dpp v72, v76, v8 row_newbcast:15 row_mask:0xf bank_mask:0xf
v_and_b32_dpp v73, v76, v9 row_newbcast:15 row_mask:0xf bank_mask:0xf
v_and_b32_dpp v74, v76, v10 row_newbcast:15 row_mask:0xf bank_mask:0xf
v_and_b32_dpp v75, v76, v11 row_newbcast:15 row_mask:0xf bank_mask:0xf
v_mfma_f32_16x16x32_bf16 v[20:23], v[60:63], a[32:35], v[20:23]
v_mfma_f32_16x16x32_bf16 v[20:23], v[64:67], a[36:39], v[20:23]
v_mfma_f32_16x16x32_bf16 v[20:23], v[68:71], a[40:43], v[20:23]
v_mfma_f32_16x16x32_bf16 v[20:23], v[72:75], a[44:47], v[20:23]
s_nop 3
v_and_b32_dpp v60, v80, v8 row_newbcast:2 row_mask:0xf bank_mask:0xf
v_and_b32_dpp v61, v80, v9 row_newbcast:2 row_mask:0xf bank_mask:0xf
v_and_b32_dpp v62, v80, v10 row_newbcast:2 row_mask:0xf bank_mask:0xf
v_and_b32_dpp v63, v80, v11 row_newbcast:2 row_mask:0xf bank_mask:0xf
v_and_b32_dpp v64, v80, v8 row_newbcast:6 row_mask:0xf bank_mask:0xf
v_and_b32_dpp v65, v80, v9 row_newbcast:6 row_mask:0xf bank_mask:0xf
v_and_b32_dpp v66, v80, v10 row_newbcast:6 row_mask:0xf bank_mask:0xf
v_and_b32_dpp v67, v80, v11 row_newbcast:6 row_mask:0xf bank_mask:0xf
v_and_b32_dpp v68, v80, v8 row_newbcast:10 row_mask:0xf bank_mask:0xf
v_and_b32_dpp v69, v80, v9 row_newbcast:10 row_mask:0xf bank_mask:0xf
v_and_b32_dpp v70, v80, v10 row_newbcast:10 row_mask:0xf bank_mask:0xf
v_and_b32_dpp v71, v80, v11 row_newbcast:10 row_mask:0xf bank_mask:0xf
v_and_b32_dpp v72, v80, v8 row_newbcast:14 row_mask:0xf bank_mask:0xf
v_and_b32_dpp v73, v80, v9 row_newbcast:14 row_mask:0xf bank_mask:0xf
v_and_b32_dpp v74, v80, v10 row_newbcast:14 row_mask:0xf bank_mask:0xf
v_and_b32_dpp v75, v80, v11 row_newbcast:14 row_mask:0xf bank_mask:0xf
s_waitcnt vmcnt(35)
v_mfma_f32_16x16x32_bf16 v[20:23], v[60:63], v[216:219], v[20:23]
v_mfma_f32_16x16x32_bf16 v[20:23], v[64:67], v[220:223], v[20:23]
v_mfma_f32_16x16x32_bf16 v[20:23], v[68:71], v[224:227], v[20:23]
v_mfma_f32_16x16x32_bf16 v[20:23], v[72:75], v[228:231], v[20:23]
v_add_u32 v117, 1, v117
buffer_store_dword v117, v118, s[64:67], 0 offen
buffer_load_dwordx4 v[216:219], v2, s[52:55], s12 offen offset:0 nt
buffer_load_dwordx4 v[220:223], v2, s[52:55], s12 offen offset:1024 nt
buffer_load_dwordx4 v[224:227], v2, s[52:55], s12 offen offset:2048 nt
buffer_load_dwordx4 v[228:231], v2, s[52:55], s12 offen offset:3072 nt
s_add_u32 s13, s13, 24576
s_min_u32 s12, s13, 2146435072
ds_read_b64_tr_b16 a[152:153], v90 offset:36872
ds_read_b64_tr_b16 a[154:155], v90 offset:39176
ds_read_b64_tr_b16 a[156:157], v90 offset:55304
ds_read_b64_tr_b16 a[158:159], v90 offset:57608
v_and_b32_dpp v60, v80, v8 row_newbcast:3 row_mask:0xf bank_mask:0xf
v_and_b32_dpp v61, v80, v9 row_newbcast:3 row_mask:0xf bank_mask:0xf
v_and_b32_dpp v62, v80, v10 row_newbcast:3 row_mask:0xf bank_mask:0xf
v_and_b32_dpp v63, v80, v11 row_newbcast:3 row_mask:0xf bank_mask:0xf
v_and_b32_dpp v64, v80, v8 row_newbcast:7 row_mask:0xf bank_mask:0xf
v_and_b32_dpp v65, v80, v9 row_newbcast:7 row_mask:0xf bank_mask:0xf
v_and_b32_dpp v66, v80, v10 row_newbcast:7 row_mask:0xf bank_mask:0xf
v_and_b32_dpp v67, v80, v11 row_newbcast:7 row_mask:0xf bank_mask:0xf
v_and_b32_dpp v68, v80, v8 row_newbcast:11 row_mask:0xf bank_mask:0xf
v_and_b32_dpp v69, v80, v9 row_newbcast:11 row_mask:0xf bank_mask:0xf
v_and_b32_dpp v70, v80, v10 row_newbcast:11 row_mask:0xf bank_mask:0xf
v_and_b32_dpp v71, v80, v11 row_newbcast:11 row_mask:0xf bank_mask:0xf
v_and_b32_dpp v72, v80, v8 row_newbcast:15 row_mask:0xf bank_mask:0xf
v_and_b32_dpp v73, v80, v9 row_newbcast:15 row_mask:0xf bank_mask:0xf
v_and_b32_dpp v74, v80, v10 row_newbcast:15 row_mask:0xf bank_mask:0xf
v_and_b32_dpp v75, v80, v11 row_newbcast:15 row_mask:0xf bank_mask:0xf
s_waitcnt vmcnt(35)
v_mfma_f32_16x16x32_bf16 v[20:23], v[60:63], v[232:235], v[20:23]
v_mfma_f32_16x16x32_bf16 v[20:23], v[64:67], v[236:239], v[20:23]
v_mfma_f32_16x16x32_bf16 v[20:23], v[68:71], v[240:243], v[20:23]
v_mfma_f32_16x16x32_bf16 v[20:23], v[72:75], v[244:247], v[20:23]
v_add_u32 v117, 1, v117
buffer_store_dword v117, v118, s[64:67], 0 offen
buffer_load_dwordx4 v[232:235], v2, s[52:55], s12 offen offset:0 nt
buffer_load_dwordx4 v[236:239], v2, s[52:55], s12 offen offset:1024 nt
buffer_load_dwordx4 v[240:243], v2, s[52:55], s12 offen offset:2048 nt
buffer_load_dwordx4 v[244:247], v2, s[52:55], s12 offen offset:3072 nt
s_add_u32 s13, s13, 24576
s_min_u32 s12, s13, 2146435072
ds_read_b64_tr_b16 a[160:161], v88 offset:16
ds_read_b64_tr_b16 a[162:163], v88 offset:2320
ds_read_b64_tr_b16 a[164:165], v88 offset:18448
ds_read_b64_tr_b16 a[166:167], v88 offset:20752
v_and_b32_dpp v60, v81, v8 row_newbcast:0 row_mask:0xf bank_mask:0xf
v_and_b32_dpp v61, v81, v9 row_newbcast:0 row_mask:0xf bank_mask:0xf
v_and_b32_dpp v62, v81, v10 row_newbcast:0 row_mask:0xf bank_mask:0xf
v_and_b32_dpp v63, v81, v11 row_newbcast:0 row_mask:0xf bank_mask:0xf
v_and_b32_dpp v64, v81, v8 row_newbcast:4 row_mask:0xf bank_mask:0xf
v_and_b32_dpp v65, v81, v9 row_newbcast:4 row_mask:0xf bank_mask:0xf
v_and_b32_dpp v66, v81, v10 row_newbcast:4 row_mask:0xf bank_mask:0xf
v_and_b32_dpp v67, v81, v11 row_newbcast:4 row_mask:0xf bank_mask:0xf
v_and_b32_dpp v68, v81, v8 row_newbcast:8 row_mask:0xf bank_mask:0xf
v_and_b32_dpp v69, v81, v9 row_newbcast:8 row_mask:0xf bank_mask:0xf
v_and_b32_dpp v70, v81, v10 row_newbcast:8 row_mask:0xf bank_mask:0xf
v_and_b32_dpp v71, v81, v11 row_newbcast:8 row_mask:0xf bank_mask:0xf
v_and_b32_dpp v72, v81, v8 row_newbcast:12 row_mask:0xf bank_mask:0xf
v_and_b32_dpp v73, v81, v9 row_newbcast:12 row_mask:0xf bank_mask:0xf
v_and_b32_dpp v74, v81, v10 row_newbcast:12 row_mask:0xf bank_mask:0xf
v_and_b32_dpp v75, v81, v11 row_newbcast:12 row_mask:0xf bank_mask:0xf
s_waitcnt vmcnt(35)
v_mfma_f32_16x16x32_bf16 v[20:23], v[60:63], v[120:123], v[20:23]
v_mfma_f32_16x16x32_bf16 v[20:23], v[64:67], v[124:127], v[20:23]
v_mfma_f32_16x16x32_bf16 v[20:23], v[68:71], v[128:131], v[20:23]
v_mfma_f32_16x16x32_bf16 v[20:23], v[72:75], v[132:135], v[20:23]
v_add_u32 v117, 1, v117
buffer_store_dword v117, v118, s[64:67], 0 offen
buffer_load_dwordx4 v[120:123], v2, s[52:55], s12 offen offset:0 nt
buffer_load_dwordx4 v[124:127], v2, s[52:55], s12 offen offset:1024 nt
buffer_load_dwordx4 v[128:131], v2, s[52:55], s12 offen offset:2048 nt
buffer_load_dwordx4 v[132:135], v2, s[52:55], s12 offen offset:3072 nt
s_add_u32 s13, s13, 24576
s_min_u32 s12, s13, 2146435072
ds_read_b64_tr_b16 a[168:169], v88 offset:36880
ds_read_b64_tr_b16 a[170:171], v88 offset:39184
ds_read_b64_tr_b16 a[172:173], v88 offset:55312
ds_read_b64_tr_b16 a[174:175], v88 offset:57616
v_and_b32_dpp v60, v81, v8 row_newbcast:1 row_mask:0xf bank_mask:0xf
v_and_b32_dpp v61, v81, v9 row_newbcast:1 row_mask:0xf bank_mask:0xf
v_and_b32_dpp v62, v81, v10 row_newbcast:1 row_mask:0xf bank_mask:0xf
v_and_b32_dpp v63, v81, v11 row_newbcast:1 row_mask:0xf bank_mask:0xf
v_and_b32_dpp v64, v81, v8 row_newbcast:5 row_mask:0xf bank_mask:0xf
v_and_b32_dpp v65, v81, v9 row_newbcast:5 row_mask:0xf bank_mask:0xf
v_and_b32_dpp v66, v81, v10 row_newbcast:5 row_mask:0xf bank_mask:0xf
v_and_b32_dpp v67, v81, v11 row_newbcast:5 row_mask:0xf bank_mask:0xf
v_and_b32_dpp v68, v81, v8 row_newbcast:9 row_mask:0xf bank_mask:0xf
v_and_b32_dpp v69, v81, v9 row_newbcast:9 row_mask:0xf bank_mask:0xf
v_and_b32_dpp v70, v81, v10 row_newbcast:9 row_mask:0xf bank_mask:0xf
v_and_b32_dpp v71, v81, v11 row_newbcast:9 row_mask:0xf bank_mask:0xf
v_and_b32_dpp v72, v81, v8 row_newbcast:13 row_mask:0xf bank_mask:0xf
v_and_b32_dpp v73, v81, v9 row_newbcast:13 row_mask:0xf bank_mask:0xf
v_and_b32_dpp v74, v81, v10 row_newbcast:13 row_mask:0xf bank_mask:0xf
v_and_b32_dpp v75, v81, v11 row_newbcast:13 row_mask:0xf bank_mask:0xf
s_waitcnt vmcnt(35)
v_mfma_f32_16x16x32_bf16 v[20:23], v[60:63], v[136:139], v[20:23]
v_mfma_f32_16x16x32_bf16 v[20:23], v[64:67], v[140:143], v[20:23]
v_mfma_f32_16x16x32_bf16 v[20:23], v[68:71], v[144:147], v[20:23]
v_mfma_f32_16x16x32_bf16 v[20:23], v[72:75], v[148:151], v[20:23]
v_add_u32 v117, 1, v117
buffer_store_dword v117, v118, s[64:67], 0 offen
buffer_load_dwordx4 v[136:139], v2, s[52:55], s12 offen offset:0 nt
buffer_load_dwordx4 v[140:143], v2, s[52:55], s12 offen offset:1024 nt
buffer_load_dwordx4 v[144:147], v2, s[52:55], s12 offen offset:2048 nt
buffer_load_dwordx4 v[148:151], v2, s[52:55], s12 offen offset:3072 nt
s_add_u32 s13, s13, 24576
s_min_u32 s12, s13, 2146435072
ds_read_b64_tr_b16 a[176:177], v90 offset:16
ds_read_b64_tr_b16 a[178:179], v90 offset:2320
ds_read_b64_tr_b16 a[180:181], v90 offset:18448
ds_read_b64_tr_b16 a[182:183], v90 offset:20752
v_and_b32_dpp v60, v77, v8 row_newbcast:0 row_mask:0xf bank_mask:0xf
v_and_b32_dpp v61, v77, v9 row_newbcast:0 row_mask:0xf bank_mask:0xf
v_and_b32_dpp v62, v77, v10 row_newbcast:0 row_mask:0xf bank_mask:0xf
v_and_b32_dpp v63, v77, v11 row_newbcast:0 row_mask:0xf bank_mask:0xf
v_and_b32_dpp v64, v77, v8 row_newbcast:4 row_mask:0xf bank_mask:0xf
v_and_b32_dpp v65, v77, v9 row_newbcast:4 row_mask:0xf bank_mask:0xf
v_and_b32_dpp v66, v77, v10 row_newbcast:4 row_mask:0xf bank_mask:0xf
v_and_b32_dpp v67, v77, v11 row_newbcast:4 row_mask:0xf bank_mask:0xf
v_and_b32_dpp v68, v77, v8 row_newbcast:8 row_mask:0xf bank_mask:0xf
v_and_b32_dpp v69, v77, v9 row_newbcast:8 row_mask:0xf bank_mask:0xf
v_and_b32_dpp v70, v77, v10 row_newbcast:8 row_mask:0xf bank_mask:0xf
v_and_b32_dpp v71, v77, v11 row_newbcast:8 row_mask:0xf bank_mask:0xf
v_and_b32_dpp v72, v77, v8 row_newbcast:12 row_mask:0xf bank_mask:0xf
v_and_b32_dpp v73, v77, v9 row_newbcast:12 row_mask:0xf bank_mask:0xf
v_and_b32_dpp v74, v77, v10 row_newbcast:12 row_mask:0xf bank_mask:0xf
v_and_b32_dpp v75, v77, v11 row_newbcast:12 row_mask:0xf bank_mask:0xf
v_mfma_f32_16x16x32_bf16 v[20:23], v[60:63], a[48:51], v[20:23]
v_mfma_f32_16x16x32_bf16 v[20:23], v[64:67], a[52:55], v[20:23]
v_mfma_f32_16x16x32_bf16 v[20:23], v[68:71], a[56:59], v[20:23]
v_mfma_f32_16x16x32_bf16 v[20:23], v[72:75], a[60:63], v[20:23]
s_nop 3
v_and_b32_dpp v60, v81, v8 row_newbcast:2 row_mask:0xf bank_mask:0xf
v_and_b32_dpp v61, v81, v9 row_newbcast:2 row_mask:0xf bank_mask:0xf
v_and_b32_dpp v62, v81, v10 row_newbcast:2 row_mask:0xf bank_mask:0xf
v_and_b32_dpp v63, v81, v11 row_newbcast:2 row_mask:0xf bank_mask:0xf
v_and_b32_dpp v64, v81, v8 row_newbcast:6 row_mask:0xf bank_mask:0xf
v_and_b32_dpp v65, v81, v9 row_newbcast:6 row_mask:0xf bank_mask:0xf
v_and_b32_dpp v66, v81, v10 row_newbcast:6 row_mask:0xf bank_mask:0xf
v_and_b32_dpp v67, v81, v11 row_newbcast:6 row_mask:0xf bank_mask:0xf
v_and_b32_dpp v68, v81, v8 row_newbcast:10 row_mask:0xf bank_mask:0xf
v_and_b32_dpp v69, v81, v9 row_newbcast:10 row_mask:0xf bank_mask:0xf
v_and_b32_dpp v70, v81, v10 row_newbcast:10 row_mask:0xf bank_mask:0xf
v_and_b32_dpp v71, v81, v11 row_newbcast:10 row_mask:0xf bank_mask:0xf
v_and_b32_dpp v72, v81, v8 row_newbcast:14 row_mask:0xf bank_mask:0xf
v_and_b32_dpp v73, v81, v9 row_newbcast:14 row_mask:0xf bank_mask:0xf
v_and_b32_dpp v74, v81, v10 row_newbcast:14 row_mask:0xf bank_mask:0xf
v_and_b32_dpp v75, v81, v11 row_newbcast:14 row_mask:0xf bank_mask:0xf
s_waitcnt vmcnt(35)
v_mfma_f32_16x16x32_bf16 v[20:23], v[60:63], v[152:155], v[20:23]
v_mfma_f32_16x16x32_bf16 v[20:23], v[64:67], v[156:159], v[20:23]
v_mfma_f32_16x16x32_bf16 v[20:23], v[68:71], v[160:163], v[20:23]
v_mfma_f32_16x16x32_bf16 v[20:23], v[72:75], v[164:167], v[20:23]
v_add_u32 v117, 1, v117
buffer_store_dword v117, v118, s[64:67], 0 offen
buffer_load_dwordx4 v[152:155], v2, s[52:55], s12 offen offset:0 nt
buffer_load_dwordx4 v[156:159], v2, s[52:55], s12 offen offset:1024 nt
buffer_load_dwordx4 v[160:163], v2, s[52:55], s12 offen offset:2048 nt
buffer_load_dwordx4 v[164:167], v2, s[52:55], s12 offen offset:3072 nt
s_add_u32 s13, s13, 24576
s_min_u32 s12, s13, 2146435072
ds_read_b64_tr_b16 a[184:185], v90 offset:36880
ds_read_b64_tr_b16 a[186:187], v90 offset:39184
ds_read_b64_tr_b16 a[188:189], v90 offset:55312
ds_read_b64_tr_b16 a[190:191], v90 offset:57616
v_and_b32_dpp v60, v81, v8 row_newbcast:3 row_mask:0xf bank_mask:0xf
v_and_b32_dpp v61, v81, v9 row_newbcast:3 row_mask:0xf bank_mask:0xf
v_and_b32_dpp v62, v81, v10 row_newbcast:3 row_mask:0xf bank_mask:0xf
v_and_b32_dpp v63, v81, v11 row_newbcast:3 row_mask:0xf bank_mask:0xf
v_and_b32_dpp v64, v81, v8 row_newbcast:7 row_mask:0xf bank_mask:0xf
v_and_b32_dpp v65, v81, v9 row_newbcast:7 row_mask:0xf bank_mask:0xf
v_and_b32_dpp v66, v81, v10 row_newbcast:7 row_mask:0xf bank_mask:0xf
v_and_b32_dpp v67, v81, v11 row_newbcast:7 row_mask:0xf bank_mask:0xf
v_and_b32_dpp v68, v81, v8 row_newbcast:11 row_mask:0xf bank_mask:0xf
v_and_b32_dpp v69, v81, v9 row_newbcast:11 row_mask:0xf bank_mask:0xf
v_and_b32_dpp v70, v81, v10 row_newbcast:11 row_mask:0xf bank_mask:0xf
v_and_b32_dpp v71, v81, v11 row_newbcast:11 row_mask:0xf bank_mask:0xf
v_and_b32_dpp v72, v81, v8 row_newbcast:15 row_mask:0xf bank_mask:0xf
v_and_b32_dpp v73, v81, v9 row_newbcast:15 row_mask:0xf bank_mask:0xf
v_and_b32_dpp v74, v81, v10 row_newbcast:15 row_mask:0xf bank_mask:0xf
v_and_b32_dpp v75, v81, v11 row_newbcast:15 row_mask:0xf bank_mask:0xf
s_waitcnt vmcnt(35)
v_mfma_f32_16x16x32_bf16 v[20:23], v[60:63], v[168:171], v[20:23]
v_mfma_f32_16x16x32_bf16 v[20:23], v[64:67], v[172:175], v[20:23]
v_mfma_f32_16x16x32_bf16 v[20:23], v[68:71], v[176:179], v[20:23]
v_mfma_f32_16x16x32_bf16 v[20:23], v[72:75], v[180:183], v[20:23]
v_add_u32 v117, 1, v117
buffer_store_dword v117, v118, s[64:67], 0 offen
buffer_load_dwordx4 v[168:171], v2, s[52:55], s12 offen offset:0 nt
buffer_load_dwordx4 v[172:175], v2, s[52:55], s12 offen offset:1024 nt
buffer_load_dwordx4 v[176:179], v2, s[52:55], s12 offen offset:2048 nt
buffer_load_dwordx4 v[180:183], v2, s[52:55], s12 offen offset:3072 nt
s_add_u32 s13, s13, 24576
s_min_u32 s12, s13, 2146435072
ds_read_b64_tr_b16 a[192:193], v88 offset:24
ds_read_b64_tr_b16 a[194:195], v88 offset:2328
ds_read_b64_tr_b16 a[196:197], v88 offset:18456
ds_read_b64_tr_b16 a[198:199], v88 offset:20760
v_and_b32_dpp v60, v82, v8 row_newbcast:0 row_mask:0xf bank_mask:0xf
v_and_b32_dpp v61, v82, v9 row_newbcast:0 row_mask:0xf bank_mask:0xf
v_and_b32_dpp v62, v82, v10 row_newbcast:0 row_mask:0xf bank_mask:0xf
v_and_b32_dpp v63, v82, v11 row_newbcast:0 row_mask:0xf bank_mask:0xf
v_and_b32_dpp v64, v82, v8 row_newbcast:4 row_mask:0xf bank_mask:0xf
v_and_b32_dpp v65, v82, v9 row_newbcast:4 row_mask:0xf bank_mask:0xf
v_and_b32_dpp v66, v82, v10 row_newbcast:4 row_mask:0xf bank_mask:0xf
v_and_b32_dpp v67, v82, v11 row_newbcast:4 row_mask:0xf bank_mask:0xf
v_and_b32_dpp v68, v82, v8 row_newbcast:8 row_mask:0xf bank_mask:0xf
v_and_b32_dpp v69, v82, v9 row_newbcast:8 row_mask:0xf bank_mask:0xf
v_and_b32_dpp v70, v82, v10 row_newbcast:8 row_mask:0xf bank_mask:0xf
v_and_b32_dpp v71, v82, v11 row_newbcast:8 row_mask:0xf bank_mask:0xf
v_and_b32_dpp v72, v82, v8 row_newbcast:12 row_mask:0xf bank_mask:0xf
v_and_b32_dpp v73, v82, v9 row_newbcast:12 row_mask:0xf bank_mask:0xf
v_and_b32_dpp v74, v82, v10 row_newbcast:12 row_mask:0xf bank_mask:0xf
v_and_b32_dpp v75, v82, v11 row_newbcast:12 row_mask:0xf bank_mask:0xf
s_waitcnt vmcnt(35)
v_mfma_f32_16x16x32_bf16 v[20:23], v[60:63], v[184:187], v[20:23]
v_mfma_f32_16x16x32_bf16 v[20:23], v[64:67], v[188:191], v[20:23]
v_mfma_f32_16x16x32_bf16 v[20:23], v[68:71], v[192:195], v[20:23]
v_mfma_f32_16x16x32_bf16 v[20:23], v[72:75], v[196:199], v[20:23]
v_add_u32 v117, 1, v117
buffer_store_dword v117, v118, s[64:67], 0 offen
s_cmp_le_u32 s15, 32
s_cbranch_scc0 L_thr_15
s_waitcnt vmcnt(7)
L_thr_15:
buffer_load_dwordx4 v[184:187], v2, s[52:55], s12 offen offset:0 nt
buffer_load_dwordx4 v[188:191], v2, s[52:55], s12 offen offset:1024 nt
s_cbranch_scc0 L_thr_16
s_waitcnt vmcnt(7)
L_thr_16:
buffer_load_dwordx4 v[192:195], v2, s[52:55], s12 offen offset:2048 nt
buffer_load_dwordx4 v[196:199], v2, s[52:55], s12 offen offset:3072 nt
s_add_u32 s13, s13, 24576
s_min_u32 s12, s13, 2146435072
ds_read_b64_tr_b16 a[200:201], v88 offset:36888
ds_read_b64_tr_b16 a[202:203], v88 offset:39192
ds_read_b64_tr_b16 a[204:205], v88 offset:55320
ds_read_b64_tr_b16 a[206:207], v88 offset:57624
v_and_b32_dpp v60, v82, v8 row_newbcast:1 row_mask:0xf bank_mask:0xf
v_and_b32_dpp v61, v82, v9 row_newbcast:1 row_mask:0xf bank_mask:0xf
v_and_b32_dpp v62, v82, v10 row_newbcast:1 row_mask:0xf bank_mask:0xf
v_and_b32_dpp v63, v82, v11 row_newbcast:1 row_mask:0xf bank_mask:0xf
v_and_b32_dpp v64, v82, v8 row_newbcast:5 row_mask:0xf bank_mask:0xf
v_and_b32_dpp v65, v82, v9 row_newbcast:5 row_mask:0xf bank_mask:0xf
v_and_b32_dpp v66, v82, v10 row_newbcast:5 row_mask:0xf bank_mask:0xf
v_and_b32_dpp v67, v82, v11 row_newbcast:5 row_mask:0xf bank_mask:0xf
v_and_b32_dpp v68, v82, v8 row_newbcast:9 row_mask:0xf bank_mask:0xf
v_and_b32_dpp v69, v82, v9 row_newbcast:9 row_mask:0xf bank_mask:0xf
v_and_b32_dpp v70, v82, v10 row_newbcast:9 row_mask:0xf bank_mask:0xf
v_and_b32_dpp v71, v82, v11 row_newbcast:9 row_mask:0xf bank_mask:0xf
v_and_b32_dpp v72, v82, v8 row_newbcast:13 row_mask:0xf bank_mask:0xf
v_and_b32_dpp v73, v82, v9 row_newbcast:13 row_mask:0xf bank_mask:0xf
v_and_b32_dpp v74, v82, v10 row_newbcast:13 row_mask:0xf bank_mask:0xf
v_and_b32_dpp v75, v82, v11 row_newbcast:13 row_mask:0xf bank_mask:0xf
s_waitcnt vmcnt(35)
v_mfma_f32_16x16x32_bf16 v[20:23], v[60:63], v[200:203], v[20:23]
v_mfma_f32_16x16x32_bf16 v[20:23], v[64:67], v[204:207], v[20:23]
v_mfma_f32_16x16x32_bf16 v[20:23], v[68:71], v[208:211], v[20:23]
v_mfma_f32_16x16x32_bf16 v[20:23], v[72:75], v[212:215], v[20:23]
v_add_u32 v117, 1, v117
buffer_store_dword v117, v118, s[64:67], 0 offen
s_cmp_le_u32 s15, 33
s_cbranch_scc0 L_thr_17
s_waitcnt vmcnt(7)
L_thr_17:
buffer_load_dwordx4 v[200:203], v2, s[52:55], s12 offen offset:0 nt
buffer_load_dwordx4 v[204:207], v2, s[52:55], s12 offen offset:1024 nt
s_cbranch_scc0 L_thr_18
s_waitcnt vmcnt(7)
L_thr_18:
buffer_load_dwordx4 v[208:211], v2, s[52:55], s12 offen offset:2048 nt
buffer_load_dwordx4 v[212:215], v2, s[52:55], s12 offen offset:3072 nt
s_add_u32 s13, s13, 24576
s_min_u32 s12, s13, 2146435072
ds_read_b64_tr_b16 a[208:209], v90 offset:24
ds_read_b64_tr_b16 a[210:211], v90 offset:2328
ds_read_b64_tr_b16 a[212:213], v90 offset:18456
ds_read_b64_tr_b16 a[214:215], v90 offset:20760
v_and_b32_dpp v60, v77, v8 row_newbcast:1 row_mask:0xf bank_mask:0xf
v_and_b32_dpp v61, v77, v9 row_newbcast:1 row_mask:0xf bank_mask:0xf
v_and_b32_dpp v62, v77, v10 row_newbcast:1 row_mask:0xf bank_mask:0xf
v_and_b32_dpp v63, v77, v11 row_newbcast:1 row_mask:0xf bank_mask:0xf
v_and_b32_dpp v64, v77, v8 row_newbcast:5 row_mask:0xf bank_mask:0xf
v_and_b32_dpp v65, v77, v9 row_newbcast:5 row_mask:0xf bank_mask:0xf
v_and_b32_dpp v66, v77, v10 row_newbcast:5 row_mask:0xf bank_mask:0xf
v_and_b32_dpp v67, v77, v11 row_newbcast:5 row_mask:0xf bank_mask:0xf
v_and_b32_dpp v68, v77, v8 row_newbcast:9 row_mask:0xf bank_mask:0xf
v_and_b32_dpp v69, v77, v9 row_newbcast:9 row_mask:0xf bank_mask:0xf
v_and_b32_dpp v70, v77, v10 row_newbcast:9 row_mask:0xf bank_mask:0xf
v_and_b32_dpp v71, v77, v11 row_newbcast:9 row_mask:0xf bank_mask:0xf
v_and_b32_dpp v72, v77, v8 row_newbcast:13 row_mask:0xf bank_mask:0xf
v_and_b32_dpp v73, v77, v9 row_newbcast:13 row_mask:0xf bank_mask:0xf
v_and_b32_dpp v74, v77, v10 row_newbcast:13 row_mask:0xf bank_mask:0xf
v_and_b32_dpp v75, v77, v11 row_newbcast:13 row_mask:0xf bank_mask:0xf
v_mfma_f32_16x16x32_bf16 v[20:23], v[60:63], a[64:67], v[20:23]
v_mfma_f32_16x16x32_bf16 v[20:23], v[64:67], a[68:71], v[20:23]
v_mfma_f32_16x16x32_bf16 v[20:23], v[68:71], a[72:75], v[20:23]
v_mfma_f32_16x16x32_bf16 v[20:23], v[72:75], a[76:79], v[20:23]
s_nop 3
v_and_b32_dpp v60, v82, v8 row_newbcast:2 row_mask:0xf bank_mask:0xf
v_and_b32_dpp v61, v82, v9 row_newbcast:2 row_mask:0xf bank_mask:0xf
v_and_b32_dpp v62, v82, v10 row_newbcast:2 row_mask:0xf bank_mask:0xf
v_and_b32_dpp v63, v82, v11 row_newbcast:2 row_mask:0xf bank_mask:0xf
v_and_b32_dpp v64, v82, v8 row_newbcast:6 row_mask:0xf bank_mask:0xf
v_and_b32_dpp v65, v82, v9 row_newbcast:6 row_mask:0xf bank_mask:0xf
v_and_b32_dpp v66, v82, v10 row_newbcast:6 row_mask:0xf bank_mask:0xf
v_and_b32_dpp v67, v82, v11 row_newbcast:6 row_mask:0xf bank_mask:0xf
v_and_b32_dpp v68, v82, v8 row_newbcast:10 row_mask:0xf bank_mask:0xf
v_and_b32_dpp v69, v82, v9 row_newbcast:10 row_mask:0xf bank_mask:0xf
v_and_b32_dpp v70, v82, v10 row_newbcast:10 row_mask:0xf bank_mask:0xf
v_and_b32_dpp v71, v82, v11 row_newbcast:10 row_mask:0xf bank_mask:0xf
v_and_b32_dpp v72, v82, v8 row_newbcast:14 row_mask:0xf bank_mask:0xf
v_and_b32_dpp v73, v82, v9 row_newbcast:14 row_mask:0xf bank_mask:0xf
v_and_b32_dpp v74, v82, v10 row_newbcast:14 row_mask:0xf bank_mask:0xf
v_and_b32_dpp v75, v82, v11 row_newbcast:14 row_mask:0xf bank_mask:0xf
s_waitcnt vmcnt(35)
v_mfma_f32_16x16x32_bf16 v[20:23], v[60:63], v[216:219], v[20:23]
v_mfma_f32_16x16x32_bf16 v[20:23], v[64:67], v[220:223], v[20:23]
v_mfma_f32_16x16x32_bf16 v[20:23], v[68:71], v[224:227], v[20:23]
v_mfma_f32_16x16x32_bf16 v[20:23], v[72:75], v[228:231], v[20:23]
v_add_u32 v117, 1, v117
buffer_store_dword v117, v118, s[64:67], 0 offen
s_cmp_le_u32 s15, 34
s_cbranch_scc0 L_thr_19
s_waitcnt vmcnt(7)
L_thr_19:
buffer_load_dwordx4 v[216:219], v2, s[52:55], s12 offen offset:0 nt
buffer_load_dwordx4 v[220:223], v2, s[52:55], s12 offen offset:1024 nt
s_cbranch_scc0 L_thr_20
s_waitcnt vmcnt(7)
L_thr_20:
buffer_load_dwordx4 v[224:227], v2, s[52:55], s12 offen offset:2048 nt
buffer_load_dwordx4 v[228:231], v2, s[52:55], s12 offen offset:3072 nt
s_add_u32 s13, s13, 24576
s_min_u32 s12, s13, 2146435072
ds_read_b64_tr_b16 a[216:217], v90 offset:36888
ds_read_b64_tr_b16 a[218:219], v90 offset:39192
ds_read_b64_tr_b16 a[220:221], v90 offset:55320
ds_read_b64_tr_b16 a[222:223], v90 offset:57624
v_and_b32_dpp v60, v82, v8 row_newbcast:3 row_mask:0xf bank_mask:0xf
v_and_b32_dpp v61, v82, v9 row_newbcast:3 row_mask:0xf bank_mask:0xf
v_and_b32_dpp v62, v82, v10 row_newbcast:3 row_mask:0xf bank_mask:0xf
v_and_b32_dpp v63, v82, v11 row_newbcast:3 row_mask:0xf bank_mask:0xf
v_and_b32_dpp v64, v82, v8 row_newbcast:7 row_mask:0xf bank_mask:0xf
v_and_b32_dpp v65, v82, v9 row_newbcast:7 row_mask:0xf bank_mask:0xf
v_and_b32_dpp v66, v82, v10 row_newbcast:7 row_mask:0xf bank_mask:0xf
v_and_b32_dpp v67, v82, v11 row_newbcast:7 row_mask:0xf bank_mask:0xf
v_and_b32_dpp v68, v82, v8 row_newbcast:11 row_mask:0xf bank_mask:0xf
v_and_b32_dpp v69, v82, v9 row_newbcast:11 row_mask:0xf bank_mask:0xf
v_and_b32_dpp v70, v82, v10 row_newbcast:11 row_mask:0xf bank_mask:0xf
v_and_b32_dpp v71, v82, v11 row_newbcast:11 row_mask:0xf bank_mask:0xf
v_and_b32_dpp v72, v82, v8 row_newbcast:15 row_mask:0xf bank_mask:0xf
v_and_b32_dpp v73, v82, v9 row_newbcast:15 row_mask:0xf bank_mask:0xf
v_and_b32_dpp v74, v82, v10 row_newbcast:15 row_mask:0xf bank_mask:0xf
v_and_b32_dpp v75, v82, v11 row_newbcast:15 row_mask:0xf bank_mask:0xf
s_waitcnt vmcnt(35)
v_mfma_f32_16x16x32_bf16 v[20:23], v[60:63], v[232:235], v[20:23]
v_mfma_f32_16x16x32_bf16 v[20:23], v[64:67], v[236:239], v[20:23]
v_mfma_f32_16x16x32_bf16 v[20:23], v[68:71], v[240:243], v[20:23]
v_mfma_f32_16x16x32_bf16 v[20:23], v[72:75], v[244:247], v[20:23]
v_add_u32 v117, 1, v117
buffer_store_dword v117, v118, s[64:67], 0 offen
s_cmp_le_u32 s15, 35
s_cbranch_scc0 L_thr_21
s_waitcnt vmcnt(7)
L_thr_21:
buffer_load_dwordx4 v[232:235], v2, s[52:55], s12 offen offset:0 nt
buffer_load_dwordx4 v[236:239], v2, s[52:55], s12 offen offset:1024 nt
s_cbranch_scc0 L_thr_22
s_waitcnt vmcnt(7)
L_thr_22:
buffer_load_dwordx4 v[240:243], v2, s[52:55], s12 offen offset:2048 nt
buffer_load_dwordx4 v[244:247], v2, s[52:55], s12 offen offset:3072 nt
s_add_u32 s13, s13, 24576
s_min_u32 s12, s13, 2146435072
ds_read_b64_tr_b16 a[224:225], v89 offset:0
ds_read_b64_tr_b16 a[226:227], v89 offset:4608
ds_read_b64_tr_b16 a[228:229], v89 offset:36864
ds_read_b64_tr_b16 a[230:231], v89 offset:41472
buffer_load_dwordx4 v[40:43], off, s[64:67], s82 offset:0 sc1
buffer_load_dwordx4 v[44:47], off, s[64:67], s82 offset:16 sc1
buffer_load_dwordx4 v[48:51], off, s[64:67], s82 offset:32 sc1
v_and_b32_dpp v60, v83, v8 row_newbcast:0 row_mask:0xf bank_mask:0xf
v_and_b32_dpp v61, v83, v9 row_newbcast:0 row_mask:0xf bank_mask:0xf
v_and_b32_dpp v62, v83, v10 row_newbcast:0 row_mask:0xf bank_mask:0xf
v_and_b32_dpp v63, v83, v11 row_newbcast:0 row_mask:0xf bank_mask:0xf
v_and_b32_dpp v64, v83, v8 row_newbcast:4 row_mask:0xf bank_mask:0xf
v_and_b32_dpp v65, v83, v9 row_newbcast:4 row_mask:0xf bank_mask:0xf
v_and_b32_dpp v66, v83, v10 row_newbcast:4 row_mask:0xf bank_mask:0xf
v_and_b32_dpp v67, v83, v11 row_newbcast:4 row_mask:0xf bank_mask:0xf
v_and_b32_dpp v68, v83, v8 row_newbcast:8 row_mask:0xf bank_mask:0xf
v_and_b32_dpp v69, v83, v9 row_newbcast:8 row_mask:0xf bank_mask:0xf
v_and_b32_dpp v70, v83, v10 row_newbcast:8 row_mask:0xf bank_mask:0xf
v_and_b32_dpp v71, v83, v11 row_newbcast:8 row_mask:0xf bank_mask:0xf
v_and_b32_dpp v72, v83, v8 row_newbcast:12 row_mask:0xf bank_mask:0xf
v_and_b32_dpp v73, v83, v9 row_newbcast:12 row_mask:0xf bank_mask:0xf
v_and_b32_dpp v74, v83, v10 row_newbcast:12 row_mask:0xf bank_mask:0xf
v_and_b32_dpp v75, v83, v11 row_newbcast:12 row_mask:0xf bank_mask:0xf
s_waitcnt vmcnt(38)
v_mfma_f32_16x16x32_bf16 v[20:23], v[60:63], v[120:123], v[20:23]
v_mfma_f32_16x16x32_bf16 v[20:23], v[64:67], v[124:127], v[20:23]
v_mfma_f32_16x16x32_bf16 v[20:23], v[68:71], v[128:131], v[20:23]
v_mfma_f32_16x16x32_bf16 v[20:23], v[72:75], v[132:135], v[20:23]
v_add_u32 v117, 1, v117
buffer_store_dword v117, v118, s[64:67], 0 offen
s_cmp_le_u32 s15, 36
s_cbranch_scc0 L_thr_23
s_waitcnt vmcnt(7)
L_thr_23:
buffer_load_dwordx4 v[120:123], v2, s[52:55], s12 offen offset:0 nt
buffer_load_dwordx4 v[124:127], v2, s[52:55], s12 offen offset:1024 nt
s_cbranch_scc0 L_thr_24
s_waitcnt vmcnt(7)
L_thr_24:
buffer_load_dwordx4 v[128:131], v2, s[52:55], s12 offen offset:2048 nt
buffer_load_dwordx4 v[132:135], v2, s[52:55], s12 offen offset:3072 nt
s_add_u32 s13, s13, 24576
s_min_u32 s12, s13, 2146435072
ds_read_b64_tr_b16 a[232:233], v91 offset:0
ds_read_b64_tr_b16 a[234:235], v91 offset:4608
ds_read_b64_tr_b16 a[236:237], v91 offset:36864
ds_read_b64_tr_b16 a[238:239], v91 offset:41472
v_and_b32_dpp v60, v83, v8 row_newbcast:1 row_mask:0xf bank_mask:0xf
v_and_b32_dpp v61, v83, v9 row_newbcast:1 row_mask:0xf bank_mask:0xf
v_and_b32_dpp v62, v83, v10 row_newbcast:1 row_mask:0xf bank_mask:0xf
v_and_b32_dpp v63, v83, v11 row_newbcast:1 row_mask:0xf bank_mask:0xf
v_and_b32_dpp v64, v83, v8 row_newbcast:5 row_mask:0xf bank_mask:0xf
v_and_b32_dpp v65, v83, v9 row_newbcast:5 row_mask:0xf bank_mask:0xf
v_and_b32_dpp v66, v83, v10 row_newbcast:5 row_mask:0xf bank_mask:0xf
v_and_b32_dpp v67, v83, v11 row_newbcast:5 row_mask:0xf bank_mask:0xf
v_and_b32_dpp v68, v83, v8 row_newbcast:9 row_mask:0xf bank_mask:0xf
v_and_b32_dpp v69, v83, v9 row_newbcast:9 row_mask:0xf bank_mask:0xf
v_and_b32_dpp v70, v83, v10 row_newbcast:9 row_mask:0xf bank_mask:0xf
v_and_b32_dpp v71, v83, v11 row_newbcast:9 row_mask:0xf bank_mask:0xf
v_and_b32_dpp v72, v83, v8 row_newbcast:13 row_mask:0xf bank_mask:0xf
v_and_b32_dpp v73, v83, v9 row_newbcast:13 row_mask:0xf bank_mask:0xf
v_and_b32_dpp v74, v83, v10 row_newbcast:13 row_mask:0xf bank_mask:0xf
v_and_b32_dpp v75, v83, v11 row_newbcast:13 row_mask:0xf bank_mask:0xf
s_waitcnt vmcnt(38)
v_mfma_f32_16x16x32_bf16 v[20:23], v[60:63], v[136:139], v[20:23]
v_mfma_f32_16x16x32_bf16 v[20:23], v[64:67], v[140:143], v[20:23]
v_mfma_f32_16x16x32_bf16 v[20:23], v[68:71], v[144:147], v[20:23]
v_mfma_f32_16x16x32_bf16 v[20:23], v[72:75], v[148:151], v[20:23]
s_nop 3
v_and_b32_dpp v60, v83, v8 row_newbcast:2 row_mask:0xf bank_mask:0xf
v_and_b32_dpp v61, v83, v9 row_newbcast:2 row_mask:0xf bank_mask:0xf
v_and_b32_dpp v62, v83, v10 row_newbcast:2 row_mask:0xf bank_mask:0xf
v_and_b32_dpp v63, v83, v11 row_newbcast:2 row_mask:0xf bank_mask:0xf
v_and_b32_dpp v64, v83, v8 row_newbcast:6 row_mask:0xf bank_mask:0xf
v_and_b32_dpp v65, v83, v9 row_newbcast:6 row_mask:0xf bank_mask:0xf
v_and_b32_dpp v66, v83, v10 row_newbcast:6 row_mask:0xf bank_mask:0xf
v_and_b32_dpp v67, v83, v11 row_newbcast:6 row_mask:0xf bank_mask:0xf
v_and_b32_dpp v68, v83, v8 row_newbcast:10 row_mask:0xf bank_mask:0xf
v_and_b32_dpp v69, v83, v9 row_newbcast:10 row_mask:0xf bank_mask:0xf
v_and_b32_dpp v70, v83, v10 row_newbcast:10 row_mask:0xf bank_mask:0xf
v_and_b32_dpp v71, v83, v11 row_newbcast:10 row_mask:0xf bank_mask:0xf
v_and_b32_dpp v72, v83, v8 row_newbcast:14 row_mask:0xf bank_mask:0xf
v_and_b32_dpp v73, v83, v9 row_newbcast:14 row_mask:0xf bank_mask:0xf
v_and_b32_dpp v74, v83, v10 row_newbcast:14 row_mask:0xf bank_mask:0xf
v_and_b32_dpp v75, v83, v11 row_newbcast:14 row_mask:0xf bank_mask:0xf
s_waitcnt vmcnt(33)
v_mfma_f32_16x16x32_bf16 v[20:23], v[60:63], v[152:155], v[20:23]
v_mfma_f32_16x16x32_bf16 v[20:23], v[64:67], v[156:159], v[20:23]
v_mfma_f32_16x16x32_bf16 v[20:23], v[68:71], v[160:163], v[20:23]
v_mfma_f32_16x16x32_bf16 v[20:23], v[72:75], v[164:167], v[20:23]
v_add_u32 v117, 1, v117
buffer_store_dword v117, v118, s[64:67], 0 offen
s_cmp_le_u32 s15, 37
s_cbranch_scc0 L_thr_25
s_waitcnt vmcnt(7)
L_thr_25:
buffer_load_dwordx4 v[136:139], v2, s[52:55], s12 offen offset:0 nt
buffer_load_dwordx4 v[140:143], v2, s[52:55], s12 offen offset:1024 nt
s_cbranch_scc0 L_thr_26
s_waitcnt vmcnt(7)
L_thr_26:
buffer_load_dwordx4 v[144:147], v2, s[52:55], s12 offen offset:2048 nt
buffer_load_dwordx4 v[148:151], v2, s[52:55], s12 offen offset:3072 nt
s_add_u32 s13, s13, 24576
s_min_u32 s12, s13, 2146435072
v_and_b32_dpp v60, v77, v8 row_newbcast:2 row_mask:0xf bank_mask:0xf
v_and_b32_dpp v61, v77, v9 row_newbcast:2 row_mask:0xf bank_mask:0xf
v_and_b32_dpp v62, v77, v10 row_newbcast:2 row_mask:0xf bank_mask:0xf
v_and_b32_dpp v63, v77, v11 row_newbcast:2 row_mask:0xf bank_mask:0xf
v_and_b32_dpp v64, v77, v8 row_newbcast:6 row_mask:0xf bank_mask:0xf
v_and_b32_dpp v65, v77, v9 row_newbcast:6 row_mask:0xf bank_mask:0xf
v_and_b32_dpp v66, v77, v10 row_newbcast:6 row_mask:0xf bank_mask:0xf
v_and_b32_dpp v67, v77, v11 row_newbcast:6 row_mask:0xf bank_mask:0xf
v_and_b32_dpp v68, v77, v8 row_newbcast:10 row_mask:0xf bank_mask:0xf
v_and_b32_dpp v69, v77, v9 row_newbcast:10 row_mask:0xf bank_mask:0xf
v_and_b32_dpp v70, v77, v10 row_newbcast:10 row_mask:0xf bank_mask:0xf
v_and_b32_dpp v71, v77, v11 row_newbcast:10 row_mask:0xf bank_mask:0xf
v_and_b32_dpp v72, v77, v8 row_newbcast:14 row_mask:0xf bank_mask:0xf
v_and_b32_dpp v73, v77, v9 row_newbcast:14 row_mask:0xf bank_mask:0xf
v_and_b32_dpp v74, v77, v10 row_newbcast:14 row_mask:0xf bank_mask:0xf
v_and_b32_dpp v75, v77, v11 row_newbcast:14 row_mask:0xf bank_mask:0xf
v_mfma_f32_16x16x32_bf16 v[20:23], v[60:63], a[80:83], v[20:23]
v_mfma_f32_16x16x32_bf16 v[20:23], v[64:67], a[84:87], v[20:23]
v_mfma_f32_16x16x32_bf16 v[20:23], v[68:71], a[88:91], v[20:23]
v_mfma_f32_16x16x32_bf16 v[20:23], v[72:75], a[92:95], v[20:23]
s_nop 3
v_and_b32_dpp v60, v83, v8 row_newbcast:3 row_mask:0xf bank_mask:0xf
v_and_b32_dpp v61, v83, v9 row_newbcast:3 row_mask:0xf bank_mask:0xf
v_and_b32_dpp v62, v83, v10 row_newbcast:3 row_mask:0xf bank_mask:0xf
v_and_b32_dpp v63, v83, v11 row_newbcast:3 row_mask:0xf bank_mask:0xf
v_and_b32_dpp v64, v83, v8 row_newbcast:7 row_mask:0xf bank_mask:0xf
v_and_b32_dpp v65, v83, v9 row_newbcast:7 row_mask:0xf bank_mask:0xf
v_and_b32_dpp v66, v83, v10 row_newbcast:7 row_mask:0xf bank_mask:0xf
v_and_b32_dpp v67, v83, v11 row_newbcast:7 row_mask:0xf bank_mask:0xf
v_and_b32_dpp v68, v83, v8 row_newbcast:11 row_mask:0xf bank_mask:0xf
v_and_b32_dpp v69, v83, v9 row_newbcast:11 row_mask:0xf bank_mask:0xf
v_and_b32_dpp v70, v83, v10 row_newbcast:11 row_mask:0xf bank_mask:0xf
v_and_b32_dpp v71, v83, v11 row_newbcast:11 row_mask:0xf bank_mask:0xf
v_and_b32_dpp v72, v83, v8 row_newbcast:15 row_mask:0xf bank_mask:0xf
v_and_b32_dpp v73, v83, v9 row_newbcast:15 row_mask:0xf bank_mask:0xf
v_and_b32_dpp v74, v83, v10 row_newbcast:15 row_mask:0xf bank_mask:0xf
v_and_b32_dpp v75, v83, v11 row_newbcast:15 row_mask:0xf bank_mask:0xf
s_waitcnt vmcnt(33)
v_mfma_f32_16x16x32_bf16 v[20:23], v[60:63], v[168:171], v[20:23]
v_mfma_f32_16x16x32_bf16 v[20:23], v[64:67], v[172:175], v[20:23]
v_mfma_f32_16x16x32_bf16 v[20:23], v[68:71], v[176:179], v[20:23]
v_mfma_f32_16x16x32_bf16 v[20:23], v[72:75], v[180:183], v[20:23]
s_nop 3
v_and_b32_dpp v60, v84, v8 row_newbcast:0 row_mask:0xf bank_mask:0xf
v_and_b32_dpp v61, v84, v9 row_newbcast:0 row_mask:0xf bank_mask:0xf
v_and_b32_dpp v62, v84, v10 row_newbcast:0 row_mask:0xf bank_mask:0xf
v_and_b32_dpp v63, v84, v11 row_newbcast:0 row_mask:0xf bank_mask:0xf
v_and_b32_dpp v64, v84, v8 row_newbcast:4 row_mask:0xf bank_mask:0xf
v_and_b32_dpp v65, v84, v9 row_newbcast:4 row_mask:0xf bank_mask:0xf
v_and_b32_dpp v66, v84, v10 row_newbcast:4 row_mask:0xf bank_mask:0xf
v_and_b32_dpp v67, v84, v11 row_newbcast:4 row_mask:0xf bank_mask:0xf
v_and_b32_dpp v68, v84, v8 row_newbcast:8 row_mask:0xf bank_mask:0xf
v_and_b32_dpp v69, v84, v9 row_newbcast:8 row_mask:0xf bank_mask:0xf
v_and_b32_dpp v70, v84, v10 row_newbcast:8 row_mask:0xf bank_mask:0xf
v_and_b32_dpp v71, v84, v11 row_newbcast:8 row_mask:0xf bank_mask:0xf
v_and_b32_dpp v72, v84, v8 row_newbcast:12 row_mask:0xf bank_mask:0xf
v_and_b32_dpp v73, v84, v9 row_newbcast:12 row_mask:0xf bank_mask:0xf
v_and_b32_dpp v74, v84, v10 row_newbcast:12 row_mask:0xf bank_mask:0xf
v_and_b32_dpp v75, v84, v11 row_newbcast:12 row_mask:0xf bank_mask:0xf
s_waitcnt vmcnt(28)
v_mfma_f32_16x16x32_bf16 v[20:23], v[60:63], v[184:187], v[20:23]
v_mfma_f32_16x16x32_bf16 v[20:23], v[64:67], v[188:191], v[20:23]
v_mfma_f32_16x16x32_bf16 v[20:23], v[68:71], v[192:195], v[20:23]
v_mfma_f32_16x16x32_bf16 v[20:23], v[72:75], v[196:199], v[20:23]
v_add_u32 v117, 1, v117
buffer_store_dword v117, v118, s[64:67], 0 offen
s_cmp_le_u32 s15, 38
s_cbranch_scc0 L_thr_27
s_waitcnt vmcnt(7)
L_thr_27:
buffer_load_dwordx4 v[152:155], v2, s[52:55], s12 offen offset:0 nt
buffer_load_dwordx4 v[156:159], v2, s[52:55], s12 offen offset:1024 nt
s_cbranch_scc0 L_thr_28
s_waitcnt vmcnt(7)
L_thr_28:
buffer_load_dwordx4 v[160:163], v2, s[52:55], s12 offen offset:2048 nt
buffer_load_dwordx4 v[164:167], v2, s[52:55], s12 offen offset:3072 nt
s_add_u32 s13, s13, 24576
s_min_u32 s12, s13, 2146435072
v_and_b32_dpp v60, v84, v8 row_newbcast:1 row_mask:0xf bank_mask:0xf
v_and_b32_dpp v61, v84, v9 row_newbcast:1 row_mask:0xf bank_mask:0xf
v_and_b32_dpp v62, v84, v10 row_newbcast:1 row_mask:0xf bank_mask:0xf
v_and_b32_dpp v63, v84, v11 row_newbcast:1 row_mask:0xf bank_mask:0xf
v_and_b32_dpp v64, v84, v8 row_newbcast:5 row_mask:0xf bank_mask:0xf
v_and_b32_dpp v65, v84, v9 row_newbcast:5 row_mask:0xf bank_mask:0xf
v_and_b32_dpp v66, v84, v10 row_newbcast:5 row_mask:0xf bank_mask:0xf
v_and_b32_dpp v67, v84, v11 row_newbcast:5 row_mask:0xf bank_mask:0xf
v_and_b32_dpp v68, v84, v8 row_newbcast:9 row_mask:0xf bank_mask:0xf
v_and_b32_dpp v69, v84, v9 row_newbcast:9 row_mask:0xf bank_mask:0xf
v_and_b32_dpp v70, v84, v10 row_newbcast:9 row_mask:0xf bank_mask:0xf
v_and_b32_dpp v71, v84, v11 row_newbcast:9 row_mask:0xf bank_mask:0xf
v_and_b32_dpp v72, v84, v8 row_newbcast:13 row_mask:0xf bank_mask:0xf
v_and_b32_dpp v73, v84, v9 row_newbcast:13 row_mask:0xf bank_mask:0xf
v_and_b32_dpp v74, v84, v10 row_newbcast:13 row_mask:0xf bank_mask:0xf
v_and_b32_dpp v75, v84, v11 row_newbcast:13 row_mask:0xf bank_mask:0xf
s_waitcnt vmcnt(28)
v_mfma_f32_16x16x32_bf16 v[20:23], v[60:63], v[200:203], v[20:23]
v_mfma_f32_16x16x32_bf16 v[20:23], v[64:67], v[204:207], v[20:23]
v_mfma_f32_16x16x32_bf16 v[20:23], v[68:71], v[208:211], v[20:23]
v_mfma_f32_16x16x32_bf16 v[20:23], v[72:75], v[212:215], v[20:23]
s_nop 3
v_and_b32_dpp v60, v84, v8 row_newbcast:2 row_mask:0xf bank_mask:0xf
v_and_b32_dpp v61, v84, v9 row_newbcast:2 row_mask:0xf bank_mask:0xf
v_and_b32_dpp v62, v84, v10 row_newbcast:2 row_mask:0xf bank_mask:0xf
v_and_b32_dpp v63, v84, v11 row_newbcast:2 row_mask:0xf bank_mask:0xf
v_and_b32_dpp v64, v84, v8 row_newbcast:6 row_mask:0xf bank_mask:0xf
v_and_b32_dpp v65, v84, v9 row_newbcast:6 row_mask:0xf bank_mask:0xf
v_and_b32_dpp v66, v84, v10 row_newbcast:6 row_mask:0xf bank_mask:0xf
v_and_b32_dpp v67, v84, v11 row_newbcast:6 row_mask:0xf bank_mask:0xf
v_and_b32_dpp v68, v84, v8 row_newbcast:10 row_mask:0xf bank_mask:0xf
v_and_b32_dpp v69, v84, v9 row_newbcast:10 row_mask:0xf bank_mask:0xf
v_and_b32_dpp v70, v84, v10 row_newbcast:10 row_mask:0xf bank_mask:0xf
v_and_b32_dpp v71, v84, v11 row_newbcast:10 row_mask:0xf bank_mask:0xf
v_and_b32_dpp v72, v84, v8 row_newbcast:14 row_mask:0xf bank_mask:0xf
v_and_b32_dpp v73, v84, v9 row_newbcast:14 row_mask:0xf bank_mask:0xf
v_and_b32_dpp v74, v84, v10 row_newbcast:14 row_mask:0xf bank_mask:0xf
v_and_b32_dpp v75, v84, v11 row_newbcast:14 row_mask:0xf bank_mask:0xf
s_waitcnt vmcnt(23)
v_mfma_f32_16x16x32_bf16 v[20:23], v[60:63], v[216:219], v[20:23]
v_mfma_f32_16x16x32_bf16 v[20:23], v[64:67], v[220:223], v[20:23]
v_mfma_f32_16x16x32_bf16 v[20:23], v[68:71], v[224:227], v[20:23]
v_mfma_f32_16x16x32_bf16 v[20:23], v[72:75], v[228:231], v[20:23]
v_add_u32 v117, 1, v117
buffer_store_dword v117, v118, s[64:67], 0 offen
s_cmp_le_u32 s15, 39
s_cbranch_scc0 L_thr_29
s_waitcnt vmcnt(7)
L_thr_29:
buffer_load_dwordx4 v[168:171], v2, s[52:55], s12 offen offset:0 nt
buffer_load_dwordx4 v[172:175], v2, s[52:55], s12 offen offset:1024 nt
s_cbranch_scc0 L_thr_30
s_waitcnt vmcnt(7)
L_thr_30:
buffer_load_dwordx4 v[176:179], v2, s[52:55], s12 offen offset:2048 nt
buffer_load_dwordx4 v[180:183], v2, s[52:55], s12 offen offset:3072 nt
s_add_u32 s13, s13, 24576
s_min_u32 s12, s13, 2146435072
v_and_b32_dpp v60, v84, v8 row_newbcast:3 row_mask:0xf bank_mask:0xf
v_and_b32_dpp v61, v84, v9 row_newbcast:3 row_mask:0xf bank_mask:0xf
v_and_b32_dpp v62, v84, v10 row_newbcast:3 row_mask:0xf bank_mask:0xf
v_and_b32_dpp v63, v84, v11 row_newbcast:3 row_mask:0xf bank_mask:0xf
v_and_b32_dpp v64, v84, v8 row_newbcast:7 row_mask:0xf bank_mask:0xf
v_and_b32_dpp v65, v84, v9 row_newbcast:7 row_mask:0xf bank_mask:0xf
v_and_b32_dpp v66, v84, v10 row_newbcast:7 row_mask:0xf bank_mask:0xf
v_and_b32_dpp v67, v84, v11 row_newbcast:7 row_mask:0xf bank_mask:0xf
v_and_b32_dpp v68, v84, v8 row_newbcast:11 row_mask:0xf bank_mask:0xf
v_and_b32_dpp v69, v84, v9 row_newbcast:11 row_mask:0xf bank_mask:0xf
v_and_b32_dpp v70, v84, v10 row_newbcast:11 row_mask:0xf bank_mask:0xf
v_and_b32_dpp v71, v84, v11 row_newbcast:11 row_mask:0xf bank_mask:0xf
v_and_b32_dpp v72, v84, v8 row_newbcast:15 row_mask:0xf bank_mask:0xf
v_and_b32_dpp v73, v84, v9 row_newbcast:15 row_mask:0xf bank_mask:0xf
v_and_b32_dpp v74, v84, v10 row_newbcast:15 row_mask:0xf bank_mask:0xf
v_and_b32_dpp v75, v84, v11 row_newbcast:15 row_mask:0xf bank_mask:0xf
s_waitcnt vmcnt(23)
v_mfma_f32_16x16x32_bf16 v[20:23], v[60:63], v[232:235], v[20:23]
v_mfma_f32_16x16x32_bf16 v[20:23], v[64:67], v[236:239], v[20:23]
v_mfma_f32_16x16x32_bf16 v[20:23], v[68:71], v[240:243], v[20:23]
v_mfma_f32_16x16x32_bf16 v[20:23], v[72:75], v[244:247], v[20:23]
s_nop 3
v_and_b32_dpp v60, v85, v8 row_newbcast:0 row_mask:0xf bank_mask:0xf
v_and_b32_dpp v61, v85, v9 row_newbcast:0 row_mask:0xf bank_mask:0xf
v_and_b32_dpp v62, v85, v10 row_newbcast:0 row_mask:0xf bank_mask:0xf
v_and_b32_dpp v63, v85, v11 row_newbcast:0 row_mask:0xf bank_mask:0xf
v_and_b32_dpp v64, v85, v8 row_newbcast:4 row_mask:0xf bank_mask:0xf
v_and_b32_dpp v65, v85, v9 row_newbcast:4 row_mask:0xf bank_mask:0xf
v_and_b32_dpp v66, v85, v10 row_newbcast:4 row_mask:0xf bank_mask:0xf
v_and_b32_dpp v67, v85, v11 row_newbcast:4 row_mask:0xf bank_mask:0xf
v_and_b32_dpp v68, v85, v8 row_newbcast:8 row_mask:0xf bank_mask:0xf
v_and_b32_dpp v69, v85, v9 row_newbcast:8 row_mask:0xf bank_mask:0xf
v_and_b32_dpp v70, v85, v10 row_newbcast:8 row_mask:0xf bank_mask:0xf
v_and_b32_dpp v71, v85, v11 row_newbcast:8 row_mask:0xf bank_mask:0xf
v_and_b32_dpp v72, v85, v8 row_newbcast:12 row_mask:0xf bank_mask:0xf
v_and_b32_dpp v73, v85, v9 row_newbcast:12 row_mask:0xf bank_mask:0xf
v_and_b32_dpp v74, v85, v10 row_newbcast:12 row_mask:0xf bank_mask:0xf
v_and_b32_dpp v75, v85, v11 row_newbcast:12 row_mask:0xf bank_mask:0xf
s_waitcnt vmcnt(15)
v_mfma_f32_16x16x32_bf16 v[20:23], v[60:63], v[120:123], v[20:23]
v_mfma_f32_16x16x32_bf16 v[20:23], v[64:67], v[124:127], v[20:23]
v_mfma_f32_16x16x32_bf16 v[20:23], v[68:71], v[128:131], v[20:23]
v_mfma_f32_16x16x32_bf16 v[20:23], v[72:75], v[132:135], v[20:23]
v_add_u32 v117, 1, v117
buffer_store_dword v117, v118, s[64:67], 0 offen
s_cmp_le_u32 s15, 40
s_cbranch_scc0 L_thr_31
s_waitcnt vmcnt(7)
L_thr_31:
buffer_load_dwordx4 v[184:187], v2, s[52:55], s12 offen offset:0 nt
buffer_load_dwordx4 v[188:191], v2, s[52:55], s12 offen offset:1024 nt
s_cbranch_scc0 L_thr_32
s_waitcnt vmcnt(7)
L_thr_32:
buffer_load_dwordx4 v[192:195], v2, s[52:55], s12 offen offset:2048 nt
buffer_load_dwordx4 v[196:199], v2, s[52:55], s12 offen offset:3072 nt
s_add_u32 s13, s13, 24576
s_min_u32 s12, s13, 2146435072
s_mov_b32 s7, 400000
A_ev2_chk:
v_max3_u32 v35, v40, v41, v42
v_max3_u32 v35, v35, v43, v44
v_max3_u32 v35, v35, v45, v46
v_max3_u32 v35, v35, v47, v48
v_max3_u32 v35, v35, v49, v50
v_max_u32 v35, v35, v51
v_cmp_eq_u32 vcc, -1, v35
s_cbranch_vccz A_ev2_ok
buffer_load_dwordx4 v[40:43], off, s[64:67], s82 offset:0 sc1
buffer_load_dwordx4 v[44:47], off, s[64:67], s82 offset:16 sc1
buffer_load_dwordx4 v[48:51], off, s[64:67], s82 offset:32 sc1
s_waitcnt vmcnt(0)
s_sub_u32 s7, s7, 1
s_cmp_lg_u32 s7, 0
s_cbranch_scc1 A_ev2_chk
A_ev2_ok:
v_max3_f32 v35, v40, v42, v44
v_max3_f32 v36, v46, v48, v50
v_max_f32 v35, v35, v36
v_sub_f32 v40, v40, v35
v_sub_f32 v42, v42, v35
v_sub_f32 v44, v44, v35
v_sub_f32 v46, v46, v35
v_sub_f32 v48, v48, v35
v_sub_f32 v50, v50, v35
v_sub_f32 v37, v32, v35
v_exp_f32 v40, v40
v_exp_f32 v42, v42
v_exp_f32 v44, v44
v_exp_f32 v46, v46
v_exp_f32 v48, v48
v_exp_f32 v50, v50
v_exp_f32 v37, v37
v_mul_f32 v35, v40, v41
v_fma_f32 v35, v42, v43, v35
v_fma_f32 v35, v44, v45, v35
v_fma_f32 v35, v46, v47, v35
v_fma_f32 v35, v48, v49, v35
v_fma_f32 v35, v50, v51, v35
v_rcp_f32 v35, v35
s_nop 0
v_mul_f32 v37, v37, v35
v_and_b32_dpp v60, v85, v8 row_newbcast:1 row_mask:0xf bank_mask:0xf
v_and_b32_dpp v61, v85, v9 row_newbcast:1 row_mask:0xf bank_mask:0xf
v_and_b32_dpp v62, v85, v10 row_newbcast:1 row_mask:0xf bank_mask:0xf
v_and_b32_dpp v63, v85, v11 row_newbcast:1 row_mask:0xf bank_mask:0xf
v_and_b32_dpp v64, v85, v8 row_newbcast:5 row_mask:0xf bank_mask:0xf
v_and_b32_dpp v65, v85, v9 row_newbcast:5 row_mask:0xf bank_mask:0xf
v_and_b32_dpp v66, v85, v10 row_newbcast:5 row_mask:0xf bank_mask:0xf
v_and_b32_dpp v67, v85, v11 row_newbcast:5 row_mask:0xf bank_mask:0xf
v_and_b32_dpp v68, v85, v8 row_newbcast:9 row_mask:0xf bank_mask:0xf
v_and_b32_dpp v69, v85, v9 row_newbcast:9 row_mask:0xf bank_mask:0xf
v_and_b32_dpp v70, v85, v10 row_newbcast:9 row_mask:0xf bank_mask:0xf
v_and_b32_dpp v71, v85, v11 row_newbcast:9 row_mask:0xf bank_mask:0xf
v_and_b32_dpp v72, v85, v8 row_newbcast:13 row_mask:0xf bank_mask:0xf
v_and_b32_dpp v73, v85, v9 row_newbcast:13 row_mask:0xf bank_mask:0xf
v_and_b32_dpp v74, v85, v10 row_newbcast:13 row_mask:0xf bank_mask:0xf
v_and_b32_dpp v75, v85, v11 row_newbcast:13 row_mask:0xf bank_mask:0xf
s_waitcnt vmcnt(15)
v_mfma_f32_16x16x32_bf16 v[20:23], v[60:63], v[136:139], v[20:23]
v_mfma_f32_16x16x32_bf16 v[20:23], v[64:67], v[140:143], v[20:23]
v_mfma_f32_16x16x32_bf16 v[20:23], v[68:71], v[144:147], v[20:23]
v_mfma_f32_16x16x32_bf16 v[20:23], v[72:75], v[148:151], v[20:23]
v_add_u32 v117, 1, v117
buffer_store_dword v117, v118, s[64:67], 0 offen
s_cmp_le_u32 s15, 41
s_cbranch_scc0 L_thr_33
s_waitcnt vmcnt(7)
L_thr_33:
buffer_load_dwordx4 v[200:203], v2, s[52:55], s12 offen offset:0 nt
buffer_load_dwordx4 v[204:207], v2, s[52:55], s12 offen offset:1024 nt
s_cbranch_scc0 L_thr_34
s_waitcnt vmcnt(7)
L_thr_34:
buffer_load_dwordx4 v[208:211], v2, s[52:55], s12 offen offset:2048 nt
buffer_load_dwordx4 v[212:215], v2, s[52:55], s12 offen offset:3072 nt
s_add_u32 s13, s13, 24576
s_min_u32 s12, s13, 2146435072
v_and_b32_dpp v60, v77, v8 row_newbcast:3 row_mask:0xf bank_mask:0xf
v_and_b32_dpp v61, v77, v9 row_newbcast:3 row_mask:0xf bank_mask:0xf
v_and_b32_dpp v62, v77, v10 row_newbcast:3 row_mask:0xf bank_mask:0xf
v_and_b32_dpp v63, v77, v11 row_newbcast:3 row_mask:0xf bank_mask:0xf
v_and_b32_dpp v64, v77, v8 row_newbcast:7 row_mask:0xf bank_mask:0xf
v_and_b32_dpp v65, v77, v9 row_newbcast:7 row_mask:0xf bank_mask:0xf
v_and_b32_dpp v66, v77, v10 row_newbcast:7 row_mask:0xf bank_mask:0xf
v_and_b32_dpp v67, v77, v11 row_newbcast:7 row_mask:0xf bank_mask:0xf
v_and_b32_dpp v68, v77, v8 row_newbcast:11 row_mask:0xf bank_mask:0xf
v_and_b32_dpp v69, v77, v9 row_newbcast:11 row_mask:0xf bank_mask:0xf
v_and_b32_dpp v70, v77, v10 row_newbcast:11 row_mask:0xf bank_mask:0xf
v_and_b32_dpp v71, v77, v11 row_newbcast:11 row_mask:0xf bank_mask:0xf
v_and_b32_dpp v72, v77, v8 row_newbcast:15 row_mask:0xf bank_mask:0xf
v_and_b32_dpp v73, v77, v9 row_newbcast:15 row_mask:0xf bank_mask:0xf
v_and_b32_dpp v74, v77, v10 row_newbcast:15 row_mask:0xf bank_mask:0xf
v_and_b32_dpp v75, v77, v11 row_newbcast:15 row_mask:0xf bank_mask:0xf
v_mfma_f32_16x16x32_bf16 v[20:23], v[60:63], a[240:243], v[20:23]
v_mfma_f32_16x16x32_bf16 v[20:23], v[64:67], a[244:247], v[20:23]
v_mfma_f32_16x16x32_bf16 v[20:23], v[68:71], a[248:251], v[20:23]
v_mfma_f32_16x16x32_bf16 v[20:23], v[72:75], a[252:255], v[20:23]
s_nop 3
v_and_b32_dpp v60, v85, v8 row_newbcast:2 row_mask:0xf bank_mask:0xf
v_and_b32_dpp v61, v85, v9 row_newbcast:2 row_mask:0xf bank_mask:0xf
v_and_b32_dpp v62, v85, v10 row_newbcast:2 row_mask:0xf bank_mask:0xf
v_and_b32_dpp v63, v85, v11 row_newbcast:2 row_mask:0xf bank_mask:0xf
v_and_b32_dpp v64, v85, v8 row_newbcast:6 row_mask:0xf bank_mask:0xf
v_and_b32_dpp v65, v85, v9 row_newbcast:6 row_mask:0xf bank_mask:0xf
v_and_b32_dpp v66, v85, v10 row_newbcast:6 row_mask:0xf bank_mask:0xf
v_and_b32_dpp v67, v85, v11 row_newbcast:6 row_mask:0xf bank_mask:0xf
v_and_b32_dpp v68, v85, v8 row_newbcast:10 row_mask:0xf bank_mask:0xf
v_and_b32_dpp v69, v85, v9 row_newbcast:10 row_mask:0xf bank_mask:0xf
v_and_b32_dpp v70, v85, v10 row_newbcast:10 row_mask:0xf bank_mask:0xf
v_and_b32_dpp v71, v85, v11 row_newbcast:10 row_mask:0xf bank_mask:0xf
v_and_b32_dpp v72, v85, v8 row_newbcast:14 row_mask:0xf bank_mask:0xf
v_and_b32_dpp v73, v85, v9 row_newbcast:14 row_mask:0xf bank_mask:0xf
v_and_b32_dpp v74, v85, v10 row_newbcast:14 row_mask:0xf bank_mask:0xf
v_and_b32_dpp v75, v85, v11 row_newbcast:14 row_mask:0xf bank_mask:0xf
s_waitcnt vmcnt(15)
v_mfma_f32_16x16x32_bf16 v[20:23], v[60:63], v[152:155], v[20:23]
v_mfma_f32_16x16x32_bf16 v[20:23], v[64:67], v[156:159], v[20:23]
v_mfma_f32_16x16x32_bf16 v[20:23], v[68:71], v[160:163], v[20:23]
v_mfma_f32_16x16x32_bf16 v[20:23], v[72:75], v[164:167], v[20:23]
v_add_u32 v117, 1, v117
buffer_store_dword v117, v118, s[64:67], 0 offen
buffer_load_dwordx4 v[216:219], v2, s[52:55], s12 offen offset:0 nt
buffer_load_dwordx4 v[220:223], v2, s[52:55], s12 offen offset:1024 nt
buffer_load_dwordx4 v[224:227], v2, s[52:55], s12 offen offset:2048 nt
buffer_load_dwordx4 v[228:231], v2, s[52:55], s12 offen offset:3072 nt
s_add_u32 s13, s13, 24576
s_min_u32 s12, s13, 2146435072
v_and_b32_dpp v60, v85, v8 row_newbcast:3 row_mask:0xf bank_mask:0xf
v_and_b32_dpp v61, v85, v9 row_newbcast:3 row_mask:0xf bank_mask:0xf
v_and_b32_dpp v62, v85, v10 row_newbcast:3 row_mask:0xf bank_mask:0xf
v_and_b32_dpp v63, v85, v11 row_newbcast:3 row_mask:0xf bank_mask:0xf
v_and_b32_dpp v64, v85, v8 row_newbcast:7 row_mask:0xf bank_mask:0xf
v_and_b32_dpp v65, v85, v9 row_newbcast:7 row_mask:0xf bank_mask:0xf
v_and_b32_dpp v66, v85, v10 row_newbcast:7 row_mask:0xf bank_mask:0xf
v_and_b32_dpp v67, v85, v11 row_newbcast:7 row_mask:0xf bank_mask:0xf
v_and_b32_dpp v68, v85, v8 row_newbcast:11 row_mask:0xf bank_mask:0xf
v_and_b32_dpp v69, v85, v9 row_newbcast:11 row_mask:0xf bank_mask:0xf
v_and_b32_dpp v70, v85, v10 row_newbcast:11 row_mask:0xf bank_mask:0xf
v_and_b32_dpp v71, v85, v11 row_newbcast:11 row_mask:0xf bank_mask:0xf
v_and_b32_dpp v72, v85, v8 row_newbcast:15 row_mask:0xf bank_mask:0xf
v_and_b32_dpp v73, v85, v9 row_newbcast:15 row_mask:0xf bank_mask:0xf
v_and_b32_dpp v74, v85, v10 row_newbcast:15 row_mask:0xf bank_mask:0xf
v_and_b32_dpp v75, v85, v11 row_newbcast:15 row_mask:0xf bank_mask:0xf
s_waitcnt vmcnt(15)
v_mfma_f32_16x16x32_bf16 v[20:23], v[60:63], v[168:171], v[20:23]
v_mfma_f32_16x16x32_bf16 v[20:23], v[64:67], v[172:175], v[20:23]
v_mfma_f32_16x16x32_bf16 v[20:23], v[68:71], v[176:179], v[20:23]
v_mfma_f32_16x16x32_bf16 v[20:23], v[72:75], v[180:183], v[20:23]
v_add_u32 v117, 1, v117
buffer_store_dword v117, v118, s[64:67], 0 offen
buffer_load_dwordx4 v[232:235], v2, s[52:55], s12 offen offset:0 nt
buffer_load_dwordx4 v[236:239], v2, s[52:55], s12 offen offset:1024 nt
buffer_load_dwordx4 v[240:243], v2, s[52:55], s12 offen offset:2048 nt
buffer_load_dwordx4 v[244:247], v2, s[52:55], s12 offen offset:3072 nt
s_add_u32 s13, s13, 24576
s_min_u32 s12, s13, 2146435072
v_mov_b32 v40, 0
v_mov_b32 v41, 0
v_mov_b32 v42, 0
v_mov_b32 v43, 0
v_mov_b32 v44, 0
v_mov_b32 v45, 0
v_mov_b32 v46, 0
v_mov_b32 v47, 0
v_mov_b32 v48, 0
v_mov_b32 v49, 0
v_mov_b32 v50, 0
v_mov_b32 v51, 0
v_mov_b32 v52, 0
v_mov_b32 v53, 0
v_mov_b32 v54, 0
v_mov_b32 v55, 0
v_and_b32_dpp v120, v86, v8 row_newbcast:0 row_mask:0xf bank_mask:0xf
v_and_b32_dpp v121, v86, v9 row_newbcast:0 row_mask:0xf bank_mask:0xf
v_and_b32_dpp v122, v86, v10 row_newbcast:0 row_mask:0xf bank_mask:0xf
v_and_b32_dpp v123, v86, v11 row_newbcast:0 row_mask:0xf bank_mask:0xf
v_and_b32_dpp v124, v86, v8 row_newbcast:4 row_mask:0xf bank_mask:0xf
v_and_b32_dpp v125, v86, v9 row_newbcast:4 row_mask:0xf bank_mask:0xf
v_and_b32_dpp v126, v86, v10 row_newbcast:4 row_mask:0xf bank_mask:0xf
v_and_b32_dpp v127, v86, v11 row_newbcast:4 row_mask:0xf bank_mask:0xf
v_and_b32_dpp v128, v86, v8 row_newbcast:8 row_mask:0xf bank_mask:0xf
v_and_b32_dpp v129, v86, v9 row_newbcast:8 row_mask:0xf bank_mask:0xf
v_and_b32_dpp v130, v86, v10 row_newbcast:8 row_mask:0xf bank_mask:0xf
v_and_b32_dpp v131, v86, v11 row_newbcast:8 row_mask:0xf bank_mask:0xf
v_and_b32_dpp v132, v86, v8 row_newbcast:12 row_mask:0xf bank_mask:0xf
v_and_b32_dpp v133, v86, v9 row_newbcast:12 row_mask:0xf bank_mask:0xf
v_and_b32_dpp v134, v86, v10 row_newbcast:12 row_mask:0xf bank_mask:0xf
v_and_b32_dpp v135, v86, v11 row_newbcast:12 row_mask:0xf bank_mask:0xf
v_and_b32_dpp v136, v86, v8 row_newbcast:1 row_mask:0xf bank_mask:0xf
v_and_b32_dpp v137, v86, v9 row_newbcast:1 row_mask:0xf bank_mask:0xf
v_and_b32_dpp v138, v86, v10 row_newbcast:1 row_mask:0xf bank_mask:0xf
v_and_b32_dpp v139, v86, v11 row_newbcast:1 row_mask:0xf bank_mask:0xf
v_and_b32_dpp v140, v86, v8 row_newbcast:5 row_mask:0xf bank_mask:0xf
v_and_b32_dpp v141, v86, v9 row_newbcast:5 row_mask:0xf bank_mask:0xf
v_and_b32_dpp v142, v86, v10 row_newbcast:5 row_mask:0xf bank_mask:0xf
v_and_b32_dpp v143, v86, v11 row_newbcast:5 row_mask:0xf bank_mask:0xf
v_and_b32_dpp v144, v86, v8 row_newbcast:9 row_mask:0xf bank_mask:0xf
v_and_b32_dpp v145, v86, v9 row_newbcast:9 row_mask:0xf bank_mask:0xf
v_and_b32_dpp v146, v86, v10 row_newbcast:9 row_mask:0xf bank_mask:0xf
v_and_b32_dpp v147, v86, v11 row_newbcast:9 row_mask:0xf bank_mask:0xf
v_and_b32_dpp v148, v86, v8 row_newbcast:13 row_mask:0xf bank_mask:0xf
v_and_b32_dpp v149, v86, v9 row_newbcast:13 row_mask:0xf bank_mask:0xf
v_and_b32_dpp v150, v86, v10 row_newbcast:13 row_mask:0xf bank_mask:0xf
v_and_b32_dpp v151, v86, v11 row_newbcast:13 row_mask:0xf bank_mask:0xf
v_and_b32_dpp v152, v86, v8 row_newbcast:2 row_mask:0xf bank_mask:0xf
v_and_b32_dpp v153, v86, v9 row_newbcast:2 row_mask:0xf bank_mask:0xf
v_and_b32_dpp v154, v86, v10 row_newbcast:2 row_mask:0xf bank_mask:0xf
v_and_b32_dpp v155, v86, v11 row_newbcast:2 row_mask:0xf bank_mask:0xf
v_and_b32_dpp v156, v86, v8 row_newbcast:6 row_mask:0xf bank_mask:0xf
v_and_b32_dpp v157, v86, v9 row_newbcast:6 row_mask:0xf bank_mask:0xf
v_and_b32_dpp v158, v86, v10 row_newbcast:6 row_mask:0xf bank_mask:0xf
v_and_b32_dpp v159, v86, v11 row_newbcast:6 row_mask:0xf bank_mask:0xf
v_and_b32_dpp v160, v86, v8 row_newbcast:10 row_mask:0xf bank_mask:0xf
v_and_b32_dpp v161, v86, v9 row_newbcast:10 row_mask:0xf bank_mask:0xf
v_and_b32_dpp v162, v86, v10 row_newbcast:10 row_mask:0xf bank_mask:0xf
v_and_b32_dpp v163, v86, v11 row_newbcast:10 row_mask:0xf bank_mask:0xf
v_and_b32_dpp v164, v86, v8 row_newbcast:14 row_mask:0xf bank_mask:0xf
v_and_b32_dpp v165, v86, v9 row_newbcast:14 row_mask:0xf bank_mask:0xf
v_and_b32_dpp v166, v86, v10 row_newbcast:14 row_mask:0xf bank_mask:0xf
v_and_b32_dpp v167, v86, v11 row_newbcast:14 row_mask:0xf bank_mask:0xf
v_and_b32_dpp v168, v86, v8 row_newbcast:3 row_mask:0xf bank_mask:0xf
v_and_b32_dpp v169, v86, v9 row_newbcast:3 row_mask:0xf bank_mask:0xf
v_and_b32_dpp v170, v86, v10 row_newbcast:3 row_mask:0xf bank_mask:0xf
v_and_b32_dpp v171, v86, v11 row_newbcast:3 row_mask:0xf bank_mask:0xf
v_and_b32_dpp v172, v86, v8 row_newbcast:7 row_mask:0xf bank_mask:0xf
v_and_b32_dpp v173, v86, v9 row_newbcast:7 row_mask:0xf bank_mask:0xf
v_and_b32_dpp v174, v86, v10 row_newbcast:7 row_mask:0xf bank_mask:0xf
v_and_b32_dpp v175, v86, v11 row_newbcast:7 row_mask:0xf bank_mask:0xf
v_and_b32_dpp v176, v86, v8 row_newbcast:11 row_mask:0xf bank_mask:0xf
v_and_b32_dpp v177, v86, v9 row_newbcast:11 row_mask:0xf bank_mask:0xf
v_and_b32_dpp v178, v86, v10 row_newbcast:11 row_mask:0xf bank_mask:0xf
v_and_b32_dpp v179, v86, v11 row_newbcast:11 row_mask:0xf bank_mask:0xf
v_and_b32_dpp v180, v86, v8 row_newbcast:15 row_mask:0xf bank_mask:0xf
v_and_b32_dpp v181, v86, v9 row_newbcast:15 row_mask:0xf bank_mask:0xf
v_and_b32_dpp v182, v86, v10 row_newbcast:15 row_mask:0xf bank_mask:0xf
v_and_b32_dpp v183, v86, v11 row_newbcast:15 row_mask:0xf bank_mask:0xf
s_waitcnt vmcnt(15)
v_mfma_f32_16x16x32_bf16 v[20:23], v[120:123], v[184:187], v[20:23]
v_mfma_f32_16x16x32_bf16 v[20:23], v[124:127], v[188:191], v[20:23]
v_mfma_f32_16x16x32_bf16 v[20:23], v[128:131], v[192:195], v[20:23]
v_mfma_f32_16x16x32_bf16 v[20:23], v[132:135], v[196:199], v[20:23]
s_waitcnt vmcnt(10)
v_mfma_f32_16x16x32_bf16 v[20:23], v[136:139], v[200:203], v[20:23]
v_mfma_f32_16x16x32_bf16 v[20:23], v[140:143], v[204:207], v[20:23]
v_mfma_f32_16x16x32_bf16 v[20:23], v[144:147], v[208:211], v[20:23]
v_mfma_f32_16x16x32_bf16 v[20:23], v[148:151], v[212:215], v[20:23]
s_waitcnt vmcnt(5)
v_mfma_f32_16x16x32_bf16 v[20:23], v[152:155], v[216:219], v[20:23]
v_mfma_f32_16x16x32_bf16 v[20:23], v[156:159], v[220:223], v[20:23]
v_mfma_f32_16x16x32_bf16 v[20:23], v[160:163], v[224:227], v[20:23]
v_mfma_f32_16x16x32_bf16 v[20:23], v[164:167], v[228:231], v[20:23]
s_waitcnt vmcnt(3)
v_mfma_f32_16x16x32_bf16 v[20:23], v[168:171], v[232:235], v[20:23]
s_waitcnt vmcnt(2)
v_mfma_f32_16x16x32_bf16 v[20:23], v[172:175], v[236:239], v[20:23]
s_waitcnt vmcnt(1)
v_mfma_f32_16x16x32_bf16 v[20:23], v[176:179], v[240:243], v[20:23]
s_waitcnt vmcnt(0)
v_mfma_f32_16x16x32_bf16 v[20:23], v[180:183], v[244:247], v[20:23]
A_tail:
s_nop 7
v_mul_f32 v20, v20, v37
v_mul_f32 v21, v21, v37
v_mul_f32 v22, v22, v37
v_mul_f32 v23, v23, v37
v_cvt_pk_bf16_f32 v28, v20, v21
v_cvt_pk_bf16_f32 v29, v22, v23
ds_write_b64 v94, v[28:29]
s_waitcnt lgkmcnt(0)
s_barrier
ds_read_b128 a[0:3], v95 offset:0
ds_read_b128 a[4:7], v95 offset:64
ds_read_b128 a[8:11], v95 offset:128
ds_read_b128 a[12:15], v95 offset:192
s_waitcnt lgkmcnt(3)
v_mfma_f32_16x16x32_bf16 v[72:75], a[0:3], a[224:227], 0
s_waitcnt lgkmcnt(2)
v_mfma_f32_16x16x32_bf16 v[72:75], a[4:7], a[228:231], v[72:75]
s_waitcnt lgkmcnt(1)
v_mfma_f32_16x16x32_bf16 v[72:75], a[8:11], a[232:235], v[72:75]
s_waitcnt lgkmcnt(0)
v_mfma_f32_16x16x32_bf16 v[72:75], a[12:15], a[236:239], v[72:75]
v_smfmac_f32_16x16x64_bf16 v[40:43], a[0:3], a[96:103], v105
v_smfmac_f32_16x16x64_bf16 v[40:43], a[4:7], a[104:111], v105
v_smfmac_f32_16x16x64_bf16 v[40:43], a[8:11], a[112:119], v105
v_smfmac_f32_16x16x64_bf16 v[40:43], a[12:15], a[120:127], v105
v_smfmac_f32_16x16x64_bf16 v[44:47], a[0:3], a[128:135], v105
v_smfmac_f32_16x16x64_bf16 v[44:47], a[4:7], a[136:143], v105
v_smfmac_f32_16x16x64_bf16 v[44:47], a[8:11], a[144:151], v105
v_smfmac_f32_16x16x64_bf16 v[44:47], a[12:15], a[152:159], v105
v_pk_mul_f32 v[102:103], v[106:107], v[72:73]
v_pk_fma_f32 v[102:103], v[108:109], v[74:75], v[102:103]
v_smfmac_f32_16x16x64_bf16 v[48:51], a[0:3], a[160:167], v105
v_add_f32 v114, v102, v103
v_pk_mul_f32 v[102:103], v[106:107], v[40:41]
v_smfmac_f32_16x16x64_bf16 v[48:51], a[4:7], a[168:175], v105
v_pk_fma_f32 v[102:103], v[108:109], v[42:43], v[102:103]
v_mov_b32_dpp v29, v114 row_shl:2 row_mask:0xf bank_mask:0xf
v_smfmac_f32_16x16x64_bf16 v[48:51], a[8:11], a[176:183], v105
v_cvt_pk_bf16_f32 v28, v114, v29
v_min_u32 v28, -2, v28
v_smfmac_f32_16x16x64_bf16 v[48:51], a[12:15], a[184:191], v105
v_add_f32 v98, v102, v103
v_pk_mul_f32 v[102:103], v[106:107], v[44:45]
v_smfmac_f32_16x16x64_bf16 v[52:55], a[0:3], a[192:199], v105
v_mov_b32_dpp v29, v28 row_shl:4 row_mask:0xf bank_mask:0xf
v_mov_b32_dpp v30, v28 row_shl:8 row_mask:0xf bank_mask:0xf
v_smfmac_f32_16x16x64_bf16 v[52:55], a[4:7], a[200:207], v105
v_mov_b32_dpp v31, v28 row_shl:12 row_mask:0xf bank_mask:0xf
s_mov_b64 exec, 0x00030003
buffer_store_dwordx4 v[28:31], v93, s[64:67], 0 offen offset:1024 sc1
s_mov_b64 exec, -1
v_smfmac_f32_16x16x64_bf16 v[52:55], a[8:11], a[208:215], v105
v_pk_fma_f32 v[102:103], v[108:109], v[46:47], v[102:103]
v_add_f32 v99, v102, v103
v_smfmac_f32_16x16x64_bf16 v[52:55], a[12:15], a[216:223], v105
v_cvt_pk_bf16_f32 v110, v98, v99
v_min_u32 v110, -2, v110
v_pk_mul_f32 v[102:103], v[106:107], v[48:49]
v_pk_fma_f32 v[102:103], v[108:109], v[50:51], v[102:103]
v_add_f32 v100, v102, v103
v_permlane32_swap_b32 v110, v112
s_nop 1
v_pk_mul_f32 v[102:103], v[106:107], v[52:53]
v_pk_fma_f32 v[102:103], v[108:109], v[54:55], v[102:103]
v_add_f32 v101, v102, v103
v_cvt_pk_bf16_f32 v111, v100, v101
v_min_u32 v111, -2, v111
s_nop 1
v_permlane32_swap_b32 v111, v113
s_mov_b64 exec, 0xffffffff
buffer_store_dwordx4 v[110:113], v92, s[64:67], 0 offen sc1
s_mov_b64 exec, -1
s_endpgm
L_exit:
s_endpgm
B_role:
s_mov_b32 s8, s5
s_lshl_b32 s9, s4, 1
s_add_u32 s9, s9, s8
v_and_b32 v1, 63, v0
v_lshlrev_b32 v2, 4, v1
v_lshrrev_b32 v9, 4, v1
v_and_b32 v8, 15, v1
s_cmp_eq_u32 s8, 1
s_cbranch_scc1 D_role
v_mul_u32_u24 v3, 294912, v9
v_lshl_add_u32 v3, v8, 4, v3
v_mul_u32_u24 v4, 72, v9
v_lshrrev_b32 v6, 3, v8
v_mul_u32_u24 v6, 1152, v6
v_add_u32 v4, v4, v6
v_lshlrev_b32 v238, 17, v9
v_lshl_add_u32 v238, v8, 4, v238
s_waitcnt lgkmcnt(0)
s_mul_i32 s6, s3, 288
s_sub_u32 s7, 4608, s6
s_add_u32 s44, s26, s6
s_addc_u32 s45, s27, 0
s_mov_b32 s46, s7
s_mov_b32 s47, 0x20000
s_mul_i32 s6, s3, 1179648
s_lshl_b32 s7, s4, 8
s_add_u32 s6, s6, s7
s_sub_u32 s7, 4718592, s6
s_add_u32 s48, s30, s6
s_addc_u32 s49, s31, 0
s_mov_b32 s50, s7
s_mov_b32 s51, 0x20000
buffer_load_dwordx4 v[24:27], v4, s[44:47], 0 offen offset:0
buffer_load_dwordx4 v[28:31], v4, s[44:47], 0 offen offset:16
buffer_load_dwordx4 v[32:35], v4, s[44:47], 0 offen offset:32
buffer_load_dwordx4 v[36:39], v4, s[44:47], 0 offen offset:48
buffer_load_dwordx2 v[40:41], v4, s[44:47], 0 offen offset:64
buffer_load_dwordx4 v[44:47], v4, s[44:47], 0 offen offset:2304
buffer_load_dwordx4 v[48:51], v4, s[44:47], 0 offen offset:2320
buffer_load_dwordx4 v[52:55], v4, s[44:47], 0 offen offset:2336
buffer_load_dwordx4 v[56:59], v4, s[44:47], 0 offen offset:2352
buffer_load_dwordx2 v[60:61], v4, s[44:47], 0 offen offset:2368
s_mov_b32 s6, 0
buffer_load_dwordx4 a[96:99], v3, s[48:51], s6 offen nt
s_mov_b32 s6, 8192
buffer_load_dwordx4 a[100:103], v3, s[48:51], s6 offen nt
s_mov_b32 s6, 16384
buffer_load_dwordx4 a[104:107], v3, s[48:51], s6 offen nt
s_mov_b32 s6, 24576
buffer_load_dwordx4 a[108:111], v3, s[48:51], s6 offen nt
s_mov_b32 s6, 32768
buffer_load_dwordx4 a[112:115], v3, s[48:51], s6 offen nt
s_mov_b32 s6, 40960
buffer_load_dwordx4 a[116:119], v3, s[48:51], s6 offen nt
s_mov_b32 s6, 49152
buffer_load_dwordx4 a[120:123], v3, s[48:51], s6 offen nt
s_mov_b32 s6, 57344
buffer_load_dwordx4 a[124:127], v3, s[48:51], s6 offen nt
s_mov_b32 s6, 65536
buffer_load_dwordx4 a[128:131], v3, s[48:51], s6 offen nt
s_mov_b32 s6, 73728
buffer_load_dwordx4 a[132:135], v3, s[48:51], s6 offen nt
s_mov_b32 s6, 81920
buffer_load_dwordx4 a[136:139], v3, s[48:51], s6 offen nt
s_mov_b32 s6, 90112
buffer_load_dwordx4 a[140:143], v3, s[48:51], s6 offen nt
s_mov_b32 s6, 98304
buffer_load_dwordx4 a[144:147], v3, s[48:51], s6 offen nt
s_mov_b32 s6, 106496
buffer_load_dwordx4 a[148:151], v3, s[48:51], s6 offen nt
s_mov_b32 s6, 114688
buffer_load_dwordx4 a[152:155], v3, s[48:51], s6 offen nt
s_mov_b32 s6, 122880
buffer_load_dwordx4 a[156:159], v3, s[48:51], s6 offen nt
s_mov_b32 s6, 131072
buffer_load_dwordx4 a[160:163], v3, s[48:51], s6 offen nt
s_mov_b32 s6, 139264
buffer_load_dwordx4 a[164:167], v3, s[48:51], s6 offen nt
s_mov_b32 s6, 147456
buffer_load_dwordx4 a[168:171], v3, s[48:51], s6 offen nt
s_mov_b32 s6, 155648
buffer_load_dwordx4 a[172:175], v3, s[48:51], s6 offen nt
s_mov_b32 s6, 163840
buffer_load_dwordx4 a[176:179], v3, s[48:51], s6 offen nt
s_mov_b32 s6, 172032
buffer_load_dwordx4 a[180:183], v3, s[48:51], s6 offen nt
s_mov_b32 s6, 180224
buffer_load_dwordx4 a[184:187], v3, s[48:51], s6 offen nt
s_mov_b32 s6, 188416
buffer_load_dwordx4 a[188:191], v3, s[48:51], s6 offen nt
s_mov_b32 s6, 196608
buffer_load_dwordx4 a[192:195], v3, s[48:51], s6 offen nt
s_mov_b32 s6, 204800
buffer_load_dwordx4 a[196:199], v3, s[48:51], s6 offen nt
s_mov_b32 s6, 212992
buffer_load_dwordx4 a[200:203], v3, s[48:51], s6 offen nt
s_mov_b32 s6, 221184
buffer_load_dwordx4 a[204:207], v3, s[48:51], s6 offen nt
s_mov_b32 s6, 229376
buffer_load_dwordx4 a[208:211], v3, s[48:51], s6 offen nt
s_mov_b32 s6, 237568
buffer_load_dwordx4 a[212:215], v3, s[48:51], s6 offen nt
s_mov_b32 s6, 245760
buffer_load_dwordx4 a[216:219], v3, s[48:51], s6 offen nt
s_mov_b32 s6, 253952
buffer_load_dwordx4 a[220:223], v3, s[48:51], s6 offen nt
s_mov_b32 s6, 262144
buffer_load_dwordx4 a[224:227], v3, s[48:51], s6 offen nt
s_mov_b32 s6, 270336
buffer_load_dwordx4 a[228:231], v3, s[48:51], s6 offen nt
s_mov_b32 s6, 278528
buffer_load_dwordx4 a[232:235], v3, s[48:51], s6 offen nt
s_mov_b32 s6, 286720
buffer_load_dwordx4 a[236:239], v3, s[48:51], s6 offen nt
s_lshl_b32 s6, s3, 20
s_lshl_b32 s7, s4, 8
s_add_u32 s6, s6, s7
s_sub_u32 s7, 4194304, s6
s_add_u32 s76, s32, s6
s_addc_u32 s77, s33, 0
s_mov_b32 s78, s7
s_mov_b32 s79, 0x20000
s_add_u32 s52, s34, s6
s_addc_u32 s53, s35, 0
s_mov_b32 s54, s7
s_mov_b32 s55, 0x20000
s_mov_b32 s6, 0
buffer_load_dwordx4 v[88:91], v238, s[76:79], s6 offen nt
s_mov_b32 s6, 8192
buffer_load_dwordx4 v[92:95], v238, s[76:79], s6 offen nt
s_mov_b32 s6, 16384
buffer_load_dwordx4 v[96:99], v238, s[76:79], s6 offen nt
s_mov_b32 s6, 24576
buffer_load_dwordx4 v[100:103], v238, s[76:79], s6 offen nt
s_mov_b32 s6, 32768
buffer_load_dwordx4 v[104:107], v238, s[76:79], s6 offen nt
s_mov_b32 s6, 40960
buffer_load_dwordx4 v[108:111], v238, s[76:79], s6 offen nt
s_mov_b32 s6, 49152
buffer_load_dwordx4 v[112:115], v238, s[76:79], s6 offen nt
s_mov_b32 s6, 57344
buffer_load_dwordx4 v[116:119], v238, s[76:79], s6 offen nt
s_mov_b32 s6, 65536
buffer_load_dwordx4 v[120:123], v238, s[76:79], s6 offen nt
s_mov_b32 s6, 73728
buffer_load_dwordx4 v[124:127], v238, s[76:79], s6 offen nt
s_mov_b32 s6, 81920
buffer_load_dwordx4 v[128:131], v238, s[76:79], s6 offen nt
s_mov_b32 s6, 90112
buffer_load_dwordx4 v[132:135], v238, s[76:79], s6 offen nt
s_mov_b32 s64, s42
s_mov_b32 s65, s43
s_mov_b32 s66, 16777216
s_mov_b32 s67, 0x20000
s_mov_b32 s68, s40
s_mov_b32 s69, s41
s_mov_b32 s70, 256
s_mov_b32 s71, 0x20000
s_mov_b32 s72, s38
s_mov_b32 s73, s39
s_mov_b32 s74, 9216
s_mov_b32 s75, 0x20000
s_mul_i32 s6, s4, 147456
s_add_u32 s60, s36, s6
s_addc_u32 s61, s37, 0
s_mov_b32 s62, 147456
s_mov_b32 s63, 0x20000
v_and_b32 v5, 1, v1
v_lshlrev_b32 v5, 4, v5
v_mov_b32 v6, 0xffff
v_lshlrev_b32 v5, v5, v6
v_bfe_u32 v6, v1, 1, 2
v_cmp_eq_u32 vcc, 0, v6
s_nop 1
v_cndmask_b32 v12, 0, v5, vcc
v_cmp_eq_u32 vcc, 1, v6
s_nop 1
v_cndmask_b32 v13, 0, v5, vcc
v_cmp_eq_u32 vcc, 2, v6
s_nop 1
v_cndmask_b32 v14, 0, v5, vcc
v_cmp_eq_u32 vcc, 3, v6
s_nop 1
v_cndmask_b32 v15, 0, v5, vcc
v_mov_b32 v5, 0x0c0c0c0c
s_mov_b32 s6, 0x01000100
s_mov_b32 s7, 0x03020302
v_bfi_b32 v16, v12, s6, v5
v_bfi_b32 v17, v13, s6, v5
v_bfi_b32 v18, v14, s6, v5
v_bfi_b32 v19, v15, s6, v5
v_bfi_b32 v20, v12, s7, v5
v_bfi_b32 v21, v13, s7, v5
v_bfi_b32 v22, v14, s7, v5
v_bfi_b32 v23, v15, s7, v5
v_lshrrev_b32 v5, 4, v1
v_lshlrev_b32 v5, 3, v5
v_bfe_u32 v6, v1, 2, 2
v_add_u32 v5, v5, v6
v_mul_u32_u24 v5, 1152, v5
s_mul_i32 s6, s3, 288
v_add_u32 v5, s6, v5
v_and_b32 v6, 3, v1
v_lshl_add_u32 v240, v6, 5, v5
v_lshl_add_u32 v241, v6, 3, v5
v_add_u32 v241, 256, v241
v_add_u32 v242, 73728, v240
v_add_u32 v243, 73728, v241
s_mul_i32 s12, s3, 36864
s_waitcnt vmcnt(47)
v_perm_b32 v64, v24, v24, v16
v_perm_b32 v65, v24, v24, v17
v_perm_b32 v66, v24, v24, v18
v_perm_b32 v67, v24, v24, v19
s_nop 1
v_mfma_f32_16x16x32_bf16 v[80:83], v[64:67], a[96:99], 0
v_perm_b32 v68, v44, v44, v16
v_perm_b32 v69, v44, v44, v17
v_perm_b32 v70, v44, v44, v18
v_perm_b32 v71, v44, v44, v19
s_nop 1
v_mfma_f32_16x16x32_bf16 v[84:87], v[68:71], a[96:99], 0
s_mov_b32 s6, 98304
buffer_load_dwordx4 v[136:139], v238, s[76:79], s6 offen nt
s_waitcnt vmcnt(47)
v_perm_b32 v72, v24, v24, v20
v_perm_b32 v73, v24, v24, v21
v_perm_b32 v74, v24, v24, v22
v_perm_b32 v75, v24, v24, v23
s_nop 1
v_mfma_f32_16x16x32_bf16 v[80:83], v[72:75], a[100:103], v[80:83]
v_perm_b32 v76, v44, v44, v20
v_perm_b32 v77, v44, v44, v21
v_perm_b32 v78, v44, v44, v22
v_perm_b32 v79, v44, v44, v23
s_nop 1
v_mfma_f32_16x16x32_bf16 v[84:87], v[76:79], a[100:103], v[84:87]
s_mov_b32 s6, 106496
buffer_load_dwordx4 v[140:143], v238, s[76:79], s6 offen nt
s_waitcnt vmcnt(47)
v_perm_b32 v64, v25, v25, v16
v_perm_b32 v65, v25, v25, v17
v_perm_b32 v66, v25, v25, v18
v_perm_b32 v67, v25, v25, v19
s_nop 1
v_mfma_f32_16x16x32_bf16 v[80:83], v[64:67], a[104:107], v[80:83]
v_perm_b32 v68, v45, v45, v16
v_perm_b32 v69, v45, v45, v17
v_perm_b32 v70, v45, v45, v18
v_perm_b32 v71, v45, v45, v19
s_nop 1
v_mfma_f32_16x16x32_bf16 v[84:87], v[68:71], a[104:107], v[84:87]
s_mov_b32 s6, 114688
buffer_load_dwordx4 v[144:147], v238, s[76:79], s6 offen nt
s_waitcnt vmcnt(47)
v_perm_b32 v72, v25, v25, v20
v_perm_b32 v73, v25, v25, v21
v_perm_b32 v74, v25, v25, v22
v_perm_b32 v75, v25, v25, v23
s_nop 1
v_mfma_f32_16x16x32_bf16 v[80:83], v[72:75], a[108:111], v[80:83]
v_perm_b32 v76, v45, v45, v20
v_perm_b32 v77, v45, v45, v21
v_perm_b32 v78, v45, v45, v22
v_perm_b32 v79, v45, v45, v23
s_nop 1
v_mfma_f32_16x16x32_bf16 v[84:87], v[76:79], a[108:111], v[84:87]
s_mov_b32 s6, 122880
buffer_load_dwordx4 v[148:151], v238, s[76:79], s6 offen nt
s_waitcnt vmcnt(47)
v_perm_b32 v64, v26, v26, v16
v_perm_b32 v65, v26, v26, v17
v_perm_b32 v66, v26, v26, v18
v_perm_b32 v67, v26, v26, v19
s_nop 1
v_mfma_f32_16x16x32_bf16 v[80:83], v[64:67], a[112:115], v[80:83]
v_perm_b32 v68, v46, v46, v16
v_perm_b32 v69, v46, v46, v17
v_perm_b32 v70, v46, v46, v18
v_perm_b32 v71, v46, v46, v19
s_nop 1
v_mfma_f32_16x16x32_bf16 v[84:87], v[68:71], a[112:115], v[84:87]
s_mov_b32 s6, 524288
buffer_load_dwordx4 v[152:155], v238, s[76:79], s6 offen nt
s_waitcnt vmcnt(47)
v_perm_b32 v72, v26, v26, v20
v_perm_b32 v73, v26, v26, v21
v_perm_b32 v74, v26, v26, v22
v_perm_b32 v75, v26, v26, v23
s_nop 1
v_mfma_f32_16x16x32_bf16 v[80:83], v[72:75], a[116:119], v[80:83]
v_perm_b32 v76, v46, v46, v20
v_perm_b32 v77, v46, v46, v21
v_perm_b32 v78, v46, v46, v22
v_perm_b32 v79, v46, v46, v23
s_nop 1
v_mfma_f32_16x16x32_bf16 v[84:87], v[76:79], a[116:119], v[84:87]
s_mov_b32 s6, 532480
buffer_load_dwordx4 v[156:159], v238, s[76:79], s6 offen nt
s_waitcnt vmcnt(47)
v_perm_b32 v64, v27, v27, v16
v_perm_b32 v65, v27, v27, v17
v_perm_b32 v66, v27, v27, v18
v_perm_b32 v67, v27, v27, v19
s_nop 1
v_mfma_f32_16x16x32_bf16 v[80:83], v[64:67], a[120:123], v[80:83]
v_perm_b32 v68, v47, v47, v16
v_perm_b32 v69, v47, v47, v17
v_perm_b32 v70, v47, v47, v18
v_perm_b32 v71, v47, v47, v19
s_nop 1
v_mfma_f32_16x16x32_bf16 v[84:87], v[68:71], a[120:123], v[84:87]
s_mov_b32 s6, 540672
buffer_load_dwordx4 v[160:163], v238, s[76:79], s6 offen nt
s_waitcnt vmcnt(47)
v_perm_b32 v72, v27, v27, v20
v_perm_b32 v73, v27, v27, v21
v_perm_b32 v74, v27, v27, v22
v_perm_b32 v75, v27, v27, v23
s_nop 1
v_mfma_f32_16x16x32_bf16 v[80:83], v[72:75], a[124:127], v[80:83]
v_perm_b32 v76, v47, v47, v20
v_perm_b32 v77, v47, v47, v21
v_perm_b32 v78, v47, v47, v22
v_perm_b32 v79, v47, v47, v23
s_nop 1
v_mfma_f32_16x16x32_bf16 v[84:87], v[76:79], a[124:127], v[84:87]
s_mov_b32 s6, 548864
buffer_load_dwordx4 v[164:167], v238, s[76:79], s6 offen nt
s_waitcnt vmcnt(47)
v_perm_b32 v64, v28, v28, v16
v_perm_b32 v65, v28, v28, v17
v_perm_b32 v66, v28, v28, v18
v_perm_b32 v67, v28, v28, v19
s_nop 1
v_mfma_f32_16x16x32_bf16 v[80:83], v[64:67], a[128:131], v[80:83]
v_perm_b32 v68, v48, v48, v16
v_perm_b32 v69, v48, v48, v17
v_perm_b32 v70, v48, v48, v18
v_perm_b32 v71, v48, v48, v19
s_nop 1
v_mfma_f32_16x16x32_bf16 v[84:87], v[68:71], a[128:131], v[84:87]
s_mov_b32 s6, 557056
buffer_load_dwordx4 v[168:171], v238, s[76:79], s6 offen nt
s_waitcnt vmcnt(47)
v_perm_b32 v72, v28, v28, v20
v_perm_b32 v73, v28, v28, v21
v_perm_b32 v74, v28, v28, v22
v_perm_b32 v75, v28, v28, v23
s_nop 1
v_mfma_f32_16x16x32_bf16 v[80:83], v[72:75], a[132:135], v[80:83]
v_perm_b32 v76, v48, v48, v20
v_perm_b32 v77, v48, v48, v21
v_perm_b32 v78, v48, v48, v22
v_perm_b32 v79, v48, v48, v23
s_nop 1
v_mfma_f32_16x16x32_bf16 v[84:87], v[76:79], a[132:135], v[84:87]
s_mov_b32 s6, 565248
buffer_load_dwordx4 v[172:175], v238, s[76:79], s6 offen nt
s_waitcnt vmcnt(47)
v_perm_b32 v64, v29, v29, v16
v_perm_b32 v65, v29, v29, v17
v_perm_b32 v66, v29, v29, v18
v_perm_b32 v67, v29, v29, v19
s_nop 1
v_mfma_f32_16x16x32_bf16 v[80:83], v[64:67], a[136:139], v[80:83]
v_perm_b32 v68, v49, v49, v16
v_perm_b32 v69, v49, v49, v17
v_perm_b32 v70, v49, v49, v18
v_perm_b32 v71, v49, v49, v19
s_nop 1
v_mfma_f32_16x16x32_bf16 v[84:87], v[68:71], a[136:139], v[84:87]
s_mov_b32 s6, 573440
buffer_load_dwordx4 v[176:179], v238, s[76:79], s6 offen nt
s_waitcnt vmcnt(47)
v_perm_b32 v72, v29, v29, v20
v_perm_b32 v73, v29, v29, v21
v_perm_b32 v74, v29, v29, v22
v_perm_b32 v75, v29, v29, v23
s_nop 1
v_mfma_f32_16x16x32_bf16 v[80:83], v[72:75], a[140:143], v[80:83]
v_perm_b32 v76, v49, v49, v20
v_perm_b32 v77, v49, v49, v21
v_perm_b32 v78, v49, v49, v22
v_perm_b32 v79, v49, v49, v23
s_nop 1
v_mfma_f32_16x16x32_bf16 v[84:87], v[76:79], a[140:143], v[84:87]
s_mov_b32 s6, 581632
buffer_load_dwordx4 v[180:183], v238, s[76:79], s6 offen nt
s_waitcnt vmcnt(47)
v_perm_b32 v64, v30, v30, v16
v_perm_b32 v65, v30, v30, v17
v_perm_b32 v66, v30, v30, v18
v_perm_b32 v67, v30, v30, v19
s_nop 1
v_mfma_f32_16x16x32_bf16 v[80:83], v[64:67], a[144:147], v[80:83]
v_perm_b32 v68, v50, v50, v16
v_perm_b32 v69, v50, v50, v17
v_perm_b32 v70, v50, v50, v18
v_perm_b32 v71, v50, v50, v19
s_nop 1
v_mfma_f32_16x16x32_bf16 v[84:87], v[68:71], a[144:147], v[84:87]
s_mov_b32 s6, 589824
buffer_load_dwordx4 v[184:187], v238, s[76:79], s6 offen nt
s_waitcnt vmcnt(47)
v_perm_b32 v72, v30, v30, v20
v_perm_b32 v73, v30, v30, v21
v_perm_b32 v74, v30, v30, v22
v_perm_b32 v75, v30, v30, v23
s_nop 1
v_mfma_f32_16x16x32_bf16 v[80:83], v[72:75], a[148:151], v[80:83]
v_perm_b32 v76, v50, v50, v20
v_perm_b32 v77, v50, v50, v21
v_perm_b32 v78, v50, v50, v22
v_perm_b32 v79, v50, v50, v23
s_nop 1
v_mfma_f32_16x16x32_bf16 v[84:87], v[76:79], a[148:151], v[84:87]
s_mov_b32 s6, 598016
buffer_load_dwordx4 v[188:191], v238, s[76:79], s6 offen nt
s_waitcnt vmcnt(47)
v_perm_b32 v64, v31, v31, v16
v_perm_b32 v65, v31, v31, v17
v_perm_b32 v66, v31, v31, v18
v_perm_b32 v67, v31, v31, v19
s_nop 1
v_mfma_f32_16x16x32_bf16 v[80:83], v[64:67], a[152:155], v[80:83]
v_perm_b32 v68, v51, v51, v16
v_perm_b32 v69, v51, v51, v17
v_perm_b32 v70, v51, v51, v18
v_perm_b32 v71, v51, v51, v19
s_nop 1
v_mfma_f32_16x16x32_bf16 v[84:87], v[68:71], a[152:155], v[84:87]
s_mov_b32 s6, 606208
buffer_load_dwordx4 v[192:195], v238, s[76:79], s6 offen nt
s_waitcnt vmcnt(47)
v_perm_b32 v72, v31, v31, v20
v_perm_b32 v73, v31, v31, v21
v_perm_b32 v74, v31, v31, v22
v_perm_b32 v75, v31, v31, v23
s_nop 1
v_mfma_f32_16x16x32_bf16 v[80:83], v[72:75], a[156:159], v[80:83]
v_perm_b32 v76, v51, v51, v20
v_perm_b32 v77, v51, v51, v21
v_perm_b32 v78, v51, v51, v22
v_perm_b32 v79, v51, v51, v23
s_nop 1
v_mfma_f32_16x16x32_bf16 v[84:87], v[76:79], a[156:159], v[84:87]
s_mov_b32 s6, 614400
buffer_load_dwordx4 v[196:199], v238, s[76:79], s6 offen nt
s_waitcnt vmcnt(47)
v_perm_b32 v64, v32, v32, v16
v_perm_b32 v65, v32, v32, v17
v_perm_b32 v66, v32, v32, v18
v_perm_b32 v67, v32, v32, v19
s_nop 1
v_mfma_f32_16x16x32_bf16 v[80:83], v[64:67], a[160:163], v[80:83]
v_perm_b32 v68, v52, v52, v16
v_perm_b32 v69, v52, v52, v17
v_perm_b32 v70, v52, v52, v18
v_perm_b32 v71, v52, v52, v19
s_nop 1
v_mfma_f32_16x16x32_bf16 v[84:87], v[68:71], a[160:163], v[84:87]
s_mov_b32 s6, 622592
buffer_load_dwordx4 v[200:203], v238, s[76:79], s6 offen nt
s_waitcnt vmcnt(47)
v_perm_b32 v72, v32, v32, v20
v_perm_b32 v73, v32, v32, v21
v_perm_b32 v74, v32, v32, v22
v_perm_b32 v75, v32, v32, v23
s_nop 1
v_mfma_f32_16x16x32_bf16 v[80:83], v[72:75], a[164:167], v[80:83]
v_perm_b32 v76, v52, v52, v20
v_perm_b32 v77, v52, v52, v21
v_perm_b32 v78, v52, v52, v22
v_perm_b32 v79, v52, v52, v23
s_nop 1
v_mfma_f32_16x16x32_bf16 v[84:87], v[76:79], a[164:167], v[84:87]
s_mov_b32 s6, 630784
buffer_load_dwordx4 v[204:207], v238, s[76:79], s6 offen nt
s_waitcnt vmcnt(47)
v_perm_b32 v64, v33, v33, v16
v_perm_b32 v65, v33, v33, v17
v_perm_b32 v66, v33, v33, v18
v_perm_b32 v67, v33, v33, v19
s_nop 1
v_mfma_f32_16x16x32_bf16 v[80:83], v[64:67], a[168:171], v[80:83]
v_perm_b32 v68, v53, v53, v16
v_perm_b32 v69, v53, v53, v17
v_perm_b32 v70, v53, v53, v18
v_perm_b32 v71, v53, v53, v19
s_nop 1
v_mfma_f32_16x16x32_bf16 v[84:87], v[68:71], a[168:171], v[84:87]
s_mov_b32 s6, 638976
buffer_load_dwordx4 v[208:211], v238, s[76:79], s6 offen nt
s_waitcnt vmcnt(47)
v_perm_b32 v72, v33, v33, v20
v_perm_b32 v73, v33, v33, v21
v_perm_b32 v74, v33, v33, v22
v_perm_b32 v75, v33, v33, v23
s_nop 1
v_mfma_f32_16x16x32_bf16 v[80:83], v[72:75], a[172:175], v[80:83]
v_perm_b32 v76, v53, v53, v20
v_perm_b32 v77, v53, v53, v21
v_perm_b32 v78, v53, v53, v22
v_perm_b32 v79, v53, v53, v23
s_nop 1
v_mfma_f32_16x16x32_bf16 v[84:87], v[76:79], a[172:175], v[84:87]
s_mov_b32 s6, 647168
buffer_load_dwordx4 v[212:215], v238, s[76:79], s6 offen nt
s_waitcnt vmcnt(47)
v_perm_b32 v64, v34, v34, v16
v_perm_b32 v65, v34, v34, v17
v_perm_b32 v66, v34, v34, v18
v_perm_b32 v67, v34, v34, v19
s_nop 1
v_mfma_f32_16x16x32_bf16 v[80:83], v[64:67], a[176:179], v[80:83]
v_perm_b32 v68, v54, v54, v16
v_perm_b32 v69, v54, v54, v17
v_perm_b32 v70, v54, v54, v18
v_perm_b32 v71, v54, v54, v19
s_nop 1
v_mfma_f32_16x16x32_bf16 v[84:87], v[68:71], a[176:179], v[84:87]
buffer_load_dword v11, off, s[68:71], 0 offset:0 sc1
s_waitcnt vmcnt(47)
v_perm_b32 v72, v34, v34, v20
v_perm_b32 v73, v34, v34, v21
v_perm_b32 v74, v34, v34, v22
v_perm_b32 v75, v34, v34, v23
s_nop 1
v_mfma_f32_16x16x32_bf16 v[80:83], v[72:75], a[180:183], v[80:83]
v_perm_b32 v76, v54, v54, v20
v_perm_b32 v77, v54, v54, v21
v_perm_b32 v78, v54, v54, v22
v_perm_b32 v79, v54, v54, v23
s_nop 1
v_mfma_f32_16x16x32_bf16 v[84:87], v[76:79], a[180:183], v[84:87]
s_waitcnt vmcnt(46)
v_perm_b32 v64, v35, v35, v16
v_perm_b32 v65, v35, v35, v17
v_perm_b32 v66, v35, v35, v18
v_perm_b32 v67, v35, v35, v19
s_nop 1
v_mfma_f32_16x16x32_bf16 v[80:83], v[64:67], a[184:187], v[80:83]
v_perm_b32 v68, v55, v55, v16
v_perm_b32 v69, v55, v55, v17
v_perm_b32 v70, v55, v55, v18
v_perm_b32 v71, v55, v55, v19
s_nop 1
v_mfma_f32_16x16x32_bf16 v[84:87], v[68:71], a[184:187], v[84:87]
s_waitcnt vmcnt(45)
v_perm_b32 v72, v35, v35, v20
v_perm_b32 v73, v35, v35, v21
v_perm_b32 v74, v35, v35, v22
v_perm_b32 v75, v35, v35, v23
s_nop 1
v_mfma_f32_16x16x32_bf16 v[80:83], v[72:75], a[188:191], v[80:83]
v_perm_b32 v76, v55, v55, v20
v_perm_b32 v77, v55, v55, v21
v_perm_b32 v78, v55, v55, v22
v_perm_b32 v79, v55, v55, v23
s_nop 1
v_mfma_f32_16x16x32_bf16 v[84:87], v[76:79], a[188:191], v[84:87]
s_waitcnt vmcnt(44)
v_perm_b32 v64, v36, v36, v16
v_perm_b32 v65, v36, v36, v17
v_perm_b32 v66, v36, v36, v18
v_perm_b32 v67, v36, v36, v19
s_nop 1
v_mfma_f32_16x16x32_bf16 v[80:83], v[64:67], a[192:195], v[80:83]
v_perm_b32 v68, v56, v56, v16
v_perm_b32 v69, v56, v56, v17
v_perm_b32 v70, v56, v56, v18
v_perm_b32 v71, v56, v56, v19
s_nop 1
v_mfma_f32_16x16x32_bf16 v[84:87], v[68:71], a[192:195], v[84:87]
s_waitcnt vmcnt(43)
v_perm_b32 v72, v36, v36, v20
v_perm_b32 v73, v36, v36, v21
v_perm_b32 v74, v36, v36, v22
v_perm_b32 v75, v36, v36, v23
s_nop 1
v_mfma_f32_16x16x32_bf16 v[80:83], v[72:75], a[196:199], v[80:83]
v_perm_b32 v76, v56, v56, v20
v_perm_b32 v77, v56, v56, v21
v_perm_b32 v78, v56, v56, v22
v_perm_b32 v79, v56, v56, v23
s_nop 1
v_mfma_f32_16x16x32_bf16 v[84:87], v[76:79], a[196:199], v[84:87]
s_waitcnt vmcnt(42)
v_perm_b32 v64, v37, v37, v16
v_perm_b32 v65, v37, v37, v17
v_perm_b32 v66, v37, v37, v18
v_perm_b32 v67, v37, v37, v19
s_nop 1
v_mfma_f32_16x16x32_bf16 v[80:83], v[64:67], a[200:203], v[80:83]
v_perm_b32 v68, v57, v57, v16
v_perm_b32 v69, v57, v57, v17
v_perm_b32 v70, v57, v57, v18
v_perm_b32 v71, v57, v57, v19
s_nop 1
v_mfma_f32_16x16x32_bf16 v[84:87], v[68:71], a[200:203], v[84:87]
s_waitcnt vmcnt(41)
v_perm_b32 v72, v37, v37, v20
v_perm_b32 v73, v37, v37, v21
v_perm_b32 v74, v37, v37, v22
v_perm_b32 v75, v37, v37, v23
s_nop 1
v_mfma_f32_16x16x32_bf16 v[80:83], v[72:75], a[204:207], v[80:83]
v_perm_b32 v76, v57, v57, v20
v_perm_b32 v77, v57, v57, v21
v_perm_b32 v78, v57, v57, v22
v_perm_b32 v79, v57, v57, v23
s_nop 1
v_mfma_f32_16x16x32_bf16 v[84:87], v[76:79], a[204:207], v[84:87]
s_waitcnt vmcnt(40)
v_perm_b32 v64, v38, v38, v16
v_perm_b32 v65, v38, v38, v17
v_perm_b32 v66, v38, v38, v18
v_perm_b32 v67, v38, v38, v19
s_nop 1
v_mfma_f32_16x16x32_bf16 v[80:83], v[64:67], a[208:211], v[80:83]
v_perm_b32 v68, v58, v58, v16
v_perm_b32 v69, v58, v58, v17
v_perm_b32 v70, v58, v58, v18
v_perm_b32 v71, v58, v58, v19
s_nop 1
v_mfma_f32_16x16x32_bf16 v[84:87], v[68:71], a[208:211], v[84:87]
s_waitcnt vmcnt(39)
v_perm_b32 v72, v38, v38, v20
v_perm_b32 v73, v38, v38, v21
v_perm_b32 v74, v38, v38, v22
v_perm_b32 v75, v38, v38, v23
s_nop 1
v_mfma_f32_16x16x32_bf16 v[80:83], v[72:75], a[212:215], v[80:83]
v_perm_b32 v76, v58, v58, v20
v_perm_b32 v77, v58, v58, v21
v_perm_b32 v78, v58, v58, v22
v_perm_b32 v79, v58, v58, v23
s_nop 1
v_mfma_f32_16x16x32_bf16 v[84:87], v[76:79], a[212:215], v[84:87]
s_waitcnt vmcnt(38)
v_perm_b32 v64, v39, v39, v16
v_perm_b32 v65, v39, v39, v17
v_perm_b32 v66, v39, v39, v18
v_perm_b32 v67, v39, v39, v19
s_nop 1
v_mfma_f32_16x16x32_bf16 v[80:83], v[64:67], a[216:219], v[80:83]
v_perm_b32 v68, v59, v59, v16
v_perm_b32 v69, v59, v59, v17
v_perm_b32 v70, v59, v59, v18
v_perm_b32 v71, v59, v59, v19
s_nop 1
v_mfma_f32_16x16x32_bf16 v[84:87], v[68:71], a[216:219], v[84:87]
s_waitcnt vmcnt(37)
v_perm_b32 v72, v39, v39, v20
v_perm_b32 v73, v39, v39, v21
v_perm_b32 v74, v39, v39, v22
v_perm_b32 v75, v39, v39, v23
s_nop 1
v_mfma_f32_16x16x32_bf16 v[80:83], v[72:75], a[220:223], v[80:83]
v_perm_b32 v76, v59, v59, v20
v_perm_b32 v77, v59, v59, v21
v_perm_b32 v78, v59, v59, v22
v_perm_b32 v79, v59, v59, v23
s_nop 1
v_mfma_f32_16x16x32_bf16 v[84:87], v[76:79], a[220:223], v[84:87]
s_waitcnt vmcnt(36)
v_perm_b32 v64, v40, v40, v16
v_perm_b32 v65, v40, v40, v17
v_perm_b32 v66, v40, v40, v18
v_perm_b32 v67, v40, v40, v19
s_nop 1
v_mfma_f32_16x16x32_bf16 v[80:83], v[64:67], a[224:227], v[80:83]
v_perm_b32 v68, v60, v60, v16
v_perm_b32 v69, v60, v60, v17
v_perm_b32 v70, v60, v60, v18
v_perm_b32 v71, v60, v60, v19
s_nop 1
v_mfma_f32_16x16x32_bf16 v[84:87], v[68:71], a[224:227], v[84:87]
s_waitcnt vmcnt(35)
v_perm_b32 v72, v40, v40, v20
v_perm_b32 v73, v40, v40, v21
v_perm_b32 v74, v40, v40, v22
v_perm_b32 v75, v40, v40, v23
s_nop 1
v_mfma_f32_16x16x32_bf16 v[80:83], v[72:75], a[228:231], v[80:83]
v_perm_b32 v76, v60, v60, v20
v_perm_b32 v77, v60, v60, v21
v_perm_b32 v78, v60, v60, v22
v_perm_b32 v79, v60, v60, v23
s_nop 1
v_mfma_f32_16x16x32_bf16 v[84:87], v[76:79], a[228:231], v[84:87]
s_waitcnt vmcnt(34)
v_perm_b32 v64, v41, v41, v16
v_perm_b32 v65, v41, v41, v17
v_perm_b32 v66, v41, v41, v18
v_perm_b32 v67, v41, v41, v19
s_nop 1
v_mfma_f32_16x16x32_bf16 v[80:83], v[64:67], a[232:235], v[80:83]
v_perm_b32 v68, v61, v61, v16
v_perm_b32 v69, v61, v61, v17
v_perm_b32 v70, v61, v61, v18
v_perm_b32 v71, v61, v61, v19
s_nop 1
v_mfma_f32_16x16x32_bf16 v[84:87], v[68:71], a[232:235], v[84:87]
s_waitcnt vmcnt(33)
v_perm_b32 v72, v41, v41, v20
v_perm_b32 v73, v41, v41, v21
v_perm_b32 v74, v41, v41, v22
v_perm_b32 v75, v41, v41, v23
s_nop 1
v_mfma_f32_16x16x32_bf16 v[80:83], v[72:75], a[236:239], v[80:83]
v_perm_b32 v76, v61, v61, v20
v_perm_b32 v77, v61, v61, v21
v_perm_b32 v78, v61, v61, v22
v_perm_b32 v79, v61, v61, v23
s_nop 1
v_mfma_f32_16x16x32_bf16 v[84:87], v[76:79], a[236:239], v[84:87]
v_lshlrev_b32 v5, 5, v8
v_and_b32 v6, 1, v9
v_lshl_add_u32 v6, v6, 4, v5
v_lshrrev_b32 v7, 5, v1
v_lshl_add_u32 v6, v7, 9, v6
s_lshl_b32 s6, s3, 11
s_add_u32 s6, s6, 147456
v_add_u32 v6, s6, v6
ds_write_b128 v6, v[80:83]
ds_write_b128 v6, v[84:87] offset:1024
v_add_u32 v5, 147456, v5
s_waitcnt lgkmcnt(0)
s_barrier
ds_read_b128 v[24:27], v5 offset:0
ds_read_b128 v[28:31], v5 offset:16
ds_read_b128 v[32:35], v5 offset:2048
ds_read_b128 v[36:39], v5 offset:2064
ds_read_b128 v[40:43], v5 offset:4096
ds_read_b128 v[44:47], v5 offset:4112
ds_read_b128 v[48:51], v5 offset:6144
ds_read_b128 v[52:55], v5 offset:6160
s_waitcnt lgkmcnt(0)
v_add_f32 v24, v24, v32
v_add_f32 v40, v40, v48
v_add_f32 v25, v25, v33
v_add_f32 v41, v41, v49
v_add_f32 v26, v26, v34
v_add_f32 v42, v42, v50
v_add_f32 v27, v27, v35
v_add_f32 v43, v43, v51
v_add_f32 v28, v28, v36
v_add_f32 v44, v44, v52
v_add_f32 v29, v29, v37
v_add_f32 v45, v45, v53
v_add_f32 v30, v30, v38
v_add_f32 v46, v46, v54
v_add_f32 v31, v31, v39
v_add_f32 v47, v47, v55
v_add_f32 v24, v24, v40
v_add_f32 v25, v25, v41
v_add_f32 v26, v26, v42
v_add_f32 v27, v27, v43
v_add_f32 v28, v28, v44
v_add_f32 v29, v29, v45
v_add_f32 v30, v30, v46
v_add_f32 v31, v31, v47
v_cvt_pk_bf16_f32 v216, v24, v25
v_cvt_pk_bf16_f32 v217, v26, v27
v_cvt_pk_bf16_f32 v218, v28, v29
v_cvt_pk_bf16_f32 v219, v30, v31
ds_read_b128 v[24:27], v5 offset:512
ds_read_b128 v[28:31], v5 offset:528
ds_read_b128 v[32:35], v5 offset:2560
ds_read_b128 v[36:39], v5 offset:2576
ds_read_b128 v[40:43], v5 offset:4608
ds_read_b128 v[44:47], v5 offset:4624
ds_read_b128 v[48:51], v5 offset:6656
ds_read_b128 v[52:55], v5 offset:6672
s_waitcnt lgkmcnt(0)
v_add_f32 v24, v24, v32
v_add_f32 v40, v40, v48
v_add_f32 v25, v25, v33
v_add_f32 v41, v41, v49
v_add_f32 v26, v26, v34
v_add_f32 v42, v42, v50
v_add_f32 v27, v27, v35
v_add_f32 v43, v43, v51
v_add_f32 v28, v28, v36
v_add_f32 v44, v44, v52
v_add_f32 v29, v29, v37
v_add_f32 v45, v45, v53
v_add_f32 v30, v30, v38
v_add_f32 v46, v46, v54
v_add_f32 v31, v31, v39
v_add_f32 v47, v47, v55
v_add_f32 v24, v24, v40
v_add_f32 v25, v25, v41
v_add_f32 v26, v26, v42
v_add_f32 v27, v27, v43
v_add_f32 v28, v28, v44
v_add_f32 v29, v29, v45
v_add_f32 v30, v30, v46
v_add_f32 v31, v31, v47
v_cvt_pk_bf16_f32 v220, v24, v25
v_cvt_pk_bf16_f32 v221, v26, v27
v_cvt_pk_bf16_f32 v222, v28, v29
v_cvt_pk_bf16_f32 v223, v30, v31
ds_read_b128 v[24:27], v5 offset:1024
ds_read_b128 v[28:31], v5 offset:1040
ds_read_b128 v[32:35], v5 offset:3072
ds_read_b128 v[36:39], v5 offset:3088
ds_read_b128 v[40:43], v5 offset:5120
ds_read_b128 v[44:47], v5 offset:5136
ds_read_b128 v[48:51], v5 offset:7168
ds_read_b128 v[52:55], v5 offset:7184
s_waitcnt lgkmcnt(0)
v_add_f32 v24, v24, v32
v_add_f32 v40, v40, v48
v_add_f32 v25, v25, v33
v_add_f32 v41, v41, v49
v_add_f32 v26, v26, v34
v_add_f32 v42, v42, v50
v_add_f32 v27, v27, v35
v_add_f32 v43, v43, v51
v_add_f32 v28, v28, v36
v_add_f32 v44, v44, v52
v_add_f32 v29, v29, v37
v_add_f32 v45, v45, v53
v_add_f32 v30, v30, v38
v_add_f32 v46, v46, v54
v_add_f32 v31, v31, v39
v_add_f32 v47, v47, v55
v_add_f32 v24, v24, v40
v_add_f32 v25, v25, v41
v_add_f32 v26, v26, v42
v_add_f32 v27, v27, v43
v_add_f32 v28, v28, v44
v_add_f32 v29, v29, v45
v_add_f32 v30, v30, v46
v_add_f32 v31, v31, v47
v_cvt_pk_bf16_f32 v224, v24, v25
v_cvt_pk_bf16_f32 v225, v26, v27
v_cvt_pk_bf16_f32 v226, v28, v29
v_cvt_pk_bf16_f32 v227, v30, v31
ds_read_b128 v[24:27], v5 offset:1536
ds_read_b128 v[28:31], v5 offset:1552
ds_read_b128 v[32:35], v5 offset:3584
ds_read_b128 v[36:39], v5 offset:3600
ds_read_b128 v[40:43], v5 offset:5632
ds_read_b128 v[44:47], v5 offset:5648
ds_read_b128 v[48:51], v5 offset:7680
ds_read_b128 v[52:55], v5 offset:7696
s_waitcnt lgkmcnt(0)
v_add_f32 v24, v24, v32
v_add_f32 v40, v40, v48
v_add_f32 v25, v25, v33
v_add_f32 v41, v41, v49
v_add_f32 v26, v26, v34
v_add_f32 v42, v42, v50
v_add_f32 v27, v27, v35
v_add_f32 v43, v43, v51
v_add_f32 v28, v28, v36
v_add_f32 v44, v44, v52
v_add_f32 v29, v29, v37
v_add_f32 v45, v45, v53
v_add_f32 v30, v30, v38
v_add_f32 v46, v46, v54
v_add_f32 v31, v31, v39
v_add_f32 v47, v47, v55
v_add_f32 v24, v24, v40
v_add_f32 v25, v25, v41
v_add_f32 v26, v26, v42
v_add_f32 v27, v27, v43
v_add_f32 v28, v28, v44
v_add_f32 v29, v29, v45
v_add_f32 v30, v30, v46
v_add_f32 v31, v31, v47
v_cvt_pk_bf16_f32 v228, v24, v25
v_cvt_pk_bf16_f32 v229, v26, v27
v_cvt_pk_bf16_f32 v230, v28, v29
v_cvt_pk_bf16_f32 v231, v30, v31
v_bfe_u32 v5, v1, 2, 2
v_mul_u32_u24 v5, 32768, v5
v_lshl_add_u32 v5, v9, 5, v5
v_and_b32 v6, 1, v1
v_lshl_add_u32 v5, v6, 4, v5
v_bfe_u32 v7, v1, 1, 1
v_lshl_add_u32 v5, v7, 7, v5
s_waitcnt vmcnt(32)
v_dot2_f32_bf16 v232, v88, v216, 0
v_dot2_f32_bf16 v233, v88, v220, 0
v_dot2_f32_bf16 v234, v88, v224, 0
v_dot2_f32_bf16 v235, v88, v228, 0
v_dot2_f32_bf16 v232, v89, v217, v232
v_dot2_f32_bf16 v233, v89, v221, v233
v_dot2_f32_bf16 v234, v89, v225, v234
v_dot2_f32_bf16 v235, v89, v229, v235
v_dot2_f32_bf16 v232, v90, v218, v232
v_dot2_f32_bf16 v233, v90, v222, v233
v_dot2_f32_bf16 v234, v90, v226, v234
v_dot2_f32_bf16 v235, v90, v230, v235
v_dot2_f32_bf16 v232, v91, v219, v232
v_dot2_f32_bf16 v233, v91, v223, v233
v_dot2_f32_bf16 v234, v91, v227, v234
v_dot2_f32_bf16 v235, v91, v231, v235
v_add_f32_dpp v236, v232, v232 row_ror:8 row_mask:0xf bank_mask:0x3
v_add_f32_dpp v237, v233, v233 row_ror:8 row_mask:0xf bank_mask:0x3
v_add_f32_dpp v236, v234, v234 row_ror:8 row_mask:0xf bank_mask:0xc
v_add_f32_dpp v237, v235, v235 row_ror:8 row_mask:0xf bank_mask:0xc
s_nop 0
v_add_f32_dpp v64, v236, v236 row_half_mirror row_mask:0xf bank_mask:0x5
v_add_f32_dpp v64, v237, v237 row_half_mirror row_mask:0xf bank_mask:0xa
s_nop 1
v_add_f32_dpp v64, v64, v64 quad_perm:[1,0,3,2] row_mask:0xf bank_mask:0xf
s_nop 1
v_add_f32_dpp v64, v64, v64 quad_perm:[2,3,0,1] row_mask:0xf bank_mask:0xf
s_waitcnt vmcnt(31)
v_dot2_f32_bf16 v232, v92, v216, 0
v_dot2_f32_bf16 v233, v92, v220, 0
v_dot2_f32_bf16 v234, v92, v224, 0
v_dot2_f32_bf16 v235, v92, v228, 0
v_dot2_f32_bf16 v232, v93, v217, v232
v_dot2_f32_bf16 v233, v93, v221, v233
v_dot2_f32_bf16 v234, v93, v225, v234
v_dot2_f32_bf16 v235, v93, v229, v235
v_dot2_f32_bf16 v232, v94, v218, v232
v_dot2_f32_bf16 v233, v94, v222, v233
v_dot2_f32_bf16 v234, v94, v226, v234
v_dot2_f32_bf16 v235, v94, v230, v235
v_dot2_f32_bf16 v232, v95, v219, v232
v_dot2_f32_bf16 v233, v95, v223, v233
v_dot2_f32_bf16 v234, v95, v227, v234
v_dot2_f32_bf16 v235, v95, v231, v235
v_add_f32_dpp v236, v232, v232 row_ror:8 row_mask:0xf bank_mask:0x3
v_add_f32_dpp v237, v233, v233 row_ror:8 row_mask:0xf bank_mask:0x3
v_add_f32_dpp v236, v234, v234 row_ror:8 row_mask:0xf bank_mask:0xc
v_add_f32_dpp v237, v235, v235 row_ror:8 row_mask:0xf bank_mask:0xc
s_nop 0
v_add_f32_dpp v65, v236, v236 row_half_mirror row_mask:0xf bank_mask:0x5
v_add_f32_dpp v65, v237, v237 row_half_mirror row_mask:0xf bank_mask:0xa
s_nop 1
v_add_f32_dpp v65, v65, v65 quad_perm:[1,0,3,2] row_mask:0xf bank_mask:0xf
s_nop 1
v_add_f32_dpp v65, v65, v65 quad_perm:[2,3,0,1] row_mask:0xf bank_mask:0xf
s_waitcnt vmcnt(30)
v_dot2_f32_bf16 v232, v96, v216, 0
v_dot2_f32_bf16 v233, v96, v220, 0
v_dot2_f32_bf16 v234, v96, v224, 0
v_dot2_f32_bf16 v235, v96, v228, 0
v_dot2_f32_bf16 v232, v97, v217, v232
v_dot2_f32_bf16 v233, v97, v221, v233
v_dot2_f32_bf16 v234, v97, v225, v234
v_dot2_f32_bf16 v235, v97, v229, v235
v_dot2_f32_bf16 v232, v98, v218, v232
v_dot2_f32_bf16 v233, v98, v222, v233
v_dot2_f32_bf16 v234, v98, v226, v234
v_dot2_f32_bf16 v235, v98, v230, v235
v_dot2_f32_bf16 v232, v99, v219, v232
v_dot2_f32_bf16 v233, v99, v223, v233
v_dot2_f32_bf16 v234, v99, v227, v234
v_dot2_f32_bf16 v235, v99, v231, v235
v_add_f32_dpp v236, v232, v232 row_ror:8 row_mask:0xf bank_mask:0x3
v_add_f32_dpp v237, v233, v233 row_ror:8 row_mask:0xf bank_mask:0x3
v_add_f32_dpp v236, v234, v234 row_ror:8 row_mask:0xf bank_mask:0xc
v_add_f32_dpp v237, v235, v235 row_ror:8 row_mask:0xf bank_mask:0xc
s_nop 0
v_add_f32_dpp v66, v236, v236 row_half_mirror row_mask:0xf bank_mask:0x5
v_add_f32_dpp v66, v237, v237 row_half_mirror row_mask:0xf bank_mask:0xa
s_nop 1
v_add_f32_dpp v66, v66, v66 quad_perm:[1,0,3,2] row_mask:0xf bank_mask:0xf
s_nop 1
v_add_f32_dpp v66, v66, v66 quad_perm:[2,3,0,1] row_mask:0xf bank_mask:0xf
s_waitcnt vmcnt(29)
v_dot2_f32_bf16 v232, v100, v216, 0
v_dot2_f32_bf16 v233, v100, v220, 0
v_dot2_f32_bf16 v234, v100, v224, 0
v_dot2_f32_bf16 v235, v100, v228, 0
v_dot2_f32_bf16 v232, v101, v217, v232
v_dot2_f32_bf16 v233, v101, v221, v233
v_dot2_f32_bf16 v234, v101, v225, v234
v_dot2_f32_bf16 v235, v101, v229, v235
v_dot2_f32_bf16 v232, v102, v218, v232
v_dot2_f32_bf16 v233, v102, v222, v233
v_dot2_f32_bf16 v234, v102, v226, v234
v_dot2_f32_bf16 v235, v102, v230, v235
v_dot2_f32_bf16 v232, v103, v219, v232
v_dot2_f32_bf16 v233, v103, v223, v233
v_dot2_f32_bf16 v234, v103, v227, v234
v_dot2_f32_bf16 v235, v103, v231, v235
v_add_f32_dpp v236, v232, v232 row_ror:8 row_mask:0xf bank_mask:0x3
v_add_f32_dpp v237, v233, v233 row_ror:8 row_mask:0xf bank_mask:0x3
v_add_f32_dpp v236, v234, v234 row_ror:8 row_mask:0xf bank_mask:0xc
v_add_f32_dpp v237, v235, v235 row_ror:8 row_mask:0xf bank_mask:0xc
s_nop 0
v_add_f32_dpp v67, v236, v236 row_half_mirror row_mask:0xf bank_mask:0x5
v_add_f32_dpp v67, v237, v237 row_half_mirror row_mask:0xf bank_mask:0xa
s_nop 1
v_add_f32_dpp v67, v67, v67 quad_perm:[1,0,3,2] row_mask:0xf bank_mask:0xf
s_nop 1
v_add_f32_dpp v67, v67, v67 quad_perm:[2,3,0,1] row_mask:0xf bank_mask:0xf
s_waitcnt vmcnt(28)
v_dot2_f32_bf16 v232, v104, v216, 0
v_dot2_f32_bf16 v233, v104, v220, 0
v_dot2_f32_bf16 v234, v104, v224, 0
v_dot2_f32_bf16 v235, v104, v228, 0
v_dot2_f32_bf16 v232, v105, v217, v232
v_dot2_f32_bf16 v233, v105, v221, v233
v_dot2_f32_bf16 v234, v105, v225, v234
v_dot2_f32_bf16 v235, v105, v229, v235
v_dot2_f32_bf16 v232, v106, v218, v232
v_dot2_f32_bf16 v233, v106, v222, v233
v_dot2_f32_bf16 v234, v106, v226, v234
v_dot2_f32_bf16 v235, v106, v230, v235
v_dot2_f32_bf16 v232, v107, v219, v232
v_dot2_f32_bf16 v233, v107, v223, v233
v_dot2_f32_bf16 v234, v107, v227, v234
v_dot2_f32_bf16 v235, v107, v231, v235
v_add_f32_dpp v236, v232, v232 row_ror:8 row_mask:0xf bank_mask:0x3
v_add_f32_dpp v237, v233, v233 row_ror:8 row_mask:0xf bank_mask:0x3
v_add_f32_dpp v236, v234, v234 row_ror:8 row_mask:0xf bank_mask:0xc
v_add_f32_dpp v237, v235, v235 row_ror:8 row_mask:0xf bank_mask:0xc
s_nop 0
v_add_f32_dpp v68, v236, v236 row_half_mirror row_mask:0xf bank_mask:0x5
v_add_f32_dpp v68, v237, v237 row_half_mirror row_mask:0xf bank_mask:0xa
s_nop 1
v_add_f32_dpp v68, v68, v68 quad_perm:[1,0,3,2] row_mask:0xf bank_mask:0xf
s_nop 1
v_add_f32_dpp v68, v68, v68 quad_perm:[2,3,0,1] row_mask:0xf bank_mask:0xf
s_waitcnt vmcnt(27)
v_dot2_f32_bf16 v232, v108, v216, 0
v_dot2_f32_bf16 v233, v108, v220, 0
v_dot2_f32_bf16 v234, v108, v224, 0
v_dot2_f32_bf16 v235, v108, v228, 0
v_dot2_f32_bf16 v232, v109, v217, v232
v_dot2_f32_bf16 v233, v109, v221, v233
v_dot2_f32_bf16 v234, v109, v225, v234
v_dot2_f32_bf16 v235, v109, v229, v235
v_dot2_f32_bf16 v232, v110, v218, v232
v_dot2_f32_bf16 v233, v110, v222, v233
v_dot2_f32_bf16 v234, v110, v226, v234
v_dot2_f32_bf16 v235, v110, v230, v235
v_dot2_f32_bf16 v232, v111, v219, v232
v_dot2_f32_bf16 v233, v111, v223, v233
v_dot2_f32_bf16 v234, v111, v227, v234
v_dot2_f32_bf16 v235, v111, v231, v235
v_add_f32_dpp v236, v232, v232 row_ror:8 row_mask:0xf bank_mask:0x3
v_add_f32_dpp v237, v233, v233 row_ror:8 row_mask:0xf bank_mask:0x3
v_add_f32_dpp v236, v234, v234 row_ror:8 row_mask:0xf bank_mask:0xc
v_add_f32_dpp v237, v235, v235 row_ror:8 row_mask:0xf bank_mask:0xc
s_nop 0
v_add_f32_dpp v69, v236, v236 row_half_mirror row_mask:0xf bank_mask:0x5
v_add_f32_dpp v69, v237, v237 row_half_mirror row_mask:0xf bank_mask:0xa
s_nop 1
v_add_f32_dpp v69, v69, v69 quad_perm:[1,0,3,2] row_mask:0xf bank_mask:0xf
s_nop 1
v_add_f32_dpp v69, v69, v69 quad_perm:[2,3,0,1] row_mask:0xf bank_mask:0xf
s_waitcnt vmcnt(26)
v_dot2_f32_bf16 v232, v112, v216, 0
v_dot2_f32_bf16 v233, v112, v220, 0
v_dot2_f32_bf16 v234, v112, v224, 0
v_dot2_f32_bf16 v235, v112, v228, 0
v_dot2_f32_bf16 v232, v113, v217, v232
v_dot2_f32_bf16 v233, v113, v221, v233
v_dot2_f32_bf16 v234, v113, v225, v234
v_dot2_f32_bf16 v235, v113, v229, v235
v_dot2_f32_bf16 v232, v114, v218, v232
v_dot2_f32_bf16 v233, v114, v222, v233
v_dot2_f32_bf16 v234, v114, v226, v234
v_dot2_f32_bf16 v235, v114, v230, v235
v_dot2_f32_bf16 v232, v115, v219, v232
v_dot2_f32_bf16 v233, v115, v223, v233
v_dot2_f32_bf16 v234, v115, v227, v234
v_dot2_f32_bf16 v235, v115, v231, v235
v_add_f32_dpp v236, v232, v232 row_ror:8 row_mask:0xf bank_mask:0x3
v_add_f32_dpp v237, v233, v233 row_ror:8 row_mask:0xf bank_mask:0x3
v_add_f32_dpp v236, v234, v234 row_ror:8 row_mask:0xf bank_mask:0xc
v_add_f32_dpp v237, v235, v235 row_ror:8 row_mask:0xf bank_mask:0xc
s_nop 0
v_add_f32_dpp v70, v236, v236 row_half_mirror row_mask:0xf bank_mask:0x5
v_add_f32_dpp v70, v237, v237 row_half_mirror row_mask:0xf bank_mask:0xa
s_nop 1
v_add_f32_dpp v70, v70, v70 quad_perm:[1,0,3,2] row_mask:0xf bank_mask:0xf
s_nop 1
v_add_f32_dpp v70, v70, v70 quad_perm:[2,3,0,1] row_mask:0xf bank_mask:0xf
s_waitcnt vmcnt(25)
v_dot2_f32_bf16 v232, v116, v216, 0
v_dot2_f32_bf16 v233, v116, v220, 0
v_dot2_f32_bf16 v234, v116, v224, 0
v_dot2_f32_bf16 v235, v116, v228, 0
v_dot2_f32_bf16 v232, v117, v217, v232
v_dot2_f32_bf16 v233, v117, v221, v233
v_dot2_f32_bf16 v234, v117, v225, v234
v_dot2_f32_bf16 v235, v117, v229, v235
v_dot2_f32_bf16 v232, v118, v218, v232
v_dot2_f32_bf16 v233, v118, v222, v233
v_dot2_f32_bf16 v234, v118, v226, v234
v_dot2_f32_bf16 v235, v118, v230, v235
v_dot2_f32_bf16 v232, v119, v219, v232
v_dot2_f32_bf16 v233, v119, v223, v233
v_dot2_f32_bf16 v234, v119, v227, v234
v_dot2_f32_bf16 v235, v119, v231, v235
v_add_f32_dpp v236, v232, v232 row_ror:8 row_mask:0xf bank_mask:0x3
v_add_f32_dpp v237, v233, v233 row_ror:8 row_mask:0xf bank_mask:0x3
v_add_f32_dpp v236, v234, v234 row_ror:8 row_mask:0xf bank_mask:0xc
v_add_f32_dpp v237, v235, v235 row_ror:8 row_mask:0xf bank_mask:0xc
s_nop 0
v_add_f32_dpp v71, v236, v236 row_half_mirror row_mask:0xf bank_mask:0x5
v_add_f32_dpp v71, v237, v237 row_half_mirror row_mask:0xf bank_mask:0xa
s_nop 1
v_add_f32_dpp v71, v71, v71 quad_perm:[1,0,3,2] row_mask:0xf bank_mask:0xf
s_nop 1
v_add_f32_dpp v71, v71, v71 quad_perm:[2,3,0,1] row_mask:0xf bank_mask:0xf
s_waitcnt vmcnt(24)
v_dot2_f32_bf16 v232, v120, v216, 0
v_dot2_f32_bf16 v233, v120, v220, 0
v_dot2_f32_bf16 v234, v120, v224, 0
v_dot2_f32_bf16 v235, v120, v228, 0
v_dot2_f32_bf16 v232, v121, v217, v232
v_dot2_f32_bf16 v233, v121, v221, v233
v_dot2_f32_bf16 v234, v121, v225, v234
v_dot2_f32_bf16 v235, v121, v229, v235
v_dot2_f32_bf16 v232, v122, v218, v232
v_dot2_f32_bf16 v233, v122, v222, v233
v_dot2_f32_bf16 v234, v122, v226, v234
v_dot2_f32_bf16 v235, v122, v230, v235
v_dot2_f32_bf16 v232, v123, v219, v232
v_dot2_f32_bf16 v233, v123, v223, v233
v_dot2_f32_bf16 v234, v123, v227, v234
v_dot2_f32_bf16 v235, v123, v231, v235
v_add_f32_dpp v236, v232, v232 row_ror:8 row_mask:0xf bank_mask:0x3
v_add_f32_dpp v237, v233, v233 row_ror:8 row_mask:0xf bank_mask:0x3
v_add_f32_dpp v236, v234, v234 row_ror:8 row_mask:0xf bank_mask:0xc
v_add_f32_dpp v237, v235, v235 row_ror:8 row_mask:0xf bank_mask:0xc
s_nop 0
v_add_f32_dpp v72, v236, v236 row_half_mirror row_mask:0xf bank_mask:0x5
v_add_f32_dpp v72, v237, v237 row_half_mirror row_mask:0xf bank_mask:0xa
s_nop 1
v_add_f32_dpp v72, v72, v72 quad_perm:[1,0,3,2] row_mask:0xf bank_mask:0xf
s_nop 1
v_add_f32_dpp v72, v72, v72 quad_perm:[2,3,0,1] row_mask:0xf bank_mask:0xf
s_waitcnt vmcnt(23)
v_dot2_f32_bf16 v232, v124, v216, 0
v_dot2_f32_bf16 v233, v124, v220, 0
v_dot2_f32_bf16 v234, v124, v224, 0
v_dot2_f32_bf16 v235, v124, v228, 0
v_dot2_f32_bf16 v232, v125, v217, v232
v_dot2_f32_bf16 v233, v125, v221, v233
v_dot2_f32_bf16 v234, v125, v225, v234
v_dot2_f32_bf16 v235, v125, v229, v235
v_dot2_f32_bf16 v232, v126, v218, v232
v_dot2_f32_bf16 v233, v126, v222, v233
v_dot2_f32_bf16 v234, v126, v226, v234
v_dot2_f32_bf16 v235, v126, v230, v235
v_dot2_f32_bf16 v232, v127, v219, v232
v_dot2_f32_bf16 v233, v127, v223, v233
v_dot2_f32_bf16 v234, v127, v227, v234
v_dot2_f32_bf16 v235, v127, v231, v235
v_add_f32_dpp v236, v232, v232 row_ror:8 row_mask:0xf bank_mask:0x3
v_add_f32_dpp v237, v233, v233 row_ror:8 row_mask:0xf bank_mask:0x3
v_add_f32_dpp v236, v234, v234 row_ror:8 row_mask:0xf bank_mask:0xc
v_add_f32_dpp v237, v235, v235 row_ror:8 row_mask:0xf bank_mask:0xc
s_nop 0
v_add_f32_dpp v73, v236, v236 row_half_mirror row_mask:0xf bank_mask:0x5
v_add_f32_dpp v73, v237, v237 row_half_mirror row_mask:0xf bank_mask:0xa
s_nop 1
v_add_f32_dpp v73, v73, v73 quad_perm:[1,0,3,2] row_mask:0xf bank_mask:0xf
s_nop 1
v_add_f32_dpp v73, v73, v73 quad_perm:[2,3,0,1] row_mask:0xf bank_mask:0xf
s_waitcnt vmcnt(22)
v_dot2_f32_bf16 v232, v128, v216, 0
v_dot2_f32_bf16 v233, v128, v220, 0
v_dot2_f32_bf16 v234, v128, v224, 0
v_dot2_f32_bf16 v235, v128, v228, 0
v_dot2_f32_bf16 v232, v129, v217, v232
v_dot2_f32_bf16 v233, v129, v221, v233
v_dot2_f32_bf16 v234, v129, v225, v234
v_dot2_f32_bf16 v235, v129, v229, v235
v_dot2_f32_bf16 v232, v130, v218, v232
v_dot2_f32_bf16 v233, v130, v222, v233
v_dot2_f32_bf16 v234, v130, v226, v234
v_dot2_f32_bf16 v235, v130, v230, v235
v_dot2_f32_bf16 v232, v131, v219, v232
v_dot2_f32_bf16 v233, v131, v223, v233
v_dot2_f32_bf16 v234, v131, v227, v234
v_dot2_f32_bf16 v235, v131, v231, v235
v_add_f32_dpp v236, v232, v232 row_ror:8 row_mask:0xf bank_mask:0x3
v_add_f32_dpp v237, v233, v233 row_ror:8 row_mask:0xf bank_mask:0x3
v_add_f32_dpp v236, v234, v234 row_ror:8 row_mask:0xf bank_mask:0xc
v_add_f32_dpp v237, v235, v235 row_ror:8 row_mask:0xf bank_mask:0xc
s_nop 0
v_add_f32_dpp v74, v236, v236 row_half_mirror row_mask:0xf bank_mask:0x5
v_add_f32_dpp v74, v237, v237 row_half_mirror row_mask:0xf bank_mask:0xa
s_nop 1
v_add_f32_dpp v74, v74, v74 quad_perm:[1,0,3,2] row_mask:0xf bank_mask:0xf
s_nop 1
v_add_f32_dpp v74, v74, v74 quad_perm:[2,3,0,1] row_mask:0xf bank_mask:0xf
s_waitcnt vmcnt(21)
v_dot2_f32_bf16 v232, v132, v216, 0
v_dot2_f32_bf16 v233, v132, v220, 0
v_dot2_f32_bf16 v234, v132, v224, 0
v_dot2_f32_bf16 v235, v132, v228, 0
v_dot2_f32_bf16 v232, v133, v217, v232
v_dot2_f32_bf16 v233, v133, v221, v233
v_dot2_f32_bf16 v234, v133, v225, v234
v_dot2_f32_bf16 v235, v133, v229, v235
v_dot2_f32_bf16 v232, v134, v218, v232
v_dot2_f32_bf16 v233, v134, v222, v233
v_dot2_f32_bf16 v234, v134, v226, v234
v_dot2_f32_bf16 v235, v134, v230, v235
v_dot2_f32_bf16 v232, v135, v219, v232
v_dot2_f32_bf16 v233, v135, v223, v233
v_dot2_f32_bf16 v234, v135, v227, v234
v_dot2_f32_bf16 v235, v135, v231, v235
v_add_f32_dpp v236, v232, v232 row_ror:8 row_mask:0xf bank_mask:0x3
v_add_f32_dpp v237, v233, v233 row_ror:8 row_mask:0xf bank_mask:0x3
v_add_f32_dpp v236, v234, v234 row_ror:8 row_mask:0xf bank_mask:0xc
v_add_f32_dpp v237, v235, v235 row_ror:8 row_mask:0xf bank_mask:0xc
s_nop 0
v_add_f32_dpp v75, v236, v236 row_half_mirror row_mask:0xf bank_mask:0x5
v_add_f32_dpp v75, v237, v237 row_half_mirror row_mask:0xf bank_mask:0xa
s_nop 1
v_add_f32_dpp v75, v75, v75 quad_perm:[1,0,3,2] row_mask:0xf bank_mask:0xf
s_nop 1
v_add_f32_dpp v75, v75, v75 quad_perm:[2,3,0,1] row_mask:0xf bank_mask:0xf
s_waitcnt vmcnt(20)
v_dot2_f32_bf16 v232, v136, v216, 0
v_dot2_f32_bf16 v233, v136, v220, 0
v_dot2_f32_bf16 v234, v136, v224, 0
v_dot2_f32_bf16 v235, v136, v228, 0
v_dot2_f32_bf16 v232, v137, v217, v232
v_dot2_f32_bf16 v233, v137, v221, v233
v_dot2_f32_bf16 v234, v137, v225, v234
v_dot2_f32_bf16 v235, v137, v229, v235
v_dot2_f32_bf16 v232, v138, v218, v232
v_dot2_f32_bf16 v233, v138, v222, v233
v_dot2_f32_bf16 v234, v138, v226, v234
v_dot2_f32_bf16 v235, v138, v230, v235
v_dot2_f32_bf16 v232, v139, v219, v232
v_dot2_f32_bf16 v233, v139, v223, v233
v_dot2_f32_bf16 v234, v139, v227, v234
v_dot2_f32_bf16 v235, v139, v231, v235
v_add_f32_dpp v236, v232, v232 row_ror:8 row_mask:0xf bank_mask:0x3
v_add_f32_dpp v237, v233, v233 row_ror:8 row_mask:0xf bank_mask:0x3
v_add_f32_dpp v236, v234, v234 row_ror:8 row_mask:0xf bank_mask:0xc
v_add_f32_dpp v237, v235, v235 row_ror:8 row_mask:0xf bank_mask:0xc
s_nop 0
v_add_f32_dpp v76, v236, v236 row_half_mirror row_mask:0xf bank_mask:0x5
v_add_f32_dpp v76, v237, v237 row_half_mirror row_mask:0xf bank_mask:0xa
s_nop 1
v_add_f32_dpp v76, v76, v76 quad_perm:[1,0,3,2] row_mask:0xf bank_mask:0xf
s_nop 1
v_add_f32_dpp v76, v76, v76 quad_perm:[2,3,0,1] row_mask:0xf bank_mask:0xf
s_waitcnt vmcnt(19)
v_dot2_f32_bf16 v232, v140, v216, 0
v_dot2_f32_bf16 v233, v140, v220, 0
v_dot2_f32_bf16 v234, v140, v224, 0
v_dot2_f32_bf16 v235, v140, v228, 0
v_dot2_f32_bf16 v232, v141, v217, v232
v_dot2_f32_bf16 v233, v141, v221, v233
v_dot2_f32_bf16 v234, v141, v225, v234
v_dot2_f32_bf16 v235, v141, v229, v235
v_dot2_f32_bf16 v232, v142, v218, v232
v_dot2_f32_bf16 v233, v142, v222, v233
v_dot2_f32_bf16 v234, v142, v226, v234
v_dot2_f32_bf16 v235, v142, v230, v235
v_dot2_f32_bf16 v232, v143, v219, v232
v_dot2_f32_bf16 v233, v143, v223, v233
v_dot2_f32_bf16 v234, v143, v227, v234
v_dot2_f32_bf16 v235, v143, v231, v235
v_add_f32_dpp v236, v232, v232 row_ror:8 row_mask:0xf bank_mask:0x3
v_add_f32_dpp v237, v233, v233 row_ror:8 row_mask:0xf bank_mask:0x3
v_add_f32_dpp v236, v234, v234 row_ror:8 row_mask:0xf bank_mask:0xc
v_add_f32_dpp v237, v235, v235 row_ror:8 row_mask:0xf bank_mask:0xc
s_nop 0
v_add_f32_dpp v77, v236, v236 row_half_mirror row_mask:0xf bank_mask:0x5
v_add_f32_dpp v77, v237, v237 row_half_mirror row_mask:0xf bank_mask:0xa
s_nop 1
v_add_f32_dpp v77, v77, v77 quad_perm:[1,0,3,2] row_mask:0xf bank_mask:0xf
s_nop 1
v_add_f32_dpp v77, v77, v77 quad_perm:[2,3,0,1] row_mask:0xf bank_mask:0xf
s_waitcnt vmcnt(18)
v_dot2_f32_bf16 v232, v144, v216, 0
v_dot2_f32_bf16 v233, v144, v220, 0
v_dot2_f32_bf16 v234, v144, v224, 0
v_dot2_f32_bf16 v235, v144, v228, 0
v_dot2_f32_bf16 v232, v145, v217, v232
v_dot2_f32_bf16 v233, v145, v221, v233
v_dot2_f32_bf16 v234, v145, v225, v234
v_dot2_f32_bf16 v235, v145, v229, v235
v_dot2_f32_bf16 v232, v146, v218, v232
v_dot2_f32_bf16 v233, v146, v222, v233
v_dot2_f32_bf16 v234, v146, v226, v234
v_dot2_f32_bf16 v235, v146, v230, v235
v_dot2_f32_bf16 v232, v147, v219, v232
v_dot2_f32_bf16 v233, v147, v223, v233
v_dot2_f32_bf16 v234, v147, v227, v234
v_dot2_f32_bf16 v235, v147, v231, v235
v_add_f32_dpp v236, v232, v232 row_ror:8 row_mask:0xf bank_mask:0x3
v_add_f32_dpp v237, v233, v233 row_ror:8 row_mask:0xf bank_mask:0x3
v_add_f32_dpp v236, v234, v234 row_ror:8 row_mask:0xf bank_mask:0xc
v_add_f32_dpp v237, v235, v235 row_ror:8 row_mask:0xf bank_mask:0xc
s_nop 0
v_add_f32_dpp v78, v236, v236 row_half_mirror row_mask:0xf bank_mask:0x5
v_add_f32_dpp v78, v237, v237 row_half_mirror row_mask:0xf bank_mask:0xa
s_nop 1
v_add_f32_dpp v78, v78, v78 quad_perm:[1,0,3,2] row_mask:0xf bank_mask:0xf
s_nop 1
v_add_f32_dpp v78, v78, v78 quad_perm:[2,3,0,1] row_mask:0xf bank_mask:0xf
s_waitcnt vmcnt(17)
v_dot2_f32_bf16 v232, v148, v216, 0
v_dot2_f32_bf16 v233, v148, v220, 0
v_dot2_f32_bf16 v234, v148, v224, 0
v_dot2_f32_bf16 v235, v148, v228, 0
v_dot2_f32_bf16 v232, v149, v217, v232
v_dot2_f32_bf16 v233, v149, v221, v233
v_dot2_f32_bf16 v234, v149, v225, v234
v_dot2_f32_bf16 v235, v149, v229, v235
v_dot2_f32_bf16 v232, v150, v218, v232
v_dot2_f32_bf16 v233, v150, v222, v233
v_dot2_f32_bf16 v234, v150, v226, v234
v_dot2_f32_bf16 v235, v150, v230, v235
v_dot2_f32_bf16 v232, v151, v219, v232
v_dot2_f32_bf16 v233, v151, v223, v233
v_dot2_f32_bf16 v234, v151, v227, v234
v_dot2_f32_bf16 v235, v151, v231, v235
v_add_f32_dpp v236, v232, v232 row_ror:8 row_mask:0xf bank_mask:0x3
v_add_f32_dpp v237, v233, v233 row_ror:8 row_mask:0xf bank_mask:0x3
v_add_f32_dpp v236, v234, v234 row_ror:8 row_mask:0xf bank_mask:0xc
v_add_f32_dpp v237, v235, v235 row_ror:8 row_mask:0xf bank_mask:0xc
s_nop 0
v_add_f32_dpp v79, v236, v236 row_half_mirror row_mask:0xf bank_mask:0x5
v_add_f32_dpp v79, v237, v237 row_half_mirror row_mask:0xf bank_mask:0xa
s_nop 1
v_add_f32_dpp v79, v79, v79 quad_perm:[1,0,3,2] row_mask:0xf bank_mask:0xf
s_nop 1
v_add_f32_dpp v79, v79, v79 quad_perm:[2,3,0,1] row_mask:0xf bank_mask:0xf
v_cvt_pk_bf16_f32 v24, v64, v65
v_cvt_pk_bf16_f32 v25, v66, v67
v_cvt_pk_bf16_f32 v26, v68, v69
v_cvt_pk_bf16_f32 v27, v70, v71
v_cvt_pk_bf16_f32 v28, v72, v73
v_cvt_pk_bf16_f32 v29, v74, v75
v_cvt_pk_bf16_f32 v30, v76, v77
v_cvt_pk_bf16_f32 v31, v78, v79
v_cmp_eq_u32 vcc, 1, v6
s_nop 1
v_cndmask_b32 v244, v24, v28, vcc
v_cndmask_b32 v245, v25, v29, vcc
v_cndmask_b32 v246, v26, v30, vcc
v_cndmask_b32 v247, v27, v31, vcc
s_waitcnt vmcnt(16)
v_dot2_f32_bf16 v232, v152, v216, 0
v_dot2_f32_bf16 v233, v152, v220, 0
v_dot2_f32_bf16 v234, v152, v224, 0
v_dot2_f32_bf16 v235, v152, v228, 0
v_dot2_f32_bf16 v232, v153, v217, v232
v_dot2_f32_bf16 v233, v153, v221, v233
v_dot2_f32_bf16 v234, v153, v225, v234
v_dot2_f32_bf16 v235, v153, v229, v235
v_dot2_f32_bf16 v232, v154, v218, v232
v_dot2_f32_bf16 v233, v154, v222, v233
v_dot2_f32_bf16 v234, v154, v226, v234
v_dot2_f32_bf16 v235, v154, v230, v235
v_dot2_f32_bf16 v232, v155, v219, v232
v_dot2_f32_bf16 v233, v155, v223, v233
v_dot2_f32_bf16 v234, v155, v227, v234
v_dot2_f32_bf16 v235, v155, v231, v235
v_add_f32_dpp v236, v232, v232 row_ror:8 row_mask:0xf bank_mask:0x3
v_add_f32_dpp v237, v233, v233 row_ror:8 row_mask:0xf bank_mask:0x3
v_add_f32_dpp v236, v234, v234 row_ror:8 row_mask:0xf bank_mask:0xc
v_add_f32_dpp v237, v235, v235 row_ror:8 row_mask:0xf bank_mask:0xc
s_nop 0
v_add_f32_dpp v64, v236, v236 row_half_mirror row_mask:0xf bank_mask:0x5
v_add_f32_dpp v64, v237, v237 row_half_mirror row_mask:0xf bank_mask:0xa
s_nop 1
v_add_f32_dpp v64, v64, v64 quad_perm:[1,0,3,2] row_mask:0xf bank_mask:0xf
s_nop 1
v_add_f32_dpp v64, v64, v64 quad_perm:[2,3,0,1] row_mask:0xf bank_mask:0xf
s_waitcnt vmcnt(15)
v_dot2_f32_bf16 v232, v156, v216, 0
v_dot2_f32_bf16 v233, v156, v220, 0
v_dot2_f32_bf16 v234, v156, v224, 0
v_dot2_f32_bf16 v235, v156, v228, 0
v_dot2_f32_bf16 v232, v157, v217, v232
v_dot2_f32_bf16 v233, v157, v221, v233
v_dot2_f32_bf16 v234, v157, v225, v234
v_dot2_f32_bf16 v235, v157, v229, v235
v_dot2_f32_bf16 v232, v158, v218, v232
v_dot2_f32_bf16 v233, v158, v222, v233
v_dot2_f32_bf16 v234, v158, v226, v234
v_dot2_f32_bf16 v235, v158, v230, v235
v_dot2_f32_bf16 v232, v159, v219, v232
v_dot2_f32_bf16 v233, v159, v223, v233
v_dot2_f32_bf16 v234, v159, v227, v234
v_dot2_f32_bf16 v235, v159, v231, v235
v_add_f32_dpp v236, v232, v232 row_ror:8 row_mask:0xf bank_mask:0x3
v_add_f32_dpp v237, v233, v233 row_ror:8 row_mask:0xf bank_mask:0x3
v_add_f32_dpp v236, v234, v234 row_ror:8 row_mask:0xf bank_mask:0xc
v_add_f32_dpp v237, v235, v235 row_ror:8 row_mask:0xf bank_mask:0xc
s_nop 0
v_add_f32_dpp v65, v236, v236 row_half_mirror row_mask:0xf bank_mask:0x5
v_add_f32_dpp v65, v237, v237 row_half_mirror row_mask:0xf bank_mask:0xa
s_nop 1
v_add_f32_dpp v65, v65, v65 quad_perm:[1,0,3,2] row_mask:0xf bank_mask:0xf
s_nop 1
v_add_f32_dpp v65, v65, v65 quad_perm:[2,3,0,1] row_mask:0xf bank_mask:0xf
s_waitcnt vmcnt(14)
v_dot2_f32_bf16 v232, v160, v216, 0
v_dot2_f32_bf16 v233, v160, v220, 0
v_dot2_f32_bf16 v234, v160, v224, 0
v_dot2_f32_bf16 v235, v160, v228, 0
v_dot2_f32_bf16 v232, v161, v217, v232
v_dot2_f32_bf16 v233, v161, v221, v233
v_dot2_f32_bf16 v234, v161, v225, v234
v_dot2_f32_bf16 v235, v161, v229, v235
v_dot2_f32_bf16 v232, v162, v218, v232
v_dot2_f32_bf16 v233, v162, v222, v233
v_dot2_f32_bf16 v234, v162, v226, v234
v_dot2_f32_bf16 v235, v162, v230, v235
v_dot2_f32_bf16 v232, v163, v219, v232
v_dot2_f32_bf16 v233, v163, v223, v233
v_dot2_f32_bf16 v234, v163, v227, v234
v_dot2_f32_bf16 v235, v163, v231, v235
v_add_f32_dpp v236, v232, v232 row_ror:8 row_mask:0xf bank_mask:0x3
v_add_f32_dpp v237, v233, v233 row_ror:8 row_mask:0xf bank_mask:0x3
v_add_f32_dpp v236, v234, v234 row_ror:8 row_mask:0xf bank_mask:0xc
v_add_f32_dpp v237, v235, v235 row_ror:8 row_mask:0xf bank_mask:0xc
s_nop 0
v_add_f32_dpp v66, v236, v236 row_half_mirror row_mask:0xf bank_mask:0x5
v_add_f32_dpp v66, v237, v237 row_half_mirror row_mask:0xf bank_mask:0xa
s_nop 1
v_add_f32_dpp v66, v66, v66 quad_perm:[1,0,3,2] row_mask:0xf bank_mask:0xf
s_nop 1
v_add_f32_dpp v66, v66, v66 quad_perm:[2,3,0,1] row_mask:0xf bank_mask:0xf
s_waitcnt vmcnt(13)
v_dot2_f32_bf16 v232, v164, v216, 0
v_dot2_f32_bf16 v233, v164, v220, 0
v_dot2_f32_bf16 v234, v164, v224, 0
v_dot2_f32_bf16 v235, v164, v228, 0
v_dot2_f32_bf16 v232, v165, v217, v232
v_dot2_f32_bf16 v233, v165, v221, v233
v_dot2_f32_bf16 v234, v165, v225, v234
v_dot2_f32_bf16 v235, v165, v229, v235
v_dot2_f32_bf16 v232, v166, v218, v232
v_dot2_f32_bf16 v233, v166, v222, v233
v_dot2_f32_bf16 v234, v166, v226, v234
v_dot2_f32_bf16 v235, v166, v230, v235
v_dot2_f32_bf16 v232, v167, v219, v232
v_dot2_f32_bf16 v233, v167, v223, v233
v_dot2_f32_bf16 v234, v167, v227, v234
v_dot2_f32_bf16 v235, v167, v231, v235
v_add_f32_dpp v236, v232, v232 row_ror:8 row_mask:0xf bank_mask:0x3
v_add_f32_dpp v237, v233, v233 row_ror:8 row_mask:0xf bank_mask:0x3
v_add_f32_dpp v236, v234, v234 row_ror:8 row_mask:0xf bank_mask:0xc
v_add_f32_dpp v237, v235, v235 row_ror:8 row_mask:0xf bank_mask:0xc
s_nop 0
v_add_f32_dpp v67, v236, v236 row_half_mirror row_mask:0xf bank_mask:0x5
v_add_f32_dpp v67, v237, v237 row_half_mirror row_mask:0xf bank_mask:0xa
s_nop 1
v_add_f32_dpp v67, v67, v67 quad_perm:[1,0,3,2] row_mask:0xf bank_mask:0xf
s_nop 1
v_add_f32_dpp v67, v67, v67 quad_perm:[2,3,0,1] row_mask:0xf bank_mask:0xf
s_waitcnt vmcnt(12)
v_dot2_f32_bf16 v232, v168, v216, 0
v_dot2_f32_bf16 v233, v168, v220, 0
v_dot2_f32_bf16 v234, v168, v224, 0
v_dot2_f32_bf16 v235, v168, v228, 0
v_dot2_f32_bf16 v232, v169, v217, v232
v_dot2_f32_bf16 v233, v169, v221, v233
v_dot2_f32_bf16 v234, v169, v225, v234
v_dot2_f32_bf16 v235, v169, v229, v235
v_dot2_f32_bf16 v232, v170, v218, v232
v_dot2_f32_bf16 v233, v170, v222, v233
v_dot2_f32_bf16 v234, v170, v226, v234
v_dot2_f32_bf16 v235, v170, v230, v235
v_dot2_f32_bf16 v232, v171, v219, v232
v_dot2_f32_bf16 v233, v171, v223, v233
v_dot2_f32_bf16 v234, v171, v227, v234
v_dot2_f32_bf16 v235, v171, v231, v235
v_add_f32_dpp v236, v232, v232 row_ror:8 row_mask:0xf bank_mask:0x3
v_add_f32_dpp v237, v233, v233 row_ror:8 row_mask:0xf bank_mask:0x3
v_add_f32_dpp v236, v234, v234 row_ror:8 row_mask:0xf bank_mask:0xc
v_add_f32_dpp v237, v235, v235 row_ror:8 row_mask:0xf bank_mask:0xc
s_nop 0
v_add_f32_dpp v68, v236, v236 row_half_mirror row_mask:0xf bank_mask:0x5
v_add_f32_dpp v68, v237, v237 row_half_mirror row_mask:0xf bank_mask:0xa
s_nop 1
v_add_f32_dpp v68, v68, v68 quad_perm:[1,0,3,2] row_mask:0xf bank_mask:0xf
s_nop 1
v_add_f32_dpp v68, v68, v68 quad_perm:[2,3,0,1] row_mask:0xf bank_mask:0xf
s_waitcnt vmcnt(11)
v_dot2_f32_bf16 v232, v172, v216, 0
v_dot2_f32_bf16 v233, v172, v220, 0
v_dot2_f32_bf16 v234, v172, v224, 0
v_dot2_f32_bf16 v235, v172, v228, 0
v_dot2_f32_bf16 v232, v173, v217, v232
v_dot2_f32_bf16 v233, v173, v221, v233
v_dot2_f32_bf16 v234, v173, v225, v234
v_dot2_f32_bf16 v235, v173, v229, v235
v_dot2_f32_bf16 v232, v174, v218, v232
v_dot2_f32_bf16 v233, v174, v222, v233
v_dot2_f32_bf16 v234, v174, v226, v234
v_dot2_f32_bf16 v235, v174, v230, v235
v_dot2_f32_bf16 v232, v175, v219, v232
v_dot2_f32_bf16 v233, v175, v223, v233
v_dot2_f32_bf16 v234, v175, v227, v234
v_dot2_f32_bf16 v235, v175, v231, v235
v_add_f32_dpp v236, v232, v232 row_ror:8 row_mask:0xf bank_mask:0x3
v_add_f32_dpp v237, v233, v233 row_ror:8 row_mask:0xf bank_mask:0x3
v_add_f32_dpp v236, v234, v234 row_ror:8 row_mask:0xf bank_mask:0xc
v_add_f32_dpp v237, v235, v235 row_ror:8 row_mask:0xf bank_mask:0xc
s_nop 0
v_add_f32_dpp v69, v236, v236 row_half_mirror row_mask:0xf bank_mask:0x5
v_add_f32_dpp v69, v237, v237 row_half_mirror row_mask:0xf bank_mask:0xa
s_nop 1
v_add_f32_dpp v69, v69, v69 quad_perm:[1,0,3,2] row_mask:0xf bank_mask:0xf
s_nop 1
v_add_f32_dpp v69, v69, v69 quad_perm:[2,3,0,1] row_mask:0xf bank_mask:0xf
s_waitcnt vmcnt(10)
v_dot2_f32_bf16 v232, v176, v216, 0
v_dot2_f32_bf16 v233, v176, v220, 0
v_dot2_f32_bf16 v234, v176, v224, 0
v_dot2_f32_bf16 v235, v176, v228, 0
v_dot2_f32_bf16 v232, v177, v217, v232
v_dot2_f32_bf16 v233, v177, v221, v233
v_dot2_f32_bf16 v234, v177, v225, v234
v_dot2_f32_bf16 v235, v177, v229, v235
v_dot2_f32_bf16 v232, v178, v218, v232
v_dot2_f32_bf16 v233, v178, v222, v233
v_dot2_f32_bf16 v234, v178, v226, v234
v_dot2_f32_bf16 v235, v178, v230, v235
v_dot2_f32_bf16 v232, v179, v219, v232
v_dot2_f32_bf16 v233, v179, v223, v233
v_dot2_f32_bf16 v234, v179, v227, v234
v_dot2_f32_bf16 v235, v179, v231, v235
v_add_f32_dpp v236, v232, v232 row_ror:8 row_mask:0xf bank_mask:0x3
v_add_f32_dpp v237, v233, v233 row_ror:8 row_mask:0xf bank_mask:0x3
v_add_f32_dpp v236, v234, v234 row_ror:8 row_mask:0xf bank_mask:0xc
v_add_f32_dpp v237, v235, v235 row_ror:8 row_mask:0xf bank_mask:0xc
s_nop 0
v_add_f32_dpp v70, v236, v236 row_half_mirror row_mask:0xf bank_mask:0x5
v_add_f32_dpp v70, v237, v237 row_half_mirror row_mask:0xf bank_mask:0xa
s_nop 1
v_add_f32_dpp v70, v70, v70 quad_perm:[1,0,3,2] row_mask:0xf bank_mask:0xf
s_nop 1
v_add_f32_dpp v70, v70, v70 quad_perm:[2,3,0,1] row_mask:0xf bank_mask:0xf
s_waitcnt vmcnt(9)
v_dot2_f32_bf16 v232, v180, v216, 0
v_dot2_f32_bf16 v233, v180, v220, 0
v_dot2_f32_bf16 v234, v180, v224, 0
v_dot2_f32_bf16 v235, v180, v228, 0
v_dot2_f32_bf16 v232, v181, v217, v232
v_dot2_f32_bf16 v233, v181, v221, v233
v_dot2_f32_bf16 v234, v181, v225, v234
v_dot2_f32_bf16 v235, v181, v229, v235
v_dot2_f32_bf16 v232, v182, v218, v232
v_dot2_f32_bf16 v233, v182, v222, v233
v_dot2_f32_bf16 v234, v182, v226, v234
v_dot2_f32_bf16 v235, v182, v230, v235
v_dot2_f32_bf16 v232, v183, v219, v232
v_dot2_f32_bf16 v233, v183, v223, v233
v_dot2_f32_bf16 v234, v183, v227, v234
v_dot2_f32_bf16 v235, v183, v231, v235
v_add_f32_dpp v236, v232, v232 row_ror:8 row_mask:0xf bank_mask:0x3
v_add_f32_dpp v237, v233, v233 row_ror:8 row_mask:0xf bank_mask:0x3
v_add_f32_dpp v236, v234, v234 row_ror:8 row_mask:0xf bank_mask:0xc
v_add_f32_dpp v237, v235, v235 row_ror:8 row_mask:0xf bank_mask:0xc
s_nop 0
v_add_f32_dpp v71, v236, v236 row_half_mirror row_mask:0xf bank_mask:0x5
v_add_f32_dpp v71, v237, v237 row_half_mirror row_mask:0xf bank_mask:0xa
s_nop 1
v_add_f32_dpp v71, v71, v71 quad_perm:[1,0,3,2] row_mask:0xf bank_mask:0xf
s_nop 1
v_add_f32_dpp v71, v71, v71 quad_perm:[2,3,0,1] row_mask:0xf bank_mask:0xf
s_waitcnt vmcnt(8)
v_dot2_f32_bf16 v232, v184, v216, 0
v_dot2_f32_bf16 v233, v184, v220, 0
v_dot2_f32_bf16 v234, v184, v224, 0
v_dot2_f32_bf16 v235, v184, v228, 0
v_dot2_f32_bf16 v232, v185, v217, v232
v_dot2_f32_bf16 v233, v185, v221, v233
v_dot2_f32_bf16 v234, v185, v225, v234
v_dot2_f32_bf16 v235, v185, v229, v235
v_dot2_f32_bf16 v232, v186, v218, v232
v_dot2_f32_bf16 v233, v186, v222, v233
v_dot2_f32_bf16 v234, v186, v226, v234
v_dot2_f32_bf16 v235, v186, v230, v235
v_dot2_f32_bf16 v232, v187, v219, v232
v_dot2_f32_bf16 v233, v187, v223, v233
v_dot2_f32_bf16 v234, v187, v227, v234
v_dot2_f32_bf16 v235, v187, v231, v235
v_add_f32_dpp v236, v232, v232 row_ror:8 row_mask:0xf bank_mask:0x3
v_add_f32_dpp v237, v233, v233 row_ror:8 row_mask:0xf bank_mask:0x3
v_add_f32_dpp v236, v234, v234 row_ror:8 row_mask:0xf bank_mask:0xc
v_add_f32_dpp v237, v235, v235 row_ror:8 row_mask:0xf bank_mask:0xc
s_nop 0
v_add_f32_dpp v72, v236, v236 row_half_mirror row_mask:0xf bank_mask:0x5
v_add_f32_dpp v72, v237, v237 row_half_mirror row_mask:0xf bank_mask:0xa
s_nop 1
v_add_f32_dpp v72, v72, v72 quad_perm:[1,0,3,2] row_mask:0xf bank_mask:0xf
s_nop 1
v_add_f32_dpp v72, v72, v72 quad_perm:[2,3,0,1] row_mask:0xf bank_mask:0xf
s_waitcnt vmcnt(7)
v_dot2_f32_bf16 v232, v188, v216, 0
v_dot2_f32_bf16 v233, v188, v220, 0
v_dot2_f32_bf16 v234, v188, v224, 0
v_dot2_f32_bf16 v235, v188, v228, 0
v_dot2_f32_bf16 v232, v189, v217, v232
v_dot2_f32_bf16 v233, v189, v221, v233
v_dot2_f32_bf16 v234, v189, v225, v234
v_dot2_f32_bf16 v235, v189, v229, v235
v_dot2_f32_bf16 v232, v190, v218, v232
v_dot2_f32_bf16 v233, v190, v222, v233
v_dot2_f32_bf16 v234, v190, v226, v234
v_dot2_f32_bf16 v235, v190, v230, v235
v_dot2_f32_bf16 v232, v191, v219, v232
v_dot2_f32_bf16 v233, v191, v223, v233
v_dot2_f32_bf16 v234, v191, v227, v234
v_dot2_f32_bf16 v235, v191, v231, v235
v_add_f32_dpp v236, v232, v232 row_ror:8 row_mask:0xf bank_mask:0x3
v_add_f32_dpp v237, v233, v233 row_ror:8 row_mask:0xf bank_mask:0x3
v_add_f32_dpp v236, v234, v234 row_ror:8 row_mask:0xf bank_mask:0xc
v_add_f32_dpp v237, v235, v235 row_ror:8 row_mask:0xf bank_mask:0xc
s_nop 0
v_add_f32_dpp v73, v236, v236 row_half_mirror row_mask:0xf bank_mask:0x5
v_add_f32_dpp v73, v237, v237 row_half_mirror row_mask:0xf bank_mask:0xa
s_nop 1
v_add_f32_dpp v73, v73, v73 quad_perm:[1,0,3,2] row_mask:0xf bank_mask:0xf
s_nop 1
v_add_f32_dpp v73, v73, v73 quad_perm:[2,3,0,1] row_mask:0xf bank_mask:0xf
s_waitcnt vmcnt(6)
v_dot2_f32_bf16 v232, v192, v216, 0
v_dot2_f32_bf16 v233, v192, v220, 0
v_dot2_f32_bf16 v234, v192, v224, 0
v_dot2_f32_bf16 v235, v192, v228, 0
v_dot2_f32_bf16 v232, v193, v217, v232
v_dot2_f32_bf16 v233, v193, v221, v233
v_dot2_f32_bf16 v234, v193, v225, v234
v_dot2_f32_bf16 v235, v193, v229, v235
v_dot2_f32_bf16 v232, v194, v218, v232
v_dot2_f32_bf16 v233, v194, v222, v233
v_dot2_f32_bf16 v234, v194, v226, v234
v_dot2_f32_bf16 v235, v194, v230, v235
v_dot2_f32_bf16 v232, v195, v219, v232
v_dot2_f32_bf16 v233, v195, v223, v233
v_dot2_f32_bf16 v234, v195, v227, v234
v_dot2_f32_bf16 v235, v195, v231, v235
v_add_f32_dpp v236, v232, v232 row_ror:8 row_mask:0xf bank_mask:0x3
v_add_f32_dpp v237, v233, v233 row_ror:8 row_mask:0xf bank_mask:0x3
v_add_f32_dpp v236, v234, v234 row_ror:8 row_mask:0xf bank_mask:0xc
v_add_f32_dpp v237, v235, v235 row_ror:8 row_mask:0xf bank_mask:0xc
s_nop 0
v_add_f32_dpp v74, v236, v236 row_half_mirror row_mask:0xf bank_mask:0x5
v_add_f32_dpp v74, v237, v237 row_half_mirror row_mask:0xf bank_mask:0xa
s_nop 1
v_add_f32_dpp v74, v74, v74 quad_perm:[1,0,3,2] row_mask:0xf bank_mask:0xf
s_nop 1
v_add_f32_dpp v74, v74, v74 quad_perm:[2,3,0,1] row_mask:0xf bank_mask:0xf
s_waitcnt vmcnt(5)
v_dot2_f32_bf16 v232, v196, v216, 0
v_dot2_f32_bf16 v233, v196, v220, 0
v_dot2_f32_bf16 v234, v196, v224, 0
v_dot2_f32_bf16 v235, v196, v228, 0
v_dot2_f32_bf16 v232, v197, v217, v232
v_dot2_f32_bf16 v233, v197, v221, v233
v_dot2_f32_bf16 v234, v197, v225, v234
v_dot2_f32_bf16 v235, v197, v229, v235
v_dot2_f32_bf16 v232, v198, v218, v232
v_dot2_f32_bf16 v233, v198, v222, v233
v_dot2_f32_bf16 v234, v198, v226, v234
v_dot2_f32_bf16 v235, v198, v230, v235
v_dot2_f32_bf16 v232, v199, v219, v232
v_dot2_f32_bf16 v233, v199, v223, v233
v_dot2_f32_bf16 v234, v199, v227, v234
v_dot2_f32_bf16 v235, v199, v231, v235
v_add_f32_dpp v236, v232, v232 row_ror:8 row_mask:0xf bank_mask:0x3
v_add_f32_dpp v237, v233, v233 row_ror:8 row_mask:0xf bank_mask:0x3
v_add_f32_dpp v236, v234, v234 row_ror:8 row_mask:0xf bank_mask:0xc
v_add_f32_dpp v237, v235, v235 row_ror:8 row_mask:0xf bank_mask:0xc
s_nop 0
v_add_f32_dpp v75, v236, v236 row_half_mirror row_mask:0xf bank_mask:0x5
v_add_f32_dpp v75, v237, v237 row_half_mirror row_mask:0xf bank_mask:0xa
s_nop 1
v_add_f32_dpp v75, v75, v75 quad_perm:[1,0,3,2] row_mask:0xf bank_mask:0xf
s_nop 1
v_add_f32_dpp v75, v75, v75 quad_perm:[2,3,0,1] row_mask:0xf bank_mask:0xf
s_waitcnt vmcnt(4)
v_dot2_f32_bf16 v232, v200, v216, 0
v_dot2_f32_bf16 v233, v200, v220, 0
v_dot2_f32_bf16 v234, v200, v224, 0
v_dot2_f32_bf16 v235, v200, v228, 0
v_dot2_f32_bf16 v232, v201, v217, v232
v_dot2_f32_bf16 v233, v201, v221, v233
v_dot2_f32_bf16 v234, v201, v225, v234
v_dot2_f32_bf16 v235, v201, v229, v235
v_dot2_f32_bf16 v232, v202, v218, v232
v_dot2_f32_bf16 v233, v202, v222, v233
v_dot2_f32_bf16 v234, v202, v226, v234
v_dot2_f32_bf16 v235, v202, v230, v235
v_dot2_f32_bf16 v232, v203, v219, v232
v_dot2_f32_bf16 v233, v203, v223, v233
v_dot2_f32_bf16 v234, v203, v227, v234
v_dot2_f32_bf16 v235, v203, v231, v235
v_add_f32_dpp v236, v232, v232 row_ror:8 row_mask:0xf bank_mask:0x3
v_add_f32_dpp v237, v233, v233 row_ror:8 row_mask:0xf bank_mask:0x3
v_add_f32_dpp v236, v234, v234 row_ror:8 row_mask:0xf bank_mask:0xc
v_add_f32_dpp v237, v235, v235 row_ror:8 row_mask:0xf bank_mask:0xc
s_nop 0
v_add_f32_dpp v76, v236, v236 row_half_mirror row_mask:0xf bank_mask:0x5
v_add_f32_dpp v76, v237, v237 row_half_mirror row_mask:0xf bank_mask:0xa
s_nop 1
v_add_f32_dpp v76, v76, v76 quad_perm:[1,0,3,2] row_mask:0xf bank_mask:0xf
s_nop 1
v_add_f32_dpp v76, v76, v76 quad_perm:[2,3,0,1] row_mask:0xf bank_mask:0xf
s_waitcnt vmcnt(3)
v_dot2_f32_bf16 v232, v204, v216, 0
v_dot2_f32_bf16 v233, v204, v220, 0
v_dot2_f32_bf16 v234, v204, v224, 0
v_dot2_f32_bf16 v235, v204, v228, 0
v_dot2_f32_bf16 v232, v205, v217, v232
v_dot2_f32_bf16 v233, v205, v221, v233
v_dot2_f32_bf16 v234, v205, v225, v234
v_dot2_f32_bf16 v235, v205, v229, v235
v_dot2_f32_bf16 v232, v206, v218, v232
v_dot2_f32_bf16 v233, v206, v222, v233
v_dot2_f32_bf16 v234, v206, v226, v234
v_dot2_f32_bf16 v235, v206, v230, v235
v_dot2_f32_bf16 v232, v207, v219, v232
v_dot2_f32_bf16 v233, v207, v223, v233
v_dot2_f32_bf16 v234, v207, v227, v234
v_dot2_f32_bf16 v235, v207, v231, v235
v_add_f32_dpp v236, v232, v232 row_ror:8 row_mask:0xf bank_mask:0x3
v_add_f32_dpp v237, v233, v233 row_ror:8 row_mask:0xf bank_mask:0x3
v_add_f32_dpp v236, v234, v234 row_ror:8 row_mask:0xf bank_mask:0xc
v_add_f32_dpp v237, v235, v235 row_ror:8 row_mask:0xf bank_mask:0xc
s_nop 0
v_add_f32_dpp v77, v236, v236 row_half_mirror row_mask:0xf bank_mask:0x5
v_add_f32_dpp v77, v237, v237 row_half_mirror row_mask:0xf bank_mask:0xa
s_nop 1
v_add_f32_dpp v77, v77, v77 quad_perm:[1,0,3,2] row_mask:0xf bank_mask:0xf
s_nop 1
v_add_f32_dpp v77, v77, v77 quad_perm:[2,3,0,1] row_mask:0xf bank_mask:0xf
s_waitcnt vmcnt(2)
v_dot2_f32_bf16 v232, v208, v216, 0
v_dot2_f32_bf16 v233, v208, v220, 0
v_dot2_f32_bf16 v234, v208, v224, 0
v_dot2_f32_bf16 v235, v208, v228, 0
v_dot2_f32_bf16 v232, v209, v217, v232
v_dot2_f32_bf16 v233, v209, v221, v233
v_dot2_f32_bf16 v234, v209, v225, v234
v_dot2_f32_bf16 v235, v209, v229, v235
v_dot2_f32_bf16 v232, v210, v218, v232
v_dot2_f32_bf16 v233, v210, v222, v233
v_dot2_f32_bf16 v234, v210, v226, v234
v_dot2_f32_bf16 v235, v210, v230, v235
v_dot2_f32_bf16 v232, v211, v219, v232
v_dot2_f32_bf16 v233, v211, v223, v233
v_dot2_f32_bf16 v234, v211, v227, v234
v_dot2_f32_bf16 v235, v211, v231, v235
v_add_f32_dpp v236, v232, v232 row_ror:8 row_mask:0xf bank_mask:0x3
v_add_f32_dpp v237, v233, v233 row_ror:8 row_mask:0xf bank_mask:0x3
v_add_f32_dpp v236, v234, v234 row_ror:8 row_mask:0xf bank_mask:0xc
v_add_f32_dpp v237, v235, v235 row_ror:8 row_mask:0xf bank_mask:0xc
s_nop 0
v_add_f32_dpp v78, v236, v236 row_half_mirror row_mask:0xf bank_mask:0x5
v_add_f32_dpp v78, v237, v237 row_half_mirror row_mask:0xf bank_mask:0xa
s_nop 1
v_add_f32_dpp v78, v78, v78 quad_perm:[1,0,3,2] row_mask:0xf bank_mask:0xf
s_nop 1
v_add_f32_dpp v78, v78, v78 quad_perm:[2,3,0,1] row_mask:0xf bank_mask:0xf
s_waitcnt vmcnt(1)
v_dot2_f32_bf16 v232, v212, v216, 0
v_dot2_f32_bf16 v233, v212, v220, 0
v_dot2_f32_bf16 v234, v212, v224, 0
v_dot2_f32_bf16 v235, v212, v228, 0
v_dot2_f32_bf16 v232, v213, v217, v232
v_dot2_f32_bf16 v233, v213, v221, v233
v_dot2_f32_bf16 v234, v213, v225, v234
v_dot2_f32_bf16 v235, v213, v229, v235
v_dot2_f32_bf16 v232, v214, v218, v232
v_dot2_f32_bf16 v233, v214, v222, v233
v_dot2_f32_bf16 v234, v214, v226, v234
v_dot2_f32_bf16 v235, v214, v230, v235
v_dot2_f32_bf16 v232, v215, v219, v232
v_dot2_f32_bf16 v233, v215, v223, v233
v_dot2_f32_bf16 v234, v215, v227, v234
v_dot2_f32_bf16 v235, v215, v231, v235
v_add_f32_dpp v236, v232, v232 row_ror:8 row_mask:0xf bank_mask:0x3
v_add_f32_dpp v237, v233, v233 row_ror:8 row_mask:0xf bank_mask:0x3
v_add_f32_dpp v236, v234, v234 row_ror:8 row_mask:0xf bank_mask:0xc
v_add_f32_dpp v237, v235, v235 row_ror:8 row_mask:0xf bank_mask:0xc
s_nop 0
v_add_f32_dpp v79, v236, v236 row_half_mirror row_mask:0xf bank_mask:0x5
v_add_f32_dpp v79, v237, v237 row_half_mirror row_mask:0xf bank_mask:0xa
s_nop 1
v_add_f32_dpp v79, v79, v79 quad_perm:[1,0,3,2] row_mask:0xf bank_mask:0xf
s_nop 1
v_add_f32_dpp v79, v79, v79 quad_perm:[2,3,0,1] row_mask:0xf bank_mask:0xf
v_cvt_pk_bf16_f32 v24, v64, v65
v_cvt_pk_bf16_f32 v25, v66, v67
v_cvt_pk_bf16_f32 v26, v68, v69
v_cvt_pk_bf16_f32 v27, v70, v71
v_cvt_pk_bf16_f32 v28, v72, v73
v_cvt_pk_bf16_f32 v29, v74, v75
v_cvt_pk_bf16_f32 v30, v76, v77
v_cvt_pk_bf16_f32 v31, v78, v79
v_cmp_eq_u32 vcc, 1, v6
s_nop 1
v_cndmask_b32 v248, v24, v28, vcc
v_cndmask_b32 v249, v25, v29, vcc
v_cndmask_b32 v250, v26, v30, vcc
v_cndmask_b32 v251, v27, v31, vcc
v_cmp_eq_u32 vcc, 1, v7
s_nop 1
v_cndmask_b32 v244, v244, v248, vcc
v_cndmask_b32 v245, v245, v249, vcc
v_cndmask_b32 v246, v246, v250, vcc
v_cndmask_b32 v247, v247, v251, vcc
v_min_u32 v244, -2, v244
v_min_u32 v245, -2, v245
v_min_u32 v246, -2, v246
v_min_u32 v247, -2, v247
s_waitcnt vmcnt(0)
s_mov_b32 s7, 400000
L_ens_35:
v_readfirstlane_b32 s6, v11
s_cmp_ge_u32 s6, 32
s_cbranch_scc1 L_ensd_36
s_sleep 16
buffer_load_dword v11, off, s[68:71], 0 offset:0 sc1
s_waitcnt vmcnt(0)
s_sub_u32 s7, s7, 1
s_cmp_lg_u32 s7, 0
s_cbranch_scc1 L_ens_35
L_ensd_36:
s_lshl_b32 s6, s4, 10
s_lshl_b32 s7, s3, 8
s_add_u32 s6, s6, s7
s_add_u32 s6, s6, 0
buffer_store_dwordx4 v[244:247], v5, s[64:67], s6 offen sc1
s_mov_b32 m0, s12
s_nop 0
buffer_load_dwordx4 v2, s[60:63], s12 offen offset:0 nt lds
buffer_load_dwordx4 v2, s[60:63], s12 offen offset:1024 nt lds
s_waitcnt vmcnt(2)
buffer_load_dwordx4 v2, s[60:63], s12 offen offset:2048 nt lds
s_waitcnt vmcnt(2)
buffer_load_dwordx4 v2, s[60:63], s12 offen offset:3072 nt lds
s_add_u32 s12, s12, 4096
s_mov_b32 m0, s12
s_waitcnt vmcnt(2)
buffer_load_dwordx4 v2, s[60:63], s12 offen offset:0 nt lds
s_waitcnt vmcnt(2)
buffer_load_dwordx4 v2, s[60:63], s12 offen offset:1024 nt lds
s_waitcnt vmcnt(2)
buffer_load_dwordx4 v2, s[60:63], s12 offen offset:2048 nt lds
s_waitcnt vmcnt(2)
buffer_load_dwordx4 v2, s[60:63], s12 offen offset:3072 nt lds
s_add_u32 s12, s12, 4096
s_mov_b32 m0, s12
s_waitcnt vmcnt(2)
buffer_load_dwordx4 v2, s[60:63], s12 offen offset:0 nt lds
s_waitcnt vmcnt(2)
buffer_load_dwordx4 v2, s[60:63], s12 offen offset:1024 nt lds
s_waitcnt vmcnt(2)
buffer_load_dwordx4 v2, s[60:63], s12 offen offset:2048 nt lds
s_waitcnt vmcnt(2)
buffer_load_dwordx4 v2, s[60:63], s12 offen offset:3072 nt lds
s_add_u32 s12, s12, 4096
s_mov_b32 m0, s12
s_waitcnt vmcnt(2)
buffer_load_dwordx4 v2, s[60:63], s12 offen offset:0 nt lds
s_waitcnt vmcnt(2)
buffer_load_dwordx4 v2, s[60:63], s12 offen offset:1024 nt lds
s_waitcnt vmcnt(2)
buffer_load_dwordx4 v2, s[60:63], s12 offen offset:2048 nt lds
s_waitcnt vmcnt(2)
buffer_load_dwordx4 v2, s[60:63], s12 offen offset:3072 nt lds
s_add_u32 s12, s12, 4096
s_mov_b32 m0, s12
s_waitcnt vmcnt(2)
buffer_load_dwordx4 v2, s[60:63], s12 offen offset:0 nt lds
s_waitcnt vmcnt(2)
buffer_load_dwordx4 v2, s[60:63], s12 offen offset:1024 nt lds
s_waitcnt vmcnt(2)
buffer_load_dwordx4 v2, s[60:63], s12 offen offset:2048 nt lds
s_waitcnt vmcnt(2)
buffer_load_dwordx4 v2, s[60:63], s12 offen offset:3072 nt lds
s_add_u32 s12, s12, 4096
s_mov_b32 m0, s12
s_waitcnt vmcnt(2)
buffer_load_dwordx4 v2, s[60:63], s12 offen offset:0 nt lds
s_waitcnt vmcnt(2)
buffer_load_dwordx4 v2, s[60:63], s12 offen offset:1024 nt lds
s_waitcnt vmcnt(2)
buffer_load_dwordx4 v2, s[60:63], s12 offen offset:2048 nt lds
s_waitcnt vmcnt(2)
buffer_load_dwordx4 v2, s[60:63], s12 offen offset:3072 nt lds
s_add_u32 s12, s12, 4096
s_mov_b32 m0, s12
s_waitcnt vmcnt(2)
buffer_load_dwordx4 v2, s[60:63], s12 offen offset:0 nt lds
s_waitcnt vmcnt(2)
buffer_load_dwordx4 v2, s[60:63], s12 offen offset:1024 nt lds
s_waitcnt vmcnt(2)
buffer_load_dwordx4 v2, s[60:63], s12 offen offset:2048 nt lds
s_waitcnt vmcnt(2)
buffer_load_dwordx4 v2, s[60:63], s12 offen offset:3072 nt lds
s_add_u32 s12, s12, 4096
s_mov_b32 m0, s12
s_waitcnt vmcnt(2)
buffer_load_dwordx4 v2, s[60:63], s12 offen offset:0 nt lds
s_waitcnt vmcnt(2)
buffer_load_dwordx4 v2, s[60:63], s12 offen offset:1024 nt lds
s_waitcnt vmcnt(2)
buffer_load_dwordx4 v2, s[60:63], s12 offen offset:2048 nt lds
s_waitcnt vmcnt(2)
buffer_load_dwordx4 v2, s[60:63], s12 offen offset:3072 nt lds
s_add_u32 s12, s12, 4096
s_mov_b32 m0, s12
s_waitcnt vmcnt(2)
buffer_load_dwordx4 v2, s[60:63], s12 offen offset:0 nt lds
s_waitcnt vmcnt(2)
buffer_load_dwordx4 v2, s[60:63], s12 offen offset:1024 nt lds
s_waitcnt vmcnt(2)
buffer_load_dwordx4 v2, s[60:63], s12 offen offset:2048 nt lds
s_waitcnt vmcnt(2)
buffer_load_dwordx4 v2, s[60:63], s12 offen offset:3072 nt lds
v_lshlrev_b32 v238, 18, v9
v_lshl_add_u32 v238, v8, 4, v238
s_mov_b32 s6, 0
s_waitcnt vmcnt(2)
buffer_load_dwordx4 v[88:91], v238, s[52:55], s6 offen nt
s_mov_b32 s6, 8192
s_waitcnt vmcnt(2)
buffer_load_dwordx4 v[92:95], v238, s[52:55], s6 offen nt
s_mov_b32 s6, 16384
s_waitcnt vmcnt(2)
buffer_load_dwordx4 v[96:99], v238, s[52:55], s6 offen nt
s_mov_b32 s6, 24576
s_waitcnt vmcnt(2)
buffer_load_dwordx4 v[100:103], v238, s[52:55], s6 offen nt
s_mov_b32 s6, 32768
s_waitcnt vmcnt(2)
buffer_load_dwordx4 v[104:107], v238, s[52:55], s6 offen nt
s_mov_b32 s6, 40960
s_waitcnt vmcnt(2)
buffer_load_dwordx4 v[108:111], v238, s[52:55], s6 offen nt
s_mov_b32 s6, 49152
s_waitcnt vmcnt(2)
buffer_load_dwordx4 v[112:115], v238, s[52:55], s6 offen nt
s_mov_b32 s6, 57344
s_waitcnt vmcnt(2)
buffer_load_dwordx4 v[116:119], v238, s[52:55], s6 offen nt
s_mov_b32 s6, 65536
s_waitcnt vmcnt(2)
buffer_load_dwordx4 v[120:123], v238, s[52:55], s6 offen nt
s_mov_b32 s6, 73728
s_waitcnt vmcnt(2)
buffer_load_dwordx4 v[124:127], v238, s[52:55], s6 offen nt
s_mov_b32 s6, 81920
s_waitcnt vmcnt(2)
buffer_load_dwordx4 v[128:131], v238, s[52:55], s6 offen nt
s_mov_b32 s6, 90112
s_waitcnt vmcnt(2)
buffer_load_dwordx4 v[132:135], v238, s[52:55], s6 offen nt
s_mov_b32 s6, 98304
s_waitcnt vmcnt(2)
buffer_load_dwordx4 v[136:139], v238, s[52:55], s6 offen nt
s_mov_b32 s6, 106496
s_waitcnt vmcnt(2)
buffer_load_dwordx4 v[140:143], v238, s[52:55], s6 offen nt
s_mov_b32 s6, 114688
s_waitcnt vmcnt(2)
buffer_load_dwordx4 v[144:147], v238, s[52:55], s6 offen nt
s_mov_b32 s6, 122880
s_waitcnt vmcnt(2)
buffer_load_dwordx4 v[148:151], v238, s[52:55], s6 offen nt
s_mov_b32 s6, 131072
s_waitcnt vmcnt(2)
buffer_load_dwordx4 v[152:155], v238, s[52:55], s6 offen nt
s_mov_b32 s6, 139264
s_waitcnt vmcnt(2)
buffer_load_dwordx4 v[156:159], v238, s[52:55], s6 offen nt
s_mov_b32 s6, 147456
s_waitcnt vmcnt(2)
buffer_load_dwordx4 v[160:163], v238, s[52:55], s6 offen nt
s_mov_b32 s6, 155648
s_waitcnt vmcnt(2)
buffer_load_dwordx4 v[164:167], v238, s[52:55], s6 offen nt
s_mov_b32 s6, 163840
s_waitcnt vmcnt(2)
buffer_load_dwordx4 v[168:171], v238, s[52:55], s6 offen nt
s_mov_b32 s6, 172032
s_waitcnt vmcnt(2)
buffer_load_dwordx4 v[172:175], v238, s[52:55], s6 offen nt
s_mov_b32 s6, 180224
s_waitcnt vmcnt(2)
buffer_load_dwordx4 v[176:179], v238, s[52:55], s6 offen nt
s_mov_b32 s6, 188416
s_waitcnt vmcnt(2)
buffer_load_dwordx4 v[180:183], v238, s[52:55], s6 offen nt
s_mov_b32 s6, 196608
s_waitcnt vmcnt(2)
buffer_load_dwordx4 v[184:187], v238, s[52:55], s6 offen nt
s_mov_b32 s6, 204800
s_waitcnt vmcnt(2)
buffer_load_dwordx4 v[188:191], v238, s[52:55], s6 offen nt
s_mov_b32 s6, 212992
s_waitcnt vmcnt(2)
buffer_load_dwordx4 v[192:195], v238, s[52:55], s6 offen nt
s_mov_b32 s6, 221184
s_waitcnt vmcnt(2)
buffer_load_dwordx4 v[196:199], v238, s[52:55], s6 offen nt
s_mov_b32 s6, 229376
s_waitcnt vmcnt(2)
buffer_load_dwordx4 v[200:203], v238, s[52:55], s6 offen nt
s_mov_b32 s6, 237568
s_waitcnt vmcnt(2)
buffer_load_dwordx4 v[204:207], v238, s[52:55], s6 offen nt
s_mov_b32 s6, 245760
s_waitcnt vmcnt(2)
buffer_load_dwordx4 v[208:211], v238, s[52:55], s6 offen nt
s_mov_b32 s6, 253952
s_waitcnt vmcnt(2)
buffer_load_dwordx4 v[212:215], v238, s[52:55], s6 offen nt
v_mov_b32 v11, 163824
v_mov_b32 v7, 0
ds_write_b32 v11, v7
s_waitcnt lgkmcnt(0)
s_barrier
ds_read_b64_tr_b16 a[96:97], v240 offset:0
ds_read_b64_tr_b16 a[98:99], v240 offset:4608
ds_read_b64_tr_b16 a[100:101], v240 offset:36864
ds_read_b64_tr_b16 a[102:103], v240 offset:41472
ds_read_b64_tr_b16 a[104:105], v242 offset:0
ds_read_b64_tr_b16 a[106:107], v242 offset:4608
ds_read_b64_tr_b16 a[108:109], v242 offset:36864
ds_read_b64_tr_b16 a[110:111], v242 offset:41472
ds_read_b64_tr_b16 a[112:113], v240 offset:8
ds_read_b64_tr_b16 a[114:115], v240 offset:4616
ds_read_b64_tr_b16 a[116:117], v240 offset:36872
ds_read_b64_tr_b16 a[118:119], v240 offset:41480
ds_read_b64_tr_b16 a[120:121], v242 offset:8
ds_read_b64_tr_b16 a[122:123], v242 offset:4616
ds_read_b64_tr_b16 a[124:125], v242 offset:36872
ds_read_b64_tr_b16 a[126:127], v242 offset:41480
ds_read_b64_tr_b16 a[128:129], v240 offset:16
ds_read_b64_tr_b16 a[130:131], v240 offset:4624
ds_read_b64_tr_b16 a[132:133], v240 offset:36880
ds_read_b64_tr_b16 a[134:135], v240 offset:41488
ds_read_b64_tr_b16 a[136:137], v242 offset:16
ds_read_b64_tr_b16 a[138:139], v242 offset:4624
ds_read_b64_tr_b16 a[140:141], v242 offset:36880
ds_read_b64_tr_b16 a[142:143], v242 offset:41488
ds_read_b64_tr_b16 a[144:145], v240 offset:24
ds_read_b64_tr_b16 a[146:147], v240 offset:4632
ds_read_b64_tr_b16 a[148:149], v240 offset:36888
ds_read_b64_tr_b16 a[150:151], v240 offset:41496
ds_read_b64_tr_b16 a[152:153], v242 offset:24
ds_read_b64_tr_b16 a[154:155], v242 offset:4632
ds_read_b64_tr_b16 a[156:157], v242 offset:36888
ds_read_b64_tr_b16 a[158:159], v242 offset:41496
ds_read_b64_tr_b16 a[160:161], v240 offset:128
ds_read_b64_tr_b16 a[162:163], v240 offset:4736
ds_read_b64_tr_b16 a[164:165], v240 offset:36992
ds_read_b64_tr_b16 a[166:167], v240 offset:41600
ds_read_b64_tr_b16 a[168:169], v242 offset:128
ds_read_b64_tr_b16 a[170:171], v242 offset:4736
ds_read_b64_tr_b16 a[172:173], v242 offset:36992
ds_read_b64_tr_b16 a[174:175], v242 offset:41600
ds_read_b64_tr_b16 a[176:177], v240 offset:136
ds_read_b64_tr_b16 a[178:179], v240 offset:4744
ds_read_b64_tr_b16 a[180:181], v240 offset:37000
ds_read_b64_tr_b16 a[182:183], v240 offset:41608
ds_read_b64_tr_b16 a[184:185], v242 offset:136
ds_read_b64_tr_b16 a[186:187], v242 offset:4744
ds_read_b64_tr_b16 a[188:189], v242 offset:37000
ds_read_b64_tr_b16 a[190:191], v242 offset:41608
ds_read_b64_tr_b16 a[192:193], v240 offset:144
ds_read_b64_tr_b16 a[194:195], v240 offset:4752
ds_read_b64_tr_b16 a[196:197], v240 offset:37008
ds_read_b64_tr_b16 a[198:199], v240 offset:41616
ds_read_b64_tr_b16 a[200:201], v242 offset:144
ds_read_b64_tr_b16 a[202:203], v242 offset:4752
ds_read_b64_tr_b16 a[204:205], v242 offset:37008
ds_read_b64_tr_b16 a[206:207], v242 offset:41616
ds_read_b64_tr_b16 a[208:209], v240 offset:152
ds_read_b64_tr_b16 a[210:211], v240 offset:4760
ds_read_b64_tr_b16 a[212:213], v240 offset:37016
ds_read_b64_tr_b16 a[214:215], v240 offset:41624
ds_read_b64_tr_b16 a[216:217], v242 offset:152
ds_read_b64_tr_b16 a[218:219], v242 offset:4760
ds_read_b64_tr_b16 a[220:221], v242 offset:37016
ds_read_b64_tr_b16 a[222:223], v242 offset:41624
ds_read_b64_tr_b16 a[224:225], v241 offset:0
ds_read_b64_tr_b16 a[226:227], v241 offset:4608
ds_read_b64_tr_b16 a[228:229], v241 offset:36864
ds_read_b64_tr_b16 a[230:231], v241 offset:41472
ds_read_b64_tr_b16 a[232:233], v243 offset:0
ds_read_b64_tr_b16 a[234:235], v243 offset:4608
ds_read_b64_tr_b16 a[236:237], v243 offset:36864
ds_read_b64_tr_b16 a[238:239], v243 offset:41472
v_and_b32 v6, 7, v1
v_mul_u32_u24 v6, 8, v6
s_lshl_b32 s6, s4, 8
s_mul_i32 s7, s3, 64
s_add_u32 s6, s6, s7
s_add_u32 s15, s6, 262144
s_mov_b32 s7, 400000
P_poll:
buffer_load_dwordx2 v[232:233], v6, s[64:67], s15 offen sc1
s_waitcnt vmcnt(0)
v_max_u32 v234, v232, v233
v_cmp_eq_u32 vcc, -1, v234
s_cbranch_vccz P_ok
s_sleep 16
s_sub_u32 s7, s7, 1
s_cmp_lg_u32 s7, 0
s_cbranch_scc1 P_poll
P_ok:
s_lshr_b32 s6, s4, 3
s_mul_i32 s6, s6, 524288
s_bitcmp1_b32 s4, 0
s_cselect_b32 s7, 98304, 0
s_add_u32 s6, s6, s7
s_bitcmp1_b32 s4, 1
s_cselect_b32 s7, 131072, 0
s_add_u32 s6, s6, s7
s_bitcmp1_b32 s4, 2
s_cselect_b32 s7, 262144, 0
s_add_u32 s6, s6, s7
s_lshl_b32 s7, s3, 13
s_add_u32 s6, s6, s7
s_add_u32 s6, s6, 2097152
buffer_load_dwordx4 v[24:27], v2, s[64:67], s6 offen offset:0 sc1
buffer_load_dwordx4 v[28:31], v2, s[64:67], s6 offen offset:1024 sc1
buffer_load_dwordx4 v[32:35], v2, s[64:67], s6 offen offset:2048 sc1
buffer_load_dwordx4 v[36:39], v2, s[64:67], s6 offen offset:3072 sc1
s_add_u32 s6, s6, 4096
buffer_load_dwordx4 v[40:43], v2, s[64:67], s6 offen offset:0 sc1
buffer_load_dwordx4 v[44:47], v2, s[64:67], s6 offen offset:1024 sc1
buffer_load_dwordx4 v[48:51], v2, s[64:67], s6 offen offset:2048 sc1
buffer_load_dwordx4 v[52:55], v2, s[64:67], s6 offen offset:3072 sc1
v_mov_b32 v234, v232
s_nop 1
v_max_f32_dpp v234, v234, v234 row_ror:4 row_mask:0xf bank_mask:0xf
s_nop 1
v_max_f32_dpp v234, v234, v234 row_ror:2 row_mask:0xf bank_mask:0xf
s_nop 1
v_max_f32_dpp v234, v234, v234 row_ror:1 row_mask:0xf bank_mask:0xf
v_sub_f32 v232, v232, v234
v_exp_f32 v232, v232
s_nop 0
v_mul_f32 v235, v232, v233
s_nop 1
v_add_f32_dpp v235, v235, v235 row_ror:4 row_mask:0xf bank_mask:0xf
s_nop 1
v_add_f32_dpp v235, v235, v235 row_ror:2 row_mask:0xf bank_mask:0xf
s_nop 1
v_add_f32_dpp v235, v235, v235 row_ror:1 row_mask:0xf bank_mask:0xf
v_rcp_f32 v235, v235
s_nop 0
v_mul_f32 v232, v232, v235
s_nop 0
v_readlane_b32 s26, v232, 0
v_readlane_b32 s27, v232, 1
v_readlane_b32 s28, v232, 2
v_readlane_b32 s29, v232, 3
v_readlane_b32 s30, v232, 4
v_readlane_b32 s31, v232, 5
v_readlane_b32 s32, v232, 6
v_readlane_b32 s33, v232, 7
s_mul_i32 s6, s3, 1040
s_add_u32 s6, s6, 147456
v_add_u32 v5, s6, v2
v_lshrrev_b32 v6, 3, v8
v_mul_u32_u24 v6, 1040, v6
v_lshl_add_u32 v6, v9, 6, v6
s_lshl_b32 s6, s3, 8
s_add_u32 s6, s6, 147456
v_add_u32 v6, s6, v6
s_waitcnt vmcnt(7)
v_lshlrev_b32 v244, 16, v24
v_and_b32 v245, 0xffff0000, v24
v_lshlrev_b32 v246, 16, v25
v_and_b32 v247, 0xffff0000, v25
v_lshlrev_b32 v248, 16, v26
v_and_b32 v249, 0xffff0000, v26
v_lshlrev_b32 v250, 16, v27
v_and_b32 v251, 0xffff0000, v27
v_mul_f32 v216, s26, v244
v_mul_f32 v217, s26, v245
v_mul_f32 v218, s26, v246
v_mul_f32 v219, s26, v247
v_mul_f32 v220, s26, v248
v_mul_f32 v221, s26, v249
v_mul_f32 v222, s26, v250
v_mul_f32 v223, s26, v251
s_waitcnt vmcnt(6)
v_lshlrev_b32 v244, 16, v28
v_and_b32 v245, 0xffff0000, v28
v_lshlrev_b32 v246, 16, v29
v_and_b32 v247, 0xffff0000, v29
v_lshlrev_b32 v248, 16, v30
v_and_b32 v249, 0xffff0000, v30
v_lshlrev_b32 v250, 16, v31
v_and_b32 v251, 0xffff0000, v31
v_fma_f32 v216, v244, s27, v216
v_fma_f32 v217, v245, s27, v217
v_fma_f32 v218, v246, s27, v218
v_fma_f32 v219, v247, s27, v219
v_fma_f32 v220, v248, s27, v220
v_fma_f32 v221, v249, s27, v221
v_fma_f32 v222, v250, s27, v222
v_fma_f32 v223, v251, s27, v223
s_waitcnt vmcnt(5)
v_lshlrev_b32 v244, 16, v32
v_and_b32 v245, 0xffff0000, v32
v_lshlrev_b32 v246, 16, v33
v_and_b32 v247, 0xffff0000, v33
v_lshlrev_b32 v248, 16, v34
v_and_b32 v249, 0xffff0000, v34
v_lshlrev_b32 v250, 16, v35
v_and_b32 v251, 0xffff0000, v35
v_fma_f32 v216, v244, s28, v216
v_fma_f32 v217, v245, s28, v217
v_fma_f32 v218, v246, s28, v218
v_fma_f32 v219, v247, s28, v219
v_fma_f32 v220, v248, s28, v220
v_fma_f32 v221, v249, s28, v221
v_fma_f32 v222, v250, s28, v222
v_fma_f32 v223, v251, s28, v223
s_waitcnt vmcnt(4)
v_lshlrev_b32 v244, 16, v36
v_and_b32 v245, 0xffff0000, v36
v_lshlrev_b32 v246, 16, v37
v_and_b32 v247, 0xffff0000, v37
v_lshlrev_b32 v248, 16, v38
v_and_b32 v249, 0xffff0000, v38
v_lshlrev_b32 v250, 16, v39
v_and_b32 v251, 0xffff0000, v39
v_fma_f32 v216, v244, s29, v216
v_fma_f32 v217, v245, s29, v217
v_fma_f32 v218, v246, s29, v218
v_fma_f32 v219, v247, s29, v219
v_fma_f32 v220, v248, s29, v220
v_fma_f32 v221, v249, s29, v221
v_fma_f32 v222, v250, s29, v222
v_fma_f32 v223, v251, s29, v223
s_waitcnt vmcnt(3)
v_lshlrev_b32 v244, 16, v40
v_and_b32 v245, 0xffff0000, v40
v_lshlrev_b32 v246, 16, v41
v_and_b32 v247, 0xffff0000, v41
v_lshlrev_b32 v248, 16, v42
v_and_b32 v249, 0xffff0000, v42
v_lshlrev_b32 v250, 16, v43
v_and_b32 v251, 0xffff0000, v43
v_fma_f32 v216, v244, s30, v216
v_fma_f32 v217, v245, s30, v217
v_fma_f32 v218, v246, s30, v218
v_fma_f32 v219, v247, s30, v219
v_fma_f32 v220, v248, s30, v220
v_fma_f32 v221, v249, s30, v221
v_fma_f32 v222, v250, s30, v222
v_fma_f32 v223, v251, s30, v223
s_waitcnt vmcnt(2)
v_lshlrev_b32 v244, 16, v44
v_and_b32 v245, 0xffff0000, v44
v_lshlrev_b32 v246, 16, v45
v_and_b32 v247, 0xffff0000, v45
v_lshlrev_b32 v248, 16, v46
v_and_b32 v249, 0xffff0000, v46
v_lshlrev_b32 v250, 16, v47
v_and_b32 v251, 0xffff0000, v47
v_fma_f32 v216, v244, s31, v216
v_fma_f32 v217, v245, s31, v217
v_fma_f32 v218, v246, s31, v218
v_fma_f32 v219, v247, s31, v219
v_fma_f32 v220, v248, s31, v220
v_fma_f32 v221, v249, s31, v221
v_fma_f32 v222, v250, s31, v222
v_fma_f32 v223, v251, s31, v223
s_waitcnt vmcnt(1)
v_lshlrev_b32 v244, 16, v48
v_and_b32 v245, 0xffff0000, v48
v_lshlrev_b32 v246, 16, v49
v_and_b32 v247, 0xffff0000, v49
v_lshlrev_b32 v248, 16, v50
v_and_b32 v249, 0xffff0000, v50
v_lshlrev_b32 v250, 16, v51
v_and_b32 v251, 0xffff0000, v51
v_fma_f32 v216, v244, s32, v216
v_fma_f32 v217, v245, s32, v217
v_fma_f32 v218, v246, s32, v218
v_fma_f32 v219, v247, s32, v219
v_fma_f32 v220, v248, s32, v220
v_fma_f32 v221, v249, s32, v221
v_fma_f32 v222, v250, s32, v222
v_fma_f32 v223, v251, s32, v223
s_waitcnt vmcnt(0)
v_lshlrev_b32 v244, 16, v52
v_and_b32 v245, 0xffff0000, v52
v_lshlrev_b32 v246, 16, v53
v_and_b32 v247, 0xffff0000, v53
v_lshlrev_b32 v248, 16, v54
v_and_b32 v249, 0xffff0000, v54
v_lshlrev_b32 v250, 16, v55
v_and_b32 v251, 0xffff0000, v55
v_fma_f32 v216, v244, s33, v216
v_fma_f32 v217, v245, s33, v217
v_fma_f32 v218, v246, s33, v218
v_fma_f32 v219, v247, s33, v219
v_fma_f32 v220, v248, s33, v220
v_fma_f32 v221, v249, s33, v221
v_fma_f32 v222, v250, s33, v222
v_fma_f32 v223, v251, s33, v223
v_cvt_pk_bf16_f32 v224, v216, v217
v_cvt_pk_bf16_f32 v225, v218, v219
v_cvt_pk_bf16_f32 v226, v220, v221
v_cvt_pk_bf16_f32 v227, v222, v223
ds_write_b128 v5, v[224:227]
s_waitcnt lgkmcnt(0)
s_barrier
ds_read_b128 v[24:27], v6 offset:0
ds_read_b128 v[44:47], v6 offset:2080
ds_read_b128 v[28:31], v6 offset:16
ds_read_b128 v[48:51], v6 offset:2096
ds_read_b128 v[32:35], v6 offset:32
ds_read_b128 v[52:55], v6 offset:2112
ds_read_b128 v[36:39], v6 offset:48
ds_read_b128 v[56:59], v6 offset:2128
v_lshrrev_b32 v5, 5, v1
v_mul_u32_u24 v5, 1088, v5
v_lshl_add_u32 v5, v8, 4, v5
v_and_b32 v7, 1, v9
v_lshl_add_u32 v5, v7, 3, v5
s_mul_i32 s6, s3, 272
s_add_u32 s6, s6, 155648
v_add_u32 v5, s6, v5
v_mul_u32_u24 v7, 272, v8
v_lshl_add_u32 v7, v9, 4, v7
v_add_u32 v7, 155648, v7
s_waitcnt lgkmcnt(0)
v_perm_b32 v64, v24, v24, v16
v_perm_b32 v65, v24, v24, v17
v_perm_b32 v66, v24, v24, v18
v_perm_b32 v67, v24, v24, v19
s_nop 1
v_mfma_f32_16x16x32_bf16 v[80:83], v[64:67], v[88:91], 0
v_perm_b32 v68, v44, v44, v16
v_perm_b32 v69, v44, v44, v17
v_perm_b32 v70, v44, v44, v18
v_perm_b32 v71, v44, v44, v19
s_nop 1
v_mfma_f32_16x16x32_bf16 v[84:87], v[68:71], v[88:91], 0
v_perm_b32 v72, v24, v24, v20
v_perm_b32 v73, v24, v24, v21
v_perm_b32 v74, v24, v24, v22
v_perm_b32 v75, v24, v24, v23
s_nop 1
v_mfma_f32_16x16x32_bf16 v[80:83], v[72:75], v[92:95], v[80:83]
v_perm_b32 v76, v44, v44, v20
v_perm_b32 v77, v44, v44, v21
v_perm_b32 v78, v44, v44, v22
v_perm_b32 v79, v44, v44, v23
s_nop 1
v_mfma_f32_16x16x32_bf16 v[84:87], v[76:79], v[92:95], v[84:87]
v_perm_b32 v64, v25, v25, v16
v_perm_b32 v65, v25, v25, v17
v_perm_b32 v66, v25, v25, v18
v_perm_b32 v67, v25, v25, v19
s_nop 1
v_mfma_f32_16x16x32_bf16 v[80:83], v[64:67], v[96:99], v[80:83]
v_perm_b32 v68, v45, v45, v16
v_perm_b32 v69, v45, v45, v17
v_perm_b32 v70, v45, v45, v18
v_perm_b32 v71, v45, v45, v19
s_nop 1
v_mfma_f32_16x16x32_bf16 v[84:87], v[68:71], v[96:99], v[84:87]
v_perm_b32 v72, v25, v25, v20
v_perm_b32 v73, v25, v25, v21
v_perm_b32 v74, v25, v25, v22
v_perm_b32 v75, v25, v25, v23
s_nop 1
v_mfma_f32_16x16x32_bf16 v[80:83], v[72:75], v[100:103], v[80:83]
v_perm_b32 v76, v45, v45, v20
v_perm_b32 v77, v45, v45, v21
v_perm_b32 v78, v45, v45, v22
v_perm_b32 v79, v45, v45, v23
s_nop 1
v_mfma_f32_16x16x32_bf16 v[84:87], v[76:79], v[100:103], v[84:87]
v_perm_b32 v64, v26, v26, v16
v_perm_b32 v65, v26, v26, v17
v_perm_b32 v66, v26, v26, v18
v_perm_b32 v67, v26, v26, v19
s_nop 1
v_mfma_f32_16x16x32_bf16 v[80:83], v[64:67], v[104:107], v[80:83]
v_perm_b32 v68, v46, v46, v16
v_perm_b32 v69, v46, v46, v17
v_perm_b32 v70, v46, v46, v18
v_perm_b32 v71, v46, v46, v19
s_nop 1
v_mfma_f32_16x16x32_bf16 v[84:87], v[68:71], v[104:107], v[84:87]
v_perm_b32 v72, v26, v26, v20
v_perm_b32 v73, v26, v26, v21
v_perm_b32 v74, v26, v26, v22
v_perm_b32 v75, v26, v26, v23
s_nop 1
v_mfma_f32_16x16x32_bf16 v[80:83], v[72:75], v[108:111], v[80:83]
v_perm_b32 v76, v46, v46, v20
v_perm_b32 v77, v46, v46, v21
v_perm_b32 v78, v46, v46, v22
v_perm_b32 v79, v46, v46, v23
s_nop 1
v_mfma_f32_16x16x32_bf16 v[84:87], v[76:79], v[108:111], v[84:87]
v_perm_b32 v64, v27, v27, v16
v_perm_b32 v65, v27, v27, v17
v_perm_b32 v66, v27, v27, v18
v_perm_b32 v67, v27, v27, v19
s_nop 1
v_mfma_f32_16x16x32_bf16 v[80:83], v[64:67], v[112:115], v[80:83]
v_perm_b32 v68, v47, v47, v16
v_perm_b32 v69, v47, v47, v17
v_perm_b32 v70, v47, v47, v18
v_perm_b32 v71, v47, v47, v19
s_nop 1
v_mfma_f32_16x16x32_bf16 v[84:87], v[68:71], v[112:115], v[84:87]
v_perm_b32 v72, v27, v27, v20
v_perm_b32 v73, v27, v27, v21
v_perm_b32 v74, v27, v27, v22
v_perm_b32 v75, v27, v27, v23
s_nop 1
v_mfma_f32_16x16x32_bf16 v[80:83], v[72:75], v[116:119], v[80:83]
v_perm_b32 v76, v47, v47, v20
v_perm_b32 v77, v47, v47, v21
v_perm_b32 v78, v47, v47, v22
v_perm_b32 v79, v47, v47, v23
s_nop 1
v_mfma_f32_16x16x32_bf16 v[84:87], v[76:79], v[116:119], v[84:87]
v_perm_b32 v64, v28, v28, v16
v_perm_b32 v65, v28, v28, v17
v_perm_b32 v66, v28, v28, v18
v_perm_b32 v67, v28, v28, v19
s_nop 1
v_mfma_f32_16x16x32_bf16 v[80:83], v[64:67], v[120:123], v[80:83]
v_perm_b32 v68, v48, v48, v16
v_perm_b32 v69, v48, v48, v17
v_perm_b32 v70, v48, v48, v18
v_perm_b32 v71, v48, v48, v19
s_nop 1
v_mfma_f32_16x16x32_bf16 v[84:87], v[68:71], v[120:123], v[84:87]
v_perm_b32 v72, v28, v28, v20
v_perm_b32 v73, v28, v28, v21
v_perm_b32 v74, v28, v28, v22
v_perm_b32 v75, v28, v28, v23
s_nop 1
v_mfma_f32_16x16x32_bf16 v[80:83], v[72:75], v[124:127], v[80:83]
v_perm_b32 v76, v48, v48, v20
v_perm_b32 v77, v48, v48, v21
v_perm_b32 v78, v48, v48, v22
v_perm_b32 v79, v48, v48, v23
s_nop 1
v_mfma_f32_16x16x32_bf16 v[84:87], v[76:79], v[124:127], v[84:87]
v_perm_b32 v64, v29, v29, v16
v_perm_b32 v65, v29, v29, v17
v_perm_b32 v66, v29, v29, v18
v_perm_b32 v67, v29, v29, v19
s_nop 1
v_mfma_f32_16x16x32_bf16 v[80:83], v[64:67], v[128:131], v[80:83]
v_perm_b32 v68, v49, v49, v16
v_perm_b32 v69, v49, v49, v17
v_perm_b32 v70, v49, v49, v18
v_perm_b32 v71, v49, v49, v19
s_nop 1
v_mfma_f32_16x16x32_bf16 v[84:87], v[68:71], v[128:131], v[84:87]
v_perm_b32 v72, v29, v29, v20
v_perm_b32 v73, v29, v29, v21
v_perm_b32 v74, v29, v29, v22
v_perm_b32 v75, v29, v29, v23
s_nop 1
v_mfma_f32_16x16x32_bf16 v[80:83], v[72:75], v[132:135], v[80:83]
v_perm_b32 v76, v49, v49, v20
v_perm_b32 v77, v49, v49, v21
v_perm_b32 v78, v49, v49, v22
v_perm_b32 v79, v49, v49, v23
s_nop 1
v_mfma_f32_16x16x32_bf16 v[84:87], v[76:79], v[132:135], v[84:87]
v_perm_b32 v64, v30, v30, v16
v_perm_b32 v65, v30, v30, v17
v_perm_b32 v66, v30, v30, v18
v_perm_b32 v67, v30, v30, v19
s_nop 1
v_mfma_f32_16x16x32_bf16 v[80:83], v[64:67], v[136:139], v[80:83]
v_perm_b32 v68, v50, v50, v16
v_perm_b32 v69, v50, v50, v17
v_perm_b32 v70, v50, v50, v18
v_perm_b32 v71, v50, v50, v19
s_nop 1
v_mfma_f32_16x16x32_bf16 v[84:87], v[68:71], v[136:139], v[84:87]
v_perm_b32 v72, v30, v30, v20
v_perm_b32 v73, v30, v30, v21
v_perm_b32 v74, v30, v30, v22
v_perm_b32 v75, v30, v30, v23
s_nop 1
v_mfma_f32_16x16x32_bf16 v[80:83], v[72:75], v[140:143], v[80:83]
v_perm_b32 v76, v50, v50, v20
v_perm_b32 v77, v50, v50, v21
v_perm_b32 v78, v50, v50, v22
v_perm_b32 v79, v50, v50, v23
s_nop 1
v_mfma_f32_16x16x32_bf16 v[84:87], v[76:79], v[140:143], v[84:87]
v_perm_b32 v64, v31, v31, v16
v_perm_b32 v65, v31, v31, v17
v_perm_b32 v66, v31, v31, v18
v_perm_b32 v67, v31, v31, v19
s_nop 1
v_mfma_f32_16x16x32_bf16 v[80:83], v[64:67], v[144:147], v[80:83]
v_perm_b32 v68, v51, v51, v16
v_perm_b32 v69, v51, v51, v17
v_perm_b32 v70, v51, v51, v18
v_perm_b32 v71, v51, v51, v19
s_nop 1
v_mfma_f32_16x16x32_bf16 v[84:87], v[68:71], v[144:147], v[84:87]
v_perm_b32 v72, v31, v31, v20
v_perm_b32 v73, v31, v31, v21
v_perm_b32 v74, v31, v31, v22
v_perm_b32 v75, v31, v31, v23
s_nop 1
v_mfma_f32_16x16x32_bf16 v[80:83], v[72:75], v[148:151], v[80:83]
v_perm_b32 v76, v51, v51, v20
v_perm_b32 v77, v51, v51, v21
v_perm_b32 v78, v51, v51, v22
v_perm_b32 v79, v51, v51, v23
s_nop 1
v_mfma_f32_16x16x32_bf16 v[84:87], v[76:79], v[148:151], v[84:87]
v_perm_b32 v64, v32, v32, v16
v_perm_b32 v65, v32, v32, v17
v_perm_b32 v66, v32, v32, v18
v_perm_b32 v67, v32, v32, v19
s_nop 1
v_mfma_f32_16x16x32_bf16 v[80:83], v[64:67], v[152:155], v[80:83]
v_perm_b32 v68, v52, v52, v16
v_perm_b32 v69, v52, v52, v17
v_perm_b32 v70, v52, v52, v18
v_perm_b32 v71, v52, v52, v19
s_nop 1
v_mfma_f32_16x16x32_bf16 v[84:87], v[68:71], v[152:155], v[84:87]
v_perm_b32 v72, v32, v32, v20
v_perm_b32 v73, v32, v32, v21
v_perm_b32 v74, v32, v32, v22
v_perm_b32 v75, v32, v32, v23
s_nop 1
v_mfma_f32_16x16x32_bf16 v[80:83], v[72:75], v[156:159], v[80:83]
v_perm_b32 v76, v52, v52, v20
v_perm_b32 v77, v52, v52, v21
v_perm_b32 v78, v52, v52, v22
v_perm_b32 v79, v52, v52, v23
s_nop 1
v_mfma_f32_16x16x32_bf16 v[84:87], v[76:79], v[156:159], v[84:87]
v_perm_b32 v64, v33, v33, v16
v_perm_b32 v65, v33, v33, v17
v_perm_b32 v66, v33, v33, v18
v_perm_b32 v67, v33, v33, v19
s_nop 1
v_mfma_f32_16x16x32_bf16 v[80:83], v[64:67], v[160:163], v[80:83]
v_perm_b32 v68, v53, v53, v16
v_perm_b32 v69, v53, v53, v17
v_perm_b32 v70, v53, v53, v18
v_perm_b32 v71, v53, v53, v19
s_nop 1
v_mfma_f32_16x16x32_bf16 v[84:87], v[68:71], v[160:163], v[84:87]
v_perm_b32 v72, v33, v33, v20
v_perm_b32 v73, v33, v33, v21
v_perm_b32 v74, v33, v33, v22
v_perm_b32 v75, v33, v33, v23
s_nop 1
v_mfma_f32_16x16x32_bf16 v[80:83], v[72:75], v[164:167], v[80:83]
v_perm_b32 v76, v53, v53, v20
v_perm_b32 v77, v53, v53, v21
v_perm_b32 v78, v53, v53, v22
v_perm_b32 v79, v53, v53, v23
s_nop 1
v_mfma_f32_16x16x32_bf16 v[84:87], v[76:79], v[164:167], v[84:87]
v_perm_b32 v64, v34, v34, v16
v_perm_b32 v65, v34, v34, v17
v_perm_b32 v66, v34, v34, v18
v_perm_b32 v67, v34, v34, v19
s_nop 1
v_mfma_f32_16x16x32_bf16 v[80:83], v[64:67], v[168:171], v[80:83]
v_perm_b32 v68, v54, v54, v16
v_perm_b32 v69, v54, v54, v17
v_perm_b32 v70, v54, v54, v18
v_perm_b32 v71, v54, v54, v19
s_nop 1
v_mfma_f32_16x16x32_bf16 v[84:87], v[68:71], v[168:171], v[84:87]
v_perm_b32 v72, v34, v34, v20
v_perm_b32 v73, v34, v34, v21
v_perm_b32 v74, v34, v34, v22
v_perm_b32 v75, v34, v34, v23
s_nop 1
v_mfma_f32_16x16x32_bf16 v[80:83], v[72:75], v[172:175], v[80:83]
v_perm_b32 v76, v54, v54, v20
v_perm_b32 v77, v54, v54, v21
v_perm_b32 v78, v54, v54, v22
v_perm_b32 v79, v54, v54, v23
s_nop 1
v_mfma_f32_16x16x32_bf16 v[84:87], v[76:79], v[172:175], v[84:87]
v_perm_b32 v64, v35, v35, v16
v_perm_b32 v65, v35, v35, v17
v_perm_b32 v66, v35, v35, v18
v_perm_b32 v67, v35, v35, v19
s_nop 1
v_mfma_f32_16x16x32_bf16 v[80:83], v[64:67], v[176:179], v[80:83]
v_perm_b32 v68, v55, v55, v16
v_perm_b32 v69, v55, v55, v17
v_perm_b32 v70, v55, v55, v18
v_perm_b32 v71, v55, v55, v19
s_nop 1
v_mfma_f32_16x16x32_bf16 v[84:87], v[68:71], v[176:179], v[84:87]
v_perm_b32 v72, v35, v35, v20
v_perm_b32 v73, v35, v35, v21
v_perm_b32 v74, v35, v35, v22
v_perm_b32 v75, v35, v35, v23
s_nop 1
v_mfma_f32_16x16x32_bf16 v[80:83], v[72:75], v[180:183], v[80:83]
v_perm_b32 v76, v55, v55, v20
v_perm_b32 v77, v55, v55, v21
v_perm_b32 v78, v55, v55, v22
v_perm_b32 v79, v55, v55, v23
s_nop 1
v_mfma_f32_16x16x32_bf16 v[84:87], v[76:79], v[180:183], v[84:87]
v_perm_b32 v64, v36, v36, v16
v_perm_b32 v65, v36, v36, v17
v_perm_b32 v66, v36, v36, v18
v_perm_b32 v67, v36, v36, v19
s_nop 1
v_mfma_f32_16x16x32_bf16 v[80:83], v[64:67], v[184:187], v[80:83]
v_perm_b32 v68, v56, v56, v16
v_perm_b32 v69, v56, v56, v17
v_perm_b32 v70, v56, v56, v18
v_perm_b32 v71, v56, v56, v19
s_nop 1
v_mfma_f32_16x16x32_bf16 v[84:87], v[68:71], v[184:187], v[84:87]
v_perm_b32 v72, v36, v36, v20
v_perm_b32 v73, v36, v36, v21
v_perm_b32 v74, v36, v36, v22
v_perm_b32 v75, v36, v36, v23
s_nop 1
v_mfma_f32_16x16x32_bf16 v[80:83], v[72:75], v[188:191], v[80:83]
v_perm_b32 v76, v56, v56, v20
v_perm_b32 v77, v56, v56, v21
v_perm_b32 v78, v56, v56, v22
v_perm_b32 v79, v56, v56, v23
s_nop 1
v_mfma_f32_16x16x32_bf16 v[84:87], v[76:79], v[188:191], v[84:87]
v_perm_b32 v64, v37, v37, v16
v_perm_b32 v65, v37, v37, v17
v_perm_b32 v66, v37, v37, v18
v_perm_b32 v67, v37, v37, v19
s_nop 1
v_mfma_f32_16x16x32_bf16 v[80:83], v[64:67], v[192:195], v[80:83]
v_perm_b32 v68, v57, v57, v16
v_perm_b32 v69, v57, v57, v17
v_perm_b32 v70, v57, v57, v18
v_perm_b32 v71, v57, v57, v19
s_nop 1
v_mfma_f32_16x16x32_bf16 v[84:87], v[68:71], v[192:195], v[84:87]
v_perm_b32 v72, v37, v37, v20
v_perm_b32 v73, v37, v37, v21
v_perm_b32 v74, v37, v37, v22
v_perm_b32 v75, v37, v37, v23
s_nop 1
v_mfma_f32_16x16x32_bf16 v[80:83], v[72:75], v[196:199], v[80:83]
v_perm_b32 v76, v57, v57, v20
v_perm_b32 v77, v57, v57, v21
v_perm_b32 v78, v57, v57, v22
v_perm_b32 v79, v57, v57, v23
s_nop 1
v_mfma_f32_16x16x32_bf16 v[84:87], v[76:79], v[196:199], v[84:87]
v_perm_b32 v64, v38, v38, v16
v_perm_b32 v65, v38, v38, v17
v_perm_b32 v66, v38, v38, v18
v_perm_b32 v67, v38, v38, v19
s_nop 1
v_mfma_f32_16x16x32_bf16 v[80:83], v[64:67], v[200:203], v[80:83]
v_perm_b32 v68, v58, v58, v16
v_perm_b32 v69, v58, v58, v17
v_perm_b32 v70, v58, v58, v18
v_perm_b32 v71, v58, v58, v19
s_nop 1
v_mfma_f32_16x16x32_bf16 v[84:87], v[68:71], v[200:203], v[84:87]
v_perm_b32 v72, v38, v38, v20
v_perm_b32 v73, v38, v38, v21
v_perm_b32 v74, v38, v38, v22
v_perm_b32 v75, v38, v38, v23
s_nop 1
v_mfma_f32_16x16x32_bf16 v[80:83], v[72:75], v[204:207], v[80:83]
v_perm_b32 v76, v58, v58, v20
v_perm_b32 v77, v58, v58, v21
v_perm_b32 v78, v58, v58, v22
v_perm_b32 v79, v58, v58, v23
s_nop 1
v_mfma_f32_16x16x32_bf16 v[84:87], v[76:79], v[204:207], v[84:87]
v_perm_b32 v64, v39, v39, v16
v_perm_b32 v65, v39, v39, v17
v_perm_b32 v66, v39, v39, v18
v_perm_b32 v67, v39, v39, v19
s_nop 1
v_mfma_f32_16x16x32_bf16 v[80:83], v[64:67], v[208:211], v[80:83]
v_perm_b32 v68, v59, v59, v16
v_perm_b32 v69, v59, v59, v17
v_perm_b32 v70, v59, v59, v18
v_perm_b32 v71, v59, v59, v19
s_nop 1
v_mfma_f32_16x16x32_bf16 v[84:87], v[68:71], v[208:211], v[84:87]
v_perm_b32 v72, v39, v39, v20
v_perm_b32 v73, v39, v39, v21
v_perm_b32 v74, v39, v39, v22
v_perm_b32 v75, v39, v39, v23
s_nop 1
v_mfma_f32_16x16x32_bf16 v[80:83], v[72:75], v[212:215], v[80:83]
v_perm_b32 v76, v59, v59, v20
v_perm_b32 v77, v59, v59, v21
v_perm_b32 v78, v59, v59, v22
v_perm_b32 v79, v59, v59, v23
s_nop 1
v_mfma_f32_16x16x32_bf16 v[84:87], v[76:79], v[212:215], v[84:87]
s_nop 0
v_cvt_pk_bf16_f32 v244, v80, v81
v_cvt_pk_bf16_f32 v245, v82, v83
ds_write_b64 v5, v[244:245] offset:0
s_nop 3
v_cvt_pk_bf16_f32 v246, v84, v85
v_cvt_pk_bf16_f32 v247, v86, v87
ds_write_b64 v5, v[246:247] offset:2176
s_waitcnt lgkmcnt(0)
s_barrier
ds_read_b128 v[64:67], v7 offset:0
ds_read_b128 v[68:71], v7 offset:64
ds_read_b128 v[72:75], v7 offset:128
ds_read_b128 v[76:79], v7 offset:192
v_mul_u32_u24 v5, 36864, v9
v_lshl_add_u32 v5, v8, 4, v5
s_mul_i32 s6, s4, 1152
s_add_u32 s6, s6, 5242880
s_lshl_b32 s7, s3, 5
v_add_u32 v6, s7, v5
s_lshl_b32 s7, s3, 8
v_add_u32 v5, s7, v5
s_waitcnt lgkmcnt(0)
v_mfma_f32_16x16x32_bf16 v[24:27], v[64:67], a[96:99], 0
v_mfma_f32_16x16x32_bf16 v[24:27], v[68:71], a[100:103], v[24:27]
v_mfma_f32_16x16x32_bf16 v[24:27], v[72:75], a[104:107], v[24:27]
v_mfma_f32_16x16x32_bf16 v[24:27], v[76:79], a[108:111], v[24:27]
v_mfma_f32_16x16x32_bf16 v[28:31], v[64:67], a[112:115], 0
v_mfma_f32_16x16x32_bf16 v[28:31], v[68:71], a[116:119], v[28:31]
v_mfma_f32_16x16x32_bf16 v[28:31], v[72:75], a[120:123], v[28:31]
v_mfma_f32_16x16x32_bf16 v[28:31], v[76:79], a[124:127], v[28:31]
v_mfma_f32_16x16x32_bf16 v[32:35], v[64:67], a[128:131], 0
v_mfma_f32_16x16x32_bf16 v[32:35], v[68:71], a[132:135], v[32:35]
v_mfma_f32_16x16x32_bf16 v[32:35], v[72:75], a[136:139], v[32:35]
v_mfma_f32_16x16x32_bf16 v[32:35], v[76:79], a[140:143], v[32:35]
v_mfma_f32_16x16x32_bf16 v[36:39], v[64:67], a[144:147], 0
v_mfma_f32_16x16x32_bf16 v[36:39], v[68:71], a[148:151], v[36:39]
v_mfma_f32_16x16x32_bf16 v[36:39], v[72:75], a[152:155], v[36:39]
v_mfma_f32_16x16x32_bf16 v[36:39], v[76:79], a[156:159], v[36:39]
v_mfma_f32_16x16x32_bf16 v[40:43], v[64:67], a[160:163], 0
v_mfma_f32_16x16x32_bf16 v[40:43], v[68:71], a[164:167], v[40:43]
v_mfma_f32_16x16x32_bf16 v[40:43], v[72:75], a[168:171], v[40:43]
v_mfma_f32_16x16x32_bf16 v[40:43], v[76:79], a[172:175], v[40:43]
v_mfma_f32_16x16x32_bf16 v[44:47], v[64:67], a[176:179], 0
v_mfma_f32_16x16x32_bf16 v[44:47], v[68:71], a[180:183], v[44:47]
v_mfma_f32_16x16x32_bf16 v[44:47], v[72:75], a[184:187], v[44:47]
v_mfma_f32_16x16x32_bf16 v[44:47], v[76:79], a[188:191], v[44:47]
v_mfma_f32_16x16x32_bf16 v[48:51], v[64:67], a[192:195], 0
v_mfma_f32_16x16x32_bf16 v[48:51], v[68:71], a[196:199], v[48:51]
v_mfma_f32_16x16x32_bf16 v[48:51], v[72:75], a[200:203], v[48:51]
v_mfma_f32_16x16x32_bf16 v[48:51], v[76:79], a[204:207], v[48:51]
v_mfma_f32_16x16x32_bf16 v[52:55], v[64:67], a[208:211], 0
v_mfma_f32_16x16x32_bf16 v[52:55], v[68:71], a[212:215], v[52:55]
v_mfma_f32_16x16x32_bf16 v[52:55], v[72:75], a[216:219], v[52:55]
v_mfma_f32_16x16x32_bf16 v[52:55], v[76:79], a[220:223], v[52:55]
v_mfma_f32_16x16x32_bf16 v[56:59], v[64:67], a[224:227], 0
v_mfma_f32_16x16x32_bf16 v[56:59], v[68:71], a[228:231], v[56:59]
v_mfma_f32_16x16x32_bf16 v[56:59], v[72:75], a[232:235], v[56:59]
v_mfma_f32_16x16x32_bf16 v[56:59], v[76:79], a[236:239], v[56:59]
v_add_f32 v24, v24, v25
v_add_f32 v26, v26, v27
v_add_f32 v216, v24, v26
v_min_u32 v216, -2, v216
v_add_f32 v28, v28, v29
v_add_f32 v30, v30, v31
v_add_f32 v217, v28, v30
v_min_u32 v217, -2, v217
v_add_f32 v32, v32, v33
v_add_f32 v34, v34, v35
v_add_f32 v218, v32, v34
v_min_u32 v218, -2, v218
v_add_f32 v36, v36, v37
v_add_f32 v38, v38, v39
v_add_f32 v219, v36, v38
v_min_u32 v219, -2, v219
v_add_f32 v40, v40, v41
v_add_f32 v42, v42, v43
v_add_f32 v220, v40, v42
v_min_u32 v220, -2, v220
v_add_f32 v44, v44, v45
v_add_f32 v46, v46, v47
v_add_f32 v221, v44, v46
v_min_u32 v221, -2, v221
v_add_f32 v48, v48, v49
v_add_f32 v50, v50, v51
v_add_f32 v222, v48, v50
v_min_u32 v222, -2, v222
v_add_f32 v52, v52, v53
v_add_f32 v54, v54, v55
v_add_f32 v223, v52, v54
v_min_u32 v223, -2, v223
v_add_f32 v56, v56, v57
v_add_f32 v58, v58, v59
v_add_f32 v224, v56, v58
v_min_u32 v224, -2, v224
v_cvt_pk_bf16_f32 v216, v216, v217
v_min_u32 v216, -2, v216
v_cvt_pk_bf16_f32 v217, v218, v219
v_min_u32 v217, -2, v217
v_cvt_pk_bf16_f32 v218, v220, v221
v_min_u32 v218, -2, v218
v_cvt_pk_bf16_f32 v219, v222, v223
v_min_u32 v219, -2, v219
buffer_store_dwordx4 v[216:219], v5, s[64:67], s6 offen sc1
v_mov_b32_dpp v229, v224 row_shl:2 row_mask:0xf bank_mask:0xf
v_cvt_pk_bf16_f32 v228, v224, v229
v_min_u32 v228, -2, v228
s_nop 1
v_mov_b32_dpp v229, v228 row_shl:4 row_mask:0xf bank_mask:0xf
v_mov_b32_dpp v230, v228 row_shl:8 row_mask:0xf bank_mask:0xf
v_mov_b32_dpp v231, v228 row_shl:12 row_mask:0xf bank_mask:0xf
s_mov_b32 exec_lo, 0x00030003
s_mov_b32 exec_hi, 196611
buffer_store_dwordx4 v[228:231], v6, s[64:67], s6 offen offset:1024 sc1
s_mov_b64 exec, -1
s_nop 1
s_branch B_final
D_role:
s_lshr_b32 s10, s4, 3
s_lshr_b32 s80, s4, 0
s_and_b32 s11, s80, 7
v_xor_b32 v10, 32, v2
v_mov_b32 v76, -1
v_mov_b32 v77, -1
v_mov_b32 v78, -1
v_mov_b32 v79, -1
s_waitcnt lgkmcnt(0)
s_mov_b32 s64, s42
s_mov_b32 s65, s43
s_mov_b32 s66, 16777216
s_mov_b32 s67, 0x20000
s_lshl_b32 s6, s10, 22
s_add_u32 s52, s28, s6
s_addc_u32 s53, s29, 0
s_mov_b32 s54, 4194304
s_mov_b32 s55, 0x20000
s_cmp_eq_u32 s3, 3
s_cbranch_scc1 L_clr3_37
s_mul_i32 s6, s4, 9216
s_mul_i32 s7, s3, 4608
s_add_u32 s6, s6, s7
s_add_u32 s6, s6, 4194304
s_mul_i32 s7, s4, 4608
s_add_u32 s7, s7, 5242880
s_cmp_eq_u32 s3, 2
s_cselect_b32 s6, s7, s6
buffer_store_dwordx4 v[76:79], v2, s[64:67], s6 offen offset:0 sc1
buffer_store_dwordx4 v[76:79], v2, s[64:67], s6 offen offset:1024 sc1
buffer_store_dwordx4 v[76:79], v2, s[64:67], s6 offen offset:2048 sc1
buffer_store_dwordx4 v[76:79], v2, s[64:67], s6 offen offset:3072 sc1
s_add_u32 s6, s6, 4096
s_mov_b64 exec, 0xffffffff
buffer_store_dwordx4 v[76:79], v2, s[64:67], s6 offen offset:0 sc1
s_mov_b64 exec, -1
s_branch L_clrd_38
L_clr3_37:
s_mul_i32 s6, s4, 4096
s_add_u32 s6, s6, 0
buffer_store_dwordx4 v[76:79], v2, s[64:67], s6 offen offset:0 sc1
buffer_store_dwordx4 v[76:79], v2, s[64:67], s6 offen offset:1024 sc1
buffer_store_dwordx4 v[76:79], v2, s[64:67], s6 offen offset:2048 sc1
buffer_store_dwordx4 v[76:79], v2, s[64:67], s6 offen offset:3072 sc1
s_mov_b64 exec, 0xffff
s_mul_i32 s6, s4, 256
s_mul_i32 s7, s4, 256
s_add_u32 s7, s7, 327680
s_add_u32 s6, s6, 262144
v_lshrrev_b32 v6, 2, v1
v_mul_u32_u24 v6, 0, v6
v_add_u32 v6, v6, v2
buffer_store_dwordx4 v[76:79], v2, s[64:67], s6 offen sc1
buffer_store_dwordx4 v[76:79], v6, s[64:67], s7 offen sc1
s_mov_b64 exec, 3
s_mul_i32 s6, s4, 32
s_add_u32 s6, s6, 393216
s_lshr_b32 s7, s4, 2
s_mul_i32 s7, s7, 4224
s_add_u32 s6, s6, s7
v_mul_u32_u24 v5, 16, v1
buffer_store_dwordx4 v[76:79], v5, s[64:67], s6 offen sc1
s_mov_b64 exec, -1
L_clrd_38:
s_mov_b32 s68, s40
s_mov_b32 s69, s41
s_mov_b32 s70, 256
s_mov_b32 s71, 0x20000
s_mov_b32 s72, s38
s_mov_b32 s73, s39
s_mov_b32 s74, 9216
s_mov_b32 s75, 0x20000
s_mul_i32 s12, s3, 17408
s_lshl_b32 s13, s11, 2
s_add_u32 s13, s13, s3
s_lshl_b32 s13, s13, 12
s_add_u32 m0, s12, 0
s_add_u32 s6, s13, 0
buffer_load_dwordx4 v2, s[52:55], s6 offen nt lds
s_add_u32 m0, s12, 1088
s_add_u32 s6, s13, 1024
buffer_load_dwordx4 v2, s[52:55], s6 offen nt lds
s_add_u32 m0, s12, 2176
s_add_u32 s6, s13, 2048
buffer_load_dwordx4 v2, s[52:55], s6 offen nt lds
s_add_u32 m0, s12, 3264
s_add_u32 s6, s13, 3072
buffer_load_dwordx4 v2, s[52:55], s6 offen nt lds
s_add_u32 m0, s12, 4352
s_add_u32 s6, s13, 131072
buffer_load_dwordx4 v2, s[52:55], s6 offen nt lds
s_add_u32 m0, s12, 5440
s_add_u32 s6, s13, 132096
buffer_load_dwordx4 v2, s[52:55], s6 offen nt lds
s_add_u32 m0, s12, 6528
s_add_u32 s6, s13, 133120
buffer_load_dwordx4 v2, s[52:55], s6 offen nt lds
s_add_u32 m0, s12, 7616
s_add_u32 s6, s13, 134144
buffer_load_dwordx4 v2, s[52:55], s6 offen nt lds
s_waitcnt vmcnt(8)
s_barrier
s_cmp_lg_u32 s3, 0
s_cbranch_scc1 D_nosig
v_mov_b32 v7, 1
s_mov_b64 exec, 1
buffer_atomic_add v7, off, s[68:71], 0 offset:0
s_mov_b64 exec, -1
D_nosig:
s_add_u32 m0, s12, 8704
s_add_u32 s6, s13, 262144
s_waitcnt vmcnt(3)
buffer_load_dwordx4 v10, s[52:55], s6 offen nt lds
s_add_u32 m0, s12, 9792
s_add_u32 s6, s13, 263168
s_waitcnt vmcnt(3)
buffer_load_dwordx4 v10, s[52:55], s6 offen nt lds
s_add_u32 m0, s12, 10880
s_add_u32 s6, s13, 264192
s_waitcnt vmcnt(3)
buffer_load_dwordx4 v10, s[52:55], s6 offen nt lds
s_add_u32 m0, s12, 11968
s_add_u32 s6, s13, 265216
s_waitcnt vmcnt(3)
buffer_load_dwordx4 v10, s[52:55], s6 offen nt lds
s_add_u32 m0, s12, 13056
s_add_u32 s6, s13, 393216
s_waitcnt vmcnt(3)
buffer_load_dwordx4 v10, s[52:55], s6 offen nt lds
s_add_u32 m0, s12, 14144
s_add_u32 s6, s13, 394240
s_waitcnt vmcnt(3)
buffer_load_dwordx4 v10, s[52:55], s6 offen nt lds
s_add_u32 m0, s12, 15232
s_add_u32 s6, s13, 395264
s_waitcnt vmcnt(3)
buffer_load_dwordx4 v10, s[52:55], s6 offen nt lds
s_add_u32 m0, s12, 16320
s_add_u32 s6, s13, 396288
s_waitcnt vmcnt(3)
buffer_load_dwordx4 v10, s[52:55], s6 offen nt lds
s_add_u32 m0, s12, 69632
s_add_u32 s6, s13, 524288
s_waitcnt vmcnt(3)
buffer_load_dwordx4 v2, s[52:55], s6 offen nt lds
s_add_u32 m0, s12, 70720
s_add_u32 s6, s13, 525312
s_waitcnt vmcnt(3)
buffer_load_dwordx4 v2, s[52:55], s6 offen nt lds
s_add_u32 m0, s12, 71808
s_add_u32 s6, s13, 526336
s_waitcnt vmcnt(3)
buffer_load_dwordx4 v2, s[52:55], s6 offen nt lds
s_add_u32 m0, s12, 72896
s_add_u32 s6, s13, 527360
s_waitcnt vmcnt(3)
buffer_load_dwordx4 v2, s[52:55], s6 offen nt lds
s_add_u32 m0, s12, 73984
s_add_u32 s6, s13, 655360
s_waitcnt vmcnt(3)
buffer_load_dwordx4 v2, s[52:55], s6 offen nt lds
s_add_u32 m0, s12, 75072
s_add_u32 s6, s13, 656384
s_waitcnt vmcnt(3)
buffer_load_dwordx4 v2, s[52:55], s6 offen nt lds
s_add_u32 m0, s12, 76160
s_add_u32 s6, s13, 657408
s_waitcnt vmcnt(3)
buffer_load_dwordx4 v2, s[52:55], s6 offen nt lds
s_add_u32 m0, s12, 77248
s_add_u32 s6, s13, 658432
s_waitcnt vmcnt(3)
buffer_load_dwordx4 v2, s[52:55], s6 offen nt lds
s_add_u32 m0, s12, 78336
s_add_u32 s6, s13, 786432
s_waitcnt vmcnt(3)
buffer_load_dwordx4 v10, s[52:55], s6 offen nt lds
s_add_u32 m0, s12, 79424
s_add_u32 s6, s13, 787456
s_waitcnt vmcnt(3)
buffer_load_dwordx4 v10, s[52:55], s6 offen nt lds
s_add_u32 m0, s12, 80512
s_add_u32 s6, s13, 788480
s_waitcnt vmcnt(3)
buffer_load_dwordx4 v10, s[52:55], s6 offen nt lds
s_add_u32 m0, s12, 81600
s_add_u32 s6, s13, 789504
s_waitcnt vmcnt(3)
buffer_load_dwordx4 v10, s[52:55], s6 offen nt lds
s_add_u32 m0, s12, 82688
s_add_u32 s6, s13, 917504
s_waitcnt vmcnt(3)
buffer_load_dwordx4 v10, s[52:55], s6 offen nt lds
s_add_u32 m0, s12, 83776
s_add_u32 s6, s13, 918528
s_waitcnt vmcnt(3)
buffer_load_dwordx4 v10, s[52:55], s6 offen nt lds
s_add_u32 m0, s12, 84864
s_add_u32 s6, s13, 919552
s_waitcnt vmcnt(3)
buffer_load_dwordx4 v10, s[52:55], s6 offen nt lds
s_add_u32 m0, s12, 85952
s_add_u32 s6, s13, 920576
s_waitcnt vmcnt(3)
buffer_load_dwordx4 v10, s[52:55], s6 offen nt lds
s_add_u32 s6, s13, 1048576
s_waitcnt vmcnt(3)
buffer_load_dwordx4 a[128:131], v2, s[52:55], s6 offen nt
s_add_u32 s6, s13, 1049600
s_waitcnt vmcnt(3)
buffer_load_dwordx4 a[132:135], v2, s[52:55], s6 offen nt
s_add_u32 s6, s13, 1050624
s_waitcnt vmcnt(3)
buffer_load_dwordx4 a[136:139], v2, s[52:55], s6 offen nt
s_add_u32 s6, s13, 1051648
s_waitcnt vmcnt(3)
buffer_load_dwordx4 a[140:143], v2, s[52:55], s6 offen nt
s_add_u32 s6, s13, 1179648
s_waitcnt vmcnt(3)
buffer_load_dwordx4 a[144:147], v2, s[52:55], s6 offen nt
s_add_u32 s6, s13, 1180672
s_waitcnt vmcnt(3)
buffer_load_dwordx4 a[148:151], v2, s[52:55], s6 offen nt
s_add_u32 s6, s13, 1181696
s_waitcnt vmcnt(3)
buffer_load_dwordx4 a[152:155], v2, s[52:55], s6 offen nt
s_add_u32 s6, s13, 1182720
s_waitcnt vmcnt(3)
buffer_load_dwordx4 a[156:159], v2, s[52:55], s6 offen nt
s_add_u32 s6, s13, 1310720
s_waitcnt vmcnt(3)
buffer_load_dwordx4 a[160:163], v10, s[52:55], s6 offen nt
s_add_u32 s6, s13, 1311744
s_waitcnt vmcnt(3)
buffer_load_dwordx4 a[164:167], v10, s[52:55], s6 offen nt
s_add_u32 s6, s13, 1312768
s_waitcnt vmcnt(3)
buffer_load_dwordx4 a[168:171], v10, s[52:55], s6 offen nt
s_add_u32 s6, s13, 1313792
s_waitcnt vmcnt(3)
buffer_load_dwordx4 a[172:175], v10, s[52:55], s6 offen nt
s_add_u32 s6, s13, 1441792
s_waitcnt vmcnt(3)
buffer_load_dwordx4 a[176:179], v10, s[52:55], s6 offen nt
s_add_u32 s6, s13, 1442816
s_waitcnt vmcnt(3)
buffer_load_dwordx4 a[180:183], v10, s[52:55], s6 offen nt
s_add_u32 s6, s13, 1443840
s_waitcnt vmcnt(3)
buffer_load_dwordx4 a[184:187], v10, s[52:55], s6 offen nt
s_add_u32 s6, s13, 1444864
s_waitcnt vmcnt(3)
buffer_load_dwordx4 a[188:191], v10, s[52:55], s6 offen nt
s_add_u32 s6, s13, 1572864
s_waitcnt vmcnt(3)
buffer_load_dwordx4 a[192:195], v2, s[52:55], s6 offen nt
s_add_u32 s6, s13, 1573888
s_waitcnt vmcnt(3)
buffer_load_dwordx4 a[196:199], v2, s[52:55], s6 offen nt
s_add_u32 s6, s13, 1574912
s_waitcnt vmcnt(3)
buffer_load_dwordx4 a[200:203], v2, s[52:55], s6 offen nt
s_add_u32 s6, s13, 1575936
s_waitcnt vmcnt(3)
buffer_load_dwordx4 a[204:207], v2, s[52:55], s6 offen nt
s_add_u32 s6, s13, 1703936
s_waitcnt vmcnt(3)
buffer_load_dwordx4 a[208:211], v2, s[52:55], s6 offen nt
s_add_u32 s6, s13, 1704960
s_waitcnt vmcnt(3)
buffer_load_dwordx4 a[212:215], v2, s[52:55], s6 offen nt
s_add_u32 s6, s13, 1705984
s_waitcnt vmcnt(3)
buffer_load_dwordx4 a[216:219], v2, s[52:55], s6 offen nt
s_add_u32 s6, s13, 1707008
s_waitcnt vmcnt(3)
buffer_load_dwordx4 a[220:223], v2, s[52:55], s6 offen nt
s_add_u32 s6, s13, 1835008
s_waitcnt vmcnt(3)
buffer_load_dwordx4 a[224:227], v10, s[52:55], s6 offen nt
s_add_u32 s6, s13, 1836032
s_waitcnt vmcnt(3)
buffer_load_dwordx4 a[228:231], v10, s[52:55], s6 offen nt
s_add_u32 s6, s13, 1837056
s_waitcnt vmcnt(3)
buffer_load_dwordx4 a[232:235], v10, s[52:55], s6 offen nt
s_add_u32 s6, s13, 1838080
s_waitcnt vmcnt(3)
buffer_load_dwordx4 a[236:239], v10, s[52:55], s6 offen nt
s_add_u32 s6, s13, 1966080
s_waitcnt vmcnt(3)
buffer_load_dwordx4 a[240:243], v10, s[52:55], s6 offen nt
s_add_u32 s6, s13, 1967104
s_waitcnt vmcnt(3)
buffer_load_dwordx4 a[244:247], v10, s[52:55], s6 offen nt
s_add_u32 s6, s13, 1968128
s_waitcnt vmcnt(3)
buffer_load_dwordx4 a[248:251], v10, s[52:55], s6 offen nt
s_add_u32 s6, s13, 1969152
s_waitcnt vmcnt(3)
buffer_load_dwordx4 a[252:255], v10, s[52:55], s6 offen nt
buffer_load_dword v11, off, s[68:71], 0 offset:0 sc1
s_lshl_b32 s14, s10, 3
s_add_u32 s14, s14, s3
s_mul_i32 s14, s14, 4096
s_add_u32 s14, s14, 0
s_add_u32 s15, s14, 16384
s_lshl_b32 s6, s3, 4
v_add_u32 v5, s6, v8
v_mul_u32_u24 v5, 1088, v5
v_lshrrev_b32 v6, 3, v8
v_lshlrev_b32 v6, 1, v6
v_xor_b32 v6, v6, v9
v_lshl_add_u32 v194, v6, 4, v5
v_add_u32 v195, 69632, v194
v_lshrrev_b32 v5, 5, v1
v_lshlrev_b32 v5, 3, v5
v_bfe_u32 v6, v1, 2, 2
v_add_u32 v5, v5, v6
v_mul_u32_u24 v5, 1088, v5
v_lshrrev_b32 v6, 1, v9
v_xor_b32 v6, v6, v9
v_and_b32 v6, 1, v6
v_lshl_add_u32 v5, v6, 5, v5
v_and_b32 v6, 3, v1
v_lshl_add_u32 v5, v6, 3, v5
s_lshl_b32 s6, s3, 8
v_add_u32 v196, s6, v5
v_add_u32 v197, 69632, v196
v_lshlrev_b32 v199, 4, v8
v_add_u32 v199, 160256, v199
s_lshl_b32 s6, s3, 2
v_add_u32 v198, s6, v199
v_and_b32 v5, 31, v1
v_lshlrev_b32 v200, 4, v5
v_add_u32 v200, 160256, v200
v_lshlrev_b32 v202, 5, v5
v_lshrrev_b32 v6, 5, v1
v_lshl_add_u32 v202, v6, 4, v202
v_add_u32 v202, 156160, v202
v_lshlrev_b32 v201, 5, v8
v_lshl_add_u32 v201, v9, 3, v201
s_lshl_b32 s6, s3, 10
s_add_u32 s6, s6, 156160
v_add_u32 v201, s6, v201
v_mul_u32_u24 v203, 1056, v8
v_lshl_add_u32 v203, v9, 4, v203
v_add_u32 v203, 139264, v203
s_mul_i32 s6, s3, 4224
s_add_u32 s6, s6, 139264
v_add_u32 v204, s6, v2
v_add_u32 v206, s12, v2
v_add_u32 v207, 69632, v206
v_mov_b32 v185, 0x3e0293ee
v_mov_b32 v176, 0xff800000
v_mov_b32 v177, 0xff800000
v_mov_b32 v178, 0xff800000
v_mov_b32 v180, 0
v_mov_b32 v181, 0
s_waitcnt vmcnt(0)
s_mov_b32 s7, 400000
L_ens_39:
v_readfirstlane_b32 s6, v11
s_cmp_ge_u32 s6, 32
s_cbranch_scc1 L_ensd_40
s_sleep 16
buffer_load_dword v11, off, s[68:71], 0 offset:0 sc1
s_waitcnt vmcnt(0)
s_sub_u32 s7, s7, 1
s_cmp_lg_u32 s7, 0
s_cbranch_scc1 L_ens_39
L_ensd_40:
s_mov_b32 s7, 400000
v_and_b32 v5, 3, v1
v_bfe_u32 v6, v1, 2, 1
v_mul_u32_u24 v6, 16384, v6
v_lshl_add_u32 v5, v5, 10, v6
Q_slow:
buffer_load_dword v192, v5, s[64:67], s14 offen offset:768 sc1
s_waitcnt vmcnt(0)
v_cmp_eq_u32 vcc, -1, v192
s_cbranch_vccz Q_chk
s_sleep 8
s_sub_u32 s7, s7, 1
s_cmp_lg_u32 s7, 1
s_cbranch_scc1 Q_slow
Q_chk:
buffer_load_dwordx4 v[84:87], v2, s[64:67], s14 offen offset:0 sc1
buffer_load_dwordx4 v[88:91], v2, s[64:67], s14 offen offset:1024 sc1
buffer_load_dwordx4 v[92:95], v2, s[64:67], s14 offen offset:2048 sc1
buffer_load_dwordx4 v[96:99], v2, s[64:67], s14 offen offset:3072 sc1
buffer_load_dwordx4 v[100:103], v2, s[64:67], s15 offen offset:0 sc1
buffer_load_dwordx4 v[104:107], v2, s[64:67], s15 offen offset:1024 sc1
buffer_load_dwordx4 v[108:111], v2, s[64:67], s15 offen offset:2048 sc1
buffer_load_dwordx4 v[112:115], v2, s[64:67], s15 offen offset:3072 sc1
s_waitcnt vmcnt(0)
v_max3_u32 v192, v84, v85, v86
v_max3_u32 v192, v192, v87, v88
v_max3_u32 v192, v192, v89, v90
v_max3_u32 v192, v192, v91, v92
v_max3_u32 v192, v192, v93, v94
v_max3_u32 v192, v192, v95, v96
v_max3_u32 v192, v192, v97, v98
v_max3_u32 v192, v192, v99, v100
v_max3_u32 v192, v192, v101, v102
v_max3_u32 v192, v192, v103, v104
v_max3_u32 v192, v192, v105, v106
v_max3_u32 v192, v192, v107, v108
v_max3_u32 v192, v192, v109, v110
v_max3_u32 v192, v192, v111, v112
v_max3_u32 v192, v192, v113, v114
v_max_u32 v192, v192, v115
v_cmp_eq_u32 vcc, -1, v192
s_cbranch_vccz Q_ok
s_sleep 16
s_sub_u32 s7, s7, 1
s_cmp_lg_u32 s7, 0
s_cbranch_scc1 Q_chk
Q_ok:
ds_write_b128 v204, v[84:87] offset:0
ds_write_b128 v204, v[88:91] offset:1056
ds_write_b128 v204, v[92:95] offset:2112
ds_write_b128 v204, v[96:99] offset:3168
s_waitcnt lgkmcnt(0)
s_barrier
ds_read_b128 a[0:3], v203 offset:0
ds_read_b128 a[4:7], v203 offset:64
ds_read_b128 a[8:11], v203 offset:128
ds_read_b128 a[12:15], v203 offset:192
ds_read_b128 a[16:19], v203 offset:256
ds_read_b128 a[20:23], v203 offset:320
ds_read_b128 a[24:27], v203 offset:384
ds_read_b128 a[28:31], v203 offset:448
ds_read_b128 a[32:35], v203 offset:512
ds_read_b128 a[36:39], v203 offset:576
ds_read_b128 a[40:43], v203 offset:640
ds_read_b128 a[44:47], v203 offset:704
ds_read_b128 a[48:51], v203 offset:768
ds_read_b128 a[52:55], v203 offset:832
ds_read_b128 a[56:59], v203 offset:896
ds_read_b128 a[60:63], v203 offset:960
s_waitcnt lgkmcnt(0)
s_barrier
ds_write_b128 v204, v[100:103] offset:0
ds_write_b128 v204, v[104:107] offset:1056
ds_write_b128 v204, v[108:111] offset:2112
ds_write_b128 v204, v[112:115] offset:3168
s_waitcnt lgkmcnt(0)
s_barrier
ds_read_b128 a[64:67], v203 offset:0
ds_read_b128 a[68:71], v203 offset:64
ds_read_b128 a[72:75], v203 offset:128
ds_read_b128 a[76:79], v203 offset:192
ds_read_b128 a[80:83], v203 offset:256
ds_read_b128 a[84:87], v203 offset:320
ds_read_b128 a[88:91], v203 offset:384
ds_read_b128 a[92:95], v203 offset:448
ds_read_b128 a[96:99], v203 offset:512
ds_read_b128 a[100:103], v203 offset:576
ds_read_b128 a[104:107], v203 offset:640
ds_read_b128 a[108:111], v203 offset:704
ds_read_b128 a[112:115], v203 offset:768
ds_read_b128 a[116:119], v203 offset:832
ds_read_b128 a[120:123], v203 offset:896
ds_read_b128 a[124:127], v203 offset:960
s_waitcnt lgkmcnt(0)
s_mov_b32 s81, 4
ds_read_b128 v[84:87], v194 offset:0
ds_read_b128 v[88:91], v194 offset:64
ds_read_b128 v[92:95], v194 offset:128
ds_read_b128 v[96:99], v194 offset:192
ds_read_b128 v[100:103], v194 offset:256
ds_read_b128 v[104:107], v194 offset:320
ds_read_b128 v[108:111], v194 offset:384
ds_read_b128 v[112:115], v194 offset:448
ds_read_b128 v[116:119], v194 offset:512
ds_read_b128 v[120:123], v194 offset:576
ds_read_b128 v[124:127], v194 offset:640
ds_read_b128 v[128:131], v194 offset:704
ds_read_b128 v[132:135], v194 offset:768
ds_read_b128 v[136:139], v194 offset:832
ds_read_b128 v[140:143], v194 offset:896
ds_read_b128 v[144:147], v194 offset:960
s_waitcnt lgkmcnt(15)
v_mfma_f32_16x16x32_bf16 v[76:79], v[84:87], a[0:3], 0
v_mfma_f32_16x16x32_bf16 v[80:83], v[84:87], a[64:67], 0
s_waitcnt lgkmcnt(14)
v_mfma_f32_16x16x32_bf16 v[76:79], v[88:91], a[4:7], v[76:79]
v_mfma_f32_16x16x32_bf16 v[80:83], v[88:91], a[68:71], v[80:83]
s_waitcnt lgkmcnt(13)
v_mfma_f32_16x16x32_bf16 v[76:79], v[92:95], a[8:11], v[76:79]
v_mfma_f32_16x16x32_bf16 v[80:83], v[92:95], a[72:75], v[80:83]
s_waitcnt lgkmcnt(12)
v_mfma_f32_16x16x32_bf16 v[76:79], v[96:99], a[12:15], v[76:79]
v_mfma_f32_16x16x32_bf16 v[80:83], v[96:99], a[76:79], v[80:83]
s_waitcnt lgkmcnt(11)
v_mfma_f32_16x16x32_bf16 v[76:79], v[100:103], a[16:19], v[76:79]
v_mfma_f32_16x16x32_bf16 v[80:83], v[100:103], a[80:83], v[80:83]
s_waitcnt lgkmcnt(10)
v_mfma_f32_16x16x32_bf16 v[76:79], v[104:107], a[20:23], v[76:79]
v_mfma_f32_16x16x32_bf16 v[80:83], v[104:107], a[84:87], v[80:83]
s_waitcnt lgkmcnt(9)
v_mfma_f32_16x16x32_bf16 v[76:79], v[108:111], a[24:27], v[76:79]
v_mfma_f32_16x16x32_bf16 v[80:83], v[108:111], a[88:91], v[80:83]
s_waitcnt lgkmcnt(8)
v_mfma_f32_16x16x32_bf16 v[76:79], v[112:115], a[28:31], v[76:79]
v_mfma_f32_16x16x32_bf16 v[80:83], v[112:115], a[92:95], v[80:83]
s_waitcnt lgkmcnt(7)
v_mfma_f32_16x16x32_bf16 v[76:79], v[116:119], a[32:35], v[76:79]
v_mfma_f32_16x16x32_bf16 v[80:83], v[116:119], a[96:99], v[80:83]
s_waitcnt lgkmcnt(6)
v_mfma_f32_16x16x32_bf16 v[76:79], v[120:123], a[36:39], v[76:79]
v_mfma_f32_16x16x32_bf16 v[80:83], v[120:123], a[100:103], v[80:83]
s_waitcnt lgkmcnt(5)
v_mfma_f32_16x16x32_bf16 v[76:79], v[124:127], a[40:43], v[76:79]
v_mfma_f32_16x16x32_bf16 v[80:83], v[124:127], a[104:107], v[80:83]
s_waitcnt lgkmcnt(4)
v_mfma_f32_16x16x32_bf16 v[76:79], v[128:131], a[44:47], v[76:79]
v_mfma_f32_16x16x32_bf16 v[80:83], v[128:131], a[108:111], v[80:83]
s_waitcnt lgkmcnt(3)
v_mfma_f32_16x16x32_bf16 v[76:79], v[132:135], a[48:51], v[76:79]
v_mfma_f32_16x16x32_bf16 v[80:83], v[132:135], a[112:115], v[80:83]
s_waitcnt lgkmcnt(2)
v_mfma_f32_16x16x32_bf16 v[76:79], v[136:139], a[52:55], v[76:79]
v_mfma_f32_16x16x32_bf16 v[80:83], v[136:139], a[116:119], v[80:83]
s_waitcnt lgkmcnt(1)
v_mfma_f32_16x16x32_bf16 v[76:79], v[140:143], a[56:59], v[76:79]
v_mfma_f32_16x16x32_bf16 v[80:83], v[140:143], a[120:123], v[80:83]
s_waitcnt lgkmcnt(0)
v_mfma_f32_16x16x32_bf16 v[76:79], v[144:147], a[60:63], v[76:79]
v_mfma_f32_16x16x32_bf16 v[80:83], v[144:147], a[124:127], v[80:83]
s_nop 6
v_max_f32 v190, v76, v77
v_max3_f32 v190, v190, v78, v79
v_mov_b32 v192, v190
s_nop 1
v_permlane16_swap_b32 v190, v192
v_max_f32 v190, v190, v192
v_mov_b32 v192, v190
s_nop 1
v_permlane32_swap_b32 v190, v192
v_max_f32 v190, v190, v192
ds_write_b32 v198, v190 offset:0
v_max_f32 v191, v80, v81
v_max3_f32 v191, v191, v82, v83
v_mov_b32 v192, v191
s_nop 1
v_permlane16_swap_b32 v191, v192
v_max_f32 v191, v191, v192
v_mov_b32 v192, v191
s_nop 1
v_permlane32_swap_b32 v191, v192
v_max_f32 v191, v191, v192
ds_write_b32 v198, v191 offset:256
s_waitcnt lgkmcnt(0)
s_barrier
ds_read_b128 v[164:167], v199
ds_read_b128 v[168:171], v199 offset:256
ds_read_b128 v[172:175], v200
s_waitcnt lgkmcnt(0)
v_max_f32 v164, v164, v165
v_max3_f32 v164, v164, v166, v167
v_mul_f32 v164, v164, v185
v_max_f32 v164, v164, v176
v_sub_f32 v182, v176, v164
v_exp_f32 v182, v182
v_mov_b32 v176, v164
v_max_f32 v168, v168, v169
v_max3_f32 v168, v168, v170, v171
v_mul_f32 v168, v168, v185
v_max_f32 v168, v168, v177
v_sub_f32 v183, v177, v168
v_exp_f32 v183, v183
v_mov_b32 v177, v168
v_max_f32 v172, v172, v173
v_max3_f32 v172, v172, v174, v175
v_mul_f32 v172, v172, v185
v_max_f32 v172, v172, v178
v_sub_f32 v184, v178, v172
v_exp_f32 v184, v184
v_mov_b32 v178, v172
v_fma_f32 v76, v76, v185, -v176
v_fma_f32 v77, v77, v185, -v176
v_fma_f32 v78, v78, v185, -v176
v_fma_f32 v79, v79, v185, -v176
v_exp_f32 v76, v76
v_exp_f32 v77, v77
v_exp_f32 v78, v78
v_exp_f32 v79, v79
v_mul_f32 v180, v180, v182
v_cvt_pk_bf16_f32 v186, v76, v77
v_cvt_pk_bf16_f32 v187, v78, v79
ds_write_b64 v201, v[186:187] offset:0
v_add_f32 v180, v180, v76
v_add_f32 v180, v180, v77
v_add_f32 v180, v180, v78
v_add_f32 v180, v180, v79
v_fma_f32 v80, v80, v185, -v177
v_fma_f32 v81, v81, v185, -v177
v_fma_f32 v82, v82, v185, -v177
v_fma_f32 v83, v83, v185, -v177
v_exp_f32 v80, v80
v_exp_f32 v81, v81
v_exp_f32 v82, v82
v_exp_f32 v83, v83
v_mul_f32 v181, v181, v183
v_cvt_pk_bf16_f32 v188, v80, v81
v_cvt_pk_bf16_f32 v189, v82, v83
ds_write_b64 v201, v[188:189] offset:512
v_add_f32 v181, v181, v80
v_add_f32 v181, v181, v81
v_add_f32 v181, v181, v82
v_add_f32 v181, v181, v83
s_waitcnt lgkmcnt(0)
s_barrier
ds_read_b128 v[148:151], v202 offset:0
ds_read_b128 v[152:155], v202 offset:1024
ds_read_b128 v[156:159], v202 offset:2048
ds_read_b128 v[160:163], v202 offset:3072
ds_read_b64_tr_b16 v[84:85], v196 offset:0
ds_read_b64_tr_b16 v[86:87], v196 offset:4352
ds_read_b64_tr_b16 v[88:89], v196 offset:64
ds_read_b64_tr_b16 v[90:91], v196 offset:4416
ds_read_b64_tr_b16 v[92:93], v196 offset:128
ds_read_b64_tr_b16 v[94:95], v196 offset:4480
ds_read_b64_tr_b16 v[96:97], v196 offset:192
ds_read_b64_tr_b16 v[98:99], v196 offset:4544
ds_read_b64_tr_b16 v[100:101], v196 offset:17408
ds_read_b64_tr_b16 v[102:103], v196 offset:21760
ds_read_b64_tr_b16 v[104:105], v196 offset:17472
ds_read_b64_tr_b16 v[106:107], v196 offset:21824
ds_read_b64_tr_b16 v[108:109], v196 offset:17536
ds_read_b64_tr_b16 v[110:111], v196 offset:21888
ds_read_b64_tr_b16 v[112:113], v196 offset:17600
ds_read_b64_tr_b16 v[114:115], v196 offset:21952
ds_read_b64_tr_b16 v[116:117], v196 offset:34816
ds_read_b64_tr_b16 v[118:119], v196 offset:39168
ds_read_b64_tr_b16 v[120:121], v196 offset:34880
ds_read_b64_tr_b16 v[122:123], v196 offset:39232
ds_read_b64_tr_b16 v[124:125], v196 offset:34944
ds_read_b64_tr_b16 v[126:127], v196 offset:39296
ds_read_b64_tr_b16 v[128:129], v196 offset:35008
ds_read_b64_tr_b16 v[130:131], v196 offset:39360
ds_read_b64_tr_b16 v[132:133], v196 offset:52224
ds_read_b64_tr_b16 v[134:135], v196 offset:56576
ds_read_b64_tr_b16 v[136:137], v196 offset:52288
ds_read_b64_tr_b16 v[138:139], v196 offset:56640
ds_read_b64_tr_b16 v[140:141], v196 offset:52352
ds_read_b64_tr_b16 v[142:143], v196 offset:56704
ds_read_b64_tr_b16 v[144:145], v196 offset:52416
ds_read_b64_tr_b16 v[146:147], v196 offset:56768
s_waitcnt lgkmcnt(15)
v_mfma_f32_32x32x16_bf16 v[12:27], v[84:87], v[148:151], 0
v_mfma_f32_32x32x16_bf16 v[28:43], v[88:91], v[148:151], 0
v_mfma_f32_32x32x16_bf16 v[44:59], v[92:95], v[148:151], 0
v_mfma_f32_32x32x16_bf16 v[60:75], v[96:99], v[148:151], 0
s_waitcnt lgkmcnt(15)
v_mfma_f32_32x32x16_bf16 v[12:27], v[100:103], v[152:155], v[12:27]
v_mfma_f32_32x32x16_bf16 v[28:43], v[104:107], v[152:155], v[28:43]
v_mfma_f32_32x32x16_bf16 v[44:59], v[108:111], v[152:155], v[44:59]
v_mfma_f32_32x32x16_bf16 v[60:75], v[112:115], v[152:155], v[60:75]
s_waitcnt lgkmcnt(8)
v_mfma_f32_32x32x16_bf16 v[12:27], v[116:119], v[156:159], v[12:27]
v_mfma_f32_32x32x16_bf16 v[28:43], v[120:123], v[156:159], v[28:43]
v_mfma_f32_32x32x16_bf16 v[44:59], v[124:127], v[156:159], v[44:59]
v_mfma_f32_32x32x16_bf16 v[60:75], v[128:131], v[156:159], v[60:75]
s_waitcnt lgkmcnt(0)
v_mfma_f32_32x32x16_bf16 v[12:27], v[132:135], v[160:163], v[12:27]
v_mfma_f32_32x32x16_bf16 v[28:43], v[136:139], v[160:163], v[28:43]
v_mfma_f32_32x32x16_bf16 v[44:59], v[140:143], v[160:163], v[44:59]
v_mfma_f32_32x32x16_bf16 v[60:75], v[144:147], v[160:163], v[60:75]
ds_read_b128 v[84:87], v195 offset:0
ds_read_b128 v[88:91], v195 offset:64
ds_read_b128 v[92:95], v195 offset:128
ds_read_b128 v[96:99], v195 offset:192
ds_read_b128 v[100:103], v195 offset:256
ds_read_b128 v[104:107], v195 offset:320
ds_read_b128 v[108:111], v195 offset:384
ds_read_b128 v[112:115], v195 offset:448
ds_read_b128 v[116:119], v195 offset:512
ds_read_b128 v[120:123], v195 offset:576
ds_read_b128 v[124:127], v195 offset:640
ds_read_b128 v[128:131], v195 offset:704
ds_read_b128 v[132:135], v195 offset:768
ds_read_b128 v[136:139], v195 offset:832
ds_read_b128 v[140:143], v195 offset:896
ds_read_b128 v[144:147], v195 offset:960
s_waitcnt lgkmcnt(15)
v_mfma_f32_16x16x32_bf16 v[76:79], v[84:87], a[0:3], 0
v_mfma_f32_16x16x32_bf16 v[80:83], v[84:87], a[64:67], 0
s_waitcnt lgkmcnt(14)
v_mfma_f32_16x16x32_bf16 v[76:79], v[88:91], a[4:7], v[76:79]
v_mfma_f32_16x16x32_bf16 v[80:83], v[88:91], a[68:71], v[80:83]
s_waitcnt lgkmcnt(13)
v_mfma_f32_16x16x32_bf16 v[76:79], v[92:95], a[8:11], v[76:79]
v_mfma_f32_16x16x32_bf16 v[80:83], v[92:95], a[72:75], v[80:83]
s_waitcnt lgkmcnt(12)
v_mfma_f32_16x16x32_bf16 v[76:79], v[96:99], a[12:15], v[76:79]
v_mfma_f32_16x16x32_bf16 v[80:83], v[96:99], a[76:79], v[80:83]
s_waitcnt lgkmcnt(11)
v_mfma_f32_16x16x32_bf16 v[76:79], v[100:103], a[16:19], v[76:79]
v_mfma_f32_16x16x32_bf16 v[80:83], v[100:103], a[80:83], v[80:83]
s_waitcnt lgkmcnt(10)
v_mfma_f32_16x16x32_bf16 v[76:79], v[104:107], a[20:23], v[76:79]
v_mfma_f32_16x16x32_bf16 v[80:83], v[104:107], a[84:87], v[80:83]
s_waitcnt lgkmcnt(9)
v_mfma_f32_16x16x32_bf16 v[76:79], v[108:111], a[24:27], v[76:79]
v_mfma_f32_16x16x32_bf16 v[80:83], v[108:111], a[88:91], v[80:83]
s_waitcnt lgkmcnt(8)
v_mfma_f32_16x16x32_bf16 v[76:79], v[112:115], a[28:31], v[76:79]
v_mfma_f32_16x16x32_bf16 v[80:83], v[112:115], a[92:95], v[80:83]
s_waitcnt lgkmcnt(7)
v_mfma_f32_16x16x32_bf16 v[76:79], v[116:119], a[32:35], v[76:79]
v_mfma_f32_16x16x32_bf16 v[80:83], v[116:119], a[96:99], v[80:83]
s_waitcnt lgkmcnt(6)
v_mfma_f32_16x16x32_bf16 v[76:79], v[120:123], a[36:39], v[76:79]
v_mfma_f32_16x16x32_bf16 v[80:83], v[120:123], a[100:103], v[80:83]
s_waitcnt lgkmcnt(5)
v_mfma_f32_16x16x32_bf16 v[76:79], v[124:127], a[40:43], v[76:79]
v_mfma_f32_16x16x32_bf16 v[80:83], v[124:127], a[104:107], v[80:83]
s_waitcnt lgkmcnt(4)
v_mfma_f32_16x16x32_bf16 v[76:79], v[128:131], a[44:47], v[76:79]
v_mfma_f32_16x16x32_bf16 v[80:83], v[128:131], a[108:111], v[80:83]
s_waitcnt lgkmcnt(3)
v_mfma_f32_16x16x32_bf16 v[76:79], v[132:135], a[48:51], v[76:79]
v_mfma_f32_16x16x32_bf16 v[80:83], v[132:135], a[112:115], v[80:83]
s_waitcnt lgkmcnt(2)
v_mfma_f32_16x16x32_bf16 v[76:79], v[136:139], a[52:55], v[76:79]
v_mfma_f32_16x16x32_bf16 v[80:83], v[136:139], a[116:119], v[80:83]
s_waitcnt lgkmcnt(1)
v_mfma_f32_16x16x32_bf16 v[76:79], v[140:143], a[56:59], v[76:79]
v_mfma_f32_16x16x32_bf16 v[80:83], v[140:143], a[120:123], v[80:83]
s_waitcnt lgkmcnt(0)
v_mfma_f32_16x16x32_bf16 v[76:79], v[144:147], a[60:63], v[76:79]
v_mfma_f32_16x16x32_bf16 v[80:83], v[144:147], a[124:127], v[80:83]
s_nop 6
v_max_f32 v190, v76, v77
v_max3_f32 v190, v190, v78, v79
v_mov_b32 v192, v190
s_nop 1
v_permlane16_swap_b32 v190, v192
v_max_f32 v190, v190, v192
v_mov_b32 v192, v190
s_nop 1
v_permlane32_swap_b32 v190, v192
v_max_f32 v190, v190, v192
ds_write_b32 v198, v190 offset:0
v_max_f32 v191, v80, v81
v_max3_f32 v191, v191, v82, v83
v_mov_b32 v192, v191
s_nop 1
v_permlane16_swap_b32 v191, v192
v_max_f32 v191, v191, v192
v_mov_b32 v192, v191
s_nop 1
v_permlane32_swap_b32 v191, v192
v_max_f32 v191, v191, v192
ds_write_b32 v198, v191 offset:256
s_waitcnt lgkmcnt(0)
s_barrier
ds_read_b128 v[164:167], v199
ds_read_b128 v[168:171], v199 offset:256
ds_read_b128 v[172:175], v200
ds_write_b128 v206, a[128:131] offset:0
ds_write_b128 v206, a[132:135] offset:1088
ds_write_b128 v206, a[136:139] offset:2176
ds_write_b128 v206, a[140:143] offset:3264
ds_write_b128 v206, a[144:147] offset:4352
ds_write_b128 v206, a[148:151] offset:5440
ds_write_b128 v206, a[152:155] offset:6528
ds_write_b128 v206, a[156:159] offset:7616
ds_write_b128 v206, a[160:163] offset:8704
ds_write_b128 v206, a[164:167] offset:9792
ds_write_b128 v206, a[168:171] offset:10880
ds_write_b128 v206, a[172:175] offset:11968
ds_write_b128 v206, a[176:179] offset:13056
ds_write_b128 v206, a[180:183] offset:14144
ds_write_b128 v206, a[184:187] offset:15232
ds_write_b128 v206, a[188:191] offset:16320
s_waitcnt lgkmcnt(15)
v_max_f32 v164, v164, v165
v_max3_f32 v164, v164, v166, v167
v_mul_f32 v164, v164, v185
v_max_f32 v164, v164, v176
v_sub_f32 v182, v176, v164
v_exp_f32 v182, v182
v_mov_b32 v176, v164
v_max_f32 v168, v168, v169
v_max3_f32 v168, v168, v170, v171
v_mul_f32 v168, v168, v185
v_max_f32 v168, v168, v177
v_sub_f32 v183, v177, v168
v_exp_f32 v183, v183
v_mov_b32 v177, v168
v_max_f32 v172, v172, v173
v_max3_f32 v172, v172, v174, v175
v_mul_f32 v172, v172, v185
v_max_f32 v172, v172, v178
v_sub_f32 v184, v178, v172
v_exp_f32 v184, v184
v_mov_b32 v178, v172
v_fma_f32 v76, v76, v185, -v176
v_fma_f32 v77, v77, v185, -v176
v_fma_f32 v78, v78, v185, -v176
v_fma_f32 v79, v79, v185, -v176
v_exp_f32 v76, v76
v_exp_f32 v77, v77
v_exp_f32 v78, v78
v_exp_f32 v79, v79
v_mul_f32 v180, v180, v182
v_cvt_pk_bf16_f32 v186, v76, v77
v_cvt_pk_bf16_f32 v187, v78, v79
ds_write_b64 v201, v[186:187] offset:0
v_add_f32 v180, v180, v76
v_add_f32 v180, v180, v77
v_add_f32 v180, v180, v78
v_add_f32 v180, v180, v79
v_fma_f32 v80, v80, v185, -v177
v_fma_f32 v81, v81, v185, -v177
v_fma_f32 v82, v82, v185, -v177
v_fma_f32 v83, v83, v185, -v177
v_exp_f32 v80, v80
v_exp_f32 v81, v81
v_exp_f32 v82, v82
v_exp_f32 v83, v83
v_mul_f32 v181, v181, v183
v_cvt_pk_bf16_f32 v188, v80, v81
v_cvt_pk_bf16_f32 v189, v82, v83
ds_write_b64 v201, v[188:189] offset:512
v_add_f32 v181, v181, v80
v_add_f32 v181, v181, v81
v_add_f32 v181, v181, v82
v_add_f32 v181, v181, v83
v_mul_f32 v12, v12, v184
v_mul_f32 v13, v13, v184
v_mul_f32 v14, v14, v184
v_mul_f32 v15, v15, v184
v_mul_f32 v16, v16, v184
v_mul_f32 v17, v17, v184
v_mul_f32 v18, v18, v184
v_mul_f32 v19, v19, v184
v_mul_f32 v20, v20, v184
v_mul_f32 v21, v21, v184
v_mul_f32 v22, v22, v184
v_mul_f32 v23, v23, v184
v_mul_f32 v24, v24, v184
v_mul_f32 v25, v25, v184
v_mul_f32 v26, v26, v184
v_mul_f32 v27, v27, v184
v_mul_f32 v28, v28, v184
v_mul_f32 v29, v29, v184
v_mul_f32 v30, v30, v184
v_mul_f32 v31, v31, v184
v_mul_f32 v32, v32, v184
v_mul_f32 v33, v33, v184
v_mul_f32 v34, v34, v184
v_mul_f32 v35, v35, v184
v_mul_f32 v36, v36, v184
v_mul_f32 v37, v37, v184
v_mul_f32 v38, v38, v184
v_mul_f32 v39, v39, v184
v_mul_f32 v40, v40, v184
v_mul_f32 v41, v41, v184
v_mul_f32 v42, v42, v184
v_mul_f32 v43, v43, v184
v_mul_f32 v44, v44, v184
v_mul_f32 v45, v45, v184
v_mul_f32 v46, v46, v184
v_mul_f32 v47, v47, v184
v_mul_f32 v48, v48, v184
v_mul_f32 v49, v49, v184
v_mul_f32 v50, v50, v184
v_mul_f32 v51, v51, v184
v_mul_f32 v52, v52, v184
v_mul_f32 v53, v53, v184
v_mul_f32 v54, v54, v184
v_mul_f32 v55, v55, v184
v_mul_f32 v56, v56, v184
v_mul_f32 v57, v57, v184
v_mul_f32 v58, v58, v184
v_mul_f32 v59, v59, v184
v_mul_f32 v60, v60, v184
v_mul_f32 v61, v61, v184
v_mul_f32 v62, v62, v184
v_mul_f32 v63, v63, v184
v_mul_f32 v64, v64, v184
v_mul_f32 v65, v65, v184
v_mul_f32 v66, v66, v184
v_mul_f32 v67, v67, v184
v_mul_f32 v68, v68, v184
v_mul_f32 v69, v69, v184
v_mul_f32 v70, v70, v184
v_mul_f32 v71, v71, v184
v_mul_f32 v72, v72, v184
v_mul_f32 v73, v73, v184
v_mul_f32 v74, v74, v184
v_mul_f32 v75, v75, v184
s_waitcnt lgkmcnt(0)
s_barrier
ds_read_b128 v[148:151], v202 offset:0
ds_read_b128 v[152:155], v202 offset:1024
ds_read_b128 v[156:159], v202 offset:2048
ds_read_b128 v[160:163], v202 offset:3072
ds_read_b64_tr_b16 v[84:85], v197 offset:0
ds_read_b64_tr_b16 v[86:87], v197 offset:4352
ds_read_b64_tr_b16 v[88:89], v197 offset:64
ds_read_b64_tr_b16 v[90:91], v197 offset:4416
ds_read_b64_tr_b16 v[92:93], v197 offset:128
ds_read_b64_tr_b16 v[94:95], v197 offset:4480
ds_read_b64_tr_b16 v[96:97], v197 offset:192
ds_read_b64_tr_b16 v[98:99], v197 offset:4544
ds_read_b64_tr_b16 v[100:101], v197 offset:17408
ds_read_b64_tr_b16 v[102:103], v197 offset:21760
ds_read_b64_tr_b16 v[104:105], v197 offset:17472
ds_read_b64_tr_b16 v[106:107], v197 offset:21824
ds_read_b64_tr_b16 v[108:109], v197 offset:17536
ds_read_b64_tr_b16 v[110:111], v197 offset:21888
ds_read_b64_tr_b16 v[112:113], v197 offset:17600
ds_read_b64_tr_b16 v[114:115], v197 offset:21952
ds_read_b64_tr_b16 v[116:117], v197 offset:34816
ds_read_b64_tr_b16 v[118:119], v197 offset:39168
ds_read_b64_tr_b16 v[120:121], v197 offset:34880
ds_read_b64_tr_b16 v[122:123], v197 offset:39232
ds_read_b64_tr_b16 v[124:125], v197 offset:34944
ds_read_b64_tr_b16 v[126:127], v197 offset:39296
ds_read_b64_tr_b16 v[128:129], v197 offset:35008
ds_read_b64_tr_b16 v[130:131], v197 offset:39360
ds_read_b64_tr_b16 v[132:133], v197 offset:52224
ds_read_b64_tr_b16 v[134:135], v197 offset:56576
ds_read_b64_tr_b16 v[136:137], v197 offset:52288
ds_read_b64_tr_b16 v[138:139], v197 offset:56640
ds_read_b64_tr_b16 v[140:141], v197 offset:52352
ds_read_b64_tr_b16 v[142:143], v197 offset:56704
ds_read_b64_tr_b16 v[144:145], v197 offset:52416
ds_read_b64_tr_b16 v[146:147], v197 offset:56768
s_waitcnt lgkmcnt(15)
v_mfma_f32_32x32x16_bf16 v[12:27], v[84:87], v[148:151], v[12:27]
v_mfma_f32_32x32x16_bf16 v[28:43], v[88:91], v[148:151], v[28:43]
s_add_u32 s6, s13, 2097152
buffer_load_dwordx4 a[128:131], v2, s[52:55], s6 offen nt
v_mfma_f32_32x32x16_bf16 v[44:59], v[92:95], v[148:151], v[44:59]
v_mfma_f32_32x32x16_bf16 v[60:75], v[96:99], v[148:151], v[60:75]
s_add_u32 s6, s13, 2098176
buffer_load_dwordx4 a[132:135], v2, s[52:55], s6 offen nt
s_waitcnt lgkmcnt(15)
v_mfma_f32_32x32x16_bf16 v[12:27], v[100:103], v[152:155], v[12:27]
v_mfma_f32_32x32x16_bf16 v[28:43], v[104:107], v[152:155], v[28:43]
s_add_u32 s6, s13, 2099200
buffer_load_dwordx4 a[136:139], v2, s[52:55], s6 offen nt
v_mfma_f32_32x32x16_bf16 v[44:59], v[108:111], v[152:155], v[44:59]
v_mfma_f32_32x32x16_bf16 v[60:75], v[112:115], v[152:155], v[60:75]
s_add_u32 s6, s13, 2100224
buffer_load_dwordx4 a[140:143], v2, s[52:55], s6 offen nt
s_waitcnt lgkmcnt(8)
v_mfma_f32_32x32x16_bf16 v[12:27], v[116:119], v[156:159], v[12:27]
v_mfma_f32_32x32x16_bf16 v[28:43], v[120:123], v[156:159], v[28:43]
s_add_u32 s6, s13, 2228224
buffer_load_dwordx4 a[144:147], v2, s[52:55], s6 offen nt
v_mfma_f32_32x32x16_bf16 v[44:59], v[124:127], v[156:159], v[44:59]
v_mfma_f32_32x32x16_bf16 v[60:75], v[128:131], v[156:159], v[60:75]
s_add_u32 s6, s13, 2229248
buffer_load_dwordx4 a[148:151], v2, s[52:55], s6 offen nt
s_waitcnt lgkmcnt(0)
v_mfma_f32_32x32x16_bf16 v[12:27], v[132:135], v[160:163], v[12:27]
v_mfma_f32_32x32x16_bf16 v[28:43], v[136:139], v[160:163], v[28:43]
s_add_u32 s6, s13, 2230272
buffer_load_dwordx4 a[152:155], v2, s[52:55], s6 offen nt
v_mfma_f32_32x32x16_bf16 v[44:59], v[140:143], v[160:163], v[44:59]
v_mfma_f32_32x32x16_bf16 v[60:75], v[144:147], v[160:163], v[60:75]
s_add_u32 s6, s13, 2231296
buffer_load_dwordx4 a[156:159], v2, s[52:55], s6 offen nt
ds_read_b128 v[84:87], v194 offset:0
ds_read_b128 v[88:91], v194 offset:64
ds_read_b128 v[92:95], v194 offset:128
ds_read_b128 v[96:99], v194 offset:192
ds_read_b128 v[100:103], v194 offset:256
ds_read_b128 v[104:107], v194 offset:320
ds_read_b128 v[108:111], v194 offset:384
ds_read_b128 v[112:115], v194 offset:448
ds_read_b128 v[116:119], v194 offset:512
ds_read_b128 v[120:123], v194 offset:576
ds_read_b128 v[124:127], v194 offset:640
ds_read_b128 v[128:131], v194 offset:704
ds_read_b128 v[132:135], v194 offset:768
ds_read_b128 v[136:139], v194 offset:832
ds_read_b128 v[140:143], v194 offset:896
ds_read_b128 v[144:147], v194 offset:960
s_waitcnt lgkmcnt(15)
v_mfma_f32_16x16x32_bf16 v[76:79], v[84:87], a[0:3], 0
v_mfma_f32_16x16x32_bf16 v[80:83], v[84:87], a[64:67], 0
s_waitcnt lgkmcnt(14)
v_mfma_f32_16x16x32_bf16 v[76:79], v[88:91], a[4:7], v[76:79]
v_mfma_f32_16x16x32_bf16 v[80:83], v[88:91], a[68:71], v[80:83]
s_add_u32 s6, s13, 2359296
buffer_load_dwordx4 a[160:163], v10, s[52:55], s6 offen nt
s_waitcnt lgkmcnt(13)
v_mfma_f32_16x16x32_bf16 v[76:79], v[92:95], a[8:11], v[76:79]
v_mfma_f32_16x16x32_bf16 v[80:83], v[92:95], a[72:75], v[80:83]
s_waitcnt lgkmcnt(12)
v_mfma_f32_16x16x32_bf16 v[76:79], v[96:99], a[12:15], v[76:79]
v_mfma_f32_16x16x32_bf16 v[80:83], v[96:99], a[76:79], v[80:83]
s_add_u32 s6, s13, 2360320
buffer_load_dwordx4 a[164:167], v10, s[52:55], s6 offen nt
s_waitcnt lgkmcnt(11)
v_mfma_f32_16x16x32_bf16 v[76:79], v[100:103], a[16:19], v[76:79]
v_mfma_f32_16x16x32_bf16 v[80:83], v[100:103], a[80:83], v[80:83]
s_waitcnt lgkmcnt(10)
v_mfma_f32_16x16x32_bf16 v[76:79], v[104:107], a[20:23], v[76:79]
v_mfma_f32_16x16x32_bf16 v[80:83], v[104:107], a[84:87], v[80:83]
s_add_u32 s6, s13, 2361344
buffer_load_dwordx4 a[168:171], v10, s[52:55], s6 offen nt
s_waitcnt lgkmcnt(9)
v_mfma_f32_16x16x32_bf16 v[76:79], v[108:111], a[24:27], v[76:79]
v_mfma_f32_16x16x32_bf16 v[80:83], v[108:111], a[88:91], v[80:83]
s_waitcnt lgkmcnt(8)
v_mfma_f32_16x16x32_bf16 v[76:79], v[112:115], a[28:31], v[76:79]
v_mfma_f32_16x16x32_bf16 v[80:83], v[112:115], a[92:95], v[80:83]
s_add_u32 s6, s13, 2362368
buffer_load_dwordx4 a[172:175], v10, s[52:55], s6 offen nt
s_waitcnt lgkmcnt(7)
v_mfma_f32_16x16x32_bf16 v[76:79], v[116:119], a[32:35], v[76:79]
v_mfma_f32_16x16x32_bf16 v[80:83], v[116:119], a[96:99], v[80:83]
s_waitcnt lgkmcnt(6)
v_mfma_f32_16x16x32_bf16 v[76:79], v[120:123], a[36:39], v[76:79]
v_mfma_f32_16x16x32_bf16 v[80:83], v[120:123], a[100:103], v[80:83]
s_add_u32 s6, s13, 2490368
buffer_load_dwordx4 a[176:179], v10, s[52:55], s6 offen nt
s_waitcnt lgkmcnt(5)
v_mfma_f32_16x16x32_bf16 v[76:79], v[124:127], a[40:43], v[76:79]
v_mfma_f32_16x16x32_bf16 v[80:83], v[124:127], a[104:107], v[80:83]
s_waitcnt lgkmcnt(4)
v_mfma_f32_16x16x32_bf16 v[76:79], v[128:131], a[44:47], v[76:79]
v_mfma_f32_16x16x32_bf16 v[80:83], v[128:131], a[108:111], v[80:83]
s_add_u32 s6, s13, 2491392
buffer_load_dwordx4 a[180:183], v10, s[52:55], s6 offen nt
s_waitcnt lgkmcnt(3)
v_mfma_f32_16x16x32_bf16 v[76:79], v[132:135], a[48:51], v[76:79]
v_mfma_f32_16x16x32_bf16 v[80:83], v[132:135], a[112:115], v[80:83]
s_waitcnt lgkmcnt(2)
v_mfma_f32_16x16x32_bf16 v[76:79], v[136:139], a[52:55], v[76:79]
v_mfma_f32_16x16x32_bf16 v[80:83], v[136:139], a[116:119], v[80:83]
s_add_u32 s6, s13, 2492416
buffer_load_dwordx4 a[184:187], v10, s[52:55], s6 offen nt
s_waitcnt lgkmcnt(1)
v_mfma_f32_16x16x32_bf16 v[76:79], v[140:143], a[56:59], v[76:79]
v_mfma_f32_16x16x32_bf16 v[80:83], v[140:143], a[120:123], v[80:83]
s_waitcnt lgkmcnt(0)
v_mfma_f32_16x16x32_bf16 v[76:79], v[144:147], a[60:63], v[76:79]
v_mfma_f32_16x16x32_bf16 v[80:83], v[144:147], a[124:127], v[80:83]
s_add_u32 s6, s13, 2493440
buffer_load_dwordx4 a[188:191], v10, s[52:55], s6 offen nt
s_nop 4
v_max_f32 v190, v76, v77
v_max3_f32 v190, v190, v78, v79
v_mov_b32 v192, v190
s_nop 1
v_permlane16_swap_b32 v190, v192
v_max_f32 v190, v190, v192
v_mov_b32 v192, v190
s_nop 1
v_permlane32_swap_b32 v190, v192
v_max_f32 v190, v190, v192
ds_write_b32 v198, v190 offset:0
v_max_f32 v191, v80, v81
v_max3_f32 v191, v191, v82, v83
v_mov_b32 v192, v191
s_nop 1
v_permlane16_swap_b32 v191, v192
v_max_f32 v191, v191, v192
v_mov_b32 v192, v191
s_nop 1
v_permlane32_swap_b32 v191, v192
v_max_f32 v191, v191, v192
ds_write_b32 v198, v191 offset:256
s_waitcnt lgkmcnt(0)
s_barrier
ds_read_b128 v[164:167], v199
ds_read_b128 v[168:171], v199 offset:256
ds_read_b128 v[172:175], v200
ds_write_b128 v207, a[192:195] offset:0
ds_write_b128 v207, a[196:199] offset:1088
ds_write_b128 v207, a[200:203] offset:2176
ds_write_b128 v207, a[204:207] offset:3264
ds_write_b128 v207, a[208:211] offset:4352
ds_write_b128 v207, a[212:215] offset:5440
ds_write_b128 v207, a[216:219] offset:6528
ds_write_b128 v207, a[220:223] offset:7616
ds_write_b128 v207, a[224:227] offset:8704
ds_write_b128 v207, a[228:231] offset:9792
ds_write_b128 v207, a[232:235] offset:10880
ds_write_b128 v207, a[236:239] offset:11968
ds_write_b128 v207, a[240:243] offset:13056
ds_write_b128 v207, a[244:247] offset:14144
ds_write_b128 v207, a[248:251] offset:15232
ds_write_b128 v207, a[252:255] offset:16320
s_waitcnt lgkmcnt(15)
v_max_f32 v164, v164, v165
v_max3_f32 v164, v164, v166, v167
v_mul_f32 v164, v164, v185
v_max_f32 v164, v164, v176
v_sub_f32 v182, v176, v164
v_exp_f32 v182, v182
v_mov_b32 v176, v164
v_max_f32 v168, v168, v169
v_max3_f32 v168, v168, v170, v171
v_mul_f32 v168, v168, v185
v_max_f32 v168, v168, v177
v_sub_f32 v183, v177, v168
v_exp_f32 v183, v183
v_mov_b32 v177, v168
v_max_f32 v172, v172, v173
v_max3_f32 v172, v172, v174, v175
v_mul_f32 v172, v172, v185
v_max_f32 v172, v172, v178
v_sub_f32 v184, v178, v172
v_exp_f32 v184, v184
v_mov_b32 v178, v172
v_fma_f32 v76, v76, v185, -v176
v_fma_f32 v77, v77, v185, -v176
v_fma_f32 v78, v78, v185, -v176
v_fma_f32 v79, v79, v185, -v176
v_exp_f32 v76, v76
v_exp_f32 v77, v77
v_exp_f32 v78, v78
v_exp_f32 v79, v79
v_mul_f32 v180, v180, v182
v_cvt_pk_bf16_f32 v186, v76, v77
v_cvt_pk_bf16_f32 v187, v78, v79
ds_write_b64 v201, v[186:187] offset:0
v_add_f32 v180, v180, v76
v_add_f32 v180, v180, v77
v_add_f32 v180, v180, v78
v_add_f32 v180, v180, v79
v_fma_f32 v80, v80, v185, -v177
v_fma_f32 v81, v81, v185, -v177
v_fma_f32 v82, v82, v185, -v177
v_fma_f32 v83, v83, v185, -v177
v_exp_f32 v80, v80
v_exp_f32 v81, v81
v_exp_f32 v82, v82
v_exp_f32 v83, v83
v_mul_f32 v181, v181, v183
v_cvt_pk_bf16_f32 v188, v80, v81
v_cvt_pk_bf16_f32 v189, v82, v83
ds_write_b64 v201, v[188:189] offset:512
v_add_f32 v181, v181, v80
v_add_f32 v181, v181, v81
v_add_f32 v181, v181, v82
v_add_f32 v181, v181, v83
v_mul_f32 v12, v12, v184
v_mul_f32 v13, v13, v184
v_mul_f32 v14, v14, v184
v_mul_f32 v15, v15, v184
v_mul_f32 v16, v16, v184
v_mul_f32 v17, v17, v184
v_mul_f32 v18, v18, v184
v_mul_f32 v19, v19, v184
v_mul_f32 v20, v20, v184
v_mul_f32 v21, v21, v184
v_mul_f32 v22, v22, v184
v_mul_f32 v23, v23, v184
v_mul_f32 v24, v24, v184
v_mul_f32 v25, v25, v184
v_mul_f32 v26, v26, v184
v_mul_f32 v27, v27, v184
v_mul_f32 v28, v28, v184
v_mul_f32 v29, v29, v184
v_mul_f32 v30, v30, v184
v_mul_f32 v31, v31, v184
v_mul_f32 v32, v32, v184
v_mul_f32 v33, v33, v184
v_mul_f32 v34, v34, v184
v_mul_f32 v35, v35, v184
v_mul_f32 v36, v36, v184
v_mul_f32 v37, v37, v184
v_mul_f32 v38, v38, v184
v_mul_f32 v39, v39, v184
v_mul_f32 v40, v40, v184
v_mul_f32 v41, v41, v184
v_mul_f32 v42, v42, v184
v_mul_f32 v43, v43, v184
v_mul_f32 v44, v44, v184
v_mul_f32 v45, v45, v184
v_mul_f32 v46, v46, v184
v_mul_f32 v47, v47, v184
v_mul_f32 v48, v48, v184
v_mul_f32 v49, v49, v184
v_mul_f32 v50, v50, v184
v_mul_f32 v51, v51, v184
v_mul_f32 v52, v52, v184
v_mul_f32 v53, v53, v184
v_mul_f32 v54, v54, v184
v_mul_f32 v55, v55, v184
v_mul_f32 v56, v56, v184
v_mul_f32 v57, v57, v184
v_mul_f32 v58, v58, v184
v_mul_f32 v59, v59, v184
v_mul_f32 v60, v60, v184
v_mul_f32 v61, v61, v184
v_mul_f32 v62, v62, v184
v_mul_f32 v63, v63, v184
v_mul_f32 v64, v64, v184
v_mul_f32 v65, v65, v184
v_mul_f32 v66, v66, v184
v_mul_f32 v67, v67, v184
v_mul_f32 v68, v68, v184
v_mul_f32 v69, v69, v184
v_mul_f32 v70, v70, v184
v_mul_f32 v71, v71, v184
v_mul_f32 v72, v72, v184
v_mul_f32 v73, v73, v184
v_mul_f32 v74, v74, v184
v_mul_f32 v75, v75, v184
s_waitcnt lgkmcnt(0)
s_barrier
ds_read_b128 v[148:151], v202 offset:0
ds_read_b128 v[152:155], v202 offset:1024
ds_read_b128 v[156:159], v202 offset:2048
ds_read_b128 v[160:163], v202 offset:3072
ds_read_b64_tr_b16 v[84:85], v196 offset:0
ds_read_b64_tr_b16 v[86:87], v196 offset:4352
ds_read_b64_tr_b16 v[88:89], v196 offset:64
ds_read_b64_tr_b16 v[90:91], v196 offset:4416
ds_read_b64_tr_b16 v[92:93], v196 offset:128
ds_read_b64_tr_b16 v[94:95], v196 offset:4480
ds_read_b64_tr_b16 v[96:97], v196 offset:192
ds_read_b64_tr_b16 v[98:99], v196 offset:4544
ds_read_b64_tr_b16 v[100:101], v196 offset:17408
ds_read_b64_tr_b16 v[102:103], v196 offset:21760
ds_read_b64_tr_b16 v[104:105], v196 offset:17472
ds_read_b64_tr_b16 v[106:107], v196 offset:21824
ds_read_b64_tr_b16 v[108:109], v196 offset:17536
ds_read_b64_tr_b16 v[110:111], v196 offset:21888
ds_read_b64_tr_b16 v[112:113], v196 offset:17600
ds_read_b64_tr_b16 v[114:115], v196 offset:21952
ds_read_b64_tr_b16 v[116:117], v196 offset:34816
ds_read_b64_tr_b16 v[118:119], v196 offset:39168
ds_read_b64_tr_b16 v[120:121], v196 offset:34880
ds_read_b64_tr_b16 v[122:123], v196 offset:39232
ds_read_b64_tr_b16 v[124:125], v196 offset:34944
ds_read_b64_tr_b16 v[126:127], v196 offset:39296
ds_read_b64_tr_b16 v[128:129], v196 offset:35008
ds_read_b64_tr_b16 v[130:131], v196 offset:39360
ds_read_b64_tr_b16 v[132:133], v196 offset:52224
ds_read_b64_tr_b16 v[134:135], v196 offset:56576
ds_read_b64_tr_b16 v[136:137], v196 offset:52288
ds_read_b64_tr_b16 v[138:139], v196 offset:56640
ds_read_b64_tr_b16 v[140:141], v196 offset:52352
ds_read_b64_tr_b16 v[142:143], v196 offset:56704
ds_read_b64_tr_b16 v[144:145], v196 offset:52416
ds_read_b64_tr_b16 v[146:147], v196 offset:56768
s_waitcnt lgkmcnt(15)
v_mfma_f32_32x32x16_bf16 v[12:27], v[84:87], v[148:151], v[12:27]
v_mfma_f32_32x32x16_bf16 v[28:43], v[88:91], v[148:151], v[28:43]
s_add_u32 s6, s13, 2621440
buffer_load_dwordx4 a[192:195], v2, s[52:55], s6 offen nt
v_mfma_f32_32x32x16_bf16 v[44:59], v[92:95], v[148:151], v[44:59]
v_mfma_f32_32x32x16_bf16 v[60:75], v[96:99], v[148:151], v[60:75]
s_add_u32 s6, s13, 2622464
buffer_load_dwordx4 a[196:199], v2, s[52:55], s6 offen nt
s_waitcnt lgkmcnt(15)
v_mfma_f32_32x32x16_bf16 v[12:27], v[100:103], v[152:155], v[12:27]
v_mfma_f32_32x32x16_bf16 v[28:43], v[104:107], v[152:155], v[28:43]
s_add_u32 s6, s13, 2623488
buffer_load_dwordx4 a[200:203], v2, s[52:55], s6 offen nt
v_mfma_f32_32x32x16_bf16 v[44:59], v[108:111], v[152:155], v[44:59]
v_mfma_f32_32x32x16_bf16 v[60:75], v[112:115], v[152:155], v[60:75]
s_add_u32 s6, s13, 2624512
buffer_load_dwordx4 a[204:207], v2, s[52:55], s6 offen nt
s_waitcnt lgkmcnt(8)
v_mfma_f32_32x32x16_bf16 v[12:27], v[116:119], v[156:159], v[12:27]
v_mfma_f32_32x32x16_bf16 v[28:43], v[120:123], v[156:159], v[28:43]
s_add_u32 s6, s13, 2752512
buffer_load_dwordx4 a[208:211], v2, s[52:55], s6 offen nt
v_mfma_f32_32x32x16_bf16 v[44:59], v[124:127], v[156:159], v[44:59]
v_mfma_f32_32x32x16_bf16 v[60:75], v[128:131], v[156:159], v[60:75]
s_add_u32 s6, s13, 2753536
buffer_load_dwordx4 a[212:215], v2, s[52:55], s6 offen nt
s_waitcnt lgkmcnt(0)
v_mfma_f32_32x32x16_bf16 v[12:27], v[132:135], v[160:163], v[12:27]
v_mfma_f32_32x32x16_bf16 v[28:43], v[136:139], v[160:163], v[28:43]
s_add_u32 s6, s13, 2754560
buffer_load_dwordx4 a[216:219], v2, s[52:55], s6 offen nt
v_mfma_f32_32x32x16_bf16 v[44:59], v[140:143], v[160:163], v[44:59]
v_mfma_f32_32x32x16_bf16 v[60:75], v[144:147], v[160:163], v[60:75]
s_add_u32 s6, s13, 2755584
buffer_load_dwordx4 a[220:223], v2, s[52:55], s6 offen nt
ds_read_b128 v[84:87], v195 offset:0
ds_read_b128 v[88:91], v195 offset:64
ds_read_b128 v[92:95], v195 offset:128
ds_read_b128 v[96:99], v195 offset:192
ds_read_b128 v[100:103], v195 offset:256
ds_read_b128 v[104:107], v195 offset:320
ds_read_b128 v[108:111], v195 offset:384
ds_read_b128 v[112:115], v195 offset:448
ds_read_b128 v[116:119], v195 offset:512
ds_read_b128 v[120:123], v195 offset:576
ds_read_b128 v[124:127], v195 offset:640
ds_read_b128 v[128:131], v195 offset:704
ds_read_b128 v[132:135], v195 offset:768
ds_read_b128 v[136:139], v195 offset:832
ds_read_b128 v[140:143], v195 offset:896
ds_read_b128 v[144:147], v195 offset:960
s_waitcnt lgkmcnt(15)
v_mfma_f32_16x16x32_bf16 v[76:79], v[84:87], a[0:3], 0
v_mfma_f32_16x16x32_bf16 v[80:83], v[84:87], a[64:67], 0
s_waitcnt lgkmcnt(14)
v_mfma_f32_16x16x32_bf16 v[76:79], v[88:91], a[4:7], v[76:79]
v_mfma_f32_16x16x32_bf16 v[80:83], v[88:91], a[68:71], v[80:83]
s_add_u32 s6, s13, 2883584
buffer_load_dwordx4 a[224:227], v10, s[52:55], s6 offen nt
s_waitcnt lgkmcnt(13)
v_mfma_f32_16x16x32_bf16 v[76:79], v[92:95], a[8:11], v[76:79]
v_mfma_f32_16x16x32_bf16 v[80:83], v[92:95], a[72:75], v[80:83]
s_waitcnt lgkmcnt(12)
v_mfma_f32_16x16x32_bf16 v[76:79], v[96:99], a[12:15], v[76:79]
v_mfma_f32_16x16x32_bf16 v[80:83], v[96:99], a[76:79], v[80:83]
s_add_u32 s6, s13, 2884608
buffer_load_dwordx4 a[228:231], v10, s[52:55], s6 offen nt
s_waitcnt lgkmcnt(11)
v_mfma_f32_16x16x32_bf16 v[76:79], v[100:103], a[16:19], v[76:79]
v_mfma_f32_16x16x32_bf16 v[80:83], v[100:103], a[80:83], v[80:83]
s_waitcnt lgkmcnt(10)
v_mfma_f32_16x16x32_bf16 v[76:79], v[104:107], a[20:23], v[76:79]
v_mfma_f32_16x16x32_bf16 v[80:83], v[104:107], a[84:87], v[80:83]
s_add_u32 s6, s13, 2885632
buffer_load_dwordx4 a[232:235], v10, s[52:55], s6 offen nt
s_waitcnt lgkmcnt(9)
v_mfma_f32_16x16x32_bf16 v[76:79], v[108:111], a[24:27], v[76:79]
v_mfma_f32_16x16x32_bf16 v[80:83], v[108:111], a[88:91], v[80:83]
s_waitcnt lgkmcnt(8)
v_mfma_f32_16x16x32_bf16 v[76:79], v[112:115], a[28:31], v[76:79]
v_mfma_f32_16x16x32_bf16 v[80:83], v[112:115], a[92:95], v[80:83]
s_add_u32 s6, s13, 2886656
buffer_load_dwordx4 a[236:239], v10, s[52:55], s6 offen nt
s_waitcnt lgkmcnt(7)
v_mfma_f32_16x16x32_bf16 v[76:79], v[116:119], a[32:35], v[76:79]
v_mfma_f32_16x16x32_bf16 v[80:83], v[116:119], a[96:99], v[80:83]
s_waitcnt lgkmcnt(6)
v_mfma_f32_16x16x32_bf16 v[76:79], v[120:123], a[36:39], v[76:79]
v_mfma_f32_16x16x32_bf16 v[80:83], v[120:123], a[100:103], v[80:83]
s_add_u32 s6, s13, 3014656
buffer_load_dwordx4 a[240:243], v10, s[52:55], s6 offen nt
s_waitcnt lgkmcnt(5)
v_mfma_f32_16x16x32_bf16 v[76:79], v[124:127], a[40:43], v[76:79]
v_mfma_f32_16x16x32_bf16 v[80:83], v[124:127], a[104:107], v[80:83]
s_waitcnt lgkmcnt(4)
v_mfma_f32_16x16x32_bf16 v[76:79], v[128:131], a[44:47], v[76:79]
v_mfma_f32_16x16x32_bf16 v[80:83], v[128:131], a[108:111], v[80:83]
s_add_u32 s6, s13, 3015680
buffer_load_dwordx4 a[244:247], v10, s[52:55], s6 offen nt
s_waitcnt lgkmcnt(3)
v_mfma_f32_16x16x32_bf16 v[76:79], v[132:135], a[48:51], v[76:79]
v_mfma_f32_16x16x32_bf16 v[80:83], v[132:135], a[112:115], v[80:83]
s_waitcnt lgkmcnt(2)
v_mfma_f32_16x16x32_bf16 v[76:79], v[136:139], a[52:55], v[76:79]
v_mfma_f32_16x16x32_bf16 v[80:83], v[136:139], a[116:119], v[80:83]
s_add_u32 s6, s13, 3016704
buffer_load_dwordx4 a[248:251], v10, s[52:55], s6 offen nt
s_waitcnt lgkmcnt(1)
v_mfma_f32_16x16x32_bf16 v[76:79], v[140:143], a[56:59], v[76:79]
v_mfma_f32_16x16x32_bf16 v[80:83], v[140:143], a[120:123], v[80:83]
s_waitcnt lgkmcnt(0)
v_mfma_f32_16x16x32_bf16 v[76:79], v[144:147], a[60:63], v[76:79]
v_mfma_f32_16x16x32_bf16 v[80:83], v[144:147], a[124:127], v[80:83]
s_add_u32 s6, s13, 3017728
buffer_load_dwordx4 a[252:255], v10, s[52:55], s6 offen nt
s_nop 4
v_max_f32 v190, v76, v77
v_max3_f32 v190, v190, v78, v79
v_mov_b32 v192, v190
s_nop 1
v_permlane16_swap_b32 v190, v192
v_max_f32 v190, v190, v192
v_mov_b32 v192, v190
s_nop 1
v_permlane32_swap_b32 v190, v192
v_max_f32 v190, v190, v192
ds_write_b32 v198, v190 offset:0
v_max_f32 v191, v80, v81
v_max3_f32 v191, v191, v82, v83
v_mov_b32 v192, v191
s_nop 1
v_permlane16_swap_b32 v191, v192
v_max_f32 v191, v191, v192
v_mov_b32 v192, v191
s_nop 1
v_permlane32_swap_b32 v191, v192
v_max_f32 v191, v191, v192
ds_write_b32 v198, v191 offset:256
s_waitcnt lgkmcnt(0)
s_barrier
ds_read_b128 v[164:167], v199
ds_read_b128 v[168:171], v199 offset:256
ds_read_b128 v[172:175], v200
s_waitcnt vmcnt(16)
ds_write_b128 v206, a[128:131] offset:0
ds_write_b128 v206, a[132:135] offset:1088
ds_write_b128 v206, a[136:139] offset:2176
ds_write_b128 v206, a[140:143] offset:3264
ds_write_b128 v206, a[144:147] offset:4352
ds_write_b128 v206, a[148:151] offset:5440
ds_write_b128 v206, a[152:155] offset:6528
ds_write_b128 v206, a[156:159] offset:7616
ds_write_b128 v206, a[160:163] offset:8704
ds_write_b128 v206, a[164:167] offset:9792
ds_write_b128 v206, a[168:171] offset:10880
ds_write_b128 v206, a[172:175] offset:11968
ds_write_b128 v206, a[176:179] offset:13056
ds_write_b128 v206, a[180:183] offset:14144
ds_write_b128 v206, a[184:187] offset:15232
ds_write_b128 v206, a[188:191] offset:16320
s_waitcnt lgkmcnt(15)
v_max_f32 v164, v164, v165
v_max3_f32 v164, v164, v166, v167
v_mul_f32 v164, v164, v185
v_max_f32 v164, v164, v176
v_sub_f32 v182, v176, v164
v_exp_f32 v182, v182
v_mov_b32 v176, v164
v_max_f32 v168, v168, v169
v_max3_f32 v168, v168, v170, v171
v_mul_f32 v168, v168, v185
v_max_f32 v168, v168, v177
v_sub_f32 v183, v177, v168
v_exp_f32 v183, v183
v_mov_b32 v177, v168
v_max_f32 v172, v172, v173
v_max3_f32 v172, v172, v174, v175
v_mul_f32 v172, v172, v185
v_max_f32 v172, v172, v178
v_sub_f32 v184, v178, v172
v_exp_f32 v184, v184
v_mov_b32 v178, v172
v_fma_f32 v76, v76, v185, -v176
v_fma_f32 v77, v77, v185, -v176
v_fma_f32 v78, v78, v185, -v176
v_fma_f32 v79, v79, v185, -v176
v_exp_f32 v76, v76
v_exp_f32 v77, v77
v_exp_f32 v78, v78
v_exp_f32 v79, v79
v_mul_f32 v180, v180, v182
v_cvt_pk_bf16_f32 v186, v76, v77
v_cvt_pk_bf16_f32 v187, v78, v79
ds_write_b64 v201, v[186:187] offset:0
v_add_f32 v180, v180, v76
v_add_f32 v180, v180, v77
v_add_f32 v180, v180, v78
v_add_f32 v180, v180, v79
v_fma_f32 v80, v80, v185, -v177
v_fma_f32 v81, v81, v185, -v177
v_fma_f32 v82, v82, v185, -v177
v_fma_f32 v83, v83, v185, -v177
v_exp_f32 v80, v80
v_exp_f32 v81, v81
v_exp_f32 v82, v82
v_exp_f32 v83, v83
v_mul_f32 v181, v181, v183
v_cvt_pk_bf16_f32 v188, v80, v81
v_cvt_pk_bf16_f32 v189, v82, v83
ds_write_b64 v201, v[188:189] offset:512
v_add_f32 v181, v181, v80
v_add_f32 v181, v181, v81
v_add_f32 v181, v181, v82
v_add_f32 v181, v181, v83
v_mul_f32 v12, v12, v184
v_mul_f32 v13, v13, v184
v_mul_f32 v14, v14, v184
v_mul_f32 v15, v15, v184
v_mul_f32 v16, v16, v184
v_mul_f32 v17, v17, v184
v_mul_f32 v18, v18, v184
v_mul_f32 v19, v19, v184
v_mul_f32 v20, v20, v184
v_mul_f32 v21, v21, v184
v_mul_f32 v22, v22, v184
v_mul_f32 v23, v23, v184
v_mul_f32 v24, v24, v184
v_mul_f32 v25, v25, v184
v_mul_f32 v26, v26, v184
v_mul_f32 v27, v27, v184
v_mul_f32 v28, v28, v184
v_mul_f32 v29, v29, v184
v_mul_f32 v30, v30, v184
v_mul_f32 v31, v31, v184
v_mul_f32 v32, v32, v184
v_mul_f32 v33, v33, v184
v_mul_f32 v34, v34, v184
v_mul_f32 v35, v35, v184
v_mul_f32 v36, v36, v184
v_mul_f32 v37, v37, v184
v_mul_f32 v38, v38, v184
v_mul_f32 v39, v39, v184
v_mul_f32 v40, v40, v184
v_mul_f32 v41, v41, v184
v_mul_f32 v42, v42, v184
v_mul_f32 v43, v43, v184
v_mul_f32 v44, v44, v184
v_mul_f32 v45, v45, v184
v_mul_f32 v46, v46, v184
v_mul_f32 v47, v47, v184
v_mul_f32 v48, v48, v184
v_mul_f32 v49, v49, v184
v_mul_f32 v50, v50, v184
v_mul_f32 v51, v51, v184
v_mul_f32 v52, v52, v184
v_mul_f32 v53, v53, v184
v_mul_f32 v54, v54, v184
v_mul_f32 v55, v55, v184
v_mul_f32 v56, v56, v184
v_mul_f32 v57, v57, v184
v_mul_f32 v58, v58, v184
v_mul_f32 v59, v59, v184
v_mul_f32 v60, v60, v184
v_mul_f32 v61, v61, v184
v_mul_f32 v62, v62, v184
v_mul_f32 v63, v63, v184
v_mul_f32 v64, v64, v184
v_mul_f32 v65, v65, v184
v_mul_f32 v66, v66, v184
v_mul_f32 v67, v67, v184
v_mul_f32 v68, v68, v184
v_mul_f32 v69, v69, v184
v_mul_f32 v70, v70, v184
v_mul_f32 v71, v71, v184
v_mul_f32 v72, v72, v184
v_mul_f32 v73, v73, v184
v_mul_f32 v74, v74, v184
v_mul_f32 v75, v75, v184
s_waitcnt lgkmcnt(0)
s_barrier
ds_read_b128 v[148:151], v202 offset:0
ds_read_b128 v[152:155], v202 offset:1024
ds_read_b128 v[156:159], v202 offset:2048
ds_read_b128 v[160:163], v202 offset:3072
ds_read_b64_tr_b16 v[84:85], v197 offset:0
ds_read_b64_tr_b16 v[86:87], v197 offset:4352
ds_read_b64_tr_b16 v[88:89], v197 offset:64
ds_read_b64_tr_b16 v[90:91], v197 offset:4416
ds_read_b64_tr_b16 v[92:93], v197 offset:128
ds_read_b64_tr_b16 v[94:95], v197 offset:4480
ds_read_b64_tr_b16 v[96:97], v197 offset:192
ds_read_b64_tr_b16 v[98:99], v197 offset:4544
ds_read_b64_tr_b16 v[100:101], v197 offset:17408
ds_read_b64_tr_b16 v[102:103], v197 offset:21760
ds_read_b64_tr_b16 v[104:105], v197 offset:17472
ds_read_b64_tr_b16 v[106:107], v197 offset:21824
ds_read_b64_tr_b16 v[108:109], v197 offset:17536
ds_read_b64_tr_b16 v[110:111], v197 offset:21888
ds_read_b64_tr_b16 v[112:113], v197 offset:17600
ds_read_b64_tr_b16 v[114:115], v197 offset:21952
ds_read_b64_tr_b16 v[116:117], v197 offset:34816
ds_read_b64_tr_b16 v[118:119], v197 offset:39168
ds_read_b64_tr_b16 v[120:121], v197 offset:34880
ds_read_b64_tr_b16 v[122:123], v197 offset:39232
ds_read_b64_tr_b16 v[124:125], v197 offset:34944
ds_read_b64_tr_b16 v[126:127], v197 offset:39296
ds_read_b64_tr_b16 v[128:129], v197 offset:35008
ds_read_b64_tr_b16 v[130:131], v197 offset:39360
ds_read_b64_tr_b16 v[132:133], v197 offset:52224
ds_read_b64_tr_b16 v[134:135], v197 offset:56576
ds_read_b64_tr_b16 v[136:137], v197 offset:52288
ds_read_b64_tr_b16 v[138:139], v197 offset:56640
ds_read_b64_tr_b16 v[140:141], v197 offset:52352
ds_read_b64_tr_b16 v[142:143], v197 offset:56704
ds_read_b64_tr_b16 v[144:145], v197 offset:52416
ds_read_b64_tr_b16 v[146:147], v197 offset:56768
s_waitcnt lgkmcnt(15)
v_mfma_f32_32x32x16_bf16 v[12:27], v[84:87], v[148:151], v[12:27]
v_mfma_f32_32x32x16_bf16 v[28:43], v[88:91], v[148:151], v[28:43]
s_add_u32 s6, s13, 3145728
buffer_load_dwordx4 a[128:131], v2, s[52:55], s6 offen nt
v_mfma_f32_32x32x16_bf16 v[44:59], v[92:95], v[148:151], v[44:59]
v_mfma_f32_32x32x16_bf16 v[60:75], v[96:99], v[148:151], v[60:75]
s_add_u32 s6, s13, 3146752
buffer_load_dwordx4 a[132:135], v2, s[52:55], s6 offen nt
s_waitcnt lgkmcnt(15)
v_mfma_f32_32x32x16_bf16 v[12:27], v[100:103], v[152:155], v[12:27]
v_mfma_f32_32x32x16_bf16 v[28:43], v[104:107], v[152:155], v[28:43]
s_add_u32 s6, s13, 3147776
buffer_load_dwordx4 a[136:139], v2, s[52:55], s6 offen nt
v_mfma_f32_32x32x16_bf16 v[44:59], v[108:111], v[152:155], v[44:59]
v_mfma_f32_32x32x16_bf16 v[60:75], v[112:115], v[152:155], v[60:75]
s_add_u32 s6, s13, 3148800
buffer_load_dwordx4 a[140:143], v2, s[52:55], s6 offen nt
s_waitcnt lgkmcnt(8)
v_mfma_f32_32x32x16_bf16 v[12:27], v[116:119], v[156:159], v[12:27]
v_mfma_f32_32x32x16_bf16 v[28:43], v[120:123], v[156:159], v[28:43]
s_add_u32 s6, s13, 3276800
buffer_load_dwordx4 a[144:147], v2, s[52:55], s6 offen nt
v_mfma_f32_32x32x16_bf16 v[44:59], v[124:127], v[156:159], v[44:59]
v_mfma_f32_32x32x16_bf16 v[60:75], v[128:131], v[156:159], v[60:75]
s_add_u32 s6, s13, 3277824
buffer_load_dwordx4 a[148:151], v2, s[52:55], s6 offen nt
s_waitcnt lgkmcnt(0)
v_mfma_f32_32x32x16_bf16 v[12:27], v[132:135], v[160:163], v[12:27]
v_mfma_f32_32x32x16_bf16 v[28:43], v[136:139], v[160:163], v[28:43]
s_add_u32 s6, s13, 3278848
buffer_load_dwordx4 a[152:155], v2, s[52:55], s6 offen nt
v_mfma_f32_32x32x16_bf16 v[44:59], v[140:143], v[160:163], v[44:59]
v_mfma_f32_32x32x16_bf16 v[60:75], v[144:147], v[160:163], v[60:75]
s_add_u32 s6, s13, 3279872
buffer_load_dwordx4 a[156:159], v2, s[52:55], s6 offen nt
ds_read_b128 v[84:87], v194 offset:0
ds_read_b128 v[88:91], v194 offset:64
ds_read_b128 v[92:95], v194 offset:128
ds_read_b128 v[96:99], v194 offset:192
ds_read_b128 v[100:103], v194 offset:256
ds_read_b128 v[104:107], v194 offset:320
ds_read_b128 v[108:111], v194 offset:384
ds_read_b128 v[112:115], v194 offset:448
ds_read_b128 v[116:119], v194 offset:512
ds_read_b128 v[120:123], v194 offset:576
ds_read_b128 v[124:127], v194 offset:640
ds_read_b128 v[128:131], v194 offset:704
ds_read_b128 v[132:135], v194 offset:768
ds_read_b128 v[136:139], v194 offset:832
ds_read_b128 v[140:143], v194 offset:896
ds_read_b128 v[144:147], v194 offset:960
s_waitcnt lgkmcnt(15)
v_mfma_f32_16x16x32_bf16 v[76:79], v[84:87], a[0:3], 0
v_mfma_f32_16x16x32_bf16 v[80:83], v[84:87], a[64:67], 0
s_waitcnt lgkmcnt(14)
v_mfma_f32_16x16x32_bf16 v[76:79], v[88:91], a[4:7], v[76:79]
v_mfma_f32_16x16x32_bf16 v[80:83], v[88:91], a[68:71], v[80:83]
s_add_u32 s6, s13, 3407872
buffer_load_dwordx4 a[160:163], v10, s[52:55], s6 offen nt
s_waitcnt lgkmcnt(13)
v_mfma_f32_16x16x32_bf16 v[76:79], v[92:95], a[8:11], v[76:79]
v_mfma_f32_16x16x32_bf16 v[80:83], v[92:95], a[72:75], v[80:83]
s_waitcnt lgkmcnt(12)
v_mfma_f32_16x16x32_bf16 v[76:79], v[96:99], a[12:15], v[76:79]
v_mfma_f32_16x16x32_bf16 v[80:83], v[96:99], a[76:79], v[80:83]
s_add_u32 s6, s13, 3408896
buffer_load_dwordx4 a[164:167], v10, s[52:55], s6 offen nt
s_waitcnt lgkmcnt(11)
v_mfma_f32_16x16x32_bf16 v[76:79], v[100:103], a[16:19], v[76:79]
v_mfma_f32_16x16x32_bf16 v[80:83], v[100:103], a[80:83], v[80:83]
s_waitcnt lgkmcnt(10)
v_mfma_f32_16x16x32_bf16 v[76:79], v[104:107], a[20:23], v[76:79]
v_mfma_f32_16x16x32_bf16 v[80:83], v[104:107], a[84:87], v[80:83]
s_add_u32 s6, s13, 3409920
buffer_load_dwordx4 a[168:171], v10, s[52:55], s6 offen nt
s_waitcnt lgkmcnt(9)
v_mfma_f32_16x16x32_bf16 v[76:79], v[108:111], a[24:27], v[76:79]
v_mfma_f32_16x16x32_bf16 v[80:83], v[108:111], a[88:91], v[80:83]
s_waitcnt lgkmcnt(8)
v_mfma_f32_16x16x32_bf16 v[76:79], v[112:115], a[28:31], v[76:79]
v_mfma_f32_16x16x32_bf16 v[80:83], v[112:115], a[92:95], v[80:83]
s_add_u32 s6, s13, 3410944
buffer_load_dwordx4 a[172:175], v10, s[52:55], s6 offen nt
s_waitcnt lgkmcnt(7)
v_mfma_f32_16x16x32_bf16 v[76:79], v[116:119], a[32:35], v[76:79]
v_mfma_f32_16x16x32_bf16 v[80:83], v[116:119], a[96:99], v[80:83]
s_waitcnt lgkmcnt(6)
v_mfma_f32_16x16x32_bf16 v[76:79], v[120:123], a[36:39], v[76:79]
v_mfma_f32_16x16x32_bf16 v[80:83], v[120:123], a[100:103], v[80:83]
s_add_u32 s6, s13, 3538944
buffer_load_dwordx4 a[176:179], v10, s[52:55], s6 offen nt
s_waitcnt lgkmcnt(5)
v_mfma_f32_16x16x32_bf16 v[76:79], v[124:127], a[40:43], v[76:79]
v_mfma_f32_16x16x32_bf16 v[80:83], v[124:127], a[104:107], v[80:83]
s_waitcnt lgkmcnt(4)
v_mfma_f32_16x16x32_bf16 v[76:79], v[128:131], a[44:47], v[76:79]
v_mfma_f32_16x16x32_bf16 v[80:83], v[128:131], a[108:111], v[80:83]
s_add_u32 s6, s13, 3539968
buffer_load_dwordx4 a[180:183], v10, s[52:55], s6 offen nt
s_waitcnt lgkmcnt(3)
v_mfma_f32_16x16x32_bf16 v[76:79], v[132:135], a[48:51], v[76:79]
v_mfma_f32_16x16x32_bf16 v[80:83], v[132:135], a[112:115], v[80:83]
s_waitcnt lgkmcnt(2)
v_mfma_f32_16x16x32_bf16 v[76:79], v[136:139], a[52:55], v[76:79]
v_mfma_f32_16x16x32_bf16 v[80:83], v[136:139], a[116:119], v[80:83]
s_add_u32 s6, s13, 3540992
buffer_load_dwordx4 a[184:187], v10, s[52:55], s6 offen nt
s_waitcnt lgkmcnt(1)
v_mfma_f32_16x16x32_bf16 v[76:79], v[140:143], a[56:59], v[76:79]
v_mfma_f32_16x16x32_bf16 v[80:83], v[140:143], a[120:123], v[80:83]
s_waitcnt lgkmcnt(0)
v_mfma_f32_16x16x32_bf16 v[76:79], v[144:147], a[60:63], v[76:79]
v_mfma_f32_16x16x32_bf16 v[80:83], v[144:147], a[124:127], v[80:83]
s_add_u32 s6, s13, 3542016
buffer_load_dwordx4 a[188:191], v10, s[52:55], s6 offen nt
s_nop 4
v_max_f32 v190, v76, v77
v_max3_f32 v190, v190, v78, v79
v_mov_b32 v192, v190
s_nop 1
v_permlane16_swap_b32 v190, v192
v_max_f32 v190, v190, v192
v_mov_b32 v192, v190
s_nop 1
v_permlane32_swap_b32 v190, v192
v_max_f32 v190, v190, v192
ds_write_b32 v198, v190 offset:0
v_max_f32 v191, v80, v81
v_max3_f32 v191, v191, v82, v83
v_mov_b32 v192, v191
s_nop 1
v_permlane16_swap_b32 v191, v192
v_max_f32 v191, v191, v192
v_mov_b32 v192, v191
s_nop 1
v_permlane32_swap_b32 v191, v192
v_max_f32 v191, v191, v192
ds_write_b32 v198, v191 offset:256
s_waitcnt lgkmcnt(0)
s_barrier
ds_read_b128 v[164:167], v199
ds_read_b128 v[168:171], v199 offset:256
ds_read_b128 v[172:175], v200
s_waitcnt vmcnt(16)
ds_write_b128 v207, a[192:195] offset:0
ds_write_b128 v207, a[196:199] offset:1088
ds_write_b128 v207, a[200:203] offset:2176
ds_write_b128 v207, a[204:207] offset:3264
ds_write_b128 v207, a[208:211] offset:4352
ds_write_b128 v207, a[212:215] offset:5440
ds_write_b128 v207, a[216:219] offset:6528
ds_write_b128 v207, a[220:223] offset:7616
ds_write_b128 v207, a[224:227] offset:8704
ds_write_b128 v207, a[228:231] offset:9792
ds_write_b128 v207, a[232:235] offset:10880
ds_write_b128 v207, a[236:239] offset:11968
ds_write_b128 v207, a[240:243] offset:13056
ds_write_b128 v207, a[244:247] offset:14144
ds_write_b128 v207, a[248:251] offset:15232
ds_write_b128 v207, a[252:255] offset:16320
s_waitcnt lgkmcnt(15)
v_max_f32 v164, v164, v165
v_max3_f32 v164, v164, v166, v167
v_mul_f32 v164, v164, v185
v_max_f32 v164, v164, v176
v_sub_f32 v182, v176, v164
v_exp_f32 v182, v182
v_mov_b32 v176, v164
v_max_f32 v168, v168, v169
v_max3_f32 v168, v168, v170, v171
v_mul_f32 v168, v168, v185
v_max_f32 v168, v168, v177
v_sub_f32 v183, v177, v168
v_exp_f32 v183, v183
v_mov_b32 v177, v168
v_max_f32 v172, v172, v173
v_max3_f32 v172, v172, v174, v175
v_mul_f32 v172, v172, v185
v_max_f32 v172, v172, v178
v_sub_f32 v184, v178, v172
v_exp_f32 v184, v184
v_mov_b32 v178, v172
v_fma_f32 v76, v76, v185, -v176
v_fma_f32 v77, v77, v185, -v176
v_fma_f32 v78, v78, v185, -v176
v_fma_f32 v79, v79, v185, -v176
v_exp_f32 v76, v76
v_exp_f32 v77, v77
v_exp_f32 v78, v78
v_exp_f32 v79, v79
v_mul_f32 v180, v180, v182
v_cvt_pk_bf16_f32 v186, v76, v77
v_cvt_pk_bf16_f32 v187, v78, v79
ds_write_b64 v201, v[186:187] offset:0
v_add_f32 v180, v180, v76
v_add_f32 v180, v180, v77
v_add_f32 v180, v180, v78
v_add_f32 v180, v180, v79
v_fma_f32 v80, v80, v185, -v177
v_fma_f32 v81, v81, v185, -v177
v_fma_f32 v82, v82, v185, -v177
v_fma_f32 v83, v83, v185, -v177
v_exp_f32 v80, v80
v_exp_f32 v81, v81
v_exp_f32 v82, v82
v_exp_f32 v83, v83
v_mul_f32 v181, v181, v183
v_cvt_pk_bf16_f32 v188, v80, v81
v_cvt_pk_bf16_f32 v189, v82, v83
ds_write_b64 v201, v[188:189] offset:512
v_add_f32 v181, v181, v80
v_add_f32 v181, v181, v81
v_add_f32 v181, v181, v82
v_add_f32 v181, v181, v83
v_mul_f32 v12, v12, v184
v_mul_f32 v13, v13, v184
v_mul_f32 v14, v14, v184
v_mul_f32 v15, v15, v184
v_mul_f32 v16, v16, v184
v_mul_f32 v17, v17, v184
v_mul_f32 v18, v18, v184
v_mul_f32 v19, v19, v184
v_mul_f32 v20, v20, v184
v_mul_f32 v21, v21, v184
v_mul_f32 v22, v22, v184
v_mul_f32 v23, v23, v184
v_mul_f32 v24, v24, v184
v_mul_f32 v25, v25, v184
v_mul_f32 v26, v26, v184
v_mul_f32 v27, v27, v184
v_mul_f32 v28, v28, v184
v_mul_f32 v29, v29, v184
v_mul_f32 v30, v30, v184
v_mul_f32 v31, v31, v184
v_mul_f32 v32, v32, v184
v_mul_f32 v33, v33, v184
v_mul_f32 v34, v34, v184
v_mul_f32 v35, v35, v184
v_mul_f32 v36, v36, v184
v_mul_f32 v37, v37, v184
v_mul_f32 v38, v38, v184
v_mul_f32 v39, v39, v184
v_mul_f32 v40, v40, v184
v_mul_f32 v41, v41, v184
v_mul_f32 v42, v42, v184
v_mul_f32 v43, v43, v184
v_mul_f32 v44, v44, v184
v_mul_f32 v45, v45, v184
v_mul_f32 v46, v46, v184
v_mul_f32 v47, v47, v184
v_mul_f32 v48, v48, v184
v_mul_f32 v49, v49, v184
v_mul_f32 v50, v50, v184
v_mul_f32 v51, v51, v184
v_mul_f32 v52, v52, v184
v_mul_f32 v53, v53, v184
v_mul_f32 v54, v54, v184
v_mul_f32 v55, v55, v184
v_mul_f32 v56, v56, v184
v_mul_f32 v57, v57, v184
v_mul_f32 v58, v58, v184
v_mul_f32 v59, v59, v184
v_mul_f32 v60, v60, v184
v_mul_f32 v61, v61, v184
v_mul_f32 v62, v62, v184
v_mul_f32 v63, v63, v184
v_mul_f32 v64, v64, v184
v_mul_f32 v65, v65, v184
v_mul_f32 v66, v66, v184
v_mul_f32 v67, v67, v184
v_mul_f32 v68, v68, v184
v_mul_f32 v69, v69, v184
v_mul_f32 v70, v70, v184
v_mul_f32 v71, v71, v184
v_mul_f32 v72, v72, v184
v_mul_f32 v73, v73, v184
v_mul_f32 v74, v74, v184
v_mul_f32 v75, v75, v184
s_waitcnt lgkmcnt(0)
s_barrier
ds_read_b128 v[148:151], v202 offset:0
ds_read_b128 v[152:155], v202 offset:1024
ds_read_b128 v[156:159], v202 offset:2048
ds_read_b128 v[160:163], v202 offset:3072
ds_read_b64_tr_b16 v[84:85], v196 offset:0
ds_read_b64_tr_b16 v[86:87], v196 offset:4352
ds_read_b64_tr_b16 v[88:89], v196 offset:64
ds_read_b64_tr_b16 v[90:91], v196 offset:4416
ds_read_b64_tr_b16 v[92:93], v196 offset:128
ds_read_b64_tr_b16 v[94:95], v196 offset:4480
ds_read_b64_tr_b16 v[96:97], v196 offset:192
ds_read_b64_tr_b16 v[98:99], v196 offset:4544
ds_read_b64_tr_b16 v[100:101], v196 offset:17408
ds_read_b64_tr_b16 v[102:103], v196 offset:21760
ds_read_b64_tr_b16 v[104:105], v196 offset:17472
ds_read_b64_tr_b16 v[106:107], v196 offset:21824
ds_read_b64_tr_b16 v[108:109], v196 offset:17536
ds_read_b64_tr_b16 v[110:111], v196 offset:21888
ds_read_b64_tr_b16 v[112:113], v196 offset:17600
ds_read_b64_tr_b16 v[114:115], v196 offset:21952
ds_read_b64_tr_b16 v[116:117], v196 offset:34816
ds_read_b64_tr_b16 v[118:119], v196 offset:39168
ds_read_b64_tr_b16 v[120:121], v196 offset:34880
ds_read_b64_tr_b16 v[122:123], v196 offset:39232
ds_read_b64_tr_b16 v[124:125], v196 offset:34944
ds_read_b64_tr_b16 v[126:127], v196 offset:39296
ds_read_b64_tr_b16 v[128:129], v196 offset:35008
ds_read_b64_tr_b16 v[130:131], v196 offset:39360
ds_read_b64_tr_b16 v[132:133], v196 offset:52224
ds_read_b64_tr_b16 v[134:135], v196 offset:56576
ds_read_b64_tr_b16 v[136:137], v196 offset:52288
ds_read_b64_tr_b16 v[138:139], v196 offset:56640
ds_read_b64_tr_b16 v[140:141], v196 offset:52352
ds_read_b64_tr_b16 v[142:143], v196 offset:56704
ds_read_b64_tr_b16 v[144:145], v196 offset:52416
ds_read_b64_tr_b16 v[146:147], v196 offset:56768
s_waitcnt lgkmcnt(15)
v_mfma_f32_32x32x16_bf16 v[12:27], v[84:87], v[148:151], v[12:27]
v_mfma_f32_32x32x16_bf16 v[28:43], v[88:91], v[148:151], v[28:43]
s_add_u32 s6, s13, 3670016
buffer_load_dwordx4 a[192:195], v2, s[52:55], s6 offen nt
v_mfma_f32_32x32x16_bf16 v[44:59], v[92:95], v[148:151], v[44:59]
v_mfma_f32_32x32x16_bf16 v[60:75], v[96:99], v[148:151], v[60:75]
s_add_u32 s6, s13, 3671040
buffer_load_dwordx4 a[196:199], v2, s[52:55], s6 offen nt
s_waitcnt lgkmcnt(15)
v_mfma_f32_32x32x16_bf16 v[12:27], v[100:103], v[152:155], v[12:27]
v_mfma_f32_32x32x16_bf16 v[28:43], v[104:107], v[152:155], v[28:43]
s_add_u32 s6, s13, 3672064
buffer_load_dwordx4 a[200:203], v2, s[52:55], s6 offen nt
v_mfma_f32_32x32x16_bf16 v[44:59], v[108:111], v[152:155], v[44:59]
v_mfma_f32_32x32x16_bf16 v[60:75], v[112:115], v[152:155], v[60:75]
s_add_u32 s6, s13, 3673088
buffer_load_dwordx4 a[204:207], v2, s[52:55], s6 offen nt
s_waitcnt lgkmcnt(8)
v_mfma_f32_32x32x16_bf16 v[12:27], v[116:119], v[156:159], v[12:27]
v_mfma_f32_32x32x16_bf16 v[28:43], v[120:123], v[156:159], v[28:43]
s_add_u32 s6, s13, 3801088
buffer_load_dwordx4 a[208:211], v2, s[52:55], s6 offen nt
v_mfma_f32_32x32x16_bf16 v[44:59], v[124:127], v[156:159], v[44:59]
v_mfma_f32_32x32x16_bf16 v[60:75], v[128:131], v[156:159], v[60:75]
s_add_u32 s6, s13, 3802112
buffer_load_dwordx4 a[212:215], v2, s[52:55], s6 offen nt
s_waitcnt lgkmcnt(0)
v_mfma_f32_32x32x16_bf16 v[12:27], v[132:135], v[160:163], v[12:27]
v_mfma_f32_32x32x16_bf16 v[28:43], v[136:139], v[160:163], v[28:43]
s_add_u32 s6, s13, 3803136
buffer_load_dwordx4 a[216:219], v2, s[52:55], s6 offen nt
v_mfma_f32_32x32x16_bf16 v[44:59], v[140:143], v[160:163], v[44:59]
v_mfma_f32_32x32x16_bf16 v[60:75], v[144:147], v[160:163], v[60:75]
s_add_u32 s6, s13, 3804160
buffer_load_dwordx4 a[220:223], v2, s[52:55], s6 offen nt
ds_read_b128 v[84:87], v195 offset:0
ds_read_b128 v[88:91], v195 offset:64
ds_read_b128 v[92:95], v195 offset:128
ds_read_b128 v[96:99], v195 offset:192
ds_read_b128 v[100:103], v195 offset:256
ds_read_b128 v[104:107], v195 offset:320
ds_read_b128 v[108:111], v195 offset:384
ds_read_b128 v[112:115], v195 offset:448
ds_read_b128 v[116:119], v195 offset:512
ds_read_b128 v[120:123], v195 offset:576
ds_read_b128 v[124:127], v195 offset:640
ds_read_b128 v[128:131], v195 offset:704
ds_read_b128 v[132:135], v195 offset:768
ds_read_b128 v[136:139], v195 offset:832
ds_read_b128 v[140:143], v195 offset:896
ds_read_b128 v[144:147], v195 offset:960
s_waitcnt lgkmcnt(15)
v_mfma_f32_16x16x32_bf16 v[76:79], v[84:87], a[0:3], 0
v_mfma_f32_16x16x32_bf16 v[80:83], v[84:87], a[64:67], 0
s_waitcnt lgkmcnt(14)
v_mfma_f32_16x16x32_bf16 v[76:79], v[88:91], a[4:7], v[76:79]
v_mfma_f32_16x16x32_bf16 v[80:83], v[88:91], a[68:71], v[80:83]
s_add_u32 s6, s13, 3932160
buffer_load_dwordx4 a[224:227], v10, s[52:55], s6 offen nt
s_waitcnt lgkmcnt(13)
v_mfma_f32_16x16x32_bf16 v[76:79], v[92:95], a[8:11], v[76:79]
v_mfma_f32_16x16x32_bf16 v[80:83], v[92:95], a[72:75], v[80:83]
s_waitcnt lgkmcnt(12)
v_mfma_f32_16x16x32_bf16 v[76:79], v[96:99], a[12:15], v[76:79]
v_mfma_f32_16x16x32_bf16 v[80:83], v[96:99], a[76:79], v[80:83]
s_add_u32 s6, s13, 3933184
buffer_load_dwordx4 a[228:231], v10, s[52:55], s6 offen nt
s_waitcnt lgkmcnt(11)
v_mfma_f32_16x16x32_bf16 v[76:79], v[100:103], a[16:19], v[76:79]
v_mfma_f32_16x16x32_bf16 v[80:83], v[100:103], a[80:83], v[80:83]
s_waitcnt lgkmcnt(10)
v_mfma_f32_16x16x32_bf16 v[76:79], v[104:107], a[20:23], v[76:79]
v_mfma_f32_16x16x32_bf16 v[80:83], v[104:107], a[84:87], v[80:83]
s_add_u32 s6, s13, 3934208
buffer_load_dwordx4 a[232:235], v10, s[52:55], s6 offen nt
s_waitcnt lgkmcnt(9)
v_mfma_f32_16x16x32_bf16 v[76:79], v[108:111], a[24:27], v[76:79]
v_mfma_f32_16x16x32_bf16 v[80:83], v[108:111], a[88:91], v[80:83]
s_waitcnt lgkmcnt(8)
v_mfma_f32_16x16x32_bf16 v[76:79], v[112:115], a[28:31], v[76:79]
v_mfma_f32_16x16x32_bf16 v[80:83], v[112:115], a[92:95], v[80:83]
s_add_u32 s6, s13, 3935232
buffer_load_dwordx4 a[236:239], v10, s[52:55], s6 offen nt
s_waitcnt lgkmcnt(7)
v_mfma_f32_16x16x32_bf16 v[76:79], v[116:119], a[32:35], v[76:79]
v_mfma_f32_16x16x32_bf16 v[80:83], v[116:119], a[96:99], v[80:83]
s_waitcnt lgkmcnt(6)
v_mfma_f32_16x16x32_bf16 v[76:79], v[120:123], a[36:39], v[76:79]
v_mfma_f32_16x16x32_bf16 v[80:83], v[120:123], a[100:103], v[80:83]
s_add_u32 s6, s13, 4063232
buffer_load_dwordx4 a[240:243], v10, s[52:55], s6 offen nt
s_waitcnt lgkmcnt(5)
v_mfma_f32_16x16x32_bf16 v[76:79], v[124:127], a[40:43], v[76:79]
v_mfma_f32_16x16x32_bf16 v[80:83], v[124:127], a[104:107], v[80:83]
s_waitcnt lgkmcnt(4)
v_mfma_f32_16x16x32_bf16 v[76:79], v[128:131], a[44:47], v[76:79]
v_mfma_f32_16x16x32_bf16 v[80:83], v[128:131], a[108:111], v[80:83]
s_add_u32 s6, s13, 4064256
buffer_load_dwordx4 a[244:247], v10, s[52:55], s6 offen nt
s_waitcnt lgkmcnt(3)
v_mfma_f32_16x16x32_bf16 v[76:79], v[132:135], a[48:51], v[76:79]
v_mfma_f32_16x16x32_bf16 v[80:83], v[132:135], a[112:115], v[80:83]
s_waitcnt lgkmcnt(2)
v_mfma_f32_16x16x32_bf16 v[76:79], v[136:139], a[52:55], v[76:79]
v_mfma_f32_16x16x32_bf16 v[80:83], v[136:139], a[116:119], v[80:83]
s_add_u32 s6, s13, 4065280
buffer_load_dwordx4 a[248:251], v10, s[52:55], s6 offen nt
s_waitcnt lgkmcnt(1)
v_mfma_f32_16x16x32_bf16 v[76:79], v[140:143], a[56:59], v[76:79]
v_mfma_f32_16x16x32_bf16 v[80:83], v[140:143], a[120:123], v[80:83]
s_waitcnt lgkmcnt(0)
v_mfma_f32_16x16x32_bf16 v[76:79], v[144:147], a[60:63], v[76:79]
v_mfma_f32_16x16x32_bf16 v[80:83], v[144:147], a[124:127], v[80:83]
s_add_u32 s6, s13, 4066304
buffer_load_dwordx4 a[252:255], v10, s[52:55], s6 offen nt
s_nop 4
v_max_f32 v190, v76, v77
v_max3_f32 v190, v190, v78, v79
v_mov_b32 v192, v190
s_nop 1
v_permlane16_swap_b32 v190, v192
v_max_f32 v190, v190, v192
v_mov_b32 v192, v190
s_nop 1
v_permlane32_swap_b32 v190, v192
v_max_f32 v190, v190, v192
ds_write_b32 v198, v190 offset:0
v_max_f32 v191, v80, v81
v_max3_f32 v191, v191, v82, v83
v_mov_b32 v192, v191
s_nop 1
v_permlane16_swap_b32 v191, v192
v_max_f32 v191, v191, v192
v_mov_b32 v192, v191
s_nop 1
v_permlane32_swap_b32 v191, v192
v_max_f32 v191, v191, v192
ds_write_b32 v198, v191 offset:256
s_waitcnt lgkmcnt(0)
s_barrier
ds_read_b128 v[164:167], v199
ds_read_b128 v[168:171], v199 offset:256
ds_read_b128 v[172:175], v200
s_waitcnt vmcnt(16)
ds_write_b128 v206, a[128:131] offset:0
ds_write_b128 v206, a[132:135] offset:1088
ds_write_b128 v206, a[136:139] offset:2176
ds_write_b128 v206, a[140:143] offset:3264
ds_write_b128 v206, a[144:147] offset:4352
ds_write_b128 v206, a[148:151] offset:5440
ds_write_b128 v206, a[152:155] offset:6528
ds_write_b128 v206, a[156:159] offset:7616
ds_write_b128 v206, a[160:163] offset:8704
ds_write_b128 v206, a[164:167] offset:9792
ds_write_b128 v206, a[168:171] offset:10880
ds_write_b128 v206, a[172:175] offset:11968
ds_write_b128 v206, a[176:179] offset:13056
ds_write_b128 v206, a[180:183] offset:14144
ds_write_b128 v206, a[184:187] offset:15232
ds_write_b128 v206, a[188:191] offset:16320
s_waitcnt lgkmcnt(15)
v_max_f32 v164, v164, v165
v_max3_f32 v164, v164, v166, v167
v_mul_f32 v164, v164, v185
v_max_f32 v164, v164, v176
v_sub_f32 v182, v176, v164
v_exp_f32 v182, v182
v_mov_b32 v176, v164
v_max_f32 v168, v168, v169
v_max3_f32 v168, v168, v170, v171
v_mul_f32 v168, v168, v185
v_max_f32 v168, v168, v177
v_sub_f32 v183, v177, v168
v_exp_f32 v183, v183
v_mov_b32 v177, v168
v_max_f32 v172, v172, v173
v_max3_f32 v172, v172, v174, v175
v_mul_f32 v172, v172, v185
v_max_f32 v172, v172, v178
v_sub_f32 v184, v178, v172
v_exp_f32 v184, v184
v_mov_b32 v178, v172
v_fma_f32 v76, v76, v185, -v176
v_fma_f32 v77, v77, v185, -v176
v_fma_f32 v78, v78, v185, -v176
v_fma_f32 v79, v79, v185, -v176
v_exp_f32 v76, v76
v_exp_f32 v77, v77
v_exp_f32 v78, v78
v_exp_f32 v79, v79
v_mul_f32 v180, v180, v182
v_cvt_pk_bf16_f32 v186, v76, v77
v_cvt_pk_bf16_f32 v187, v78, v79
ds_write_b64 v201, v[186:187] offset:0
v_add_f32 v180, v180, v76
v_add_f32 v180, v180, v77
v_add_f32 v180, v180, v78
v_add_f32 v180, v180, v79
v_fma_f32 v80, v80, v185, -v177
v_fma_f32 v81, v81, v185, -v177
v_fma_f32 v82, v82, v185, -v177
v_fma_f32 v83, v83, v185, -v177
v_exp_f32 v80, v80
v_exp_f32 v81, v81
v_exp_f32 v82, v82
v_exp_f32 v83, v83
v_mul_f32 v181, v181, v183
v_cvt_pk_bf16_f32 v188, v80, v81
v_cvt_pk_bf16_f32 v189, v82, v83
ds_write_b64 v201, v[188:189] offset:512
v_add_f32 v181, v181, v80
v_add_f32 v181, v181, v81
v_add_f32 v181, v181, v82
v_add_f32 v181, v181, v83
v_mul_f32 v12, v12, v184
v_mul_f32 v13, v13, v184
v_mul_f32 v14, v14, v184
v_mul_f32 v15, v15, v184
v_mul_f32 v16, v16, v184
v_mul_f32 v17, v17, v184
v_mul_f32 v18, v18, v184
v_mul_f32 v19, v19, v184
v_mul_f32 v20, v20, v184
v_mul_f32 v21, v21, v184
v_mul_f32 v22, v22, v184
v_mul_f32 v23, v23, v184
v_mul_f32 v24, v24, v184
v_mul_f32 v25, v25, v184
v_mul_f32 v26, v26, v184
v_mul_f32 v27, v27, v184
v_mul_f32 v28, v28, v184
v_mul_f32 v29, v29, v184
v_mul_f32 v30, v30, v184
v_mul_f32 v31, v31, v184
v_mul_f32 v32, v32, v184
v_mul_f32 v33, v33, v184
v_mul_f32 v34, v34, v184
v_mul_f32 v35, v35, v184
v_mul_f32 v36, v36, v184
v_mul_f32 v37, v37, v184
v_mul_f32 v38, v38, v184
v_mul_f32 v39, v39, v184
v_mul_f32 v40, v40, v184
v_mul_f32 v41, v41, v184
v_mul_f32 v42, v42, v184
v_mul_f32 v43, v43, v184
v_mul_f32 v44, v44, v184
v_mul_f32 v45, v45, v184
v_mul_f32 v46, v46, v184
v_mul_f32 v47, v47, v184
v_mul_f32 v48, v48, v184
v_mul_f32 v49, v49, v184
v_mul_f32 v50, v50, v184
v_mul_f32 v51, v51, v184
v_mul_f32 v52, v52, v184
v_mul_f32 v53, v53, v184
v_mul_f32 v54, v54, v184
v_mul_f32 v55, v55, v184
v_mul_f32 v56, v56, v184
v_mul_f32 v57, v57, v184
v_mul_f32 v58, v58, v184
v_mul_f32 v59, v59, v184
v_mul_f32 v60, v60, v184
v_mul_f32 v61, v61, v184
v_mul_f32 v62, v62, v184
v_mul_f32 v63, v63, v184
v_mul_f32 v64, v64, v184
v_mul_f32 v65, v65, v184
v_mul_f32 v66, v66, v184
v_mul_f32 v67, v67, v184
v_mul_f32 v68, v68, v184
v_mul_f32 v69, v69, v184
v_mul_f32 v70, v70, v184
v_mul_f32 v71, v71, v184
v_mul_f32 v72, v72, v184
v_mul_f32 v73, v73, v184
v_mul_f32 v74, v74, v184
v_mul_f32 v75, v75, v184
s_waitcnt lgkmcnt(0)
s_barrier
ds_read_b128 v[148:151], v202 offset:0
ds_read_b128 v[152:155], v202 offset:1024
ds_read_b128 v[156:159], v202 offset:2048
ds_read_b128 v[160:163], v202 offset:3072
ds_read_b64_tr_b16 v[84:85], v197 offset:0
ds_read_b64_tr_b16 v[86:87], v197 offset:4352
ds_read_b64_tr_b16 v[88:89], v197 offset:64
ds_read_b64_tr_b16 v[90:91], v197 offset:4416
ds_read_b64_tr_b16 v[92:93], v197 offset:128
ds_read_b64_tr_b16 v[94:95], v197 offset:4480
ds_read_b64_tr_b16 v[96:97], v197 offset:192
ds_read_b64_tr_b16 v[98:99], v197 offset:4544
ds_read_b64_tr_b16 v[100:101], v197 offset:17408
ds_read_b64_tr_b16 v[102:103], v197 offset:21760
ds_read_b64_tr_b16 v[104:105], v197 offset:17472
ds_read_b64_tr_b16 v[106:107], v197 offset:21824
ds_read_b64_tr_b16 v[108:109], v197 offset:17536
ds_read_b64_tr_b16 v[110:111], v197 offset:21888
ds_read_b64_tr_b16 v[112:113], v197 offset:17600
ds_read_b64_tr_b16 v[114:115], v197 offset:21952
ds_read_b64_tr_b16 v[116:117], v197 offset:34816
ds_read_b64_tr_b16 v[118:119], v197 offset:39168
ds_read_b64_tr_b16 v[120:121], v197 offset:34880
ds_read_b64_tr_b16 v[122:123], v197 offset:39232
ds_read_b64_tr_b16 v[124:125], v197 offset:34944
ds_read_b64_tr_b16 v[126:127], v197 offset:39296
ds_read_b64_tr_b16 v[128:129], v197 offset:35008
ds_read_b64_tr_b16 v[130:131], v197 offset:39360
ds_read_b64_tr_b16 v[132:133], v197 offset:52224
ds_read_b64_tr_b16 v[134:135], v197 offset:56576
ds_read_b64_tr_b16 v[136:137], v197 offset:52288
ds_read_b64_tr_b16 v[138:139], v197 offset:56640
ds_read_b64_tr_b16 v[140:141], v197 offset:52352
ds_read_b64_tr_b16 v[142:143], v197 offset:56704
ds_read_b64_tr_b16 v[144:145], v197 offset:52416
ds_read_b64_tr_b16 v[146:147], v197 offset:56768
s_waitcnt lgkmcnt(15)
v_mfma_f32_32x32x16_bf16 v[12:27], v[84:87], v[148:151], v[12:27]
v_mfma_f32_32x32x16_bf16 v[28:43], v[88:91], v[148:151], v[28:43]
v_mfma_f32_32x32x16_bf16 v[44:59], v[92:95], v[148:151], v[44:59]
v_mfma_f32_32x32x16_bf16 v[60:75], v[96:99], v[148:151], v[60:75]
s_waitcnt lgkmcnt(15)
v_mfma_f32_32x32x16_bf16 v[12:27], v[100:103], v[152:155], v[12:27]
v_mfma_f32_32x32x16_bf16 v[28:43], v[104:107], v[152:155], v[28:43]
v_mfma_f32_32x32x16_bf16 v[44:59], v[108:111], v[152:155], v[44:59]
v_mfma_f32_32x32x16_bf16 v[60:75], v[112:115], v[152:155], v[60:75]
s_waitcnt lgkmcnt(8)
v_mfma_f32_32x32x16_bf16 v[12:27], v[116:119], v[156:159], v[12:27]
v_mfma_f32_32x32x16_bf16 v[28:43], v[120:123], v[156:159], v[28:43]
v_mfma_f32_32x32x16_bf16 v[44:59], v[124:127], v[156:159], v[44:59]
v_mfma_f32_32x32x16_bf16 v[60:75], v[128:131], v[156:159], v[60:75]
s_waitcnt lgkmcnt(0)
v_mfma_f32_32x32x16_bf16 v[12:27], v[132:135], v[160:163], v[12:27]
v_mfma_f32_32x32x16_bf16 v[28:43], v[136:139], v[160:163], v[28:43]
v_mfma_f32_32x32x16_bf16 v[44:59], v[140:143], v[160:163], v[44:59]
v_mfma_f32_32x32x16_bf16 v[60:75], v[144:147], v[160:163], v[60:75]
ds_read_b128 v[84:87], v194 offset:0
ds_read_b128 v[88:91], v194 offset:64
ds_read_b128 v[92:95], v194 offset:128
ds_read_b128 v[96:99], v194 offset:192
ds_read_b128 v[100:103], v194 offset:256
ds_read_b128 v[104:107], v194 offset:320
ds_read_b128 v[108:111], v194 offset:384
ds_read_b128 v[112:115], v194 offset:448
ds_read_b128 v[116:119], v194 offset:512
ds_read_b128 v[120:123], v194 offset:576
ds_read_b128 v[124:127], v194 offset:640
ds_read_b128 v[128:131], v194 offset:704
ds_read_b128 v[132:135], v194 offset:768
ds_read_b128 v[136:139], v194 offset:832
ds_read_b128 v[140:143], v194 offset:896
ds_read_b128 v[144:147], v194 offset:960
s_waitcnt lgkmcnt(15)
v_mfma_f32_16x16x32_bf16 v[76:79], v[84:87], a[0:3], 0
v_mfma_f32_16x16x32_bf16 v[80:83], v[84:87], a[64:67], 0
s_waitcnt lgkmcnt(14)
v_mfma_f32_16x16x32_bf16 v[76:79], v[88:91], a[4:7], v[76:79]
v_mfma_f32_16x16x32_bf16 v[80:83], v[88:91], a[68:71], v[80:83]
s_waitcnt lgkmcnt(13)
v_mfma_f32_16x16x32_bf16 v[76:79], v[92:95], a[8:11], v[76:79]
v_mfma_f32_16x16x32_bf16 v[80:83], v[92:95], a[72:75], v[80:83]
s_waitcnt lgkmcnt(12)
v_mfma_f32_16x16x32_bf16 v[76:79], v[96:99], a[12:15], v[76:79]
v_mfma_f32_16x16x32_bf16 v[80:83], v[96:99], a[76:79], v[80:83]
s_waitcnt lgkmcnt(11)
v_mfma_f32_16x16x32_bf16 v[76:79], v[100:103], a[16:19], v[76:79]
v_mfma_f32_16x16x32_bf16 v[80:83], v[100:103], a[80:83], v[80:83]
s_waitcnt lgkmcnt(10)
v_mfma_f32_16x16x32_bf16 v[76:79], v[104:107], a[20:23], v[76:79]
v_mfma_f32_16x16x32_bf16 v[80:83], v[104:107], a[84:87], v[80:83]
s_waitcnt lgkmcnt(9)
v_mfma_f32_16x16x32_bf16 v[76:79], v[108:111], a[24:27], v[76:79]
v_mfma_f32_16x16x32_bf16 v[80:83], v[108:111], a[88:91], v[80:83]
s_waitcnt lgkmcnt(8)
v_mfma_f32_16x16x32_bf16 v[76:79], v[112:115], a[28:31], v[76:79]
v_mfma_f32_16x16x32_bf16 v[80:83], v[112:115], a[92:95], v[80:83]
s_waitcnt lgkmcnt(7)
v_mfma_f32_16x16x32_bf16 v[76:79], v[116:119], a[32:35], v[76:79]
v_mfma_f32_16x16x32_bf16 v[80:83], v[116:119], a[96:99], v[80:83]
s_waitcnt lgkmcnt(6)
v_mfma_f32_16x16x32_bf16 v[76:79], v[120:123], a[36:39], v[76:79]
v_mfma_f32_16x16x32_bf16 v[80:83], v[120:123], a[100:103], v[80:83]
s_waitcnt lgkmcnt(5)
v_mfma_f32_16x16x32_bf16 v[76:79], v[124:127], a[40:43], v[76:79]
v_mfma_f32_16x16x32_bf16 v[80:83], v[124:127], a[104:107], v[80:83]
s_waitcnt lgkmcnt(4)
v_mfma_f32_16x16x32_bf16 v[76:79], v[128:131], a[44:47], v[76:79]
v_mfma_f32_16x16x32_bf16 v[80:83], v[128:131], a[108:111], v[80:83]
s_waitcnt lgkmcnt(3)
v_mfma_f32_16x16x32_bf16 v[76:79], v[132:135], a[48:51], v[76:79]
v_mfma_f32_16x16x32_bf16 v[80:83], v[132:135], a[112:115], v[80:83]
s_waitcnt lgkmcnt(2)
v_mfma_f32_16x16x32_bf16 v[76:79], v[136:139], a[52:55], v[76:79]
v_mfma_f32_16x16x32_bf16 v[80:83], v[136:139], a[116:119], v[80:83]
s_waitcnt lgkmcnt(1)
v_mfma_f32_16x16x32_bf16 v[76:79], v[140:143], a[56:59], v[76:79]
v_mfma_f32_16x16x32_bf16 v[80:83], v[140:143], a[120:123], v[80:83]
s_waitcnt lgkmcnt(0)
v_mfma_f32_16x16x32_bf16 v[76:79], v[144:147], a[60:63], v[76:79]
v_mfma_f32_16x16x32_bf16 v[80:83], v[144:147], a[124:127], v[80:83]
s_nop 6
v_max_f32 v190, v76, v77
v_max3_f32 v190, v190, v78, v79
v_mov_b32 v192, v190
s_nop 1
v_permlane16_swap_b32 v190, v192
v_max_f32 v190, v190, v192
v_mov_b32 v192, v190
s_nop 1
v_permlane32_swap_b32 v190, v192
v_max_f32 v190, v190, v192
ds_write_b32 v198, v190 offset:0
v_max_f32 v191, v80, v81
v_max3_f32 v191, v191, v82, v83
v_mov_b32 v192, v191
s_nop 1
v_permlane16_swap_b32 v191, v192
v_max_f32 v191, v191, v192
v_mov_b32 v192, v191
s_nop 1
v_permlane32_swap_b32 v191, v192
v_max_f32 v191, v191, v192
ds_write_b32 v198, v191 offset:256
s_waitcnt lgkmcnt(0)
s_barrier
ds_read_b128 v[164:167], v199
ds_read_b128 v[168:171], v199 offset:256
ds_read_b128 v[172:175], v200
s_waitcnt vmcnt(0)
ds_write_b128 v207, a[192:195] offset:0
ds_write_b128 v207, a[196:199] offset:1088
ds_write_b128 v207, a[200:203] offset:2176
ds_write_b128 v207, a[204:207] offset:3264
ds_write_b128 v207, a[208:211] offset:4352
ds_write_b128 v207, a[212:215] offset:5440
ds_write_b128 v207, a[216:219] offset:6528
ds_write_b128 v207, a[220:223] offset:7616
ds_write_b128 v207, a[224:227] offset:8704
ds_write_b128 v207, a[228:231] offset:9792
ds_write_b128 v207, a[232:235] offset:10880
ds_write_b128 v207, a[236:239] offset:11968
ds_write_b128 v207, a[240:243] offset:13056
ds_write_b128 v207, a[244:247] offset:14144
ds_write_b128 v207, a[248:251] offset:15232
ds_write_b128 v207, a[252:255] offset:16320
s_waitcnt lgkmcnt(15)
v_max_f32 v164, v164, v165
v_max3_f32 v164, v164, v166, v167
v_mul_f32 v164, v164, v185
v_max_f32 v164, v164, v176
v_sub_f32 v182, v176, v164
v_exp_f32 v182, v182
v_mov_b32 v176, v164
v_max_f32 v168, v168, v169
v_max3_f32 v168, v168, v170, v171
v_mul_f32 v168, v168, v185
v_max_f32 v168, v168, v177
v_sub_f32 v183, v177, v168
v_exp_f32 v183, v183
v_mov_b32 v177, v168
v_max_f32 v172, v172, v173
v_max3_f32 v172, v172, v174, v175
v_mul_f32 v172, v172, v185
v_max_f32 v172, v172, v178
v_sub_f32 v184, v178, v172
v_exp_f32 v184, v184
v_mov_b32 v178, v172
v_fma_f32 v76, v76, v185, -v176
v_fma_f32 v77, v77, v185, -v176
v_fma_f32 v78, v78, v185, -v176
v_fma_f32 v79, v79, v185, -v176
v_exp_f32 v76, v76
v_exp_f32 v77, v77
v_exp_f32 v78, v78
v_exp_f32 v79, v79
v_mul_f32 v180, v180, v182
v_cvt_pk_bf16_f32 v186, v76, v77
v_cvt_pk_bf16_f32 v187, v78, v79
ds_write_b64 v201, v[186:187] offset:0
v_add_f32 v180, v180, v76
v_add_f32 v180, v180, v77
v_add_f32 v180, v180, v78
v_add_f32 v180, v180, v79
v_fma_f32 v80, v80, v185, -v177
v_fma_f32 v81, v81, v185, -v177
v_fma_f32 v82, v82, v185, -v177
v_fma_f32 v83, v83, v185, -v177
v_exp_f32 v80, v80
v_exp_f32 v81, v81
v_exp_f32 v82, v82
v_exp_f32 v83, v83
v_mul_f32 v181, v181, v183
v_cvt_pk_bf16_f32 v188, v80, v81
v_cvt_pk_bf16_f32 v189, v82, v83
ds_write_b64 v201, v[188:189] offset:512
v_add_f32 v181, v181, v80
v_add_f32 v181, v181, v81
v_add_f32 v181, v181, v82
v_add_f32 v181, v181, v83
v_mul_f32 v12, v12, v184
v_mul_f32 v13, v13, v184
v_mul_f32 v14, v14, v184
v_mul_f32 v15, v15, v184
v_mul_f32 v16, v16, v184
v_mul_f32 v17, v17, v184
v_mul_f32 v18, v18, v184
v_mul_f32 v19, v19, v184
v_mul_f32 v20, v20, v184
v_mul_f32 v21, v21, v184
v_mul_f32 v22, v22, v184
v_mul_f32 v23, v23, v184
v_mul_f32 v24, v24, v184
v_mul_f32 v25, v25, v184
v_mul_f32 v26, v26, v184
v_mul_f32 v27, v27, v184
v_mul_f32 v28, v28, v184
v_mul_f32 v29, v29, v184
v_mul_f32 v30, v30, v184
v_mul_f32 v31, v31, v184
v_mul_f32 v32, v32, v184
v_mul_f32 v33, v33, v184
v_mul_f32 v34, v34, v184
v_mul_f32 v35, v35, v184
v_mul_f32 v36, v36, v184
v_mul_f32 v37, v37, v184
v_mul_f32 v38, v38, v184
v_mul_f32 v39, v39, v184
v_mul_f32 v40, v40, v184
v_mul_f32 v41, v41, v184
v_mul_f32 v42, v42, v184
v_mul_f32 v43, v43, v184
v_mul_f32 v44, v44, v184
v_mul_f32 v45, v45, v184
v_mul_f32 v46, v46, v184
v_mul_f32 v47, v47, v184
v_mul_f32 v48, v48, v184
v_mul_f32 v49, v49, v184
v_mul_f32 v50, v50, v184
v_mul_f32 v51, v51, v184
v_mul_f32 v52, v52, v184
v_mul_f32 v53, v53, v184
v_mul_f32 v54, v54, v184
v_mul_f32 v55, v55, v184
v_mul_f32 v56, v56, v184
v_mul_f32 v57, v57, v184
v_mul_f32 v58, v58, v184
v_mul_f32 v59, v59, v184
v_mul_f32 v60, v60, v184
v_mul_f32 v61, v61, v184
v_mul_f32 v62, v62, v184
v_mul_f32 v63, v63, v184
v_mul_f32 v64, v64, v184
v_mul_f32 v65, v65, v184
v_mul_f32 v66, v66, v184
v_mul_f32 v67, v67, v184
v_mul_f32 v68, v68, v184
v_mul_f32 v69, v69, v184
v_mul_f32 v70, v70, v184
v_mul_f32 v71, v71, v184
v_mul_f32 v72, v72, v184
v_mul_f32 v73, v73, v184
v_mul_f32 v74, v74, v184
v_mul_f32 v75, v75, v184
s_waitcnt lgkmcnt(0)
s_barrier
ds_read_b128 v[148:151], v202 offset:0
ds_read_b128 v[152:155], v202 offset:1024
ds_read_b128 v[156:159], v202 offset:2048
ds_read_b128 v[160:163], v202 offset:3072
ds_read_b64_tr_b16 v[84:85], v196 offset:0
ds_read_b64_tr_b16 v[86:87], v196 offset:4352
ds_read_b64_tr_b16 v[88:89], v196 offset:64
ds_read_b64_tr_b16 v[90:91], v196 offset:4416
ds_read_b64_tr_b16 v[92:93], v196 offset:128
ds_read_b64_tr_b16 v[94:95], v196 offset:4480
ds_read_b64_tr_b16 v[96:97], v196 offset:192
ds_read_b64_tr_b16 v[98:99], v196 offset:4544
ds_read_b64_tr_b16 v[100:101], v196 offset:17408
ds_read_b64_tr_b16 v[102:103], v196 offset:21760
ds_read_b64_tr_b16 v[104:105], v196 offset:17472
ds_read_b64_tr_b16 v[106:107], v196 offset:21824
ds_read_b64_tr_b16 v[108:109], v196 offset:17536
ds_read_b64_tr_b16 v[110:111], v196 offset:21888
ds_read_b64_tr_b16 v[112:113], v196 offset:17600
ds_read_b64_tr_b16 v[114:115], v196 offset:21952
ds_read_b64_tr_b16 v[116:117], v196 offset:34816
ds_read_b64_tr_b16 v[118:119], v196 offset:39168
ds_read_b64_tr_b16 v[120:121], v196 offset:34880
ds_read_b64_tr_b16 v[122:123], v196 offset:39232
ds_read_b64_tr_b16 v[124:125], v196 offset:34944
ds_read_b64_tr_b16 v[126:127], v196 offset:39296
ds_read_b64_tr_b16 v[128:129], v196 offset:35008
ds_read_b64_tr_b16 v[130:131], v196 offset:39360
ds_read_b64_tr_b16 v[132:133], v196 offset:52224
ds_read_b64_tr_b16 v[134:135], v196 offset:56576
ds_read_b64_tr_b16 v[136:137], v196 offset:52288
ds_read_b64_tr_b16 v[138:139], v196 offset:56640
ds_read_b64_tr_b16 v[140:141], v196 offset:52352
ds_read_b64_tr_b16 v[142:143], v196 offset:56704
ds_read_b64_tr_b16 v[144:145], v196 offset:52416
ds_read_b64_tr_b16 v[146:147], v196 offset:56768
s_waitcnt lgkmcnt(15)
v_mfma_f32_32x32x16_bf16 v[12:27], v[84:87], v[148:151], v[12:27]
v_mfma_f32_32x32x16_bf16 v[28:43], v[88:91], v[148:151], v[28:43]
v_mfma_f32_32x32x16_bf16 v[44:59], v[92:95], v[148:151], v[44:59]
v_mfma_f32_32x32x16_bf16 v[60:75], v[96:99], v[148:151], v[60:75]
s_waitcnt lgkmcnt(15)
v_mfma_f32_32x32x16_bf16 v[12:27], v[100:103], v[152:155], v[12:27]
v_mfma_f32_32x32x16_bf16 v[28:43], v[104:107], v[152:155], v[28:43]
v_mfma_f32_32x32x16_bf16 v[44:59], v[108:111], v[152:155], v[44:59]
v_mfma_f32_32x32x16_bf16 v[60:75], v[112:115], v[152:155], v[60:75]
s_waitcnt lgkmcnt(8)
v_mfma_f32_32x32x16_bf16 v[12:27], v[116:119], v[156:159], v[12:27]
v_mfma_f32_32x32x16_bf16 v[28:43], v[120:123], v[156:159], v[28:43]
v_mfma_f32_32x32x16_bf16 v[44:59], v[124:127], v[156:159], v[44:59]
v_mfma_f32_32x32x16_bf16 v[60:75], v[128:131], v[156:159], v[60:75]
s_waitcnt lgkmcnt(0)
v_mfma_f32_32x32x16_bf16 v[12:27], v[132:135], v[160:163], v[12:27]
v_mfma_f32_32x32x16_bf16 v[28:43], v[136:139], v[160:163], v[28:43]
v_mfma_f32_32x32x16_bf16 v[44:59], v[140:143], v[160:163], v[44:59]
v_mfma_f32_32x32x16_bf16 v[60:75], v[144:147], v[160:163], v[60:75]
ds_read_b128 v[84:87], v195 offset:0
ds_read_b128 v[88:91], v195 offset:64
ds_read_b128 v[92:95], v195 offset:128
ds_read_b128 v[96:99], v195 offset:192
ds_read_b128 v[100:103], v195 offset:256
ds_read_b128 v[104:107], v195 offset:320
ds_read_b128 v[108:111], v195 offset:384
ds_read_b128 v[112:115], v195 offset:448
ds_read_b128 v[116:119], v195 offset:512
ds_read_b128 v[120:123], v195 offset:576
ds_read_b128 v[124:127], v195 offset:640
ds_read_b128 v[128:131], v195 offset:704
ds_read_b128 v[132:135], v195 offset:768
ds_read_b128 v[136:139], v195 offset:832
ds_read_b128 v[140:143], v195 offset:896
ds_read_b128 v[144:147], v195 offset:960
s_waitcnt lgkmcnt(15)
v_mfma_f32_16x16x32_bf16 v[76:79], v[84:87], a[0:3], 0
v_mfma_f32_16x16x32_bf16 v[80:83], v[84:87], a[64:67], 0
s_waitcnt lgkmcnt(14)
v_mfma_f32_16x16x32_bf16 v[76:79], v[88:91], a[4:7], v[76:79]
v_mfma_f32_16x16x32_bf16 v[80:83], v[88:91], a[68:71], v[80:83]
s_waitcnt lgkmcnt(13)
v_mfma_f32_16x16x32_bf16 v[76:79], v[92:95], a[8:11], v[76:79]
v_mfma_f32_16x16x32_bf16 v[80:83], v[92:95], a[72:75], v[80:83]
s_waitcnt lgkmcnt(12)
v_mfma_f32_16x16x32_bf16 v[76:79], v[96:99], a[12:15], v[76:79]
v_mfma_f32_16x16x32_bf16 v[80:83], v[96:99], a[76:79], v[80:83]
s_waitcnt lgkmcnt(11)
v_mfma_f32_16x16x32_bf16 v[76:79], v[100:103], a[16:19], v[76:79]
v_mfma_f32_16x16x32_bf16 v[80:83], v[100:103], a[80:83], v[80:83]
s_waitcnt lgkmcnt(10)
v_mfma_f32_16x16x32_bf16 v[76:79], v[104:107], a[20:23], v[76:79]
v_mfma_f32_16x16x32_bf16 v[80:83], v[104:107], a[84:87], v[80:83]
s_waitcnt lgkmcnt(9)
v_mfma_f32_16x16x32_bf16 v[76:79], v[108:111], a[24:27], v[76:79]
v_mfma_f32_16x16x32_bf16 v[80:83], v[108:111], a[88:91], v[80:83]
s_waitcnt lgkmcnt(8)
v_mfma_f32_16x16x32_bf16 v[76:79], v[112:115], a[28:31], v[76:79]
v_mfma_f32_16x16x32_bf16 v[80:83], v[112:115], a[92:95], v[80:83]
s_waitcnt lgkmcnt(7)
v_mfma_f32_16x16x32_bf16 v[76:79], v[116:119], a[32:35], v[76:79]
v_mfma_f32_16x16x32_bf16 v[80:83], v[116:119], a[96:99], v[80:83]
s_waitcnt lgkmcnt(6)
v_mfma_f32_16x16x32_bf16 v[76:79], v[120:123], a[36:39], v[76:79]
v_mfma_f32_16x16x32_bf16 v[80:83], v[120:123], a[100:103], v[80:83]
s_waitcnt lgkmcnt(5)
v_mfma_f32_16x16x32_bf16 v[76:79], v[124:127], a[40:43], v[76:79]
v_mfma_f32_16x16x32_bf16 v[80:83], v[124:127], a[104:107], v[80:83]
s_waitcnt lgkmcnt(4)
v_mfma_f32_16x16x32_bf16 v[76:79], v[128:131], a[44:47], v[76:79]
v_mfma_f32_16x16x32_bf16 v[80:83], v[128:131], a[108:111], v[80:83]
s_waitcnt lgkmcnt(3)
v_mfma_f32_16x16x32_bf16 v[76:79], v[132:135], a[48:51], v[76:79]
v_mfma_f32_16x16x32_bf16 v[80:83], v[132:135], a[112:115], v[80:83]
s_waitcnt lgkmcnt(2)
v_mfma_f32_16x16x32_bf16 v[76:79], v[136:139], a[52:55], v[76:79]
v_mfma_f32_16x16x32_bf16 v[80:83], v[136:139], a[116:119], v[80:83]
s_waitcnt lgkmcnt(1)
v_mfma_f32_16x16x32_bf16 v[76:79], v[140:143], a[56:59], v[76:79]
v_mfma_f32_16x16x32_bf16 v[80:83], v[140:143], a[120:123], v[80:83]
s_waitcnt lgkmcnt(0)
v_mfma_f32_16x16x32_bf16 v[76:79], v[144:147], a[60:63], v[76:79]
v_mfma_f32_16x16x32_bf16 v[80:83], v[144:147], a[124:127], v[80:83]
s_nop 6
v_max_f32 v190, v76, v77
v_max3_f32 v190, v190, v78, v79
v_mov_b32 v192, v190
s_nop 1
v_permlane16_swap_b32 v190, v192
v_max_f32 v190, v190, v192
v_mov_b32 v192, v190
s_nop 1
v_permlane32_swap_b32 v190, v192
v_max_f32 v190, v190, v192
ds_write_b32 v198, v190 offset:0
v_max_f32 v191, v80, v81
v_max3_f32 v191, v191, v82, v83
v_mov_b32 v192, v191
s_nop 1
v_permlane16_swap_b32 v191, v192
v_max_f32 v191, v191, v192
v_mov_b32 v192, v191
s_nop 1
v_permlane32_swap_b32 v191, v192
v_max_f32 v191, v191, v192
ds_write_b32 v198, v191 offset:256
s_waitcnt lgkmcnt(0)
s_barrier
ds_read_b128 v[164:167], v199
ds_read_b128 v[168:171], v199 offset:256
ds_read_b128 v[172:175], v200
s_waitcnt lgkmcnt(0)
v_max_f32 v164, v164, v165
v_max3_f32 v164, v164, v166, v167
v_mul_f32 v164, v164, v185
v_max_f32 v164, v164, v176
v_sub_f32 v182, v176, v164
v_exp_f32 v182, v182
v_mov_b32 v176, v164
v_max_f32 v168, v168, v169
v_max3_f32 v168, v168, v170, v171
v_mul_f32 v168, v168, v185
v_max_f32 v168, v168, v177
v_sub_f32 v183, v177, v168
v_exp_f32 v183, v183
v_mov_b32 v177, v168
v_max_f32 v172, v172, v173
v_max3_f32 v172, v172, v174, v175
v_mul_f32 v172, v172, v185
v_max_f32 v172, v172, v178
v_sub_f32 v184, v178, v172
v_exp_f32 v184, v184
v_mov_b32 v178, v172
v_fma_f32 v76, v76, v185, -v176
v_fma_f32 v77, v77, v185, -v176
v_fma_f32 v78, v78, v185, -v176
v_fma_f32 v79, v79, v185, -v176
v_exp_f32 v76, v76
v_exp_f32 v77, v77
v_exp_f32 v78, v78
v_exp_f32 v79, v79
v_mul_f32 v180, v180, v182
v_cvt_pk_bf16_f32 v186, v76, v77
v_cvt_pk_bf16_f32 v187, v78, v79
ds_write_b64 v201, v[186:187] offset:0
v_add_f32 v180, v180, v76
v_add_f32 v180, v180, v77
v_add_f32 v180, v180, v78
v_add_f32 v180, v180, v79
v_fma_f32 v80, v80, v185, -v177
v_fma_f32 v81, v81, v185, -v177
v_fma_f32 v82, v82, v185, -v177
v_fma_f32 v83, v83, v185, -v177
v_exp_f32 v80, v80
v_exp_f32 v81, v81
v_exp_f32 v82, v82
v_exp_f32 v83, v83
v_mul_f32 v181, v181, v183
v_cvt_pk_bf16_f32 v188, v80, v81
v_cvt_pk_bf16_f32 v189, v82, v83
ds_write_b64 v201, v[188:189] offset:512
v_add_f32 v181, v181, v80
v_add_f32 v181, v181, v81
v_add_f32 v181, v181, v82
v_add_f32 v181, v181, v83
v_mul_f32 v12, v12, v184
v_mul_f32 v13, v13, v184
v_mul_f32 v14, v14, v184
v_mul_f32 v15, v15, v184
v_mul_f32 v16, v16, v184
v_mul_f32 v17, v17, v184
v_mul_f32 v18, v18, v184
v_mul_f32 v19, v19, v184
v_mul_f32 v20, v20, v184
v_mul_f32 v21, v21, v184
v_mul_f32 v22, v22, v184
v_mul_f32 v23, v23, v184
v_mul_f32 v24, v24, v184
v_mul_f32 v25, v25, v184
v_mul_f32 v26, v26, v184
v_mul_f32 v27, v27, v184
v_mul_f32 v28, v28, v184
v_mul_f32 v29, v29, v184
v_mul_f32 v30, v30, v184
v_mul_f32 v31, v31, v184
v_mul_f32 v32, v32, v184
v_mul_f32 v33, v33, v184
v_mul_f32 v34, v34, v184
v_mul_f32 v35, v35, v184
v_mul_f32 v36, v36, v184
v_mul_f32 v37, v37, v184
v_mul_f32 v38, v38, v184
v_mul_f32 v39, v39, v184
v_mul_f32 v40, v40, v184
v_mul_f32 v41, v41, v184
v_mul_f32 v42, v42, v184
v_mul_f32 v43, v43, v184
v_mul_f32 v44, v44, v184
v_mul_f32 v45, v45, v184
v_mul_f32 v46, v46, v184
v_mul_f32 v47, v47, v184
v_mul_f32 v48, v48, v184
v_mul_f32 v49, v49, v184
v_mul_f32 v50, v50, v184
v_mul_f32 v51, v51, v184
v_mul_f32 v52, v52, v184
v_mul_f32 v53, v53, v184
v_mul_f32 v54, v54, v184
v_mul_f32 v55, v55, v184
v_mul_f32 v56, v56, v184
v_mul_f32 v57, v57, v184
v_mul_f32 v58, v58, v184
v_mul_f32 v59, v59, v184
v_mul_f32 v60, v60, v184
v_mul_f32 v61, v61, v184
v_mul_f32 v62, v62, v184
v_mul_f32 v63, v63, v184
v_mul_f32 v64, v64, v184
v_mul_f32 v65, v65, v184
v_mul_f32 v66, v66, v184
v_mul_f32 v67, v67, v184
v_mul_f32 v68, v68, v184
v_mul_f32 v69, v69, v184
v_mul_f32 v70, v70, v184
v_mul_f32 v71, v71, v184
v_mul_f32 v72, v72, v184
v_mul_f32 v73, v73, v184
v_mul_f32 v74, v74, v184
v_mul_f32 v75, v75, v184
s_waitcnt lgkmcnt(0)
s_barrier
ds_read_b128 v[148:151], v202 offset:0
ds_read_b128 v[152:155], v202 offset:1024
ds_read_b128 v[156:159], v202 offset:2048
ds_read_b128 v[160:163], v202 offset:3072
ds_read_b64_tr_b16 v[84:85], v197 offset:0
ds_read_b64_tr_b16 v[86:87], v197 offset:4352
ds_read_b64_tr_b16 v[88:89], v197 offset:64
ds_read_b64_tr_b16 v[90:91], v197 offset:4416
ds_read_b64_tr_b16 v[92:93], v197 offset:128
ds_read_b64_tr_b16 v[94:95], v197 offset:4480
ds_read_b64_tr_b16 v[96:97], v197 offset:192
ds_read_b64_tr_b16 v[98:99], v197 offset:4544
ds_read_b64_tr_b16 v[100:101], v197 offset:17408
ds_read_b64_tr_b16 v[102:103], v197 offset:21760
ds_read_b64_tr_b16 v[104:105], v197 offset:17472
ds_read_b64_tr_b16 v[106:107], v197 offset:21824
ds_read_b64_tr_b16 v[108:109], v197 offset:17536
ds_read_b64_tr_b16 v[110:111], v197 offset:21888
ds_read_b64_tr_b16 v[112:113], v197 offset:17600
ds_read_b64_tr_b16 v[114:115], v197 offset:21952
ds_read_b64_tr_b16 v[116:117], v197 offset:34816
ds_read_b64_tr_b16 v[118:119], v197 offset:39168
ds_read_b64_tr_b16 v[120:121], v197 offset:34880
ds_read_b64_tr_b16 v[122:123], v197 offset:39232
ds_read_b64_tr_b16 v[124:125], v197 offset:34944
ds_read_b64_tr_b16 v[126:127], v197 offset:39296
ds_read_b64_tr_b16 v[128:129], v197 offset:35008
ds_read_b64_tr_b16 v[130:131], v197 offset:39360
ds_read_b64_tr_b16 v[132:133], v197 offset:52224
ds_read_b64_tr_b16 v[134:135], v197 offset:56576
ds_read_b64_tr_b16 v[136:137], v197 offset:52288
ds_read_b64_tr_b16 v[138:139], v197 offset:56640
ds_read_b64_tr_b16 v[140:141], v197 offset:52352
ds_read_b64_tr_b16 v[142:143], v197 offset:56704
ds_read_b64_tr_b16 v[144:145], v197 offset:52416
ds_read_b64_tr_b16 v[146:147], v197 offset:56768
s_waitcnt lgkmcnt(15)
v_mfma_f32_32x32x16_bf16 v[12:27], v[84:87], v[148:151], v[12:27]
v_mfma_f32_32x32x16_bf16 v[28:43], v[88:91], v[148:151], v[28:43]
v_mfma_f32_32x32x16_bf16 v[44:59], v[92:95], v[148:151], v[44:59]
v_mfma_f32_32x32x16_bf16 v[60:75], v[96:99], v[148:151], v[60:75]
s_waitcnt lgkmcnt(15)
v_mfma_f32_32x32x16_bf16 v[12:27], v[100:103], v[152:155], v[12:27]
v_mfma_f32_32x32x16_bf16 v[28:43], v[104:107], v[152:155], v[28:43]
v_mfma_f32_32x32x16_bf16 v[44:59], v[108:111], v[152:155], v[44:59]
v_mfma_f32_32x32x16_bf16 v[60:75], v[112:115], v[152:155], v[60:75]
s_waitcnt lgkmcnt(8)
v_mfma_f32_32x32x16_bf16 v[12:27], v[116:119], v[156:159], v[12:27]
v_mfma_f32_32x32x16_bf16 v[28:43], v[120:123], v[156:159], v[28:43]
v_mfma_f32_32x32x16_bf16 v[44:59], v[124:127], v[156:159], v[44:59]
v_mfma_f32_32x32x16_bf16 v[60:75], v[128:131], v[156:159], v[60:75]
s_waitcnt lgkmcnt(0)
v_mfma_f32_32x32x16_bf16 v[12:27], v[132:135], v[160:163], v[12:27]
v_mfma_f32_32x32x16_bf16 v[28:43], v[136:139], v[160:163], v[28:43]
v_mfma_f32_32x32x16_bf16 v[44:59], v[140:143], v[160:163], v[44:59]
v_mfma_f32_32x32x16_bf16 v[60:75], v[144:147], v[160:163], v[60:75]
v_mov_b32 v192, v180
s_nop 1
v_permlane16_swap_b32 v180, v192
v_add_f32 v180, v180, v192
v_mov_b32 v192, v180
s_nop 1
v_permlane32_swap_b32 v180, v192
v_add_f32 v180, v180, v192
ds_write_b32 v198, v180 offset:512
v_mov_b32 v192, v181
s_nop 1
v_permlane16_swap_b32 v181, v192
v_add_f32 v181, v181, v192
v_mov_b32 v192, v181
s_nop 1
v_permlane32_swap_b32 v181, v192
v_add_f32 v181, v181, v192
ds_write_b32 v198, v181 offset:768
v_and_b32 v5, 31, v1
v_mul_u32_u24 v5, 1040, v5
v_lshrrev_b32 v6, 5, v1
v_lshl_add_u32 v5, v6, 3, v5
s_lshl_b32 s6, s3, 8
v_add_u32 v5, s6, v5
v_cvt_pk_bf16_f32 v84, v12, v13
v_cvt_pk_bf16_f32 v85, v14, v15
ds_write_b64 v5, v[84:85] offset:0
v_cvt_pk_bf16_f32 v86, v16, v17
v_cvt_pk_bf16_f32 v87, v18, v19
ds_write_b64 v5, v[86:87] offset:16
v_cvt_pk_bf16_f32 v88, v20, v21
v_cvt_pk_bf16_f32 v89, v22, v23
ds_write_b64 v5, v[88:89] offset:32
v_cvt_pk_bf16_f32 v90, v24, v25
v_cvt_pk_bf16_f32 v91, v26, v27
ds_write_b64 v5, v[90:91] offset:48
v_cvt_pk_bf16_f32 v92, v28, v29
v_cvt_pk_bf16_f32 v93, v30, v31
ds_write_b64 v5, v[92:93] offset:64
v_cvt_pk_bf16_f32 v94, v32, v33
v_cvt_pk_bf16_f32 v95, v34, v35
ds_write_b64 v5, v[94:95] offset:80
v_cvt_pk_bf16_f32 v96, v36, v37
v_cvt_pk_bf16_f32 v97, v38, v39
ds_write_b64 v5, v[96:97] offset:96
v_cvt_pk_bf16_f32 v98, v40, v41
v_cvt_pk_bf16_f32 v99, v42, v43
ds_write_b64 v5, v[98:99] offset:112
v_cvt_pk_bf16_f32 v100, v44, v45
v_cvt_pk_bf16_f32 v101, v46, v47
ds_write_b64 v5, v[100:101] offset:128
v_cvt_pk_bf16_f32 v102, v48, v49
v_cvt_pk_bf16_f32 v103, v50, v51
ds_write_b64 v5, v[102:103] offset:144
v_cvt_pk_bf16_f32 v104, v52, v53
v_cvt_pk_bf16_f32 v105, v54, v55
ds_write_b64 v5, v[104:105] offset:160
v_cvt_pk_bf16_f32 v106, v56, v57
v_cvt_pk_bf16_f32 v107, v58, v59
ds_write_b64 v5, v[106:107] offset:176
v_cvt_pk_bf16_f32 v108, v60, v61
v_cvt_pk_bf16_f32 v109, v62, v63
ds_write_b64 v5, v[108:109] offset:192
v_cvt_pk_bf16_f32 v110, v64, v65
v_cvt_pk_bf16_f32 v111, v66, v67
ds_write_b64 v5, v[110:111] offset:208
v_cvt_pk_bf16_f32 v112, v68, v69
v_cvt_pk_bf16_f32 v113, v70, v71
ds_write_b64 v5, v[112:113] offset:224
v_cvt_pk_bf16_f32 v114, v72, v73
v_cvt_pk_bf16_f32 v115, v74, v75
ds_write_b64 v5, v[114:115] offset:240
v_mov_b32 v11, 163824
v_mov_b32 v7, 0
ds_write_b32 v11, v7
s_waitcnt lgkmcnt(0)
s_barrier
s_mul_i32 s6, s3, 8320
v_add_u32 v5, s6, v2
ds_read_b128 v[116:119], v5 offset:0
ds_read_b128 v[120:123], v5 offset:1040
ds_read_b128 v[124:127], v5 offset:2080
ds_read_b128 v[128:131], v5 offset:3120
ds_read_b128 v[132:135], v5 offset:4160
ds_read_b128 v[136:139], v5 offset:5200
ds_read_b128 v[140:143], v5 offset:6240
ds_read_b128 v[144:147], v5 offset:7280
ds_read_b128 v[164:167], v200 offset:512
s_mul_i32 s7, s3, 524288
s_lshl_b32 s6, s80, 10
s_add_u32 s7, s7, s6
s_add_u32 s7, s7, 2097152
s_waitcnt lgkmcnt(8)
s_add_u32 s6, s7, 0
buffer_store_dwordx4 v[116:119], v2, s[64:67], s6 offen sc1
s_waitcnt lgkmcnt(7)
s_add_u32 s6, s7, 98304
buffer_store_dwordx4 v[120:123], v2, s[64:67], s6 offen sc1
s_waitcnt lgkmcnt(6)
s_add_u32 s6, s7, 131072
buffer_store_dwordx4 v[124:127], v2, s[64:67], s6 offen sc1
s_waitcnt lgkmcnt(5)
s_add_u32 s6, s7, 229376
buffer_store_dwordx4 v[128:131], v2, s[64:67], s6 offen sc1
s_waitcnt lgkmcnt(4)
s_add_u32 s6, s7, 262144
buffer_store_dwordx4 v[132:135], v2, s[64:67], s6 offen sc1
s_waitcnt lgkmcnt(3)
s_add_u32 s6, s7, 360448
buffer_store_dwordx4 v[136:139], v2, s[64:67], s6 offen sc1
s_waitcnt lgkmcnt(2)
s_add_u32 s6, s7, 393216
buffer_store_dwordx4 v[140:143], v2, s[64:67], s6 offen sc1
s_waitcnt lgkmcnt(1)
s_add_u32 s6, s7, 491520
buffer_store_dwordx4 v[144:147], v2, s[64:67], s6 offen sc1
s_waitcnt lgkmcnt(0)
v_add_f32 v164, v164, v165
v_add_f32 v166, v166, v167
v_add_f32 v187, v164, v166
v_mov_b32 v186, v178
v_lshlrev_b32 v5, 8, v1
s_mul_i32 s6, s80, 8
s_add_u32 s6, s6, 262144
v_min_u32 v186, -2, v186
v_min_u32 v187, -2, v187
s_waitcnt vmcnt(0)
s_barrier
s_cmp_lg_u32 s3, 0
s_cbranch_scc1 L_nops_41
s_mov_b64 exec, 0xffffffff
buffer_store_dwordx2 v[186:187], v5, s[64:67], s6 offen sc1
s_mov_b64 exec, -1
L_nops_41:
B_final:
s_cmp_eq_u32 s3, 3
s_cbranch_scc1 H_start
s_mov_b32 s14, s9
s_lshr_b32 s7, s3, 1
s_cmp_lg_u32 s3, 1
s_cbranch_scc1 L_w1_42
s_and_b32 s7, s9, 7
s_cmp_ge_u32 s7, 2
s_cbranch_scc1 B_end
s_lshr_b32 s14, s9, 3
s_add_u32 s14, s14, 64
L_w1_42:
s_mul_i32 s15, s14, 57
s_lshr_b32 s15, s15, 10
s_mul_i32 s6, s15, 18
s_sub_u32 s80, s14, s6
s_mul_i32 s81, s15, 73728
s_lshr_b32 s81, s81, s7
s_lshl_b32 s6, s80, 6
s_add_u32 s81, s81, s6
s_mul_i32 s6, s7, 1048576
s_add_u32 s81, s81, s6
s_add_u32 s81, s81, 4194304
v_lshrrev_b32 v5, 2, v1
v_and_b32 v6, 3, v1
v_mul_u32_u24 v44, 1152, v5
v_lshl_add_u32 v44, v6, 4, v44
v_bfe_u32 v5, v1, 2, 2
v_lshl_add_u32 v5, v5, 2, v6
v_lshrrev_b32 v46, 4, v1
v_lshl_add_u32 v45, v46, 6, v5
v_lshrrev_b32 v5, 1, v6
v_mul_u32_u24 v5, 142, v5
v_add_u32 v5, v5, v6
v_lshrrev_b32 v46, 2, v1
v_lshl_add_u32 v5, v46, 1, v5
s_lshr_b32 s6, s80, 2
s_mul_i32 s6, s6, 80
s_lshl_b32 s83, s80, 4
s_add_u32 s83, s83, s6
s_mul_i32 s6, s80, 288
s_sub_u32 s6, s6, 4480
s_cmp_ge_u32 s80, 16
s_cselect_b32 s83, s6, s83
s_cselect_b64 vcc, -1, 0
v_cndmask_b32 v45, v45, v5, vcc
v_lshlrev_b32 v45, 1, v45
s_lshl_b32 s83, s83, 1
s_mul_i32 s6, s15, 2304
s_add_u32 s83, s83, s6
s_mul_i32 s6, s7, 1152
s_add_u32 s83, s83, s6
v_and_b32 v6, 1, v1
v_lshlrev_b32 v6, 4, v6
v_mov_b32 v46, 0x3f80
v_lshlrev_b32 v46, v6, v46
v_bfe_u32 v6, v1, 1, 3
v_cmp_eq_u32 vcc, 0, v6
s_nop 1
v_cndmask_b32 v20, 0, v46, vcc
v_cmp_eq_u32 vcc, 1, v6
s_nop 1
v_cndmask_b32 v21, 0, v46, vcc
v_cmp_eq_u32 vcc, 2, v6
s_nop 1
v_cndmask_b32 v22, 0, v46, vcc
v_cmp_eq_u32 vcc, 3, v6
s_nop 1
v_cndmask_b32 v23, 0, v46, vcc
s_sub_u32 s6, s7, 1
s_mov_b32 s16, -1
s_mov_b32 s17, -1
s_mov_b32 s18, -1
s_mov_b32 s19, -1
s_mov_b32 s20, s6
s_mov_b32 s21, s6
s_mov_b32 s22, s6
s_mov_b32 s23, s6
v_mov_b32 v48, -1
v_mov_b32 v49, -1
v_mov_b32 v50, -1
v_mov_b32 v51, -1
v_mov_b32 v52, -1
v_mov_b32 v53, -1
v_mov_b32 v54, -1
v_mov_b32 v55, -1
v_mov_b32 v56, s6
v_mov_b32 v57, s6
v_mov_b32 v58, s6
v_mov_b32 v59, s6
v_mov_b32 v60, s6
v_mov_b32 v61, s6
v_mov_b32 v62, s6
v_mov_b32 v63, s6
v_mov_b32 v64, -1
v_mov_b32 v65, -1
v_mov_b32 v66, -1
v_mov_b32 v67, -1
v_mov_b32 v68, -1
v_mov_b32 v69, -1
v_mov_b32 v70, -1
v_mov_b32 v71, -1
v_mov_b32 v72, -1
v_mov_b32 v73, -1
v_mov_b32 v74, -1
v_mov_b32 v75, -1
v_mov_b32 v76, -1
v_mov_b32 v77, -1
v_mov_b32 v78, -1
v_mov_b32 v79, -1
v_mov_b32 v80, -1
v_mov_b32 v81, -1
v_mov_b32 v82, -1
v_mov_b32 v83, -1
v_mov_b32 v84, -1
v_mov_b32 v85, -1
v_mov_b32 v86, -1
v_mov_b32 v87, -1
v_mov_b32 v88, -1
v_mov_b32 v89, -1
v_mov_b32 v90, -1
v_mov_b32 v91, -1
v_mov_b32 v92, -1
v_mov_b32 v93, -1
v_mov_b32 v94, -1
v_mov_b32 v95, -1
s_add_u32 s24, s81, 0
s_add_u32 s25, s81, 18432
s_add_u32 s26, s81, 36864
s_add_u32 s27, s81, 55296
s_mov_b32 s7, 400000
v_lshrrev_b32 v5, 3, v1
v_mul_u32_u24 v5, 4608, v5
s_and_b32 s6, s20, 1
v_lshlrev_b32 v5, s6, v5
R_slow:
buffer_load_dword v46, v5, s[64:67], s81 offen sc1
s_waitcnt vmcnt(0)
v_cmp_ne_u32 vcc, -1, v46
s_bcnt1_i32_b64 s6, vcc
s_cmp_ge_u32 s6, 32
s_cbranch_scc1 R_pass
s_sleep 8
s_sub_u32 s7, s7, 1
s_cmp_lg_u32 s7, 1
s_cbranch_scc1 R_slow
R_pass:
s_mov_b64 exec, s[16:17]
s_cbranch_execz L_ld_43
buffer_load_dwordx4 v[64:67], v44, s[64:67], s24 offen sc1
L_ld_43:
s_mov_b64 exec, s[18:19]
s_cbranch_execz L_ld_44
buffer_load_dwordx4 v[68:71], v44, s[64:67], s25 offen sc1
L_ld_44:
s_mov_b64 exec, s[20:21]
s_cbranch_execz L_ld_45
buffer_load_dwordx4 v[72:75], v44, s[64:67], s26 offen sc1
L_ld_45:
s_mov_b64 exec, s[22:23]
s_cbranch_execz L_ld_46
buffer_load_dwordx4 v[76:79], v44, s[64:67], s27 offen sc1
L_ld_46:
s_mov_b64 exec, -1
s_waitcnt vmcnt(0)
s_cmp_eq_u64 s[16:17], 0
s_cbranch_scc1 L_ck_47
v_min_u32 v48, v48, v64
v_min_u32 v49, v49, v65
v_min_u32 v50, v50, v66
v_min_u32 v51, v51, v67
v_max3_u32 v46, v48, v49, v50
v_max_u32 v46, v46, v51
v_cmp_eq_u32 s[16:17], -1, v46
L_ck_47:
s_cmp_eq_u64 s[18:19], 0
s_cbranch_scc1 L_ck_48
v_min_u32 v52, v52, v68
v_min_u32 v53, v53, v69
v_min_u32 v54, v54, v70
v_min_u32 v55, v55, v71
v_max3_u32 v46, v52, v53, v54
v_max_u32 v46, v46, v55
v_cmp_eq_u32 s[18:19], -1, v46
L_ck_48:
s_cmp_eq_u64 s[20:21], 0
s_cbranch_scc1 L_ck_49
v_min_u32 v56, v56, v72
v_min_u32 v57, v57, v73
v_min_u32 v58, v58, v74
v_min_u32 v59, v59, v75
v_max3_u32 v46, v56, v57, v58
v_max_u32 v46, v46, v59
v_cmp_eq_u32 s[20:21], -1, v46
L_ck_49:
s_cmp_eq_u64 s[22:23], 0
s_cbranch_scc1 L_ck_50
v_min_u32 v60, v60, v76
v_min_u32 v61, v61, v77
v_min_u32 v62, v62, v78
v_min_u32 v63, v63, v79
v_max3_u32 v46, v60, v61, v62
v_max_u32 v46, v46, v63
v_cmp_eq_u32 s[22:23], -1, v46
L_ck_50:
s_or_b64 s[28:29], s[16:17], s[18:19]
s_or_b64 s[30:31], s[20:21], s[22:23]
s_or_b64 s[28:29], s[28:29], s[30:31]
s_cbranch_scc0 R_done
s_bcnt1_i32_b64 s6, s[16:17]
s_bcnt1_i32_b64 s28, s[18:19]
s_add_u32 s6, s6, s28
s_bcnt1_i32_b64 s28, s[20:21]
s_add_u32 s6, s6, s28
s_bcnt1_i32_b64 s28, s[22:23]
s_add_u32 s6, s6, s28
s_cmp_le_u32 s6, 48
s_cbranch_scc1 R_fast
s_sub_u32 s7, s7, 1
s_cmp_gt_u32 s7, 1
s_cbranch_scc1 R_pass
R_fast:
s_or_b64 exec, s[16:17], 1
buffer_load_dwordx4 v[64:67], v44, s[64:67], s24 offen sc1
s_or_b64 exec, s[18:19], 1
buffer_load_dwordx4 v[68:71], v44, s[64:67], s25 offen sc1
s_or_b64 exec, s[20:21], 1
buffer_load_dwordx4 v[72:75], v44, s[64:67], s26 offen sc1
s_or_b64 exec, s[22:23], 1
buffer_load_dwordx4 v[76:79], v44, s[64:67], s27 offen sc1
s_mov_b64 exec, -1
s_sleep 9
s_or_b64 exec, s[16:17], 1
buffer_load_dwordx4 v[80:83], v44, s[64:67], s24 offen sc1
s_or_b64 exec, s[18:19], 1
buffer_load_dwordx4 v[84:87], v44, s[64:67], s25 offen sc1
s_or_b64 exec, s[20:21], 1
buffer_load_dwordx4 v[88:91], v44, s[64:67], s26 offen sc1
s_or_b64 exec, s[22:23], 1
buffer_load_dwordx4 v[92:95], v44, s[64:67], s27 offen sc1
s_mov_b64 exec, -1
R_loop:
s_waitcnt vmcnt(4)
s_cmp_eq_u64 s[16:17], 0
s_cbranch_scc1 L_ck_51
v_min_u32 v48, v48, v64
v_min_u32 v49, v49, v65
v_min_u32 v50, v50, v66
v_min_u32 v51, v51, v67
v_max3_u32 v46, v48, v49, v50
v_max_u32 v46, v46, v51
v_cmp_eq_u32 s[16:17], -1, v46
L_ck_51:
s_cmp_eq_u64 s[18:19], 0
s_cbranch_scc1 L_ck_52
v_min_u32 v52, v52, v68
v_min_u32 v53, v53, v69
v_min_u32 v54, v54, v70
v_min_u32 v55, v55, v71
v_max3_u32 v46, v52, v53, v54
v_max_u32 v46, v46, v55
v_cmp_eq_u32 s[18:19], -1, v46
L_ck_52:
s_cmp_eq_u64 s[20:21], 0
s_cbranch_scc1 L_ck_53
v_min_u32 v56, v56, v72
v_min_u32 v57, v57, v73
v_min_u32 v58, v58, v74
v_min_u32 v59, v59, v75
v_max3_u32 v46, v56, v57, v58
v_max_u32 v46, v46, v59
v_cmp_eq_u32 s[20:21], -1, v46
L_ck_53:
s_cmp_eq_u64 s[22:23], 0
s_cbranch_scc1 L_ck_54
v_min_u32 v60, v60, v76
v_min_u32 v61, v61, v77
v_min_u32 v62, v62, v78
v_min_u32 v63, v63, v79
v_max3_u32 v46, v60, v61, v62
v_max_u32 v46, v46, v63
v_cmp_eq_u32 s[22:23], -1, v46
L_ck_54:
s_or_b64 s[28:29], s[16:17], s[18:19]
s_or_b64 s[30:31], s[20:21], s[22:23]
s_or_b64 s[28:29], s[28:29], s[30:31]
s_cbranch_scc0 R_done
s_or_b64 exec, s[16:17], 1
buffer_load_dwordx4 v[64:67], v44, s[64:67], s24 offen sc1
s_or_b64 exec, s[18:19], 1
buffer_load_dwordx4 v[68:71], v44, s[64:67], s25 offen sc1
s_or_b64 exec, s[20:21], 1
buffer_load_dwordx4 v[72:75], v44, s[64:67], s26 offen sc1
s_or_b64 exec, s[22:23], 1
buffer_load_dwordx4 v[76:79], v44, s[64:67], s27 offen sc1
s_mov_b64 exec, -1
s_waitcnt vmcnt(4)
s_cmp_eq_u64 s[16:17], 0
s_cbranch_scc1 L_ck_55
v_min_u32 v48, v48, v80
v_min_u32 v49, v49, v81
v_min_u32 v50, v50, v82
v_min_u32 v51, v51, v83
v_max3_u32 v46, v48, v49, v50
v_max_u32 v46, v46, v51
v_cmp_eq_u32 s[16:17], -1, v46
L_ck_55:
s_cmp_eq_u64 s[18:19], 0
s_cbranch_scc1 L_ck_56
v_min_u32 v52, v52, v84
v_min_u32 v53, v53, v85
v_min_u32 v54, v54, v86
v_min_u32 v55, v55, v87
v_max3_u32 v46, v52, v53, v54
v_max_u32 v46, v46, v55
v_cmp_eq_u32 s[18:19], -1, v46
L_ck_56:
s_cmp_eq_u64 s[20:21], 0
s_cbranch_scc1 L_ck_57
v_min_u32 v56, v56, v88
v_min_u32 v57, v57, v89
v_min_u32 v58, v58, v90
v_min_u32 v59, v59, v91
v_max3_u32 v46, v56, v57, v58
v_max_u32 v46, v46, v59
v_cmp_eq_u32 s[20:21], -1, v46
L_ck_57:
s_cmp_eq_u64 s[22:23], 0
s_cbranch_scc1 L_ck_58
v_min_u32 v60, v60, v92
v_min_u32 v61, v61, v93
v_min_u32 v62, v62, v94
v_min_u32 v63, v63, v95
v_max3_u32 v46, v60, v61, v62
v_max_u32 v46, v46, v63
v_cmp_eq_u32 s[22:23], -1, v46
L_ck_58:
s_or_b64 s[28:29], s[16:17], s[18:19]
s_or_b64 s[30:31], s[20:21], s[22:23]
s_or_b64 s[28:29], s[28:29], s[30:31]
s_cbranch_scc0 R_done
s_or_b64 exec, s[16:17], 1
buffer_load_dwordx4 v[80:83], v44, s[64:67], s24 offen sc1
s_or_b64 exec, s[18:19], 1
buffer_load_dwordx4 v[84:87], v44, s[64:67], s25 offen sc1
s_or_b64 exec, s[20:21], 1
buffer_load_dwordx4 v[88:91], v44, s[64:67], s26 offen sc1
s_or_b64 exec, s[22:23], 1
buffer_load_dwordx4 v[92:95], v44, s[64:67], s27 offen sc1
s_mov_b64 exec, -1
s_sub_u32 s7, s7, 1
s_cmp_gt_i32 s7, 0
s_cbranch_scc1 R_loop
R_done:
v_mfma_f32_16x16x32_bf16 v[12:15], v[20:23], v[48:51], 0
v_mfma_f32_16x16x32_bf16 v[12:15], v[20:23], v[52:55], v[12:15]
v_mfma_f32_16x16x32_bf16 v[12:15], v[20:23], v[56:59], v[12:15]
v_mfma_f32_16x16x32_bf16 v[12:15], v[20:23], v[60:63], v[12:15]
s_nop 7
v_add_f32_dpp v16, v12, v12 row_ror:8 row_mask:0xf bank_mask:0x3
v_add_f32_dpp v17, v13, v13 row_ror:8 row_mask:0xf bank_mask:0x3
v_add_f32_dpp v16, v14, v14 row_ror:8 row_mask:0xf bank_mask:0xc
v_add_f32_dpp v17, v15, v15 row_ror:8 row_mask:0xf bank_mask:0xc
s_nop 0
v_add_f32_dpp v46, v16, v16 row_shl:4 row_mask:0xf bank_mask:0x5
v_add_f32_dpp v46, v17, v17 row_shr:4 row_mask:0xf bank_mask:0xa
s_mov_b64 exec, 0xffffffff
v_cvt_pk_bf16_f32 v46, v46, v46
buffer_store_short v46, v45, s[72:75], s83 offen
s_mov_b64 exec, -1
s_cmp_lg_u32 s3, 0
s_cbranch_scc1 B_fin
ds_write_b32 v11, v11
s_waitcnt lgkmcnt(0)
B_fin:
B_end:
s_endpgm
H_start:
s_lshl_b32 s6, s8, 6
s_add_u32 s6, s6, s4
s_lshl_b32 s6, s6, 20
s_add_u32 s56, s20, s6
s_addc_u32 s57, s21, 0
s_mov_b32 s58, 34603008
s_mov_b32 s59, 0x20000
v_lshlrev_b32 v16, 7, v1
v_and_b32 v17, 4095, v16
v_add_u32 v16, 4096, v16
v_lshrrev_b32 v21, 5, v1
v_mul_u32_u24 v21, 20480, v21
v_add_u32 v17, v17, v21
s_and_b32 s6, s9, 56
v_and_b32 v19, 7, v1
v_add_u32 v19, s6, v19
v_mul_u32_u24 v19, 16, v19
v_add_u32 v19, 393216, v19
s_lshr_b32 s7, s4, 2
s_mul_i32 s7, s7, 4224
v_add_u32 v19, s7, v19
s_mov_b32 s16, 43
s_mov_b32 s17, 43
s_mov_b32 s18, 43
s_mov_b32 s31, 400000
buffer_load_dwordx3 v[12:14], v19, s[64:67], 0 offen sc1
s_waitcnt vmcnt(0)
H_loop:
v_med3_i32 v12, v12, -1, 31
v_med3_i32 v13, v13, -1, 31
v_med3_i32 v14, v14, -1, 31
v_add3_u32 v20, v12, v13, v14
s_nop 1
v_add_u32_dpp v20, v20, v20 row_ror:4 row_mask:0xf bank_mask:0xf
s_nop 1
v_add_u32_dpp v20, v20, v20 row_ror:2 row_mask:0xf bank_mask:0xf
s_nop 1
v_add_u32_dpp v20, v20, v20 row_ror:1 row_mask:0xf bank_mask:0xf
v_lshlrev_b32 v20, 3, v20
s_nop 0
v_readfirstlane_b32 s28, v20
v_readlane_b32 s20, v12, s9
v_readlane_b32 s21, v13, s9
v_readlane_b32 s22, v14, s9
buffer_load_dwordx3 v[12:14], v19, s[64:67], 0 offen sc1
s_mul_i32 s6, s20, 192
s_sub_i32 s24, s28, s6
s_mul_i32 s6, s16, 24
s_add_i32 s24, s24, s6
s_add_i32 s6, s16, -15
s_cmp_ge_i32 s6, s20
s_cselect_b32 s24, s24, -1048576
s_mul_i32 s6, s21, 192
s_sub_i32 s25, s28, s6
s_mul_i32 s6, s17, 24
s_add_i32 s25, s25, s6
s_add_i32 s6, s17, -15
s_cmp_ge_i32 s6, s21
s_cselect_b32 s25, s25, -1048576
s_mul_i32 s6, s22, 192
s_sub_i32 s26, s28, s6
s_mul_i32 s6, s18, 24
s_add_i32 s26, s26, s6
s_add_i32 s6, s18, -15
s_cmp_ge_i32 s6, s22
s_cselect_b32 s26, s26, -1048576
s_cmp_ge_i32 s24, s25
s_cselect_b32 s29, 0, 1
s_max_i32 s30, s24, s25
s_cmp_ge_i32 s30, s26
s_cselect_b32 s29, s29, 2
s_max_i32 s30, s30, s26
s_cmp_eq_i32 s30, -1048576
s_cbranch_scc1 H_end
s_sub_u32 s31, s31, 1
s_cmp_eq_u32 s31, 0
s_cbranch_scc1 H_end
s_cmp_lt_i32 s30, 1416
s_cbranch_scc1 H_idle
s_cmp_eq_u32 s29, 0
s_cselect_b32 s6, s16, s6
s_subb_u32 s16, s16, 0
s_cmp_eq_u32 s29, 1
s_cselect_b32 s6, s17, s6
s_subb_u32 s17, s17, 0
s_cmp_eq_u32 s29, 2
s_cselect_b32 s6, s18, s6
s_subb_u32 s18, s18, 0
s_mul_i32 s6, s6, 24576
s_sub_u32 s6, s6, 32768
s_cmp_eq_u32 s29, 2
s_cselect_b32 s7, 33554432, 0
s_add_u32 s6, s6, s7
s_cmp_eq_u32 s29, 1
s_cselect_b64 vcc, -1, 0
s_cselect_b32 s7, 25, 13
s_lshl_b32 s7, 1, s7
s_add_u32 s7, s7, s6
v_cndmask_b32 v18, v16, v17, vcc
buffer_load_dword v22, v18, s[56:59], s6 offen
buffer_load_dword v23, v18, s[56:59], s7 offen
s_waitcnt vmcnt(2)
s_branch H_loop
H_idle:
ds_read_b32 v21, v11
s_waitcnt vmcnt(0) lgkmcnt(0)
s_sleep 4
v_cmp_eq_u32 vcc, 0, v21
s_cbranch_vccnz H_loop
H_end:
s_branch B_end
.section .rodata,"a"
.p2align 6
.amdhsa_kernel concat_heads__mha_block_cached__compressed_kv_cla__decode_kernel
  .amdhsa_next_free_vgpr 512
  .amdhsa_next_free_sgpr 102
  .amdhsa_accum_offset 256
  .amdhsa_group_segment_fixed_size 0
  .amdhsa_kernarg_size 112
  .amdhsa_user_sgpr_count 2
  .amdhsa_user_sgpr_kernarg_segment_ptr 1
  .amdhsa_system_sgpr_workgroup_id_x 1
.end_amdhsa_kernel
```

```asm
; @launch grid=(256,1,1) block=(256,1,1) lds=163840
.amdgcn_target "amdgcn-amd-amdhsa--gfx950"
.text
.globl concat_heads__mha_block_cached__compressed_kv_cla__decode_kernel
.p2align 8
.type concat_heads__mha_block_cached__compressed_kv_cla__decode_kernel,@function
concat_heads__mha_block_cached__compressed_kv_cla__decode_kernel:
s_cmp_ge_u32 s2, 256
s_cbranch_scc1 L_exit
s_load_dwordx16 s[16:31], s[0:1], 0
s_load_dwordx8 s[32:39], s[0:1], 64
s_load_dwordx4 s[40:43], s[0:1], 96
v_lshrrev_b32 v1, 6, v0
s_nop 0
v_readfirstlane_b32 s3, v1
s_and_b32 s6, s2, 7
s_bfe_u32 s7, s2, 0x20003
s_lshl_b32 s4, s6, 2
s_add_u32 s4, s4, s7
s_lshr_b32 s5, s2, 5
s_cmp_lt_u32 s5, 2
s_cbranch_scc1 B_role
A_role:
s_sub_u32 s8, s5, 2
s_cmp_ge_u32 s8, 3
s_cselect_b32 s9, 1, 0
s_cselect_b32 s6, 3, 0
s_sub_u32 s8, s8, s6
s_lshl_b32 s11, s8, 2
s_add_u32 s11, s11, s3
s_cmp_ge_u32 s11, 6
s_cselect_b32 s83, 1, 0
s_cselect_b32 s6, -1, 1
s_add_u32 s11, s11, s6
s_cmp_ge_u32 s11, 6
s_cselect_b32 s6, 6, 0
s_sub_u32 s11, s11, s6
s_lshl_b32 s10, s9, 1
s_add_u32 s10, s10, s83
v_and_b32 v1, 63, v0
v_lshlrev_b32 v2, 4, v1
s_sub_u32 s14, s11, 8
s_lshl_b32 s14, s14, 12
s_mov_b32 s13, s14
s_add_u32 s13, s13, 24576
s_min_u32 s12, s13, 2146435072
s_lshl_b32 s82, s10, 5
s_add_u32 s82, s82, s4
s_lshl_b32 s72, s82, 20
s_mov_b32 s54, 1048576
s_mov_b32 s55, 0x20000
s_waitcnt lgkmcnt(0)
s_add_u32 s52, s18, s72
s_addc_u32 s53, s19, 0
buffer_load_dwordx4 v[136:139], v2, s[52:55], s12 offen offset:0 nt
buffer_load_dwordx4 v[140:143], v2, s[52:55], s12 offen offset:1024 nt
buffer_load_dwordx4 v[144:147], v2, s[52:55], s12 offen offset:2048 nt
buffer_load_dwordx4 v[148:151], v2, s[52:55], s12 offen offset:3072 nt
s_add_u32 s13, s13, 24576
s_min_u32 s12, s13, 2146435072
buffer_load_dwordx4 v[152:155], v2, s[52:55], s12 offen offset:0 nt
buffer_load_dwordx4 v[156:159], v2, s[52:55], s12 offen offset:1024 nt
buffer_load_dwordx4 v[160:163], v2, s[52:55], s12 offen offset:2048 nt
buffer_load_dwordx4 v[164:167], v2, s[52:55], s12 offen offset:3072 nt
s_add_u32 s13, s13, 24576
s_min_u32 s12, s13, 2146435072
s_lshr_b32 s6, s2, 3
s_sub_u32 s6, s6, 8
s_lshl_b32 s6, s6, 2
s_add_u32 s6, s6, s3
s_mul_i32 s6, s6, 49152
s_and_b32 s7, s2, 7
s_lshl_b32 s7, s7, 10
s_add_u32 s75, s6, s7
s_mov_b32 s62, 4718592
s_mov_b32 s63, 0x20000
v_min_u32 v35, 47, v1
v_lshrrev_b32 v36, 3, v35
v_mul_u32_u24 v36, 7168, v36
v_lshl_add_u32 v36, v35, 7, v36
s_mov_b64 s[60:61], s[22:23]
buffer_load_dword v120, v36, s[60:63], s75 offen
s_mov_b32 s58, 1048576
s_mov_b32 s59, 0x20000
s_mul_i32 s6, s9, 2304
s_mul_i32 s7, s3, 288
s_add_u32 s73, s6, s7
s_sub_u32 s46, 4608, s73
s_mov_b32 s47, 0x20000
s_mul_i32 s6, s3, 1179648
s_lshl_b32 s7, s4, 8
s_add_u32 s74, s6, s7
s_sub_u32 s50, 4718592, s74
s_mov_b32 s51, 0x20000
v_lshrrev_b32 v5, 4, v1
v_and_b32 v6, 15, v1
v_mul_u32_u24 v3, 294912, v5
v_lshl_add_u32 v3, v6, 4, v3
v_mul_u32_u24 v4, 72, v5
v_lshrrev_b32 v6, 3, v6
v_mul_u32_u24 v6, 1152, v6
v_add_u32 v4, v4, v6
s_add_u32 s44, s16, s73
s_addc_u32 s45, s17, 0
buffer_load_dwordx4 v[40:43], v4, s[44:47], 0 offen offset:0
buffer_load_dwordx4 v[44:47], v4, s[44:47], 0 offen offset:16
buffer_load_dwordx4 v[48:51], v4, s[44:47], 0 offen offset:32
buffer_load_dwordx4 v[52:55], v4, s[44:47], 0 offen offset:48
buffer_load_dwordx2 v[56:57], v4, s[44:47], 0 offen offset:64
s_add_u32 s56, s20, s72
s_addc_u32 s57, s21, 0
s_add_u32 s48, s22, s74
s_addc_u32 s49, s23, 0
s_cmp_lg_u32 s8, 0
s_cbranch_scc1 L_nowq_1
s_waitcnt vmcnt(20)
s_mov_b32 s6, 0
buffer_load_dwordx4 a[96:99], v3, s[48:51], s6 offen
s_mov_b32 s6, 8192
buffer_load_dwordx4 a[100:103], v3, s[48:51], s6 offen
s_mov_b32 s6, 16384
buffer_load_dwordx4 a[104:107], v3, s[48:51], s6 offen
s_mov_b32 s6, 24576
buffer_load_dwordx4 a[108:111], v3, s[48:51], s6 offen
s_mov_b32 s6, 32768
buffer_load_dwordx4 a[112:115], v3, s[48:51], s6 offen
s_mov_b32 s6, 40960
buffer_load_dwordx4 a[116:119], v3, s[48:51], s6 offen
s_mov_b32 s6, 49152
buffer_load_dwordx4 a[120:123], v3, s[48:51], s6 offen
s_mov_b32 s6, 57344
buffer_load_dwordx4 a[124:127], v3, s[48:51], s6 offen
s_mov_b32 s6, 65536
buffer_load_dwordx4 a[128:131], v3, s[48:51], s6 offen
s_mov_b32 s6, 73728
buffer_load_dwordx4 a[132:135], v3, s[48:51], s6 offen
s_mov_b32 s6, 81920
buffer_load_dwordx4 a[136:139], v3, s[48:51], s6 offen
s_mov_b32 s6, 90112
buffer_load_dwordx4 a[140:143], v3, s[48:51], s6 offen
s_mov_b32 s6, 98304
buffer_load_dwordx4 a[144:147], v3, s[48:51], s6 offen
s_mov_b32 s6, 106496
buffer_load_dwordx4 a[148:151], v3, s[48:51], s6 offen
s_mov_b32 s6, 114688
buffer_load_dwordx4 a[152:155], v3, s[48:51], s6 offen
s_mov_b32 s6, 122880
buffer_load_dwordx4 a[156:159], v3, s[48:51], s6 offen
s_mov_b32 s6, 131072
buffer_load_dwordx4 a[160:163], v3, s[48:51], s6 offen
s_mov_b32 s6, 139264
buffer_load_dwordx4 a[164:167], v3, s[48:51], s6 offen
s_mov_b32 s6, 147456
buffer_load_dwordx4 a[168:171], v3, s[48:51], s6 offen
s_mov_b32 s6, 155648
buffer_load_dwordx4 a[172:175], v3, s[48:51], s6 offen
s_mov_b32 s6, 163840
buffer_load_dwordx4 a[176:179], v3, s[48:51], s6 offen
s_mov_b32 s6, 172032
buffer_load_dwordx4 a[180:183], v3, s[48:51], s6 offen
s_mov_b32 s6, 180224
buffer_load_dwordx4 a[184:187], v3, s[48:51], s6 offen
s_mov_b32 s6, 188416
buffer_load_dwordx4 a[188:191], v3, s[48:51], s6 offen
s_mov_b32 s6, 196608
buffer_load_dwordx4 a[192:195], v3, s[48:51], s6 offen
s_mov_b32 s6, 204800
buffer_load_dwordx4 a[196:199], v3, s[48:51], s6 offen
s_mov_b32 s6, 212992
buffer_load_dwordx4 a[200:203], v3, s[48:51], s6 offen
s_mov_b32 s6, 221184
buffer_load_dwordx4 a[204:207], v3, s[48:51], s6 offen
s_mov_b32 s6, 229376
buffer_load_dwordx4 a[208:211], v3, s[48:51], s6 offen
s_mov_b32 s6, 237568
buffer_load_dwordx4 a[212:215], v3, s[48:51], s6 offen
s_mov_b32 s6, 245760
buffer_load_dwordx4 a[216:219], v3, s[48:51], s6 offen
s_mov_b32 s6, 253952
buffer_load_dwordx4 a[220:223], v3, s[48:51], s6 offen
s_mov_b32 s6, 262144
buffer_load_dwordx4 a[224:227], v3, s[48:51], s6 offen
s_mov_b32 s6, 270336
buffer_load_dwordx4 a[228:231], v3, s[48:51], s6 offen
s_mov_b32 s6, 278528
buffer_load_dwordx4 a[232:235], v3, s[48:51], s6 offen
s_mov_b32 s6, 286720
buffer_load_dwordx4 a[236:239], v3, s[48:51], s6 offen
L_nowq_1:
s_waitcnt vmcnt(54)
buffer_load_dwordx4 v[168:171], v2, s[52:55], s12 offen offset:0 nt
buffer_load_dwordx4 v[172:175], v2, s[52:55], s12 offen offset:1024 nt
buffer_load_dwordx4 v[176:179], v2, s[52:55], s12 offen offset:2048 nt
buffer_load_dwordx4 v[180:183], v2, s[52:55], s12 offen offset:3072 nt
s_add_u32 s13, s13, 24576
s_min_u32 s12, s13, 2146435072
s_waitcnt vmcnt(54)
buffer_load_dwordx4 v[184:187], v2, s[52:55], s12 offen offset:0 nt
buffer_load_dwordx4 v[188:191], v2, s[52:55], s12 offen offset:1024 nt
buffer_load_dwordx4 v[192:195], v2, s[52:55], s12 offen offset:2048 nt
buffer_load_dwordx4 v[196:199], v2, s[52:55], s12 offen offset:3072 nt
s_add_u32 s13, s13, 24576
s_min_u32 s12, s13, 2146435072
s_waitcnt vmcnt(54)
buffer_load_dwordx4 v[200:203], v2, s[52:55], s12 offen offset:0 nt
buffer_load_dwordx4 v[204:207], v2, s[52:55], s12 offen offset:1024 nt
buffer_load_dwordx4 v[208:211], v2, s[52:55], s12 offen offset:2048 nt
buffer_load_dwordx4 v[212:215], v2, s[52:55], s12 offen offset:3072 nt
s_add_u32 s13, s13, 24576
s_min_u32 s12, s13, 2146435072
s_cmp_lg_u32 s8, 1
s_cbranch_scc1 L_nowq_2
s_waitcnt vmcnt(20)
s_mov_b32 s6, 0
buffer_load_dwordx4 a[96:99], v3, s[48:51], s6 offen
s_mov_b32 s6, 8192
buffer_load_dwordx4 a[100:103], v3, s[48:51], s6 offen
s_mov_b32 s6, 16384
buffer_load_dwordx4 a[104:107], v3, s[48:51], s6 offen
s_mov_b32 s6, 24576
buffer_load_dwordx4 a[108:111], v3, s[48:51], s6 offen
s_mov_b32 s6, 32768
buffer_load_dwordx4 a[112:115], v3, s[48:51], s6 offen
s_mov_b32 s6, 40960
buffer_load_dwordx4 a[116:119], v3, s[48:51], s6 offen
s_mov_b32 s6, 49152
buffer_load_dwordx4 a[120:123], v3, s[48:51], s6 offen
s_mov_b32 s6, 57344
buffer_load_dwordx4 a[124:127], v3, s[48:51], s6 offen
s_mov_b32 s6, 65536
buffer_load_dwordx4 a[128:131], v3, s[48:51], s6 offen
s_mov_b32 s6, 73728
buffer_load_dwordx4 a[132:135], v3, s[48:51], s6 offen
s_mov_b32 s6, 81920
buffer_load_dwordx4 a[136:139], v3, s[48:51], s6 offen
s_mov_b32 s6, 90112
buffer_load_dwordx4 a[140:143], v3, s[48:51], s6 offen
s_mov_b32 s6, 98304
buffer_load_dwordx4 a[144:147], v3, s[48:51], s6 offen
s_mov_b32 s6, 106496
buffer_load_dwordx4 a[148:151], v3, s[48:51], s6 offen
s_mov_b32 s6, 114688
buffer_load_dwordx4 a[152:155], v3, s[48:51], s6 offen
s_mov_b32 s6, 122880
buffer_load_dwordx4 a[156:159], v3, s[48:51], s6 offen
s_mov_b32 s6, 131072
buffer_load_dwordx4 a[160:163], v3, s[48:51], s6 offen
s_mov_b32 s6, 139264
buffer_load_dwordx4 a[164:167], v3, s[48:51], s6 offen
s_mov_b32 s6, 147456
buffer_load_dwordx4 a[168:171], v3, s[48:51], s6 offen
s_mov_b32 s6, 155648
buffer_load_dwordx4 a[172:175], v3, s[48:51], s6 offen
s_mov_b32 s6, 163840
buffer_load_dwordx4 a[176:179], v3, s[48:51], s6 offen
s_mov_b32 s6, 172032
buffer_load_dwordx4 a[180:183], v3, s[48:51], s6 offen
s_mov_b32 s6, 180224
buffer_load_dwordx4 a[184:187], v3, s[48:51], s6 offen
s_mov_b32 s6, 188416
buffer_load_dwordx4 a[188:191], v3, s[48:51], s6 offen
s_mov_b32 s6, 196608
buffer_load_dwordx4 a[192:195], v3, s[48:51], s6 offen
s_mov_b32 s6, 204800
buffer_load_dwordx4 a[196:199], v3, s[48:51], s6 offen
s_mov_b32 s6, 212992
buffer_load_dwordx4 a[200:203], v3, s[48:51], s6 offen
s_mov_b32 s6, 221184
buffer_load_dwordx4 a[204:207], v3, s[48:51], s6 offen
s_mov_b32 s6, 229376
buffer_load_dwordx4 a[208:211], v3, s[48:51], s6 offen
s_mov_b32 s6, 237568
buffer_load_dwordx4 a[212:215], v3, s[48:51], s6 offen
s_mov_b32 s6, 245760
buffer_load_dwordx4 a[216:219], v3, s[48:51], s6 offen
s_mov_b32 s6, 253952
buffer_load_dwordx4 a[220:223], v3, s[48:51], s6 offen
s_mov_b32 s6, 262144
buffer_load_dwordx4 a[224:227], v3, s[48:51], s6 offen
s_mov_b32 s6, 270336
buffer_load_dwordx4 a[228:231], v3, s[48:51], s6 offen
s_mov_b32 s6, 278528
buffer_load_dwordx4 a[232:235], v3, s[48:51], s6 offen
s_mov_b32 s6, 286720
buffer_load_dwordx4 a[236:239], v3, s[48:51], s6 offen
L_nowq_2:
s_waitcnt vmcnt(54)
buffer_load_dwordx4 v[216:219], v2, s[52:55], s12 offen offset:0 nt
buffer_load_dwordx4 v[220:223], v2, s[52:55], s12 offen offset:1024 nt
buffer_load_dwordx4 v[224:227], v2, s[52:55], s12 offen offset:2048 nt
buffer_load_dwordx4 v[228:231], v2, s[52:55], s12 offen offset:3072 nt
s_add_u32 s13, s13, 24576
s_min_u32 s12, s13, 2146435072
s_waitcnt vmcnt(54)
buffer_load_dwordx4 v[232:235], v2, s[52:55], s12 offen offset:0 nt
buffer_load_dwordx4 v[236:239], v2, s[52:55], s12 offen offset:1024 nt
buffer_load_dwordx4 v[240:243], v2, s[52:55], s12 offen offset:2048 nt
buffer_load_dwordx4 v[244:247], v2, s[52:55], s12 offen offset:3072 nt
s_add_u32 s13, s13, 24576
s_min_u32 s12, s13, 2146435072
s_waitcnt vmcnt(54)
s_add_u32 s34, s14, 24576
s_min_u32 s34, s34, 2146435072
buffer_load_dwordx4 a[0:3], v2, s[56:59], s34 offen offset:0 nt
buffer_load_dwordx4 a[4:7], v2, s[56:59], s34 offen offset:1024 nt
buffer_load_dwordx4 a[8:11], v2, s[56:59], s34 offen offset:2048 nt
buffer_load_dwordx4 a[12:15], v2, s[56:59], s34 offen offset:3072 nt
s_cmp_lg_u32 s8, 2
s_cbranch_scc1 L_nowq_3
s_waitcnt vmcnt(20)
s_mov_b32 s6, 0
buffer_load_dwordx4 a[96:99], v3, s[48:51], s6 offen
s_mov_b32 s6, 8192
buffer_load_dwordx4 a[100:103], v3, s[48:51], s6 offen
s_mov_b32 s6, 16384
buffer_load_dwordx4 a[104:107], v3, s[48:51], s6 offen
s_mov_b32 s6, 24576
buffer_load_dwordx4 a[108:111], v3, s[48:51], s6 offen
s_mov_b32 s6, 32768
buffer_load_dwordx4 a[112:115], v3, s[48:51], s6 offen
s_mov_b32 s6, 40960
buffer_load_dwordx4 a[116:119], v3, s[48:51], s6 offen
s_mov_b32 s6, 49152
buffer_load_dwordx4 a[120:123], v3, s[48:51], s6 offen
s_mov_b32 s6, 57344
buffer_load_dwordx4 a[124:127], v3, s[48:51], s6 offen
s_mov_b32 s6, 65536
buffer_load_dwordx4 a[128:131], v3, s[48:51], s6 offen
s_mov_b32 s6, 73728
buffer_load_dwordx4 a[132:135], v3, s[48:51], s6 offen
s_mov_b32 s6, 81920
buffer_load_dwordx4 a[136:139], v3, s[48:51], s6 offen
s_mov_b32 s6, 90112
buffer_load_dwordx4 a[140:143], v3, s[48:51], s6 offen
s_mov_b32 s6, 98304
buffer_load_dwordx4 a[144:147], v3, s[48:51], s6 offen
s_mov_b32 s6, 106496
buffer_load_dwordx4 a[148:151], v3, s[48:51], s6 offen
s_mov_b32 s6, 114688
buffer_load_dwordx4 a[152:155], v3, s[48:51], s6 offen
s_mov_b32 s6, 122880
buffer_load_dwordx4 a[156:159], v3, s[48:51], s6 offen
s_mov_b32 s6, 131072
buffer_load_dwordx4 a[160:163], v3, s[48:51], s6 offen
s_mov_b32 s6, 139264
buffer_load_dwordx4 a[164:167], v3, s[48:51], s6 offen
s_mov_b32 s6, 147456
buffer_load_dwordx4 a[168:171], v3, s[48:51], s6 offen
s_mov_b32 s6, 155648
buffer_load_dwordx4 a[172:175], v3, s[48:51], s6 offen
s_mov_b32 s6, 163840
buffer_load_dwordx4 a[176:179], v3, s[48:51], s6 offen
s_mov_b32 s6, 172032
buffer_load_dwordx4 a[180:183], v3, s[48:51], s6 offen
s_mov_b32 s6, 180224
buffer_load_dwordx4 a[184:187], v3, s[48:51], s6 offen
s_mov_b32 s6, 188416
buffer_load_dwordx4 a[188:191], v3, s[48:51], s6 offen
s_mov_b32 s6, 196608
buffer_load_dwordx4 a[192:195], v3, s[48:51], s6 offen
s_mov_b32 s6, 204800
buffer_load_dwordx4 a[196:199], v3, s[48:51], s6 offen
s_mov_b32 s6, 212992
buffer_load_dwordx4 a[200:203], v3, s[48:51], s6 offen
s_mov_b32 s6, 221184
buffer_load_dwordx4 a[204:207], v3, s[48:51], s6 offen
s_mov_b32 s6, 229376
buffer_load_dwordx4 a[208:211], v3, s[48:51], s6 offen
s_mov_b32 s6, 237568
buffer_load_dwordx4 a[212:215], v3, s[48:51], s6 offen
s_mov_b32 s6, 245760
buffer_load_dwordx4 a[216:219], v3, s[48:51], s6 offen
s_mov_b32 s6, 253952
buffer_load_dwordx4 a[220:223], v3, s[48:51], s6 offen
s_mov_b32 s6, 262144
buffer_load_dwordx4 a[224:227], v3, s[48:51], s6 offen
s_mov_b32 s6, 270336
buffer_load_dwordx4 a[228:231], v3, s[48:51], s6 offen
s_mov_b32 s6, 278528
buffer_load_dwordx4 a[232:235], v3, s[48:51], s6 offen
s_mov_b32 s6, 286720
buffer_load_dwordx4 a[236:239], v3, s[48:51], s6 offen
L_nowq_3:
s_mov_b32 s64, s42
s_mov_b32 s65, s43
s_mov_b32 s66, 16777216
s_mov_b32 s67, 0x20000
s_mov_b32 s68, s40
s_mov_b32 s69, s41
s_mov_b32 s70, 256
s_mov_b32 s71, 0x20000
s_mul_i32 s6, s4, 147456
s_add_u32 s60, s24, s6
s_addc_u32 s61, s25, 0
s_mov_b32 s62, 147456
s_mov_b32 s63, 0x20000
v_and_b32 v5, 1, v1
v_lshlrev_b32 v5, 4, v5
v_mov_b32 v6, 0xffff
v_lshlrev_b32 v5, v5, v6
v_bfe_u32 v6, v1, 1, 2
v_cmp_eq_u32 vcc, 0, v6
s_nop 1
v_cndmask_b32 v8, 0, v5, vcc
v_cmp_eq_u32 vcc, 1, v6
s_nop 1
v_cndmask_b32 v9, 0, v5, vcc
v_cmp_eq_u32 vcc, 2, v6
s_nop 1
v_cndmask_b32 v10, 0, v5, vcc
v_cmp_eq_u32 vcc, 3, v6
s_nop 1
v_cndmask_b32 v11, 0, v5, vcc
v_mov_b32 v5, 0x0c0c0c0c
s_mov_b32 s6, 0x01000100
s_mov_b32 s7, 0x03020302
v_bfi_b32 v12, v8, s6, v5
v_bfi_b32 v13, v9, s6, v5
v_bfi_b32 v14, v10, s6, v5
v_bfi_b32 v15, v11, s6, v5
v_bfi_b32 v16, v8, s7, v5
v_bfi_b32 v17, v9, s7, v5
v_bfi_b32 v18, v10, s7, v5
v_bfi_b32 v19, v11, s7, v5
v_mov_b32 v7, 0x3e0293ee
v_mov_b32 v86, 0xff800000
v_lshrrev_b32 v5, 4, v1
v_lshlrev_b32 v5, 3, v5
v_bfe_u32 v6, v1, 2, 2
v_add_u32 v5, v5, v6
v_mul_u32_u24 v5, 1152, v5
s_mul_i32 s6, s3, 288
v_add_u32 v5, s6, v5
v_and_b32 v6, 3, v1
v_lshl_add_u32 v88, v6, 5, v5
v_lshl_add_u32 v89, v6, 3, v5
v_add_u32 v89, 256, v89
v_bfe_u32 v6, v1, 3, 1
v_mul_u32_u24 v6, 2176, v6
v_sub_u32 v88, v88, v6
v_lshrrev_b32 v6, 4, v1
v_mul_u32_u24 v6, 4608, v6
v_sub_u32 v88, v88, v6
v_add_u32 v90, 73728, v88
v_add_u32 v91, 73728, v89
s_mul_i32 s82, s82, 64
s_add_u32 s82, s82, 327680
s_mov_b64 s[72:73], 0
s_cmp_ge_u32 s11, 2
s_cselect_b32 s74, 0x22222222, 0
s_mov_b32 s75, s74
s_mov_b32 s76, 0x44444444
s_mov_b32 s77, s76
s_mov_b32 s78, 0x88888888
s_mov_b32 s79, s78
v_bfe_u32 v5, v1, 4, 1
s_lshl_b32 s6, s9, 7
s_lshl_b32 s7, s4, 1
s_add_u32 s6, s6, s7
s_add_u32 s6, s6, s8
v_mul_u32_u24 v6, 63, v5
v_add_u32 v6, s6, v6
v_mul_u32_u24 v92, 1152, v6
v_add_u32 v92, 4194304, v92
v_sub_u32 v6, s8, v5
v_cmp_lt_u32 vcc, 1, v6
v_mov_b32 v6, 2146435072
s_nop 0
v_cndmask_b32 v92, v92, v6, vcc
v_and_b32 v35, 15, v1
v_lshl_add_u32 v92, v35, 4, v92
s_lshl_b32 s6, s3, 5
v_add_u32 v93, s6, v92
s_lshl_b32 s6, s3, 8
v_add_u32 v92, s6, v92
s_lshl_b32 s6, s8, 2
s_add_u32 s6, s6, 0
s_cmp_ge_u32 s6, 6
s_cselect_b32 s6, 1, 0
v_cmp_eq_u32 vcc, s6, v5
s_nop 1
v_cndmask_b32 v106, 0, 1.0, vcc
s_lshl_b32 s6, s8, 2
s_add_u32 s6, s6, 1
s_cmp_ge_u32 s6, 6
s_cselect_b32 s6, 1, 0
v_cmp_eq_u32 vcc, s6, v5
s_nop 1
v_cndmask_b32 v107, 0, 1.0, vcc
s_lshl_b32 s6, s8, 2
s_add_u32 s6, s6, 2
s_cmp_ge_u32 s6, 6
s_cselect_b32 s6, 1, 0
v_cmp_eq_u32 vcc, s6, v5
s_nop 1
v_cndmask_b32 v108, 0, 1.0, vcc
s_lshl_b32 s6, s8, 2
s_add_u32 s6, s6, 3
s_cmp_ge_u32 s6, 6
s_cselect_b32 s6, 1, 0
v_cmp_eq_u32 vcc, s6, v5
s_nop 1
v_cndmask_b32 v109, 0, 1.0, vcc
v_bfe_i32 v35, v1, 3, 1
v_and_b32 v35, 0xaaaaaaaa, v35
v_or_b32 v105, 0x44444444, v35
v_and_b32 v35, 15, v1
v_lshlrev_b32 v35, 4, v35
v_lshl_add_u32 v94, v5, 3, v35
s_lshl_b32 s6, s3, 8
s_add_u32 s6, s6, 151552
v_add_u32 v94, s6, v94
v_and_b32 v35, 3, v1
v_lshlrev_b32 v35, 8, v35
v_lshrrev_b32 v36, 4, v1
v_lshl_add_u32 v95, v36, 4, v35
v_add_u32 v95, 151552, v95
s_mul_i32 s15, s3, 36864
s_mov_b32 s80, 0x0
s_mov_b32 s81, 0
s_lshl_b32 s6, s4, 1
s_add_u32 s6, s6, s9
s_mul_i32 s6, s6, 4
s_add_u32 s6, s6, s8
s_lshl_b32 s6, s6, 2
s_add_u32 s6, s6, 393216
s_lshr_b32 s7, s4, 2
s_mul_i32 s7, s7, 4224
s_add_u32 s6, s6, s7
v_mov_b32 v118, 2146435072
v_mov_b32 v117, s6
v_cmp_eq_u32 vcc, 0, v0
s_nop 1
v_cndmask_b32 v118, v118, v117, vcc
v_mov_b32 v117, 3
v_and_b32 v35, 15, v1
v_lshlrev_b32 v35, 5, v35
v_lshl_add_u32 v36, v5, 4, v35
v_lshrrev_b32 v6, 5, v1
v_lshl_add_u32 v36, v6, 9, v36
s_lshl_b32 s6, s3, 10
s_add_u32 s6, s6, 147456
v_add_u32 v36, s6, v36
s_lshl_b32 s6, s83, 9
s_add_u32 s6, s6, 147456
v_add_u32 v35, s6, v35
s_waitcnt vmcnt(35)
v_perm_b32 v60, v40, v40, v12
v_perm_b32 v61, v40, v40, v13
v_perm_b32 v62, v40, v40, v14
v_perm_b32 v63, v40, v40, v15
s_nop 1
v_mfma_f32_16x16x32_bf16 v[20:23], v[60:63], a[96:99], 0
s_add_u32 s34, s14, 49152
s_min_u32 s34, s34, 2146435072
buffer_load_dwordx4 a[16:19], v2, s[56:59], s34 offen offset:0 nt
s_waitcnt vmcnt(35)
v_perm_b32 v64, v40, v40, v16
v_perm_b32 v65, v40, v40, v17
v_perm_b32 v66, v40, v40, v18
v_perm_b32 v67, v40, v40, v19
s_nop 1
v_mfma_f32_16x16x32_bf16 v[20:23], v[64:67], a[100:103], v[20:23]
buffer_load_dwordx4 a[20:23], v2, s[56:59], s34 offen offset:1024 nt
s_waitcnt vmcnt(35)
v_perm_b32 v68, v41, v41, v12
v_perm_b32 v69, v41, v41, v13
v_perm_b32 v70, v41, v41, v14
v_perm_b32 v71, v41, v41, v15
s_nop 1
v_mfma_f32_16x16x32_bf16 v[20:23], v[68:71], a[104:107], v[20:23]
buffer_load_dwordx4 a[24:27], v2, s[56:59], s34 offen offset:2048 nt
s_waitcnt vmcnt(35)
v_perm_b32 v72, v41, v41, v16
v_perm_b32 v73, v41, v41, v17
v_perm_b32 v74, v41, v41, v18
v_perm_b32 v75, v41, v41, v19
s_nop 1
v_mfma_f32_16x16x32_bf16 v[20:23], v[72:75], a[108:111], v[20:23]
buffer_load_dwordx4 a[28:31], v2, s[56:59], s34 offen offset:3072 nt
s_waitcnt vmcnt(35)
v_perm_b32 v60, v42, v42, v12
v_perm_b32 v61, v42, v42, v13
v_perm_b32 v62, v42, v42, v14
v_perm_b32 v63, v42, v42, v15
s_nop 1
v_mfma_f32_16x16x32_bf16 v[20:23], v[60:63], a[112:115], v[20:23]
s_add_u32 s34, s14, 73728
s_min_u32 s34, s34, 2146435072
buffer_load_dwordx4 a[32:35], v2, s[56:59], s34 offen offset:0 nt
s_waitcnt vmcnt(35)
v_perm_b32 v64, v42, v42, v16
v_perm_b32 v65, v42, v42, v17
v_perm_b32 v66, v42, v42, v18
v_perm_b32 v67, v42, v42, v19
s_nop 1
v_mfma_f32_16x16x32_bf16 v[20:23], v[64:67], a[116:119], v[20:23]
buffer_load_dwordx4 a[36:39], v2, s[56:59], s34 offen offset:1024 nt
s_waitcnt vmcnt(35)
v_perm_b32 v68, v43, v43, v12
v_perm_b32 v69, v43, v43, v13
v_perm_b32 v70, v43, v43, v14
v_perm_b32 v71, v43, v43, v15
s_nop 1
v_mfma_f32_16x16x32_bf16 v[20:23], v[68:71], a[120:123], v[20:23]
buffer_load_dwordx4 a[40:43], v2, s[56:59], s34 offen offset:2048 nt
s_waitcnt vmcnt(35)
v_perm_b32 v72, v43, v43, v16
v_perm_b32 v73, v43, v43, v17
v_perm_b32 v74, v43, v43, v18
v_perm_b32 v75, v43, v43, v19
s_nop 1
v_mfma_f32_16x16x32_bf16 v[20:23], v[72:75], a[124:127], v[20:23]
buffer_load_dwordx4 a[44:47], v2, s[56:59], s34 offen offset:3072 nt
s_waitcnt vmcnt(35)
v_perm_b32 v60, v44, v44, v12
v_perm_b32 v61, v44, v44, v13
v_perm_b32 v62, v44, v44, v14
v_perm_b32 v63, v44, v44, v15
s_nop 1
v_mfma_f32_16x16x32_bf16 v[20:23], v[60:63], a[128:131], v[20:23]
s_add_u32 s34, s14, 98304
s_min_u32 s34, s34, 2146435072
buffer_load_dwordx4 a[48:51], v2, s[56:59], s34 offen offset:0 nt
s_waitcnt vmcnt(35)
v_perm_b32 v64, v44, v44, v16
v_perm_b32 v65, v44, v44, v17
v_perm_b32 v66, v44, v44, v18
v_perm_b32 v67, v44, v44, v19
s_nop 1
v_mfma_f32_16x16x32_bf16 v[20:23], v[64:67], a[132:135], v[20:23]
buffer_load_dwordx4 a[52:55], v2, s[56:59], s34 offen offset:1024 nt
s_waitcnt vmcnt(35)
v_perm_b32 v68, v45, v45, v12
v_perm_b32 v69, v45, v45, v13
v_perm_b32 v70, v45, v45, v14
v_perm_b32 v71, v45, v45, v15
s_nop 1
v_mfma_f32_16x16x32_bf16 v[20:23], v[68:71], a[136:139], v[20:23]
buffer_load_dwordx4 a[56:59], v2, s[56:59], s34 offen offset:2048 nt
s_waitcnt vmcnt(35)
v_perm_b32 v72, v45, v45, v16
v_perm_b32 v73, v45, v45, v17
v_perm_b32 v74, v45, v45, v18
v_perm_b32 v75, v45, v45, v19
s_nop 1
v_mfma_f32_16x16x32_bf16 v[20:23], v[72:75], a[140:143], v[20:23]
buffer_load_dwordx4 a[60:63], v2, s[56:59], s34 offen offset:3072 nt
s_waitcnt vmcnt(35)
v_perm_b32 v60, v46, v46, v12
v_perm_b32 v61, v46, v46, v13
v_perm_b32 v62, v46, v46, v14
v_perm_b32 v63, v46, v46, v15
s_nop 1
v_mfma_f32_16x16x32_bf16 v[20:23], v[60:63], a[144:147], v[20:23]
s_add_u32 s34, s14, 122880
s_min_u32 s34, s34, 2146435072
buffer_load_dwordx4 a[64:67], v2, s[56:59], s34 offen offset:0 nt
s_waitcnt vmcnt(35)
v_perm_b32 v64, v46, v46, v16
v_perm_b32 v65, v46, v46, v17
v_perm_b32 v66, v46, v46, v18
v_perm_b32 v67, v46, v46, v19
s_nop 1
v_mfma_f32_16x16x32_bf16 v[20:23], v[64:67], a[148:151], v[20:23]
buffer_load_dwordx4 a[68:71], v2, s[56:59], s34 offen offset:1024 nt
s_waitcnt vmcnt(35)
v_perm_b32 v68, v47, v47, v12
v_perm_b32 v69, v47, v47, v13
v_perm_b32 v70, v47, v47, v14
v_perm_b32 v71, v47, v47, v15
s_nop 1
v_mfma_f32_16x16x32_bf16 v[20:23], v[68:71], a[152:155], v[20:23]
buffer_load_dwordx4 a[72:75], v2, s[56:59], s34 offen offset:2048 nt
s_waitcnt vmcnt(35)
v_perm_b32 v72, v47, v47, v16
v_perm_b32 v73, v47, v47, v17
v_perm_b32 v74, v47, v47, v18
v_perm_b32 v75, v47, v47, v19
s_nop 1
v_mfma_f32_16x16x32_bf16 v[20:23], v[72:75], a[156:159], v[20:23]
buffer_load_dwordx4 a[76:79], v2, s[56:59], s34 offen offset:3072 nt
s_waitcnt vmcnt(35)
v_perm_b32 v60, v48, v48, v12
v_perm_b32 v61, v48, v48, v13
v_perm_b32 v62, v48, v48, v14
v_perm_b32 v63, v48, v48, v15
s_nop 1
v_mfma_f32_16x16x32_bf16 v[20:23], v[60:63], a[160:163], v[20:23]
s_add_u32 s34, s14, 147456
s_min_u32 s34, s34, 2146435072
buffer_load_dwordx4 a[80:83], v2, s[56:59], s34 offen offset:0 nt
s_waitcnt vmcnt(35)
v_perm_b32 v64, v48, v48, v16
v_perm_b32 v65, v48, v48, v17
v_perm_b32 v66, v48, v48, v18
v_perm_b32 v67, v48, v48, v19
s_nop 1
v_mfma_f32_16x16x32_bf16 v[20:23], v[64:67], a[164:167], v[20:23]
buffer_load_dwordx4 a[84:87], v2, s[56:59], s34 offen offset:1024 nt
s_waitcnt vmcnt(35)
v_perm_b32 v68, v49, v49, v12
v_perm_b32 v69, v49, v49, v13
v_perm_b32 v70, v49, v49, v14
v_perm_b32 v71, v49, v49, v15
s_nop 1
v_mfma_f32_16x16x32_bf16 v[20:23], v[68:71], a[168:171], v[20:23]
buffer_load_dwordx4 a[88:91], v2, s[56:59], s34 offen offset:2048 nt
s_waitcnt vmcnt(35)
v_perm_b32 v72, v49, v49, v16
v_perm_b32 v73, v49, v49, v17
v_perm_b32 v74, v49, v49, v18
v_perm_b32 v75, v49, v49, v19
s_nop 1
v_mfma_f32_16x16x32_bf16 v[20:23], v[72:75], a[172:175], v[20:23]
buffer_load_dwordx4 a[92:95], v2, s[56:59], s34 offen offset:3072 nt
s_waitcnt vmcnt(35)
v_perm_b32 v60, v50, v50, v12
v_perm_b32 v61, v50, v50, v13
v_perm_b32 v62, v50, v50, v14
v_perm_b32 v63, v50, v50, v15
s_nop 1
v_mfma_f32_16x16x32_bf16 v[20:23], v[60:63], a[176:179], v[20:23]
s_add_u32 s34, s14, 172032
s_min_u32 s34, s34, 2146435072
buffer_load_dwordx4 a[240:243], v2, s[56:59], s34 offen offset:0 nt
s_waitcnt vmcnt(35)
v_perm_b32 v64, v50, v50, v16
v_perm_b32 v65, v50, v50, v17
v_perm_b32 v66, v50, v50, v18
v_perm_b32 v67, v50, v50, v19
s_nop 1
v_mfma_f32_16x16x32_bf16 v[20:23], v[64:67], a[180:183], v[20:23]
buffer_load_dwordx4 a[244:247], v2, s[56:59], s34 offen offset:1024 nt
s_waitcnt vmcnt(35)
v_perm_b32 v68, v51, v51, v12
v_perm_b32 v69, v51, v51, v13
v_perm_b32 v70, v51, v51, v14
v_perm_b32 v71, v51, v51, v15
s_nop 1
v_mfma_f32_16x16x32_bf16 v[20:23], v[68:71], a[184:187], v[20:23]
buffer_load_dwordx4 a[248:251], v2, s[56:59], s34 offen offset:2048 nt
s_waitcnt vmcnt(35)
v_perm_b32 v72, v51, v51, v16
v_perm_b32 v73, v51, v51, v17
v_perm_b32 v74, v51, v51, v18
v_perm_b32 v75, v51, v51, v19
s_nop 1
v_mfma_f32_16x16x32_bf16 v[20:23], v[72:75], a[188:191], v[20:23]
buffer_load_dwordx4 a[252:255], v2, s[56:59], s34 offen offset:3072 nt
s_waitcnt vmcnt(35)
v_perm_b32 v60, v52, v52, v12
v_perm_b32 v61, v52, v52, v13
v_perm_b32 v62, v52, v52, v14
v_perm_b32 v63, v52, v52, v15
s_nop 1
v_mfma_f32_16x16x32_bf16 v[20:23], v[60:63], a[192:195], v[20:23]
s_waitcnt vmcnt(34)
v_perm_b32 v64, v52, v52, v16
v_perm_b32 v65, v52, v52, v17
v_perm_b32 v66, v52, v52, v18
v_perm_b32 v67, v52, v52, v19
s_nop 1
v_mfma_f32_16x16x32_bf16 v[20:23], v[64:67], a[196:199], v[20:23]
s_waitcnt vmcnt(33)
v_perm_b32 v68, v53, v53, v12
v_perm_b32 v69, v53, v53, v13
v_perm_b32 v70, v53, v53, v14
v_perm_b32 v71, v53, v53, v15
s_nop 1
v_mfma_f32_16x16x32_bf16 v[20:23], v[68:71], a[200:203], v[20:23]
s_waitcnt vmcnt(32)
v_perm_b32 v72, v53, v53, v16
v_perm_b32 v73, v53, v53, v17
v_perm_b32 v74, v53, v53, v18
v_perm_b32 v75, v53, v53, v19
s_nop 1
v_mfma_f32_16x16x32_bf16 v[20:23], v[72:75], a[204:207], v[20:23]
s_waitcnt vmcnt(31)
v_perm_b32 v60, v54, v54, v12
v_perm_b32 v61, v54, v54, v13
v_perm_b32 v62, v54, v54, v14
v_perm_b32 v63, v54, v54, v15
s_nop 1
v_mfma_f32_16x16x32_bf16 v[20:23], v[60:63], a[208:211], v[20:23]
s_waitcnt vmcnt(30)
v_perm_b32 v64, v54, v54, v16
v_perm_b32 v65, v54, v54, v17
v_perm_b32 v66, v54, v54, v18
v_perm_b32 v67, v54, v54, v19
s_nop 1
v_mfma_f32_16x16x32_bf16 v[20:23], v[64:67], a[212:215], v[20:23]
s_waitcnt vmcnt(29)
v_perm_b32 v68, v55, v55, v12
v_perm_b32 v69, v55, v55, v13
v_perm_b32 v70, v55, v55, v14
v_perm_b32 v71, v55, v55, v15
s_nop 1
v_mfma_f32_16x16x32_bf16 v[20:23], v[68:71], a[216:219], v[20:23]
s_waitcnt vmcnt(28)
v_perm_b32 v72, v55, v55, v16
v_perm_b32 v73, v55, v55, v17
v_perm_b32 v74, v55, v55, v18
v_perm_b32 v75, v55, v55, v19
s_nop 1
v_mfma_f32_16x16x32_bf16 v[20:23], v[72:75], a[220:223], v[20:23]
s_waitcnt vmcnt(27)
v_perm_b32 v60, v56, v56, v12
v_perm_b32 v61, v56, v56, v13
v_perm_b32 v62, v56, v56, v14
v_perm_b32 v63, v56, v56, v15
s_nop 1
v_mfma_f32_16x16x32_bf16 v[20:23], v[60:63], a[224:227], v[20:23]
s_waitcnt vmcnt(26)
v_perm_b32 v64, v56, v56, v16
v_perm_b32 v65, v56, v56, v17
v_perm_b32 v66, v56, v56, v18
v_perm_b32 v67, v56, v56, v19
s_nop 1
v_mfma_f32_16x16x32_bf16 v[20:23], v[64:67], a[228:231], v[20:23]
s_waitcnt vmcnt(25)
v_perm_b32 v68, v57, v57, v12
v_perm_b32 v69, v57, v57, v13
v_perm_b32 v70, v57, v57, v14
v_perm_b32 v71, v57, v57, v15
s_nop 1
v_mfma_f32_16x16x32_bf16 v[20:23], v[68:71], a[232:235], v[20:23]
s_waitcnt vmcnt(24)
v_perm_b32 v72, v57, v57, v16
v_perm_b32 v73, v57, v57, v17
v_perm_b32 v74, v57, v57, v18
v_perm_b32 v75, v57, v57, v19
s_nop 1
v_mfma_f32_16x16x32_bf16 v[20:23], v[72:75], a[236:239], v[20:23]
s_nop 7
ds_write_b128 v36, v[20:23]
s_waitcnt lgkmcnt(0)
s_barrier
ds_read_b128 v[40:43], v35 offset:0
ds_read_b128 v[44:47], v35 offset:16
ds_read_b128 v[48:51], v35 offset:1024
ds_read_b128 v[52:55], v35 offset:1040
ds_read_b128 v[56:59], v35 offset:2048
ds_read_b128 v[60:63], v35 offset:2064
ds_read_b128 v[64:67], v35 offset:3072
ds_read_b128 v[68:71], v35 offset:3088
v_mov_b32 v20, 0
v_mov_b32 v21, 0
v_mov_b32 v22, 0
v_mov_b32 v23, 0
s_waitcnt lgkmcnt(0)
v_add_f32 v40, v40, v48
v_add_f32 v56, v56, v64
v_add_f32 v41, v41, v49
v_add_f32 v57, v57, v65
v_add_f32 v42, v42, v50
v_add_f32 v58, v58, v66
v_add_f32 v43, v43, v51
v_add_f32 v59, v59, v67
v_add_f32 v44, v44, v52
v_add_f32 v60, v60, v68
v_add_f32 v45, v45, v53
v_add_f32 v61, v61, v69
v_add_f32 v46, v46, v54
v_add_f32 v62, v62, v70
v_add_f32 v47, v47, v55
v_add_f32 v63, v63, v71
v_add_f32 v40, v40, v56
v_add_f32 v41, v41, v57
v_add_f32 v42, v42, v58
v_add_f32 v43, v43, v59
v_add_f32 v44, v44, v60
v_add_f32 v45, v45, v61
v_add_f32 v46, v46, v62
v_add_f32 v47, v47, v63
v_cvt_pk_bf16_f32 v24, v40, v41
v_cvt_pk_bf16_f32 v25, v42, v43
v_cvt_pk_bf16_f32 v26, v44, v45
v_cvt_pk_bf16_f32 v27, v46, v47
s_add_u32 s14, s14, 196608
K_loop:
s_cmp_lg_u32 s81, 8
s_cbranch_scc1 L_c0_4
buffer_load_dword v96, off, s[68:71], 0 offset:0 sc1
L_c0_4:
s_waitcnt vmcnt(28)
v_dot2_f32_bf16 v28, v120, v24, 0
v_dot2_f32_bf16 v29, v124, v24, 0
v_dot2_f32_bf16 v30, v128, v24, 0
v_dot2_f32_bf16 v31, v132, v24, 0
v_dot2_f32_bf16 v28, v121, v25, v28
v_dot2_f32_bf16 v29, v125, v25, v29
v_dot2_f32_bf16 v30, v129, v25, v30
v_dot2_f32_bf16 v31, v133, v25, v31
v_dot2_f32_bf16 v28, v122, v26, v28
v_dot2_f32_bf16 v29, v126, v26, v29
v_dot2_f32_bf16 v30, v130, v26, v30
v_dot2_f32_bf16 v31, v134, v26, v31
v_dot2_f32_bf16 v28, v123, v27, v28
v_dot2_f32_bf16 v29, v127, v27, v29
v_dot2_f32_bf16 v30, v131, v27, v30
v_dot2_f32_bf16 v31, v135, v27, v31
buffer_load_dwordx4 v[120:123], v2, s[52:55], s12 offen offset:0 nt
buffer_load_dwordx4 v[124:127], v2, s[52:55], s12 offen offset:1024 nt
buffer_load_dwordx4 v[128:131], v2, s[52:55], s12 offen offset:2048 nt
buffer_load_dwordx4 v[132:135], v2, s[52:55], s12 offen offset:3072 nt
s_add_u32 s13, s13, 24576
s_min_u32 s12, s13, 2146435072
s_cmp_ge_u32 s80, 36
s_cbranch_scc1 L_nodma_5
s_mov_b32 m0, s15
s_nop 0
buffer_load_dwordx4 v2, s[60:63], s15 offen  lds
s_add_u32 s15, s15, 1024
L_nodma_5:
s_add_u32 s80, s80, 1
v_add_f32_dpp v32, v28, v28 row_ror:8 row_mask:0xf bank_mask:0x3
v_add_f32_dpp v33, v29, v29 row_ror:8 row_mask:0xf bank_mask:0x3
v_add_f32_dpp v32, v30, v30 row_ror:8 row_mask:0xf bank_mask:0xc
v_add_f32_dpp v33, v31, v31 row_ror:8 row_mask:0xf bank_mask:0xc
s_nop 0
v_add_f32_dpp v34, v32, v32 row_half_mirror row_mask:0xf bank_mask:0x5
v_add_f32_dpp v34, v33, v33 row_half_mirror row_mask:0xf bank_mask:0xa
s_nop 1
v_add_f32_dpp v34, v34, v34 quad_perm:[1,0,3,2] row_mask:0xf bank_mask:0xf
s_nop 1
v_add_f32_dpp v34, v34, v34 quad_perm:[2,3,0,1] row_mask:0xf bank_mask:0xf
v_cndmask_b32 v86, v86, v34, s[72:73]
s_waitcnt vmcnt(28)
v_dot2_f32_bf16 v28, v136, v24, 0
v_dot2_f32_bf16 v29, v140, v24, 0
v_dot2_f32_bf16 v30, v144, v24, 0
v_dot2_f32_bf16 v31, v148, v24, 0
v_dot2_f32_bf16 v28, v137, v25, v28
v_dot2_f32_bf16 v29, v141, v25, v29
v_dot2_f32_bf16 v30, v145, v25, v30
v_dot2_f32_bf16 v31, v149, v25, v31
v_dot2_f32_bf16 v28, v138, v26, v28
v_dot2_f32_bf16 v29, v142, v26, v29
v_dot2_f32_bf16 v30, v146, v26, v30
v_dot2_f32_bf16 v31, v150, v26, v31
v_dot2_f32_bf16 v28, v139, v27, v28
v_dot2_f32_bf16 v29, v143, v27, v29
v_dot2_f32_bf16 v30, v147, v27, v30
v_dot2_f32_bf16 v31, v151, v27, v31
buffer_load_dwordx4 v[136:139], v2, s[52:55], s12 offen offset:0 nt
buffer_load_dwordx4 v[140:143], v2, s[52:55], s12 offen offset:1024 nt
buffer_load_dwordx4 v[144:147], v2, s[52:55], s12 offen offset:2048 nt
buffer_load_dwordx4 v[148:151], v2, s[52:55], s12 offen offset:3072 nt
s_add_u32 s13, s13, 24576
s_min_u32 s12, s13, 2146435072
s_cmp_ge_u32 s80, 36
s_cbranch_scc1 L_nodma_6
s_mov_b32 m0, s15
s_nop 0
buffer_load_dwordx4 v2, s[60:63], s15 offen  lds
s_add_u32 s15, s15, 1024
L_nodma_6:
s_add_u32 s80, s80, 1
v_add_f32_dpp v32, v28, v28 row_ror:8 row_mask:0xf bank_mask:0x3
v_add_f32_dpp v33, v29, v29 row_ror:8 row_mask:0xf bank_mask:0x3
v_add_f32_dpp v32, v30, v30 row_ror:8 row_mask:0xf bank_mask:0xc
v_add_f32_dpp v33, v31, v31 row_ror:8 row_mask:0xf bank_mask:0xc
s_nop 0
v_add_f32_dpp v34, v32, v32 row_half_mirror row_mask:0xf bank_mask:0x5
v_add_f32_dpp v34, v33, v33 row_half_mirror row_mask:0xf bank_mask:0xa
s_nop 1
v_add_f32_dpp v34, v34, v34 quad_perm:[1,0,3,2] row_mask:0xf bank_mask:0xf
s_nop 1
v_add_f32_dpp v34, v34, v34 quad_perm:[2,3,0,1] row_mask:0xf bank_mask:0xf
v_cndmask_b32 v86, v86, v34, s[74:75]
s_waitcnt vmcnt(28)
v_dot2_f32_bf16 v28, v152, v24, 0
v_dot2_f32_bf16 v29, v156, v24, 0
v_dot2_f32_bf16 v30, v160, v24, 0
v_dot2_f32_bf16 v31, v164, v24, 0
v_dot2_f32_bf16 v28, v153, v25, v28
v_dot2_f32_bf16 v29, v157, v25, v29
v_dot2_f32_bf16 v30, v161, v25, v30
v_dot2_f32_bf16 v31, v165, v25, v31
v_dot2_f32_bf16 v28, v154, v26, v28
v_dot2_f32_bf16 v29, v158, v26, v29
v_dot2_f32_bf16 v30, v162, v26, v30
v_dot2_f32_bf16 v31, v166, v26, v31
v_dot2_f32_bf16 v28, v155, v27, v28
v_dot2_f32_bf16 v29, v159, v27, v29
v_dot2_f32_bf16 v30, v163, v27, v30
v_dot2_f32_bf16 v31, v167, v27, v31
buffer_load_dwordx4 v[152:155], v2, s[52:55], s12 offen offset:0 nt
buffer_load_dwordx4 v[156:159], v2, s[52:55], s12 offen offset:1024 nt
buffer_load_dwordx4 v[160:163], v2, s[52:55], s12 offen offset:2048 nt
buffer_load_dwordx4 v[164:167], v2, s[52:55], s12 offen offset:3072 nt
s_add_u32 s13, s13, 24576
s_min_u32 s12, s13, 2146435072
s_cmp_ge_u32 s80, 36
s_cbranch_scc1 L_nodma_7
s_mov_b32 m0, s15
s_nop 0
buffer_load_dwordx4 v2, s[60:63], s15 offen  lds
s_add_u32 s15, s15, 1024
L_nodma_7:
s_add_u32 s80, s80, 1
v_add_f32_dpp v32, v28, v28 row_ror:8 row_mask:0xf bank_mask:0x3
v_add_f32_dpp v33, v29, v29 row_ror:8 row_mask:0xf bank_mask:0x3
v_add_f32_dpp v32, v30, v30 row_ror:8 row_mask:0xf bank_mask:0xc
v_add_f32_dpp v33, v31, v31 row_ror:8 row_mask:0xf bank_mask:0xc
s_nop 0
v_add_f32_dpp v34, v32, v32 row_half_mirror row_mask:0xf bank_mask:0x5
v_add_f32_dpp v34, v33, v33 row_half_mirror row_mask:0xf bank_mask:0xa
s_nop 1
v_add_f32_dpp v34, v34, v34 quad_perm:[1,0,3,2] row_mask:0xf bank_mask:0xf
s_nop 1
v_add_f32_dpp v34, v34, v34 quad_perm:[2,3,0,1] row_mask:0xf bank_mask:0xf
v_cndmask_b32 v86, v86, v34, s[76:77]
s_waitcnt vmcnt(28)
v_dot2_f32_bf16 v28, v168, v24, 0
v_dot2_f32_bf16 v29, v172, v24, 0
v_dot2_f32_bf16 v30, v176, v24, 0
v_dot2_f32_bf16 v31, v180, v24, 0
v_dot2_f32_bf16 v28, v169, v25, v28
v_dot2_f32_bf16 v29, v173, v25, v29
v_dot2_f32_bf16 v30, v177, v25, v30
v_dot2_f32_bf16 v31, v181, v25, v31
v_dot2_f32_bf16 v28, v170, v26, v28
v_dot2_f32_bf16 v29, v174, v26, v29
v_dot2_f32_bf16 v30, v178, v26, v30
v_dot2_f32_bf16 v31, v182, v26, v31
v_dot2_f32_bf16 v28, v171, v27, v28
v_dot2_f32_bf16 v29, v175, v27, v29
v_dot2_f32_bf16 v30, v179, v27, v30
v_dot2_f32_bf16 v31, v183, v27, v31
buffer_load_dwordx4 v[168:171], v2, s[52:55], s12 offen offset:0 nt
buffer_load_dwordx4 v[172:175], v2, s[52:55], s12 offen offset:1024 nt
buffer_load_dwordx4 v[176:179], v2, s[52:55], s12 offen offset:2048 nt
buffer_load_dwordx4 v[180:183], v2, s[52:55], s12 offen offset:3072 nt
s_add_u32 s13, s13, 24576
s_min_u32 s12, s13, 2146435072
s_cmp_ge_u32 s80, 36
s_cbranch_scc1 L_nodma_8
s_mov_b32 m0, s15
s_nop 0
buffer_load_dwordx4 v2, s[60:63], s15 offen  lds
s_add_u32 s15, s15, 1024
L_nodma_8:
s_add_u32 s80, s80, 1
v_add_f32_dpp v32, v28, v28 row_ror:8 row_mask:0xf bank_mask:0x3
v_add_f32_dpp v33, v29, v29 row_ror:8 row_mask:0xf bank_mask:0x3
v_add_f32_dpp v32, v30, v30 row_ror:8 row_mask:0xf bank_mask:0xc
v_add_f32_dpp v33, v31, v31 row_ror:8 row_mask:0xf bank_mask:0xc
s_nop 0
v_add_f32_dpp v34, v32, v32 row_half_mirror row_mask:0xf bank_mask:0x5
v_add_f32_dpp v34, v33, v33 row_half_mirror row_mask:0xf bank_mask:0xa
s_nop 1
v_add_f32_dpp v34, v34, v34 quad_perm:[1,0,3,2] row_mask:0xf bank_mask:0xf
s_nop 1
v_add_f32_dpp v34, v34, v34 quad_perm:[2,3,0,1] row_mask:0xf bank_mask:0xf
v_cndmask_b32 v86, v86, v34, s[78:79]
s_add_u32 s81, s81, 1
s_cmp_eq_u32 s81, 11
s_cbranch_scc1 A_mid
v_mov_b32 v76, v77
v_mov_b32 v77, v78
v_mov_b32 v78, v79
v_mov_b32 v79, v80
v_mov_b32 v80, v81
v_mov_b32 v81, v82
v_mov_b32 v82, v83
v_mov_b32 v83, v84
v_mov_b32 v84, v85
v_mov_b32 v85, v86
s_lshr_b64 s[72:73], s[76:77], 2
s_lshr_b64 s[74:75], s[76:77], 1
s_cmp_eq_u32 s81, 9
s_cselect_b32 s52, s56, s52
s_cselect_b32 s53, s57, s53
s_cselect_b32 s13, s14, s13
s_min_u32 s12, s13, 2146435072
s_waitcnt vmcnt(28)
v_dot2_f32_bf16 v28, v184, v24, 0
v_dot2_f32_bf16 v29, v188, v24, 0
v_dot2_f32_bf16 v30, v192, v24, 0
v_dot2_f32_bf16 v31, v196, v24, 0
v_dot2_f32_bf16 v28, v185, v25, v28
v_dot2_f32_bf16 v29, v189, v25, v29
v_dot2_f32_bf16 v30, v193, v25, v30
v_dot2_f32_bf16 v31, v197, v25, v31
v_dot2_f32_bf16 v28, v186, v26, v28
v_dot2_f32_bf16 v29, v190, v26, v29
v_dot2_f32_bf16 v30, v194, v26, v30
v_dot2_f32_bf16 v31, v198, v26, v31
v_dot2_f32_bf16 v28, v187, v27, v28
v_dot2_f32_bf16 v29, v191, v27, v29
v_dot2_f32_bf16 v30, v195, v27, v30
v_dot2_f32_bf16 v31, v199, v27, v31
buffer_load_dwordx4 v[184:187], v2, s[52:55], s12 offen offset:0 nt
buffer_load_dwordx4 v[188:191], v2, s[52:55], s12 offen offset:1024 nt
buffer_load_dwordx4 v[192:195], v2, s[52:55], s12 offen offset:2048 nt
buffer_load_dwordx4 v[196:199], v2, s[52:55], s12 offen offset:3072 nt
s_add_u32 s13, s13, 24576
s_min_u32 s12, s13, 2146435072
s_cmp_ge_u32 s80, 36
s_cbranch_scc1 L_nodma_9
s_mov_b32 m0, s15
s_nop 0
buffer_load_dwordx4 v2, s[60:63], s15 offen  lds
s_add_u32 s15, s15, 1024
L_nodma_9:
s_add_u32 s80, s80, 1
v_add_f32_dpp v32, v28, v28 row_ror:8 row_mask:0xf bank_mask:0x3
v_add_f32_dpp v33, v29, v29 row_ror:8 row_mask:0xf bank_mask:0x3
v_add_f32_dpp v32, v30, v30 row_ror:8 row_mask:0xf bank_mask:0xc
v_add_f32_dpp v33, v31, v31 row_ror:8 row_mask:0xf bank_mask:0xc
s_nop 0
v_add_f32_dpp v34, v32, v32 row_half_mirror row_mask:0xf bank_mask:0x5
v_add_f32_dpp v34, v33, v33 row_half_mirror row_mask:0xf bank_mask:0xa
s_nop 1
v_add_f32_dpp v34, v34, v34 quad_perm:[1,0,3,2] row_mask:0xf bank_mask:0xf
s_nop 1
v_add_f32_dpp v34, v34, v34 quad_perm:[2,3,0,1] row_mask:0xf bank_mask:0xf
v_cndmask_b32 v86, v86, v34, s[72:73]
s_waitcnt vmcnt(28)
v_dot2_f32_bf16 v28, v200, v24, 0
v_dot2_f32_bf16 v29, v204, v24, 0
v_dot2_f32_bf16 v30, v208, v24, 0
v_dot2_f32_bf16 v31, v212, v24, 0
v_dot2_f32_bf16 v28, v201, v25, v28
v_dot2_f32_bf16 v29, v205, v25, v29
v_dot2_f32_bf16 v30, v209, v25, v30
v_dot2_f32_bf16 v31, v213, v25, v31
v_dot2_f32_bf16 v28, v202, v26, v28
v_dot2_f32_bf16 v29, v206, v26, v29
v_dot2_f32_bf16 v30, v210, v26, v30
v_dot2_f32_bf16 v31, v214, v26, v31
v_dot2_f32_bf16 v28, v203, v27, v28
v_dot2_f32_bf16 v29, v207, v27, v29
v_dot2_f32_bf16 v30, v211, v27, v30
v_dot2_f32_bf16 v31, v215, v27, v31
buffer_load_dwordx4 v[200:203], v2, s[52:55], s12 offen offset:0 nt
buffer_load_dwordx4 v[204:207], v2, s[52:55], s12 offen offset:1024 nt
buffer_load_dwordx4 v[208:211], v2, s[52:55], s12 offen offset:2048 nt
buffer_load_dwordx4 v[212:215], v2, s[52:55], s12 offen offset:3072 nt
s_add_u32 s13, s13, 24576
s_min_u32 s12, s13, 2146435072
s_cmp_ge_u32 s80, 36
s_cbranch_scc1 L_nodma_10
s_mov_b32 m0, s15
s_nop 0
buffer_load_dwordx4 v2, s[60:63], s15 offen  lds
s_add_u32 s15, s15, 1024
L_nodma_10:
s_add_u32 s80, s80, 1
v_add_f32_dpp v32, v28, v28 row_ror:8 row_mask:0xf bank_mask:0x3
v_add_f32_dpp v33, v29, v29 row_ror:8 row_mask:0xf bank_mask:0x3
v_add_f32_dpp v32, v30, v30 row_ror:8 row_mask:0xf bank_mask:0xc
v_add_f32_dpp v33, v31, v31 row_ror:8 row_mask:0xf bank_mask:0xc
s_nop 0
v_add_f32_dpp v34, v32, v32 row_half_mirror row_mask:0xf bank_mask:0x5
v_add_f32_dpp v34, v33, v33 row_half_mirror row_mask:0xf bank_mask:0xa
s_nop 1
v_add_f32_dpp v34, v34, v34 quad_perm:[1,0,3,2] row_mask:0xf bank_mask:0xf
s_nop 1
v_add_f32_dpp v34, v34, v34 quad_perm:[2,3,0,1] row_mask:0xf bank_mask:0xf
v_cndmask_b32 v86, v86, v34, s[74:75]
s_waitcnt vmcnt(28)
v_dot2_f32_bf16 v28, v216, v24, 0
v_dot2_f32_bf16 v29, v220, v24, 0
v_dot2_f32_bf16 v30, v224, v24, 0
v_dot2_f32_bf16 v31, v228, v24, 0
v_dot2_f32_bf16 v28, v217, v25, v28
v_dot2_f32_bf16 v29, v221, v25, v29
v_dot2_f32_bf16 v30, v225, v25, v30
v_dot2_f32_bf16 v31, v229, v25, v31
v_dot2_f32_bf16 v28, v218, v26, v28
v_dot2_f32_bf16 v29, v222, v26, v29
v_dot2_f32_bf16 v30, v226, v26, v30
v_dot2_f32_bf16 v31, v230, v26, v31
v_dot2_f32_bf16 v28, v219, v27, v28
v_dot2_f32_bf16 v29, v223, v27, v29
v_dot2_f32_bf16 v30, v227, v27, v30
v_dot2_f32_bf16 v31, v231, v27, v31
buffer_load_dwordx4 v[216:219], v2, s[52:55], s12 offen offset:0 nt
buffer_load_dwordx4 v[220:223], v2, s[52:55], s12 offen offset:1024 nt
buffer_load_dwordx4 v[224:227], v2, s[52:55], s12 offen offset:2048 nt
buffer_load_dwordx4 v[228:231], v2, s[52:55], s12 offen offset:3072 nt
s_add_u32 s13, s13, 24576
s_min_u32 s12, s13, 2146435072
s_cmp_ge_u32 s80, 36
s_cbranch_scc1 L_nodma_11
s_mov_b32 m0, s15
s_nop 0
buffer_load_dwordx4 v2, s[60:63], s15 offen  lds
s_add_u32 s15, s15, 1024
L_nodma_11:
s_add_u32 s80, s80, 1
v_add_f32_dpp v32, v28, v28 row_ror:8 row_mask:0xf bank_mask:0x3
v_add_f32_dpp v33, v29, v29 row_ror:8 row_mask:0xf bank_mask:0x3
v_add_f32_dpp v32, v30, v30 row_ror:8 row_mask:0xf bank_mask:0xc
v_add_f32_dpp v33, v31, v31 row_ror:8 row_mask:0xf bank_mask:0xc
s_nop 0
v_add_f32_dpp v34, v32, v32 row_half_mirror row_mask:0xf bank_mask:0x5
v_add_f32_dpp v34, v33, v33 row_half_mirror row_mask:0xf bank_mask:0xa
s_nop 1
v_add_f32_dpp v34, v34, v34 quad_perm:[1,0,3,2] row_mask:0xf bank_mask:0xf
s_nop 1
v_add_f32_dpp v34, v34, v34 quad_perm:[2,3,0,1] row_mask:0xf bank_mask:0xf
v_cndmask_b32 v86, v86, v34, s[76:77]
s_waitcnt vmcnt(28)
v_dot2_f32_bf16 v28, v232, v24, 0
v_dot2_f32_bf16 v29, v236, v24, 0
v_dot2_f32_bf16 v30, v240, v24, 0
v_dot2_f32_bf16 v31, v244, v24, 0
v_dot2_f32_bf16 v28, v233, v25, v28
v_dot2_f32_bf16 v29, v237, v25, v29
v_dot2_f32_bf16 v30, v241, v25, v30
v_dot2_f32_bf16 v31, v245, v25, v31
v_dot2_f32_bf16 v28, v234, v26, v28
v_dot2_f32_bf16 v29, v238, v26, v29
v_dot2_f32_bf16 v30, v242, v26, v30
v_dot2_f32_bf16 v31, v246, v26, v31
v_dot2_f32_bf16 v28, v235, v27, v28
v_dot2_f32_bf16 v29, v239, v27, v29
v_dot2_f32_bf16 v30, v243, v27, v30
v_dot2_f32_bf16 v31, v247, v27, v31
buffer_load_dwordx4 v[232:235], v2, s[52:55], s12 offen offset:0 nt
buffer_load_dwordx4 v[236:239], v2, s[52:55], s12 offen offset:1024 nt
buffer_load_dwordx4 v[240:243], v2, s[52:55], s12 offen offset:2048 nt
buffer_load_dwordx4 v[244:247], v2, s[52:55], s12 offen offset:3072 nt
s_add_u32 s13, s13, 24576
s_min_u32 s12, s13, 2146435072
s_cmp_ge_u32 s80, 36
s_cbranch_scc1 L_nodma_12
s_mov_b32 m0, s15
s_nop 0
buffer_load_dwordx4 v2, s[60:63], s15 offen  lds
s_add_u32 s15, s15, 1024
L_nodma_12:
s_add_u32 s80, s80, 1
v_add_f32_dpp v32, v28, v28 row_ror:8 row_mask:0xf bank_mask:0x3
v_add_f32_dpp v33, v29, v29 row_ror:8 row_mask:0xf bank_mask:0x3
v_add_f32_dpp v32, v30, v30 row_ror:8 row_mask:0xf bank_mask:0xc
v_add_f32_dpp v33, v31, v31 row_ror:8 row_mask:0xf bank_mask:0xc
s_nop 0
v_add_f32_dpp v34, v32, v32 row_half_mirror row_mask:0xf bank_mask:0x5
v_add_f32_dpp v34, v33, v33 row_half_mirror row_mask:0xf bank_mask:0xa
s_nop 1
v_add_f32_dpp v34, v34, v34 quad_perm:[1,0,3,2] row_mask:0xf bank_mask:0xf
s_nop 1
v_add_f32_dpp v34, v34, v34 quad_perm:[2,3,0,1] row_mask:0xf bank_mask:0xf
v_cndmask_b32 v86, v86, v34, s[78:79]
s_add_u32 s81, s81, 1
v_mov_b32 v76, v77
v_mov_b32 v77, v78
v_mov_b32 v78, v79
v_mov_b32 v79, v80
v_mov_b32 v80, v81
v_mov_b32 v81, v82
v_mov_b32 v82, v83
v_mov_b32 v83, v84
v_mov_b32 v84, v85
v_mov_b32 v85, v86
s_branch K_loop
A_mid:
v_max3_f32 v35, v76, v77, v78
v_max3_f32 v35, v35, v79, v80
v_max3_f32 v35, v35, v81, v82
v_max3_f32 v35, v35, v83, v84
v_max3_f32 v35, v35, v85, v86
s_nop 1
v_max_f32_dpp v35, v35, v35 row_ror:8 row_mask:0xf bank_mask:0xf
s_nop 1
v_max_f32_dpp v35, v35, v35 row_ror:4 row_mask:0xf bank_mask:0xf
s_nop 1
v_max_f32_dpp v35, v35, v35 row_ror:2 row_mask:0xf bank_mask:0xf
s_nop 1
v_max_f32_dpp v35, v35, v35 row_ror:1 row_mask:0xf bank_mask:0xf
v_mov_b32 v36, v35
s_nop 1
v_permlane16_swap_b32 v35, v36
v_max_f32 v35, v35, v36
v_mov_b32 v36, v35
s_nop 1
v_permlane32_swap_b32 v35, v36
v_max_f32 v35, v35, v36
v_mul_f32 v32, v35, v7
v_fma_f32 v76, v76, v7, -v32
v_fma_f32 v77, v77, v7, -v32
v_fma_f32 v78, v78, v7, -v32
v_fma_f32 v79, v79, v7, -v32
v_fma_f32 v80, v80, v7, -v32
v_fma_f32 v81, v81, v7, -v32
v_fma_f32 v82, v82, v7, -v32
v_fma_f32 v83, v83, v7, -v32
v_fma_f32 v84, v84, v7, -v32
v_fma_f32 v85, v85, v7, -v32
v_fma_f32 v86, v86, v7, -v32
v_exp_f32 v76, v76
v_exp_f32 v77, v77
v_exp_f32 v78, v78
v_exp_f32 v79, v79
v_exp_f32 v80, v80
v_exp_f32 v81, v81
v_exp_f32 v82, v82
v_exp_f32 v83, v83
v_exp_f32 v84, v84
v_exp_f32 v85, v85
v_exp_f32 v86, v86
v_add_f32 v35, v76, v77
v_add_f32 v35, v35, v78
v_add_f32 v35, v35, v79
v_add_f32 v35, v35, v80
v_add_f32 v35, v35, v81
v_add_f32 v35, v35, v82
v_add_f32 v35, v35, v83
v_add_f32 v35, v35, v84
v_add_f32 v35, v35, v85
v_add_f32 v35, v35, v86
v_cvt_pk_bf16_f32 v76, v76, v76
v_cvt_pk_bf16_f32 v77, v77, v77
v_cvt_pk_bf16_f32 v78, v78, v78
v_cvt_pk_bf16_f32 v79, v79, v79
v_cvt_pk_bf16_f32 v80, v80, v80
v_cvt_pk_bf16_f32 v81, v81, v81
v_cvt_pk_bf16_f32 v82, v82, v82
v_cvt_pk_bf16_f32 v83, v83, v83
v_cvt_pk_bf16_f32 v84, v84, v84
v_cvt_pk_bf16_f32 v85, v85, v85
v_cvt_pk_bf16_f32 v86, v86, v86
v_add_f32_dpp v35, v35, v35 row_ror:8 row_mask:0xf bank_mask:0xf
s_nop 1
v_add_f32_dpp v35, v35, v35 row_ror:4 row_mask:0xf bank_mask:0xf
s_nop 1
v_add_f32_dpp v35, v35, v35 row_ror:2 row_mask:0xf bank_mask:0xf
s_nop 1
v_add_f32_dpp v35, v35, v35 row_ror:1 row_mask:0xf bank_mask:0xf
v_mov_b32 v36, v35
s_nop 1
v_permlane16_swap_b32 v35, v36
v_add_f32 v35, v35, v36
v_mov_b32 v36, v35
s_nop 1
v_permlane32_swap_b32 v35, v36
v_add_f32 v35, v35, v36
v_min_u32 v32, -2, v32
v_min_u32 v33, -2, v35
s_mov_b32 s7, 400000
L_ens_13:
v_readfirstlane_b32 s6, v96
s_cmp_ge_u32 s6, 32
s_cbranch_scc1 L_ensd_14
s_sleep 16
buffer_load_dword v96, off, s[68:71], 0 offset:0 sc1
s_waitcnt vmcnt(0)
s_sub_u32 s7, s7, 1
s_cmp_lg_u32 s7, 0
s_cbranch_scc1 L_ens_13
L_ensd_14:
s_lshl_b32 s6, s11, 3
s_add_u32 s6, s6, s82
s_mov_b64 exec, 1
buffer_store_dwordx2 v[32:33], off, s[64:67], s6 sc1
s_mov_b64 exec, -1
s_mov_b32 s6, 0x63206320
s_mov_b32 s7, 0x63206320
s_and_b32 s15, s2, 7
s_lshl_b32 s15, s15, 3
s_lshr_b64 s[6:7], s[6:7], s15
s_and_b32 s15, s6, 255
v_and_b32_dpp v60, v78, v8 row_newbcast:0 row_mask:0xf bank_mask:0xf
v_and_b32_dpp v61, v78, v9 row_newbcast:0 row_mask:0xf bank_mask:0xf
v_and_b32_dpp v62, v78, v10 row_newbcast:0 row_mask:0xf bank_mask:0xf
v_and_b32_dpp v63, v78, v11 row_newbcast:0 row_mask:0xf bank_mask:0xf
v_and_b32_dpp v64, v78, v8 row_newbcast:4 row_mask:0xf bank_mask:0xf
v_and_b32_dpp v65, v78, v9 row_newbcast:4 row_mask:0xf bank_mask:0xf
v_and_b32_dpp v66, v78, v10 row_newbcast:4 row_mask:0xf bank_mask:0xf
v_and_b32_dpp v67, v78, v11 row_newbcast:4 row_mask:0xf bank_mask:0xf
v_and_b32_dpp v68, v78, v8 row_newbcast:8 row_mask:0xf bank_mask:0xf
v_and_b32_dpp v69, v78, v9 row_newbcast:8 row_mask:0xf bank_mask:0xf
v_and_b32_dpp v70, v78, v10 row_newbcast:8 row_mask:0xf bank_mask:0xf
v_and_b32_dpp v71, v78, v11 row_newbcast:8 row_mask:0xf bank_mask:0xf
v_and_b32_dpp v72, v78, v8 row_newbcast:12 row_mask:0xf bank_mask:0xf
v_and_b32_dpp v73, v78, v9 row_newbcast:12 row_mask:0xf bank_mask:0xf
v_and_b32_dpp v74, v78, v10 row_newbcast:12 row_mask:0xf bank_mask:0xf
v_and_b32_dpp v75, v78, v11 row_newbcast:12 row_mask:0xf bank_mask:0xf
s_waitcnt vmcnt(29)
v_mfma_f32_16x16x32_bf16 v[20:23], v[60:63], v[184:187], v[20:23]
v_mfma_f32_16x16x32_bf16 v[20:23], v[64:67], v[188:191], v[20:23]
v_mfma_f32_16x16x32_bf16 v[20:23], v[68:71], v[192:195], v[20:23]
v_mfma_f32_16x16x32_bf16 v[20:23], v[72:75], v[196:199], v[20:23]
v_add_u32 v117, 1, v117
buffer_store_dword v117, v118, s[64:67], 0 offen
buffer_load_dwordx4 v[184:187], v2, s[52:55], s12 offen offset:0 nt
buffer_load_dwordx4 v[188:191], v2, s[52:55], s12 offen offset:1024 nt
buffer_load_dwordx4 v[192:195], v2, s[52:55], s12 offen offset:2048 nt
buffer_load_dwordx4 v[196:199], v2, s[52:55], s12 offen offset:3072 nt
s_add_u32 s13, s13, 24576
s_min_u32 s12, s13, 2146435072
v_and_b32_dpp v60, v78, v8 row_newbcast:1 row_mask:0xf bank_mask:0xf
v_and_b32_dpp v61, v78, v9 row_newbcast:1 row_mask:0xf bank_mask:0xf
v_and_b32_dpp v62, v78, v10 row_newbcast:1 row_mask:0xf bank_mask:0xf
v_and_b32_dpp v63, v78, v11 row_newbcast:1 row_mask:0xf bank_mask:0xf
v_and_b32_dpp v64, v78, v8 row_newbcast:5 row_mask:0xf bank_mask:0xf
v_and_b32_dpp v65, v78, v9 row_newbcast:5 row_mask:0xf bank_mask:0xf
v_and_b32_dpp v66, v78, v10 row_newbcast:5 row_mask:0xf bank_mask:0xf
v_and_b32_dpp v67, v78, v11 row_newbcast:5 row_mask:0xf bank_mask:0xf
v_and_b32_dpp v68, v78, v8 row_newbcast:9 row_mask:0xf bank_mask:0xf
v_and_b32_dpp v69, v78, v9 row_newbcast:9 row_mask:0xf bank_mask:0xf
v_and_b32_dpp v70, v78, v10 row_newbcast:9 row_mask:0xf bank_mask:0xf
v_and_b32_dpp v71, v78, v11 row_newbcast:9 row_mask:0xf bank_mask:0xf
v_and_b32_dpp v72, v78, v8 row_newbcast:13 row_mask:0xf bank_mask:0xf
v_and_b32_dpp v73, v78, v9 row_newbcast:13 row_mask:0xf bank_mask:0xf
v_and_b32_dpp v74, v78, v10 row_newbcast:13 row_mask:0xf bank_mask:0xf
v_and_b32_dpp v75, v78, v11 row_newbcast:13 row_mask:0xf bank_mask:0xf
s_waitcnt vmcnt(30)
v_mfma_f32_16x16x32_bf16 v[20:23], v[60:63], v[200:203], v[20:23]
v_mfma_f32_16x16x32_bf16 v[20:23], v[64:67], v[204:207], v[20:23]
v_mfma_f32_16x16x32_bf16 v[20:23], v[68:71], v[208:211], v[20:23]
v_mfma_f32_16x16x32_bf16 v[20:23], v[72:75], v[212:215], v[20:23]
v_add_u32 v117, 1, v117
buffer_store_dword v117, v118, s[64:67], 0 offen
buffer_load_dwordx4 v[200:203], v2, s[52:55], s12 offen offset:0 nt
buffer_load_dwordx4 v[204:207], v2, s[52:55], s12 offen offset:1024 nt
buffer_load_dwordx4 v[208:211], v2, s[52:55], s12 offen offset:2048 nt
buffer_load_dwordx4 v[212:215], v2, s[52:55], s12 offen offset:3072 nt
s_add_u32 s13, s13, 24576
s_min_u32 s12, s13, 2146435072
v_and_b32_dpp v60, v76, v8 row_newbcast:1 row_mask:0xf bank_mask:0xf
v_and_b32_dpp v61, v76, v9 row_newbcast:1 row_mask:0xf bank_mask:0xf
v_and_b32_dpp v62, v76, v10 row_newbcast:1 row_mask:0xf bank_mask:0xf
v_and_b32_dpp v63, v76, v11 row_newbcast:1 row_mask:0xf bank_mask:0xf
v_and_b32_dpp v64, v76, v8 row_newbcast:5 row_mask:0xf bank_mask:0xf
v_and_b32_dpp v65, v76, v9 row_newbcast:5 row_mask:0xf bank_mask:0xf
v_and_b32_dpp v66, v76, v10 row_newbcast:5 row_mask:0xf bank_mask:0xf
v_and_b32_dpp v67, v76, v11 row_newbcast:5 row_mask:0xf bank_mask:0xf
v_and_b32_dpp v68, v76, v8 row_newbcast:9 row_mask:0xf bank_mask:0xf
v_and_b32_dpp v69, v76, v9 row_newbcast:9 row_mask:0xf bank_mask:0xf
v_and_b32_dpp v70, v76, v10 row_newbcast:9 row_mask:0xf bank_mask:0xf
v_and_b32_dpp v71, v76, v11 row_newbcast:9 row_mask:0xf bank_mask:0xf
v_and_b32_dpp v72, v76, v8 row_newbcast:13 row_mask:0xf bank_mask:0xf
v_and_b32_dpp v73, v76, v9 row_newbcast:13 row_mask:0xf bank_mask:0xf
v_and_b32_dpp v74, v76, v10 row_newbcast:13 row_mask:0xf bank_mask:0xf
v_and_b32_dpp v75, v76, v11 row_newbcast:13 row_mask:0xf bank_mask:0xf
v_mfma_f32_16x16x32_bf16 v[20:23], v[60:63], a[0:3], v[20:23]
v_mfma_f32_16x16x32_bf16 v[20:23], v[64:67], a[4:7], v[20:23]
v_mfma_f32_16x16x32_bf16 v[20:23], v[68:71], a[8:11], v[20:23]
v_mfma_f32_16x16x32_bf16 v[20:23], v[72:75], a[12:15], v[20:23]
s_nop 3
v_and_b32_dpp v60, v78, v8 row_newbcast:2 row_mask:0xf bank_mask:0xf
v_and_b32_dpp v61, v78, v9 row_newbcast:2 row_mask:0xf bank_mask:0xf
v_and_b32_dpp v62, v78, v10 row_newbcast:2 row_mask:0xf bank_mask:0xf
v_and_b32_dpp v63, v78, v11 row_newbcast:2 row_mask:0xf bank_mask:0xf
v_and_b32_dpp v64, v78, v8 row_newbcast:6 row_mask:0xf bank_mask:0xf
v_and_b32_dpp v65, v78, v9 row_newbcast:6 row_mask:0xf bank_mask:0xf
v_and_b32_dpp v66, v78, v10 row_newbcast:6 row_mask:0xf bank_mask:0xf
v_and_b32_dpp v67, v78, v11 row_newbcast:6 row_mask:0xf bank_mask:0xf
v_and_b32_dpp v68, v78, v8 row_newbcast:10 row_mask:0xf bank_mask:0xf
v_and_b32_dpp v69, v78, v9 row_newbcast:10 row_mask:0xf bank_mask:0xf
v_and_b32_dpp v70, v78, v10 row_newbcast:10 row_mask:0xf bank_mask:0xf
v_and_b32_dpp v71, v78, v11 row_newbcast:10 row_mask:0xf bank_mask:0xf
v_and_b32_dpp v72, v78, v8 row_newbcast:14 row_mask:0xf bank_mask:0xf
v_and_b32_dpp v73, v78, v9 row_newbcast:14 row_mask:0xf bank_mask:0xf
v_and_b32_dpp v74, v78, v10 row_newbcast:14 row_mask:0xf bank_mask:0xf
v_and_b32_dpp v75, v78, v11 row_newbcast:14 row_mask:0xf bank_mask:0xf
s_waitcnt vmcnt(31)
v_mfma_f32_16x16x32_bf16 v[20:23], v[60:63], v[216:219], v[20:23]
v_mfma_f32_16x16x32_bf16 v[20:23], v[64:67], v[220:223], v[20:23]
v_mfma_f32_16x16x32_bf16 v[20:23], v[68:71], v[224:227], v[20:23]
v_mfma_f32_16x16x32_bf16 v[20:23], v[72:75], v[228:231], v[20:23]
v_add_u32 v117, 1, v117
buffer_store_dword v117, v118, s[64:67], 0 offen
buffer_load_dwordx4 v[216:219], v2, s[52:55], s12 offen offset:0 nt
buffer_load_dwordx4 v[220:223], v2, s[52:55], s12 offen offset:1024 nt
buffer_load_dwordx4 v[224:227], v2, s[52:55], s12 offen offset:2048 nt
buffer_load_dwordx4 v[228:231], v2, s[52:55], s12 offen offset:3072 nt
s_add_u32 s13, s13, 24576
s_min_u32 s12, s13, 2146435072
v_and_b32_dpp v60, v78, v8 row_newbcast:3 row_mask:0xf bank_mask:0xf
v_and_b32_dpp v61, v78, v9 row_newbcast:3 row_mask:0xf bank_mask:0xf
v_and_b32_dpp v62, v78, v10 row_newbcast:3 row_mask:0xf bank_mask:0xf
v_and_b32_dpp v63, v78, v11 row_newbcast:3 row_mask:0xf bank_mask:0xf
v_and_b32_dpp v64, v78, v8 row_newbcast:7 row_mask:0xf bank_mask:0xf
v_and_b32_dpp v65, v78, v9 row_newbcast:7 row_mask:0xf bank_mask:0xf
v_and_b32_dpp v66, v78, v10 row_newbcast:7 row_mask:0xf bank_mask:0xf
v_and_b32_dpp v67, v78, v11 row_newbcast:7 row_mask:0xf bank_mask:0xf
v_and_b32_dpp v68, v78, v8 row_newbcast:11 row_mask:0xf bank_mask:0xf
v_and_b32_dpp v69, v78, v9 row_newbcast:11 row_mask:0xf bank_mask:0xf
v_and_b32_dpp v70, v78, v10 row_newbcast:11 row_mask:0xf bank_mask:0xf
v_and_b32_dpp v71, v78, v11 row_newbcast:11 row_mask:0xf bank_mask:0xf
v_and_b32_dpp v72, v78, v8 row_newbcast:15 row_mask:0xf bank_mask:0xf
v_and_b32_dpp v73, v78, v9 row_newbcast:15 row_mask:0xf bank_mask:0xf
v_and_b32_dpp v74, v78, v10 row_newbcast:15 row_mask:0xf bank_mask:0xf
v_and_b32_dpp v75, v78, v11 row_newbcast:15 row_mask:0xf bank_mask:0xf
s_waitcnt vmcnt(32)
v_mfma_f32_16x16x32_bf16 v[20:23], v[60:63], v[232:235], v[20:23]
v_mfma_f32_16x16x32_bf16 v[20:23], v[64:67], v[236:239], v[20:23]
v_mfma_f32_16x16x32_bf16 v[20:23], v[68:71], v[240:243], v[20:23]
v_mfma_f32_16x16x32_bf16 v[20:23], v[72:75], v[244:247], v[20:23]
v_add_u32 v117, 1, v117
buffer_store_dword v117, v118, s[64:67], 0 offen
buffer_load_dwordx4 v[232:235], v2, s[52:55], s12 offen offset:0 nt
buffer_load_dwordx4 v[236:239], v2, s[52:55], s12 offen offset:1024 nt
buffer_load_dwordx4 v[240:243], v2, s[52:55], s12 offen offset:2048 nt
buffer_load_dwordx4 v[244:247], v2, s[52:55], s12 offen offset:3072 nt
s_add_u32 s13, s13, 24576
s_min_u32 s12, s13, 2146435072
s_barrier
ds_read_b64_tr_b16 a[96:97], v88 offset:0
ds_read_b64_tr_b16 a[98:99], v88 offset:2304
ds_read_b64_tr_b16 a[100:101], v88 offset:18432
ds_read_b64_tr_b16 a[102:103], v88 offset:20736
v_and_b32_dpp v60, v79, v8 row_newbcast:0 row_mask:0xf bank_mask:0xf
v_and_b32_dpp v61, v79, v9 row_newbcast:0 row_mask:0xf bank_mask:0xf
v_and_b32_dpp v62, v79, v10 row_newbcast:0 row_mask:0xf bank_mask:0xf
v_and_b32_dpp v63, v79, v11 row_newbcast:0 row_mask:0xf bank_mask:0xf
v_and_b32_dpp v64, v79, v8 row_newbcast:4 row_mask:0xf bank_mask:0xf
v_and_b32_dpp v65, v79, v9 row_newbcast:4 row_mask:0xf bank_mask:0xf
v_and_b32_dpp v66, v79, v10 row_newbcast:4 row_mask:0xf bank_mask:0xf
v_and_b32_dpp v67, v79, v11 row_newbcast:4 row_mask:0xf bank_mask:0xf
v_and_b32_dpp v68, v79, v8 row_newbcast:8 row_mask:0xf bank_mask:0xf
v_and_b32_dpp v69, v79, v9 row_newbcast:8 row_mask:0xf bank_mask:0xf
v_and_b32_dpp v70, v79, v10 row_newbcast:8 row_mask:0xf bank_mask:0xf
v_and_b32_dpp v71, v79, v11 row_newbcast:8 row_mask:0xf bank_mask:0xf
v_and_b32_dpp v72, v79, v8 row_newbcast:12 row_mask:0xf bank_mask:0xf
v_and_b32_dpp v73, v79, v9 row_newbcast:12 row_mask:0xf bank_mask:0xf
v_and_b32_dpp v74, v79, v10 row_newbcast:12 row_mask:0xf bank_mask:0xf
v_and_b32_dpp v75, v79, v11 row_newbcast:12 row_mask:0xf bank_mask:0xf
s_waitcnt vmcnt(33)
v_mfma_f32_16x16x32_bf16 v[20:23], v[60:63], v[120:123], v[20:23]
v_mfma_f32_16x16x32_bf16 v[20:23], v[64:67], v[124:127], v[20:23]
v_mfma_f32_16x16x32_bf16 v[20:23], v[68:71], v[128:131], v[20:23]
v_mfma_f32_16x16x32_bf16 v[20:23], v[72:75], v[132:135], v[20:23]
v_add_u32 v117, 1, v117
buffer_store_dword v117, v118, s[64:67], 0 offen
buffer_load_dwordx4 v[120:123], v2, s[52:55], s12 offen offset:0 nt
buffer_load_dwordx4 v[124:127], v2, s[52:55], s12 offen offset:1024 nt
buffer_load_dwordx4 v[128:131], v2, s[52:55], s12 offen offset:2048 nt
buffer_load_dwordx4 v[132:135], v2, s[52:55], s12 offen offset:3072 nt
s_add_u32 s13, s13, 24576
s_min_u32 s12, s13, 2146435072
ds_read_b64_tr_b16 a[104:105], v88 offset:36864
ds_read_b64_tr_b16 a[106:107], v88 offset:39168
ds_read_b64_tr_b16 a[108:109], v88 offset:55296
ds_read_b64_tr_b16 a[110:111], v88 offset:57600
v_and_b32_dpp v60, v79, v8 row_newbcast:1 row_mask:0xf bank_mask:0xf
v_and_b32_dpp v61, v79, v9 row_newbcast:1 row_mask:0xf bank_mask:0xf
v_and_b32_dpp v62, v79, v10 row_newbcast:1 row_mask:0xf bank_mask:0xf
v_and_b32_dpp v63, v79, v11 row_newbcast:1 row_mask:0xf bank_mask:0xf
v_and_b32_dpp v64, v79, v8 row_newbcast:5 row_mask:0xf bank_mask:0xf
v_and_b32_dpp v65, v79, v9 row_newbcast:5 row_mask:0xf bank_mask:0xf
v_and_b32_dpp v66, v79, v10 row_newbcast:5 row_mask:0xf bank_mask:0xf
v_and_b32_dpp v67, v79, v11 row_newbcast:5 row_mask:0xf bank_mask:0xf
v_and_b32_dpp v68, v79, v8 row_newbcast:9 row_mask:0xf bank_mask:0xf
v_and_b32_dpp v69, v79, v9 row_newbcast:9 row_mask:0xf bank_mask:0xf
v_and_b32_dpp v70, v79, v10 row_newbcast:9 row_mask:0xf bank_mask:0xf
v_and_b32_dpp v71, v79, v11 row_newbcast:9 row_mask:0xf bank_mask:0xf
v_and_b32_dpp v72, v79, v8 row_newbcast:13 row_mask:0xf bank_mask:0xf
v_and_b32_dpp v73, v79, v9 row_newbcast:13 row_mask:0xf bank_mask:0xf
v_and_b32_dpp v74, v79, v10 row_newbcast:13 row_mask:0xf bank_mask:0xf
v_and_b32_dpp v75, v79, v11 row_newbcast:13 row_mask:0xf bank_mask:0xf
s_waitcnt vmcnt(34)
v_mfma_f32_16x16x32_bf16 v[20:23], v[60:63], v[136:139], v[20:23]
v_mfma_f32_16x16x32_bf16 v[20:23], v[64:67], v[140:143], v[20:23]
v_mfma_f32_16x16x32_bf16 v[20:23], v[68:71], v[144:147], v[20:23]
v_mfma_f32_16x16x32_bf16 v[20:23], v[72:75], v[148:151], v[20:23]
v_add_u32 v117, 1, v117
buffer_store_dword v117, v118, s[64:67], 0 offen
buffer_load_dwordx4 v[136:139], v2, s[52:55], s12 offen offset:0 nt
buffer_load_dwordx4 v[140:143], v2, s[52:55], s12 offen offset:1024 nt
buffer_load_dwordx4 v[144:147], v2, s[52:55], s12 offen offset:2048 nt
buffer_load_dwordx4 v[148:151], v2, s[52:55], s12 offen offset:3072 nt
s_add_u32 s13, s13, 24576
s_min_u32 s12, s13, 2146435072
ds_read_b64_tr_b16 a[112:113], v90 offset:0
ds_read_b64_tr_b16 a[114:115], v90 offset:2304
ds_read_b64_tr_b16 a[116:117], v90 offset:18432
ds_read_b64_tr_b16 a[118:119], v90 offset:20736
v_and_b32_dpp v60, v76, v8 row_newbcast:2 row_mask:0xf bank_mask:0xf
v_and_b32_dpp v61, v76, v9 row_newbcast:2 row_mask:0xf bank_mask:0xf
v_and_b32_dpp v62, v76, v10 row_newbcast:2 row_mask:0xf bank_mask:0xf
v_and_b32_dpp v63, v76, v11 row_newbcast:2 row_mask:0xf bank_mask:0xf
v_and_b32_dpp v64, v76, v8 row_newbcast:6 row_mask:0xf bank_mask:0xf
v_and_b32_dpp v65, v76, v9 row_newbcast:6 row_mask:0xf bank_mask:0xf
v_and_b32_dpp v66, v76, v10 row_newbcast:6 row_mask:0xf bank_mask:0xf
v_and_b32_dpp v67, v76, v11 row_newbcast:6 row_mask:0xf bank_mask:0xf
v_and_b32_dpp v68, v76, v8 row_newbcast:10 row_mask:0xf bank_mask:0xf
v_and_b32_dpp v69, v76, v9 row_newbcast:10 row_mask:0xf bank_mask:0xf
v_and_b32_dpp v70, v76, v10 row_newbcast:10 row_mask:0xf bank_mask:0xf
v_and_b32_dpp v71, v76, v11 row_newbcast:10 row_mask:0xf bank_mask:0xf
v_and_b32_dpp v72, v76, v8 row_newbcast:14 row_mask:0xf bank_mask:0xf
v_and_b32_dpp v73, v76, v9 row_newbcast:14 row_mask:0xf bank_mask:0xf
v_and_b32_dpp v74, v76, v10 row_newbcast:14 row_mask:0xf bank_mask:0xf
v_and_b32_dpp v75, v76, v11 row_newbcast:14 row_mask:0xf bank_mask:0xf
v_mfma_f32_16x16x32_bf16 v[20:23], v[60:63], a[16:19], v[20:23]
v_mfma_f32_16x16x32_bf16 v[20:23], v[64:67], a[20:23], v[20:23]
v_mfma_f32_16x16x32_bf16 v[20:23], v[68:71], a[24:27], v[20:23]
v_mfma_f32_16x16x32_bf16 v[20:23], v[72:75], a[28:31], v[20:23]
s_nop 3
v_and_b32_dpp v60, v79, v8 row_newbcast:2 row_mask:0xf bank_mask:0xf
v_and_b32_dpp v61, v79, v9 row_newbcast:2 row_mask:0xf bank_mask:0xf
v_and_b32_dpp v62, v79, v10 row_newbcast:2 row_mask:0xf bank_mask:0xf
v_and_b32_dpp v63, v79, v11 row_newbcast:2 row_mask:0xf bank_mask:0xf
v_and_b32_dpp v64, v79, v8 row_newbcast:6 row_mask:0xf bank_mask:0xf
v_and_b32_dpp v65, v79, v9 row_newbcast:6 row_mask:0xf bank_mask:0xf
v_and_b32_dpp v66, v79, v10 row_newbcast:6 row_mask:0xf bank_mask:0xf
v_and_b32_dpp v67, v79, v11 row_newbcast:6 row_mask:0xf bank_mask:0xf
v_and_b32_dpp v68, v79, v8 row_newbcast:10 row_mask:0xf bank_mask:0xf
v_and_b32_dpp v69, v79, v9 row_newbcast:10 row_mask:0xf bank_mask:0xf
v_and_b32_dpp v70, v79, v10 row_newbcast:10 row_mask:0xf bank_mask:0xf
v_and_b32_dpp v71, v79, v11 row_newbcast:10 row_mask:0xf bank_mask:0xf
v_and_b32_dpp v72, v79, v8 row_newbcast:14 row_mask:0xf bank_mask:0xf
v_and_b32_dpp v73, v79, v9 row_newbcast:14 row_mask:0xf bank_mask:0xf
v_and_b32_dpp v74, v79, v10 row_newbcast:14 row_mask:0xf bank_mask:0xf
v_and_b32_dpp v75, v79, v11 row_newbcast:14 row_mask:0xf bank_mask:0xf
s_waitcnt vmcnt(35)
v_mfma_f32_16x16x32_bf16 v[20:23], v[60:63], v[152:155], v[20:23]
v_mfma_f32_16x16x32_bf16 v[20:23], v[64:67], v[156:159], v[20:23]
v_mfma_f32_16x16x32_bf16 v[20:23], v[68:71], v[160:163], v[20:23]
v_mfma_f32_16x16x32_bf16 v[20:23], v[72:75], v[164:167], v[20:23]
v_add_u32 v117, 1, v117
buffer_store_dword v117, v118, s[64:67], 0 offen
buffer_load_dwordx4 v[152:155], v2, s[52:55], s12 offen offset:0 nt
buffer_load_dwordx4 v[156:159], v2, s[52:55], s12 offen offset:1024 nt
buffer_load_dwordx4 v[160:163], v2, s[52:55], s12 offen offset:2048 nt
buffer_load_dwordx4 v[164:167], v2, s[52:55], s12 offen offset:3072 nt
s_add_u32 s13, s13, 24576
s_min_u32 s12, s13, 2146435072
ds_read_b64_tr_b16 a[120:121], v90 offset:36864
ds_read_b64_tr_b16 a[122:123], v90 offset:39168
ds_read_b64_tr_b16 a[124:125], v90 offset:55296
ds_read_b64_tr_b16 a[126:127], v90 offset:57600
v_and_b32_dpp v60, v79, v8 row_newbcast:3 row_mask:0xf bank_mask:0xf
v_and_b32_dpp v61, v79, v9 row_newbcast:3 row_mask:0xf bank_mask:0xf
v_and_b32_dpp v62, v79, v10 row_newbcast:3 row_mask:0xf bank_mask:0xf
v_and_b32_dpp v63, v79, v11 row_newbcast:3 row_mask:0xf bank_mask:0xf
v_and_b32_dpp v64, v79, v8 row_newbcast:7 row_mask:0xf bank_mask:0xf
v_and_b32_dpp v65, v79, v9 row_newbcast:7 row_mask:0xf bank_mask:0xf
v_and_b32_dpp v66, v79, v10 row_newbcast:7 row_mask:0xf bank_mask:0xf
v_and_b32_dpp v67, v79, v11 row_newbcast:7 row_mask:0xf bank_mask:0xf
v_and_b32_dpp v68, v79, v8 row_newbcast:11 row_mask:0xf bank_mask:0xf
v_and_b32_dpp v69, v79, v9 row_newbcast:11 row_mask:0xf bank_mask:0xf
v_and_b32_dpp v70, v79, v10 row_newbcast:11 row_mask:0xf bank_mask:0xf
v_and_b32_dpp v71, v79, v11 row_newbcast:11 row_mask:0xf bank_mask:0xf
v_and_b32_dpp v72, v79, v8 row_newbcast:15 row_mask:0xf bank_mask:0xf
v_and_b32_dpp v73, v79, v9 row_newbcast:15 row_mask:0xf bank_mask:0xf
v_and_b32_dpp v74, v79, v10 row_newbcast:15 row_mask:0xf bank_mask:0xf
v_and_b32_dpp v75, v79, v11 row_newbcast:15 row_mask:0xf bank_mask:0xf
s_waitcnt vmcnt(36)
v_mfma_f32_16x16x32_bf16 v[20:23], v[60:63], v[168:171], v[20:23]
v_mfma_f32_16x16x32_bf16 v[20:23], v[64:67], v[172:175], v[20:23]
v_mfma_f32_16x16x32_bf16 v[20:23], v[68:71], v[176:179], v[20:23]
v_mfma_f32_16x16x32_bf16 v[20:23], v[72:75], v[180:183], v[20:23]
v_add_u32 v117, 1, v117
buffer_store_dword v117, v118, s[64:67], 0 offen
buffer_load_dwordx4 v[168:171], v2, s[52:55], s12 offen offset:0 nt
buffer_load_dwordx4 v[172:175], v2, s[52:55], s12 offen offset:1024 nt
buffer_load_dwordx4 v[176:179], v2, s[52:55], s12 offen offset:2048 nt
buffer_load_dwordx4 v[180:183], v2, s[52:55], s12 offen offset:3072 nt
s_add_u32 s13, s13, 24576
s_min_u32 s12, s13, 2146435072
ds_read_b64_tr_b16 a[128:129], v88 offset:8
ds_read_b64_tr_b16 a[130:131], v88 offset:2312
ds_read_b64_tr_b16 a[132:133], v88 offset:18440
ds_read_b64_tr_b16 a[134:135], v88 offset:20744
v_and_b32_dpp v60, v80, v8 row_newbcast:0 row_mask:0xf bank_mask:0xf
v_and_b32_dpp v61, v80, v9 row_newbcast:0 row_mask:0xf bank_mask:0xf
v_and_b32_dpp v62, v80, v10 row_newbcast:0 row_mask:0xf bank_mask:0xf
v_and_b32_dpp v63, v80, v11 row_newbcast:0 row_mask:0xf bank_mask:0xf
v_and_b32_dpp v64, v80, v8 row_newbcast:4 row_mask:0xf bank_mask:0xf
v_and_b32_dpp v65, v80, v9 row_newbcast:4 row_mask:0xf bank_mask:0xf
v_and_b32_dpp v66, v80, v10 row_newbcast:4 row_mask:0xf bank_mask:0xf
v_and_b32_dpp v67, v80, v11 row_newbcast:4 row_mask:0xf bank_mask:0xf
v_and_b32_dpp v68, v80, v8 row_newbcast:8 row_mask:0xf bank_mask:0xf
v_and_b32_dpp v69, v80, v9 row_newbcast:8 row_mask:0xf bank_mask:0xf
v_and_b32_dpp v70, v80, v10 row_newbcast:8 row_mask:0xf bank_mask:0xf
v_and_b32_dpp v71, v80, v11 row_newbcast:8 row_mask:0xf bank_mask:0xf
v_and_b32_dpp v72, v80, v8 row_newbcast:12 row_mask:0xf bank_mask:0xf
v_and_b32_dpp v73, v80, v9 row_newbcast:12 row_mask:0xf bank_mask:0xf
v_and_b32_dpp v74, v80, v10 row_newbcast:12 row_mask:0xf bank_mask:0xf
v_and_b32_dpp v75, v80, v11 row_newbcast:12 row_mask:0xf bank_mask:0xf
s_waitcnt vmcnt(35)
v_mfma_f32_16x16x32_bf16 v[20:23], v[60:63], v[184:187], v[20:23]
v_mfma_f32_16x16x32_bf16 v[20:23], v[64:67], v[188:191], v[20:23]
v_mfma_f32_16x16x32_bf16 v[20:23], v[68:71], v[192:195], v[20:23]
v_mfma_f32_16x16x32_bf16 v[20:23], v[72:75], v[196:199], v[20:23]
v_add_u32 v117, 1, v117
buffer_store_dword v117, v118, s[64:67], 0 offen
buffer_load_dwordx4 v[184:187], v2, s[52:55], s12 offen offset:0 nt
buffer_load_dwordx4 v[188:191], v2, s[52:55], s12 offen offset:1024 nt
buffer_load_dwordx4 v[192:195], v2, s[52:55], s12 offen offset:2048 nt
buffer_load_dwordx4 v[196:199], v2, s[52:55], s12 offen offset:3072 nt
s_add_u32 s13, s13, 24576
s_min_u32 s12, s13, 2146435072
ds_read_b64_tr_b16 a[136:137], v88 offset:36872
ds_read_b64_tr_b16 a[138:139], v88 offset:39176
ds_read_b64_tr_b16 a[140:141], v88 offset:55304
ds_read_b64_tr_b16 a[142:143], v88 offset:57608
v_and_b32_dpp v60, v80, v8 row_newbcast:1 row_mask:0xf bank_mask:0xf
v_and_b32_dpp v61, v80, v9 row_newbcast:1 row_mask:0xf bank_mask:0xf
v_and_b32_dpp v62, v80, v10 row_newbcast:1 row_mask:0xf bank_mask:0xf
v_and_b32_dpp v63, v80, v11 row_newbcast:1 row_mask:0xf bank_mask:0xf
v_and_b32_dpp v64, v80, v8 row_newbcast:5 row_mask:0xf bank_mask:0xf
v_and_b32_dpp v65, v80, v9 row_newbcast:5 row_mask:0xf bank_mask:0xf
v_and_b32_dpp v66, v80, v10 row_newbcast:5 row_mask:0xf bank_mask:0xf
v_and_b32_dpp v67, v80, v11 row_newbcast:5 row_mask:0xf bank_mask:0xf
v_and_b32_dpp v68, v80, v8 row_newbcast:9 row_mask:0xf bank_mask:0xf
v_and_b32_dpp v69, v80, v9 row_newbcast:9 row_mask:0xf bank_mask:0xf
v_and_b32_dpp v70, v80, v10 row_newbcast:9 row_mask:0xf bank_mask:0xf
v_and_b32_dpp v71, v80, v11 row_newbcast:9 row_mask:0xf bank_mask:0xf
v_and_b32_dpp v72, v80, v8 row_newbcast:13 row_mask:0xf bank_mask:0xf
v_and_b32_dpp v73, v80, v9 row_newbcast:13 row_mask:0xf bank_mask:0xf
v_and_b32_dpp v74, v80, v10 row_newbcast:13 row_mask:0xf bank_mask:0xf
v_and_b32_dpp v75, v80, v11 row_newbcast:13 row_mask:0xf bank_mask:0xf
s_waitcnt vmcnt(35)
v_mfma_f32_16x16x32_bf16 v[20:23], v[60:63], v[200:203], v[20:23]
v_mfma_f32_16x16x32_bf16 v[20:23], v[64:67], v[204:207], v[20:23]
v_mfma_f32_16x16x32_bf16 v[20:23], v[68:71], v[208:211], v[20:23]
v_mfma_f32_16x16x32_bf16 v[20:23], v[72:75], v[212:215], v[20:23]
v_add_u32 v117, 1, v117
buffer_store_dword v117, v118, s[64:67], 0 offen
buffer_load_dwordx4 v[200:203], v2, s[52:55], s12 offen offset:0 nt
buffer_load_dwordx4 v[204:207], v2, s[52:55], s12 offen offset:1024 nt
buffer_load_dwordx4 v[208:211], v2, s[52:55], s12 offen offset:2048 nt
buffer_load_dwordx4 v[212:215], v2, s[52:55], s12 offen offset:3072 nt
s_add_u32 s13, s13, 24576
s_min_u32 s12, s13, 2146435072
ds_read_b64_tr_b16 a[144:145], v90 offset:8
ds_read_b64_tr_b16 a[146:147], v90 offset:2312
ds_read_b64_tr_b16 a[148:149], v90 offset:18440
ds_read_b64_tr_b16 a[150:151], v90 offset:20744
v_and_b32_dpp v60, v76, v8 row_newbcast:3 row_mask:0xf bank_mask:0xf
v_and_b32_dpp v61, v76, v9 row_newbcast:3 row_mask:0xf bank_mask:0xf
v_and_b32_dpp v62, v76, v10 row_newbcast:3 row_mask:0xf bank_mask:0xf
v_and_b32_dpp v63, v76, v11 row_newbcast:3 row_mask:0xf bank_mask:0xf
v_and_b32_dpp v64, v76, v8 row_newbcast:7 row_mask:0xf bank_mask:0xf
v_and_b32_dpp v65, v76, v9 row_newbcast:7 row_mask:0xf bank_mask:0xf
v_and_b32_dpp v66, v76, v10 row_newbcast:7 row_mask:0xf bank_mask:0xf
v_and_b32_dpp v67, v76, v11 row_newbcast:7 row_mask:0xf bank_mask:0xf
v_and_b32_dpp v68, v76, v8 row_newbcast:11 row_mask:0xf bank_mask:0xf
v_and_b32_dpp v69, v76, v9 row_newbcast:11 row_mask:0xf bank_mask:0xf
v_and_b32_dpp v70, v76, v10 row_newbcast:11 row_mask:0xf bank_mask:0xf
v_and_b32_dpp v71, v76, v11 row_newbcast:11 row_mask:0xf bank_mask:0xf
v_and_b32_dpp v72, v76, v8 row_newbcast:15 row_mask:0xf bank_mask:0xf
v_and_b32_dpp v73, v76, v9 row_newbcast:15 row_mask:0xf bank_mask:0xf
v_and_b32_dpp v74, v76, v10 row_newbcast:15 row_mask:0xf bank_mask:0xf
v_and_b32_dpp v75, v76, v11 row_newbcast:15 row_mask:0xf bank_mask:0xf
v_mfma_f32_16x16x32_bf16 v[20:23], v[60:63], a[32:35], v[20:23]
v_mfma_f32_16x16x32_bf16 v[20:23], v[64:67], a[36:39], v[20:23]
v_mfma_f32_16x16x32_bf16 v[20:23], v[68:71], a[40:43], v[20:23]
v_mfma_f32_16x16x32_bf16 v[20:23], v[72:75], a[44:47], v[20:23]
s_nop 3
v_and_b32_dpp v60, v80, v8 row_newbcast:2 row_mask:0xf bank_mask:0xf
v_and_b32_dpp v61, v80, v9 row_newbcast:2 row_mask:0xf bank_mask:0xf
v_and_b32_dpp v62, v80, v10 row_newbcast:2 row_mask:0xf bank_mask:0xf
v_and_b32_dpp v63, v80, v11 row_newbcast:2 row_mask:0xf bank_mask:0xf
v_and_b32_dpp v64, v80, v8 row_newbcast:6 row_mask:0xf bank_mask:0xf
v_and_b32_dpp v65, v80, v9 row_newbcast:6 row_mask:0xf bank_mask:0xf
v_and_b32_dpp v66, v80, v10 row_newbcast:6 row_mask:0xf bank_mask:0xf
v_and_b32_dpp v67, v80, v11 row_newbcast:6 row_mask:0xf bank_mask:0xf
v_and_b32_dpp v68, v80, v8 row_newbcast:10 row_mask:0xf bank_mask:0xf
v_and_b32_dpp v69, v80, v9 row_newbcast:10 row_mask:0xf bank_mask:0xf
v_and_b32_dpp v70, v80, v10 row_newbcast:10 row_mask:0xf bank_mask:0xf
v_and_b32_dpp v71, v80, v11 row_newbcast:10 row_mask:0xf bank_mask:0xf
v_and_b32_dpp v72, v80, v8 row_newbcast:14 row_mask:0xf bank_mask:0xf
v_and_b32_dpp v73, v80, v9 row_newbcast:14 row_mask:0xf bank_mask:0xf
v_and_b32_dpp v74, v80, v10 row_newbcast:14 row_mask:0xf bank_mask:0xf
v_and_b32_dpp v75, v80, v11 row_newbcast:14 row_mask:0xf bank_mask:0xf
s_waitcnt vmcnt(35)
v_mfma_f32_16x16x32_bf16 v[20:23], v[60:63], v[216:219], v[20:23]
v_mfma_f32_16x16x32_bf16 v[20:23], v[64:67], v[220:223], v[20:23]
v_mfma_f32_16x16x32_bf16 v[20:23], v[68:71], v[224:227], v[20:23]
v_mfma_f32_16x16x32_bf16 v[20:23], v[72:75], v[228:231], v[20:23]
v_add_u32 v117, 1, v117
buffer_store_dword v117, v118, s[64:67], 0 offen
buffer_load_dwordx4 v[216:219], v2, s[52:55], s12 offen offset:0 nt
buffer_load_dwordx4 v[220:223], v2, s[52:55], s12 offen offset:1024 nt
buffer_load_dwordx4 v[224:227], v2, s[52:55], s12 offen offset:2048 nt
buffer_load_dwordx4 v[228:231], v2, s[52:55], s12 offen offset:3072 nt
s_add_u32 s13, s13, 24576
s_min_u32 s12, s13, 2146435072
ds_read_b64_tr_b16 a[152:153], v90 offset:36872
ds_read_b64_tr_b16 a[154:155], v90 offset:39176
ds_read_b64_tr_b16 a[156:157], v90 offset:55304
ds_read_b64_tr_b16 a[158:159], v90 offset:57608
v_and_b32_dpp v60, v80, v8 row_newbcast:3 row_mask:0xf bank_mask:0xf
v_and_b32_dpp v61, v80, v9 row_newbcast:3 row_mask:0xf bank_mask:0xf
v_and_b32_dpp v62, v80, v10 row_newbcast:3 row_mask:0xf bank_mask:0xf
v_and_b32_dpp v63, v80, v11 row_newbcast:3 row_mask:0xf bank_mask:0xf
v_and_b32_dpp v64, v80, v8 row_newbcast:7 row_mask:0xf bank_mask:0xf
v_and_b32_dpp v65, v80, v9 row_newbcast:7 row_mask:0xf bank_mask:0xf
v_and_b32_dpp v66, v80, v10 row_newbcast:7 row_mask:0xf bank_mask:0xf
v_and_b32_dpp v67, v80, v11 row_newbcast:7 row_mask:0xf bank_mask:0xf
v_and_b32_dpp v68, v80, v8 row_newbcast:11 row_mask:0xf bank_mask:0xf
v_and_b32_dpp v69, v80, v9 row_newbcast:11 row_mask:0xf bank_mask:0xf
v_and_b32_dpp v70, v80, v10 row_newbcast:11 row_mask:0xf bank_mask:0xf
v_and_b32_dpp v71, v80, v11 row_newbcast:11 row_mask:0xf bank_mask:0xf
v_and_b32_dpp v72, v80, v8 row_newbcast:15 row_mask:0xf bank_mask:0xf
v_and_b32_dpp v73, v80, v9 row_newbcast:15 row_mask:0xf bank_mask:0xf
v_and_b32_dpp v74, v80, v10 row_newbcast:15 row_mask:0xf bank_mask:0xf
v_and_b32_dpp v75, v80, v11 row_newbcast:15 row_mask:0xf bank_mask:0xf
s_waitcnt vmcnt(35)
v_mfma_f32_16x16x32_bf16 v[20:23], v[60:63], v[232:235], v[20:23]
v_mfma_f32_16x16x32_bf16 v[20:23], v[64:67], v[236:239], v[20:23]
v_mfma_f32_16x16x32_bf16 v[20:23], v[68:71], v[240:243], v[20:23]
v_mfma_f32_16x16x32_bf16 v[20:23], v[72:75], v[244:247], v[20:23]
v_add_u32 v117, 1, v117
buffer_store_dword v117, v118, s[64:67], 0 offen
buffer_load_dwordx4 v[232:235], v2, s[52:55], s12 offen offset:0 nt
buffer_load_dwordx4 v[236:239], v2, s[52:55], s12 offen offset:1024 nt
buffer_load_dwordx4 v[240:243], v2, s[52:55], s12 offen offset:2048 nt
buffer_load_dwordx4 v[244:247], v2, s[52:55], s12 offen offset:3072 nt
s_add_u32 s13, s13, 24576
s_min_u32 s12, s13, 2146435072
ds_read_b64_tr_b16 a[160:161], v88 offset:16
ds_read_b64_tr_b16 a[162:163], v88 offset:2320
ds_read_b64_tr_b16 a[164:165], v88 offset:18448
ds_read_b64_tr_b16 a[166:167], v88 offset:20752
v_and_b32_dpp v60, v81, v8 row_newbcast:0 row_mask:0xf bank_mask:0xf
v_and_b32_dpp v61, v81, v9 row_newbcast:0 row_mask:0xf bank_mask:0xf
v_and_b32_dpp v62, v81, v10 row_newbcast:0 row_mask:0xf bank_mask:0xf
v_and_b32_dpp v63, v81, v11 row_newbcast:0 row_mask:0xf bank_mask:0xf
v_and_b32_dpp v64, v81, v8 row_newbcast:4 row_mask:0xf bank_mask:0xf
v_and_b32_dpp v65, v81, v9 row_newbcast:4 row_mask:0xf bank_mask:0xf
v_and_b32_dpp v66, v81, v10 row_newbcast:4 row_mask:0xf bank_mask:0xf
v_and_b32_dpp v67, v81, v11 row_newbcast:4 row_mask:0xf bank_mask:0xf
v_and_b32_dpp v68, v81, v8 row_newbcast:8 row_mask:0xf bank_mask:0xf
v_and_b32_dpp v69, v81, v9 row_newbcast:8 row_mask:0xf bank_mask:0xf
v_and_b32_dpp v70, v81, v10 row_newbcast:8 row_mask:0xf bank_mask:0xf
v_and_b32_dpp v71, v81, v11 row_newbcast:8 row_mask:0xf bank_mask:0xf
v_and_b32_dpp v72, v81, v8 row_newbcast:12 row_mask:0xf bank_mask:0xf
v_and_b32_dpp v73, v81, v9 row_newbcast:12 row_mask:0xf bank_mask:0xf
v_and_b32_dpp v74, v81, v10 row_newbcast:12 row_mask:0xf bank_mask:0xf
v_and_b32_dpp v75, v81, v11 row_newbcast:12 row_mask:0xf bank_mask:0xf
s_waitcnt vmcnt(35)
v_mfma_f32_16x16x32_bf16 v[20:23], v[60:63], v[120:123], v[20:23]
v_mfma_f32_16x16x32_bf16 v[20:23], v[64:67], v[124:127], v[20:23]
v_mfma_f32_16x16x32_bf16 v[20:23], v[68:71], v[128:131], v[20:23]
v_mfma_f32_16x16x32_bf16 v[20:23], v[72:75], v[132:135], v[20:23]
v_add_u32 v117, 1, v117
buffer_store_dword v117, v118, s[64:67], 0 offen
buffer_load_dwordx4 v[120:123], v2, s[52:55], s12 offen offset:0 nt
buffer_load_dwordx4 v[124:127], v2, s[52:55], s12 offen offset:1024 nt
buffer_load_dwordx4 v[128:131], v2, s[52:55], s12 offen offset:2048 nt
buffer_load_dwordx4 v[132:135], v2, s[52:55], s12 offen offset:3072 nt
s_add_u32 s13, s13, 24576
s_min_u32 s12, s13, 2146435072
ds_read_b64_tr_b16 a[168:169], v88 offset:36880
ds_read_b64_tr_b16 a[170:171], v88 offset:39184
ds_read_b64_tr_b16 a[172:173], v88 offset:55312
ds_read_b64_tr_b16 a[174:175], v88 offset:57616
v_and_b32_dpp v60, v81, v8 row_newbcast:1 row_mask:0xf bank_mask:0xf
v_and_b32_dpp v61, v81, v9 row_newbcast:1 row_mask:0xf bank_mask:0xf
v_and_b32_dpp v62, v81, v10 row_newbcast:1 row_mask:0xf bank_mask:0xf
v_and_b32_dpp v63, v81, v11 row_newbcast:1 row_mask:0xf bank_mask:0xf
v_and_b32_dpp v64, v81, v8 row_newbcast:5 row_mask:0xf bank_mask:0xf
v_and_b32_dpp v65, v81, v9 row_newbcast:5 row_mask:0xf bank_mask:0xf
v_and_b32_dpp v66, v81, v10 row_newbcast:5 row_mask:0xf bank_mask:0xf
v_and_b32_dpp v67, v81, v11 row_newbcast:5 row_mask:0xf bank_mask:0xf
v_and_b32_dpp v68, v81, v8 row_newbcast:9 row_mask:0xf bank_mask:0xf
v_and_b32_dpp v69, v81, v9 row_newbcast:9 row_mask:0xf bank_mask:0xf
v_and_b32_dpp v70, v81, v10 row_newbcast:9 row_mask:0xf bank_mask:0xf
v_and_b32_dpp v71, v81, v11 row_newbcast:9 row_mask:0xf bank_mask:0xf
v_and_b32_dpp v72, v81, v8 row_newbcast:13 row_mask:0xf bank_mask:0xf
v_and_b32_dpp v73, v81, v9 row_newbcast:13 row_mask:0xf bank_mask:0xf
v_and_b32_dpp v74, v81, v10 row_newbcast:13 row_mask:0xf bank_mask:0xf
v_and_b32_dpp v75, v81, v11 row_newbcast:13 row_mask:0xf bank_mask:0xf
s_waitcnt vmcnt(35)
v_mfma_f32_16x16x32_bf16 v[20:23], v[60:63], v[136:139], v[20:23]
v_mfma_f32_16x16x32_bf16 v[20:23], v[64:67], v[140:143], v[20:23]
v_mfma_f32_16x16x32_bf16 v[20:23], v[68:71], v[144:147], v[20:23]
v_mfma_f32_16x16x32_bf16 v[20:23], v[72:75], v[148:151], v[20:23]
v_add_u32 v117, 1, v117
buffer_store_dword v117, v118, s[64:67], 0 offen
buffer_load_dwordx4 v[136:139], v2, s[52:55], s12 offen offset:0 nt
buffer_load_dwordx4 v[140:143], v2, s[52:55], s12 offen offset:1024 nt
buffer_load_dwordx4 v[144:147], v2, s[52:55], s12 offen offset:2048 nt
buffer_load_dwordx4 v[148:151], v2, s[52:55], s12 offen offset:3072 nt
s_add_u32 s13, s13, 24576
s_min_u32 s12, s13, 2146435072
ds_read_b64_tr_b16 a[176:177], v90 offset:16
ds_read_b64_tr_b16 a[178:179], v90 offset:2320
ds_read_b64_tr_b16 a[180:181], v90 offset:18448
ds_read_b64_tr_b16 a[182:183], v90 offset:20752
v_and_b32_dpp v60, v77, v8 row_newbcast:0 row_mask:0xf bank_mask:0xf
v_and_b32_dpp v61, v77, v9 row_newbcast:0 row_mask:0xf bank_mask:0xf
v_and_b32_dpp v62, v77, v10 row_newbcast:0 row_mask:0xf bank_mask:0xf
v_and_b32_dpp v63, v77, v11 row_newbcast:0 row_mask:0xf bank_mask:0xf
v_and_b32_dpp v64, v77, v8 row_newbcast:4 row_mask:0xf bank_mask:0xf
v_and_b32_dpp v65, v77, v9 row_newbcast:4 row_mask:0xf bank_mask:0xf
v_and_b32_dpp v66, v77, v10 row_newbcast:4 row_mask:0xf bank_mask:0xf
v_and_b32_dpp v67, v77, v11 row_newbcast:4 row_mask:0xf bank_mask:0xf
v_and_b32_dpp v68, v77, v8 row_newbcast:8 row_mask:0xf bank_mask:0xf
v_and_b32_dpp v69, v77, v9 row_newbcast:8 row_mask:0xf bank_mask:0xf
v_and_b32_dpp v70, v77, v10 row_newbcast:8 row_mask:0xf bank_mask:0xf
v_and_b32_dpp v71, v77, v11 row_newbcast:8 row_mask:0xf bank_mask:0xf
v_and_b32_dpp v72, v77, v8 row_newbcast:12 row_mask:0xf bank_mask:0xf
v_and_b32_dpp v73, v77, v9 row_newbcast:12 row_mask:0xf bank_mask:0xf
v_and_b32_dpp v74, v77, v10 row_newbcast:12 row_mask:0xf bank_mask:0xf
v_and_b32_dpp v75, v77, v11 row_newbcast:12 row_mask:0xf bank_mask:0xf
v_mfma_f32_16x16x32_bf16 v[20:23], v[60:63], a[48:51], v[20:23]
v_mfma_f32_16x16x32_bf16 v[20:23], v[64:67], a[52:55], v[20:23]
v_mfma_f32_16x16x32_bf16 v[20:23], v[68:71], a[56:59], v[20:23]
v_mfma_f32_16x16x32_bf16 v[20:23], v[72:75], a[60:63], v[20:23]
s_nop 3
v_and_b32_dpp v60, v81, v8 row_newbcast:2 row_mask:0xf bank_mask:0xf
v_and_b32_dpp v61, v81, v9 row_newbcast:2 row_mask:0xf bank_mask:0xf
v_and_b32_dpp v62, v81, v10 row_newbcast:2 row_mask:0xf bank_mask:0xf
v_and_b32_dpp v63, v81, v11 row_newbcast:2 row_mask:0xf bank_mask:0xf
v_and_b32_dpp v64, v81, v8 row_newbcast:6 row_mask:0xf bank_mask:0xf
v_and_b32_dpp v65, v81, v9 row_newbcast:6 row_mask:0xf bank_mask:0xf
v_and_b32_dpp v66, v81, v10 row_newbcast:6 row_mask:0xf bank_mask:0xf
v_and_b32_dpp v67, v81, v11 row_newbcast:6 row_mask:0xf bank_mask:0xf
v_and_b32_dpp v68, v81, v8 row_newbcast:10 row_mask:0xf bank_mask:0xf
v_and_b32_dpp v69, v81, v9 row_newbcast:10 row_mask:0xf bank_mask:0xf
v_and_b32_dpp v70, v81, v10 row_newbcast:10 row_mask:0xf bank_mask:0xf
v_and_b32_dpp v71, v81, v11 row_newbcast:10 row_mask:0xf bank_mask:0xf
v_and_b32_dpp v72, v81, v8 row_newbcast:14 row_mask:0xf bank_mask:0xf
v_and_b32_dpp v73, v81, v9 row_newbcast:14 row_mask:0xf bank_mask:0xf
v_and_b32_dpp v74, v81, v10 row_newbcast:14 row_mask:0xf bank_mask:0xf
v_and_b32_dpp v75, v81, v11 row_newbcast:14 row_mask:0xf bank_mask:0xf
s_waitcnt vmcnt(35)
v_mfma_f32_16x16x32_bf16 v[20:23], v[60:63], v[152:155], v[20:23]
v_mfma_f32_16x16x32_bf16 v[20:23], v[64:67], v[156:159], v[20:23]
v_mfma_f32_16x16x32_bf16 v[20:23], v[68:71], v[160:163], v[20:23]
v_mfma_f32_16x16x32_bf16 v[20:23], v[72:75], v[164:167], v[20:23]
v_add_u32 v117, 1, v117
buffer_store_dword v117, v118, s[64:67], 0 offen
buffer_load_dwordx4 v[152:155], v2, s[52:55], s12 offen offset:0 nt
buffer_load_dwordx4 v[156:159], v2, s[52:55], s12 offen offset:1024 nt
buffer_load_dwordx4 v[160:163], v2, s[52:55], s12 offen offset:2048 nt
buffer_load_dwordx4 v[164:167], v2, s[52:55], s12 offen offset:3072 nt
s_add_u32 s13, s13, 24576
s_min_u32 s12, s13, 2146435072
ds_read_b64_tr_b16 a[184:185], v90 offset:36880
ds_read_b64_tr_b16 a[186:187], v90 offset:39184
ds_read_b64_tr_b16 a[188:189], v90 offset:55312
ds_read_b64_tr_b16 a[190:191], v90 offset:57616
v_and_b32_dpp v60, v81, v8 row_newbcast:3 row_mask:0xf bank_mask:0xf
v_and_b32_dpp v61, v81, v9 row_newbcast:3 row_mask:0xf bank_mask:0xf
v_and_b32_dpp v62, v81, v10 row_newbcast:3 row_mask:0xf bank_mask:0xf
v_and_b32_dpp v63, v81, v11 row_newbcast:3 row_mask:0xf bank_mask:0xf
v_and_b32_dpp v64, v81, v8 row_newbcast:7 row_mask:0xf bank_mask:0xf
v_and_b32_dpp v65, v81, v9 row_newbcast:7 row_mask:0xf bank_mask:0xf
v_and_b32_dpp v66, v81, v10 row_newbcast:7 row_mask:0xf bank_mask:0xf
v_and_b32_dpp v67, v81, v11 row_newbcast:7 row_mask:0xf bank_mask:0xf
v_and_b32_dpp v68, v81, v8 row_newbcast:11 row_mask:0xf bank_mask:0xf
v_and_b32_dpp v69, v81, v9 row_newbcast:11 row_mask:0xf bank_mask:0xf
v_and_b32_dpp v70, v81, v10 row_newbcast:11 row_mask:0xf bank_mask:0xf
v_and_b32_dpp v71, v81, v11 row_newbcast:11 row_mask:0xf bank_mask:0xf
v_and_b32_dpp v72, v81, v8 row_newbcast:15 row_mask:0xf bank_mask:0xf
v_and_b32_dpp v73, v81, v9 row_newbcast:15 row_mask:0xf bank_mask:0xf
v_and_b32_dpp v74, v81, v10 row_newbcast:15 row_mask:0xf bank_mask:0xf
v_and_b32_dpp v75, v81, v11 row_newbcast:15 row_mask:0xf bank_mask:0xf
s_waitcnt vmcnt(35)
v_mfma_f32_16x16x32_bf16 v[20:23], v[60:63], v[168:171], v[20:23]
v_mfma_f32_16x16x32_bf16 v[20:23], v[64:67], v[172:175], v[20:23]
v_mfma_f32_16x16x32_bf16 v[20:23], v[68:71], v[176:179], v[20:23]
v_mfma_f32_16x16x32_bf16 v[20:23], v[72:75], v[180:183], v[20:23]
v_add_u32 v117, 1, v117
buffer_store_dword v117, v118, s[64:67], 0 offen
buffer_load_dwordx4 v[168:171], v2, s[52:55], s12 offen offset:0 nt
buffer_load_dwordx4 v[172:175], v2, s[52:55], s12 offen offset:1024 nt
buffer_load_dwordx4 v[176:179], v2, s[52:55], s12 offen offset:2048 nt
buffer_load_dwordx4 v[180:183], v2, s[52:55], s12 offen offset:3072 nt
s_add_u32 s13, s13, 24576
s_min_u32 s12, s13, 2146435072
ds_read_b64_tr_b16 a[192:193], v88 offset:24
ds_read_b64_tr_b16 a[194:195], v88 offset:2328
ds_read_b64_tr_b16 a[196:197], v88 offset:18456
ds_read_b64_tr_b16 a[198:199], v88 offset:20760
v_and_b32_dpp v60, v82, v8 row_newbcast:0 row_mask:0xf bank_mask:0xf
v_and_b32_dpp v61, v82, v9 row_newbcast:0 row_mask:0xf bank_mask:0xf
v_and_b32_dpp v62, v82, v10 row_newbcast:0 row_mask:0xf bank_mask:0xf
v_and_b32_dpp v63, v82, v11 row_newbcast:0 row_mask:0xf bank_mask:0xf
v_and_b32_dpp v64, v82, v8 row_newbcast:4 row_mask:0xf bank_mask:0xf
v_and_b32_dpp v65, v82, v9 row_newbcast:4 row_mask:0xf bank_mask:0xf
v_and_b32_dpp v66, v82, v10 row_newbcast:4 row_mask:0xf bank_mask:0xf
v_and_b32_dpp v67, v82, v11 row_newbcast:4 row_mask:0xf bank_mask:0xf
v_and_b32_dpp v68, v82, v8 row_newbcast:8 row_mask:0xf bank_mask:0xf
v_and_b32_dpp v69, v82, v9 row_newbcast:8 row_mask:0xf bank_mask:0xf
v_and_b32_dpp v70, v82, v10 row_newbcast:8 row_mask:0xf bank_mask:0xf
v_and_b32_dpp v71, v82, v11 row_newbcast:8 row_mask:0xf bank_mask:0xf
v_and_b32_dpp v72, v82, v8 row_newbcast:12 row_mask:0xf bank_mask:0xf
v_and_b32_dpp v73, v82, v9 row_newbcast:12 row_mask:0xf bank_mask:0xf
v_and_b32_dpp v74, v82, v10 row_newbcast:12 row_mask:0xf bank_mask:0xf
v_and_b32_dpp v75, v82, v11 row_newbcast:12 row_mask:0xf bank_mask:0xf
s_waitcnt vmcnt(35)
v_mfma_f32_16x16x32_bf16 v[20:23], v[60:63], v[184:187], v[20:23]
v_mfma_f32_16x16x32_bf16 v[20:23], v[64:67], v[188:191], v[20:23]
v_mfma_f32_16x16x32_bf16 v[20:23], v[68:71], v[192:195], v[20:23]
v_mfma_f32_16x16x32_bf16 v[20:23], v[72:75], v[196:199], v[20:23]
v_add_u32 v117, 1, v117
buffer_store_dword v117, v118, s[64:67], 0 offen
s_cmp_le_u32 s15, 32
s_cbranch_scc0 L_thr_15
s_waitcnt vmcnt(7)
L_thr_15:
buffer_load_dwordx4 v[184:187], v2, s[52:55], s12 offen offset:0 nt
buffer_load_dwordx4 v[188:191], v2, s[52:55], s12 offen offset:1024 nt
s_cbranch_scc0 L_thr_16
s_waitcnt vmcnt(7)
L_thr_16:
buffer_load_dwordx4 v[192:195], v2, s[52:55], s12 offen offset:2048 nt
buffer_load_dwordx4 v[196:199], v2, s[52:55], s12 offen offset:3072 nt
s_add_u32 s13, s13, 24576
s_min_u32 s12, s13, 2146435072
ds_read_b64_tr_b16 a[200:201], v88 offset:36888
ds_read_b64_tr_b16 a[202:203], v88 offset:39192
ds_read_b64_tr_b16 a[204:205], v88 offset:55320
ds_read_b64_tr_b16 a[206:207], v88 offset:57624
v_and_b32_dpp v60, v82, v8 row_newbcast:1 row_mask:0xf bank_mask:0xf
v_and_b32_dpp v61, v82, v9 row_newbcast:1 row_mask:0xf bank_mask:0xf
v_and_b32_dpp v62, v82, v10 row_newbcast:1 row_mask:0xf bank_mask:0xf
v_and_b32_dpp v63, v82, v11 row_newbcast:1 row_mask:0xf bank_mask:0xf
v_and_b32_dpp v64, v82, v8 row_newbcast:5 row_mask:0xf bank_mask:0xf
v_and_b32_dpp v65, v82, v9 row_newbcast:5 row_mask:0xf bank_mask:0xf
v_and_b32_dpp v66, v82, v10 row_newbcast:5 row_mask:0xf bank_mask:0xf
v_and_b32_dpp v67, v82, v11 row_newbcast:5 row_mask:0xf bank_mask:0xf
v_and_b32_dpp v68, v82, v8 row_newbcast:9 row_mask:0xf bank_mask:0xf
v_and_b32_dpp v69, v82, v9 row_newbcast:9 row_mask:0xf bank_mask:0xf
v_and_b32_dpp v70, v82, v10 row_newbcast:9 row_mask:0xf bank_mask:0xf
v_and_b32_dpp v71, v82, v11 row_newbcast:9 row_mask:0xf bank_mask:0xf
v_and_b32_dpp v72, v82, v8 row_newbcast:13 row_mask:0xf bank_mask:0xf
v_and_b32_dpp v73, v82, v9 row_newbcast:13 row_mask:0xf bank_mask:0xf
v_and_b32_dpp v74, v82, v10 row_newbcast:13 row_mask:0xf bank_mask:0xf
v_and_b32_dpp v75, v82, v11 row_newbcast:13 row_mask:0xf bank_mask:0xf
s_waitcnt vmcnt(35)
v_mfma_f32_16x16x32_bf16 v[20:23], v[60:63], v[200:203], v[20:23]
v_mfma_f32_16x16x32_bf16 v[20:23], v[64:67], v[204:207], v[20:23]
v_mfma_f32_16x16x32_bf16 v[20:23], v[68:71], v[208:211], v[20:23]
v_mfma_f32_16x16x32_bf16 v[20:23], v[72:75], v[212:215], v[20:23]
v_add_u32 v117, 1, v117
buffer_store_dword v117, v118, s[64:67], 0 offen
s_cmp_le_u32 s15, 33
s_cbranch_scc0 L_thr_17
s_waitcnt vmcnt(7)
L_thr_17:
buffer_load_dwordx4 v[200:203], v2, s[52:55], s12 offen offset:0 nt
buffer_load_dwordx4 v[204:207], v2, s[52:55], s12 offen offset:1024 nt
s_cbranch_scc0 L_thr_18
s_waitcnt vmcnt(7)
L_thr_18:
buffer_load_dwordx4 v[208:211], v2, s[52:55], s12 offen offset:2048 nt
buffer_load_dwordx4 v[212:215], v2, s[52:55], s12 offen offset:3072 nt
s_add_u32 s13, s13, 24576
s_min_u32 s12, s13, 2146435072
ds_read_b64_tr_b16 a[208:209], v90 offset:24
ds_read_b64_tr_b16 a[210:211], v90 offset:2328
ds_read_b64_tr_b16 a[212:213], v90 offset:18456
ds_read_b64_tr_b16 a[214:215], v90 offset:20760
v_and_b32_dpp v60, v77, v8 row_newbcast:1 row_mask:0xf bank_mask:0xf
v_and_b32_dpp v61, v77, v9 row_newbcast:1 row_mask:0xf bank_mask:0xf
v_and_b32_dpp v62, v77, v10 row_newbcast:1 row_mask:0xf bank_mask:0xf
v_and_b32_dpp v63, v77, v11 row_newbcast:1 row_mask:0xf bank_mask:0xf
v_and_b32_dpp v64, v77, v8 row_newbcast:5 row_mask:0xf bank_mask:0xf
v_and_b32_dpp v65, v77, v9 row_newbcast:5 row_mask:0xf bank_mask:0xf
v_and_b32_dpp v66, v77, v10 row_newbcast:5 row_mask:0xf bank_mask:0xf
v_and_b32_dpp v67, v77, v11 row_newbcast:5 row_mask:0xf bank_mask:0xf
v_and_b32_dpp v68, v77, v8 row_newbcast:9 row_mask:0xf bank_mask:0xf
v_and_b32_dpp v69, v77, v9 row_newbcast:9 row_mask:0xf bank_mask:0xf
v_and_b32_dpp v70, v77, v10 row_newbcast:9 row_mask:0xf bank_mask:0xf
v_and_b32_dpp v71, v77, v11 row_newbcast:9 row_mask:0xf bank_mask:0xf
v_and_b32_dpp v72, v77, v8 row_newbcast:13 row_mask:0xf bank_mask:0xf
v_and_b32_dpp v73, v77, v9 row_newbcast:13 row_mask:0xf bank_mask:0xf
v_and_b32_dpp v74, v77, v10 row_newbcast:13 row_mask:0xf bank_mask:0xf
v_and_b32_dpp v75, v77, v11 row_newbcast:13 row_mask:0xf bank_mask:0xf
v_mfma_f32_16x16x32_bf16 v[20:23], v[60:63], a[64:67], v[20:23]
v_mfma_f32_16x16x32_bf16 v[20:23], v[64:67], a[68:71], v[20:23]
v_mfma_f32_16x16x32_bf16 v[20:23], v[68:71], a[72:75], v[20:23]
v_mfma_f32_16x16x32_bf16 v[20:23], v[72:75], a[76:79], v[20:23]
s_nop 3
v_and_b32_dpp v60, v82, v8 row_newbcast:2 row_mask:0xf bank_mask:0xf
v_and_b32_dpp v61, v82, v9 row_newbcast:2 row_mask:0xf bank_mask:0xf
v_and_b32_dpp v62, v82, v10 row_newbcast:2 row_mask:0xf bank_mask:0xf
v_and_b32_dpp v63, v82, v11 row_newbcast:2 row_mask:0xf bank_mask:0xf
v_and_b32_dpp v64, v82, v8 row_newbcast:6 row_mask:0xf bank_mask:0xf
v_and_b32_dpp v65, v82, v9 row_newbcast:6 row_mask:0xf bank_mask:0xf
v_and_b32_dpp v66, v82, v10 row_newbcast:6 row_mask:0xf bank_mask:0xf
v_and_b32_dpp v67, v82, v11 row_newbcast:6 row_mask:0xf bank_mask:0xf
v_and_b32_dpp v68, v82, v8 row_newbcast:10 row_mask:0xf bank_mask:0xf
v_and_b32_dpp v69, v82, v9 row_newbcast:10 row_mask:0xf bank_mask:0xf
v_and_b32_dpp v70, v82, v10 row_newbcast:10 row_mask:0xf bank_mask:0xf
v_and_b32_dpp v71, v82, v11 row_newbcast:10 row_mask:0xf bank_mask:0xf
v_and_b32_dpp v72, v82, v8 row_newbcast:14 row_mask:0xf bank_mask:0xf
v_and_b32_dpp v73, v82, v9 row_newbcast:14 row_mask:0xf bank_mask:0xf
v_and_b32_dpp v74, v82, v10 row_newbcast:14 row_mask:0xf bank_mask:0xf
v_and_b32_dpp v75, v82, v11 row_newbcast:14 row_mask:0xf bank_mask:0xf
s_waitcnt vmcnt(35)
v_mfma_f32_16x16x32_bf16 v[20:23], v[60:63], v[216:219], v[20:23]
v_mfma_f32_16x16x32_bf16 v[20:23], v[64:67], v[220:223], v[20:23]
v_mfma_f32_16x16x32_bf16 v[20:23], v[68:71], v[224:227], v[20:23]
v_mfma_f32_16x16x32_bf16 v[20:23], v[72:75], v[228:231], v[20:23]
v_add_u32 v117, 1, v117
buffer_store_dword v117, v118, s[64:67], 0 offen
s_cmp_le_u32 s15, 34
s_cbranch_scc0 L_thr_19
s_waitcnt vmcnt(7)
L_thr_19:
buffer_load_dwordx4 v[216:219], v2, s[52:55], s12 offen offset:0 nt
buffer_load_dwordx4 v[220:223], v2, s[52:55], s12 offen offset:1024 nt
s_cbranch_scc0 L_thr_20
s_waitcnt vmcnt(7)
L_thr_20:
buffer_load_dwordx4 v[224:227], v2, s[52:55], s12 offen offset:2048 nt
buffer_load_dwordx4 v[228:231], v2, s[52:55], s12 offen offset:3072 nt
s_add_u32 s13, s13, 24576
s_min_u32 s12, s13, 2146435072
ds_read_b64_tr_b16 a[216:217], v90 offset:36888
ds_read_b64_tr_b16 a[218:219], v90 offset:39192
ds_read_b64_tr_b16 a[220:221], v90 offset:55320
ds_read_b64_tr_b16 a[222:223], v90 offset:57624
v_and_b32_dpp v60, v82, v8 row_newbcast:3 row_mask:0xf bank_mask:0xf
v_and_b32_dpp v61, v82, v9 row_newbcast:3 row_mask:0xf bank_mask:0xf
v_and_b32_dpp v62, v82, v10 row_newbcast:3 row_mask:0xf bank_mask:0xf
v_and_b32_dpp v63, v82, v11 row_newbcast:3 row_mask:0xf bank_mask:0xf
v_and_b32_dpp v64, v82, v8 row_newbcast:7 row_mask:0xf bank_mask:0xf
v_and_b32_dpp v65, v82, v9 row_newbcast:7 row_mask:0xf bank_mask:0xf
v_and_b32_dpp v66, v82, v10 row_newbcast:7 row_mask:0xf bank_mask:0xf
v_and_b32_dpp v67, v82, v11 row_newbcast:7 row_mask:0xf bank_mask:0xf
v_and_b32_dpp v68, v82, v8 row_newbcast:11 row_mask:0xf bank_mask:0xf
v_and_b32_dpp v69, v82, v9 row_newbcast:11 row_mask:0xf bank_mask:0xf
v_and_b32_dpp v70, v82, v10 row_newbcast:11 row_mask:0xf bank_mask:0xf
v_and_b32_dpp v71, v82, v11 row_newbcast:11 row_mask:0xf bank_mask:0xf
v_and_b32_dpp v72, v82, v8 row_newbcast:15 row_mask:0xf bank_mask:0xf
v_and_b32_dpp v73, v82, v9 row_newbcast:15 row_mask:0xf bank_mask:0xf
v_and_b32_dpp v74, v82, v10 row_newbcast:15 row_mask:0xf bank_mask:0xf
v_and_b32_dpp v75, v82, v11 row_newbcast:15 row_mask:0xf bank_mask:0xf
s_waitcnt vmcnt(35)
v_mfma_f32_16x16x32_bf16 v[20:23], v[60:63], v[232:235], v[20:23]
v_mfma_f32_16x16x32_bf16 v[20:23], v[64:67], v[236:239], v[20:23]
v_mfma_f32_16x16x32_bf16 v[20:23], v[68:71], v[240:243], v[20:23]
v_mfma_f32_16x16x32_bf16 v[20:23], v[72:75], v[244:247], v[20:23]
v_add_u32 v117, 1, v117
buffer_store_dword v117, v118, s[64:67], 0 offen
s_cmp_le_u32 s15, 35
s_cbranch_scc0 L_thr_21
s_waitcnt vmcnt(7)
L_thr_21:
buffer_load_dwordx4 v[232:235], v2, s[52:55], s12 offen offset:0 nt
buffer_load_dwordx4 v[236:239], v2, s[52:55], s12 offen offset:1024 nt
s_cbranch_scc0 L_thr_22
s_waitcnt vmcnt(7)
L_thr_22:
buffer_load_dwordx4 v[240:243], v2, s[52:55], s12 offen offset:2048 nt
buffer_load_dwordx4 v[244:247], v2, s[52:55], s12 offen offset:3072 nt
s_add_u32 s13, s13, 24576
s_min_u32 s12, s13, 2146435072
ds_read_b64_tr_b16 a[224:225], v89 offset:0
ds_read_b64_tr_b16 a[226:227], v89 offset:4608
ds_read_b64_tr_b16 a[228:229], v89 offset:36864
ds_read_b64_tr_b16 a[230:231], v89 offset:41472
buffer_load_dwordx4 v[40:43], off, s[64:67], s82 offset:0 sc1
buffer_load_dwordx4 v[44:47], off, s[64:67], s82 offset:16 sc1
buffer_load_dwordx4 v[48:51], off, s[64:67], s82 offset:32 sc1
v_and_b32_dpp v60, v83, v8 row_newbcast:0 row_mask:0xf bank_mask:0xf
v_and_b32_dpp v61, v83, v9 row_newbcast:0 row_mask:0xf bank_mask:0xf
v_and_b32_dpp v62, v83, v10 row_newbcast:0 row_mask:0xf bank_mask:0xf
v_and_b32_dpp v63, v83, v11 row_newbcast:0 row_mask:0xf bank_mask:0xf
v_and_b32_dpp v64, v83, v8 row_newbcast:4 row_mask:0xf bank_mask:0xf
v_and_b32_dpp v65, v83, v9 row_newbcast:4 row_mask:0xf bank_mask:0xf
v_and_b32_dpp v66, v83, v10 row_newbcast:4 row_mask:0xf bank_mask:0xf
v_and_b32_dpp v67, v83, v11 row_newbcast:4 row_mask:0xf bank_mask:0xf
v_and_b32_dpp v68, v83, v8 row_newbcast:8 row_mask:0xf bank_mask:0xf
v_and_b32_dpp v69, v83, v9 row_newbcast:8 row_mask:0xf bank_mask:0xf
v_and_b32_dpp v70, v83, v10 row_newbcast:8 row_mask:0xf bank_mask:0xf
v_and_b32_dpp v71, v83, v11 row_newbcast:8 row_mask:0xf bank_mask:0xf
v_and_b32_dpp v72, v83, v8 row_newbcast:12 row_mask:0xf bank_mask:0xf
v_and_b32_dpp v73, v83, v9 row_newbcast:12 row_mask:0xf bank_mask:0xf
v_and_b32_dpp v74, v83, v10 row_newbcast:12 row_mask:0xf bank_mask:0xf
v_and_b32_dpp v75, v83, v11 row_newbcast:12 row_mask:0xf bank_mask:0xf
s_waitcnt vmcnt(38)
v_mfma_f32_16x16x32_bf16 v[20:23], v[60:63], v[120:123], v[20:23]
v_mfma_f32_16x16x32_bf16 v[20:23], v[64:67], v[124:127], v[20:23]
v_mfma_f32_16x16x32_bf16 v[20:23], v[68:71], v[128:131], v[20:23]
v_mfma_f32_16x16x32_bf16 v[20:23], v[72:75], v[132:135], v[20:23]
v_add_u32 v117, 1, v117
buffer_store_dword v117, v118, s[64:67], 0 offen
s_cmp_le_u32 s15, 36
s_cbranch_scc0 L_thr_23
s_waitcnt vmcnt(7)
L_thr_23:
buffer_load_dwordx4 v[120:123], v2, s[52:55], s12 offen offset:0 nt
buffer_load_dwordx4 v[124:127], v2, s[52:55], s12 offen offset:1024 nt
s_cbranch_scc0 L_thr_24
s_waitcnt vmcnt(7)
L_thr_24:
buffer_load_dwordx4 v[128:131], v2, s[52:55], s12 offen offset:2048 nt
buffer_load_dwordx4 v[132:135], v2, s[52:55], s12 offen offset:3072 nt
s_add_u32 s13, s13, 24576
s_min_u32 s12, s13, 2146435072
ds_read_b64_tr_b16 a[232:233], v91 offset:0
ds_read_b64_tr_b16 a[234:235], v91 offset:4608
ds_read_b64_tr_b16 a[236:237], v91 offset:36864
ds_read_b64_tr_b16 a[238:239], v91 offset:41472
v_and_b32_dpp v60, v83, v8 row_newbcast:1 row_mask:0xf bank_mask:0xf
v_and_b32_dpp v61, v83, v9 row_newbcast:1 row_mask:0xf bank_mask:0xf
v_and_b32_dpp v62, v83, v10 row_newbcast:1 row_mask:0xf bank_mask:0xf
v_and_b32_dpp v63, v83, v11 row_newbcast:1 row_mask:0xf bank_mask:0xf
v_and_b32_dpp v64, v83, v8 row_newbcast:5 row_mask:0xf bank_mask:0xf
v_and_b32_dpp v65, v83, v9 row_newbcast:5 row_mask:0xf bank_mask:0xf
v_and_b32_dpp v66, v83, v10 row_newbcast:5 row_mask:0xf bank_mask:0xf
v_and_b32_dpp v67, v83, v11 row_newbcast:5 row_mask:0xf bank_mask:0xf
v_and_b32_dpp v68, v83, v8 row_newbcast:9 row_mask:0xf bank_mask:0xf
v_and_b32_dpp v69, v83, v9 row_newbcast:9 row_mask:0xf bank_mask:0xf
v_and_b32_dpp v70, v83, v10 row_newbcast:9 row_mask:0xf bank_mask:0xf
v_and_b32_dpp v71, v83, v11 row_newbcast:9 row_mask:0xf bank_mask:0xf
v_and_b32_dpp v72, v83, v8 row_newbcast:13 row_mask:0xf bank_mask:0xf
v_and_b32_dpp v73, v83, v9 row_newbcast:13 row_mask:0xf bank_mask:0xf
v_and_b32_dpp v74, v83, v10 row_newbcast:13 row_mask:0xf bank_mask:0xf
v_and_b32_dpp v75, v83, v11 row_newbcast:13 row_mask:0xf bank_mask:0xf
s_waitcnt vmcnt(38)
v_mfma_f32_16x16x32_bf16 v[20:23], v[60:63], v[136:139], v[20:23]
v_mfma_f32_16x16x32_bf16 v[20:23], v[64:67], v[140:143], v[20:23]
v_mfma_f32_16x16x32_bf16 v[20:23], v[68:71], v[144:147], v[20:23]
v_mfma_f32_16x16x32_bf16 v[20:23], v[72:75], v[148:151], v[20:23]
s_nop 3
v_and_b32_dpp v60, v83, v8 row_newbcast:2 row_mask:0xf bank_mask:0xf
v_and_b32_dpp v61, v83, v9 row_newbcast:2 row_mask:0xf bank_mask:0xf
v_and_b32_dpp v62, v83, v10 row_newbcast:2 row_mask:0xf bank_mask:0xf
v_and_b32_dpp v63, v83, v11 row_newbcast:2 row_mask:0xf bank_mask:0xf
v_and_b32_dpp v64, v83, v8 row_newbcast:6 row_mask:0xf bank_mask:0xf
v_and_b32_dpp v65, v83, v9 row_newbcast:6 row_mask:0xf bank_mask:0xf
v_and_b32_dpp v66, v83, v10 row_newbcast:6 row_mask:0xf bank_mask:0xf
v_and_b32_dpp v67, v83, v11 row_newbcast:6 row_mask:0xf bank_mask:0xf
v_and_b32_dpp v68, v83, v8 row_newbcast:10 row_mask:0xf bank_mask:0xf
v_and_b32_dpp v69, v83, v9 row_newbcast:10 row_mask:0xf bank_mask:0xf
v_and_b32_dpp v70, v83, v10 row_newbcast:10 row_mask:0xf bank_mask:0xf
v_and_b32_dpp v71, v83, v11 row_newbcast:10 row_mask:0xf bank_mask:0xf
v_and_b32_dpp v72, v83, v8 row_newbcast:14 row_mask:0xf bank_mask:0xf
v_and_b32_dpp v73, v83, v9 row_newbcast:14 row_mask:0xf bank_mask:0xf
v_and_b32_dpp v74, v83, v10 row_newbcast:14 row_mask:0xf bank_mask:0xf
v_and_b32_dpp v75, v83, v11 row_newbcast:14 row_mask:0xf bank_mask:0xf
s_waitcnt vmcnt(33)
v_mfma_f32_16x16x32_bf16 v[20:23], v[60:63], v[152:155], v[20:23]
v_mfma_f32_16x16x32_bf16 v[20:23], v[64:67], v[156:159], v[20:23]
v_mfma_f32_16x16x32_bf16 v[20:23], v[68:71], v[160:163], v[20:23]
v_mfma_f32_16x16x32_bf16 v[20:23], v[72:75], v[164:167], v[20:23]
v_add_u32 v117, 1, v117
buffer_store_dword v117, v118, s[64:67], 0 offen
s_cmp_le_u32 s15, 37
s_cbranch_scc0 L_thr_25
s_waitcnt vmcnt(7)
L_thr_25:
buffer_load_dwordx4 v[136:139], v2, s[52:55], s12 offen offset:0 nt
buffer_load_dwordx4 v[140:143], v2, s[52:55], s12 offen offset:1024 nt
s_cbranch_scc0 L_thr_26
s_waitcnt vmcnt(7)
L_thr_26:
buffer_load_dwordx4 v[144:147], v2, s[52:55], s12 offen offset:2048 nt
buffer_load_dwordx4 v[148:151], v2, s[52:55], s12 offen offset:3072 nt
s_add_u32 s13, s13, 24576
s_min_u32 s12, s13, 2146435072
v_and_b32_dpp v60, v77, v8 row_newbcast:2 row_mask:0xf bank_mask:0xf
v_and_b32_dpp v61, v77, v9 row_newbcast:2 row_mask:0xf bank_mask:0xf
v_and_b32_dpp v62, v77, v10 row_newbcast:2 row_mask:0xf bank_mask:0xf
v_and_b32_dpp v63, v77, v11 row_newbcast:2 row_mask:0xf bank_mask:0xf
v_and_b32_dpp v64, v77, v8 row_newbcast:6 row_mask:0xf bank_mask:0xf
v_and_b32_dpp v65, v77, v9 row_newbcast:6 row_mask:0xf bank_mask:0xf
v_and_b32_dpp v66, v77, v10 row_newbcast:6 row_mask:0xf bank_mask:0xf
v_and_b32_dpp v67, v77, v11 row_newbcast:6 row_mask:0xf bank_mask:0xf
v_and_b32_dpp v68, v77, v8 row_newbcast:10 row_mask:0xf bank_mask:0xf
v_and_b32_dpp v69, v77, v9 row_newbcast:10 row_mask:0xf bank_mask:0xf
v_and_b32_dpp v70, v77, v10 row_newbcast:10 row_mask:0xf bank_mask:0xf
v_and_b32_dpp v71, v77, v11 row_newbcast:10 row_mask:0xf bank_mask:0xf
v_and_b32_dpp v72, v77, v8 row_newbcast:14 row_mask:0xf bank_mask:0xf
v_and_b32_dpp v73, v77, v9 row_newbcast:14 row_mask:0xf bank_mask:0xf
v_and_b32_dpp v74, v77, v10 row_newbcast:14 row_mask:0xf bank_mask:0xf
v_and_b32_dpp v75, v77, v11 row_newbcast:14 row_mask:0xf bank_mask:0xf
v_mfma_f32_16x16x32_bf16 v[20:23], v[60:63], a[80:83], v[20:23]
v_mfma_f32_16x16x32_bf16 v[20:23], v[64:67], a[84:87], v[20:23]
v_mfma_f32_16x16x32_bf16 v[20:23], v[68:71], a[88:91], v[20:23]
v_mfma_f32_16x16x32_bf16 v[20:23], v[72:75], a[92:95], v[20:23]
s_nop 3
v_and_b32_dpp v60, v83, v8 row_newbcast:3 row_mask:0xf bank_mask:0xf
v_and_b32_dpp v61, v83, v9 row_newbcast:3 row_mask:0xf bank_mask:0xf
v_and_b32_dpp v62, v83, v10 row_newbcast:3 row_mask:0xf bank_mask:0xf
v_and_b32_dpp v63, v83, v11 row_newbcast:3 row_mask:0xf bank_mask:0xf
v_and_b32_dpp v64, v83, v8 row_newbcast:7 row_mask:0xf bank_mask:0xf
v_and_b32_dpp v65, v83, v9 row_newbcast:7 row_mask:0xf bank_mask:0xf
v_and_b32_dpp v66, v83, v10 row_newbcast:7 row_mask:0xf bank_mask:0xf
v_and_b32_dpp v67, v83, v11 row_newbcast:7 row_mask:0xf bank_mask:0xf
v_and_b32_dpp v68, v83, v8 row_newbcast:11 row_mask:0xf bank_mask:0xf
v_and_b32_dpp v69, v83, v9 row_newbcast:11 row_mask:0xf bank_mask:0xf
v_and_b32_dpp v70, v83, v10 row_newbcast:11 row_mask:0xf bank_mask:0xf
v_and_b32_dpp v71, v83, v11 row_newbcast:11 row_mask:0xf bank_mask:0xf
v_and_b32_dpp v72, v83, v8 row_newbcast:15 row_mask:0xf bank_mask:0xf
v_and_b32_dpp v73, v83, v9 row_newbcast:15 row_mask:0xf bank_mask:0xf
v_and_b32_dpp v74, v83, v10 row_newbcast:15 row_mask:0xf bank_mask:0xf
v_and_b32_dpp v75, v83, v11 row_newbcast:15 row_mask:0xf bank_mask:0xf
s_waitcnt vmcnt(33)
v_mfma_f32_16x16x32_bf16 v[20:23], v[60:63], v[168:171], v[20:23]
v_mfma_f32_16x16x32_bf16 v[20:23], v[64:67], v[172:175], v[20:23]
v_mfma_f32_16x16x32_bf16 v[20:23], v[68:71], v[176:179], v[20:23]
v_mfma_f32_16x16x32_bf16 v[20:23], v[72:75], v[180:183], v[20:23]
s_nop 3
v_and_b32_dpp v60, v84, v8 row_newbcast:0 row_mask:0xf bank_mask:0xf
v_and_b32_dpp v61, v84, v9 row_newbcast:0 row_mask:0xf bank_mask:0xf
v_and_b32_dpp v62, v84, v10 row_newbcast:0 row_mask:0xf bank_mask:0xf
v_and_b32_dpp v63, v84, v11 row_newbcast:0 row_mask:0xf bank_mask:0xf
v_and_b32_dpp v64, v84, v8 row_newbcast:4 row_mask:0xf bank_mask:0xf
v_and_b32_dpp v65, v84, v9 row_newbcast:4 row_mask:0xf bank_mask:0xf
v_and_b32_dpp v66, v84, v10 row_newbcast:4 row_mask:0xf bank_mask:0xf
v_and_b32_dpp v67, v84, v11 row_newbcast:4 row_mask:0xf bank_mask:0xf
v_and_b32_dpp v68, v84, v8 row_newbcast:8 row_mask:0xf bank_mask:0xf
v_and_b32_dpp v69, v84, v9 row_newbcast:8 row_mask:0xf bank_mask:0xf
v_and_b32_dpp v70, v84, v10 row_newbcast:8 row_mask:0xf bank_mask:0xf
v_and_b32_dpp v71, v84, v11 row_newbcast:8 row_mask:0xf bank_mask:0xf
v_and_b32_dpp v72, v84, v8 row_newbcast:12 row_mask:0xf bank_mask:0xf
v_and_b32_dpp v73, v84, v9 row_newbcast:12 row_mask:0xf bank_mask:0xf
v_and_b32_dpp v74, v84, v10 row_newbcast:12 row_mask:0xf bank_mask:0xf
v_and_b32_dpp v75, v84, v11 row_newbcast:12 row_mask:0xf bank_mask:0xf
s_waitcnt vmcnt(28)
v_mfma_f32_16x16x32_bf16 v[20:23], v[60:63], v[184:187], v[20:23]
v_mfma_f32_16x16x32_bf16 v[20:23], v[64:67], v[188:191], v[20:23]
v_mfma_f32_16x16x32_bf16 v[20:23], v[68:71], v[192:195], v[20:23]
v_mfma_f32_16x16x32_bf16 v[20:23], v[72:75], v[196:199], v[20:23]
v_add_u32 v117, 1, v117
buffer_store_dword v117, v118, s[64:67], 0 offen
s_cmp_le_u32 s15, 38
s_cbranch_scc0 L_thr_27
s_waitcnt vmcnt(7)
L_thr_27:
buffer_load_dwordx4 v[152:155], v2, s[52:55], s12 offen offset:0 nt
buffer_load_dwordx4 v[156:159], v2, s[52:55], s12 offen offset:1024 nt
s_cbranch_scc0 L_thr_28
s_waitcnt vmcnt(7)
L_thr_28:
buffer_load_dwordx4 v[160:163], v2, s[52:55], s12 offen offset:2048 nt
buffer_load_dwordx4 v[164:167], v2, s[52:55], s12 offen offset:3072 nt
s_add_u32 s13, s13, 24576
s_min_u32 s12, s13, 2146435072
v_and_b32_dpp v60, v84, v8 row_newbcast:1 row_mask:0xf bank_mask:0xf
v_and_b32_dpp v61, v84, v9 row_newbcast:1 row_mask:0xf bank_mask:0xf
v_and_b32_dpp v62, v84, v10 row_newbcast:1 row_mask:0xf bank_mask:0xf
v_and_b32_dpp v63, v84, v11 row_newbcast:1 row_mask:0xf bank_mask:0xf
v_and_b32_dpp v64, v84, v8 row_newbcast:5 row_mask:0xf bank_mask:0xf
v_and_b32_dpp v65, v84, v9 row_newbcast:5 row_mask:0xf bank_mask:0xf
v_and_b32_dpp v66, v84, v10 row_newbcast:5 row_mask:0xf bank_mask:0xf
v_and_b32_dpp v67, v84, v11 row_newbcast:5 row_mask:0xf bank_mask:0xf
v_and_b32_dpp v68, v84, v8 row_newbcast:9 row_mask:0xf bank_mask:0xf
v_and_b32_dpp v69, v84, v9 row_newbcast:9 row_mask:0xf bank_mask:0xf
v_and_b32_dpp v70, v84, v10 row_newbcast:9 row_mask:0xf bank_mask:0xf
v_and_b32_dpp v71, v84, v11 row_newbcast:9 row_mask:0xf bank_mask:0xf
v_and_b32_dpp v72, v84, v8 row_newbcast:13 row_mask:0xf bank_mask:0xf
v_and_b32_dpp v73, v84, v9 row_newbcast:13 row_mask:0xf bank_mask:0xf
v_and_b32_dpp v74, v84, v10 row_newbcast:13 row_mask:0xf bank_mask:0xf
v_and_b32_dpp v75, v84, v11 row_newbcast:13 row_mask:0xf bank_mask:0xf
s_waitcnt vmcnt(28)
v_mfma_f32_16x16x32_bf16 v[20:23], v[60:63], v[200:203], v[20:23]
v_mfma_f32_16x16x32_bf16 v[20:23], v[64:67], v[204:207], v[20:23]
v_mfma_f32_16x16x32_bf16 v[20:23], v[68:71], v[208:211], v[20:23]
v_mfma_f32_16x16x32_bf16 v[20:23], v[72:75], v[212:215], v[20:23]
s_nop 3
v_and_b32_dpp v60, v84, v8 row_newbcast:2 row_mask:0xf bank_mask:0xf
v_and_b32_dpp v61, v84, v9 row_newbcast:2 row_mask:0xf bank_mask:0xf
v_and_b32_dpp v62, v84, v10 row_newbcast:2 row_mask:0xf bank_mask:0xf
v_and_b32_dpp v63, v84, v11 row_newbcast:2 row_mask:0xf bank_mask:0xf
v_and_b32_dpp v64, v84, v8 row_newbcast:6 row_mask:0xf bank_mask:0xf
v_and_b32_dpp v65, v84, v9 row_newbcast:6 row_mask:0xf bank_mask:0xf
v_and_b32_dpp v66, v84, v10 row_newbcast:6 row_mask:0xf bank_mask:0xf
v_and_b32_dpp v67, v84, v11 row_newbcast:6 row_mask:0xf bank_mask:0xf
v_and_b32_dpp v68, v84, v8 row_newbcast:10 row_mask:0xf bank_mask:0xf
v_and_b32_dpp v69, v84, v9 row_newbcast:10 row_mask:0xf bank_mask:0xf
v_and_b32_dpp v70, v84, v10 row_newbcast:10 row_mask:0xf bank_mask:0xf
v_and_b32_dpp v71, v84, v11 row_newbcast:10 row_mask:0xf bank_mask:0xf
v_and_b32_dpp v72, v84, v8 row_newbcast:14 row_mask:0xf bank_mask:0xf
v_and_b32_dpp v73, v84, v9 row_newbcast:14 row_mask:0xf bank_mask:0xf
v_and_b32_dpp v74, v84, v10 row_newbcast:14 row_mask:0xf bank_mask:0xf
v_and_b32_dpp v75, v84, v11 row_newbcast:14 row_mask:0xf bank_mask:0xf
s_waitcnt vmcnt(23)
v_mfma_f32_16x16x32_bf16 v[20:23], v[60:63], v[216:219], v[20:23]
v_mfma_f32_16x16x32_bf16 v[20:23], v[64:67], v[220:223], v[20:23]
v_mfma_f32_16x16x32_bf16 v[20:23], v[68:71], v[224:227], v[20:23]
v_mfma_f32_16x16x32_bf16 v[20:23], v[72:75], v[228:231], v[20:23]
v_add_u32 v117, 1, v117
buffer_store_dword v117, v118, s[64:67], 0 offen
s_cmp_le_u32 s15, 39
s_cbranch_scc0 L_thr_29
s_waitcnt vmcnt(7)
L_thr_29:
buffer_load_dwordx4 v[168:171], v2, s[52:55], s12 offen offset:0 nt
buffer_load_dwordx4 v[172:175], v2, s[52:55], s12 offen offset:1024 nt
s_cbranch_scc0 L_thr_30
s_waitcnt vmcnt(7)
L_thr_30:
buffer_load_dwordx4 v[176:179], v2, s[52:55], s12 offen offset:2048 nt
buffer_load_dwordx4 v[180:183], v2, s[52:55], s12 offen offset:3072 nt
s_add_u32 s13, s13, 24576
s_min_u32 s12, s13, 2146435072
v_and_b32_dpp v60, v84, v8 row_newbcast:3 row_mask:0xf bank_mask:0xf
v_and_b32_dpp v61, v84, v9 row_newbcast:3 row_mask:0xf bank_mask:0xf
v_and_b32_dpp v62, v84, v10 row_newbcast:3 row_mask:0xf bank_mask:0xf
v_and_b32_dpp v63, v84, v11 row_newbcast:3 row_mask:0xf bank_mask:0xf
v_and_b32_dpp v64, v84, v8 row_newbcast:7 row_mask:0xf bank_mask:0xf
v_and_b32_dpp v65, v84, v9 row_newbcast:7 row_mask:0xf bank_mask:0xf
v_and_b32_dpp v66, v84, v10 row_newbcast:7 row_mask:0xf bank_mask:0xf
v_and_b32_dpp v67, v84, v11 row_newbcast:7 row_mask:0xf bank_mask:0xf
v_and_b32_dpp v68, v84, v8 row_newbcast:11 row_mask:0xf bank_mask:0xf
v_and_b32_dpp v69, v84, v9 row_newbcast:11 row_mask:0xf bank_mask:0xf
v_and_b32_dpp v70, v84, v10 row_newbcast:11 row_mask:0xf bank_mask:0xf
v_and_b32_dpp v71, v84, v11 row_newbcast:11 row_mask:0xf bank_mask:0xf
v_and_b32_dpp v72, v84, v8 row_newbcast:15 row_mask:0xf bank_mask:0xf
v_and_b32_dpp v73, v84, v9 row_newbcast:15 row_mask:0xf bank_mask:0xf
v_and_b32_dpp v74, v84, v10 row_newbcast:15 row_mask:0xf bank_mask:0xf
v_and_b32_dpp v75, v84, v11 row_newbcast:15 row_mask:0xf bank_mask:0xf
s_waitcnt vmcnt(23)
v_mfma_f32_16x16x32_bf16 v[20:23], v[60:63], v[232:235], v[20:23]
v_mfma_f32_16x16x32_bf16 v[20:23], v[64:67], v[236:239], v[20:23]
v_mfma_f32_16x16x32_bf16 v[20:23], v[68:71], v[240:243], v[20:23]
v_mfma_f32_16x16x32_bf16 v[20:23], v[72:75], v[244:247], v[20:23]
s_nop 3
v_and_b32_dpp v60, v85, v8 row_newbcast:0 row_mask:0xf bank_mask:0xf
v_and_b32_dpp v61, v85, v9 row_newbcast:0 row_mask:0xf bank_mask:0xf
v_and_b32_dpp v62, v85, v10 row_newbcast:0 row_mask:0xf bank_mask:0xf
v_and_b32_dpp v63, v85, v11 row_newbcast:0 row_mask:0xf bank_mask:0xf
v_and_b32_dpp v64, v85, v8 row_newbcast:4 row_mask:0xf bank_mask:0xf
v_and_b32_dpp v65, v85, v9 row_newbcast:4 row_mask:0xf bank_mask:0xf
v_and_b32_dpp v66, v85, v10 row_newbcast:4 row_mask:0xf bank_mask:0xf
v_and_b32_dpp v67, v85, v11 row_newbcast:4 row_mask:0xf bank_mask:0xf
v_and_b32_dpp v68, v85, v8 row_newbcast:8 row_mask:0xf bank_mask:0xf
v_and_b32_dpp v69, v85, v9 row_newbcast:8 row_mask:0xf bank_mask:0xf
v_and_b32_dpp v70, v85, v10 row_newbcast:8 row_mask:0xf bank_mask:0xf
v_and_b32_dpp v71, v85, v11 row_newbcast:8 row_mask:0xf bank_mask:0xf
v_and_b32_dpp v72, v85, v8 row_newbcast:12 row_mask:0xf bank_mask:0xf
v_and_b32_dpp v73, v85, v9 row_newbcast:12 row_mask:0xf bank_mask:0xf
v_and_b32_dpp v74, v85, v10 row_newbcast:12 row_mask:0xf bank_mask:0xf
v_and_b32_dpp v75, v85, v11 row_newbcast:12 row_mask:0xf bank_mask:0xf
s_waitcnt vmcnt(15)
v_mfma_f32_16x16x32_bf16 v[20:23], v[60:63], v[120:123], v[20:23]
v_mfma_f32_16x16x32_bf16 v[20:23], v[64:67], v[124:127], v[20:23]
v_mfma_f32_16x16x32_bf16 v[20:23], v[68:71], v[128:131], v[20:23]
v_mfma_f32_16x16x32_bf16 v[20:23], v[72:75], v[132:135], v[20:23]
v_add_u32 v117, 1, v117
buffer_store_dword v117, v118, s[64:67], 0 offen
s_cmp_le_u32 s15, 40
s_cbranch_scc0 L_thr_31
s_waitcnt vmcnt(7)
L_thr_31:
buffer_load_dwordx4 v[184:187], v2, s[52:55], s12 offen offset:0 nt
buffer_load_dwordx4 v[188:191], v2, s[52:55], s12 offen offset:1024 nt
s_cbranch_scc0 L_thr_32
s_waitcnt vmcnt(7)
L_thr_32:
buffer_load_dwordx4 v[192:195], v2, s[52:55], s12 offen offset:2048 nt
buffer_load_dwordx4 v[196:199], v2, s[52:55], s12 offen offset:3072 nt
s_add_u32 s13, s13, 24576
s_min_u32 s12, s13, 2146435072
s_mov_b32 s7, 400000
A_ev2_chk:
v_max3_u32 v35, v40, v41, v42
v_max3_u32 v35, v35, v43, v44
v_max3_u32 v35, v35, v45, v46
v_max3_u32 v35, v35, v47, v48
v_max3_u32 v35, v35, v49, v50
v_max_u32 v35, v35, v51
v_cmp_eq_u32 vcc, -1, v35
s_cbranch_vccz A_ev2_ok
buffer_load_dwordx4 v[40:43], off, s[64:67], s82 offset:0 sc1
buffer_load_dwordx4 v[44:47], off, s[64:67], s82 offset:16 sc1
buffer_load_dwordx4 v[48:51], off, s[64:67], s82 offset:32 sc1
s_waitcnt vmcnt(0)
s_sub_u32 s7, s7, 1
s_cmp_lg_u32 s7, 0
s_cbranch_scc1 A_ev2_chk
A_ev2_ok:
v_max3_f32 v35, v40, v42, v44
v_max3_f32 v36, v46, v48, v50
v_max_f32 v35, v35, v36
v_sub_f32 v40, v40, v35
v_sub_f32 v42, v42, v35
v_sub_f32 v44, v44, v35
v_sub_f32 v46, v46, v35
v_sub_f32 v48, v48, v35
v_sub_f32 v50, v50, v35
v_sub_f32 v37, v32, v35
v_exp_f32 v40, v40
v_exp_f32 v42, v42
v_exp_f32 v44, v44
v_exp_f32 v46, v46
v_exp_f32 v48, v48
v_exp_f32 v50, v50
v_exp_f32 v37, v37
v_mul_f32 v35, v40, v41
v_fma_f32 v35, v42, v43, v35
v_fma_f32 v35, v44, v45, v35
v_fma_f32 v35, v46, v47, v35
v_fma_f32 v35, v48, v49, v35
v_fma_f32 v35, v50, v51, v35
v_rcp_f32 v35, v35
s_nop 0
v_mul_f32 v37, v37, v35
v_and_b32_dpp v60, v85, v8 row_newbcast:1 row_mask:0xf bank_mask:0xf
v_and_b32_dpp v61, v85, v9 row_newbcast:1 row_mask:0xf bank_mask:0xf
v_and_b32_dpp v62, v85, v10 row_newbcast:1 row_mask:0xf bank_mask:0xf
v_and_b32_dpp v63, v85, v11 row_newbcast:1 row_mask:0xf bank_mask:0xf
v_and_b32_dpp v64, v85, v8 row_newbcast:5 row_mask:0xf bank_mask:0xf
v_and_b32_dpp v65, v85, v9 row_newbcast:5 row_mask:0xf bank_mask:0xf
v_and_b32_dpp v66, v85, v10 row_newbcast:5 row_mask:0xf bank_mask:0xf
v_and_b32_dpp v67, v85, v11 row_newbcast:5 row_mask:0xf bank_mask:0xf
v_and_b32_dpp v68, v85, v8 row_newbcast:9 row_mask:0xf bank_mask:0xf
v_and_b32_dpp v69, v85, v9 row_newbcast:9 row_mask:0xf bank_mask:0xf
v_and_b32_dpp v70, v85, v10 row_newbcast:9 row_mask:0xf bank_mask:0xf
v_and_b32_dpp v71, v85, v11 row_newbcast:9 row_mask:0xf bank_mask:0xf
v_and_b32_dpp v72, v85, v8 row_newbcast:13 row_mask:0xf bank_mask:0xf
v_and_b32_dpp v73, v85, v9 row_newbcast:13 row_mask:0xf bank_mask:0xf
v_and_b32_dpp v74, v85, v10 row_newbcast:13 row_mask:0xf bank_mask:0xf
v_and_b32_dpp v75, v85, v11 row_newbcast:13 row_mask:0xf bank_mask:0xf
s_waitcnt vmcnt(15)
v_mfma_f32_16x16x32_bf16 v[20:23], v[60:63], v[136:139], v[20:23]
v_mfma_f32_16x16x32_bf16 v[20:23], v[64:67], v[140:143], v[20:23]
v_mfma_f32_16x16x32_bf16 v[20:23], v[68:71], v[144:147], v[20:23]
v_mfma_f32_16x16x32_bf16 v[20:23], v[72:75], v[148:151], v[20:23]
v_add_u32 v117, 1, v117
buffer_store_dword v117, v118, s[64:67], 0 offen
s_cmp_le_u32 s15, 41
s_cbranch_scc0 L_thr_33
s_waitcnt vmcnt(7)
L_thr_33:
buffer_load_dwordx4 v[200:203], v2, s[52:55], s12 offen offset:0 nt
buffer_load_dwordx4 v[204:207], v2, s[52:55], s12 offen offset:1024 nt
s_cbranch_scc0 L_thr_34
s_waitcnt vmcnt(7)
L_thr_34:
buffer_load_dwordx4 v[208:211], v2, s[52:55], s12 offen offset:2048 nt
buffer_load_dwordx4 v[212:215], v2, s[52:55], s12 offen offset:3072 nt
s_add_u32 s13, s13, 24576
s_min_u32 s12, s13, 2146435072
v_and_b32_dpp v60, v77, v8 row_newbcast:3 row_mask:0xf bank_mask:0xf
v_and_b32_dpp v61, v77, v9 row_newbcast:3 row_mask:0xf bank_mask:0xf
v_and_b32_dpp v62, v77, v10 row_newbcast:3 row_mask:0xf bank_mask:0xf
v_and_b32_dpp v63, v77, v11 row_newbcast:3 row_mask:0xf bank_mask:0xf
v_and_b32_dpp v64, v77, v8 row_newbcast:7 row_mask:0xf bank_mask:0xf
v_and_b32_dpp v65, v77, v9 row_newbcast:7 row_mask:0xf bank_mask:0xf
v_and_b32_dpp v66, v77, v10 row_newbcast:7 row_mask:0xf bank_mask:0xf
v_and_b32_dpp v67, v77, v11 row_newbcast:7 row_mask:0xf bank_mask:0xf
v_and_b32_dpp v68, v77, v8 row_newbcast:11 row_mask:0xf bank_mask:0xf
v_and_b32_dpp v69, v77, v9 row_newbcast:11 row_mask:0xf bank_mask:0xf
v_and_b32_dpp v70, v77, v10 row_newbcast:11 row_mask:0xf bank_mask:0xf
v_and_b32_dpp v71, v77, v11 row_newbcast:11 row_mask:0xf bank_mask:0xf
v_and_b32_dpp v72, v77, v8 row_newbcast:15 row_mask:0xf bank_mask:0xf
v_and_b32_dpp v73, v77, v9 row_newbcast:15 row_mask:0xf bank_mask:0xf
v_and_b32_dpp v74, v77, v10 row_newbcast:15 row_mask:0xf bank_mask:0xf
v_and_b32_dpp v75, v77, v11 row_newbcast:15 row_mask:0xf bank_mask:0xf
v_mfma_f32_16x16x32_bf16 v[20:23], v[60:63], a[240:243], v[20:23]
v_mfma_f32_16x16x32_bf16 v[20:23], v[64:67], a[244:247], v[20:23]
v_mfma_f32_16x16x32_bf16 v[20:23], v[68:71], a[248:251], v[20:23]
v_mfma_f32_16x16x32_bf16 v[20:23], v[72:75], a[252:255], v[20:23]
s_nop 3
v_and_b32_dpp v60, v85, v8 row_newbcast:2 row_mask:0xf bank_mask:0xf
v_and_b32_dpp v61, v85, v9 row_newbcast:2 row_mask:0xf bank_mask:0xf
v_and_b32_dpp v62, v85, v10 row_newbcast:2 row_mask:0xf bank_mask:0xf
v_and_b32_dpp v63, v85, v11 row_newbcast:2 row_mask:0xf bank_mask:0xf
v_and_b32_dpp v64, v85, v8 row_newbcast:6 row_mask:0xf bank_mask:0xf
v_and_b32_dpp v65, v85, v9 row_newbcast:6 row_mask:0xf bank_mask:0xf
v_and_b32_dpp v66, v85, v10 row_newbcast:6 row_mask:0xf bank_mask:0xf
v_and_b32_dpp v67, v85, v11 row_newbcast:6 row_mask:0xf bank_mask:0xf
v_and_b32_dpp v68, v85, v8 row_newbcast:10 row_mask:0xf bank_mask:0xf
v_and_b32_dpp v69, v85, v9 row_newbcast:10 row_mask:0xf bank_mask:0xf
v_and_b32_dpp v70, v85, v10 row_newbcast:10 row_mask:0xf bank_mask:0xf
v_and_b32_dpp v71, v85, v11 row_newbcast:10 row_mask:0xf bank_mask:0xf
v_and_b32_dpp v72, v85, v8 row_newbcast:14 row_mask:0xf bank_mask:0xf
v_and_b32_dpp v73, v85, v9 row_newbcast:14 row_mask:0xf bank_mask:0xf
v_and_b32_dpp v74, v85, v10 row_newbcast:14 row_mask:0xf bank_mask:0xf
v_and_b32_dpp v75, v85, v11 row_newbcast:14 row_mask:0xf bank_mask:0xf
s_waitcnt vmcnt(15)
v_mfma_f32_16x16x32_bf16 v[20:23], v[60:63], v[152:155], v[20:23]
v_mfma_f32_16x16x32_bf16 v[20:23], v[64:67], v[156:159], v[20:23]
v_mfma_f32_16x16x32_bf16 v[20:23], v[68:71], v[160:163], v[20:23]
v_mfma_f32_16x16x32_bf16 v[20:23], v[72:75], v[164:167], v[20:23]
v_add_u32 v117, 1, v117
buffer_store_dword v117, v118, s[64:67], 0 offen
buffer_load_dwordx4 v[216:219], v2, s[52:55], s12 offen offset:0 nt
buffer_load_dwordx4 v[220:223], v2, s[52:55], s12 offen offset:1024 nt
buffer_load_dwordx4 v[224:227], v2, s[52:55], s12 offen offset:2048 nt
buffer_load_dwordx4 v[228:231], v2, s[52:55], s12 offen offset:3072 nt
s_add_u32 s13, s13, 24576
s_min_u32 s12, s13, 2146435072
v_and_b32_dpp v60, v85, v8 row_newbcast:3 row_mask:0xf bank_mask:0xf
v_and_b32_dpp v61, v85, v9 row_newbcast:3 row_mask:0xf bank_mask:0xf
v_and_b32_dpp v62, v85, v10 row_newbcast:3 row_mask:0xf bank_mask:0xf
v_and_b32_dpp v63, v85, v11 row_newbcast:3 row_mask:0xf bank_mask:0xf
v_and_b32_dpp v64, v85, v8 row_newbcast:7 row_mask:0xf bank_mask:0xf
v_and_b32_dpp v65, v85, v9 row_newbcast:7 row_mask:0xf bank_mask:0xf
v_and_b32_dpp v66, v85, v10 row_newbcast:7 row_mask:0xf bank_mask:0xf
v_and_b32_dpp v67, v85, v11 row_newbcast:7 row_mask:0xf bank_mask:0xf
v_and_b32_dpp v68, v85, v8 row_newbcast:11 row_mask:0xf bank_mask:0xf
v_and_b32_dpp v69, v85, v9 row_newbcast:11 row_mask:0xf bank_mask:0xf
v_and_b32_dpp v70, v85, v10 row_newbcast:11 row_mask:0xf bank_mask:0xf
v_and_b32_dpp v71, v85, v11 row_newbcast:11 row_mask:0xf bank_mask:0xf
v_and_b32_dpp v72, v85, v8 row_newbcast:15 row_mask:0xf bank_mask:0xf
v_and_b32_dpp v73, v85, v9 row_newbcast:15 row_mask:0xf bank_mask:0xf
v_and_b32_dpp v74, v85, v10 row_newbcast:15 row_mask:0xf bank_mask:0xf
v_and_b32_dpp v75, v85, v11 row_newbcast:15 row_mask:0xf bank_mask:0xf
s_waitcnt vmcnt(15)
v_mfma_f32_16x16x32_bf16 v[20:23], v[60:63], v[168:171], v[20:23]
v_mfma_f32_16x16x32_bf16 v[20:23], v[64:67], v[172:175], v[20:23]
v_mfma_f32_16x16x32_bf16 v[20:23], v[68:71], v[176:179], v[20:23]
v_mfma_f32_16x16x32_bf16 v[20:23], v[72:75], v[180:183], v[20:23]
v_add_u32 v117, 1, v117
buffer_store_dword v117, v118, s[64:67], 0 offen
buffer_load_dwordx4 v[232:235], v2, s[52:55], s12 offen offset:0 nt
buffer_load_dwordx4 v[236:239], v2, s[52:55], s12 offen offset:1024 nt
buffer_load_dwordx4 v[240:243], v2, s[52:55], s12 offen offset:2048 nt
buffer_load_dwordx4 v[244:247], v2, s[52:55], s12 offen offset:3072 nt
s_add_u32 s13, s13, 24576
s_min_u32 s12, s13, 2146435072
v_mov_b32 v40, 0
v_mov_b32 v41, 0
v_mov_b32 v42, 0
v_mov_b32 v43, 0
v_mov_b32 v44, 0
v_mov_b32 v45, 0
v_mov_b32 v46, 0
v_mov_b32 v47, 0
v_mov_b32 v48, 0
v_mov_b32 v49, 0
v_mov_b32 v50, 0
v_mov_b32 v51, 0
v_mov_b32 v52, 0
v_mov_b32 v53, 0
v_mov_b32 v54, 0
v_mov_b32 v55, 0
v_and_b32_dpp v120, v86, v8 row_newbcast:0 row_mask:0xf bank_mask:0xf
v_and_b32_dpp v121, v86, v9 row_newbcast:0 row_mask:0xf bank_mask:0xf
v_and_b32_dpp v122, v86, v10 row_newbcast:0 row_mask:0xf bank_mask:0xf
v_and_b32_dpp v123, v86, v11 row_newbcast:0 row_mask:0xf bank_mask:0xf
v_and_b32_dpp v124, v86, v8 row_newbcast:4 row_mask:0xf bank_mask:0xf
v_and_b32_dpp v125, v86, v9 row_newbcast:4 row_mask:0xf bank_mask:0xf
v_and_b32_dpp v126, v86, v10 row_newbcast:4 row_mask:0xf bank_mask:0xf
v_and_b32_dpp v127, v86, v11 row_newbcast:4 row_mask:0xf bank_mask:0xf
v_and_b32_dpp v128, v86, v8 row_newbcast:8 row_mask:0xf bank_mask:0xf
v_and_b32_dpp v129, v86, v9 row_newbcast:8 row_mask:0xf bank_mask:0xf
v_and_b32_dpp v130, v86, v10 row_newbcast:8 row_mask:0xf bank_mask:0xf
v_and_b32_dpp v131, v86, v11 row_newbcast:8 row_mask:0xf bank_mask:0xf
v_and_b32_dpp v132, v86, v8 row_newbcast:12 row_mask:0xf bank_mask:0xf
v_and_b32_dpp v133, v86, v9 row_newbcast:12 row_mask:0xf bank_mask:0xf
v_and_b32_dpp v134, v86, v10 row_newbcast:12 row_mask:0xf bank_mask:0xf
v_and_b32_dpp v135, v86, v11 row_newbcast:12 row_mask:0xf bank_mask:0xf
v_and_b32_dpp v136, v86, v8 row_newbcast:1 row_mask:0xf bank_mask:0xf
v_and_b32_dpp v137, v86, v9 row_newbcast:1 row_mask:0xf bank_mask:0xf
v_and_b32_dpp v138, v86, v10 row_newbcast:1 row_mask:0xf bank_mask:0xf
v_and_b32_dpp v139, v86, v11 row_newbcast:1 row_mask:0xf bank_mask:0xf
v_and_b32_dpp v140, v86, v8 row_newbcast:5 row_mask:0xf bank_mask:0xf
v_and_b32_dpp v141, v86, v9 row_newbcast:5 row_mask:0xf bank_mask:0xf
v_and_b32_dpp v142, v86, v10 row_newbcast:5 row_mask:0xf bank_mask:0xf
v_and_b32_dpp v143, v86, v11 row_newbcast:5 row_mask:0xf bank_mask:0xf
v_and_b32_dpp v144, v86, v8 row_newbcast:9 row_mask:0xf bank_mask:0xf
v_and_b32_dpp v145, v86, v9 row_newbcast:9 row_mask:0xf bank_mask:0xf
v_and_b32_dpp v146, v86, v10 row_newbcast:9 row_mask:0xf bank_mask:0xf
v_and_b32_dpp v147, v86, v11 row_newbcast:9 row_mask:0xf bank_mask:0xf
v_and_b32_dpp v148, v86, v8 row_newbcast:13 row_mask:0xf bank_mask:0xf
v_and_b32_dpp v149, v86, v9 row_newbcast:13 row_mask:0xf bank_mask:0xf
v_and_b32_dpp v150, v86, v10 row_newbcast:13 row_mask:0xf bank_mask:0xf
v_and_b32_dpp v151, v86, v11 row_newbcast:13 row_mask:0xf bank_mask:0xf
v_and_b32_dpp v152, v86, v8 row_newbcast:2 row_mask:0xf bank_mask:0xf
v_and_b32_dpp v153, v86, v9 row_newbcast:2 row_mask:0xf bank_mask:0xf
v_and_b32_dpp v154, v86, v10 row_newbcast:2 row_mask:0xf bank_mask:0xf
v_and_b32_dpp v155, v86, v11 row_newbcast:2 row_mask:0xf bank_mask:0xf
v_and_b32_dpp v156, v86, v8 row_newbcast:6 row_mask:0xf bank_mask:0xf
v_and_b32_dpp v157, v86, v9 row_newbcast:6 row_mask:0xf bank_mask:0xf
v_and_b32_dpp v158, v86, v10 row_newbcast:6 row_mask:0xf bank_mask:0xf
v_and_b32_dpp v159, v86, v11 row_newbcast:6 row_mask:0xf bank_mask:0xf
v_and_b32_dpp v160, v86, v8 row_newbcast:10 row_mask:0xf bank_mask:0xf
v_and_b32_dpp v161, v86, v9 row_newbcast:10 row_mask:0xf bank_mask:0xf
v_and_b32_dpp v162, v86, v10 row_newbcast:10 row_mask:0xf bank_mask:0xf
v_and_b32_dpp v163, v86, v11 row_newbcast:10 row_mask:0xf bank_mask:0xf
v_and_b32_dpp v164, v86, v8 row_newbcast:14 row_mask:0xf bank_mask:0xf
v_and_b32_dpp v165, v86, v9 row_newbcast:14 row_mask:0xf bank_mask:0xf
v_and_b32_dpp v166, v86, v10 row_newbcast:14 row_mask:0xf bank_mask:0xf
v_and_b32_dpp v167, v86, v11 row_newbcast:14 row_mask:0xf bank_mask:0xf
v_and_b32_dpp v168, v86, v8 row_newbcast:3 row_mask:0xf bank_mask:0xf
v_and_b32_dpp v169, v86, v9 row_newbcast:3 row_mask:0xf bank_mask:0xf
v_and_b32_dpp v170, v86, v10 row_newbcast:3 row_mask:0xf bank_mask:0xf
v_and_b32_dpp v171, v86, v11 row_newbcast:3 row_mask:0xf bank_mask:0xf
v_and_b32_dpp v172, v86, v8 row_newbcast:7 row_mask:0xf bank_mask:0xf
v_and_b32_dpp v173, v86, v9 row_newbcast:7 row_mask:0xf bank_mask:0xf
v_and_b32_dpp v174, v86, v10 row_newbcast:7 row_mask:0xf bank_mask:0xf
v_and_b32_dpp v175, v86, v11 row_newbcast:7 row_mask:0xf bank_mask:0xf
v_and_b32_dpp v176, v86, v8 row_newbcast:11 row_mask:0xf bank_mask:0xf
v_and_b32_dpp v177, v86, v9 row_newbcast:11 row_mask:0xf bank_mask:0xf
v_and_b32_dpp v178, v86, v10 row_newbcast:11 row_mask:0xf bank_mask:0xf
v_and_b32_dpp v179, v86, v11 row_newbcast:11 row_mask:0xf bank_mask:0xf
v_and_b32_dpp v180, v86, v8 row_newbcast:15 row_mask:0xf bank_mask:0xf
v_and_b32_dpp v181, v86, v9 row_newbcast:15 row_mask:0xf bank_mask:0xf
v_and_b32_dpp v182, v86, v10 row_newbcast:15 row_mask:0xf bank_mask:0xf
v_and_b32_dpp v183, v86, v11 row_newbcast:15 row_mask:0xf bank_mask:0xf
s_waitcnt vmcnt(15)
v_mfma_f32_16x16x32_bf16 v[20:23], v[120:123], v[184:187], v[20:23]
v_mfma_f32_16x16x32_bf16 v[20:23], v[124:127], v[188:191], v[20:23]
v_mfma_f32_16x16x32_bf16 v[20:23], v[128:131], v[192:195], v[20:23]
v_mfma_f32_16x16x32_bf16 v[20:23], v[132:135], v[196:199], v[20:23]
s_waitcnt vmcnt(10)
v_mfma_f32_16x16x32_bf16 v[20:23], v[136:139], v[200:203], v[20:23]
v_mfma_f32_16x16x32_bf16 v[20:23], v[140:143], v[204:207], v[20:23]
v_mfma_f32_16x16x32_bf16 v[20:23], v[144:147], v[208:211], v[20:23]
v_mfma_f32_16x16x32_bf16 v[20:23], v[148:151], v[212:215], v[20:23]
s_waitcnt vmcnt(5)
v_mfma_f32_16x16x32_bf16 v[20:23], v[152:155], v[216:219], v[20:23]
v_mfma_f32_16x16x32_bf16 v[20:23], v[156:159], v[220:223], v[20:23]
v_mfma_f32_16x16x32_bf16 v[20:23], v[160:163], v[224:227], v[20:23]
v_mfma_f32_16x16x32_bf16 v[20:23], v[164:167], v[228:231], v[20:23]
s_waitcnt vmcnt(3)
v_mfma_f32_16x16x32_bf16 v[20:23], v[168:171], v[232:235], v[20:23]
s_waitcnt vmcnt(2)
v_mfma_f32_16x16x32_bf16 v[20:23], v[172:175], v[236:239], v[20:23]
s_waitcnt vmcnt(1)
v_mfma_f32_16x16x32_bf16 v[20:23], v[176:179], v[240:243], v[20:23]
s_waitcnt vmcnt(0)
v_mfma_f32_16x16x32_bf16 v[20:23], v[180:183], v[244:247], v[20:23]
A_tail:
s_nop 7
v_mul_f32 v20, v20, v37
v_mul_f32 v21, v21, v37
v_mul_f32 v22, v22, v37
v_mul_f32 v23, v23, v37
v_cvt_pk_bf16_f32 v28, v20, v21
v_cvt_pk_bf16_f32 v29, v22, v23
ds_write_b64 v94, v[28:29]
s_waitcnt lgkmcnt(0)
s_barrier
ds_read_b128 a[0:3], v95 offset:0
ds_read_b128 a[4:7], v95 offset:64
ds_read_b128 a[8:11], v95 offset:128
ds_read_b128 a[12:15], v95 offset:192
s_waitcnt lgkmcnt(3)
v_mfma_f32_16x16x32_bf16 v[72:75], a[0:3], a[224:227], 0
s_waitcnt lgkmcnt(2)
v_mfma_f32_16x16x32_bf16 v[72:75], a[4:7], a[228:231], v[72:75]
s_waitcnt lgkmcnt(1)
v_mfma_f32_16x16x32_bf16 v[72:75], a[8:11], a[232:235], v[72:75]
s_waitcnt lgkmcnt(0)
v_mfma_f32_16x16x32_bf16 v[72:75], a[12:15], a[236:239], v[72:75]
v_smfmac_f32_16x16x64_bf16 v[40:43], a[0:3], a[96:103], v105
v_smfmac_f32_16x16x64_bf16 v[40:43], a[4:7], a[104:111], v105
v_smfmac_f32_16x16x64_bf16 v[40:43], a[8:11], a[112:119], v105
v_smfmac_f32_16x16x64_bf16 v[40:43], a[12:15], a[120:127], v105
v_smfmac_f32_16x16x64_bf16 v[44:47], a[0:3], a[128:135], v105
v_smfmac_f32_16x16x64_bf16 v[44:47], a[4:7], a[136:143], v105
v_smfmac_f32_16x16x64_bf16 v[44:47], a[8:11], a[144:151], v105
v_smfmac_f32_16x16x64_bf16 v[44:47], a[12:15], a[152:159], v105
v_pk_mul_f32 v[102:103], v[106:107], v[72:73]
v_pk_fma_f32 v[102:103], v[108:109], v[74:75], v[102:103]
v_smfmac_f32_16x16x64_bf16 v[48:51], a[0:3], a[160:167], v105
v_add_f32 v114, v102, v103
v_pk_mul_f32 v[102:103], v[106:107], v[40:41]
v_smfmac_f32_16x16x64_bf16 v[48:51], a[4:7], a[168:175], v105
v_pk_fma_f32 v[102:103], v[108:109], v[42:43], v[102:103]
v_mov_b32_dpp v29, v114 row_shl:2 row_mask:0xf bank_mask:0xf
v_smfmac_f32_16x16x64_bf16 v[48:51], a[8:11], a[176:183], v105
v_cvt_pk_bf16_f32 v28, v114, v29
v_min_u32 v28, -2, v28
v_smfmac_f32_16x16x64_bf16 v[48:51], a[12:15], a[184:191], v105
v_add_f32 v98, v102, v103
v_pk_mul_f32 v[102:103], v[106:107], v[44:45]
v_smfmac_f32_16x16x64_bf16 v[52:55], a[0:3], a[192:199], v105
v_mov_b32_dpp v29, v28 row_shl:4 row_mask:0xf bank_mask:0xf
v_mov_b32_dpp v30, v28 row_shl:8 row_mask:0xf bank_mask:0xf
v_smfmac_f32_16x16x64_bf16 v[52:55], a[4:7], a[200:207], v105
v_mov_b32_dpp v31, v28 row_shl:12 row_mask:0xf bank_mask:0xf
s_mov_b64 exec, 0x00030003
buffer_store_dwordx4 v[28:31], v93, s[64:67], 0 offen offset:1024 sc1
s_mov_b64 exec, -1
v_smfmac_f32_16x16x64_bf16 v[52:55], a[8:11], a[208:215], v105
v_pk_fma_f32 v[102:103], v[108:109], v[46:47], v[102:103]
v_add_f32 v99, v102, v103
v_smfmac_f32_16x16x64_bf16 v[52:55], a[12:15], a[216:223], v105
v_cvt_pk_bf16_f32 v110, v98, v99
v_min_u32 v110, -2, v110
v_pk_mul_f32 v[102:103], v[106:107], v[48:49]
v_pk_fma_f32 v[102:103], v[108:109], v[50:51], v[102:103]
v_add_f32 v100, v102, v103
v_permlane32_swap_b32 v110, v112
s_nop 1
v_pk_mul_f32 v[102:103], v[106:107], v[52:53]
v_pk_fma_f32 v[102:103], v[108:109], v[54:55], v[102:103]
v_add_f32 v101, v102, v103
v_cvt_pk_bf16_f32 v111, v100, v101
v_min_u32 v111, -2, v111
s_nop 1
v_permlane32_swap_b32 v111, v113
s_mov_b64 exec, 0xffffffff
buffer_store_dwordx4 v[110:113], v92, s[64:67], 0 offen sc1
s_mov_b64 exec, -1
s_endpgm
L_exit:
s_endpgm
B_role:
s_mov_b32 s8, s5
s_lshl_b32 s9, s4, 1
s_add_u32 s9, s9, s8
v_and_b32 v1, 63, v0
v_lshlrev_b32 v2, 4, v1
v_lshrrev_b32 v9, 4, v1
v_and_b32 v8, 15, v1
s_cmp_eq_u32 s8, 1
s_cbranch_scc1 D_role
v_mul_u32_u24 v3, 294912, v9
v_lshl_add_u32 v3, v8, 4, v3
v_mul_u32_u24 v4, 72, v9
v_lshrrev_b32 v6, 3, v8
v_mul_u32_u24 v6, 1152, v6
v_add_u32 v4, v4, v6
v_lshlrev_b32 v238, 17, v9
v_lshl_add_u32 v238, v8, 4, v238
s_waitcnt lgkmcnt(0)
s_mul_i32 s6, s3, 288
s_sub_u32 s7, 4608, s6
s_add_u32 s44, s26, s6
s_addc_u32 s45, s27, 0
s_mov_b32 s46, s7
s_mov_b32 s47, 0x20000
s_mul_i32 s6, s3, 1179648
s_lshl_b32 s7, s4, 8
s_add_u32 s6, s6, s7
s_sub_u32 s7, 4718592, s6
s_add_u32 s48, s30, s6
s_addc_u32 s49, s31, 0
s_mov_b32 s50, s7
s_mov_b32 s51, 0x20000
buffer_load_dwordx4 v[24:27], v4, s[44:47], 0 offen offset:0
buffer_load_dwordx4 v[28:31], v4, s[44:47], 0 offen offset:16
buffer_load_dwordx4 v[32:35], v4, s[44:47], 0 offen offset:32
buffer_load_dwordx4 v[36:39], v4, s[44:47], 0 offen offset:48
buffer_load_dwordx2 v[40:41], v4, s[44:47], 0 offen offset:64
buffer_load_dwordx4 v[44:47], v4, s[44:47], 0 offen offset:2304
buffer_load_dwordx4 v[48:51], v4, s[44:47], 0 offen offset:2320
buffer_load_dwordx4 v[52:55], v4, s[44:47], 0 offen offset:2336
buffer_load_dwordx4 v[56:59], v4, s[44:47], 0 offen offset:2352
buffer_load_dwordx2 v[60:61], v4, s[44:47], 0 offen offset:2368
s_mov_b32 s6, 0
buffer_load_dwordx4 a[96:99], v3, s[48:51], s6 offen nt
s_mov_b32 s6, 8192
buffer_load_dwordx4 a[100:103], v3, s[48:51], s6 offen nt
s_mov_b32 s6, 16384
buffer_load_dwordx4 a[104:107], v3, s[48:51], s6 offen nt
s_mov_b32 s6, 24576
buffer_load_dwordx4 a[108:111], v3, s[48:51], s6 offen nt
s_mov_b32 s6, 32768
buffer_load_dwordx4 a[112:115], v3, s[48:51], s6 offen nt
s_mov_b32 s6, 40960
buffer_load_dwordx4 a[116:119], v3, s[48:51], s6 offen nt
s_mov_b32 s6, 49152
buffer_load_dwordx4 a[120:123], v3, s[48:51], s6 offen nt
s_mov_b32 s6, 57344
buffer_load_dwordx4 a[124:127], v3, s[48:51], s6 offen nt
s_mov_b32 s6, 65536
buffer_load_dwordx4 a[128:131], v3, s[48:51], s6 offen nt
s_mov_b32 s6, 73728
buffer_load_dwordx4 a[132:135], v3, s[48:51], s6 offen nt
s_mov_b32 s6, 81920
buffer_load_dwordx4 a[136:139], v3, s[48:51], s6 offen nt
s_mov_b32 s6, 90112
buffer_load_dwordx4 a[140:143], v3, s[48:51], s6 offen nt
s_mov_b32 s6, 98304
buffer_load_dwordx4 a[144:147], v3, s[48:51], s6 offen nt
s_mov_b32 s6, 106496
buffer_load_dwordx4 a[148:151], v3, s[48:51], s6 offen nt
s_mov_b32 s6, 114688
buffer_load_dwordx4 a[152:155], v3, s[48:51], s6 offen nt
s_mov_b32 s6, 122880
buffer_load_dwordx4 a[156:159], v3, s[48:51], s6 offen nt
s_mov_b32 s6, 131072
buffer_load_dwordx4 a[160:163], v3, s[48:51], s6 offen nt
s_mov_b32 s6, 139264
buffer_load_dwordx4 a[164:167], v3, s[48:51], s6 offen nt
s_mov_b32 s6, 147456
buffer_load_dwordx4 a[168:171], v3, s[48:51], s6 offen nt
s_mov_b32 s6, 155648
buffer_load_dwordx4 a[172:175], v3, s[48:51], s6 offen nt
s_mov_b32 s6, 163840
buffer_load_dwordx4 a[176:179], v3, s[48:51], s6 offen nt
s_mov_b32 s6, 172032
buffer_load_dwordx4 a[180:183], v3, s[48:51], s6 offen nt
s_mov_b32 s6, 180224
buffer_load_dwordx4 a[184:187], v3, s[48:51], s6 offen nt
s_mov_b32 s6, 188416
buffer_load_dwordx4 a[188:191], v3, s[48:51], s6 offen nt
s_mov_b32 s6, 196608
buffer_load_dwordx4 a[192:195], v3, s[48:51], s6 offen nt
s_mov_b32 s6, 204800
buffer_load_dwordx4 a[196:199], v3, s[48:51], s6 offen nt
s_mov_b32 s6, 212992
buffer_load_dwordx4 a[200:203], v3, s[48:51], s6 offen nt
s_mov_b32 s6, 221184
buffer_load_dwordx4 a[204:207], v3, s[48:51], s6 offen nt
s_mov_b32 s6, 229376
buffer_load_dwordx4 a[208:211], v3, s[48:51], s6 offen nt
s_mov_b32 s6, 237568
buffer_load_dwordx4 a[212:215], v3, s[48:51], s6 offen nt
s_mov_b32 s6, 245760
buffer_load_dwordx4 a[216:219], v3, s[48:51], s6 offen nt
s_mov_b32 s6, 253952
buffer_load_dwordx4 a[220:223], v3, s[48:51], s6 offen nt
s_mov_b32 s6, 262144
buffer_load_dwordx4 a[224:227], v3, s[48:51], s6 offen nt
s_mov_b32 s6, 270336
buffer_load_dwordx4 a[228:231], v3, s[48:51], s6 offen nt
s_mov_b32 s6, 278528
buffer_load_dwordx4 a[232:235], v3, s[48:51], s6 offen nt
s_mov_b32 s6, 286720
buffer_load_dwordx4 a[236:239], v3, s[48:51], s6 offen nt
s_lshl_b32 s6, s3, 20
s_lshl_b32 s7, s4, 8
s_add_u32 s6, s6, s7
s_sub_u32 s7, 4194304, s6
s_add_u32 s76, s32, s6
s_addc_u32 s77, s33, 0
s_mov_b32 s78, s7
s_mov_b32 s79, 0x20000
s_add_u32 s52, s34, s6
s_addc_u32 s53, s35, 0
s_mov_b32 s54, s7
s_mov_b32 s55, 0x20000
s_mov_b32 s6, 0
buffer_load_dwordx4 v[88:91], v238, s[76:79], s6 offen nt
s_mov_b32 s6, 8192
buffer_load_dwordx4 v[92:95], v238, s[76:79], s6 offen nt
s_mov_b32 s6, 16384
buffer_load_dwordx4 v[96:99], v238, s[76:79], s6 offen nt
s_mov_b32 s6, 24576
buffer_load_dwordx4 v[100:103], v238, s[76:79], s6 offen nt
s_mov_b32 s6, 32768
buffer_load_dwordx4 v[104:107], v238, s[76:79], s6 offen nt
s_mov_b32 s6, 40960
buffer_load_dwordx4 v[108:111], v238, s[76:79], s6 offen nt
s_mov_b32 s6, 49152
buffer_load_dwordx4 v[112:115], v238, s[76:79], s6 offen nt
s_mov_b32 s6, 57344
buffer_load_dwordx4 v[116:119], v238, s[76:79], s6 offen nt
s_mov_b32 s6, 65536
buffer_load_dwordx4 v[120:123], v238, s[76:79], s6 offen nt
s_mov_b32 s6, 73728
buffer_load_dwordx4 v[124:127], v238, s[76:79], s6 offen nt
s_mov_b32 s6, 81920
buffer_load_dwordx4 v[128:131], v238, s[76:79], s6 offen nt
s_mov_b32 s6, 90112
buffer_load_dwordx4 v[132:135], v238, s[76:79], s6 offen nt
s_mov_b32 s64, s42
s_mov_b32 s65, s43
s_mov_b32 s66, 16777216
s_mov_b32 s67, 0x20000
s_mov_b32 s68, s40
s_mov_b32 s69, s41
s_mov_b32 s70, 256
s_mov_b32 s71, 0x20000
s_mov_b32 s72, s38
s_mov_b32 s73, s39
s_mov_b32 s74, 9216
s_mov_b32 s75, 0x20000
s_mul_i32 s6, s4, 147456
s_add_u32 s60, s36, s6
s_addc_u32 s61, s37, 0
s_mov_b32 s62, 147456
s_mov_b32 s63, 0x20000
v_and_b32 v5, 1, v1
v_lshlrev_b32 v5, 4, v5
v_mov_b32 v6, 0xffff
v_lshlrev_b32 v5, v5, v6
v_bfe_u32 v6, v1, 1, 2
v_cmp_eq_u32 vcc, 0, v6
s_nop 1
v_cndmask_b32 v12, 0, v5, vcc
v_cmp_eq_u32 vcc, 1, v6
s_nop 1
v_cndmask_b32 v13, 0, v5, vcc
v_cmp_eq_u32 vcc, 2, v6
s_nop 1
v_cndmask_b32 v14, 0, v5, vcc
v_cmp_eq_u32 vcc, 3, v6
s_nop 1
v_cndmask_b32 v15, 0, v5, vcc
v_mov_b32 v5, 0x0c0c0c0c
s_mov_b32 s6, 0x01000100
s_mov_b32 s7, 0x03020302
v_bfi_b32 v16, v12, s6, v5
v_bfi_b32 v17, v13, s6, v5
v_bfi_b32 v18, v14, s6, v5
v_bfi_b32 v19, v15, s6, v5
v_bfi_b32 v20, v12, s7, v5
v_bfi_b32 v21, v13, s7, v5
v_bfi_b32 v22, v14, s7, v5
v_bfi_b32 v23, v15, s7, v5
v_lshrrev_b32 v5, 4, v1
v_lshlrev_b32 v5, 3, v5
v_bfe_u32 v6, v1, 2, 2
v_add_u32 v5, v5, v6
v_mul_u32_u24 v5, 1152, v5
s_mul_i32 s6, s3, 288
v_add_u32 v5, s6, v5
v_and_b32 v6, 3, v1
v_lshl_add_u32 v240, v6, 5, v5
v_lshl_add_u32 v241, v6, 3, v5
v_add_u32 v241, 256, v241
v_add_u32 v242, 73728, v240
v_add_u32 v243, 73728, v241
s_mul_i32 s12, s3, 36864
s_waitcnt vmcnt(47)
v_perm_b32 v64, v24, v24, v16
v_perm_b32 v65, v24, v24, v17
v_perm_b32 v66, v24, v24, v18
v_perm_b32 v67, v24, v24, v19
s_nop 1
v_mfma_f32_16x16x32_bf16 v[80:83], v[64:67], a[96:99], 0
v_perm_b32 v68, v44, v44, v16
v_perm_b32 v69, v44, v44, v17
v_perm_b32 v70, v44, v44, v18
v_perm_b32 v71, v44, v44, v19
s_nop 1
v_mfma_f32_16x16x32_bf16 v[84:87], v[68:71], a[96:99], 0
s_mov_b32 s6, 98304
buffer_load_dwordx4 v[136:139], v238, s[76:79], s6 offen nt
s_waitcnt vmcnt(47)
v_perm_b32 v72, v24, v24, v20
v_perm_b32 v73, v24, v24, v21
v_perm_b32 v74, v24, v24, v22
v_perm_b32 v75, v24, v24, v23
s_nop 1
v_mfma_f32_16x16x32_bf16 v[80:83], v[72:75], a[100:103], v[80:83]
v_perm_b32 v76, v44, v44, v20
v_perm_b32 v77, v44, v44, v21
v_perm_b32 v78, v44, v44, v22
v_perm_b32 v79, v44, v44, v23
s_nop 1
v_mfma_f32_16x16x32_bf16 v[84:87], v[76:79], a[100:103], v[84:87]
s_mov_b32 s6, 106496
buffer_load_dwordx4 v[140:143], v238, s[76:79], s6 offen nt
s_waitcnt vmcnt(47)
v_perm_b32 v64, v25, v25, v16
v_perm_b32 v65, v25, v25, v17
v_perm_b32 v66, v25, v25, v18
v_perm_b32 v67, v25, v25, v19
s_nop 1
v_mfma_f32_16x16x32_bf16 v[80:83], v[64:67], a[104:107], v[80:83]
v_perm_b32 v68, v45, v45, v16
v_perm_b32 v69, v45, v45, v17
v_perm_b32 v70, v45, v45, v18
v_perm_b32 v71, v45, v45, v19
s_nop 1
v_mfma_f32_16x16x32_bf16 v[84:87], v[68:71], a[104:107], v[84:87]
s_mov_b32 s6, 114688
buffer_load_dwordx4 v[144:147], v238, s[76:79], s6 offen nt
s_waitcnt vmcnt(47)
v_perm_b32 v72, v25, v25, v20
v_perm_b32 v73, v25, v25, v21
v_perm_b32 v74, v25, v25, v22
v_perm_b32 v75, v25, v25, v23
s_nop 1
v_mfma_f32_16x16x32_bf16 v[80:83], v[72:75], a[108:111], v[80:83]
v_perm_b32 v76, v45, v45, v20
v_perm_b32 v77, v45, v45, v21
v_perm_b32 v78, v45, v45, v22
v_perm_b32 v79, v45, v45, v23
s_nop 1
v_mfma_f32_16x16x32_bf16 v[84:87], v[76:79], a[108:111], v[84:87]
s_mov_b32 s6, 122880
buffer_load_dwordx4 v[148:151], v238, s[76:79], s6 offen nt
s_waitcnt vmcnt(47)
v_perm_b32 v64, v26, v26, v16
v_perm_b32 v65, v26, v26, v17
v_perm_b32 v66, v26, v26, v18
v_perm_b32 v67, v26, v26, v19
s_nop 1
v_mfma_f32_16x16x32_bf16 v[80:83], v[64:67], a[112:115], v[80:83]
v_perm_b32 v68, v46, v46, v16
v_perm_b32 v69, v46, v46, v17
v_perm_b32 v70, v46, v46, v18
v_perm_b32 v71, v46, v46, v19
s_nop 1
v_mfma_f32_16x16x32_bf16 v[84:87], v[68:71], a[112:115], v[84:87]
s_mov_b32 s6, 524288
buffer_load_dwordx4 v[152:155], v238, s[76:79], s6 offen nt
s_waitcnt vmcnt(47)
v_perm_b32 v72, v26, v26, v20
v_perm_b32 v73, v26, v26, v21
v_perm_b32 v74, v26, v26, v22
v_perm_b32 v75, v26, v26, v23
s_nop 1
v_mfma_f32_16x16x32_bf16 v[80:83], v[72:75], a[116:119], v[80:83]
v_perm_b32 v76, v46, v46, v20
v_perm_b32 v77, v46, v46, v21
v_perm_b32 v78, v46, v46, v22
v_perm_b32 v79, v46, v46, v23
s_nop 1
v_mfma_f32_16x16x32_bf16 v[84:87], v[76:79], a[116:119], v[84:87]
s_mov_b32 s6, 532480
buffer_load_dwordx4 v[156:159], v238, s[76:79], s6 offen nt
s_waitcnt vmcnt(47)
v_perm_b32 v64, v27, v27, v16
v_perm_b32 v65, v27, v27, v17
v_perm_b32 v66, v27, v27, v18
v_perm_b32 v67, v27, v27, v19
s_nop 1
v_mfma_f32_16x16x32_bf16 v[80:83], v[64:67], a[120:123], v[80:83]
v_perm_b32 v68, v47, v47, v16
v_perm_b32 v69, v47, v47, v17
v_perm_b32 v70, v47, v47, v18
v_perm_b32 v71, v47, v47, v19
s_nop 1
v_mfma_f32_16x16x32_bf16 v[84:87], v[68:71], a[120:123], v[84:87]
s_mov_b32 s6, 540672
buffer_load_dwordx4 v[160:163], v238, s[76:79], s6 offen nt
s_waitcnt vmcnt(47)
v_perm_b32 v72, v27, v27, v20
v_perm_b32 v73, v27, v27, v21
v_perm_b32 v74, v27, v27, v22
v_perm_b32 v75, v27, v27, v23
s_nop 1
v_mfma_f32_16x16x32_bf16 v[80:83], v[72:75], a[124:127], v[80:83]
v_perm_b32 v76, v47, v47, v20
v_perm_b32 v77, v47, v47, v21
v_perm_b32 v78, v47, v47, v22
v_perm_b32 v79, v47, v47, v23
s_nop 1
v_mfma_f32_16x16x32_bf16 v[84:87], v[76:79], a[124:127], v[84:87]
s_mov_b32 s6, 548864
buffer_load_dwordx4 v[164:167], v238, s[76:79], s6 offen nt
s_waitcnt vmcnt(47)
v_perm_b32 v64, v28, v28, v16
v_perm_b32 v65, v28, v28, v17
v_perm_b32 v66, v28, v28, v18
v_perm_b32 v67, v28, v28, v19
s_nop 1
v_mfma_f32_16x16x32_bf16 v[80:83], v[64:67], a[128:131], v[80:83]
v_perm_b32 v68, v48, v48, v16
v_perm_b32 v69, v48, v48, v17
v_perm_b32 v70, v48, v48, v18
v_perm_b32 v71, v48, v48, v19
s_nop 1
v_mfma_f32_16x16x32_bf16 v[84:87], v[68:71], a[128:131], v[84:87]
s_mov_b32 s6, 557056
buffer_load_dwordx4 v[168:171], v238, s[76:79], s6 offen nt
s_waitcnt vmcnt(47)
v_perm_b32 v72, v28, v28, v20
v_perm_b32 v73, v28, v28, v21
v_perm_b32 v74, v28, v28, v22
v_perm_b32 v75, v28, v28, v23
s_nop 1
v_mfma_f32_16x16x32_bf16 v[80:83], v[72:75], a[132:135], v[80:83]
v_perm_b32 v76, v48, v48, v20
v_perm_b32 v77, v48, v48, v21
v_perm_b32 v78, v48, v48, v22
v_perm_b32 v79, v48, v48, v23
s_nop 1
v_mfma_f32_16x16x32_bf16 v[84:87], v[76:79], a[132:135], v[84:87]
s_mov_b32 s6, 565248
buffer_load_dwordx4 v[172:175], v238, s[76:79], s6 offen nt
s_waitcnt vmcnt(47)
v_perm_b32 v64, v29, v29, v16
v_perm_b32 v65, v29, v29, v17
v_perm_b32 v66, v29, v29, v18
v_perm_b32 v67, v29, v29, v19
s_nop 1
v_mfma_f32_16x16x32_bf16 v[80:83], v[64:67], a[136:139], v[80:83]
v_perm_b32 v68, v49, v49, v16
v_perm_b32 v69, v49, v49, v17
v_perm_b32 v70, v49, v49, v18
v_perm_b32 v71, v49, v49, v19
s_nop 1
v_mfma_f32_16x16x32_bf16 v[84:87], v[68:71], a[136:139], v[84:87]
s_mov_b32 s6, 573440
buffer_load_dwordx4 v[176:179], v238, s[76:79], s6 offen nt
s_waitcnt vmcnt(47)
v_perm_b32 v72, v29, v29, v20
v_perm_b32 v73, v29, v29, v21
v_perm_b32 v74, v29, v29, v22
v_perm_b32 v75, v29, v29, v23
s_nop 1
v_mfma_f32_16x16x32_bf16 v[80:83], v[72:75], a[140:143], v[80:83]
v_perm_b32 v76, v49, v49, v20
v_perm_b32 v77, v49, v49, v21
v_perm_b32 v78, v49, v49, v22
v_perm_b32 v79, v49, v49, v23
s_nop 1
v_mfma_f32_16x16x32_bf16 v[84:87], v[76:79], a[140:143], v[84:87]
s_mov_b32 s6, 581632
buffer_load_dwordx4 v[180:183], v238, s[76:79], s6 offen nt
s_waitcnt vmcnt(47)
v_perm_b32 v64, v30, v30, v16
v_perm_b32 v65, v30, v30, v17
v_perm_b32 v66, v30, v30, v18
v_perm_b32 v67, v30, v30, v19
s_nop 1
v_mfma_f32_16x16x32_bf16 v[80:83], v[64:67], a[144:147], v[80:83]
v_perm_b32 v68, v50, v50, v16
v_perm_b32 v69, v50, v50, v17
v_perm_b32 v70, v50, v50, v18
v_perm_b32 v71, v50, v50, v19
s_nop 1
v_mfma_f32_16x16x32_bf16 v[84:87], v[68:71], a[144:147], v[84:87]
s_mov_b32 s6, 589824
buffer_load_dwordx4 v[184:187], v238, s[76:79], s6 offen nt
s_waitcnt vmcnt(47)
v_perm_b32 v72, v30, v30, v20
v_perm_b32 v73, v30, v30, v21
v_perm_b32 v74, v30, v30, v22
v_perm_b32 v75, v30, v30, v23
s_nop 1
v_mfma_f32_16x16x32_bf16 v[80:83], v[72:75], a[148:151], v[80:83]
v_perm_b32 v76, v50, v50, v20
v_perm_b32 v77, v50, v50, v21
v_perm_b32 v78, v50, v50, v22
v_perm_b32 v79, v50, v50, v23
s_nop 1
v_mfma_f32_16x16x32_bf16 v[84:87], v[76:79], a[148:151], v[84:87]
s_mov_b32 s6, 598016
buffer_load_dwordx4 v[188:191], v238, s[76:79], s6 offen nt
s_waitcnt vmcnt(47)
v_perm_b32 v64, v31, v31, v16
v_perm_b32 v65, v31, v31, v17
v_perm_b32 v66, v31, v31, v18
v_perm_b32 v67, v31, v31, v19
s_nop 1
v_mfma_f32_16x16x32_bf16 v[80:83], v[64:67], a[152:155], v[80:83]
v_perm_b32 v68, v51, v51, v16
v_perm_b32 v69, v51, v51, v17
v_perm_b32 v70, v51, v51, v18
v_perm_b32 v71, v51, v51, v19
s_nop 1
v_mfma_f32_16x16x32_bf16 v[84:87], v[68:71], a[152:155], v[84:87]
s_mov_b32 s6, 606208
buffer_load_dwordx4 v[192:195], v238, s[76:79], s6 offen nt
s_waitcnt vmcnt(47)
v_perm_b32 v72, v31, v31, v20
v_perm_b32 v73, v31, v31, v21
v_perm_b32 v74, v31, v31, v22
v_perm_b32 v75, v31, v31, v23
s_nop 1
v_mfma_f32_16x16x32_bf16 v[80:83], v[72:75], a[156:159], v[80:83]
v_perm_b32 v76, v51, v51, v20
v_perm_b32 v77, v51, v51, v21
v_perm_b32 v78, v51, v51, v22
v_perm_b32 v79, v51, v51, v23
s_nop 1
v_mfma_f32_16x16x32_bf16 v[84:87], v[76:79], a[156:159], v[84:87]
s_mov_b32 s6, 614400
buffer_load_dwordx4 v[196:199], v238, s[76:79], s6 offen nt
s_waitcnt vmcnt(47)
v_perm_b32 v64, v32, v32, v16
v_perm_b32 v65, v32, v32, v17
v_perm_b32 v66, v32, v32, v18
v_perm_b32 v67, v32, v32, v19
s_nop 1
v_mfma_f32_16x16x32_bf16 v[80:83], v[64:67], a[160:163], v[80:83]
v_perm_b32 v68, v52, v52, v16
v_perm_b32 v69, v52, v52, v17
v_perm_b32 v70, v52, v52, v18
v_perm_b32 v71, v52, v52, v19
s_nop 1
v_mfma_f32_16x16x32_bf16 v[84:87], v[68:71], a[160:163], v[84:87]
s_mov_b32 s6, 622592
buffer_load_dwordx4 v[200:203], v238, s[76:79], s6 offen nt
s_waitcnt vmcnt(47)
v_perm_b32 v72, v32, v32, v20
v_perm_b32 v73, v32, v32, v21
v_perm_b32 v74, v32, v32, v22
v_perm_b32 v75, v32, v32, v23
s_nop 1
v_mfma_f32_16x16x32_bf16 v[80:83], v[72:75], a[164:167], v[80:83]
v_perm_b32 v76, v52, v52, v20
v_perm_b32 v77, v52, v52, v21
v_perm_b32 v78, v52, v52, v22
v_perm_b32 v79, v52, v52, v23
s_nop 1
v_mfma_f32_16x16x32_bf16 v[84:87], v[76:79], a[164:167], v[84:87]
s_mov_b32 s6, 630784
buffer_load_dwordx4 v[204:207], v238, s[76:79], s6 offen nt
s_waitcnt vmcnt(47)
v_perm_b32 v64, v33, v33, v16
v_perm_b32 v65, v33, v33, v17
v_perm_b32 v66, v33, v33, v18
v_perm_b32 v67, v33, v33, v19
s_nop 1
v_mfma_f32_16x16x32_bf16 v[80:83], v[64:67], a[168:171], v[80:83]
v_perm_b32 v68, v53, v53, v16
v_perm_b32 v69, v53, v53, v17
v_perm_b32 v70, v53, v53, v18
v_perm_b32 v71, v53, v53, v19
s_nop 1
v_mfma_f32_16x16x32_bf16 v[84:87], v[68:71], a[168:171], v[84:87]
s_mov_b32 s6, 638976
buffer_load_dwordx4 v[208:211], v238, s[76:79], s6 offen nt
s_waitcnt vmcnt(47)
v_perm_b32 v72, v33, v33, v20
v_perm_b32 v73, v33, v33, v21
v_perm_b32 v74, v33, v33, v22
v_perm_b32 v75, v33, v33, v23
s_nop 1
v_mfma_f32_16x16x32_bf16 v[80:83], v[72:75], a[172:175], v[80:83]
v_perm_b32 v76, v53, v53, v20
v_perm_b32 v77, v53, v53, v21
v_perm_b32 v78, v53, v53, v22
v_perm_b32 v79, v53, v53, v23
s_nop 1
v_mfma_f32_16x16x32_bf16 v[84:87], v[76:79], a[172:175], v[84:87]
s_mov_b32 s6, 647168
buffer_load_dwordx4 v[212:215], v238, s[76:79], s6 offen nt
s_waitcnt vmcnt(47)
v_perm_b32 v64, v34, v34, v16
v_perm_b32 v65, v34, v34, v17
v_perm_b32 v66, v34, v34, v18
v_perm_b32 v67, v34, v34, v19
s_nop 1
v_mfma_f32_16x16x32_bf16 v[80:83], v[64:67], a[176:179], v[80:83]
v_perm_b32 v68, v54, v54, v16
v_perm_b32 v69, v54, v54, v17
v_perm_b32 v70, v54, v54, v18
v_perm_b32 v71, v54, v54, v19
s_nop 1
v_mfma_f32_16x16x32_bf16 v[84:87], v[68:71], a[176:179], v[84:87]
buffer_load_dword v11, off, s[68:71], 0 offset:0 sc1
s_waitcnt vmcnt(47)
v_perm_b32 v72, v34, v34, v20
v_perm_b32 v73, v34, v34, v21
v_perm_b32 v74, v34, v34, v22
v_perm_b32 v75, v34, v34, v23
s_nop 1
v_mfma_f32_16x16x32_bf16 v[80:83], v[72:75], a[180:183], v[80:83]
v_perm_b32 v76, v54, v54, v20
v_perm_b32 v77, v54, v54, v21
v_perm_b32 v78, v54, v54, v22
v_perm_b32 v79, v54, v54, v23
s_nop 1
v_mfma_f32_16x16x32_bf16 v[84:87], v[76:79], a[180:183], v[84:87]
s_waitcnt vmcnt(46)
v_perm_b32 v64, v35, v35, v16
v_perm_b32 v65, v35, v35, v17
v_perm_b32 v66, v35, v35, v18
v_perm_b32 v67, v35, v35, v19
s_nop 1
v_mfma_f32_16x16x32_bf16 v[80:83], v[64:67], a[184:187], v[80:83]
v_perm_b32 v68, v55, v55, v16
v_perm_b32 v69, v55, v55, v17
v_perm_b32 v70, v55, v55, v18
v_perm_b32 v71, v55, v55, v19
s_nop 1
v_mfma_f32_16x16x32_bf16 v[84:87], v[68:71], a[184:187], v[84:87]
s_waitcnt vmcnt(45)
v_perm_b32 v72, v35, v35, v20
v_perm_b32 v73, v35, v35, v21
v_perm_b32 v74, v35, v35, v22
v_perm_b32 v75, v35, v35, v23
s_nop 1
v_mfma_f32_16x16x32_bf16 v[80:83], v[72:75], a[188:191], v[80:83]
v_perm_b32 v76, v55, v55, v20
v_perm_b32 v77, v55, v55, v21
v_perm_b32 v78, v55, v55, v22
v_perm_b32 v79, v55, v55, v23
s_nop 1
v_mfma_f32_16x16x32_bf16 v[84:87], v[76:79], a[188:191], v[84:87]
s_waitcnt vmcnt(44)
v_perm_b32 v64, v36, v36, v16
v_perm_b32 v65, v36, v36, v17
v_perm_b32 v66, v36, v36, v18
v_perm_b32 v67, v36, v36, v19
s_nop 1
v_mfma_f32_16x16x32_bf16 v[80:83], v[64:67], a[192:195], v[80:83]
v_perm_b32 v68, v56, v56, v16
v_perm_b32 v69, v56, v56, v17
v_perm_b32 v70, v56, v56, v18
v_perm_b32 v71, v56, v56, v19
s_nop 1
v_mfma_f32_16x16x32_bf16 v[84:87], v[68:71], a[192:195], v[84:87]
s_waitcnt vmcnt(43)
v_perm_b32 v72, v36, v36, v20
v_perm_b32 v73, v36, v36, v21
v_perm_b32 v74, v36, v36, v22
v_perm_b32 v75, v36, v36, v23
s_nop 1
v_mfma_f32_16x16x32_bf16 v[80:83], v[72:75], a[196:199], v[80:83]
v_perm_b32 v76, v56, v56, v20
v_perm_b32 v77, v56, v56, v21
v_perm_b32 v78, v56, v56, v22
v_perm_b32 v79, v56, v56, v23
s_nop 1
v_mfma_f32_16x16x32_bf16 v[84:87], v[76:79], a[196:199], v[84:87]
s_waitcnt vmcnt(42)
v_perm_b32 v64, v37, v37, v16
v_perm_b32 v65, v37, v37, v17
v_perm_b32 v66, v37, v37, v18
v_perm_b32 v67, v37, v37, v19
s_nop 1
v_mfma_f32_16x16x32_bf16 v[80:83], v[64:67], a[200:203], v[80:83]
v_perm_b32 v68, v57, v57, v16
v_perm_b32 v69, v57, v57, v17
v_perm_b32 v70, v57, v57, v18
v_perm_b32 v71, v57, v57, v19
s_nop 1
v_mfma_f32_16x16x32_bf16 v[84:87], v[68:71], a[200:203], v[84:87]
s_waitcnt vmcnt(41)
v_perm_b32 v72, v37, v37, v20
v_perm_b32 v73, v37, v37, v21
v_perm_b32 v74, v37, v37, v22
v_perm_b32 v75, v37, v37, v23
s_nop 1
v_mfma_f32_16x16x32_bf16 v[80:83], v[72:75], a[204:207], v[80:83]
v_perm_b32 v76, v57, v57, v20
v_perm_b32 v77, v57, v57, v21
v_perm_b32 v78, v57, v57, v22
v_perm_b32 v79, v57, v57, v23
s_nop 1
v_mfma_f32_16x16x32_bf16 v[84:87], v[76:79], a[204:207], v[84:87]
s_waitcnt vmcnt(40)
v_perm_b32 v64, v38, v38, v16
v_perm_b32 v65, v38, v38, v17
v_perm_b32 v66, v38, v38, v18
v_perm_b32 v67, v38, v38, v19
s_nop 1
v_mfma_f32_16x16x32_bf16 v[80:83], v[64:67], a[208:211], v[80:83]
v_perm_b32 v68, v58, v58, v16
v_perm_b32 v69, v58, v58, v17
v_perm_b32 v70, v58, v58, v18
v_perm_b32 v71, v58, v58, v19
s_nop 1
v_mfma_f32_16x16x32_bf16 v[84:87], v[68:71], a[208:211], v[84:87]
s_waitcnt vmcnt(39)
v_perm_b32 v72, v38, v38, v20
v_perm_b32 v73, v38, v38, v21
v_perm_b32 v74, v38, v38, v22
v_perm_b32 v75, v38, v38, v23
s_nop 1
v_mfma_f32_16x16x32_bf16 v[80:83], v[72:75], a[212:215], v[80:83]
v_perm_b32 v76, v58, v58, v20
v_perm_b32 v77, v58, v58, v21
v_perm_b32 v78, v58, v58, v22
v_perm_b32 v79, v58, v58, v23
s_nop 1
v_mfma_f32_16x16x32_bf16 v[84:87], v[76:79], a[212:215], v[84:87]
s_waitcnt vmcnt(38)
v_perm_b32 v64, v39, v39, v16
v_perm_b32 v65, v39, v39, v17
v_perm_b32 v66, v39, v39, v18
v_perm_b32 v67, v39, v39, v19
s_nop 1
v_mfma_f32_16x16x32_bf16 v[80:83], v[64:67], a[216:219], v[80:83]
v_perm_b32 v68, v59, v59, v16
v_perm_b32 v69, v59, v59, v17
v_perm_b32 v70, v59, v59, v18
v_perm_b32 v71, v59, v59, v19
s_nop 1
v_mfma_f32_16x16x32_bf16 v[84:87], v[68:71], a[216:219], v[84:87]
s_waitcnt vmcnt(37)
v_perm_b32 v72, v39, v39, v20
v_perm_b32 v73, v39, v39, v21
v_perm_b32 v74, v39, v39, v22
v_perm_b32 v75, v39, v39, v23
s_nop 1
v_mfma_f32_16x16x32_bf16 v[80:83], v[72:75], a[220:223], v[80:83]
v_perm_b32 v76, v59, v59, v20
v_perm_b32 v77, v59, v59, v21
v_perm_b32 v78, v59, v59, v22
v_perm_b32 v79, v59, v59, v23
s_nop 1
v_mfma_f32_16x16x32_bf16 v[84:87], v[76:79], a[220:223], v[84:87]
s_waitcnt vmcnt(36)
v_perm_b32 v64, v40, v40, v16
v_perm_b32 v65, v40, v40, v17
v_perm_b32 v66, v40, v40, v18
v_perm_b32 v67, v40, v40, v19
s_nop 1
v_mfma_f32_16x16x32_bf16 v[80:83], v[64:67], a[224:227], v[80:83]
v_perm_b32 v68, v60, v60, v16
v_perm_b32 v69, v60, v60, v17
v_perm_b32 v70, v60, v60, v18
v_perm_b32 v71, v60, v60, v19
s_nop 1
v_mfma_f32_16x16x32_bf16 v[84:87], v[68:71], a[224:227], v[84:87]
s_waitcnt vmcnt(35)
v_perm_b32 v72, v40, v40, v20
v_perm_b32 v73, v40, v40, v21
v_perm_b32 v74, v40, v40, v22
v_perm_b32 v75, v40, v40, v23
s_nop 1
v_mfma_f32_16x16x32_bf16 v[80:83], v[72:75], a[228:231], v[80:83]
v_perm_b32 v76, v60, v60, v20
v_perm_b32 v77, v60, v60, v21
v_perm_b32 v78, v60, v60, v22
v_perm_b32 v79, v60, v60, v23
s_nop 1
v_mfma_f32_16x16x32_bf16 v[84:87], v[76:79], a[228:231], v[84:87]
s_waitcnt vmcnt(34)
v_perm_b32 v64, v41, v41, v16
v_perm_b32 v65, v41, v41, v17
v_perm_b32 v66, v41, v41, v18
v_perm_b32 v67, v41, v41, v19
s_nop 1
v_mfma_f32_16x16x32_bf16 v[80:83], v[64:67], a[232:235], v[80:83]
v_perm_b32 v68, v61, v61, v16
v_perm_b32 v69, v61, v61, v17
v_perm_b32 v70, v61, v61, v18
v_perm_b32 v71, v61, v61, v19
s_nop 1
v_mfma_f32_16x16x32_bf16 v[84:87], v[68:71], a[232:235], v[84:87]
s_waitcnt vmcnt(33)
v_perm_b32 v72, v41, v41, v20
v_perm_b32 v73, v41, v41, v21
v_perm_b32 v74, v41, v41, v22
v_perm_b32 v75, v41, v41, v23
s_nop 1
v_mfma_f32_16x16x32_bf16 v[80:83], v[72:75], a[236:239], v[80:83]
v_perm_b32 v76, v61, v61, v20
v_perm_b32 v77, v61, v61, v21
v_perm_b32 v78, v61, v61, v22
v_perm_b32 v79, v61, v61, v23
s_nop 1
v_mfma_f32_16x16x32_bf16 v[84:87], v[76:79], a[236:239], v[84:87]
v_lshlrev_b32 v5, 5, v8
v_and_b32 v6, 1, v9
v_lshl_add_u32 v6, v6, 4, v5
v_lshrrev_b32 v7, 5, v1
v_lshl_add_u32 v6, v7, 9, v6
s_lshl_b32 s6, s3, 11
s_add_u32 s6, s6, 147456
v_add_u32 v6, s6, v6
ds_write_b128 v6, v[80:83]
ds_write_b128 v6, v[84:87] offset:1024
v_add_u32 v5, 147456, v5
s_waitcnt lgkmcnt(0)
s_barrier
ds_read_b128 v[24:27], v5 offset:0
ds_read_b128 v[28:31], v5 offset:16
ds_read_b128 v[32:35], v5 offset:2048
ds_read_b128 v[36:39], v5 offset:2064
ds_read_b128 v[40:43], v5 offset:4096
ds_read_b128 v[44:47], v5 offset:4112
ds_read_b128 v[48:51], v5 offset:6144
ds_read_b128 v[52:55], v5 offset:6160
s_waitcnt lgkmcnt(0)
v_add_f32 v24, v24, v32
v_add_f32 v40, v40, v48
v_add_f32 v25, v25, v33
v_add_f32 v41, v41, v49
v_add_f32 v26, v26, v34
v_add_f32 v42, v42, v50
v_add_f32 v27, v27, v35
v_add_f32 v43, v43, v51
v_add_f32 v28, v28, v36
v_add_f32 v44, v44, v52
v_add_f32 v29, v29, v37
v_add_f32 v45, v45, v53
v_add_f32 v30, v30, v38
v_add_f32 v46, v46, v54
v_add_f32 v31, v31, v39
v_add_f32 v47, v47, v55
v_add_f32 v24, v24, v40
v_add_f32 v25, v25, v41
v_add_f32 v26, v26, v42
v_add_f32 v27, v27, v43
v_add_f32 v28, v28, v44
v_add_f32 v29, v29, v45
v_add_f32 v30, v30, v46
v_add_f32 v31, v31, v47
v_cvt_pk_bf16_f32 v216, v24, v25
v_cvt_pk_bf16_f32 v217, v26, v27
v_cvt_pk_bf16_f32 v218, v28, v29
v_cvt_pk_bf16_f32 v219, v30, v31
ds_read_b128 v[24:27], v5 offset:512
ds_read_b128 v[28:31], v5 offset:528
ds_read_b128 v[32:35], v5 offset:2560
ds_read_b128 v[36:39], v5 offset:2576
ds_read_b128 v[40:43], v5 offset:4608
ds_read_b128 v[44:47], v5 offset:4624
ds_read_b128 v[48:51], v5 offset:6656
ds_read_b128 v[52:55], v5 offset:6672
s_waitcnt lgkmcnt(0)
v_add_f32 v24, v24, v32
v_add_f32 v40, v40, v48
v_add_f32 v25, v25, v33
v_add_f32 v41, v41, v49
v_add_f32 v26, v26, v34
v_add_f32 v42, v42, v50
v_add_f32 v27, v27, v35
v_add_f32 v43, v43, v51
v_add_f32 v28, v28, v36
v_add_f32 v44, v44, v52
v_add_f32 v29, v29, v37
v_add_f32 v45, v45, v53
v_add_f32 v30, v30, v38
v_add_f32 v46, v46, v54
v_add_f32 v31, v31, v39
v_add_f32 v47, v47, v55
v_add_f32 v24, v24, v40
v_add_f32 v25, v25, v41
v_add_f32 v26, v26, v42
v_add_f32 v27, v27, v43
v_add_f32 v28, v28, v44
v_add_f32 v29, v29, v45
v_add_f32 v30, v30, v46
v_add_f32 v31, v31, v47
v_cvt_pk_bf16_f32 v220, v24, v25
v_cvt_pk_bf16_f32 v221, v26, v27
v_cvt_pk_bf16_f32 v222, v28, v29
v_cvt_pk_bf16_f32 v223, v30, v31
ds_read_b128 v[24:27], v5 offset:1024
ds_read_b128 v[28:31], v5 offset:1040
ds_read_b128 v[32:35], v5 offset:3072
ds_read_b128 v[36:39], v5 offset:3088
ds_read_b128 v[40:43], v5 offset:5120
ds_read_b128 v[44:47], v5 offset:5136
ds_read_b128 v[48:51], v5 offset:7168
ds_read_b128 v[52:55], v5 offset:7184
s_waitcnt lgkmcnt(0)
v_add_f32 v24, v24, v32
v_add_f32 v40, v40, v48
v_add_f32 v25, v25, v33
v_add_f32 v41, v41, v49
v_add_f32 v26, v26, v34
v_add_f32 v42, v42, v50
v_add_f32 v27, v27, v35
v_add_f32 v43, v43, v51
v_add_f32 v28, v28, v36
v_add_f32 v44, v44, v52
v_add_f32 v29, v29, v37
v_add_f32 v45, v45, v53
v_add_f32 v30, v30, v38
v_add_f32 v46, v46, v54
v_add_f32 v31, v31, v39
v_add_f32 v47, v47, v55
v_add_f32 v24, v24, v40
v_add_f32 v25, v25, v41
v_add_f32 v26, v26, v42
v_add_f32 v27, v27, v43
v_add_f32 v28, v28, v44
v_add_f32 v29, v29, v45
v_add_f32 v30, v30, v46
v_add_f32 v31, v31, v47
v_cvt_pk_bf16_f32 v224, v24, v25
v_cvt_pk_bf16_f32 v225, v26, v27
v_cvt_pk_bf16_f32 v226, v28, v29
v_cvt_pk_bf16_f32 v227, v30, v31
ds_read_b128 v[24:27], v5 offset:1536
ds_read_b128 v[28:31], v5 offset:1552
ds_read_b128 v[32:35], v5 offset:3584
ds_read_b128 v[36:39], v5 offset:3600
ds_read_b128 v[40:43], v5 offset:5632
ds_read_b128 v[44:47], v5 offset:5648
ds_read_b128 v[48:51], v5 offset:7680
ds_read_b128 v[52:55], v5 offset:7696
s_waitcnt lgkmcnt(0)
v_add_f32 v24, v24, v32
v_add_f32 v40, v40, v48
v_add_f32 v25, v25, v33
v_add_f32 v41, v41, v49
v_add_f32 v26, v26, v34
v_add_f32 v42, v42, v50
v_add_f32 v27, v27, v35
v_add_f32 v43, v43, v51
v_add_f32 v28, v28, v36
v_add_f32 v44, v44, v52
v_add_f32 v29, v29, v37
v_add_f32 v45, v45, v53
v_add_f32 v30, v30, v38
v_add_f32 v46, v46, v54
v_add_f32 v31, v31, v39
v_add_f32 v47, v47, v55
v_add_f32 v24, v24, v40
v_add_f32 v25, v25, v41
v_add_f32 v26, v26, v42
v_add_f32 v27, v27, v43
v_add_f32 v28, v28, v44
v_add_f32 v29, v29, v45
v_add_f32 v30, v30, v46
v_add_f32 v31, v31, v47
v_cvt_pk_bf16_f32 v228, v24, v25
v_cvt_pk_bf16_f32 v229, v26, v27
v_cvt_pk_bf16_f32 v230, v28, v29
v_cvt_pk_bf16_f32 v231, v30, v31
v_bfe_u32 v5, v1, 2, 2
v_mul_u32_u24 v5, 32768, v5
v_lshl_add_u32 v5, v9, 5, v5
v_and_b32 v6, 1, v1
v_lshl_add_u32 v5, v6, 4, v5
v_bfe_u32 v7, v1, 1, 1
v_lshl_add_u32 v5, v7, 7, v5
s_waitcnt vmcnt(32)
v_dot2_f32_bf16 v232, v88, v216, 0
v_dot2_f32_bf16 v233, v88, v220, 0
v_dot2_f32_bf16 v234, v88, v224, 0
v_dot2_f32_bf16 v235, v88, v228, 0
v_dot2_f32_bf16 v232, v89, v217, v232
v_dot2_f32_bf16 v233, v89, v221, v233
v_dot2_f32_bf16 v234, v89, v225, v234
v_dot2_f32_bf16 v235, v89, v229, v235
v_dot2_f32_bf16 v232, v90, v218, v232
v_dot2_f32_bf16 v233, v90, v222, v233
v_dot2_f32_bf16 v234, v90, v226, v234
v_dot2_f32_bf16 v235, v90, v230, v235
v_dot2_f32_bf16 v232, v91, v219, v232
v_dot2_f32_bf16 v233, v91, v223, v233
v_dot2_f32_bf16 v234, v91, v227, v234
v_dot2_f32_bf16 v235, v91, v231, v235
v_add_f32_dpp v236, v232, v232 row_ror:8 row_mask:0xf bank_mask:0x3
v_add_f32_dpp v237, v233, v233 row_ror:8 row_mask:0xf bank_mask:0x3
v_add_f32_dpp v236, v234, v234 row_ror:8 row_mask:0xf bank_mask:0xc
v_add_f32_dpp v237, v235, v235 row_ror:8 row_mask:0xf bank_mask:0xc
s_nop 0
v_add_f32_dpp v64, v236, v236 row_half_mirror row_mask:0xf bank_mask:0x5
v_add_f32_dpp v64, v237, v237 row_half_mirror row_mask:0xf bank_mask:0xa
s_nop 1
v_add_f32_dpp v64, v64, v64 quad_perm:[1,0,3,2] row_mask:0xf bank_mask:0xf
s_nop 1
v_add_f32_dpp v64, v64, v64 quad_perm:[2,3,0,1] row_mask:0xf bank_mask:0xf
s_waitcnt vmcnt(31)
v_dot2_f32_bf16 v232, v92, v216, 0
v_dot2_f32_bf16 v233, v92, v220, 0
v_dot2_f32_bf16 v234, v92, v224, 0
v_dot2_f32_bf16 v235, v92, v228, 0
v_dot2_f32_bf16 v232, v93, v217, v232
v_dot2_f32_bf16 v233, v93, v221, v233
v_dot2_f32_bf16 v234, v93, v225, v234
v_dot2_f32_bf16 v235, v93, v229, v235
v_dot2_f32_bf16 v232, v94, v218, v232
v_dot2_f32_bf16 v233, v94, v222, v233
v_dot2_f32_bf16 v234, v94, v226, v234
v_dot2_f32_bf16 v235, v94, v230, v235
v_dot2_f32_bf16 v232, v95, v219, v232
v_dot2_f32_bf16 v233, v95, v223, v233
v_dot2_f32_bf16 v234, v95, v227, v234
v_dot2_f32_bf16 v235, v95, v231, v235
v_add_f32_dpp v236, v232, v232 row_ror:8 row_mask:0xf bank_mask:0x3
v_add_f32_dpp v237, v233, v233 row_ror:8 row_mask:0xf bank_mask:0x3
v_add_f32_dpp v236, v234, v234 row_ror:8 row_mask:0xf bank_mask:0xc
v_add_f32_dpp v237, v235, v235 row_ror:8 row_mask:0xf bank_mask:0xc
s_nop 0
v_add_f32_dpp v65, v236, v236 row_half_mirror row_mask:0xf bank_mask:0x5
v_add_f32_dpp v65, v237, v237 row_half_mirror row_mask:0xf bank_mask:0xa
s_nop 1
v_add_f32_dpp v65, v65, v65 quad_perm:[1,0,3,2] row_mask:0xf bank_mask:0xf
s_nop 1
v_add_f32_dpp v65, v65, v65 quad_perm:[2,3,0,1] row_mask:0xf bank_mask:0xf
s_waitcnt vmcnt(30)
v_dot2_f32_bf16 v232, v96, v216, 0
v_dot2_f32_bf16 v233, v96, v220, 0
v_dot2_f32_bf16 v234, v96, v224, 0
v_dot2_f32_bf16 v235, v96, v228, 0
v_dot2_f32_bf16 v232, v97, v217, v232
v_dot2_f32_bf16 v233, v97, v221, v233
v_dot2_f32_bf16 v234, v97, v225, v234
v_dot2_f32_bf16 v235, v97, v229, v235
v_dot2_f32_bf16 v232, v98, v218, v232
v_dot2_f32_bf16 v233, v98, v222, v233
v_dot2_f32_bf16 v234, v98, v226, v234
v_dot2_f32_bf16 v235, v98, v230, v235
v_dot2_f32_bf16 v232, v99, v219, v232
v_dot2_f32_bf16 v233, v99, v223, v233
v_dot2_f32_bf16 v234, v99, v227, v234
v_dot2_f32_bf16 v235, v99, v231, v235
v_add_f32_dpp v236, v232, v232 row_ror:8 row_mask:0xf bank_mask:0x3
v_add_f32_dpp v237, v233, v233 row_ror:8 row_mask:0xf bank_mask:0x3
v_add_f32_dpp v236, v234, v234 row_ror:8 row_mask:0xf bank_mask:0xc
v_add_f32_dpp v237, v235, v235 row_ror:8 row_mask:0xf bank_mask:0xc
s_nop 0
v_add_f32_dpp v66, v236, v236 row_half_mirror row_mask:0xf bank_mask:0x5
v_add_f32_dpp v66, v237, v237 row_half_mirror row_mask:0xf bank_mask:0xa
s_nop 1
v_add_f32_dpp v66, v66, v66 quad_perm:[1,0,3,2] row_mask:0xf bank_mask:0xf
s_nop 1
v_add_f32_dpp v66, v66, v66 quad_perm:[2,3,0,1] row_mask:0xf bank_mask:0xf
s_waitcnt vmcnt(29)
v_dot2_f32_bf16 v232, v100, v216, 0
v_dot2_f32_bf16 v233, v100, v220, 0
v_dot2_f32_bf16 v234, v100, v224, 0
v_dot2_f32_bf16 v235, v100, v228, 0
v_dot2_f32_bf16 v232, v101, v217, v232
v_dot2_f32_bf16 v233, v101, v221, v233
v_dot2_f32_bf16 v234, v101, v225, v234
v_dot2_f32_bf16 v235, v101, v229, v235
v_dot2_f32_bf16 v232, v102, v218, v232
v_dot2_f32_bf16 v233, v102, v222, v233
v_dot2_f32_bf16 v234, v102, v226, v234
v_dot2_f32_bf16 v235, v102, v230, v235
v_dot2_f32_bf16 v232, v103, v219, v232
v_dot2_f32_bf16 v233, v103, v223, v233
v_dot2_f32_bf16 v234, v103, v227, v234
v_dot2_f32_bf16 v235, v103, v231, v235
v_add_f32_dpp v236, v232, v232 row_ror:8 row_mask:0xf bank_mask:0x3
v_add_f32_dpp v237, v233, v233 row_ror:8 row_mask:0xf bank_mask:0x3
v_add_f32_dpp v236, v234, v234 row_ror:8 row_mask:0xf bank_mask:0xc
v_add_f32_dpp v237, v235, v235 row_ror:8 row_mask:0xf bank_mask:0xc
s_nop 0
v_add_f32_dpp v67, v236, v236 row_half_mirror row_mask:0xf bank_mask:0x5
v_add_f32_dpp v67, v237, v237 row_half_mirror row_mask:0xf bank_mask:0xa
s_nop 1
v_add_f32_dpp v67, v67, v67 quad_perm:[1,0,3,2] row_mask:0xf bank_mask:0xf
s_nop 1
v_add_f32_dpp v67, v67, v67 quad_perm:[2,3,0,1] row_mask:0xf bank_mask:0xf
s_waitcnt vmcnt(28)
v_dot2_f32_bf16 v232, v104, v216, 0
v_dot2_f32_bf16 v233, v104, v220, 0
v_dot2_f32_bf16 v234, v104, v224, 0
v_dot2_f32_bf16 v235, v104, v228, 0
v_dot2_f32_bf16 v232, v105, v217, v232
v_dot2_f32_bf16 v233, v105, v221, v233
v_dot2_f32_bf16 v234, v105, v225, v234
v_dot2_f32_bf16 v235, v105, v229, v235
v_dot2_f32_bf16 v232, v106, v218, v232
v_dot2_f32_bf16 v233, v106, v222, v233
v_dot2_f32_bf16 v234, v106, v226, v234
v_dot2_f32_bf16 v235, v106, v230, v235
v_dot2_f32_bf16 v232, v107, v219, v232
v_dot2_f32_bf16 v233, v107, v223, v233
v_dot2_f32_bf16 v234, v107, v227, v234
v_dot2_f32_bf16 v235, v107, v231, v235
v_add_f32_dpp v236, v232, v232 row_ror:8 row_mask:0xf bank_mask:0x3
v_add_f32_dpp v237, v233, v233 row_ror:8 row_mask:0xf bank_mask:0x3
v_add_f32_dpp v236, v234, v234 row_ror:8 row_mask:0xf bank_mask:0xc
v_add_f32_dpp v237, v235, v235 row_ror:8 row_mask:0xf bank_mask:0xc
s_nop 0
v_add_f32_dpp v68, v236, v236 row_half_mirror row_mask:0xf bank_mask:0x5
v_add_f32_dpp v68, v237, v237 row_half_mirror row_mask:0xf bank_mask:0xa
s_nop 1
v_add_f32_dpp v68, v68, v68 quad_perm:[1,0,3,2] row_mask:0xf bank_mask:0xf
s_nop 1
v_add_f32_dpp v68, v68, v68 quad_perm:[2,3,0,1] row_mask:0xf bank_mask:0xf
s_waitcnt vmcnt(27)
v_dot2_f32_bf16 v232, v108, v216, 0
v_dot2_f32_bf16 v233, v108, v220, 0
v_dot2_f32_bf16 v234, v108, v224, 0
v_dot2_f32_bf16 v235, v108, v228, 0
v_dot2_f32_bf16 v232, v109, v217, v232
v_dot2_f32_bf16 v233, v109, v221, v233
v_dot2_f32_bf16 v234, v109, v225, v234
v_dot2_f32_bf16 v235, v109, v229, v235
v_dot2_f32_bf16 v232, v110, v218, v232
v_dot2_f32_bf16 v233, v110, v222, v233
v_dot2_f32_bf16 v234, v110, v226, v234
v_dot2_f32_bf16 v235, v110, v230, v235
v_dot2_f32_bf16 v232, v111, v219, v232
v_dot2_f32_bf16 v233, v111, v223, v233
v_dot2_f32_bf16 v234, v111, v227, v234
v_dot2_f32_bf16 v235, v111, v231, v235
v_add_f32_dpp v236, v232, v232 row_ror:8 row_mask:0xf bank_mask:0x3
v_add_f32_dpp v237, v233, v233 row_ror:8 row_mask:0xf bank_mask:0x3
v_add_f32_dpp v236, v234, v234 row_ror:8 row_mask:0xf bank_mask:0xc
v_add_f32_dpp v237, v235, v235 row_ror:8 row_mask:0xf bank_mask:0xc
s_nop 0
v_add_f32_dpp v69, v236, v236 row_half_mirror row_mask:0xf bank_mask:0x5
v_add_f32_dpp v69, v237, v237 row_half_mirror row_mask:0xf bank_mask:0xa
s_nop 1
v_add_f32_dpp v69, v69, v69 quad_perm:[1,0,3,2] row_mask:0xf bank_mask:0xf
s_nop 1
v_add_f32_dpp v69, v69, v69 quad_perm:[2,3,0,1] row_mask:0xf bank_mask:0xf
s_waitcnt vmcnt(26)
v_dot2_f32_bf16 v232, v112, v216, 0
v_dot2_f32_bf16 v233, v112, v220, 0
v_dot2_f32_bf16 v234, v112, v224, 0
v_dot2_f32_bf16 v235, v112, v228, 0
v_dot2_f32_bf16 v232, v113, v217, v232
v_dot2_f32_bf16 v233, v113, v221, v233
v_dot2_f32_bf16 v234, v113, v225, v234
v_dot2_f32_bf16 v235, v113, v229, v235
v_dot2_f32_bf16 v232, v114, v218, v232
v_dot2_f32_bf16 v233, v114, v222, v233
v_dot2_f32_bf16 v234, v114, v226, v234
v_dot2_f32_bf16 v235, v114, v230, v235
v_dot2_f32_bf16 v232, v115, v219, v232
v_dot2_f32_bf16 v233, v115, v223, v233
v_dot2_f32_bf16 v234, v115, v227, v234
v_dot2_f32_bf16 v235, v115, v231, v235
v_add_f32_dpp v236, v232, v232 row_ror:8 row_mask:0xf bank_mask:0x3
v_add_f32_dpp v237, v233, v233 row_ror:8 row_mask:0xf bank_mask:0x3
v_add_f32_dpp v236, v234, v234 row_ror:8 row_mask:0xf bank_mask:0xc
v_add_f32_dpp v237, v235, v235 row_ror:8 row_mask:0xf bank_mask:0xc
s_nop 0
v_add_f32_dpp v70, v236, v236 row_half_mirror row_mask:0xf bank_mask:0x5
v_add_f32_dpp v70, v237, v237 row_half_mirror row_mask:0xf bank_mask:0xa
s_nop 1
v_add_f32_dpp v70, v70, v70 quad_perm:[1,0,3,2] row_mask:0xf bank_mask:0xf
s_nop 1
v_add_f32_dpp v70, v70, v70 quad_perm:[2,3,0,1] row_mask:0xf bank_mask:0xf
s_waitcnt vmcnt(25)
v_dot2_f32_bf16 v232, v116, v216, 0
v_dot2_f32_bf16 v233, v116, v220, 0
v_dot2_f32_bf16 v234, v116, v224, 0
v_dot2_f32_bf16 v235, v116, v228, 0
v_dot2_f32_bf16 v232, v117, v217, v232
v_dot2_f32_bf16 v233, v117, v221, v233
v_dot2_f32_bf16 v234, v117, v225, v234
v_dot2_f32_bf16 v235, v117, v229, v235
v_dot2_f32_bf16 v232, v118, v218, v232
v_dot2_f32_bf16 v233, v118, v222, v233
v_dot2_f32_bf16 v234, v118, v226, v234
v_dot2_f32_bf16 v235, v118, v230, v235
v_dot2_f32_bf16 v232, v119, v219, v232
v_dot2_f32_bf16 v233, v119, v223, v233
v_dot2_f32_bf16 v234, v119, v227, v234
v_dot2_f32_bf16 v235, v119, v231, v235
v_add_f32_dpp v236, v232, v232 row_ror:8 row_mask:0xf bank_mask:0x3
v_add_f32_dpp v237, v233, v233 row_ror:8 row_mask:0xf bank_mask:0x3
v_add_f32_dpp v236, v234, v234 row_ror:8 row_mask:0xf bank_mask:0xc
v_add_f32_dpp v237, v235, v235 row_ror:8 row_mask:0xf bank_mask:0xc
s_nop 0
v_add_f32_dpp v71, v236, v236 row_half_mirror row_mask:0xf bank_mask:0x5
v_add_f32_dpp v71, v237, v237 row_half_mirror row_mask:0xf bank_mask:0xa
s_nop 1
v_add_f32_dpp v71, v71, v71 quad_perm:[1,0,3,2] row_mask:0xf bank_mask:0xf
s_nop 1
v_add_f32_dpp v71, v71, v71 quad_perm:[2,3,0,1] row_mask:0xf bank_mask:0xf
s_waitcnt vmcnt(24)
v_dot2_f32_bf16 v232, v120, v216, 0
v_dot2_f32_bf16 v233, v120, v220, 0
v_dot2_f32_bf16 v234, v120, v224, 0
v_dot2_f32_bf16 v235, v120, v228, 0
v_dot2_f32_bf16 v232, v121, v217, v232
v_dot2_f32_bf16 v233, v121, v221, v233
v_dot2_f32_bf16 v234, v121, v225, v234
v_dot2_f32_bf16 v235, v121, v229, v235
v_dot2_f32_bf16 v232, v122, v218, v232
v_dot2_f32_bf16 v233, v122, v222, v233
v_dot2_f32_bf16 v234, v122, v226, v234
v_dot2_f32_bf16 v235, v122, v230, v235
v_dot2_f32_bf16 v232, v123, v219, v232
v_dot2_f32_bf16 v233, v123, v223, v233
v_dot2_f32_bf16 v234, v123, v227, v234
v_dot2_f32_bf16 v235, v123, v231, v235
v_add_f32_dpp v236, v232, v232 row_ror:8 row_mask:0xf bank_mask:0x3
v_add_f32_dpp v237, v233, v233 row_ror:8 row_mask:0xf bank_mask:0x3
v_add_f32_dpp v236, v234, v234 row_ror:8 row_mask:0xf bank_mask:0xc
v_add_f32_dpp v237, v235, v235 row_ror:8 row_mask:0xf bank_mask:0xc
s_nop 0
v_add_f32_dpp v72, v236, v236 row_half_mirror row_mask:0xf bank_mask:0x5
v_add_f32_dpp v72, v237, v237 row_half_mirror row_mask:0xf bank_mask:0xa
s_nop 1
v_add_f32_dpp v72, v72, v72 quad_perm:[1,0,3,2] row_mask:0xf bank_mask:0xf
s_nop 1
v_add_f32_dpp v72, v72, v72 quad_perm:[2,3,0,1] row_mask:0xf bank_mask:0xf
s_waitcnt vmcnt(23)
v_dot2_f32_bf16 v232, v124, v216, 0
v_dot2_f32_bf16 v233, v124, v220, 0
v_dot2_f32_bf16 v234, v124, v224, 0
v_dot2_f32_bf16 v235, v124, v228, 0
v_dot2_f32_bf16 v232, v125, v217, v232
v_dot2_f32_bf16 v233, v125, v221, v233
v_dot2_f32_bf16 v234, v125, v225, v234
v_dot2_f32_bf16 v235, v125, v229, v235
v_dot2_f32_bf16 v232, v126, v218, v232
v_dot2_f32_bf16 v233, v126, v222, v233
v_dot2_f32_bf16 v234, v126, v226, v234
v_dot2_f32_bf16 v235, v126, v230, v235
v_dot2_f32_bf16 v232, v127, v219, v232
v_dot2_f32_bf16 v233, v127, v223, v233
v_dot2_f32_bf16 v234, v127, v227, v234
v_dot2_f32_bf16 v235, v127, v231, v235
v_add_f32_dpp v236, v232, v232 row_ror:8 row_mask:0xf bank_mask:0x3
v_add_f32_dpp v237, v233, v233 row_ror:8 row_mask:0xf bank_mask:0x3
v_add_f32_dpp v236, v234, v234 row_ror:8 row_mask:0xf bank_mask:0xc
v_add_f32_dpp v237, v235, v235 row_ror:8 row_mask:0xf bank_mask:0xc
s_nop 0
v_add_f32_dpp v73, v236, v236 row_half_mirror row_mask:0xf bank_mask:0x5
v_add_f32_dpp v73, v237, v237 row_half_mirror row_mask:0xf bank_mask:0xa
s_nop 1
v_add_f32_dpp v73, v73, v73 quad_perm:[1,0,3,2] row_mask:0xf bank_mask:0xf
s_nop 1
v_add_f32_dpp v73, v73, v73 quad_perm:[2,3,0,1] row_mask:0xf bank_mask:0xf
s_waitcnt vmcnt(22)
v_dot2_f32_bf16 v232, v128, v216, 0
v_dot2_f32_bf16 v233, v128, v220, 0
v_dot2_f32_bf16 v234, v128, v224, 0
v_dot2_f32_bf16 v235, v128, v228, 0
v_dot2_f32_bf16 v232, v129, v217, v232
v_dot2_f32_bf16 v233, v129, v221, v233
v_dot2_f32_bf16 v234, v129, v225, v234
v_dot2_f32_bf16 v235, v129, v229, v235
v_dot2_f32_bf16 v232, v130, v218, v232
v_dot2_f32_bf16 v233, v130, v222, v233
v_dot2_f32_bf16 v234, v130, v226, v234
v_dot2_f32_bf16 v235, v130, v230, v235
v_dot2_f32_bf16 v232, v131, v219, v232
v_dot2_f32_bf16 v233, v131, v223, v233
v_dot2_f32_bf16 v234, v131, v227, v234
v_dot2_f32_bf16 v235, v131, v231, v235
v_add_f32_dpp v236, v232, v232 row_ror:8 row_mask:0xf bank_mask:0x3
v_add_f32_dpp v237, v233, v233 row_ror:8 row_mask:0xf bank_mask:0x3
v_add_f32_dpp v236, v234, v234 row_ror:8 row_mask:0xf bank_mask:0xc
v_add_f32_dpp v237, v235, v235 row_ror:8 row_mask:0xf bank_mask:0xc
s_nop 0
v_add_f32_dpp v74, v236, v236 row_half_mirror row_mask:0xf bank_mask:0x5
v_add_f32_dpp v74, v237, v237 row_half_mirror row_mask:0xf bank_mask:0xa
s_nop 1
v_add_f32_dpp v74, v74, v74 quad_perm:[1,0,3,2] row_mask:0xf bank_mask:0xf
s_nop 1
v_add_f32_dpp v74, v74, v74 quad_perm:[2,3,0,1] row_mask:0xf bank_mask:0xf
s_waitcnt vmcnt(21)
v_dot2_f32_bf16 v232, v132, v216, 0
v_dot2_f32_bf16 v233, v132, v220, 0
v_dot2_f32_bf16 v234, v132, v224, 0
v_dot2_f32_bf16 v235, v132, v228, 0
v_dot2_f32_bf16 v232, v133, v217, v232
v_dot2_f32_bf16 v233, v133, v221, v233
v_dot2_f32_bf16 v234, v133, v225, v234
v_dot2_f32_bf16 v235, v133, v229, v235
v_dot2_f32_bf16 v232, v134, v218, v232
v_dot2_f32_bf16 v233, v134, v222, v233
v_dot2_f32_bf16 v234, v134, v226, v234
v_dot2_f32_bf16 v235, v134, v230, v235
v_dot2_f32_bf16 v232, v135, v219, v232
v_dot2_f32_bf16 v233, v135, v223, v233
v_dot2_f32_bf16 v234, v135, v227, v234
v_dot2_f32_bf16 v235, v135, v231, v235
v_add_f32_dpp v236, v232, v232 row_ror:8 row_mask:0xf bank_mask:0x3
v_add_f32_dpp v237, v233, v233 row_ror:8 row_mask:0xf bank_mask:0x3
v_add_f32_dpp v236, v234, v234 row_ror:8 row_mask:0xf bank_mask:0xc
v_add_f32_dpp v237, v235, v235 row_ror:8 row_mask:0xf bank_mask:0xc
s_nop 0
v_add_f32_dpp v75, v236, v236 row_half_mirror row_mask:0xf bank_mask:0x5
v_add_f32_dpp v75, v237, v237 row_half_mirror row_mask:0xf bank_mask:0xa
s_nop 1
v_add_f32_dpp v75, v75, v75 quad_perm:[1,0,3,2] row_mask:0xf bank_mask:0xf
s_nop 1
v_add_f32_dpp v75, v75, v75 quad_perm:[2,3,0,1] row_mask:0xf bank_mask:0xf
s_waitcnt vmcnt(20)
v_dot2_f32_bf16 v232, v136, v216, 0
v_dot2_f32_bf16 v233, v136, v220, 0
v_dot2_f32_bf16 v234, v136, v224, 0
v_dot2_f32_bf16 v235, v136, v228, 0
v_dot2_f32_bf16 v232, v137, v217, v232
v_dot2_f32_bf16 v233, v137, v221, v233
v_dot2_f32_bf16 v234, v137, v225, v234
v_dot2_f32_bf16 v235, v137, v229, v235
v_dot2_f32_bf16 v232, v138, v218, v232
v_dot2_f32_bf16 v233, v138, v222, v233
v_dot2_f32_bf16 v234, v138, v226, v234
v_dot2_f32_bf16 v235, v138, v230, v235
v_dot2_f32_bf16 v232, v139, v219, v232
v_dot2_f32_bf16 v233, v139, v223, v233
v_dot2_f32_bf16 v234, v139, v227, v234
v_dot2_f32_bf16 v235, v139, v231, v235
v_add_f32_dpp v236, v232, v232 row_ror:8 row_mask:0xf bank_mask:0x3
v_add_f32_dpp v237, v233, v233 row_ror:8 row_mask:0xf bank_mask:0x3
v_add_f32_dpp v236, v234, v234 row_ror:8 row_mask:0xf bank_mask:0xc
v_add_f32_dpp v237, v235, v235 row_ror:8 row_mask:0xf bank_mask:0xc
s_nop 0
v_add_f32_dpp v76, v236, v236 row_half_mirror row_mask:0xf bank_mask:0x5
v_add_f32_dpp v76, v237, v237 row_half_mirror row_mask:0xf bank_mask:0xa
s_nop 1
v_add_f32_dpp v76, v76, v76 quad_perm:[1,0,3,2] row_mask:0xf bank_mask:0xf
s_nop 1
v_add_f32_dpp v76, v76, v76 quad_perm:[2,3,0,1] row_mask:0xf bank_mask:0xf
s_waitcnt vmcnt(19)
v_dot2_f32_bf16 v232, v140, v216, 0
v_dot2_f32_bf16 v233, v140, v220, 0
v_dot2_f32_bf16 v234, v140, v224, 0
v_dot2_f32_bf16 v235, v140, v228, 0
v_dot2_f32_bf16 v232, v141, v217, v232
v_dot2_f32_bf16 v233, v141, v221, v233
v_dot2_f32_bf16 v234, v141, v225, v234
v_dot2_f32_bf16 v235, v141, v229, v235
v_dot2_f32_bf16 v232, v142, v218, v232
v_dot2_f32_bf16 v233, v142, v222, v233
v_dot2_f32_bf16 v234, v142, v226, v234
v_dot2_f32_bf16 v235, v142, v230, v235
v_dot2_f32_bf16 v232, v143, v219, v232
v_dot2_f32_bf16 v233, v143, v223, v233
v_dot2_f32_bf16 v234, v143, v227, v234
v_dot2_f32_bf16 v235, v143, v231, v235
v_add_f32_dpp v236, v232, v232 row_ror:8 row_mask:0xf bank_mask:0x3
v_add_f32_dpp v237, v233, v233 row_ror:8 row_mask:0xf bank_mask:0x3
v_add_f32_dpp v236, v234, v234 row_ror:8 row_mask:0xf bank_mask:0xc
v_add_f32_dpp v237, v235, v235 row_ror:8 row_mask:0xf bank_mask:0xc
s_nop 0
v_add_f32_dpp v77, v236, v236 row_half_mirror row_mask:0xf bank_mask:0x5
v_add_f32_dpp v77, v237, v237 row_half_mirror row_mask:0xf bank_mask:0xa
s_nop 1
v_add_f32_dpp v77, v77, v77 quad_perm:[1,0,3,2] row_mask:0xf bank_mask:0xf
s_nop 1
v_add_f32_dpp v77, v77, v77 quad_perm:[2,3,0,1] row_mask:0xf bank_mask:0xf
s_waitcnt vmcnt(18)
v_dot2_f32_bf16 v232, v144, v216, 0
v_dot2_f32_bf16 v233, v144, v220, 0
v_dot2_f32_bf16 v234, v144, v224, 0
v_dot2_f32_bf16 v235, v144, v228, 0
v_dot2_f32_bf16 v232, v145, v217, v232
v_dot2_f32_bf16 v233, v145, v221, v233
v_dot2_f32_bf16 v234, v145, v225, v234
v_dot2_f32_bf16 v235, v145, v229, v235
v_dot2_f32_bf16 v232, v146, v218, v232
v_dot2_f32_bf16 v233, v146, v222, v233
v_dot2_f32_bf16 v234, v146, v226, v234
v_dot2_f32_bf16 v235, v146, v230, v235
v_dot2_f32_bf16 v232, v147, v219, v232
v_dot2_f32_bf16 v233, v147, v223, v233
v_dot2_f32_bf16 v234, v147, v227, v234
v_dot2_f32_bf16 v235, v147, v231, v235
v_add_f32_dpp v236, v232, v232 row_ror:8 row_mask:0xf bank_mask:0x3
v_add_f32_dpp v237, v233, v233 row_ror:8 row_mask:0xf bank_mask:0x3
v_add_f32_dpp v236, v234, v234 row_ror:8 row_mask:0xf bank_mask:0xc
v_add_f32_dpp v237, v235, v235 row_ror:8 row_mask:0xf bank_mask:0xc
s_nop 0
v_add_f32_dpp v78, v236, v236 row_half_mirror row_mask:0xf bank_mask:0x5
v_add_f32_dpp v78, v237, v237 row_half_mirror row_mask:0xf bank_mask:0xa
s_nop 1
v_add_f32_dpp v78, v78, v78 quad_perm:[1,0,3,2] row_mask:0xf bank_mask:0xf
s_nop 1
v_add_f32_dpp v78, v78, v78 quad_perm:[2,3,0,1] row_mask:0xf bank_mask:0xf
s_waitcnt vmcnt(17)
v_dot2_f32_bf16 v232, v148, v216, 0
v_dot2_f32_bf16 v233, v148, v220, 0
v_dot2_f32_bf16 v234, v148, v224, 0
v_dot2_f32_bf16 v235, v148, v228, 0
v_dot2_f32_bf16 v232, v149, v217, v232
v_dot2_f32_bf16 v233, v149, v221, v233
v_dot2_f32_bf16 v234, v149, v225, v234
v_dot2_f32_bf16 v235, v149, v229, v235
v_dot2_f32_bf16 v232, v150, v218, v232
v_dot2_f32_bf16 v233, v150, v222, v233
v_dot2_f32_bf16 v234, v150, v226, v234
v_dot2_f32_bf16 v235, v150, v230, v235
v_dot2_f32_bf16 v232, v151, v219, v232
v_dot2_f32_bf16 v233, v151, v223, v233
v_dot2_f32_bf16 v234, v151, v227, v234
v_dot2_f32_bf16 v235, v151, v231, v235
v_add_f32_dpp v236, v232, v232 row_ror:8 row_mask:0xf bank_mask:0x3
v_add_f32_dpp v237, v233, v233 row_ror:8 row_mask:0xf bank_mask:0x3
v_add_f32_dpp v236, v234, v234 row_ror:8 row_mask:0xf bank_mask:0xc
v_add_f32_dpp v237, v235, v235 row_ror:8 row_mask:0xf bank_mask:0xc
s_nop 0
v_add_f32_dpp v79, v236, v236 row_half_mirror row_mask:0xf bank_mask:0x5
v_add_f32_dpp v79, v237, v237 row_half_mirror row_mask:0xf bank_mask:0xa
s_nop 1
v_add_f32_dpp v79, v79, v79 quad_perm:[1,0,3,2] row_mask:0xf bank_mask:0xf
s_nop 1
v_add_f32_dpp v79, v79, v79 quad_perm:[2,3,0,1] row_mask:0xf bank_mask:0xf
v_cvt_pk_bf16_f32 v24, v64, v65
v_cvt_pk_bf16_f32 v25, v66, v67
v_cvt_pk_bf16_f32 v26, v68, v69
v_cvt_pk_bf16_f32 v27, v70, v71
v_cvt_pk_bf16_f32 v28, v72, v73
v_cvt_pk_bf16_f32 v29, v74, v75
v_cvt_pk_bf16_f32 v30, v76, v77
v_cvt_pk_bf16_f32 v31, v78, v79
v_cmp_eq_u32 vcc, 1, v6
s_nop 1
v_cndmask_b32 v244, v24, v28, vcc
v_cndmask_b32 v245, v25, v29, vcc
v_cndmask_b32 v246, v26, v30, vcc
v_cndmask_b32 v247, v27, v31, vcc
s_waitcnt vmcnt(16)
v_dot2_f32_bf16 v232, v152, v216, 0
v_dot2_f32_bf16 v233, v152, v220, 0
v_dot2_f32_bf16 v234, v152, v224, 0
v_dot2_f32_bf16 v235, v152, v228, 0
v_dot2_f32_bf16 v232, v153, v217, v232
v_dot2_f32_bf16 v233, v153, v221, v233
v_dot2_f32_bf16 v234, v153, v225, v234
v_dot2_f32_bf16 v235, v153, v229, v235
v_dot2_f32_bf16 v232, v154, v218, v232
v_dot2_f32_bf16 v233, v154, v222, v233
v_dot2_f32_bf16 v234, v154, v226, v234
v_dot2_f32_bf16 v235, v154, v230, v235
v_dot2_f32_bf16 v232, v155, v219, v232
v_dot2_f32_bf16 v233, v155, v223, v233
v_dot2_f32_bf16 v234, v155, v227, v234
v_dot2_f32_bf16 v235, v155, v231, v235
v_add_f32_dpp v236, v232, v232 row_ror:8 row_mask:0xf bank_mask:0x3
v_add_f32_dpp v237, v233, v233 row_ror:8 row_mask:0xf bank_mask:0x3
v_add_f32_dpp v236, v234, v234 row_ror:8 row_mask:0xf bank_mask:0xc
v_add_f32_dpp v237, v235, v235 row_ror:8 row_mask:0xf bank_mask:0xc
s_nop 0
v_add_f32_dpp v64, v236, v236 row_half_mirror row_mask:0xf bank_mask:0x5
v_add_f32_dpp v64, v237, v237 row_half_mirror row_mask:0xf bank_mask:0xa
s_nop 1
v_add_f32_dpp v64, v64, v64 quad_perm:[1,0,3,2] row_mask:0xf bank_mask:0xf
s_nop 1
v_add_f32_dpp v64, v64, v64 quad_perm:[2,3,0,1] row_mask:0xf bank_mask:0xf
s_waitcnt vmcnt(15)
v_dot2_f32_bf16 v232, v156, v216, 0
v_dot2_f32_bf16 v233, v156, v220, 0
v_dot2_f32_bf16 v234, v156, v224, 0
v_dot2_f32_bf16 v235, v156, v228, 0
v_dot2_f32_bf16 v232, v157, v217, v232
v_dot2_f32_bf16 v233, v157, v221, v233
v_dot2_f32_bf16 v234, v157, v225, v234
v_dot2_f32_bf16 v235, v157, v229, v235
v_dot2_f32_bf16 v232, v158, v218, v232
v_dot2_f32_bf16 v233, v158, v222, v233
v_dot2_f32_bf16 v234, v158, v226, v234
v_dot2_f32_bf16 v235, v158, v230, v235
v_dot2_f32_bf16 v232, v159, v219, v232
v_dot2_f32_bf16 v233, v159, v223, v233
v_dot2_f32_bf16 v234, v159, v227, v234
v_dot2_f32_bf16 v235, v159, v231, v235
v_add_f32_dpp v236, v232, v232 row_ror:8 row_mask:0xf bank_mask:0x3
v_add_f32_dpp v237, v233, v233 row_ror:8 row_mask:0xf bank_mask:0x3
v_add_f32_dpp v236, v234, v234 row_ror:8 row_mask:0xf bank_mask:0xc
v_add_f32_dpp v237, v235, v235 row_ror:8 row_mask:0xf bank_mask:0xc
s_nop 0
v_add_f32_dpp v65, v236, v236 row_half_mirror row_mask:0xf bank_mask:0x5
v_add_f32_dpp v65, v237, v237 row_half_mirror row_mask:0xf bank_mask:0xa
s_nop 1
v_add_f32_dpp v65, v65, v65 quad_perm:[1,0,3,2] row_mask:0xf bank_mask:0xf
s_nop 1
v_add_f32_dpp v65, v65, v65 quad_perm:[2,3,0,1] row_mask:0xf bank_mask:0xf
s_waitcnt vmcnt(14)
v_dot2_f32_bf16 v232, v160, v216, 0
v_dot2_f32_bf16 v233, v160, v220, 0
v_dot2_f32_bf16 v234, v160, v224, 0
v_dot2_f32_bf16 v235, v160, v228, 0
v_dot2_f32_bf16 v232, v161, v217, v232
v_dot2_f32_bf16 v233, v161, v221, v233
v_dot2_f32_bf16 v234, v161, v225, v234
v_dot2_f32_bf16 v235, v161, v229, v235
v_dot2_f32_bf16 v232, v162, v218, v232
v_dot2_f32_bf16 v233, v162, v222, v233
v_dot2_f32_bf16 v234, v162, v226, v234
v_dot2_f32_bf16 v235, v162, v230, v235
v_dot2_f32_bf16 v232, v163, v219, v232
v_dot2_f32_bf16 v233, v163, v223, v233
v_dot2_f32_bf16 v234, v163, v227, v234
v_dot2_f32_bf16 v235, v163, v231, v235
v_add_f32_dpp v236, v232, v232 row_ror:8 row_mask:0xf bank_mask:0x3
v_add_f32_dpp v237, v233, v233 row_ror:8 row_mask:0xf bank_mask:0x3
v_add_f32_dpp v236, v234, v234 row_ror:8 row_mask:0xf bank_mask:0xc
v_add_f32_dpp v237, v235, v235 row_ror:8 row_mask:0xf bank_mask:0xc
s_nop 0
v_add_f32_dpp v66, v236, v236 row_half_mirror row_mask:0xf bank_mask:0x5
v_add_f32_dpp v66, v237, v237 row_half_mirror row_mask:0xf bank_mask:0xa
s_nop 1
v_add_f32_dpp v66, v66, v66 quad_perm:[1,0,3,2] row_mask:0xf bank_mask:0xf
s_nop 1
v_add_f32_dpp v66, v66, v66 quad_perm:[2,3,0,1] row_mask:0xf bank_mask:0xf
s_waitcnt vmcnt(13)
v_dot2_f32_bf16 v232, v164, v216, 0
v_dot2_f32_bf16 v233, v164, v220, 0
v_dot2_f32_bf16 v234, v164, v224, 0
v_dot2_f32_bf16 v235, v164, v228, 0
v_dot2_f32_bf16 v232, v165, v217, v232
v_dot2_f32_bf16 v233, v165, v221, v233
v_dot2_f32_bf16 v234, v165, v225, v234
v_dot2_f32_bf16 v235, v165, v229, v235
v_dot2_f32_bf16 v232, v166, v218, v232
v_dot2_f32_bf16 v233, v166, v222, v233
v_dot2_f32_bf16 v234, v166, v226, v234
v_dot2_f32_bf16 v235, v166, v230, v235
v_dot2_f32_bf16 v232, v167, v219, v232
v_dot2_f32_bf16 v233, v167, v223, v233
v_dot2_f32_bf16 v234, v167, v227, v234
v_dot2_f32_bf16 v235, v167, v231, v235
v_add_f32_dpp v236, v232, v232 row_ror:8 row_mask:0xf bank_mask:0x3
v_add_f32_dpp v237, v233, v233 row_ror:8 row_mask:0xf bank_mask:0x3
v_add_f32_dpp v236, v234, v234 row_ror:8 row_mask:0xf bank_mask:0xc
v_add_f32_dpp v237, v235, v235 row_ror:8 row_mask:0xf bank_mask:0xc
s_nop 0
v_add_f32_dpp v67, v236, v236 row_half_mirror row_mask:0xf bank_mask:0x5
v_add_f32_dpp v67, v237, v237 row_half_mirror row_mask:0xf bank_mask:0xa
s_nop 1
v_add_f32_dpp v67, v67, v67 quad_perm:[1,0,3,2] row_mask:0xf bank_mask:0xf
s_nop 1
v_add_f32_dpp v67, v67, v67 quad_perm:[2,3,0,1] row_mask:0xf bank_mask:0xf
s_waitcnt vmcnt(12)
v_dot2_f32_bf16 v232, v168, v216, 0
v_dot2_f32_bf16 v233, v168, v220, 0
v_dot2_f32_bf16 v234, v168, v224, 0
v_dot2_f32_bf16 v235, v168, v228, 0
v_dot2_f32_bf16 v232, v169, v217, v232
v_dot2_f32_bf16 v233, v169, v221, v233
v_dot2_f32_bf16 v234, v169, v225, v234
v_dot2_f32_bf16 v235, v169, v229, v235
v_dot2_f32_bf16 v232, v170, v218, v232
v_dot2_f32_bf16 v233, v170, v222, v233
v_dot2_f32_bf16 v234, v170, v226, v234
v_dot2_f32_bf16 v235, v170, v230, v235
v_dot2_f32_bf16 v232, v171, v219, v232
v_dot2_f32_bf16 v233, v171, v223, v233
v_dot2_f32_bf16 v234, v171, v227, v234
v_dot2_f32_bf16 v235, v171, v231, v235
v_add_f32_dpp v236, v232, v232 row_ror:8 row_mask:0xf bank_mask:0x3
v_add_f32_dpp v237, v233, v233 row_ror:8 row_mask:0xf bank_mask:0x3
v_add_f32_dpp v236, v234, v234 row_ror:8 row_mask:0xf bank_mask:0xc
v_add_f32_dpp v237, v235, v235 row_ror:8 row_mask:0xf bank_mask:0xc
s_nop 0
v_add_f32_dpp v68, v236, v236 row_half_mirror row_mask:0xf bank_mask:0x5
v_add_f32_dpp v68, v237, v237 row_half_mirror row_mask:0xf bank_mask:0xa
s_nop 1
v_add_f32_dpp v68, v68, v68 quad_perm:[1,0,3,2] row_mask:0xf bank_mask:0xf
s_nop 1
v_add_f32_dpp v68, v68, v68 quad_perm:[2,3,0,1] row_mask:0xf bank_mask:0xf
s_waitcnt vmcnt(11)
v_dot2_f32_bf16 v232, v172, v216, 0
v_dot2_f32_bf16 v233, v172, v220, 0
v_dot2_f32_bf16 v234, v172, v224, 0
v_dot2_f32_bf16 v235, v172, v228, 0
v_dot2_f32_bf16 v232, v173, v217, v232
v_dot2_f32_bf16 v233, v173, v221, v233
v_dot2_f32_bf16 v234, v173, v225, v234
v_dot2_f32_bf16 v235, v173, v229, v235
v_dot2_f32_bf16 v232, v174, v218, v232
v_dot2_f32_bf16 v233, v174, v222, v233
v_dot2_f32_bf16 v234, v174, v226, v234
v_dot2_f32_bf16 v235, v174, v230, v235
v_dot2_f32_bf16 v232, v175, v219, v232
v_dot2_f32_bf16 v233, v175, v223, v233
v_dot2_f32_bf16 v234, v175, v227, v234
v_dot2_f32_bf16 v235, v175, v231, v235
v_add_f32_dpp v236, v232, v232 row_ror:8 row_mask:0xf bank_mask:0x3
v_add_f32_dpp v237, v233, v233 row_ror:8 row_mask:0xf bank_mask:0x3
v_add_f32_dpp v236, v234, v234 row_ror:8 row_mask:0xf bank_mask:0xc
v_add_f32_dpp v237, v235, v235 row_ror:8 row_mask:0xf bank_mask:0xc
s_nop 0
v_add_f32_dpp v69, v236, v236 row_half_mirror row_mask:0xf bank_mask:0x5
v_add_f32_dpp v69, v237, v237 row_half_mirror row_mask:0xf bank_mask:0xa
s_nop 1
v_add_f32_dpp v69, v69, v69 quad_perm:[1,0,3,2] row_mask:0xf bank_mask:0xf
s_nop 1
v_add_f32_dpp v69, v69, v69 quad_perm:[2,3,0,1] row_mask:0xf bank_mask:0xf
s_waitcnt vmcnt(10)
v_dot2_f32_bf16 v232, v176, v216, 0
v_dot2_f32_bf16 v233, v176, v220, 0
v_dot2_f32_bf16 v234, v176, v224, 0
v_dot2_f32_bf16 v235, v176, v228, 0
v_dot2_f32_bf16 v232, v177, v217, v232
v_dot2_f32_bf16 v233, v177, v221, v233
v_dot2_f32_bf16 v234, v177, v225, v234
v_dot2_f32_bf16 v235, v177, v229, v235
v_dot2_f32_bf16 v232, v178, v218, v232
v_dot2_f32_bf16 v233, v178, v222, v233
v_dot2_f32_bf16 v234, v178, v226, v234
v_dot2_f32_bf16 v235, v178, v230, v235
v_dot2_f32_bf16 v232, v179, v219, v232
v_dot2_f32_bf16 v233, v179, v223, v233
v_dot2_f32_bf16 v234, v179, v227, v234
v_dot2_f32_bf16 v235, v179, v231, v235
v_add_f32_dpp v236, v232, v232 row_ror:8 row_mask:0xf bank_mask:0x3
v_add_f32_dpp v237, v233, v233 row_ror:8 row_mask:0xf bank_mask:0x3
v_add_f32_dpp v236, v234, v234 row_ror:8 row_mask:0xf bank_mask:0xc
v_add_f32_dpp v237, v235, v235 row_ror:8 row_mask:0xf bank_mask:0xc
s_nop 0
v_add_f32_dpp v70, v236, v236 row_half_mirror row_mask:0xf bank_mask:0x5
v_add_f32_dpp v70, v237, v237 row_half_mirror row_mask:0xf bank_mask:0xa
s_nop 1
v_add_f32_dpp v70, v70, v70 quad_perm:[1,0,3,2] row_mask:0xf bank_mask:0xf
s_nop 1
v_add_f32_dpp v70, v70, v70 quad_perm:[2,3,0,1] row_mask:0xf bank_mask:0xf
s_waitcnt vmcnt(9)
v_dot2_f32_bf16 v232, v180, v216, 0
v_dot2_f32_bf16 v233, v180, v220, 0
v_dot2_f32_bf16 v234, v180, v224, 0
v_dot2_f32_bf16 v235, v180, v228, 0
v_dot2_f32_bf16 v232, v181, v217, v232
v_dot2_f32_bf16 v233, v181, v221, v233
v_dot2_f32_bf16 v234, v181, v225, v234
v_dot2_f32_bf16 v235, v181, v229, v235
v_dot2_f32_bf16 v232, v182, v218, v232
v_dot2_f32_bf16 v233, v182, v222, v233
v_dot2_f32_bf16 v234, v182, v226, v234
v_dot2_f32_bf16 v235, v182, v230, v235
v_dot2_f32_bf16 v232, v183, v219, v232
v_dot2_f32_bf16 v233, v183, v223, v233
v_dot2_f32_bf16 v234, v183, v227, v234
v_dot2_f32_bf16 v235, v183, v231, v235
v_add_f32_dpp v236, v232, v232 row_ror:8 row_mask:0xf bank_mask:0x3
v_add_f32_dpp v237, v233, v233 row_ror:8 row_mask:0xf bank_mask:0x3
v_add_f32_dpp v236, v234, v234 row_ror:8 row_mask:0xf bank_mask:0xc
v_add_f32_dpp v237, v235, v235 row_ror:8 row_mask:0xf bank_mask:0xc
s_nop 0
v_add_f32_dpp v71, v236, v236 row_half_mirror row_mask:0xf bank_mask:0x5
v_add_f32_dpp v71, v237, v237 row_half_mirror row_mask:0xf bank_mask:0xa
s_nop 1
v_add_f32_dpp v71, v71, v71 quad_perm:[1,0,3,2] row_mask:0xf bank_mask:0xf
s_nop 1
v_add_f32_dpp v71, v71, v71 quad_perm:[2,3,0,1] row_mask:0xf bank_mask:0xf
s_waitcnt vmcnt(8)
v_dot2_f32_bf16 v232, v184, v216, 0
v_dot2_f32_bf16 v233, v184, v220, 0
v_dot2_f32_bf16 v234, v184, v224, 0
v_dot2_f32_bf16 v235, v184, v228, 0
v_dot2_f32_bf16 v232, v185, v217, v232
v_dot2_f32_bf16 v233, v185, v221, v233
v_dot2_f32_bf16 v234, v185, v225, v234
v_dot2_f32_bf16 v235, v185, v229, v235
v_dot2_f32_bf16 v232, v186, v218, v232
v_dot2_f32_bf16 v233, v186, v222, v233
v_dot2_f32_bf16 v234, v186, v226, v234
v_dot2_f32_bf16 v235, v186, v230, v235
v_dot2_f32_bf16 v232, v187, v219, v232
v_dot2_f32_bf16 v233, v187, v223, v233
v_dot2_f32_bf16 v234, v187, v227, v234
v_dot2_f32_bf16 v235, v187, v231, v235
v_add_f32_dpp v236, v232, v232 row_ror:8 row_mask:0xf bank_mask:0x3
v_add_f32_dpp v237, v233, v233 row_ror:8 row_mask:0xf bank_mask:0x3
v_add_f32_dpp v236, v234, v234 row_ror:8 row_mask:0xf bank_mask:0xc
v_add_f32_dpp v237, v235, v235 row_ror:8 row_mask:0xf bank_mask:0xc
s_nop 0
v_add_f32_dpp v72, v236, v236 row_half_mirror row_mask:0xf bank_mask:0x5
v_add_f32_dpp v72, v237, v237 row_half_mirror row_mask:0xf bank_mask:0xa
s_nop 1
v_add_f32_dpp v72, v72, v72 quad_perm:[1,0,3,2] row_mask:0xf bank_mask:0xf
s_nop 1
v_add_f32_dpp v72, v72, v72 quad_perm:[2,3,0,1] row_mask:0xf bank_mask:0xf
s_waitcnt vmcnt(7)
v_dot2_f32_bf16 v232, v188, v216, 0
v_dot2_f32_bf16 v233, v188, v220, 0
v_dot2_f32_bf16 v234, v188, v224, 0
v_dot2_f32_bf16 v235, v188, v228, 0
v_dot2_f32_bf16 v232, v189, v217, v232
v_dot2_f32_bf16 v233, v189, v221, v233
v_dot2_f32_bf16 v234, v189, v225, v234
v_dot2_f32_bf16 v235, v189, v229, v235
v_dot2_f32_bf16 v232, v190, v218, v232
v_dot2_f32_bf16 v233, v190, v222, v233
v_dot2_f32_bf16 v234, v190, v226, v234
v_dot2_f32_bf16 v235, v190, v230, v235
v_dot2_f32_bf16 v232, v191, v219, v232
v_dot2_f32_bf16 v233, v191, v223, v233
v_dot2_f32_bf16 v234, v191, v227, v234
v_dot2_f32_bf16 v235, v191, v231, v235
v_add_f32_dpp v236, v232, v232 row_ror:8 row_mask:0xf bank_mask:0x3
v_add_f32_dpp v237, v233, v233 row_ror:8 row_mask:0xf bank_mask:0x3
v_add_f32_dpp v236, v234, v234 row_ror:8 row_mask:0xf bank_mask:0xc
v_add_f32_dpp v237, v235, v235 row_ror:8 row_mask:0xf bank_mask:0xc
s_nop 0
v_add_f32_dpp v73, v236, v236 row_half_mirror row_mask:0xf bank_mask:0x5
v_add_f32_dpp v73, v237, v237 row_half_mirror row_mask:0xf bank_mask:0xa
s_nop 1
v_add_f32_dpp v73, v73, v73 quad_perm:[1,0,3,2] row_mask:0xf bank_mask:0xf
s_nop 1
v_add_f32_dpp v73, v73, v73 quad_perm:[2,3,0,1] row_mask:0xf bank_mask:0xf
s_waitcnt vmcnt(6)
v_dot2_f32_bf16 v232, v192, v216, 0
v_dot2_f32_bf16 v233, v192, v220, 0
v_dot2_f32_bf16 v234, v192, v224, 0
v_dot2_f32_bf16 v235, v192, v228, 0
v_dot2_f32_bf16 v232, v193, v217, v232
v_dot2_f32_bf16 v233, v193, v221, v233
v_dot2_f32_bf16 v234, v193, v225, v234
v_dot2_f32_bf16 v235, v193, v229, v235
v_dot2_f32_bf16 v232, v194, v218, v232
v_dot2_f32_bf16 v233, v194, v222, v233
v_dot2_f32_bf16 v234, v194, v226, v234
v_dot2_f32_bf16 v235, v194, v230, v235
v_dot2_f32_bf16 v232, v195, v219, v232
v_dot2_f32_bf16 v233, v195, v223, v233
v_dot2_f32_bf16 v234, v195, v227, v234
v_dot2_f32_bf16 v235, v195, v231, v235
v_add_f32_dpp v236, v232, v232 row_ror:8 row_mask:0xf bank_mask:0x3
v_add_f32_dpp v237, v233, v233 row_ror:8 row_mask:0xf bank_mask:0x3
v_add_f32_dpp v236, v234, v234 row_ror:8 row_mask:0xf bank_mask:0xc
v_add_f32_dpp v237, v235, v235 row_ror:8 row_mask:0xf bank_mask:0xc
s_nop 0
v_add_f32_dpp v74, v236, v236 row_half_mirror row_mask:0xf bank_mask:0x5
v_add_f32_dpp v74, v237, v237 row_half_mirror row_mask:0xf bank_mask:0xa
s_nop 1
v_add_f32_dpp v74, v74, v74 quad_perm:[1,0,3,2] row_mask:0xf bank_mask:0xf
s_nop 1
v_add_f32_dpp v74, v74, v74 quad_perm:[2,3,0,1] row_mask:0xf bank_mask:0xf
s_waitcnt vmcnt(5)
v_dot2_f32_bf16 v232, v196, v216, 0
v_dot2_f32_bf16 v233, v196, v220, 0
v_dot2_f32_bf16 v234, v196, v224, 0
v_dot2_f32_bf16 v235, v196, v228, 0
v_dot2_f32_bf16 v232, v197, v217, v232
v_dot2_f32_bf16 v233, v197, v221, v233
v_dot2_f32_bf16 v234, v197, v225, v234
v_dot2_f32_bf16 v235, v197, v229, v235
v_dot2_f32_bf16 v232, v198, v218, v232
v_dot2_f32_bf16 v233, v198, v222, v233
v_dot2_f32_bf16 v234, v198, v226, v234
v_dot2_f32_bf16 v235, v198, v230, v235
v_dot2_f32_bf16 v232, v199, v219, v232
v_dot2_f32_bf16 v233, v199, v223, v233
v_dot2_f32_bf16 v234, v199, v227, v234
v_dot2_f32_bf16 v235, v199, v231, v235
v_add_f32_dpp v236, v232, v232 row_ror:8 row_mask:0xf bank_mask:0x3
v_add_f32_dpp v237, v233, v233 row_ror:8 row_mask:0xf bank_mask:0x3
v_add_f32_dpp v236, v234, v234 row_ror:8 row_mask:0xf bank_mask:0xc
v_add_f32_dpp v237, v235, v235 row_ror:8 row_mask:0xf bank_mask:0xc
s_nop 0
v_add_f32_dpp v75, v236, v236 row_half_mirror row_mask:0xf bank_mask:0x5
v_add_f32_dpp v75, v237, v237 row_half_mirror row_mask:0xf bank_mask:0xa
s_nop 1
v_add_f32_dpp v75, v75, v75 quad_perm:[1,0,3,2] row_mask:0xf bank_mask:0xf
s_nop 1
v_add_f32_dpp v75, v75, v75 quad_perm:[2,3,0,1] row_mask:0xf bank_mask:0xf
s_waitcnt vmcnt(4)
v_dot2_f32_bf16 v232, v200, v216, 0
v_dot2_f32_bf16 v233, v200, v220, 0
v_dot2_f32_bf16 v234, v200, v224, 0
v_dot2_f32_bf16 v235, v200, v228, 0
v_dot2_f32_bf16 v232, v201, v217, v232
v_dot2_f32_bf16 v233, v201, v221, v233
v_dot2_f32_bf16 v234, v201, v225, v234
v_dot2_f32_bf16 v235, v201, v229, v235
v_dot2_f32_bf16 v232, v202, v218, v232
v_dot2_f32_bf16 v233, v202, v222, v233
v_dot2_f32_bf16 v234, v202, v226, v234
v_dot2_f32_bf16 v235, v202, v230, v235
v_dot2_f32_bf16 v232, v203, v219, v232
v_dot2_f32_bf16 v233, v203, v223, v233
v_dot2_f32_bf16 v234, v203, v227, v234
v_dot2_f32_bf16 v235, v203, v231, v235
v_add_f32_dpp v236, v232, v232 row_ror:8 row_mask:0xf bank_mask:0x3
v_add_f32_dpp v237, v233, v233 row_ror:8 row_mask:0xf bank_mask:0x3
v_add_f32_dpp v236, v234, v234 row_ror:8 row_mask:0xf bank_mask:0xc
v_add_f32_dpp v237, v235, v235 row_ror:8 row_mask:0xf bank_mask:0xc
s_nop 0
v_add_f32_dpp v76, v236, v236 row_half_mirror row_mask:0xf bank_mask:0x5
v_add_f32_dpp v76, v237, v237 row_half_mirror row_mask:0xf bank_mask:0xa
s_nop 1
v_add_f32_dpp v76, v76, v76 quad_perm:[1,0,3,2] row_mask:0xf bank_mask:0xf
s_nop 1
v_add_f32_dpp v76, v76, v76 quad_perm:[2,3,0,1] row_mask:0xf bank_mask:0xf
s_waitcnt vmcnt(3)
v_dot2_f32_bf16 v232, v204, v216, 0
v_dot2_f32_bf16 v233, v204, v220, 0
v_dot2_f32_bf16 v234, v204, v224, 0
v_dot2_f32_bf16 v235, v204, v228, 0
v_dot2_f32_bf16 v232, v205, v217, v232
v_dot2_f32_bf16 v233, v205, v221, v233
v_dot2_f32_bf16 v234, v205, v225, v234
v_dot2_f32_bf16 v235, v205, v229, v235
v_dot2_f32_bf16 v232, v206, v218, v232
v_dot2_f32_bf16 v233, v206, v222, v233
v_dot2_f32_bf16 v234, v206, v226, v234
v_dot2_f32_bf16 v235, v206, v230, v235
v_dot2_f32_bf16 v232, v207, v219, v232
v_dot2_f32_bf16 v233, v207, v223, v233
v_dot2_f32_bf16 v234, v207, v227, v234
v_dot2_f32_bf16 v235, v207, v231, v235
v_add_f32_dpp v236, v232, v232 row_ror:8 row_mask:0xf bank_mask:0x3
v_add_f32_dpp v237, v233, v233 row_ror:8 row_mask:0xf bank_mask:0x3
v_add_f32_dpp v236, v234, v234 row_ror:8 row_mask:0xf bank_mask:0xc
v_add_f32_dpp v237, v235, v235 row_ror:8 row_mask:0xf bank_mask:0xc
s_nop 0
v_add_f32_dpp v77, v236, v236 row_half_mirror row_mask:0xf bank_mask:0x5
v_add_f32_dpp v77, v237, v237 row_half_mirror row_mask:0xf bank_mask:0xa
s_nop 1
v_add_f32_dpp v77, v77, v77 quad_perm:[1,0,3,2] row_mask:0xf bank_mask:0xf
s_nop 1
v_add_f32_dpp v77, v77, v77 quad_perm:[2,3,0,1] row_mask:0xf bank_mask:0xf
s_waitcnt vmcnt(2)
v_dot2_f32_bf16 v232, v208, v216, 0
v_dot2_f32_bf16 v233, v208, v220, 0
v_dot2_f32_bf16 v234, v208, v224, 0
v_dot2_f32_bf16 v235, v208, v228, 0
v_dot2_f32_bf16 v232, v209, v217, v232
v_dot2_f32_bf16 v233, v209, v221, v233
v_dot2_f32_bf16 v234, v209, v225, v234
v_dot2_f32_bf16 v235, v209, v229, v235
v_dot2_f32_bf16 v232, v210, v218, v232
v_dot2_f32_bf16 v233, v210, v222, v233
v_dot2_f32_bf16 v234, v210, v226, v234
v_dot2_f32_bf16 v235, v210, v230, v235
v_dot2_f32_bf16 v232, v211, v219, v232
v_dot2_f32_bf16 v233, v211, v223, v233
v_dot2_f32_bf16 v234, v211, v227, v234
v_dot2_f32_bf16 v235, v211, v231, v235
v_add_f32_dpp v236, v232, v232 row_ror:8 row_mask:0xf bank_mask:0x3
v_add_f32_dpp v237, v233, v233 row_ror:8 row_mask:0xf bank_mask:0x3
v_add_f32_dpp v236, v234, v234 row_ror:8 row_mask:0xf bank_mask:0xc
v_add_f32_dpp v237, v235, v235 row_ror:8 row_mask:0xf bank_mask:0xc
s_nop 0
v_add_f32_dpp v78, v236, v236 row_half_mirror row_mask:0xf bank_mask:0x5
v_add_f32_dpp v78, v237, v237 row_half_mirror row_mask:0xf bank_mask:0xa
s_nop 1
v_add_f32_dpp v78, v78, v78 quad_perm:[1,0,3,2] row_mask:0xf bank_mask:0xf
s_nop 1
v_add_f32_dpp v78, v78, v78 quad_perm:[2,3,0,1] row_mask:0xf bank_mask:0xf
s_waitcnt vmcnt(1)
v_dot2_f32_bf16 v232, v212, v216, 0
v_dot2_f32_bf16 v233, v212, v220, 0
v_dot2_f32_bf16 v234, v212, v224, 0
v_dot2_f32_bf16 v235, v212, v228, 0
v_dot2_f32_bf16 v232, v213, v217, v232
v_dot2_f32_bf16 v233, v213, v221, v233
v_dot2_f32_bf16 v234, v213, v225, v234
v_dot2_f32_bf16 v235, v213, v229, v235
v_dot2_f32_bf16 v232, v214, v218, v232
v_dot2_f32_bf16 v233, v214, v222, v233
v_dot2_f32_bf16 v234, v214, v226, v234
v_dot2_f32_bf16 v235, v214, v230, v235
v_dot2_f32_bf16 v232, v215, v219, v232
v_dot2_f32_bf16 v233, v215, v223, v233
v_dot2_f32_bf16 v234, v215, v227, v234
v_dot2_f32_bf16 v235, v215, v231, v235
v_add_f32_dpp v236, v232, v232 row_ror:8 row_mask:0xf bank_mask:0x3
v_add_f32_dpp v237, v233, v233 row_ror:8 row_mask:0xf bank_mask:0x3
v_add_f32_dpp v236, v234, v234 row_ror:8 row_mask:0xf bank_mask:0xc
v_add_f32_dpp v237, v235, v235 row_ror:8 row_mask:0xf bank_mask:0xc
s_nop 0
v_add_f32_dpp v79, v236, v236 row_half_mirror row_mask:0xf bank_mask:0x5
v_add_f32_dpp v79, v237, v237 row_half_mirror row_mask:0xf bank_mask:0xa
s_nop 1
v_add_f32_dpp v79, v79, v79 quad_perm:[1,0,3,2] row_mask:0xf bank_mask:0xf
s_nop 1
v_add_f32_dpp v79, v79, v79 quad_perm:[2,3,0,1] row_mask:0xf bank_mask:0xf
v_cvt_pk_bf16_f32 v24, v64, v65
v_cvt_pk_bf16_f32 v25, v66, v67
v_cvt_pk_bf16_f32 v26, v68, v69
v_cvt_pk_bf16_f32 v27, v70, v71
v_cvt_pk_bf16_f32 v28, v72, v73
v_cvt_pk_bf16_f32 v29, v74, v75
v_cvt_pk_bf16_f32 v30, v76, v77
v_cvt_pk_bf16_f32 v31, v78, v79
v_cmp_eq_u32 vcc, 1, v6
s_nop 1
v_cndmask_b32 v248, v24, v28, vcc
v_cndmask_b32 v249, v25, v29, vcc
v_cndmask_b32 v250, v26, v30, vcc
v_cndmask_b32 v251, v27, v31, vcc
v_cmp_eq_u32 vcc, 1, v7
s_nop 1
v_cndmask_b32 v244, v244, v248, vcc
v_cndmask_b32 v245, v245, v249, vcc
v_cndmask_b32 v246, v246, v250, vcc
v_cndmask_b32 v247, v247, v251, vcc
v_min_u32 v244, -2, v244
v_min_u32 v245, -2, v245
v_min_u32 v246, -2, v246
v_min_u32 v247, -2, v247
s_waitcnt vmcnt(0)
s_mov_b32 s7, 400000
L_ens_35:
v_readfirstlane_b32 s6, v11
s_cmp_ge_u32 s6, 32
s_cbranch_scc1 L_ensd_36
s_sleep 16
buffer_load_dword v11, off, s[68:71], 0 offset:0 sc1
s_waitcnt vmcnt(0)
s_sub_u32 s7, s7, 1
s_cmp_lg_u32 s7, 0
s_cbranch_scc1 L_ens_35
L_ensd_36:
s_lshl_b32 s6, s4, 10
s_lshl_b32 s7, s3, 8
s_add_u32 s6, s6, s7
s_add_u32 s6, s6, 0
buffer_store_dwordx4 v[244:247], v5, s[64:67], s6 offen sc1
s_mov_b32 m0, s12
s_nop 0
buffer_load_dwordx4 v2, s[60:63], s12 offen offset:0 nt lds
buffer_load_dwordx4 v2, s[60:63], s12 offen offset:1024 nt lds
buffer_load_dwordx4 v2, s[60:63], s12 offen offset:2048 nt lds
s_waitcnt vmcnt(3)
buffer_load_dwordx4 v2, s[60:63], s12 offen offset:3072 nt lds
s_add_u32 s12, s12, 4096
s_mov_b32 m0, s12
s_waitcnt vmcnt(3)
buffer_load_dwordx4 v2, s[60:63], s12 offen offset:0 nt lds
s_waitcnt vmcnt(3)
buffer_load_dwordx4 v2, s[60:63], s12 offen offset:1024 nt lds
s_waitcnt vmcnt(3)
buffer_load_dwordx4 v2, s[60:63], s12 offen offset:2048 nt lds
s_waitcnt vmcnt(3)
buffer_load_dwordx4 v2, s[60:63], s12 offen offset:3072 nt lds
s_add_u32 s12, s12, 4096
s_mov_b32 m0, s12
s_waitcnt vmcnt(3)
buffer_load_dwordx4 v2, s[60:63], s12 offen offset:0 nt lds
s_waitcnt vmcnt(3)
buffer_load_dwordx4 v2, s[60:63], s12 offen offset:1024 nt lds
s_waitcnt vmcnt(3)
buffer_load_dwordx4 v2, s[60:63], s12 offen offset:2048 nt lds
s_waitcnt vmcnt(3)
buffer_load_dwordx4 v2, s[60:63], s12 offen offset:3072 nt lds
s_add_u32 s12, s12, 4096
s_mov_b32 m0, s12
s_waitcnt vmcnt(3)
buffer_load_dwordx4 v2, s[60:63], s12 offen offset:0 nt lds
s_waitcnt vmcnt(3)
buffer_load_dwordx4 v2, s[60:63], s12 offen offset:1024 nt lds
s_waitcnt vmcnt(3)
buffer_load_dwordx4 v2, s[60:63], s12 offen offset:2048 nt lds
s_waitcnt vmcnt(3)
buffer_load_dwordx4 v2, s[60:63], s12 offen offset:3072 nt lds
s_add_u32 s12, s12, 4096
s_mov_b32 m0, s12
s_waitcnt vmcnt(3)
buffer_load_dwordx4 v2, s[60:63], s12 offen offset:0 nt lds
s_waitcnt vmcnt(3)
buffer_load_dwordx4 v2, s[60:63], s12 offen offset:1024 nt lds
s_waitcnt vmcnt(3)
buffer_load_dwordx4 v2, s[60:63], s12 offen offset:2048 nt lds
s_waitcnt vmcnt(3)
buffer_load_dwordx4 v2, s[60:63], s12 offen offset:3072 nt lds
s_add_u32 s12, s12, 4096
s_mov_b32 m0, s12
s_waitcnt vmcnt(3)
buffer_load_dwordx4 v2, s[60:63], s12 offen offset:0 nt lds
s_waitcnt vmcnt(3)
buffer_load_dwordx4 v2, s[60:63], s12 offen offset:1024 nt lds
s_waitcnt vmcnt(3)
buffer_load_dwordx4 v2, s[60:63], s12 offen offset:2048 nt lds
s_waitcnt vmcnt(3)
buffer_load_dwordx4 v2, s[60:63], s12 offen offset:3072 nt lds
s_add_u32 s12, s12, 4096
s_mov_b32 m0, s12
s_waitcnt vmcnt(3)
buffer_load_dwordx4 v2, s[60:63], s12 offen offset:0 nt lds
s_waitcnt vmcnt(3)
buffer_load_dwordx4 v2, s[60:63], s12 offen offset:1024 nt lds
s_waitcnt vmcnt(3)
buffer_load_dwordx4 v2, s[60:63], s12 offen offset:2048 nt lds
s_waitcnt vmcnt(3)
buffer_load_dwordx4 v2, s[60:63], s12 offen offset:3072 nt lds
s_add_u32 s12, s12, 4096
s_mov_b32 m0, s12
s_waitcnt vmcnt(3)
buffer_load_dwordx4 v2, s[60:63], s12 offen offset:0 nt lds
s_waitcnt vmcnt(3)
buffer_load_dwordx4 v2, s[60:63], s12 offen offset:1024 nt lds
s_waitcnt vmcnt(3)
buffer_load_dwordx4 v2, s[60:63], s12 offen offset:2048 nt lds
s_waitcnt vmcnt(3)
buffer_load_dwordx4 v2, s[60:63], s12 offen offset:3072 nt lds
s_add_u32 s12, s12, 4096
s_mov_b32 m0, s12
s_waitcnt vmcnt(3)
buffer_load_dwordx4 v2, s[60:63], s12 offen offset:0 nt lds
s_waitcnt vmcnt(3)
buffer_load_dwordx4 v2, s[60:63], s12 offen offset:1024 nt lds
s_waitcnt vmcnt(3)
buffer_load_dwordx4 v2, s[60:63], s12 offen offset:2048 nt lds
s_waitcnt vmcnt(3)
buffer_load_dwordx4 v2, s[60:63], s12 offen offset:3072 nt lds
v_lshlrev_b32 v238, 18, v9
v_lshl_add_u32 v238, v8, 4, v238
s_mov_b32 s6, 0
s_waitcnt vmcnt(3)
buffer_load_dwordx4 v[88:91], v238, s[52:55], s6 offen nt
s_mov_b32 s6, 8192
s_waitcnt vmcnt(3)
buffer_load_dwordx4 v[92:95], v238, s[52:55], s6 offen nt
s_mov_b32 s6, 16384
s_waitcnt vmcnt(3)
buffer_load_dwordx4 v[96:99], v238, s[52:55], s6 offen nt
s_mov_b32 s6, 24576
s_waitcnt vmcnt(3)
buffer_load_dwordx4 v[100:103], v238, s[52:55], s6 offen nt
s_mov_b32 s6, 32768
s_waitcnt vmcnt(3)
buffer_load_dwordx4 v[104:107], v238, s[52:55], s6 offen nt
s_mov_b32 s6, 40960
s_waitcnt vmcnt(3)
buffer_load_dwordx4 v[108:111], v238, s[52:55], s6 offen nt
s_mov_b32 s6, 49152
s_waitcnt vmcnt(3)
buffer_load_dwordx4 v[112:115], v238, s[52:55], s6 offen nt
s_mov_b32 s6, 57344
s_waitcnt vmcnt(3)
buffer_load_dwordx4 v[116:119], v238, s[52:55], s6 offen nt
s_mov_b32 s6, 65536
s_waitcnt vmcnt(3)
buffer_load_dwordx4 v[120:123], v238, s[52:55], s6 offen nt
s_mov_b32 s6, 73728
s_waitcnt vmcnt(3)
buffer_load_dwordx4 v[124:127], v238, s[52:55], s6 offen nt
s_mov_b32 s6, 81920
s_waitcnt vmcnt(3)
buffer_load_dwordx4 v[128:131], v238, s[52:55], s6 offen nt
s_mov_b32 s6, 90112
s_waitcnt vmcnt(3)
buffer_load_dwordx4 v[132:135], v238, s[52:55], s6 offen nt
s_mov_b32 s6, 98304
s_waitcnt vmcnt(3)
buffer_load_dwordx4 v[136:139], v238, s[52:55], s6 offen nt
s_mov_b32 s6, 106496
s_waitcnt vmcnt(3)
buffer_load_dwordx4 v[140:143], v238, s[52:55], s6 offen nt
s_mov_b32 s6, 114688
s_waitcnt vmcnt(3)
buffer_load_dwordx4 v[144:147], v238, s[52:55], s6 offen nt
s_mov_b32 s6, 122880
s_waitcnt vmcnt(3)
buffer_load_dwordx4 v[148:151], v238, s[52:55], s6 offen nt
s_mov_b32 s6, 131072
s_waitcnt vmcnt(3)
buffer_load_dwordx4 v[152:155], v238, s[52:55], s6 offen nt
s_mov_b32 s6, 139264
s_waitcnt vmcnt(3)
buffer_load_dwordx4 v[156:159], v238, s[52:55], s6 offen nt
s_mov_b32 s6, 147456
s_waitcnt vmcnt(3)
buffer_load_dwordx4 v[160:163], v238, s[52:55], s6 offen nt
s_mov_b32 s6, 155648
s_waitcnt vmcnt(3)
buffer_load_dwordx4 v[164:167], v238, s[52:55], s6 offen nt
s_mov_b32 s6, 163840
s_waitcnt vmcnt(3)
buffer_load_dwordx4 v[168:171], v238, s[52:55], s6 offen nt
s_mov_b32 s6, 172032
s_waitcnt vmcnt(3)
buffer_load_dwordx4 v[172:175], v238, s[52:55], s6 offen nt
s_mov_b32 s6, 180224
s_waitcnt vmcnt(3)
buffer_load_dwordx4 v[176:179], v238, s[52:55], s6 offen nt
s_mov_b32 s6, 188416
s_waitcnt vmcnt(3)
buffer_load_dwordx4 v[180:183], v238, s[52:55], s6 offen nt
s_mov_b32 s6, 196608
s_waitcnt vmcnt(3)
buffer_load_dwordx4 v[184:187], v238, s[52:55], s6 offen nt
s_mov_b32 s6, 204800
s_waitcnt vmcnt(3)
buffer_load_dwordx4 v[188:191], v238, s[52:55], s6 offen nt
s_mov_b32 s6, 212992
s_waitcnt vmcnt(3)
buffer_load_dwordx4 v[192:195], v238, s[52:55], s6 offen nt
s_mov_b32 s6, 221184
s_waitcnt vmcnt(3)
buffer_load_dwordx4 v[196:199], v238, s[52:55], s6 offen nt
s_mov_b32 s6, 229376
s_waitcnt vmcnt(3)
buffer_load_dwordx4 v[200:203], v238, s[52:55], s6 offen nt
s_mov_b32 s6, 237568
s_waitcnt vmcnt(3)
buffer_load_dwordx4 v[204:207], v238, s[52:55], s6 offen nt
s_mov_b32 s6, 245760
s_waitcnt vmcnt(3)
buffer_load_dwordx4 v[208:211], v238, s[52:55], s6 offen nt
s_mov_b32 s6, 253952
s_waitcnt vmcnt(3)
buffer_load_dwordx4 v[212:215], v238, s[52:55], s6 offen nt
v_mov_b32 v11, 163824
v_mov_b32 v7, 0
ds_write_b32 v11, v7
s_waitcnt lgkmcnt(0)
s_barrier
ds_read_b64_tr_b16 a[96:97], v240 offset:0
ds_read_b64_tr_b16 a[98:99], v240 offset:4608
ds_read_b64_tr_b16 a[100:101], v240 offset:36864
ds_read_b64_tr_b16 a[102:103], v240 offset:41472
ds_read_b64_tr_b16 a[104:105], v242 offset:0
ds_read_b64_tr_b16 a[106:107], v242 offset:4608
ds_read_b64_tr_b16 a[108:109], v242 offset:36864
ds_read_b64_tr_b16 a[110:111], v242 offset:41472
ds_read_b64_tr_b16 a[112:113], v240 offset:8
ds_read_b64_tr_b16 a[114:115], v240 offset:4616
ds_read_b64_tr_b16 a[116:117], v240 offset:36872
ds_read_b64_tr_b16 a[118:119], v240 offset:41480
ds_read_b64_tr_b16 a[120:121], v242 offset:8
ds_read_b64_tr_b16 a[122:123], v242 offset:4616
ds_read_b64_tr_b16 a[124:125], v242 offset:36872
ds_read_b64_tr_b16 a[126:127], v242 offset:41480
ds_read_b64_tr_b16 a[128:129], v240 offset:16
ds_read_b64_tr_b16 a[130:131], v240 offset:4624
ds_read_b64_tr_b16 a[132:133], v240 offset:36880
ds_read_b64_tr_b16 a[134:135], v240 offset:41488
ds_read_b64_tr_b16 a[136:137], v242 offset:16
ds_read_b64_tr_b16 a[138:139], v242 offset:4624
ds_read_b64_tr_b16 a[140:141], v242 offset:36880
ds_read_b64_tr_b16 a[142:143], v242 offset:41488
ds_read_b64_tr_b16 a[144:145], v240 offset:24
ds_read_b64_tr_b16 a[146:147], v240 offset:4632
ds_read_b64_tr_b16 a[148:149], v240 offset:36888
ds_read_b64_tr_b16 a[150:151], v240 offset:41496
ds_read_b64_tr_b16 a[152:153], v242 offset:24
ds_read_b64_tr_b16 a[154:155], v242 offset:4632
ds_read_b64_tr_b16 a[156:157], v242 offset:36888
ds_read_b64_tr_b16 a[158:159], v242 offset:41496
ds_read_b64_tr_b16 a[160:161], v240 offset:128
ds_read_b64_tr_b16 a[162:163], v240 offset:4736
ds_read_b64_tr_b16 a[164:165], v240 offset:36992
ds_read_b64_tr_b16 a[166:167], v240 offset:41600
ds_read_b64_tr_b16 a[168:169], v242 offset:128
ds_read_b64_tr_b16 a[170:171], v242 offset:4736
ds_read_b64_tr_b16 a[172:173], v242 offset:36992
ds_read_b64_tr_b16 a[174:175], v242 offset:41600
ds_read_b64_tr_b16 a[176:177], v240 offset:136
ds_read_b64_tr_b16 a[178:179], v240 offset:4744
ds_read_b64_tr_b16 a[180:181], v240 offset:37000
ds_read_b64_tr_b16 a[182:183], v240 offset:41608
ds_read_b64_tr_b16 a[184:185], v242 offset:136
ds_read_b64_tr_b16 a[186:187], v242 offset:4744
ds_read_b64_tr_b16 a[188:189], v242 offset:37000
ds_read_b64_tr_b16 a[190:191], v242 offset:41608
ds_read_b64_tr_b16 a[192:193], v240 offset:144
ds_read_b64_tr_b16 a[194:195], v240 offset:4752
ds_read_b64_tr_b16 a[196:197], v240 offset:37008
ds_read_b64_tr_b16 a[198:199], v240 offset:41616
ds_read_b64_tr_b16 a[200:201], v242 offset:144
ds_read_b64_tr_b16 a[202:203], v242 offset:4752
ds_read_b64_tr_b16 a[204:205], v242 offset:37008
ds_read_b64_tr_b16 a[206:207], v242 offset:41616
ds_read_b64_tr_b16 a[208:209], v240 offset:152
ds_read_b64_tr_b16 a[210:211], v240 offset:4760
ds_read_b64_tr_b16 a[212:213], v240 offset:37016
ds_read_b64_tr_b16 a[214:215], v240 offset:41624
ds_read_b64_tr_b16 a[216:217], v242 offset:152
ds_read_b64_tr_b16 a[218:219], v242 offset:4760
ds_read_b64_tr_b16 a[220:221], v242 offset:37016
ds_read_b64_tr_b16 a[222:223], v242 offset:41624
ds_read_b64_tr_b16 a[224:225], v241 offset:0
ds_read_b64_tr_b16 a[226:227], v241 offset:4608
ds_read_b64_tr_b16 a[228:229], v241 offset:36864
ds_read_b64_tr_b16 a[230:231], v241 offset:41472
ds_read_b64_tr_b16 a[232:233], v243 offset:0
ds_read_b64_tr_b16 a[234:235], v243 offset:4608
ds_read_b64_tr_b16 a[236:237], v243 offset:36864
ds_read_b64_tr_b16 a[238:239], v243 offset:41472
v_and_b32 v6, 7, v1
v_mul_u32_u24 v6, 8, v6
s_lshl_b32 s6, s4, 8
s_mul_i32 s7, s3, 64
s_add_u32 s6, s6, s7
s_add_u32 s15, s6, 262144
s_mov_b32 s7, 400000
P_poll:
buffer_load_dwordx2 v[232:233], v6, s[64:67], s15 offen sc1
s_waitcnt vmcnt(0)
v_max_u32 v234, v232, v233
v_cmp_eq_u32 vcc, -1, v234
s_cbranch_vccz P_ok
s_sleep 16
s_sub_u32 s7, s7, 1
s_cmp_lg_u32 s7, 0
s_cbranch_scc1 P_poll
P_ok:
s_lshr_b32 s6, s4, 3
s_mul_i32 s6, s6, 524288
s_bitcmp1_b32 s4, 0
s_cselect_b32 s7, 98304, 0
s_add_u32 s6, s6, s7
s_bitcmp1_b32 s4, 1
s_cselect_b32 s7, 131072, 0
s_add_u32 s6, s6, s7
s_bitcmp1_b32 s4, 2
s_cselect_b32 s7, 262144, 0
s_add_u32 s6, s6, s7
s_lshl_b32 s7, s3, 13
s_add_u32 s6, s6, s7
s_add_u32 s6, s6, 2097152
buffer_load_dwordx4 v[24:27], v2, s[64:67], s6 offen offset:0 sc1
buffer_load_dwordx4 v[28:31], v2, s[64:67], s6 offen offset:1024 sc1
buffer_load_dwordx4 v[32:35], v2, s[64:67], s6 offen offset:2048 sc1
buffer_load_dwordx4 v[36:39], v2, s[64:67], s6 offen offset:3072 sc1
s_add_u32 s6, s6, 4096
buffer_load_dwordx4 v[40:43], v2, s[64:67], s6 offen offset:0 sc1
buffer_load_dwordx4 v[44:47], v2, s[64:67], s6 offen offset:1024 sc1
buffer_load_dwordx4 v[48:51], v2, s[64:67], s6 offen offset:2048 sc1
buffer_load_dwordx4 v[52:55], v2, s[64:67], s6 offen offset:3072 sc1
v_mov_b32 v234, v232
s_nop 1
v_max_f32_dpp v234, v234, v234 row_ror:4 row_mask:0xf bank_mask:0xf
s_nop 1
v_max_f32_dpp v234, v234, v234 row_ror:2 row_mask:0xf bank_mask:0xf
s_nop 1
v_max_f32_dpp v234, v234, v234 row_ror:1 row_mask:0xf bank_mask:0xf
v_sub_f32 v232, v232, v234
v_exp_f32 v232, v232
s_nop 0
v_mul_f32 v235, v232, v233
s_nop 1
v_add_f32_dpp v235, v235, v235 row_ror:4 row_mask:0xf bank_mask:0xf
s_nop 1
v_add_f32_dpp v235, v235, v235 row_ror:2 row_mask:0xf bank_mask:0xf
s_nop 1
v_add_f32_dpp v235, v235, v235 row_ror:1 row_mask:0xf bank_mask:0xf
v_rcp_f32 v235, v235
s_nop 0
v_mul_f32 v232, v232, v235
s_nop 0
v_readlane_b32 s26, v232, 0
v_readlane_b32 s27, v232, 1
v_readlane_b32 s28, v232, 2
v_readlane_b32 s29, v232, 3
v_readlane_b32 s30, v232, 4
v_readlane_b32 s31, v232, 5
v_readlane_b32 s32, v232, 6
v_readlane_b32 s33, v232, 7
s_mul_i32 s6, s3, 1040
s_add_u32 s6, s6, 147456
v_add_u32 v5, s6, v2
v_lshrrev_b32 v6, 3, v8
v_mul_u32_u24 v6, 1040, v6
v_lshl_add_u32 v6, v9, 6, v6
s_lshl_b32 s6, s3, 8
s_add_u32 s6, s6, 147456
v_add_u32 v6, s6, v6
s_waitcnt vmcnt(7)
v_lshlrev_b32 v244, 16, v24
v_and_b32 v245, 0xffff0000, v24
v_lshlrev_b32 v246, 16, v25
v_and_b32 v247, 0xffff0000, v25
v_lshlrev_b32 v248, 16, v26
v_and_b32 v249, 0xffff0000, v26
v_lshlrev_b32 v250, 16, v27
v_and_b32 v251, 0xffff0000, v27
v_mul_f32 v216, s26, v244
v_mul_f32 v217, s26, v245
v_mul_f32 v218, s26, v246
v_mul_f32 v219, s26, v247
v_mul_f32 v220, s26, v248
v_mul_f32 v221, s26, v249
v_mul_f32 v222, s26, v250
v_mul_f32 v223, s26, v251
s_waitcnt vmcnt(6)
v_lshlrev_b32 v244, 16, v28
v_and_b32 v245, 0xffff0000, v28
v_lshlrev_b32 v246, 16, v29
v_and_b32 v247, 0xffff0000, v29
v_lshlrev_b32 v248, 16, v30
v_and_b32 v249, 0xffff0000, v30
v_lshlrev_b32 v250, 16, v31
v_and_b32 v251, 0xffff0000, v31
v_fma_f32 v216, v244, s27, v216
v_fma_f32 v217, v245, s27, v217
v_fma_f32 v218, v246, s27, v218
v_fma_f32 v219, v247, s27, v219
v_fma_f32 v220, v248, s27, v220
v_fma_f32 v221, v249, s27, v221
v_fma_f32 v222, v250, s27, v222
v_fma_f32 v223, v251, s27, v223
s_waitcnt vmcnt(5)
v_lshlrev_b32 v244, 16, v32
v_and_b32 v245, 0xffff0000, v32
v_lshlrev_b32 v246, 16, v33
v_and_b32 v247, 0xffff0000, v33
v_lshlrev_b32 v248, 16, v34
v_and_b32 v249, 0xffff0000, v34
v_lshlrev_b32 v250, 16, v35
v_and_b32 v251, 0xffff0000, v35
v_fma_f32 v216, v244, s28, v216
v_fma_f32 v217, v245, s28, v217
v_fma_f32 v218, v246, s28, v218
v_fma_f32 v219, v247, s28, v219
v_fma_f32 v220, v248, s28, v220
v_fma_f32 v221, v249, s28, v221
v_fma_f32 v222, v250, s28, v222
v_fma_f32 v223, v251, s28, v223
s_waitcnt vmcnt(4)
v_lshlrev_b32 v244, 16, v36
v_and_b32 v245, 0xffff0000, v36
v_lshlrev_b32 v246, 16, v37
v_and_b32 v247, 0xffff0000, v37
v_lshlrev_b32 v248, 16, v38
v_and_b32 v249, 0xffff0000, v38
v_lshlrev_b32 v250, 16, v39
v_and_b32 v251, 0xffff0000, v39
v_fma_f32 v216, v244, s29, v216
v_fma_f32 v217, v245, s29, v217
v_fma_f32 v218, v246, s29, v218
v_fma_f32 v219, v247, s29, v219
v_fma_f32 v220, v248, s29, v220
v_fma_f32 v221, v249, s29, v221
v_fma_f32 v222, v250, s29, v222
v_fma_f32 v223, v251, s29, v223
s_waitcnt vmcnt(3)
v_lshlrev_b32 v244, 16, v40
v_and_b32 v245, 0xffff0000, v40
v_lshlrev_b32 v246, 16, v41
v_and_b32 v247, 0xffff0000, v41
v_lshlrev_b32 v248, 16, v42
v_and_b32 v249, 0xffff0000, v42
v_lshlrev_b32 v250, 16, v43
v_and_b32 v251, 0xffff0000, v43
v_fma_f32 v216, v244, s30, v216
v_fma_f32 v217, v245, s30, v217
v_fma_f32 v218, v246, s30, v218
v_fma_f32 v219, v247, s30, v219
v_fma_f32 v220, v248, s30, v220
v_fma_f32 v221, v249, s30, v221
v_fma_f32 v222, v250, s30, v222
v_fma_f32 v223, v251, s30, v223
s_waitcnt vmcnt(2)
v_lshlrev_b32 v244, 16, v44
v_and_b32 v245, 0xffff0000, v44
v_lshlrev_b32 v246, 16, v45
v_and_b32 v247, 0xffff0000, v45
v_lshlrev_b32 v248, 16, v46
v_and_b32 v249, 0xffff0000, v46
v_lshlrev_b32 v250, 16, v47
v_and_b32 v251, 0xffff0000, v47
v_fma_f32 v216, v244, s31, v216
v_fma_f32 v217, v245, s31, v217
v_fma_f32 v218, v246, s31, v218
v_fma_f32 v219, v247, s31, v219
v_fma_f32 v220, v248, s31, v220
v_fma_f32 v221, v249, s31, v221
v_fma_f32 v222, v250, s31, v222
v_fma_f32 v223, v251, s31, v223
s_waitcnt vmcnt(1)
v_lshlrev_b32 v244, 16, v48
v_and_b32 v245, 0xffff0000, v48
v_lshlrev_b32 v246, 16, v49
v_and_b32 v247, 0xffff0000, v49
v_lshlrev_b32 v248, 16, v50
v_and_b32 v249, 0xffff0000, v50
v_lshlrev_b32 v250, 16, v51
v_and_b32 v251, 0xffff0000, v51
v_fma_f32 v216, v244, s32, v216
v_fma_f32 v217, v245, s32, v217
v_fma_f32 v218, v246, s32, v218
v_fma_f32 v219, v247, s32, v219
v_fma_f32 v220, v248, s32, v220
v_fma_f32 v221, v249, s32, v221
v_fma_f32 v222, v250, s32, v222
v_fma_f32 v223, v251, s32, v223
s_waitcnt vmcnt(0)
v_lshlrev_b32 v244, 16, v52
v_and_b32 v245, 0xffff0000, v52
v_lshlrev_b32 v246, 16, v53
v_and_b32 v247, 0xffff0000, v53
v_lshlrev_b32 v248, 16, v54
v_and_b32 v249, 0xffff0000, v54
v_lshlrev_b32 v250, 16, v55
v_and_b32 v251, 0xffff0000, v55
v_fma_f32 v216, v244, s33, v216
v_fma_f32 v217, v245, s33, v217
v_fma_f32 v218, v246, s33, v218
v_fma_f32 v219, v247, s33, v219
v_fma_f32 v220, v248, s33, v220
v_fma_f32 v221, v249, s33, v221
v_fma_f32 v222, v250, s33, v222
v_fma_f32 v223, v251, s33, v223
v_cvt_pk_bf16_f32 v224, v216, v217
v_cvt_pk_bf16_f32 v225, v218, v219
v_cvt_pk_bf16_f32 v226, v220, v221
v_cvt_pk_bf16_f32 v227, v222, v223
ds_write_b128 v5, v[224:227]
s_waitcnt lgkmcnt(0)
s_barrier
ds_read_b128 v[24:27], v6 offset:0
ds_read_b128 v[44:47], v6 offset:2080
ds_read_b128 v[28:31], v6 offset:16
ds_read_b128 v[48:51], v6 offset:2096
ds_read_b128 v[32:35], v6 offset:32
ds_read_b128 v[52:55], v6 offset:2112
ds_read_b128 v[36:39], v6 offset:48
ds_read_b128 v[56:59], v6 offset:2128
v_lshrrev_b32 v5, 5, v1
v_mul_u32_u24 v5, 1088, v5
v_lshl_add_u32 v5, v8, 4, v5
v_and_b32 v7, 1, v9
v_lshl_add_u32 v5, v7, 3, v5
s_mul_i32 s6, s3, 272
s_add_u32 s6, s6, 155648
v_add_u32 v5, s6, v5
v_mul_u32_u24 v7, 272, v8
v_lshl_add_u32 v7, v9, 4, v7
v_add_u32 v7, 155648, v7
s_waitcnt lgkmcnt(0)
v_perm_b32 v64, v24, v24, v16
v_perm_b32 v65, v24, v24, v17
v_perm_b32 v66, v24, v24, v18
v_perm_b32 v67, v24, v24, v19
s_nop 1
v_mfma_f32_16x16x32_bf16 v[80:83], v[64:67], v[88:91], 0
v_perm_b32 v68, v44, v44, v16
v_perm_b32 v69, v44, v44, v17
v_perm_b32 v70, v44, v44, v18
v_perm_b32 v71, v44, v44, v19
s_nop 1
v_mfma_f32_16x16x32_bf16 v[84:87], v[68:71], v[88:91], 0
v_perm_b32 v72, v24, v24, v20
v_perm_b32 v73, v24, v24, v21
v_perm_b32 v74, v24, v24, v22
v_perm_b32 v75, v24, v24, v23
s_nop 1
v_mfma_f32_16x16x32_bf16 v[80:83], v[72:75], v[92:95], v[80:83]
v_perm_b32 v76, v44, v44, v20
v_perm_b32 v77, v44, v44, v21
v_perm_b32 v78, v44, v44, v22
v_perm_b32 v79, v44, v44, v23
s_nop 1
v_mfma_f32_16x16x32_bf16 v[84:87], v[76:79], v[92:95], v[84:87]
v_perm_b32 v64, v25, v25, v16
v_perm_b32 v65, v25, v25, v17
v_perm_b32 v66, v25, v25, v18
v_perm_b32 v67, v25, v25, v19
s_nop 1
v_mfma_f32_16x16x32_bf16 v[80:83], v[64:67], v[96:99], v[80:83]
v_perm_b32 v68, v45, v45, v16
v_perm_b32 v69, v45, v45, v17
v_perm_b32 v70, v45, v45, v18
v_perm_b32 v71, v45, v45, v19
s_nop 1
v_mfma_f32_16x16x32_bf16 v[84:87], v[68:71], v[96:99], v[84:87]
v_perm_b32 v72, v25, v25, v20
v_perm_b32 v73, v25, v25, v21
v_perm_b32 v74, v25, v25, v22
v_perm_b32 v75, v25, v25, v23
s_nop 1
v_mfma_f32_16x16x32_bf16 v[80:83], v[72:75], v[100:103], v[80:83]
v_perm_b32 v76, v45, v45, v20
v_perm_b32 v77, v45, v45, v21
v_perm_b32 v78, v45, v45, v22
v_perm_b32 v79, v45, v45, v23
s_nop 1
v_mfma_f32_16x16x32_bf16 v[84:87], v[76:79], v[100:103], v[84:87]
v_perm_b32 v64, v26, v26, v16
v_perm_b32 v65, v26, v26, v17
v_perm_b32 v66, v26, v26, v18
v_perm_b32 v67, v26, v26, v19
s_nop 1
v_mfma_f32_16x16x32_bf16 v[80:83], v[64:67], v[104:107], v[80:83]
v_perm_b32 v68, v46, v46, v16
v_perm_b32 v69, v46, v46, v17
v_perm_b32 v70, v46, v46, v18
v_perm_b32 v71, v46, v46, v19
s_nop 1
v_mfma_f32_16x16x32_bf16 v[84:87], v[68:71], v[104:107], v[84:87]
v_perm_b32 v72, v26, v26, v20
v_perm_b32 v73, v26, v26, v21
v_perm_b32 v74, v26, v26, v22
v_perm_b32 v75, v26, v26, v23
s_nop 1
v_mfma_f32_16x16x32_bf16 v[80:83], v[72:75], v[108:111], v[80:83]
v_perm_b32 v76, v46, v46, v20
v_perm_b32 v77, v46, v46, v21
v_perm_b32 v78, v46, v46, v22
v_perm_b32 v79, v46, v46, v23
s_nop 1
v_mfma_f32_16x16x32_bf16 v[84:87], v[76:79], v[108:111], v[84:87]
v_perm_b32 v64, v27, v27, v16
v_perm_b32 v65, v27, v27, v17
v_perm_b32 v66, v27, v27, v18
v_perm_b32 v67, v27, v27, v19
s_nop 1
v_mfma_f32_16x16x32_bf16 v[80:83], v[64:67], v[112:115], v[80:83]
v_perm_b32 v68, v47, v47, v16
v_perm_b32 v69, v47, v47, v17
v_perm_b32 v70, v47, v47, v18
v_perm_b32 v71, v47, v47, v19
s_nop 1
v_mfma_f32_16x16x32_bf16 v[84:87], v[68:71], v[112:115], v[84:87]
v_perm_b32 v72, v27, v27, v20
v_perm_b32 v73, v27, v27, v21
v_perm_b32 v74, v27, v27, v22
v_perm_b32 v75, v27, v27, v23
s_nop 1
v_mfma_f32_16x16x32_bf16 v[80:83], v[72:75], v[116:119], v[80:83]
v_perm_b32 v76, v47, v47, v20
v_perm_b32 v77, v47, v47, v21
v_perm_b32 v78, v47, v47, v22
v_perm_b32 v79, v47, v47, v23
s_nop 1
v_mfma_f32_16x16x32_bf16 v[84:87], v[76:79], v[116:119], v[84:87]
v_perm_b32 v64, v28, v28, v16
v_perm_b32 v65, v28, v28, v17
v_perm_b32 v66, v28, v28, v18
v_perm_b32 v67, v28, v28, v19
s_nop 1
v_mfma_f32_16x16x32_bf16 v[80:83], v[64:67], v[120:123], v[80:83]
v_perm_b32 v68, v48, v48, v16
v_perm_b32 v69, v48, v48, v17
v_perm_b32 v70, v48, v48, v18
v_perm_b32 v71, v48, v48, v19
s_nop 1
v_mfma_f32_16x16x32_bf16 v[84:87], v[68:71], v[120:123], v[84:87]
v_perm_b32 v72, v28, v28, v20
v_perm_b32 v73, v28, v28, v21
v_perm_b32 v74, v28, v28, v22
v_perm_b32 v75, v28, v28, v23
s_nop 1
v_mfma_f32_16x16x32_bf16 v[80:83], v[72:75], v[124:127], v[80:83]
v_perm_b32 v76, v48, v48, v20
v_perm_b32 v77, v48, v48, v21
v_perm_b32 v78, v48, v48, v22
v_perm_b32 v79, v48, v48, v23
s_nop 1
v_mfma_f32_16x16x32_bf16 v[84:87], v[76:79], v[124:127], v[84:87]
v_perm_b32 v64, v29, v29, v16
v_perm_b32 v65, v29, v29, v17
v_perm_b32 v66, v29, v29, v18
v_perm_b32 v67, v29, v29, v19
s_nop 1
v_mfma_f32_16x16x32_bf16 v[80:83], v[64:67], v[128:131], v[80:83]
v_perm_b32 v68, v49, v49, v16
v_perm_b32 v69, v49, v49, v17
v_perm_b32 v70, v49, v49, v18
v_perm_b32 v71, v49, v49, v19
s_nop 1
v_mfma_f32_16x16x32_bf16 v[84:87], v[68:71], v[128:131], v[84:87]
v_perm_b32 v72, v29, v29, v20
v_perm_b32 v73, v29, v29, v21
v_perm_b32 v74, v29, v29, v22
v_perm_b32 v75, v29, v29, v23
s_nop 1
v_mfma_f32_16x16x32_bf16 v[80:83], v[72:75], v[132:135], v[80:83]
v_perm_b32 v76, v49, v49, v20
v_perm_b32 v77, v49, v49, v21
v_perm_b32 v78, v49, v49, v22
v_perm_b32 v79, v49, v49, v23
s_nop 1
v_mfma_f32_16x16x32_bf16 v[84:87], v[76:79], v[132:135], v[84:87]
v_perm_b32 v64, v30, v30, v16
v_perm_b32 v65, v30, v30, v17
v_perm_b32 v66, v30, v30, v18
v_perm_b32 v67, v30, v30, v19
s_nop 1
v_mfma_f32_16x16x32_bf16 v[80:83], v[64:67], v[136:139], v[80:83]
v_perm_b32 v68, v50, v50, v16
v_perm_b32 v69, v50, v50, v17
v_perm_b32 v70, v50, v50, v18
v_perm_b32 v71, v50, v50, v19
s_nop 1
v_mfma_f32_16x16x32_bf16 v[84:87], v[68:71], v[136:139], v[84:87]
v_perm_b32 v72, v30, v30, v20
v_perm_b32 v73, v30, v30, v21
v_perm_b32 v74, v30, v30, v22
v_perm_b32 v75, v30, v30, v23
s_nop 1
v_mfma_f32_16x16x32_bf16 v[80:83], v[72:75], v[140:143], v[80:83]
v_perm_b32 v76, v50, v50, v20
v_perm_b32 v77, v50, v50, v21
v_perm_b32 v78, v50, v50, v22
v_perm_b32 v79, v50, v50, v23
s_nop 1
v_mfma_f32_16x16x32_bf16 v[84:87], v[76:79], v[140:143], v[84:87]
v_perm_b32 v64, v31, v31, v16
v_perm_b32 v65, v31, v31, v17
v_perm_b32 v66, v31, v31, v18
v_perm_b32 v67, v31, v31, v19
s_nop 1
v_mfma_f32_16x16x32_bf16 v[80:83], v[64:67], v[144:147], v[80:83]
v_perm_b32 v68, v51, v51, v16
v_perm_b32 v69, v51, v51, v17
v_perm_b32 v70, v51, v51, v18
v_perm_b32 v71, v51, v51, v19
s_nop 1
v_mfma_f32_16x16x32_bf16 v[84:87], v[68:71], v[144:147], v[84:87]
v_perm_b32 v72, v31, v31, v20
v_perm_b32 v73, v31, v31, v21
v_perm_b32 v74, v31, v31, v22
v_perm_b32 v75, v31, v31, v23
s_nop 1
v_mfma_f32_16x16x32_bf16 v[80:83], v[72:75], v[148:151], v[80:83]
v_perm_b32 v76, v51, v51, v20
v_perm_b32 v77, v51, v51, v21
v_perm_b32 v78, v51, v51, v22
v_perm_b32 v79, v51, v51, v23
s_nop 1
v_mfma_f32_16x16x32_bf16 v[84:87], v[76:79], v[148:151], v[84:87]
v_perm_b32 v64, v32, v32, v16
v_perm_b32 v65, v32, v32, v17
v_perm_b32 v66, v32, v32, v18
v_perm_b32 v67, v32, v32, v19
s_nop 1
v_mfma_f32_16x16x32_bf16 v[80:83], v[64:67], v[152:155], v[80:83]
v_perm_b32 v68, v52, v52, v16
v_perm_b32 v69, v52, v52, v17
v_perm_b32 v70, v52, v52, v18
v_perm_b32 v71, v52, v52, v19
s_nop 1
v_mfma_f32_16x16x32_bf16 v[84:87], v[68:71], v[152:155], v[84:87]
v_perm_b32 v72, v32, v32, v20
v_perm_b32 v73, v32, v32, v21
v_perm_b32 v74, v32, v32, v22
v_perm_b32 v75, v32, v32, v23
s_nop 1
v_mfma_f32_16x16x32_bf16 v[80:83], v[72:75], v[156:159], v[80:83]
v_perm_b32 v76, v52, v52, v20
v_perm_b32 v77, v52, v52, v21
v_perm_b32 v78, v52, v52, v22
v_perm_b32 v79, v52, v52, v23
s_nop 1
v_mfma_f32_16x16x32_bf16 v[84:87], v[76:79], v[156:159], v[84:87]
v_perm_b32 v64, v33, v33, v16
v_perm_b32 v65, v33, v33, v17
v_perm_b32 v66, v33, v33, v18
v_perm_b32 v67, v33, v33, v19
s_nop 1
v_mfma_f32_16x16x32_bf16 v[80:83], v[64:67], v[160:163], v[80:83]
v_perm_b32 v68, v53, v53, v16
v_perm_b32 v69, v53, v53, v17
v_perm_b32 v70, v53, v53, v18
v_perm_b32 v71, v53, v53, v19
s_nop 1
v_mfma_f32_16x16x32_bf16 v[84:87], v[68:71], v[160:163], v[84:87]
v_perm_b32 v72, v33, v33, v20
v_perm_b32 v73, v33, v33, v21
v_perm_b32 v74, v33, v33, v22
v_perm_b32 v75, v33, v33, v23
s_nop 1
v_mfma_f32_16x16x32_bf16 v[80:83], v[72:75], v[164:167], v[80:83]
v_perm_b32 v76, v53, v53, v20
v_perm_b32 v77, v53, v53, v21
v_perm_b32 v78, v53, v53, v22
v_perm_b32 v79, v53, v53, v23
s_nop 1
v_mfma_f32_16x16x32_bf16 v[84:87], v[76:79], v[164:167], v[84:87]
v_perm_b32 v64, v34, v34, v16
v_perm_b32 v65, v34, v34, v17
v_perm_b32 v66, v34, v34, v18
v_perm_b32 v67, v34, v34, v19
s_nop 1
v_mfma_f32_16x16x32_bf16 v[80:83], v[64:67], v[168:171], v[80:83]
v_perm_b32 v68, v54, v54, v16
v_perm_b32 v69, v54, v54, v17
v_perm_b32 v70, v54, v54, v18
v_perm_b32 v71, v54, v54, v19
s_nop 1
v_mfma_f32_16x16x32_bf16 v[84:87], v[68:71], v[168:171], v[84:87]
v_perm_b32 v72, v34, v34, v20
v_perm_b32 v73, v34, v34, v21
v_perm_b32 v74, v34, v34, v22
v_perm_b32 v75, v34, v34, v23
s_nop 1
v_mfma_f32_16x16x32_bf16 v[80:83], v[72:75], v[172:175], v[80:83]
v_perm_b32 v76, v54, v54, v20
v_perm_b32 v77, v54, v54, v21
v_perm_b32 v78, v54, v54, v22
v_perm_b32 v79, v54, v54, v23
s_nop 1
v_mfma_f32_16x16x32_bf16 v[84:87], v[76:79], v[172:175], v[84:87]
v_perm_b32 v64, v35, v35, v16
v_perm_b32 v65, v35, v35, v17
v_perm_b32 v66, v35, v35, v18
v_perm_b32 v67, v35, v35, v19
s_nop 1
v_mfma_f32_16x16x32_bf16 v[80:83], v[64:67], v[176:179], v[80:83]
v_perm_b32 v68, v55, v55, v16
v_perm_b32 v69, v55, v55, v17
v_perm_b32 v70, v55, v55, v18
v_perm_b32 v71, v55, v55, v19
s_nop 1
v_mfma_f32_16x16x32_bf16 v[84:87], v[68:71], v[176:179], v[84:87]
v_perm_b32 v72, v35, v35, v20
v_perm_b32 v73, v35, v35, v21
v_perm_b32 v74, v35, v35, v22
v_perm_b32 v75, v35, v35, v23
s_nop 1
v_mfma_f32_16x16x32_bf16 v[80:83], v[72:75], v[180:183], v[80:83]
v_perm_b32 v76, v55, v55, v20
v_perm_b32 v77, v55, v55, v21
v_perm_b32 v78, v55, v55, v22
v_perm_b32 v79, v55, v55, v23
s_nop 1
v_mfma_f32_16x16x32_bf16 v[84:87], v[76:79], v[180:183], v[84:87]
v_perm_b32 v64, v36, v36, v16
v_perm_b32 v65, v36, v36, v17
v_perm_b32 v66, v36, v36, v18
v_perm_b32 v67, v36, v36, v19
s_nop 1
v_mfma_f32_16x16x32_bf16 v[80:83], v[64:67], v[184:187], v[80:83]
v_perm_b32 v68, v56, v56, v16
v_perm_b32 v69, v56, v56, v17
v_perm_b32 v70, v56, v56, v18
v_perm_b32 v71, v56, v56, v19
s_nop 1
v_mfma_f32_16x16x32_bf16 v[84:87], v[68:71], v[184:187], v[84:87]
v_perm_b32 v72, v36, v36, v20
v_perm_b32 v73, v36, v36, v21
v_perm_b32 v74, v36, v36, v22
v_perm_b32 v75, v36, v36, v23
s_nop 1
v_mfma_f32_16x16x32_bf16 v[80:83], v[72:75], v[188:191], v[80:83]
v_perm_b32 v76, v56, v56, v20
v_perm_b32 v77, v56, v56, v21
v_perm_b32 v78, v56, v56, v22
v_perm_b32 v79, v56, v56, v23
s_nop 1
v_mfma_f32_16x16x32_bf16 v[84:87], v[76:79], v[188:191], v[84:87]
v_perm_b32 v64, v37, v37, v16
v_perm_b32 v65, v37, v37, v17
v_perm_b32 v66, v37, v37, v18
v_perm_b32 v67, v37, v37, v19
s_nop 1
v_mfma_f32_16x16x32_bf16 v[80:83], v[64:67], v[192:195], v[80:83]
v_perm_b32 v68, v57, v57, v16
v_perm_b32 v69, v57, v57, v17
v_perm_b32 v70, v57, v57, v18
v_perm_b32 v71, v57, v57, v19
s_nop 1
v_mfma_f32_16x16x32_bf16 v[84:87], v[68:71], v[192:195], v[84:87]
v_perm_b32 v72, v37, v37, v20
v_perm_b32 v73, v37, v37, v21
v_perm_b32 v74, v37, v37, v22
v_perm_b32 v75, v37, v37, v23
s_nop 1
v_mfma_f32_16x16x32_bf16 v[80:83], v[72:75], v[196:199], v[80:83]
v_perm_b32 v76, v57, v57, v20
v_perm_b32 v77, v57, v57, v21
v_perm_b32 v78, v57, v57, v22
v_perm_b32 v79, v57, v57, v23
s_nop 1
v_mfma_f32_16x16x32_bf16 v[84:87], v[76:79], v[196:199], v[84:87]
v_perm_b32 v64, v38, v38, v16
v_perm_b32 v65, v38, v38, v17
v_perm_b32 v66, v38, v38, v18
v_perm_b32 v67, v38, v38, v19
s_nop 1
v_mfma_f32_16x16x32_bf16 v[80:83], v[64:67], v[200:203], v[80:83]
v_perm_b32 v68, v58, v58, v16
v_perm_b32 v69, v58, v58, v17
v_perm_b32 v70, v58, v58, v18
v_perm_b32 v71, v58, v58, v19
s_nop 1
v_mfma_f32_16x16x32_bf16 v[84:87], v[68:71], v[200:203], v[84:87]
v_perm_b32 v72, v38, v38, v20
v_perm_b32 v73, v38, v38, v21
v_perm_b32 v74, v38, v38, v22
v_perm_b32 v75, v38, v38, v23
s_nop 1
v_mfma_f32_16x16x32_bf16 v[80:83], v[72:75], v[204:207], v[80:83]
v_perm_b32 v76, v58, v58, v20
v_perm_b32 v77, v58, v58, v21
v_perm_b32 v78, v58, v58, v22
v_perm_b32 v79, v58, v58, v23
s_nop 1
v_mfma_f32_16x16x32_bf16 v[84:87], v[76:79], v[204:207], v[84:87]
v_perm_b32 v64, v39, v39, v16
v_perm_b32 v65, v39, v39, v17
v_perm_b32 v66, v39, v39, v18
v_perm_b32 v67, v39, v39, v19
s_nop 1
v_mfma_f32_16x16x32_bf16 v[80:83], v[64:67], v[208:211], v[80:83]
v_perm_b32 v68, v59, v59, v16
v_perm_b32 v69, v59, v59, v17
v_perm_b32 v70, v59, v59, v18
v_perm_b32 v71, v59, v59, v19
s_nop 1
v_mfma_f32_16x16x32_bf16 v[84:87], v[68:71], v[208:211], v[84:87]
v_perm_b32 v72, v39, v39, v20
v_perm_b32 v73, v39, v39, v21
v_perm_b32 v74, v39, v39, v22
v_perm_b32 v75, v39, v39, v23
s_nop 1
v_mfma_f32_16x16x32_bf16 v[80:83], v[72:75], v[212:215], v[80:83]
v_perm_b32 v76, v59, v59, v20
v_perm_b32 v77, v59, v59, v21
v_perm_b32 v78, v59, v59, v22
v_perm_b32 v79, v59, v59, v23
s_nop 1
v_mfma_f32_16x16x32_bf16 v[84:87], v[76:79], v[212:215], v[84:87]
s_nop 0
v_cvt_pk_bf16_f32 v244, v80, v81
v_cvt_pk_bf16_f32 v245, v82, v83
ds_write_b64 v5, v[244:245] offset:0
s_nop 3
v_cvt_pk_bf16_f32 v246, v84, v85
v_cvt_pk_bf16_f32 v247, v86, v87
ds_write_b64 v5, v[246:247] offset:2176
s_waitcnt lgkmcnt(0)
s_barrier
ds_read_b128 v[64:67], v7 offset:0
ds_read_b128 v[68:71], v7 offset:64
ds_read_b128 v[72:75], v7 offset:128
ds_read_b128 v[76:79], v7 offset:192
v_mul_u32_u24 v5, 36864, v9
v_lshl_add_u32 v5, v8, 4, v5
s_mul_i32 s6, s4, 1152
s_add_u32 s6, s6, 5242880
s_lshl_b32 s7, s3, 5
v_add_u32 v6, s7, v5
s_lshl_b32 s7, s3, 8
v_add_u32 v5, s7, v5
s_waitcnt lgkmcnt(0)
v_mfma_f32_16x16x32_bf16 v[24:27], v[64:67], a[96:99], 0
v_mfma_f32_16x16x32_bf16 v[24:27], v[68:71], a[100:103], v[24:27]
v_mfma_f32_16x16x32_bf16 v[24:27], v[72:75], a[104:107], v[24:27]
v_mfma_f32_16x16x32_bf16 v[24:27], v[76:79], a[108:111], v[24:27]
v_mfma_f32_16x16x32_bf16 v[28:31], v[64:67], a[112:115], 0
v_mfma_f32_16x16x32_bf16 v[28:31], v[68:71], a[116:119], v[28:31]
v_mfma_f32_16x16x32_bf16 v[28:31], v[72:75], a[120:123], v[28:31]
v_mfma_f32_16x16x32_bf16 v[28:31], v[76:79], a[124:127], v[28:31]
v_mfma_f32_16x16x32_bf16 v[32:35], v[64:67], a[128:131], 0
v_mfma_f32_16x16x32_bf16 v[32:35], v[68:71], a[132:135], v[32:35]
v_mfma_f32_16x16x32_bf16 v[32:35], v[72:75], a[136:139], v[32:35]
v_mfma_f32_16x16x32_bf16 v[32:35], v[76:79], a[140:143], v[32:35]
v_mfma_f32_16x16x32_bf16 v[36:39], v[64:67], a[144:147], 0
v_mfma_f32_16x16x32_bf16 v[36:39], v[68:71], a[148:151], v[36:39]
v_mfma_f32_16x16x32_bf16 v[36:39], v[72:75], a[152:155], v[36:39]
v_mfma_f32_16x16x32_bf16 v[36:39], v[76:79], a[156:159], v[36:39]
v_mfma_f32_16x16x32_bf16 v[40:43], v[64:67], a[160:163], 0
v_mfma_f32_16x16x32_bf16 v[40:43], v[68:71], a[164:167], v[40:43]
v_mfma_f32_16x16x32_bf16 v[40:43], v[72:75], a[168:171], v[40:43]
v_mfma_f32_16x16x32_bf16 v[40:43], v[76:79], a[172:175], v[40:43]
v_mfma_f32_16x16x32_bf16 v[44:47], v[64:67], a[176:179], 0
v_mfma_f32_16x16x32_bf16 v[44:47], v[68:71], a[180:183], v[44:47]
v_mfma_f32_16x16x32_bf16 v[44:47], v[72:75], a[184:187], v[44:47]
v_mfma_f32_16x16x32_bf16 v[44:47], v[76:79], a[188:191], v[44:47]
v_mfma_f32_16x16x32_bf16 v[48:51], v[64:67], a[192:195], 0
v_mfma_f32_16x16x32_bf16 v[48:51], v[68:71], a[196:199], v[48:51]
v_mfma_f32_16x16x32_bf16 v[48:51], v[72:75], a[200:203], v[48:51]
v_mfma_f32_16x16x32_bf16 v[48:51], v[76:79], a[204:207], v[48:51]
v_mfma_f32_16x16x32_bf16 v[52:55], v[64:67], a[208:211], 0
v_mfma_f32_16x16x32_bf16 v[52:55], v[68:71], a[212:215], v[52:55]
v_mfma_f32_16x16x32_bf16 v[52:55], v[72:75], a[216:219], v[52:55]
v_mfma_f32_16x16x32_bf16 v[52:55], v[76:79], a[220:223], v[52:55]
v_mfma_f32_16x16x32_bf16 v[56:59], v[64:67], a[224:227], 0
v_mfma_f32_16x16x32_bf16 v[56:59], v[68:71], a[228:231], v[56:59]
v_mfma_f32_16x16x32_bf16 v[56:59], v[72:75], a[232:235], v[56:59]
v_mfma_f32_16x16x32_bf16 v[56:59], v[76:79], a[236:239], v[56:59]
v_add_f32 v24, v24, v25
v_add_f32 v26, v26, v27
v_add_f32 v216, v24, v26
v_min_u32 v216, -2, v216
v_add_f32 v28, v28, v29
v_add_f32 v30, v30, v31
v_add_f32 v217, v28, v30
v_min_u32 v217, -2, v217
v_add_f32 v32, v32, v33
v_add_f32 v34, v34, v35
v_add_f32 v218, v32, v34
v_min_u32 v218, -2, v218
v_add_f32 v36, v36, v37
v_add_f32 v38, v38, v39
v_add_f32 v219, v36, v38
v_min_u32 v219, -2, v219
v_add_f32 v40, v40, v41
v_add_f32 v42, v42, v43
v_add_f32 v220, v40, v42
v_min_u32 v220, -2, v220
v_add_f32 v44, v44, v45
v_add_f32 v46, v46, v47
v_add_f32 v221, v44, v46
v_min_u32 v221, -2, v221
v_add_f32 v48, v48, v49
v_add_f32 v50, v50, v51
v_add_f32 v222, v48, v50
v_min_u32 v222, -2, v222
v_add_f32 v52, v52, v53
v_add_f32 v54, v54, v55
v_add_f32 v223, v52, v54
v_min_u32 v223, -2, v223
v_add_f32 v56, v56, v57
v_add_f32 v58, v58, v59
v_add_f32 v224, v56, v58
v_min_u32 v224, -2, v224
v_cvt_pk_bf16_f32 v216, v216, v217
v_min_u32 v216, -2, v216
v_cvt_pk_bf16_f32 v217, v218, v219
v_min_u32 v217, -2, v217
v_cvt_pk_bf16_f32 v218, v220, v221
v_min_u32 v218, -2, v218
v_cvt_pk_bf16_f32 v219, v222, v223
v_min_u32 v219, -2, v219
buffer_store_dwordx4 v[216:219], v5, s[64:67], s6 offen sc1
v_mov_b32_dpp v229, v224 row_shl:2 row_mask:0xf bank_mask:0xf
v_cvt_pk_bf16_f32 v228, v224, v229
v_min_u32 v228, -2, v228
s_nop 1
v_mov_b32_dpp v229, v228 row_shl:4 row_mask:0xf bank_mask:0xf
v_mov_b32_dpp v230, v228 row_shl:8 row_mask:0xf bank_mask:0xf
v_mov_b32_dpp v231, v228 row_shl:12 row_mask:0xf bank_mask:0xf
s_mov_b32 exec_lo, 0x00030003
s_mov_b32 exec_hi, 196611
buffer_store_dwordx4 v[228:231], v6, s[64:67], s6 offen offset:1024 sc1
s_mov_b64 exec, -1
s_nop 1
s_branch B_final
D_role:
s_lshr_b32 s10, s4, 3
s_lshr_b32 s80, s4, 0
s_and_b32 s11, s80, 7
v_xor_b32 v10, 32, v2
v_mov_b32 v76, -1
v_mov_b32 v77, -1
v_mov_b32 v78, -1
v_mov_b32 v79, -1
s_waitcnt lgkmcnt(0)
s_mov_b32 s64, s42
s_mov_b32 s65, s43
s_mov_b32 s66, 16777216
s_mov_b32 s67, 0x20000
s_lshl_b32 s6, s10, 22
s_add_u32 s52, s28, s6
s_addc_u32 s53, s29, 0
s_mov_b32 s54, 4194304
s_mov_b32 s55, 0x20000
s_cmp_eq_u32 s3, 3
s_cbranch_scc1 L_clr3_37
s_mul_i32 s6, s4, 9216
s_mul_i32 s7, s3, 4608
s_add_u32 s6, s6, s7
s_add_u32 s6, s6, 4194304
s_mul_i32 s7, s4, 4608
s_add_u32 s7, s7, 5242880
s_cmp_eq_u32 s3, 2
s_cselect_b32 s6, s7, s6
buffer_store_dwordx4 v[76:79], v2, s[64:67], s6 offen offset:0 sc1
buffer_store_dwordx4 v[76:79], v2, s[64:67], s6 offen offset:1024 sc1
buffer_store_dwordx4 v[76:79], v2, s[64:67], s6 offen offset:2048 sc1
buffer_store_dwordx4 v[76:79], v2, s[64:67], s6 offen offset:3072 sc1
s_add_u32 s6, s6, 4096
s_mov_b64 exec, 0xffffffff
buffer_store_dwordx4 v[76:79], v2, s[64:67], s6 offen offset:0 sc1
s_mov_b64 exec, -1
s_branch L_clrd_38
L_clr3_37:
s_mul_i32 s6, s4, 4096
s_add_u32 s6, s6, 0
buffer_store_dwordx4 v[76:79], v2, s[64:67], s6 offen offset:0 sc1
buffer_store_dwordx4 v[76:79], v2, s[64:67], s6 offen offset:1024 sc1
buffer_store_dwordx4 v[76:79], v2, s[64:67], s6 offen offset:2048 sc1
buffer_store_dwordx4 v[76:79], v2, s[64:67], s6 offen offset:3072 sc1
s_mov_b64 exec, 0xffff
s_mul_i32 s6, s4, 256
s_mul_i32 s7, s4, 256
s_add_u32 s7, s7, 327680
s_add_u32 s6, s6, 262144
v_lshrrev_b32 v6, 2, v1
v_mul_u32_u24 v6, 0, v6
v_add_u32 v6, v6, v2
buffer_store_dwordx4 v[76:79], v2, s[64:67], s6 offen sc1
buffer_store_dwordx4 v[76:79], v6, s[64:67], s7 offen sc1
s_mov_b64 exec, 3
s_mul_i32 s6, s4, 32
s_add_u32 s6, s6, 393216
s_lshr_b32 s7, s4, 2
s_mul_i32 s7, s7, 4224
s_add_u32 s6, s6, s7
v_mul_u32_u24 v5, 16, v1
buffer_store_dwordx4 v[76:79], v5, s[64:67], s6 offen sc1
s_mov_b64 exec, -1
L_clrd_38:
s_mov_b32 s68, s40
s_mov_b32 s69, s41
s_mov_b32 s70, 256
s_mov_b32 s71, 0x20000
s_mov_b32 s72, s38
s_mov_b32 s73, s39
s_mov_b32 s74, 9216
s_mov_b32 s75, 0x20000
s_mul_i32 s12, s3, 17408
s_lshl_b32 s13, s11, 2
s_add_u32 s13, s13, s3
s_lshl_b32 s13, s13, 12
s_add_u32 m0, s12, 0
s_add_u32 s6, s13, 0
buffer_load_dwordx4 v2, s[52:55], s6 offen nt lds
s_add_u32 m0, s12, 1088
s_add_u32 s6, s13, 1024
buffer_load_dwordx4 v2, s[52:55], s6 offen nt lds
s_add_u32 m0, s12, 2176
s_add_u32 s6, s13, 2048
buffer_load_dwordx4 v2, s[52:55], s6 offen nt lds
s_add_u32 m0, s12, 3264
s_add_u32 s6, s13, 3072
buffer_load_dwordx4 v2, s[52:55], s6 offen nt lds
s_add_u32 m0, s12, 4352
s_add_u32 s6, s13, 131072
buffer_load_dwordx4 v2, s[52:55], s6 offen nt lds
s_add_u32 m0, s12, 5440
s_add_u32 s6, s13, 132096
buffer_load_dwordx4 v2, s[52:55], s6 offen nt lds
s_add_u32 m0, s12, 6528
s_add_u32 s6, s13, 133120
buffer_load_dwordx4 v2, s[52:55], s6 offen nt lds
s_add_u32 m0, s12, 7616
s_add_u32 s6, s13, 134144
buffer_load_dwordx4 v2, s[52:55], s6 offen nt lds
s_waitcnt vmcnt(8)
s_barrier
s_cmp_lg_u32 s3, 0
s_cbranch_scc1 D_nosig
v_mov_b32 v7, 1
s_mov_b64 exec, 1
buffer_atomic_add v7, off, s[68:71], 0 offset:0
s_mov_b64 exec, -1
D_nosig:
s_add_u32 m0, s12, 8704
s_add_u32 s6, s13, 262144
s_waitcnt vmcnt(5)
buffer_load_dwordx4 v10, s[52:55], s6 offen nt lds
s_add_u32 m0, s12, 9792
s_add_u32 s6, s13, 263168
s_waitcnt vmcnt(5)
buffer_load_dwordx4 v10, s[52:55], s6 offen nt lds
s_add_u32 m0, s12, 10880
s_add_u32 s6, s13, 264192
s_waitcnt vmcnt(5)
buffer_load_dwordx4 v10, s[52:55], s6 offen nt lds
s_add_u32 m0, s12, 11968
s_add_u32 s6, s13, 265216
s_waitcnt vmcnt(5)
buffer_load_dwordx4 v10, s[52:55], s6 offen nt lds
s_add_u32 m0, s12, 13056
s_add_u32 s6, s13, 393216
s_waitcnt vmcnt(5)
buffer_load_dwordx4 v10, s[52:55], s6 offen nt lds
s_add_u32 m0, s12, 14144
s_add_u32 s6, s13, 394240
s_waitcnt vmcnt(5)
buffer_load_dwordx4 v10, s[52:55], s6 offen nt lds
s_add_u32 m0, s12, 15232
s_add_u32 s6, s13, 395264
s_waitcnt vmcnt(5)
buffer_load_dwordx4 v10, s[52:55], s6 offen nt lds
s_add_u32 m0, s12, 16320
s_add_u32 s6, s13, 396288
s_waitcnt vmcnt(5)
buffer_load_dwordx4 v10, s[52:55], s6 offen nt lds
s_add_u32 m0, s12, 69632
s_add_u32 s6, s13, 524288
s_waitcnt vmcnt(5)
buffer_load_dwordx4 v2, s[52:55], s6 offen nt lds
s_add_u32 m0, s12, 70720
s_add_u32 s6, s13, 525312
s_waitcnt vmcnt(5)
buffer_load_dwordx4 v2, s[52:55], s6 offen nt lds
s_add_u32 m0, s12, 71808
s_add_u32 s6, s13, 526336
s_waitcnt vmcnt(5)
buffer_load_dwordx4 v2, s[52:55], s6 offen nt lds
s_add_u32 m0, s12, 72896
s_add_u32 s6, s13, 527360
s_waitcnt vmcnt(5)
buffer_load_dwordx4 v2, s[52:55], s6 offen nt lds
s_add_u32 m0, s12, 73984
s_add_u32 s6, s13, 655360
s_waitcnt vmcnt(5)
buffer_load_dwordx4 v2, s[52:55], s6 offen nt lds
s_add_u32 m0, s12, 75072
s_add_u32 s6, s13, 656384
s_waitcnt vmcnt(5)
buffer_load_dwordx4 v2, s[52:55], s6 offen nt lds
s_add_u32 m0, s12, 76160
s_add_u32 s6, s13, 657408
s_waitcnt vmcnt(5)
buffer_load_dwordx4 v2, s[52:55], s6 offen nt lds
s_add_u32 m0, s12, 77248
s_add_u32 s6, s13, 658432
s_waitcnt vmcnt(5)
buffer_load_dwordx4 v2, s[52:55], s6 offen nt lds
s_add_u32 m0, s12, 78336
s_add_u32 s6, s13, 786432
s_waitcnt vmcnt(5)
buffer_load_dwordx4 v10, s[52:55], s6 offen nt lds
s_add_u32 m0, s12, 79424
s_add_u32 s6, s13, 787456
s_waitcnt vmcnt(5)
buffer_load_dwordx4 v10, s[52:55], s6 offen nt lds
s_add_u32 m0, s12, 80512
s_add_u32 s6, s13, 788480
s_waitcnt vmcnt(5)
buffer_load_dwordx4 v10, s[52:55], s6 offen nt lds
s_add_u32 m0, s12, 81600
s_add_u32 s6, s13, 789504
s_waitcnt vmcnt(5)
buffer_load_dwordx4 v10, s[52:55], s6 offen nt lds
s_add_u32 m0, s12, 82688
s_add_u32 s6, s13, 917504
s_waitcnt vmcnt(5)
buffer_load_dwordx4 v10, s[52:55], s6 offen nt lds
s_add_u32 m0, s12, 83776
s_add_u32 s6, s13, 918528
s_waitcnt vmcnt(5)
buffer_load_dwordx4 v10, s[52:55], s6 offen nt lds
s_add_u32 m0, s12, 84864
s_add_u32 s6, s13, 919552
s_waitcnt vmcnt(5)
buffer_load_dwordx4 v10, s[52:55], s6 offen nt lds
s_add_u32 m0, s12, 85952
s_add_u32 s6, s13, 920576
s_waitcnt vmcnt(5)
buffer_load_dwordx4 v10, s[52:55], s6 offen nt lds
s_add_u32 s6, s13, 1048576
s_waitcnt vmcnt(5)
buffer_load_dwordx4 a[128:131], v2, s[52:55], s6 offen nt
s_add_u32 s6, s13, 1049600
s_waitcnt vmcnt(5)
buffer_load_dwordx4 a[132:135], v2, s[52:55], s6 offen nt
s_add_u32 s6, s13, 1050624
s_waitcnt vmcnt(5)
buffer_load_dwordx4 a[136:139], v2, s[52:55], s6 offen nt
s_add_u32 s6, s13, 1051648
s_waitcnt vmcnt(5)
buffer_load_dwordx4 a[140:143], v2, s[52:55], s6 offen nt
s_add_u32 s6, s13, 1179648
s_waitcnt vmcnt(5)
buffer_load_dwordx4 a[144:147], v2, s[52:55], s6 offen nt
s_add_u32 s6, s13, 1180672
s_waitcnt vmcnt(5)
buffer_load_dwordx4 a[148:151], v2, s[52:55], s6 offen nt
s_add_u32 s6, s13, 1181696
s_waitcnt vmcnt(5)
buffer_load_dwordx4 a[152:155], v2, s[52:55], s6 offen nt
s_add_u32 s6, s13, 1182720
s_waitcnt vmcnt(5)
buffer_load_dwordx4 a[156:159], v2, s[52:55], s6 offen nt
s_add_u32 s6, s13, 1310720
s_waitcnt vmcnt(5)
buffer_load_dwordx4 a[160:163], v10, s[52:55], s6 offen nt
s_add_u32 s6, s13, 1311744
s_waitcnt vmcnt(5)
buffer_load_dwordx4 a[164:167], v10, s[52:55], s6 offen nt
s_add_u32 s6, s13, 1312768
s_waitcnt vmcnt(5)
buffer_load_dwordx4 a[168:171], v10, s[52:55], s6 offen nt
s_add_u32 s6, s13, 1313792
s_waitcnt vmcnt(5)
buffer_load_dwordx4 a[172:175], v10, s[52:55], s6 offen nt
s_add_u32 s6, s13, 1441792
s_waitcnt vmcnt(5)
buffer_load_dwordx4 a[176:179], v10, s[52:55], s6 offen nt
s_add_u32 s6, s13, 1442816
s_waitcnt vmcnt(5)
buffer_load_dwordx4 a[180:183], v10, s[52:55], s6 offen nt
s_add_u32 s6, s13, 1443840
s_waitcnt vmcnt(5)
buffer_load_dwordx4 a[184:187], v10, s[52:55], s6 offen nt
s_add_u32 s6, s13, 1444864
s_waitcnt vmcnt(5)
buffer_load_dwordx4 a[188:191], v10, s[52:55], s6 offen nt
s_add_u32 s6, s13, 1572864
s_waitcnt vmcnt(5)
buffer_load_dwordx4 a[192:195], v2, s[52:55], s6 offen nt
s_add_u32 s6, s13, 1573888
s_waitcnt vmcnt(5)
buffer_load_dwordx4 a[196:199], v2, s[52:55], s6 offen nt
s_add_u32 s6, s13, 1574912
s_waitcnt vmcnt(5)
buffer_load_dwordx4 a[200:203], v2, s[52:55], s6 offen nt
s_add_u32 s6, s13, 1575936
s_waitcnt vmcnt(5)
buffer_load_dwordx4 a[204:207], v2, s[52:55], s6 offen nt
s_add_u32 s6, s13, 1703936
s_waitcnt vmcnt(5)
buffer_load_dwordx4 a[208:211], v2, s[52:55], s6 offen nt
s_add_u32 s6, s13, 1704960
s_waitcnt vmcnt(5)
buffer_load_dwordx4 a[212:215], v2, s[52:55], s6 offen nt
s_add_u32 s6, s13, 1705984
s_waitcnt vmcnt(5)
buffer_load_dwordx4 a[216:219], v2, s[52:55], s6 offen nt
s_add_u32 s6, s13, 1707008
s_waitcnt vmcnt(5)
buffer_load_dwordx4 a[220:223], v2, s[52:55], s6 offen nt
s_add_u32 s6, s13, 1835008
s_waitcnt vmcnt(5)
buffer_load_dwordx4 a[224:227], v10, s[52:55], s6 offen nt
s_add_u32 s6, s13, 1836032
s_waitcnt vmcnt(5)
buffer_load_dwordx4 a[228:231], v10, s[52:55], s6 offen nt
s_add_u32 s6, s13, 1837056
s_waitcnt vmcnt(5)
buffer_load_dwordx4 a[232:235], v10, s[52:55], s6 offen nt
s_add_u32 s6, s13, 1838080
s_waitcnt vmcnt(5)
buffer_load_dwordx4 a[236:239], v10, s[52:55], s6 offen nt
s_add_u32 s6, s13, 1966080
s_waitcnt vmcnt(5)
buffer_load_dwordx4 a[240:243], v10, s[52:55], s6 offen nt
s_add_u32 s6, s13, 1967104
s_waitcnt vmcnt(5)
buffer_load_dwordx4 a[244:247], v10, s[52:55], s6 offen nt
s_add_u32 s6, s13, 1968128
s_waitcnt vmcnt(5)
buffer_load_dwordx4 a[248:251], v10, s[52:55], s6 offen nt
s_add_u32 s6, s13, 1969152
s_waitcnt vmcnt(5)
buffer_load_dwordx4 a[252:255], v10, s[52:55], s6 offen nt
buffer_load_dword v11, off, s[68:71], 0 offset:0 sc1
s_lshl_b32 s14, s10, 3
s_add_u32 s14, s14, s3
s_mul_i32 s14, s14, 4096
s_add_u32 s14, s14, 0
s_add_u32 s15, s14, 16384
s_lshl_b32 s6, s3, 4
v_add_u32 v5, s6, v8
v_mul_u32_u24 v5, 1088, v5
v_lshrrev_b32 v6, 3, v8
v_lshlrev_b32 v6, 1, v6
v_xor_b32 v6, v6, v9
v_lshl_add_u32 v194, v6, 4, v5
v_add_u32 v195, 69632, v194
v_lshrrev_b32 v5, 5, v1
v_lshlrev_b32 v5, 3, v5
v_bfe_u32 v6, v1, 2, 2
v_add_u32 v5, v5, v6
v_mul_u32_u24 v5, 1088, v5
v_lshrrev_b32 v6, 1, v9
v_xor_b32 v6, v6, v9
v_and_b32 v6, 1, v6
v_lshl_add_u32 v5, v6, 5, v5
v_and_b32 v6, 3, v1
v_lshl_add_u32 v5, v6, 3, v5
s_lshl_b32 s6, s3, 8
v_add_u32 v196, s6, v5
v_add_u32 v197, 69632, v196
v_lshlrev_b32 v199, 4, v8
v_add_u32 v199, 160256, v199
s_lshl_b32 s6, s3, 2
v_add_u32 v198, s6, v199
v_and_b32 v5, 31, v1
v_lshlrev_b32 v200, 4, v5
v_add_u32 v200, 160256, v200
v_lshlrev_b32 v202, 5, v5
v_lshrrev_b32 v6, 5, v1
v_lshl_add_u32 v202, v6, 4, v202
v_add_u32 v202, 156160, v202
v_lshlrev_b32 v201, 5, v8
v_lshl_add_u32 v201, v9, 3, v201
s_lshl_b32 s6, s3, 10
s_add_u32 s6, s6, 156160
v_add_u32 v201, s6, v201
v_mul_u32_u24 v203, 1056, v8
v_lshl_add_u32 v203, v9, 4, v203
v_add_u32 v203, 139264, v203
s_mul_i32 s6, s3, 4224
s_add_u32 s6, s6, 139264
v_add_u32 v204, s6, v2
v_add_u32 v206, s12, v2
v_add_u32 v207, 69632, v206
v_mov_b32 v185, 0x3e0293ee
v_mov_b32 v176, 0xff800000
v_mov_b32 v177, 0xff800000
v_mov_b32 v178, 0xff800000
v_mov_b32 v180, 0
v_mov_b32 v181, 0
s_waitcnt vmcnt(0)
s_mov_b32 s7, 400000
L_ens_39:
v_readfirstlane_b32 s6, v11
s_cmp_ge_u32 s6, 32
s_cbranch_scc1 L_ensd_40
s_sleep 16
buffer_load_dword v11, off, s[68:71], 0 offset:0 sc1
s_waitcnt vmcnt(0)
s_sub_u32 s7, s7, 1
s_cmp_lg_u32 s7, 0
s_cbranch_scc1 L_ens_39
L_ensd_40:
s_mov_b32 s7, 400000
v_and_b32 v5, 3, v1
v_bfe_u32 v6, v1, 2, 1
v_mul_u32_u24 v6, 16384, v6
v_lshl_add_u32 v5, v5, 10, v6
Q_slow:
buffer_load_dword v192, v5, s[64:67], s14 offen offset:768 sc1
s_waitcnt vmcnt(0)
v_cmp_eq_u32 vcc, -1, v192
s_cbranch_vccz Q_chk
s_sleep 8
s_sub_u32 s7, s7, 1
s_cmp_lg_u32 s7, 1
s_cbranch_scc1 Q_slow
Q_chk:
buffer_load_dwordx4 v[84:87], v2, s[64:67], s14 offen offset:0 sc1
buffer_load_dwordx4 v[88:91], v2, s[64:67], s14 offen offset:1024 sc1
buffer_load_dwordx4 v[92:95], v2, s[64:67], s14 offen offset:2048 sc1
buffer_load_dwordx4 v[96:99], v2, s[64:67], s14 offen offset:3072 sc1
buffer_load_dwordx4 v[100:103], v2, s[64:67], s15 offen offset:0 sc1
buffer_load_dwordx4 v[104:107], v2, s[64:67], s15 offen offset:1024 sc1
buffer_load_dwordx4 v[108:111], v2, s[64:67], s15 offen offset:2048 sc1
buffer_load_dwordx4 v[112:115], v2, s[64:67], s15 offen offset:3072 sc1
s_waitcnt vmcnt(0)
v_max3_u32 v192, v84, v85, v86
v_max3_u32 v192, v192, v87, v88
v_max3_u32 v192, v192, v89, v90
v_max3_u32 v192, v192, v91, v92
v_max3_u32 v192, v192, v93, v94
v_max3_u32 v192, v192, v95, v96
v_max3_u32 v192, v192, v97, v98
v_max3_u32 v192, v192, v99, v100
v_max3_u32 v192, v192, v101, v102
v_max3_u32 v192, v192, v103, v104
v_max3_u32 v192, v192, v105, v106
v_max3_u32 v192, v192, v107, v108
v_max3_u32 v192, v192, v109, v110
v_max3_u32 v192, v192, v111, v112
v_max3_u32 v192, v192, v113, v114
v_max_u32 v192, v192, v115
v_cmp_eq_u32 vcc, -1, v192
s_cbranch_vccz Q_ok
s_sleep 16
s_sub_u32 s7, s7, 1
s_cmp_lg_u32 s7, 0
s_cbranch_scc1 Q_chk
Q_ok:
ds_write_b128 v204, v[84:87] offset:0
ds_write_b128 v204, v[88:91] offset:1056
ds_write_b128 v204, v[92:95] offset:2112
ds_write_b128 v204, v[96:99] offset:3168
s_waitcnt lgkmcnt(0)
s_barrier
ds_read_b128 a[0:3], v203 offset:0
ds_read_b128 a[4:7], v203 offset:64
ds_read_b128 a[8:11], v203 offset:128
ds_read_b128 a[12:15], v203 offset:192
ds_read_b128 a[16:19], v203 offset:256
ds_read_b128 a[20:23], v203 offset:320
ds_read_b128 a[24:27], v203 offset:384
ds_read_b128 a[28:31], v203 offset:448
ds_read_b128 a[32:35], v203 offset:512
ds_read_b128 a[36:39], v203 offset:576
ds_read_b128 a[40:43], v203 offset:640
ds_read_b128 a[44:47], v203 offset:704
ds_read_b128 a[48:51], v203 offset:768
ds_read_b128 a[52:55], v203 offset:832
ds_read_b128 a[56:59], v203 offset:896
ds_read_b128 a[60:63], v203 offset:960
s_waitcnt lgkmcnt(0)
s_barrier
ds_write_b128 v204, v[100:103] offset:0
ds_write_b128 v204, v[104:107] offset:1056
ds_write_b128 v204, v[108:111] offset:2112
ds_write_b128 v204, v[112:115] offset:3168
s_waitcnt lgkmcnt(0)
s_barrier
ds_read_b128 a[64:67], v203 offset:0
ds_read_b128 a[68:71], v203 offset:64
ds_read_b128 a[72:75], v203 offset:128
ds_read_b128 a[76:79], v203 offset:192
ds_read_b128 a[80:83], v203 offset:256
ds_read_b128 a[84:87], v203 offset:320
ds_read_b128 a[88:91], v203 offset:384
ds_read_b128 a[92:95], v203 offset:448
ds_read_b128 a[96:99], v203 offset:512
ds_read_b128 a[100:103], v203 offset:576
ds_read_b128 a[104:107], v203 offset:640
ds_read_b128 a[108:111], v203 offset:704
ds_read_b128 a[112:115], v203 offset:768
ds_read_b128 a[116:119], v203 offset:832
ds_read_b128 a[120:123], v203 offset:896
ds_read_b128 a[124:127], v203 offset:960
s_waitcnt lgkmcnt(0)
s_mov_b32 s81, 4
ds_read_b128 v[84:87], v194 offset:0
ds_read_b128 v[88:91], v194 offset:64
ds_read_b128 v[92:95], v194 offset:128
ds_read_b128 v[96:99], v194 offset:192
ds_read_b128 v[100:103], v194 offset:256
ds_read_b128 v[104:107], v194 offset:320
ds_read_b128 v[108:111], v194 offset:384
ds_read_b128 v[112:115], v194 offset:448
ds_read_b128 v[116:119], v194 offset:512
ds_read_b128 v[120:123], v194 offset:576
ds_read_b128 v[124:127], v194 offset:640
ds_read_b128 v[128:131], v194 offset:704
ds_read_b128 v[132:135], v194 offset:768
ds_read_b128 v[136:139], v194 offset:832
ds_read_b128 v[140:143], v194 offset:896
ds_read_b128 v[144:147], v194 offset:960
s_waitcnt lgkmcnt(15)
v_mfma_f32_16x16x32_bf16 v[76:79], v[84:87], a[0:3], 0
v_mfma_f32_16x16x32_bf16 v[80:83], v[84:87], a[64:67], 0
s_waitcnt lgkmcnt(14)
v_mfma_f32_16x16x32_bf16 v[76:79], v[88:91], a[4:7], v[76:79]
v_mfma_f32_16x16x32_bf16 v[80:83], v[88:91], a[68:71], v[80:83]
s_waitcnt lgkmcnt(13)
v_mfma_f32_16x16x32_bf16 v[76:79], v[92:95], a[8:11], v[76:79]
v_mfma_f32_16x16x32_bf16 v[80:83], v[92:95], a[72:75], v[80:83]
s_waitcnt lgkmcnt(12)
v_mfma_f32_16x16x32_bf16 v[76:79], v[96:99], a[12:15], v[76:79]
v_mfma_f32_16x16x32_bf16 v[80:83], v[96:99], a[76:79], v[80:83]
s_waitcnt lgkmcnt(11)
v_mfma_f32_16x16x32_bf16 v[76:79], v[100:103], a[16:19], v[76:79]
v_mfma_f32_16x16x32_bf16 v[80:83], v[100:103], a[80:83], v[80:83]
s_waitcnt lgkmcnt(10)
v_mfma_f32_16x16x32_bf16 v[76:79], v[104:107], a[20:23], v[76:79]
v_mfma_f32_16x16x32_bf16 v[80:83], v[104:107], a[84:87], v[80:83]
s_waitcnt lgkmcnt(9)
v_mfma_f32_16x16x32_bf16 v[76:79], v[108:111], a[24:27], v[76:79]
v_mfma_f32_16x16x32_bf16 v[80:83], v[108:111], a[88:91], v[80:83]
s_waitcnt lgkmcnt(8)
v_mfma_f32_16x16x32_bf16 v[76:79], v[112:115], a[28:31], v[76:79]
v_mfma_f32_16x16x32_bf16 v[80:83], v[112:115], a[92:95], v[80:83]
s_waitcnt lgkmcnt(7)
v_mfma_f32_16x16x32_bf16 v[76:79], v[116:119], a[32:35], v[76:79]
v_mfma_f32_16x16x32_bf16 v[80:83], v[116:119], a[96:99], v[80:83]
s_waitcnt lgkmcnt(6)
v_mfma_f32_16x16x32_bf16 v[76:79], v[120:123], a[36:39], v[76:79]
v_mfma_f32_16x16x32_bf16 v[80:83], v[120:123], a[100:103], v[80:83]
s_waitcnt lgkmcnt(5)
v_mfma_f32_16x16x32_bf16 v[76:79], v[124:127], a[40:43], v[76:79]
v_mfma_f32_16x16x32_bf16 v[80:83], v[124:127], a[104:107], v[80:83]
s_waitcnt lgkmcnt(4)
v_mfma_f32_16x16x32_bf16 v[76:79], v[128:131], a[44:47], v[76:79]
v_mfma_f32_16x16x32_bf16 v[80:83], v[128:131], a[108:111], v[80:83]
s_waitcnt lgkmcnt(3)
v_mfma_f32_16x16x32_bf16 v[76:79], v[132:135], a[48:51], v[76:79]
v_mfma_f32_16x16x32_bf16 v[80:83], v[132:135], a[112:115], v[80:83]
s_waitcnt lgkmcnt(2)
v_mfma_f32_16x16x32_bf16 v[76:79], v[136:139], a[52:55], v[76:79]
v_mfma_f32_16x16x32_bf16 v[80:83], v[136:139], a[116:119], v[80:83]
s_waitcnt lgkmcnt(1)
v_mfma_f32_16x16x32_bf16 v[76:79], v[140:143], a[56:59], v[76:79]
v_mfma_f32_16x16x32_bf16 v[80:83], v[140:143], a[120:123], v[80:83]
s_waitcnt lgkmcnt(0)
v_mfma_f32_16x16x32_bf16 v[76:79], v[144:147], a[60:63], v[76:79]
v_mfma_f32_16x16x32_bf16 v[80:83], v[144:147], a[124:127], v[80:83]
s_nop 6
v_max_f32 v190, v76, v77
v_max3_f32 v190, v190, v78, v79
v_mov_b32 v192, v190
s_nop 1
v_permlane16_swap_b32 v190, v192
v_max_f32 v190, v190, v192
v_mov_b32 v192, v190
s_nop 1
v_permlane32_swap_b32 v190, v192
v_max_f32 v190, v190, v192
ds_write_b32 v198, v190 offset:0
v_max_f32 v191, v80, v81
v_max3_f32 v191, v191, v82, v83
v_mov_b32 v192, v191
s_nop 1
v_permlane16_swap_b32 v191, v192
v_max_f32 v191, v191, v192
v_mov_b32 v192, v191
s_nop 1
v_permlane32_swap_b32 v191, v192
v_max_f32 v191, v191, v192
ds_write_b32 v198, v191 offset:256
s_waitcnt lgkmcnt(0)
s_barrier
ds_read_b128 v[164:167], v199
ds_read_b128 v[168:171], v199 offset:256
ds_read_b128 v[172:175], v200
s_waitcnt lgkmcnt(0)
v_max_f32 v164, v164, v165
v_max3_f32 v164, v164, v166, v167
v_mul_f32 v164, v164, v185
v_max_f32 v164, v164, v176
v_sub_f32 v182, v176, v164
v_exp_f32 v182, v182
v_mov_b32 v176, v164
v_max_f32 v168, v168, v169
v_max3_f32 v168, v168, v170, v171
v_mul_f32 v168, v168, v185
v_max_f32 v168, v168, v177
v_sub_f32 v183, v177, v168
v_exp_f32 v183, v183
v_mov_b32 v177, v168
v_max_f32 v172, v172, v173
v_max3_f32 v172, v172, v174, v175
v_mul_f32 v172, v172, v185
v_max_f32 v172, v172, v178
v_sub_f32 v184, v178, v172
v_exp_f32 v184, v184
v_mov_b32 v178, v172
v_fma_f32 v76, v76, v185, -v176
v_fma_f32 v77, v77, v185, -v176
v_fma_f32 v78, v78, v185, -v176
v_fma_f32 v79, v79, v185, -v176
v_exp_f32 v76, v76
v_exp_f32 v77, v77
v_exp_f32 v78, v78
v_exp_f32 v79, v79
v_mul_f32 v180, v180, v182
v_cvt_pk_bf16_f32 v186, v76, v77
v_cvt_pk_bf16_f32 v187, v78, v79
ds_write_b64 v201, v[186:187] offset:0
v_add_f32 v180, v180, v76
v_add_f32 v180, v180, v77
v_add_f32 v180, v180, v78
v_add_f32 v180, v180, v79
v_fma_f32 v80, v80, v185, -v177
v_fma_f32 v81, v81, v185, -v177
v_fma_f32 v82, v82, v185, -v177
v_fma_f32 v83, v83, v185, -v177
v_exp_f32 v80, v80
v_exp_f32 v81, v81
v_exp_f32 v82, v82
v_exp_f32 v83, v83
v_mul_f32 v181, v181, v183
v_cvt_pk_bf16_f32 v188, v80, v81
v_cvt_pk_bf16_f32 v189, v82, v83
ds_write_b64 v201, v[188:189] offset:512
v_add_f32 v181, v181, v80
v_add_f32 v181, v181, v81
v_add_f32 v181, v181, v82
v_add_f32 v181, v181, v83
s_waitcnt lgkmcnt(0)
s_barrier
ds_read_b128 v[148:151], v202 offset:0
ds_read_b128 v[152:155], v202 offset:1024
ds_read_b128 v[156:159], v202 offset:2048
ds_read_b128 v[160:163], v202 offset:3072
ds_read_b64_tr_b16 v[84:85], v196 offset:0
ds_read_b64_tr_b16 v[86:87], v196 offset:4352
ds_read_b64_tr_b16 v[88:89], v196 offset:64
ds_read_b64_tr_b16 v[90:91], v196 offset:4416
ds_read_b64_tr_b16 v[92:93], v196 offset:128
ds_read_b64_tr_b16 v[94:95], v196 offset:4480
ds_read_b64_tr_b16 v[96:97], v196 offset:192
ds_read_b64_tr_b16 v[98:99], v196 offset:4544
ds_read_b64_tr_b16 v[100:101], v196 offset:17408
ds_read_b64_tr_b16 v[102:103], v196 offset:21760
ds_read_b64_tr_b16 v[104:105], v196 offset:17472
ds_read_b64_tr_b16 v[106:107], v196 offset:21824
ds_read_b64_tr_b16 v[108:109], v196 offset:17536
ds_read_b64_tr_b16 v[110:111], v196 offset:21888
ds_read_b64_tr_b16 v[112:113], v196 offset:17600
ds_read_b64_tr_b16 v[114:115], v196 offset:21952
ds_read_b64_tr_b16 v[116:117], v196 offset:34816
ds_read_b64_tr_b16 v[118:119], v196 offset:39168
ds_read_b64_tr_b16 v[120:121], v196 offset:34880
ds_read_b64_tr_b16 v[122:123], v196 offset:39232
ds_read_b64_tr_b16 v[124:125], v196 offset:34944
ds_read_b64_tr_b16 v[126:127], v196 offset:39296
ds_read_b64_tr_b16 v[128:129], v196 offset:35008
ds_read_b64_tr_b16 v[130:131], v196 offset:39360
ds_read_b64_tr_b16 v[132:133], v196 offset:52224
ds_read_b64_tr_b16 v[134:135], v196 offset:56576
ds_read_b64_tr_b16 v[136:137], v196 offset:52288
ds_read_b64_tr_b16 v[138:139], v196 offset:56640
ds_read_b64_tr_b16 v[140:141], v196 offset:52352
ds_read_b64_tr_b16 v[142:143], v196 offset:56704
ds_read_b64_tr_b16 v[144:145], v196 offset:52416
ds_read_b64_tr_b16 v[146:147], v196 offset:56768
s_waitcnt lgkmcnt(15)
v_mfma_f32_32x32x16_bf16 v[12:27], v[84:87], v[148:151], 0
v_mfma_f32_32x32x16_bf16 v[28:43], v[88:91], v[148:151], 0
v_mfma_f32_32x32x16_bf16 v[44:59], v[92:95], v[148:151], 0
v_mfma_f32_32x32x16_bf16 v[60:75], v[96:99], v[148:151], 0
s_waitcnt lgkmcnt(15)
v_mfma_f32_32x32x16_bf16 v[12:27], v[100:103], v[152:155], v[12:27]
v_mfma_f32_32x32x16_bf16 v[28:43], v[104:107], v[152:155], v[28:43]
v_mfma_f32_32x32x16_bf16 v[44:59], v[108:111], v[152:155], v[44:59]
v_mfma_f32_32x32x16_bf16 v[60:75], v[112:115], v[152:155], v[60:75]
s_waitcnt lgkmcnt(8)
v_mfma_f32_32x32x16_bf16 v[12:27], v[116:119], v[156:159], v[12:27]
v_mfma_f32_32x32x16_bf16 v[28:43], v[120:123], v[156:159], v[28:43]
v_mfma_f32_32x32x16_bf16 v[44:59], v[124:127], v[156:159], v[44:59]
v_mfma_f32_32x32x16_bf16 v[60:75], v[128:131], v[156:159], v[60:75]
s_waitcnt lgkmcnt(0)
v_mfma_f32_32x32x16_bf16 v[12:27], v[132:135], v[160:163], v[12:27]
v_mfma_f32_32x32x16_bf16 v[28:43], v[136:139], v[160:163], v[28:43]
v_mfma_f32_32x32x16_bf16 v[44:59], v[140:143], v[160:163], v[44:59]
v_mfma_f32_32x32x16_bf16 v[60:75], v[144:147], v[160:163], v[60:75]
ds_read_b128 v[84:87], v195 offset:0
ds_read_b128 v[88:91], v195 offset:64
ds_read_b128 v[92:95], v195 offset:128
ds_read_b128 v[96:99], v195 offset:192
ds_read_b128 v[100:103], v195 offset:256
ds_read_b128 v[104:107], v195 offset:320
ds_read_b128 v[108:111], v195 offset:384
ds_read_b128 v[112:115], v195 offset:448
ds_read_b128 v[116:119], v195 offset:512
ds_read_b128 v[120:123], v195 offset:576
ds_read_b128 v[124:127], v195 offset:640
ds_read_b128 v[128:131], v195 offset:704
ds_read_b128 v[132:135], v195 offset:768
ds_read_b128 v[136:139], v195 offset:832
ds_read_b128 v[140:143], v195 offset:896
ds_read_b128 v[144:147], v195 offset:960
s_waitcnt lgkmcnt(15)
v_mfma_f32_16x16x32_bf16 v[76:79], v[84:87], a[0:3], 0
v_mfma_f32_16x16x32_bf16 v[80:83], v[84:87], a[64:67], 0
s_waitcnt lgkmcnt(14)
v_mfma_f32_16x16x32_bf16 v[76:79], v[88:91], a[4:7], v[76:79]
v_mfma_f32_16x16x32_bf16 v[80:83], v[88:91], a[68:71], v[80:83]
s_waitcnt lgkmcnt(13)
v_mfma_f32_16x16x32_bf16 v[76:79], v[92:95], a[8:11], v[76:79]
v_mfma_f32_16x16x32_bf16 v[80:83], v[92:95], a[72:75], v[80:83]
s_waitcnt lgkmcnt(12)
v_mfma_f32_16x16x32_bf16 v[76:79], v[96:99], a[12:15], v[76:79]
v_mfma_f32_16x16x32_bf16 v[80:83], v[96:99], a[76:79], v[80:83]
s_waitcnt lgkmcnt(11)
v_mfma_f32_16x16x32_bf16 v[76:79], v[100:103], a[16:19], v[76:79]
v_mfma_f32_16x16x32_bf16 v[80:83], v[100:103], a[80:83], v[80:83]
s_waitcnt lgkmcnt(10)
v_mfma_f32_16x16x32_bf16 v[76:79], v[104:107], a[20:23], v[76:79]
v_mfma_f32_16x16x32_bf16 v[80:83], v[104:107], a[84:87], v[80:83]
s_waitcnt lgkmcnt(9)
v_mfma_f32_16x16x32_bf16 v[76:79], v[108:111], a[24:27], v[76:79]
v_mfma_f32_16x16x32_bf16 v[80:83], v[108:111], a[88:91], v[80:83]
s_waitcnt lgkmcnt(8)
v_mfma_f32_16x16x32_bf16 v[76:79], v[112:115], a[28:31], v[76:79]
v_mfma_f32_16x16x32_bf16 v[80:83], v[112:115], a[92:95], v[80:83]
s_waitcnt lgkmcnt(7)
v_mfma_f32_16x16x32_bf16 v[76:79], v[116:119], a[32:35], v[76:79]
v_mfma_f32_16x16x32_bf16 v[80:83], v[116:119], a[96:99], v[80:83]
s_waitcnt lgkmcnt(6)
v_mfma_f32_16x16x32_bf16 v[76:79], v[120:123], a[36:39], v[76:79]
v_mfma_f32_16x16x32_bf16 v[80:83], v[120:123], a[100:103], v[80:83]
s_waitcnt lgkmcnt(5)
v_mfma_f32_16x16x32_bf16 v[76:79], v[124:127], a[40:43], v[76:79]
v_mfma_f32_16x16x32_bf16 v[80:83], v[124:127], a[104:107], v[80:83]
s_waitcnt lgkmcnt(4)
v_mfma_f32_16x16x32_bf16 v[76:79], v[128:131], a[44:47], v[76:79]
v_mfma_f32_16x16x32_bf16 v[80:83], v[128:131], a[108:111], v[80:83]
s_waitcnt lgkmcnt(3)
v_mfma_f32_16x16x32_bf16 v[76:79], v[132:135], a[48:51], v[76:79]
v_mfma_f32_16x16x32_bf16 v[80:83], v[132:135], a[112:115], v[80:83]
s_waitcnt lgkmcnt(2)
v_mfma_f32_16x16x32_bf16 v[76:79], v[136:139], a[52:55], v[76:79]
v_mfma_f32_16x16x32_bf16 v[80:83], v[136:139], a[116:119], v[80:83]
s_waitcnt lgkmcnt(1)
v_mfma_f32_16x16x32_bf16 v[76:79], v[140:143], a[56:59], v[76:79]
v_mfma_f32_16x16x32_bf16 v[80:83], v[140:143], a[120:123], v[80:83]
s_waitcnt lgkmcnt(0)
v_mfma_f32_16x16x32_bf16 v[76:79], v[144:147], a[60:63], v[76:79]
v_mfma_f32_16x16x32_bf16 v[80:83], v[144:147], a[124:127], v[80:83]
s_nop 6
v_max_f32 v190, v76, v77
v_max3_f32 v190, v190, v78, v79
v_mov_b32 v192, v190
s_nop 1
v_permlane16_swap_b32 v190, v192
v_max_f32 v190, v190, v192
v_mov_b32 v192, v190
s_nop 1
v_permlane32_swap_b32 v190, v192
v_max_f32 v190, v190, v192
ds_write_b32 v198, v190 offset:0
v_max_f32 v191, v80, v81
v_max3_f32 v191, v191, v82, v83
v_mov_b32 v192, v191
s_nop 1
v_permlane16_swap_b32 v191, v192
v_max_f32 v191, v191, v192
v_mov_b32 v192, v191
s_nop 1
v_permlane32_swap_b32 v191, v192
v_max_f32 v191, v191, v192
ds_write_b32 v198, v191 offset:256
s_waitcnt lgkmcnt(0)
s_barrier
ds_read_b128 v[164:167], v199
ds_read_b128 v[168:171], v199 offset:256
ds_read_b128 v[172:175], v200
ds_write_b128 v206, a[128:131] offset:0
ds_write_b128 v206, a[132:135] offset:1088
ds_write_b128 v206, a[136:139] offset:2176
ds_write_b128 v206, a[140:143] offset:3264
ds_write_b128 v206, a[144:147] offset:4352
ds_write_b128 v206, a[148:151] offset:5440
ds_write_b128 v206, a[152:155] offset:6528
ds_write_b128 v206, a[156:159] offset:7616
ds_write_b128 v206, a[160:163] offset:8704
ds_write_b128 v206, a[164:167] offset:9792
ds_write_b128 v206, a[168:171] offset:10880
ds_write_b128 v206, a[172:175] offset:11968
ds_write_b128 v206, a[176:179] offset:13056
ds_write_b128 v206, a[180:183] offset:14144
ds_write_b128 v206, a[184:187] offset:15232
ds_write_b128 v206, a[188:191] offset:16320
s_waitcnt lgkmcnt(15)
v_max_f32 v164, v164, v165
v_max3_f32 v164, v164, v166, v167
v_mul_f32 v164, v164, v185
v_max_f32 v164, v164, v176
v_sub_f32 v182, v176, v164
v_exp_f32 v182, v182
v_mov_b32 v176, v164
v_max_f32 v168, v168, v169
v_max3_f32 v168, v168, v170, v171
v_mul_f32 v168, v168, v185
v_max_f32 v168, v168, v177
v_sub_f32 v183, v177, v168
v_exp_f32 v183, v183
v_mov_b32 v177, v168
v_max_f32 v172, v172, v173
v_max3_f32 v172, v172, v174, v175
v_mul_f32 v172, v172, v185
v_max_f32 v172, v172, v178
v_sub_f32 v184, v178, v172
v_exp_f32 v184, v184
v_mov_b32 v178, v172
v_fma_f32 v76, v76, v185, -v176
v_fma_f32 v77, v77, v185, -v176
v_fma_f32 v78, v78, v185, -v176
v_fma_f32 v79, v79, v185, -v176
v_exp_f32 v76, v76
v_exp_f32 v77, v77
v_exp_f32 v78, v78
v_exp_f32 v79, v79
v_mul_f32 v180, v180, v182
v_cvt_pk_bf16_f32 v186, v76, v77
v_cvt_pk_bf16_f32 v187, v78, v79
ds_write_b64 v201, v[186:187] offset:0
v_add_f32 v180, v180, v76
v_add_f32 v180, v180, v77
v_add_f32 v180, v180, v78
v_add_f32 v180, v180, v79
v_fma_f32 v80, v80, v185, -v177
v_fma_f32 v81, v81, v185, -v177
v_fma_f32 v82, v82, v185, -v177
v_fma_f32 v83, v83, v185, -v177
v_exp_f32 v80, v80
v_exp_f32 v81, v81
v_exp_f32 v82, v82
v_exp_f32 v83, v83
v_mul_f32 v181, v181, v183
v_cvt_pk_bf16_f32 v188, v80, v81
v_cvt_pk_bf16_f32 v189, v82, v83
ds_write_b64 v201, v[188:189] offset:512
v_add_f32 v181, v181, v80
v_add_f32 v181, v181, v81
v_add_f32 v181, v181, v82
v_add_f32 v181, v181, v83
v_mul_f32 v12, v12, v184
v_mul_f32 v13, v13, v184
v_mul_f32 v14, v14, v184
v_mul_f32 v15, v15, v184
v_mul_f32 v16, v16, v184
v_mul_f32 v17, v17, v184
v_mul_f32 v18, v18, v184
v_mul_f32 v19, v19, v184
v_mul_f32 v20, v20, v184
v_mul_f32 v21, v21, v184
v_mul_f32 v22, v22, v184
v_mul_f32 v23, v23, v184
v_mul_f32 v24, v24, v184
v_mul_f32 v25, v25, v184
v_mul_f32 v26, v26, v184
v_mul_f32 v27, v27, v184
v_mul_f32 v28, v28, v184
v_mul_f32 v29, v29, v184
v_mul_f32 v30, v30, v184
v_mul_f32 v31, v31, v184
v_mul_f32 v32, v32, v184
v_mul_f32 v33, v33, v184
v_mul_f32 v34, v34, v184
v_mul_f32 v35, v35, v184
v_mul_f32 v36, v36, v184
v_mul_f32 v37, v37, v184
v_mul_f32 v38, v38, v184
v_mul_f32 v39, v39, v184
v_mul_f32 v40, v40, v184
v_mul_f32 v41, v41, v184
v_mul_f32 v42, v42, v184
v_mul_f32 v43, v43, v184
v_mul_f32 v44, v44, v184
v_mul_f32 v45, v45, v184
v_mul_f32 v46, v46, v184
v_mul_f32 v47, v47, v184
v_mul_f32 v48, v48, v184
v_mul_f32 v49, v49, v184
v_mul_f32 v50, v50, v184
v_mul_f32 v51, v51, v184
v_mul_f32 v52, v52, v184
v_mul_f32 v53, v53, v184
v_mul_f32 v54, v54, v184
v_mul_f32 v55, v55, v184
v_mul_f32 v56, v56, v184
v_mul_f32 v57, v57, v184
v_mul_f32 v58, v58, v184
v_mul_f32 v59, v59, v184
v_mul_f32 v60, v60, v184
v_mul_f32 v61, v61, v184
v_mul_f32 v62, v62, v184
v_mul_f32 v63, v63, v184
v_mul_f32 v64, v64, v184
v_mul_f32 v65, v65, v184
v_mul_f32 v66, v66, v184
v_mul_f32 v67, v67, v184
v_mul_f32 v68, v68, v184
v_mul_f32 v69, v69, v184
v_mul_f32 v70, v70, v184
v_mul_f32 v71, v71, v184
v_mul_f32 v72, v72, v184
v_mul_f32 v73, v73, v184
v_mul_f32 v74, v74, v184
v_mul_f32 v75, v75, v184
s_waitcnt lgkmcnt(0)
s_barrier
ds_read_b128 v[148:151], v202 offset:0
ds_read_b128 v[152:155], v202 offset:1024
ds_read_b128 v[156:159], v202 offset:2048
ds_read_b128 v[160:163], v202 offset:3072
ds_read_b64_tr_b16 v[84:85], v197 offset:0
ds_read_b64_tr_b16 v[86:87], v197 offset:4352
ds_read_b64_tr_b16 v[88:89], v197 offset:64
ds_read_b64_tr_b16 v[90:91], v197 offset:4416
ds_read_b64_tr_b16 v[92:93], v197 offset:128
ds_read_b64_tr_b16 v[94:95], v197 offset:4480
ds_read_b64_tr_b16 v[96:97], v197 offset:192
ds_read_b64_tr_b16 v[98:99], v197 offset:4544
ds_read_b64_tr_b16 v[100:101], v197 offset:17408
ds_read_b64_tr_b16 v[102:103], v197 offset:21760
ds_read_b64_tr_b16 v[104:105], v197 offset:17472
ds_read_b64_tr_b16 v[106:107], v197 offset:21824
ds_read_b64_tr_b16 v[108:109], v197 offset:17536
ds_read_b64_tr_b16 v[110:111], v197 offset:21888
ds_read_b64_tr_b16 v[112:113], v197 offset:17600
ds_read_b64_tr_b16 v[114:115], v197 offset:21952
ds_read_b64_tr_b16 v[116:117], v197 offset:34816
ds_read_b64_tr_b16 v[118:119], v197 offset:39168
ds_read_b64_tr_b16 v[120:121], v197 offset:34880
ds_read_b64_tr_b16 v[122:123], v197 offset:39232
ds_read_b64_tr_b16 v[124:125], v197 offset:34944
ds_read_b64_tr_b16 v[126:127], v197 offset:39296
ds_read_b64_tr_b16 v[128:129], v197 offset:35008
ds_read_b64_tr_b16 v[130:131], v197 offset:39360
ds_read_b64_tr_b16 v[132:133], v197 offset:52224
ds_read_b64_tr_b16 v[134:135], v197 offset:56576
ds_read_b64_tr_b16 v[136:137], v197 offset:52288
ds_read_b64_tr_b16 v[138:139], v197 offset:56640
ds_read_b64_tr_b16 v[140:141], v197 offset:52352
ds_read_b64_tr_b16 v[142:143], v197 offset:56704
ds_read_b64_tr_b16 v[144:145], v197 offset:52416
ds_read_b64_tr_b16 v[146:147], v197 offset:56768
s_waitcnt lgkmcnt(15)
v_mfma_f32_32x32x16_bf16 v[12:27], v[84:87], v[148:151], v[12:27]
v_mfma_f32_32x32x16_bf16 v[28:43], v[88:91], v[148:151], v[28:43]
s_add_u32 s6, s13, 2097152
buffer_load_dwordx4 a[128:131], v2, s[52:55], s6 offen nt
v_mfma_f32_32x32x16_bf16 v[44:59], v[92:95], v[148:151], v[44:59]
v_mfma_f32_32x32x16_bf16 v[60:75], v[96:99], v[148:151], v[60:75]
s_add_u32 s6, s13, 2098176
buffer_load_dwordx4 a[132:135], v2, s[52:55], s6 offen nt
s_waitcnt lgkmcnt(15)
v_mfma_f32_32x32x16_bf16 v[12:27], v[100:103], v[152:155], v[12:27]
v_mfma_f32_32x32x16_bf16 v[28:43], v[104:107], v[152:155], v[28:43]
s_add_u32 s6, s13, 2099200
buffer_load_dwordx4 a[136:139], v2, s[52:55], s6 offen nt
v_mfma_f32_32x32x16_bf16 v[44:59], v[108:111], v[152:155], v[44:59]
v_mfma_f32_32x32x16_bf16 v[60:75], v[112:115], v[152:155], v[60:75]
s_add_u32 s6, s13, 2100224
buffer_load_dwordx4 a[140:143], v2, s[52:55], s6 offen nt
s_waitcnt lgkmcnt(8)
v_mfma_f32_32x32x16_bf16 v[12:27], v[116:119], v[156:159], v[12:27]
v_mfma_f32_32x32x16_bf16 v[28:43], v[120:123], v[156:159], v[28:43]
s_add_u32 s6, s13, 2228224
buffer_load_dwordx4 a[144:147], v2, s[52:55], s6 offen nt
v_mfma_f32_32x32x16_bf16 v[44:59], v[124:127], v[156:159], v[44:59]
v_mfma_f32_32x32x16_bf16 v[60:75], v[128:131], v[156:159], v[60:75]
s_add_u32 s6, s13, 2229248
buffer_load_dwordx4 a[148:151], v2, s[52:55], s6 offen nt
s_waitcnt lgkmcnt(0)
v_mfma_f32_32x32x16_bf16 v[12:27], v[132:135], v[160:163], v[12:27]
v_mfma_f32_32x32x16_bf16 v[28:43], v[136:139], v[160:163], v[28:43]
s_add_u32 s6, s13, 2230272
buffer_load_dwordx4 a[152:155], v2, s[52:55], s6 offen nt
v_mfma_f32_32x32x16_bf16 v[44:59], v[140:143], v[160:163], v[44:59]
v_mfma_f32_32x32x16_bf16 v[60:75], v[144:147], v[160:163], v[60:75]
s_add_u32 s6, s13, 2231296
buffer_load_dwordx4 a[156:159], v2, s[52:55], s6 offen nt
ds_read_b128 v[84:87], v194 offset:0
ds_read_b128 v[88:91], v194 offset:64
ds_read_b128 v[92:95], v194 offset:128
ds_read_b128 v[96:99], v194 offset:192
ds_read_b128 v[100:103], v194 offset:256
ds_read_b128 v[104:107], v194 offset:320
ds_read_b128 v[108:111], v194 offset:384
ds_read_b128 v[112:115], v194 offset:448
ds_read_b128 v[116:119], v194 offset:512
ds_read_b128 v[120:123], v194 offset:576
ds_read_b128 v[124:127], v194 offset:640
ds_read_b128 v[128:131], v194 offset:704
ds_read_b128 v[132:135], v194 offset:768
ds_read_b128 v[136:139], v194 offset:832
ds_read_b128 v[140:143], v194 offset:896
ds_read_b128 v[144:147], v194 offset:960
s_waitcnt lgkmcnt(15)
v_mfma_f32_16x16x32_bf16 v[76:79], v[84:87], a[0:3], 0
v_mfma_f32_16x16x32_bf16 v[80:83], v[84:87], a[64:67], 0
s_waitcnt lgkmcnt(14)
v_mfma_f32_16x16x32_bf16 v[76:79], v[88:91], a[4:7], v[76:79]
v_mfma_f32_16x16x32_bf16 v[80:83], v[88:91], a[68:71], v[80:83]
s_add_u32 s6, s13, 2359296
buffer_load_dwordx4 a[160:163], v10, s[52:55], s6 offen nt
s_waitcnt lgkmcnt(13)
v_mfma_f32_16x16x32_bf16 v[76:79], v[92:95], a[8:11], v[76:79]
v_mfma_f32_16x16x32_bf16 v[80:83], v[92:95], a[72:75], v[80:83]
s_waitcnt lgkmcnt(12)
v_mfma_f32_16x16x32_bf16 v[76:79], v[96:99], a[12:15], v[76:79]
v_mfma_f32_16x16x32_bf16 v[80:83], v[96:99], a[76:79], v[80:83]
s_add_u32 s6, s13, 2360320
buffer_load_dwordx4 a[164:167], v10, s[52:55], s6 offen nt
s_waitcnt lgkmcnt(11)
v_mfma_f32_16x16x32_bf16 v[76:79], v[100:103], a[16:19], v[76:79]
v_mfma_f32_16x16x32_bf16 v[80:83], v[100:103], a[80:83], v[80:83]
s_waitcnt lgkmcnt(10)
v_mfma_f32_16x16x32_bf16 v[76:79], v[104:107], a[20:23], v[76:79]
v_mfma_f32_16x16x32_bf16 v[80:83], v[104:107], a[84:87], v[80:83]
s_add_u32 s6, s13, 2361344
buffer_load_dwordx4 a[168:171], v10, s[52:55], s6 offen nt
s_waitcnt lgkmcnt(9)
v_mfma_f32_16x16x32_bf16 v[76:79], v[108:111], a[24:27], v[76:79]
v_mfma_f32_16x16x32_bf16 v[80:83], v[108:111], a[88:91], v[80:83]
s_waitcnt lgkmcnt(8)
v_mfma_f32_16x16x32_bf16 v[76:79], v[112:115], a[28:31], v[76:79]
v_mfma_f32_16x16x32_bf16 v[80:83], v[112:115], a[92:95], v[80:83]
s_add_u32 s6, s13, 2362368
buffer_load_dwordx4 a[172:175], v10, s[52:55], s6 offen nt
s_waitcnt lgkmcnt(7)
v_mfma_f32_16x16x32_bf16 v[76:79], v[116:119], a[32:35], v[76:79]
v_mfma_f32_16x16x32_bf16 v[80:83], v[116:119], a[96:99], v[80:83]
s_waitcnt lgkmcnt(6)
v_mfma_f32_16x16x32_bf16 v[76:79], v[120:123], a[36:39], v[76:79]
v_mfma_f32_16x16x32_bf16 v[80:83], v[120:123], a[100:103], v[80:83]
s_add_u32 s6, s13, 2490368
buffer_load_dwordx4 a[176:179], v10, s[52:55], s6 offen nt
s_waitcnt lgkmcnt(5)
v_mfma_f32_16x16x32_bf16 v[76:79], v[124:127], a[40:43], v[76:79]
v_mfma_f32_16x16x32_bf16 v[80:83], v[124:127], a[104:107], v[80:83]
s_waitcnt lgkmcnt(4)
v_mfma_f32_16x16x32_bf16 v[76:79], v[128:131], a[44:47], v[76:79]
v_mfma_f32_16x16x32_bf16 v[80:83], v[128:131], a[108:111], v[80:83]
s_add_u32 s6, s13, 2491392
buffer_load_dwordx4 a[180:183], v10, s[52:55], s6 offen nt
s_waitcnt lgkmcnt(3)
v_mfma_f32_16x16x32_bf16 v[76:79], v[132:135], a[48:51], v[76:79]
v_mfma_f32_16x16x32_bf16 v[80:83], v[132:135], a[112:115], v[80:83]
s_waitcnt lgkmcnt(2)
v_mfma_f32_16x16x32_bf16 v[76:79], v[136:139], a[52:55], v[76:79]
v_mfma_f32_16x16x32_bf16 v[80:83], v[136:139], a[116:119], v[80:83]
s_add_u32 s6, s13, 2492416
buffer_load_dwordx4 a[184:187], v10, s[52:55], s6 offen nt
s_waitcnt lgkmcnt(1)
v_mfma_f32_16x16x32_bf16 v[76:79], v[140:143], a[56:59], v[76:79]
v_mfma_f32_16x16x32_bf16 v[80:83], v[140:143], a[120:123], v[80:83]
s_waitcnt lgkmcnt(0)
v_mfma_f32_16x16x32_bf16 v[76:79], v[144:147], a[60:63], v[76:79]
v_mfma_f32_16x16x32_bf16 v[80:83], v[144:147], a[124:127], v[80:83]
s_add_u32 s6, s13, 2493440
buffer_load_dwordx4 a[188:191], v10, s[52:55], s6 offen nt
s_nop 4
v_max_f32 v190, v76, v77
v_max3_f32 v190, v190, v78, v79
v_mov_b32 v192, v190
s_nop 1
v_permlane16_swap_b32 v190, v192
v_max_f32 v190, v190, v192
v_mov_b32 v192, v190
s_nop 1
v_permlane32_swap_b32 v190, v192
v_max_f32 v190, v190, v192
ds_write_b32 v198, v190 offset:0
v_max_f32 v191, v80, v81
v_max3_f32 v191, v191, v82, v83
v_mov_b32 v192, v191
s_nop 1
v_permlane16_swap_b32 v191, v192
v_max_f32 v191, v191, v192
v_mov_b32 v192, v191
s_nop 1
v_permlane32_swap_b32 v191, v192
v_max_f32 v191, v191, v192
ds_write_b32 v198, v191 offset:256
s_waitcnt lgkmcnt(0)
s_barrier
ds_read_b128 v[164:167], v199
ds_read_b128 v[168:171], v199 offset:256
ds_read_b128 v[172:175], v200
ds_write_b128 v207, a[192:195] offset:0
ds_write_b128 v207, a[196:199] offset:1088
ds_write_b128 v207, a[200:203] offset:2176
ds_write_b128 v207, a[204:207] offset:3264
ds_write_b128 v207, a[208:211] offset:4352
ds_write_b128 v207, a[212:215] offset:5440
ds_write_b128 v207, a[216:219] offset:6528
ds_write_b128 v207, a[220:223] offset:7616
ds_write_b128 v207, a[224:227] offset:8704
ds_write_b128 v207, a[228:231] offset:9792
ds_write_b128 v207, a[232:235] offset:10880
ds_write_b128 v207, a[236:239] offset:11968
ds_write_b128 v207, a[240:243] offset:13056
ds_write_b128 v207, a[244:247] offset:14144
ds_write_b128 v207, a[248:251] offset:15232
ds_write_b128 v207, a[252:255] offset:16320
s_waitcnt lgkmcnt(15)
v_max_f32 v164, v164, v165
v_max3_f32 v164, v164, v166, v167
v_mul_f32 v164, v164, v185
v_max_f32 v164, v164, v176
v_sub_f32 v182, v176, v164
v_exp_f32 v182, v182
v_mov_b32 v176, v164
v_max_f32 v168, v168, v169
v_max3_f32 v168, v168, v170, v171
v_mul_f32 v168, v168, v185
v_max_f32 v168, v168, v177
v_sub_f32 v183, v177, v168
v_exp_f32 v183, v183
v_mov_b32 v177, v168
v_max_f32 v172, v172, v173
v_max3_f32 v172, v172, v174, v175
v_mul_f32 v172, v172, v185
v_max_f32 v172, v172, v178
v_sub_f32 v184, v178, v172
v_exp_f32 v184, v184
v_mov_b32 v178, v172
v_fma_f32 v76, v76, v185, -v176
v_fma_f32 v77, v77, v185, -v176
v_fma_f32 v78, v78, v185, -v176
v_fma_f32 v79, v79, v185, -v176
v_exp_f32 v76, v76
v_exp_f32 v77, v77
v_exp_f32 v78, v78
v_exp_f32 v79, v79
v_mul_f32 v180, v180, v182
v_cvt_pk_bf16_f32 v186, v76, v77
v_cvt_pk_bf16_f32 v187, v78, v79
ds_write_b64 v201, v[186:187] offset:0
v_add_f32 v180, v180, v76
v_add_f32 v180, v180, v77
v_add_f32 v180, v180, v78
v_add_f32 v180, v180, v79
v_fma_f32 v80, v80, v185, -v177
v_fma_f32 v81, v81, v185, -v177
v_fma_f32 v82, v82, v185, -v177
v_fma_f32 v83, v83, v185, -v177
v_exp_f32 v80, v80
v_exp_f32 v81, v81
v_exp_f32 v82, v82
v_exp_f32 v83, v83
v_mul_f32 v181, v181, v183
v_cvt_pk_bf16_f32 v188, v80, v81
v_cvt_pk_bf16_f32 v189, v82, v83
ds_write_b64 v201, v[188:189] offset:512
v_add_f32 v181, v181, v80
v_add_f32 v181, v181, v81
v_add_f32 v181, v181, v82
v_add_f32 v181, v181, v83
v_mul_f32 v12, v12, v184
v_mul_f32 v13, v13, v184
v_mul_f32 v14, v14, v184
v_mul_f32 v15, v15, v184
v_mul_f32 v16, v16, v184
v_mul_f32 v17, v17, v184
v_mul_f32 v18, v18, v184
v_mul_f32 v19, v19, v184
v_mul_f32 v20, v20, v184
v_mul_f32 v21, v21, v184
v_mul_f32 v22, v22, v184
v_mul_f32 v23, v23, v184
v_mul_f32 v24, v24, v184
v_mul_f32 v25, v25, v184
v_mul_f32 v26, v26, v184
v_mul_f32 v27, v27, v184
v_mul_f32 v28, v28, v184
v_mul_f32 v29, v29, v184
v_mul_f32 v30, v30, v184
v_mul_f32 v31, v31, v184
v_mul_f32 v32, v32, v184
v_mul_f32 v33, v33, v184
v_mul_f32 v34, v34, v184
v_mul_f32 v35, v35, v184
v_mul_f32 v36, v36, v184
v_mul_f32 v37, v37, v184
v_mul_f32 v38, v38, v184
v_mul_f32 v39, v39, v184
v_mul_f32 v40, v40, v184
v_mul_f32 v41, v41, v184
v_mul_f32 v42, v42, v184
v_mul_f32 v43, v43, v184
v_mul_f32 v44, v44, v184
v_mul_f32 v45, v45, v184
v_mul_f32 v46, v46, v184
v_mul_f32 v47, v47, v184
v_mul_f32 v48, v48, v184
v_mul_f32 v49, v49, v184
v_mul_f32 v50, v50, v184
v_mul_f32 v51, v51, v184
v_mul_f32 v52, v52, v184
v_mul_f32 v53, v53, v184
v_mul_f32 v54, v54, v184
v_mul_f32 v55, v55, v184
v_mul_f32 v56, v56, v184
v_mul_f32 v57, v57, v184
v_mul_f32 v58, v58, v184
v_mul_f32 v59, v59, v184
v_mul_f32 v60, v60, v184
v_mul_f32 v61, v61, v184
v_mul_f32 v62, v62, v184
v_mul_f32 v63, v63, v184
v_mul_f32 v64, v64, v184
v_mul_f32 v65, v65, v184
v_mul_f32 v66, v66, v184
v_mul_f32 v67, v67, v184
v_mul_f32 v68, v68, v184
v_mul_f32 v69, v69, v184
v_mul_f32 v70, v70, v184
v_mul_f32 v71, v71, v184
v_mul_f32 v72, v72, v184
v_mul_f32 v73, v73, v184
v_mul_f32 v74, v74, v184
v_mul_f32 v75, v75, v184
s_waitcnt lgkmcnt(0)
s_barrier
ds_read_b128 v[148:151], v202 offset:0
ds_read_b128 v[152:155], v202 offset:1024
ds_read_b128 v[156:159], v202 offset:2048
ds_read_b128 v[160:163], v202 offset:3072
ds_read_b64_tr_b16 v[84:85], v196 offset:0
ds_read_b64_tr_b16 v[86:87], v196 offset:4352
ds_read_b64_tr_b16 v[88:89], v196 offset:64
ds_read_b64_tr_b16 v[90:91], v196 offset:4416
ds_read_b64_tr_b16 v[92:93], v196 offset:128
ds_read_b64_tr_b16 v[94:95], v196 offset:4480
ds_read_b64_tr_b16 v[96:97], v196 offset:192
ds_read_b64_tr_b16 v[98:99], v196 offset:4544
ds_read_b64_tr_b16 v[100:101], v196 offset:17408
ds_read_b64_tr_b16 v[102:103], v196 offset:21760
ds_read_b64_tr_b16 v[104:105], v196 offset:17472
ds_read_b64_tr_b16 v[106:107], v196 offset:21824
ds_read_b64_tr_b16 v[108:109], v196 offset:17536
ds_read_b64_tr_b16 v[110:111], v196 offset:21888
ds_read_b64_tr_b16 v[112:113], v196 offset:17600
ds_read_b64_tr_b16 v[114:115], v196 offset:21952
ds_read_b64_tr_b16 v[116:117], v196 offset:34816
ds_read_b64_tr_b16 v[118:119], v196 offset:39168
ds_read_b64_tr_b16 v[120:121], v196 offset:34880
ds_read_b64_tr_b16 v[122:123], v196 offset:39232
ds_read_b64_tr_b16 v[124:125], v196 offset:34944
ds_read_b64_tr_b16 v[126:127], v196 offset:39296
ds_read_b64_tr_b16 v[128:129], v196 offset:35008
ds_read_b64_tr_b16 v[130:131], v196 offset:39360
ds_read_b64_tr_b16 v[132:133], v196 offset:52224
ds_read_b64_tr_b16 v[134:135], v196 offset:56576
ds_read_b64_tr_b16 v[136:137], v196 offset:52288
ds_read_b64_tr_b16 v[138:139], v196 offset:56640
ds_read_b64_tr_b16 v[140:141], v196 offset:52352
ds_read_b64_tr_b16 v[142:143], v196 offset:56704
ds_read_b64_tr_b16 v[144:145], v196 offset:52416
ds_read_b64_tr_b16 v[146:147], v196 offset:56768
s_waitcnt lgkmcnt(15)
v_mfma_f32_32x32x16_bf16 v[12:27], v[84:87], v[148:151], v[12:27]
v_mfma_f32_32x32x16_bf16 v[28:43], v[88:91], v[148:151], v[28:43]
s_add_u32 s6, s13, 2621440
buffer_load_dwordx4 a[192:195], v2, s[52:55], s6 offen nt
v_mfma_f32_32x32x16_bf16 v[44:59], v[92:95], v[148:151], v[44:59]
v_mfma_f32_32x32x16_bf16 v[60:75], v[96:99], v[148:151], v[60:75]
s_add_u32 s6, s13, 2622464
buffer_load_dwordx4 a[196:199], v2, s[52:55], s6 offen nt
s_waitcnt lgkmcnt(15)
v_mfma_f32_32x32x16_bf16 v[12:27], v[100:103], v[152:155], v[12:27]
v_mfma_f32_32x32x16_bf16 v[28:43], v[104:107], v[152:155], v[28:43]
s_add_u32 s6, s13, 2623488
buffer_load_dwordx4 a[200:203], v2, s[52:55], s6 offen nt
v_mfma_f32_32x32x16_bf16 v[44:59], v[108:111], v[152:155], v[44:59]
v_mfma_f32_32x32x16_bf16 v[60:75], v[112:115], v[152:155], v[60:75]
s_add_u32 s6, s13, 2624512
buffer_load_dwordx4 a[204:207], v2, s[52:55], s6 offen nt
s_waitcnt lgkmcnt(8)
v_mfma_f32_32x32x16_bf16 v[12:27], v[116:119], v[156:159], v[12:27]
v_mfma_f32_32x32x16_bf16 v[28:43], v[120:123], v[156:159], v[28:43]
s_add_u32 s6, s13, 2752512
buffer_load_dwordx4 a[208:211], v2, s[52:55], s6 offen nt
v_mfma_f32_32x32x16_bf16 v[44:59], v[124:127], v[156:159], v[44:59]
v_mfma_f32_32x32x16_bf16 v[60:75], v[128:131], v[156:159], v[60:75]
s_add_u32 s6, s13, 2753536
buffer_load_dwordx4 a[212:215], v2, s[52:55], s6 offen nt
s_waitcnt lgkmcnt(0)
v_mfma_f32_32x32x16_bf16 v[12:27], v[132:135], v[160:163], v[12:27]
v_mfma_f32_32x32x16_bf16 v[28:43], v[136:139], v[160:163], v[28:43]
s_add_u32 s6, s13, 2754560
buffer_load_dwordx4 a[216:219], v2, s[52:55], s6 offen nt
v_mfma_f32_32x32x16_bf16 v[44:59], v[140:143], v[160:163], v[44:59]
v_mfma_f32_32x32x16_bf16 v[60:75], v[144:147], v[160:163], v[60:75]
s_add_u32 s6, s13, 2755584
buffer_load_dwordx4 a[220:223], v2, s[52:55], s6 offen nt
ds_read_b128 v[84:87], v195 offset:0
ds_read_b128 v[88:91], v195 offset:64
ds_read_b128 v[92:95], v195 offset:128
ds_read_b128 v[96:99], v195 offset:192
ds_read_b128 v[100:103], v195 offset:256
ds_read_b128 v[104:107], v195 offset:320
ds_read_b128 v[108:111], v195 offset:384
ds_read_b128 v[112:115], v195 offset:448
ds_read_b128 v[116:119], v195 offset:512
ds_read_b128 v[120:123], v195 offset:576
ds_read_b128 v[124:127], v195 offset:640
ds_read_b128 v[128:131], v195 offset:704
ds_read_b128 v[132:135], v195 offset:768
ds_read_b128 v[136:139], v195 offset:832
ds_read_b128 v[140:143], v195 offset:896
ds_read_b128 v[144:147], v195 offset:960
s_waitcnt lgkmcnt(15)
v_mfma_f32_16x16x32_bf16 v[76:79], v[84:87], a[0:3], 0
v_mfma_f32_16x16x32_bf16 v[80:83], v[84:87], a[64:67], 0
s_waitcnt lgkmcnt(14)
v_mfma_f32_16x16x32_bf16 v[76:79], v[88:91], a[4:7], v[76:79]
v_mfma_f32_16x16x32_bf16 v[80:83], v[88:91], a[68:71], v[80:83]
s_add_u32 s6, s13, 2883584
buffer_load_dwordx4 a[224:227], v10, s[52:55], s6 offen nt
s_waitcnt lgkmcnt(13)
v_mfma_f32_16x16x32_bf16 v[76:79], v[92:95], a[8:11], v[76:79]
v_mfma_f32_16x16x32_bf16 v[80:83], v[92:95], a[72:75], v[80:83]
s_waitcnt lgkmcnt(12)
v_mfma_f32_16x16x32_bf16 v[76:79], v[96:99], a[12:15], v[76:79]
v_mfma_f32_16x16x32_bf16 v[80:83], v[96:99], a[76:79], v[80:83]
s_add_u32 s6, s13, 2884608
buffer_load_dwordx4 a[228:231], v10, s[52:55], s6 offen nt
s_waitcnt lgkmcnt(11)
v_mfma_f32_16x16x32_bf16 v[76:79], v[100:103], a[16:19], v[76:79]
v_mfma_f32_16x16x32_bf16 v[80:83], v[100:103], a[80:83], v[80:83]
s_waitcnt lgkmcnt(10)
v_mfma_f32_16x16x32_bf16 v[76:79], v[104:107], a[20:23], v[76:79]
v_mfma_f32_16x16x32_bf16 v[80:83], v[104:107], a[84:87], v[80:83]
s_add_u32 s6, s13, 2885632
buffer_load_dwordx4 a[232:235], v10, s[52:55], s6 offen nt
s_waitcnt lgkmcnt(9)
v_mfma_f32_16x16x32_bf16 v[76:79], v[108:111], a[24:27], v[76:79]
v_mfma_f32_16x16x32_bf16 v[80:83], v[108:111], a[88:91], v[80:83]
s_waitcnt lgkmcnt(8)
v_mfma_f32_16x16x32_bf16 v[76:79], v[112:115], a[28:31], v[76:79]
v_mfma_f32_16x16x32_bf16 v[80:83], v[112:115], a[92:95], v[80:83]
s_add_u32 s6, s13, 2886656
buffer_load_dwordx4 a[236:239], v10, s[52:55], s6 offen nt
s_waitcnt lgkmcnt(7)
v_mfma_f32_16x16x32_bf16 v[76:79], v[116:119], a[32:35], v[76:79]
v_mfma_f32_16x16x32_bf16 v[80:83], v[116:119], a[96:99], v[80:83]
s_waitcnt lgkmcnt(6)
v_mfma_f32_16x16x32_bf16 v[76:79], v[120:123], a[36:39], v[76:79]
v_mfma_f32_16x16x32_bf16 v[80:83], v[120:123], a[100:103], v[80:83]
s_add_u32 s6, s13, 3014656
buffer_load_dwordx4 a[240:243], v10, s[52:55], s6 offen nt
s_waitcnt lgkmcnt(5)
v_mfma_f32_16x16x32_bf16 v[76:79], v[124:127], a[40:43], v[76:79]
v_mfma_f32_16x16x32_bf16 v[80:83], v[124:127], a[104:107], v[80:83]
s_waitcnt lgkmcnt(4)
v_mfma_f32_16x16x32_bf16 v[76:79], v[128:131], a[44:47], v[76:79]
v_mfma_f32_16x16x32_bf16 v[80:83], v[128:131], a[108:111], v[80:83]
s_add_u32 s6, s13, 3015680
buffer_load_dwordx4 a[244:247], v10, s[52:55], s6 offen nt
s_waitcnt lgkmcnt(3)
v_mfma_f32_16x16x32_bf16 v[76:79], v[132:135], a[48:51], v[76:79]
v_mfma_f32_16x16x32_bf16 v[80:83], v[132:135], a[112:115], v[80:83]
s_waitcnt lgkmcnt(2)
v_mfma_f32_16x16x32_bf16 v[76:79], v[136:139], a[52:55], v[76:79]
v_mfma_f32_16x16x32_bf16 v[80:83], v[136:139], a[116:119], v[80:83]
s_add_u32 s6, s13, 3016704
buffer_load_dwordx4 a[248:251], v10, s[52:55], s6 offen nt
s_waitcnt lgkmcnt(1)
v_mfma_f32_16x16x32_bf16 v[76:79], v[140:143], a[56:59], v[76:79]
v_mfma_f32_16x16x32_bf16 v[80:83], v[140:143], a[120:123], v[80:83]
s_waitcnt lgkmcnt(0)
v_mfma_f32_16x16x32_bf16 v[76:79], v[144:147], a[60:63], v[76:79]
v_mfma_f32_16x16x32_bf16 v[80:83], v[144:147], a[124:127], v[80:83]
s_add_u32 s6, s13, 3017728
buffer_load_dwordx4 a[252:255], v10, s[52:55], s6 offen nt
s_nop 4
v_max_f32 v190, v76, v77
v_max3_f32 v190, v190, v78, v79
v_mov_b32 v192, v190
s_nop 1
v_permlane16_swap_b32 v190, v192
v_max_f32 v190, v190, v192
v_mov_b32 v192, v190
s_nop 1
v_permlane32_swap_b32 v190, v192
v_max_f32 v190, v190, v192
ds_write_b32 v198, v190 offset:0
v_max_f32 v191, v80, v81
v_max3_f32 v191, v191, v82, v83
v_mov_b32 v192, v191
s_nop 1
v_permlane16_swap_b32 v191, v192
v_max_f32 v191, v191, v192
v_mov_b32 v192, v191
s_nop 1
v_permlane32_swap_b32 v191, v192
v_max_f32 v191, v191, v192
ds_write_b32 v198, v191 offset:256
s_waitcnt lgkmcnt(0)
s_barrier
ds_read_b128 v[164:167], v199
ds_read_b128 v[168:171], v199 offset:256
ds_read_b128 v[172:175], v200
s_waitcnt vmcnt(16)
ds_write_b128 v206, a[128:131] offset:0
ds_write_b128 v206, a[132:135] offset:1088
ds_write_b128 v206, a[136:139] offset:2176
ds_write_b128 v206, a[140:143] offset:3264
ds_write_b128 v206, a[144:147] offset:4352
ds_write_b128 v206, a[148:151] offset:5440
ds_write_b128 v206, a[152:155] offset:6528
ds_write_b128 v206, a[156:159] offset:7616
ds_write_b128 v206, a[160:163] offset:8704
ds_write_b128 v206, a[164:167] offset:9792
ds_write_b128 v206, a[168:171] offset:10880
ds_write_b128 v206, a[172:175] offset:11968
ds_write_b128 v206, a[176:179] offset:13056
ds_write_b128 v206, a[180:183] offset:14144
ds_write_b128 v206, a[184:187] offset:15232
ds_write_b128 v206, a[188:191] offset:16320
s_waitcnt lgkmcnt(15)
v_max_f32 v164, v164, v165
v_max3_f32 v164, v164, v166, v167
v_mul_f32 v164, v164, v185
v_max_f32 v164, v164, v176
v_sub_f32 v182, v176, v164
v_exp_f32 v182, v182
v_mov_b32 v176, v164
v_max_f32 v168, v168, v169
v_max3_f32 v168, v168, v170, v171
v_mul_f32 v168, v168, v185
v_max_f32 v168, v168, v177
v_sub_f32 v183, v177, v168
v_exp_f32 v183, v183
v_mov_b32 v177, v168
v_max_f32 v172, v172, v173
v_max3_f32 v172, v172, v174, v175
v_mul_f32 v172, v172, v185
v_max_f32 v172, v172, v178
v_sub_f32 v184, v178, v172
v_exp_f32 v184, v184
v_mov_b32 v178, v172
v_fma_f32 v76, v76, v185, -v176
v_fma_f32 v77, v77, v185, -v176
v_fma_f32 v78, v78, v185, -v176
v_fma_f32 v79, v79, v185, -v176
v_exp_f32 v76, v76
v_exp_f32 v77, v77
v_exp_f32 v78, v78
v_exp_f32 v79, v79
v_mul_f32 v180, v180, v182
v_cvt_pk_bf16_f32 v186, v76, v77
v_cvt_pk_bf16_f32 v187, v78, v79
ds_write_b64 v201, v[186:187] offset:0
v_add_f32 v180, v180, v76
v_add_f32 v180, v180, v77
v_add_f32 v180, v180, v78
v_add_f32 v180, v180, v79
v_fma_f32 v80, v80, v185, -v177
v_fma_f32 v81, v81, v185, -v177
v_fma_f32 v82, v82, v185, -v177
v_fma_f32 v83, v83, v185, -v177
v_exp_f32 v80, v80
v_exp_f32 v81, v81
v_exp_f32 v82, v82
v_exp_f32 v83, v83
v_mul_f32 v181, v181, v183
v_cvt_pk_bf16_f32 v188, v80, v81
v_cvt_pk_bf16_f32 v189, v82, v83
ds_write_b64 v201, v[188:189] offset:512
v_add_f32 v181, v181, v80
v_add_f32 v181, v181, v81
v_add_f32 v181, v181, v82
v_add_f32 v181, v181, v83
v_mul_f32 v12, v12, v184
v_mul_f32 v13, v13, v184
v_mul_f32 v14, v14, v184
v_mul_f32 v15, v15, v184
v_mul_f32 v16, v16, v184
v_mul_f32 v17, v17, v184
v_mul_f32 v18, v18, v184
v_mul_f32 v19, v19, v184
v_mul_f32 v20, v20, v184
v_mul_f32 v21, v21, v184
v_mul_f32 v22, v22, v184
v_mul_f32 v23, v23, v184
v_mul_f32 v24, v24, v184
v_mul_f32 v25, v25, v184
v_mul_f32 v26, v26, v184
v_mul_f32 v27, v27, v184
v_mul_f32 v28, v28, v184
v_mul_f32 v29, v29, v184
v_mul_f32 v30, v30, v184
v_mul_f32 v31, v31, v184
v_mul_f32 v32, v32, v184
v_mul_f32 v33, v33, v184
v_mul_f32 v34, v34, v184
v_mul_f32 v35, v35, v184
v_mul_f32 v36, v36, v184
v_mul_f32 v37, v37, v184
v_mul_f32 v38, v38, v184
v_mul_f32 v39, v39, v184
v_mul_f32 v40, v40, v184
v_mul_f32 v41, v41, v184
v_mul_f32 v42, v42, v184
v_mul_f32 v43, v43, v184
v_mul_f32 v44, v44, v184
v_mul_f32 v45, v45, v184
v_mul_f32 v46, v46, v184
v_mul_f32 v47, v47, v184
v_mul_f32 v48, v48, v184
v_mul_f32 v49, v49, v184
v_mul_f32 v50, v50, v184
v_mul_f32 v51, v51, v184
v_mul_f32 v52, v52, v184
v_mul_f32 v53, v53, v184
v_mul_f32 v54, v54, v184
v_mul_f32 v55, v55, v184
v_mul_f32 v56, v56, v184
v_mul_f32 v57, v57, v184
v_mul_f32 v58, v58, v184
v_mul_f32 v59, v59, v184
v_mul_f32 v60, v60, v184
v_mul_f32 v61, v61, v184
v_mul_f32 v62, v62, v184
v_mul_f32 v63, v63, v184
v_mul_f32 v64, v64, v184
v_mul_f32 v65, v65, v184
v_mul_f32 v66, v66, v184
v_mul_f32 v67, v67, v184
v_mul_f32 v68, v68, v184
v_mul_f32 v69, v69, v184
v_mul_f32 v70, v70, v184
v_mul_f32 v71, v71, v184
v_mul_f32 v72, v72, v184
v_mul_f32 v73, v73, v184
v_mul_f32 v74, v74, v184
v_mul_f32 v75, v75, v184
s_waitcnt lgkmcnt(0)
s_barrier
ds_read_b128 v[148:151], v202 offset:0
ds_read_b128 v[152:155], v202 offset:1024
ds_read_b128 v[156:159], v202 offset:2048
ds_read_b128 v[160:163], v202 offset:3072
ds_read_b64_tr_b16 v[84:85], v197 offset:0
ds_read_b64_tr_b16 v[86:87], v197 offset:4352
ds_read_b64_tr_b16 v[88:89], v197 offset:64
ds_read_b64_tr_b16 v[90:91], v197 offset:4416
ds_read_b64_tr_b16 v[92:93], v197 offset:128
ds_read_b64_tr_b16 v[94:95], v197 offset:4480
ds_read_b64_tr_b16 v[96:97], v197 offset:192
ds_read_b64_tr_b16 v[98:99], v197 offset:4544
ds_read_b64_tr_b16 v[100:101], v197 offset:17408
ds_read_b64_tr_b16 v[102:103], v197 offset:21760
ds_read_b64_tr_b16 v[104:105], v197 offset:17472
ds_read_b64_tr_b16 v[106:107], v197 offset:21824
ds_read_b64_tr_b16 v[108:109], v197 offset:17536
ds_read_b64_tr_b16 v[110:111], v197 offset:21888
ds_read_b64_tr_b16 v[112:113], v197 offset:17600
ds_read_b64_tr_b16 v[114:115], v197 offset:21952
ds_read_b64_tr_b16 v[116:117], v197 offset:34816
ds_read_b64_tr_b16 v[118:119], v197 offset:39168
ds_read_b64_tr_b16 v[120:121], v197 offset:34880
ds_read_b64_tr_b16 v[122:123], v197 offset:39232
ds_read_b64_tr_b16 v[124:125], v197 offset:34944
ds_read_b64_tr_b16 v[126:127], v197 offset:39296
ds_read_b64_tr_b16 v[128:129], v197 offset:35008
ds_read_b64_tr_b16 v[130:131], v197 offset:39360
ds_read_b64_tr_b16 v[132:133], v197 offset:52224
ds_read_b64_tr_b16 v[134:135], v197 offset:56576
ds_read_b64_tr_b16 v[136:137], v197 offset:52288
ds_read_b64_tr_b16 v[138:139], v197 offset:56640
ds_read_b64_tr_b16 v[140:141], v197 offset:52352
ds_read_b64_tr_b16 v[142:143], v197 offset:56704
ds_read_b64_tr_b16 v[144:145], v197 offset:52416
ds_read_b64_tr_b16 v[146:147], v197 offset:56768
s_waitcnt lgkmcnt(15)
v_mfma_f32_32x32x16_bf16 v[12:27], v[84:87], v[148:151], v[12:27]
v_mfma_f32_32x32x16_bf16 v[28:43], v[88:91], v[148:151], v[28:43]
s_add_u32 s6, s13, 3145728
buffer_load_dwordx4 a[128:131], v2, s[52:55], s6 offen nt
v_mfma_f32_32x32x16_bf16 v[44:59], v[92:95], v[148:151], v[44:59]
v_mfma_f32_32x32x16_bf16 v[60:75], v[96:99], v[148:151], v[60:75]
s_add_u32 s6, s13, 3146752
buffer_load_dwordx4 a[132:135], v2, s[52:55], s6 offen nt
s_waitcnt lgkmcnt(15)
v_mfma_f32_32x32x16_bf16 v[12:27], v[100:103], v[152:155], v[12:27]
v_mfma_f32_32x32x16_bf16 v[28:43], v[104:107], v[152:155], v[28:43]
s_add_u32 s6, s13, 3147776
buffer_load_dwordx4 a[136:139], v2, s[52:55], s6 offen nt
v_mfma_f32_32x32x16_bf16 v[44:59], v[108:111], v[152:155], v[44:59]
v_mfma_f32_32x32x16_bf16 v[60:75], v[112:115], v[152:155], v[60:75]
s_add_u32 s6, s13, 3148800
buffer_load_dwordx4 a[140:143], v2, s[52:55], s6 offen nt
s_waitcnt lgkmcnt(8)
v_mfma_f32_32x32x16_bf16 v[12:27], v[116:119], v[156:159], v[12:27]
v_mfma_f32_32x32x16_bf16 v[28:43], v[120:123], v[156:159], v[28:43]
s_add_u32 s6, s13, 3276800
buffer_load_dwordx4 a[144:147], v2, s[52:55], s6 offen nt
v_mfma_f32_32x32x16_bf16 v[44:59], v[124:127], v[156:159], v[44:59]
v_mfma_f32_32x32x16_bf16 v[60:75], v[128:131], v[156:159], v[60:75]
s_add_u32 s6, s13, 3277824
buffer_load_dwordx4 a[148:151], v2, s[52:55], s6 offen nt
s_waitcnt lgkmcnt(0)
v_mfma_f32_32x32x16_bf16 v[12:27], v[132:135], v[160:163], v[12:27]
v_mfma_f32_32x32x16_bf16 v[28:43], v[136:139], v[160:163], v[28:43]
s_add_u32 s6, s13, 3278848
buffer_load_dwordx4 a[152:155], v2, s[52:55], s6 offen nt
v_mfma_f32_32x32x16_bf16 v[44:59], v[140:143], v[160:163], v[44:59]
v_mfma_f32_32x32x16_bf16 v[60:75], v[144:147], v[160:163], v[60:75]
s_add_u32 s6, s13, 3279872
buffer_load_dwordx4 a[156:159], v2, s[52:55], s6 offen nt
ds_read_b128 v[84:87], v194 offset:0
ds_read_b128 v[88:91], v194 offset:64
ds_read_b128 v[92:95], v194 offset:128
ds_read_b128 v[96:99], v194 offset:192
ds_read_b128 v[100:103], v194 offset:256
ds_read_b128 v[104:107], v194 offset:320
ds_read_b128 v[108:111], v194 offset:384
ds_read_b128 v[112:115], v194 offset:448
ds_read_b128 v[116:119], v194 offset:512
ds_read_b128 v[120:123], v194 offset:576
ds_read_b128 v[124:127], v194 offset:640
ds_read_b128 v[128:131], v194 offset:704
ds_read_b128 v[132:135], v194 offset:768
ds_read_b128 v[136:139], v194 offset:832
ds_read_b128 v[140:143], v194 offset:896
ds_read_b128 v[144:147], v194 offset:960
s_waitcnt lgkmcnt(15)
v_mfma_f32_16x16x32_bf16 v[76:79], v[84:87], a[0:3], 0
v_mfma_f32_16x16x32_bf16 v[80:83], v[84:87], a[64:67], 0
s_waitcnt lgkmcnt(14)
v_mfma_f32_16x16x32_bf16 v[76:79], v[88:91], a[4:7], v[76:79]
v_mfma_f32_16x16x32_bf16 v[80:83], v[88:91], a[68:71], v[80:83]
s_add_u32 s6, s13, 3407872
buffer_load_dwordx4 a[160:163], v10, s[52:55], s6 offen nt
s_waitcnt lgkmcnt(13)
v_mfma_f32_16x16x32_bf16 v[76:79], v[92:95], a[8:11], v[76:79]
v_mfma_f32_16x16x32_bf16 v[80:83], v[92:95], a[72:75], v[80:83]
s_waitcnt lgkmcnt(12)
v_mfma_f32_16x16x32_bf16 v[76:79], v[96:99], a[12:15], v[76:79]
v_mfma_f32_16x16x32_bf16 v[80:83], v[96:99], a[76:79], v[80:83]
s_add_u32 s6, s13, 3408896
buffer_load_dwordx4 a[164:167], v10, s[52:55], s6 offen nt
s_waitcnt lgkmcnt(11)
v_mfma_f32_16x16x32_bf16 v[76:79], v[100:103], a[16:19], v[76:79]
v_mfma_f32_16x16x32_bf16 v[80:83], v[100:103], a[80:83], v[80:83]
s_waitcnt lgkmcnt(10)
v_mfma_f32_16x16x32_bf16 v[76:79], v[104:107], a[20:23], v[76:79]
v_mfma_f32_16x16x32_bf16 v[80:83], v[104:107], a[84:87], v[80:83]
s_add_u32 s6, s13, 3409920
buffer_load_dwordx4 a[168:171], v10, s[52:55], s6 offen nt
s_waitcnt lgkmcnt(9)
v_mfma_f32_16x16x32_bf16 v[76:79], v[108:111], a[24:27], v[76:79]
v_mfma_f32_16x16x32_bf16 v[80:83], v[108:111], a[88:91], v[80:83]
s_waitcnt lgkmcnt(8)
v_mfma_f32_16x16x32_bf16 v[76:79], v[112:115], a[28:31], v[76:79]
v_mfma_f32_16x16x32_bf16 v[80:83], v[112:115], a[92:95], v[80:83]
s_add_u32 s6, s13, 3410944
buffer_load_dwordx4 a[172:175], v10, s[52:55], s6 offen nt
s_waitcnt lgkmcnt(7)
v_mfma_f32_16x16x32_bf16 v[76:79], v[116:119], a[32:35], v[76:79]
v_mfma_f32_16x16x32_bf16 v[80:83], v[116:119], a[96:99], v[80:83]
s_waitcnt lgkmcnt(6)
v_mfma_f32_16x16x32_bf16 v[76:79], v[120:123], a[36:39], v[76:79]
v_mfma_f32_16x16x32_bf16 v[80:83], v[120:123], a[100:103], v[80:83]
s_add_u32 s6, s13, 3538944
buffer_load_dwordx4 a[176:179], v10, s[52:55], s6 offen nt
s_waitcnt lgkmcnt(5)
v_mfma_f32_16x16x32_bf16 v[76:79], v[124:127], a[40:43], v[76:79]
v_mfma_f32_16x16x32_bf16 v[80:83], v[124:127], a[104:107], v[80:83]
s_waitcnt lgkmcnt(4)
v_mfma_f32_16x16x32_bf16 v[76:79], v[128:131], a[44:47], v[76:79]
v_mfma_f32_16x16x32_bf16 v[80:83], v[128:131], a[108:111], v[80:83]
s_add_u32 s6, s13, 3539968
buffer_load_dwordx4 a[180:183], v10, s[52:55], s6 offen nt
s_waitcnt lgkmcnt(3)
v_mfma_f32_16x16x32_bf16 v[76:79], v[132:135], a[48:51], v[76:79]
v_mfma_f32_16x16x32_bf16 v[80:83], v[132:135], a[112:115], v[80:83]
s_waitcnt lgkmcnt(2)
v_mfma_f32_16x16x32_bf16 v[76:79], v[136:139], a[52:55], v[76:79]
v_mfma_f32_16x16x32_bf16 v[80:83], v[136:139], a[116:119], v[80:83]
s_add_u32 s6, s13, 3540992
buffer_load_dwordx4 a[184:187], v10, s[52:55], s6 offen nt
s_waitcnt lgkmcnt(1)
v_mfma_f32_16x16x32_bf16 v[76:79], v[140:143], a[56:59], v[76:79]
v_mfma_f32_16x16x32_bf16 v[80:83], v[140:143], a[120:123], v[80:83]
s_waitcnt lgkmcnt(0)
v_mfma_f32_16x16x32_bf16 v[76:79], v[144:147], a[60:63], v[76:79]
v_mfma_f32_16x16x32_bf16 v[80:83], v[144:147], a[124:127], v[80:83]
s_add_u32 s6, s13, 3542016
buffer_load_dwordx4 a[188:191], v10, s[52:55], s6 offen nt
s_nop 4
v_max_f32 v190, v76, v77
v_max3_f32 v190, v190, v78, v79
v_mov_b32 v192, v190
s_nop 1
v_permlane16_swap_b32 v190, v192
v_max_f32 v190, v190, v192
v_mov_b32 v192, v190
s_nop 1
v_permlane32_swap_b32 v190, v192
v_max_f32 v190, v190, v192
ds_write_b32 v198, v190 offset:0
v_max_f32 v191, v80, v81
v_max3_f32 v191, v191, v82, v83
v_mov_b32 v192, v191
s_nop 1
v_permlane16_swap_b32 v191, v192
v_max_f32 v191, v191, v192
v_mov_b32 v192, v191
s_nop 1
v_permlane32_swap_b32 v191, v192
v_max_f32 v191, v191, v192
ds_write_b32 v198, v191 offset:256
s_waitcnt lgkmcnt(0)
s_barrier
ds_read_b128 v[164:167], v199
ds_read_b128 v[168:171], v199 offset:256
ds_read_b128 v[172:175], v200
s_waitcnt vmcnt(16)
ds_write_b128 v207, a[192:195] offset:0
ds_write_b128 v207, a[196:199] offset:1088
ds_write_b128 v207, a[200:203] offset:2176
ds_write_b128 v207, a[204:207] offset:3264
ds_write_b128 v207, a[208:211] offset:4352
ds_write_b128 v207, a[212:215] offset:5440
ds_write_b128 v207, a[216:219] offset:6528
ds_write_b128 v207, a[220:223] offset:7616
ds_write_b128 v207, a[224:227] offset:8704
ds_write_b128 v207, a[228:231] offset:9792
ds_write_b128 v207, a[232:235] offset:10880
ds_write_b128 v207, a[236:239] offset:11968
ds_write_b128 v207, a[240:243] offset:13056
ds_write_b128 v207, a[244:247] offset:14144
ds_write_b128 v207, a[248:251] offset:15232
ds_write_b128 v207, a[252:255] offset:16320
s_waitcnt lgkmcnt(15)
v_max_f32 v164, v164, v165
v_max3_f32 v164, v164, v166, v167
v_mul_f32 v164, v164, v185
v_max_f32 v164, v164, v176
v_sub_f32 v182, v176, v164
v_exp_f32 v182, v182
v_mov_b32 v176, v164
v_max_f32 v168, v168, v169
v_max3_f32 v168, v168, v170, v171
v_mul_f32 v168, v168, v185
v_max_f32 v168, v168, v177
v_sub_f32 v183, v177, v168
v_exp_f32 v183, v183
v_mov_b32 v177, v168
v_max_f32 v172, v172, v173
v_max3_f32 v172, v172, v174, v175
v_mul_f32 v172, v172, v185
v_max_f32 v172, v172, v178
v_sub_f32 v184, v178, v172
v_exp_f32 v184, v184
v_mov_b32 v178, v172
v_fma_f32 v76, v76, v185, -v176
v_fma_f32 v77, v77, v185, -v176
v_fma_f32 v78, v78, v185, -v176
v_fma_f32 v79, v79, v185, -v176
v_exp_f32 v76, v76
v_exp_f32 v77, v77
v_exp_f32 v78, v78
v_exp_f32 v79, v79
v_mul_f32 v180, v180, v182
v_cvt_pk_bf16_f32 v186, v76, v77
v_cvt_pk_bf16_f32 v187, v78, v79
ds_write_b64 v201, v[186:187] offset:0
v_add_f32 v180, v180, v76
v_add_f32 v180, v180, v77
v_add_f32 v180, v180, v78
v_add_f32 v180, v180, v79
v_fma_f32 v80, v80, v185, -v177
v_fma_f32 v81, v81, v185, -v177
v_fma_f32 v82, v82, v185, -v177
v_fma_f32 v83, v83, v185, -v177
v_exp_f32 v80, v80
v_exp_f32 v81, v81
v_exp_f32 v82, v82
v_exp_f32 v83, v83
v_mul_f32 v181, v181, v183
v_cvt_pk_bf16_f32 v188, v80, v81
v_cvt_pk_bf16_f32 v189, v82, v83
ds_write_b64 v201, v[188:189] offset:512
v_add_f32 v181, v181, v80
v_add_f32 v181, v181, v81
v_add_f32 v181, v181, v82
v_add_f32 v181, v181, v83
v_mul_f32 v12, v12, v184
v_mul_f32 v13, v13, v184
v_mul_f32 v14, v14, v184
v_mul_f32 v15, v15, v184
v_mul_f32 v16, v16, v184
v_mul_f32 v17, v17, v184
v_mul_f32 v18, v18, v184
v_mul_f32 v19, v19, v184
v_mul_f32 v20, v20, v184
v_mul_f32 v21, v21, v184
v_mul_f32 v22, v22, v184
v_mul_f32 v23, v23, v184
v_mul_f32 v24, v24, v184
v_mul_f32 v25, v25, v184
v_mul_f32 v26, v26, v184
v_mul_f32 v27, v27, v184
v_mul_f32 v28, v28, v184
v_mul_f32 v29, v29, v184
v_mul_f32 v30, v30, v184
v_mul_f32 v31, v31, v184
v_mul_f32 v32, v32, v184
v_mul_f32 v33, v33, v184
v_mul_f32 v34, v34, v184
v_mul_f32 v35, v35, v184
v_mul_f32 v36, v36, v184
v_mul_f32 v37, v37, v184
v_mul_f32 v38, v38, v184
v_mul_f32 v39, v39, v184
v_mul_f32 v40, v40, v184
v_mul_f32 v41, v41, v184
v_mul_f32 v42, v42, v184
v_mul_f32 v43, v43, v184
v_mul_f32 v44, v44, v184
v_mul_f32 v45, v45, v184
v_mul_f32 v46, v46, v184
v_mul_f32 v47, v47, v184
v_mul_f32 v48, v48, v184
v_mul_f32 v49, v49, v184
v_mul_f32 v50, v50, v184
v_mul_f32 v51, v51, v184
v_mul_f32 v52, v52, v184
v_mul_f32 v53, v53, v184
v_mul_f32 v54, v54, v184
v_mul_f32 v55, v55, v184
v_mul_f32 v56, v56, v184
v_mul_f32 v57, v57, v184
v_mul_f32 v58, v58, v184
v_mul_f32 v59, v59, v184
v_mul_f32 v60, v60, v184
v_mul_f32 v61, v61, v184
v_mul_f32 v62, v62, v184
v_mul_f32 v63, v63, v184
v_mul_f32 v64, v64, v184
v_mul_f32 v65, v65, v184
v_mul_f32 v66, v66, v184
v_mul_f32 v67, v67, v184
v_mul_f32 v68, v68, v184
v_mul_f32 v69, v69, v184
v_mul_f32 v70, v70, v184
v_mul_f32 v71, v71, v184
v_mul_f32 v72, v72, v184
v_mul_f32 v73, v73, v184
v_mul_f32 v74, v74, v184
v_mul_f32 v75, v75, v184
s_waitcnt lgkmcnt(0)
s_barrier
ds_read_b128 v[148:151], v202 offset:0
ds_read_b128 v[152:155], v202 offset:1024
ds_read_b128 v[156:159], v202 offset:2048
ds_read_b128 v[160:163], v202 offset:3072
ds_read_b64_tr_b16 v[84:85], v196 offset:0
ds_read_b64_tr_b16 v[86:87], v196 offset:4352
ds_read_b64_tr_b16 v[88:89], v196 offset:64
ds_read_b64_tr_b16 v[90:91], v196 offset:4416
ds_read_b64_tr_b16 v[92:93], v196 offset:128
ds_read_b64_tr_b16 v[94:95], v196 offset:4480
ds_read_b64_tr_b16 v[96:97], v196 offset:192
ds_read_b64_tr_b16 v[98:99], v196 offset:4544
ds_read_b64_tr_b16 v[100:101], v196 offset:17408
ds_read_b64_tr_b16 v[102:103], v196 offset:21760
ds_read_b64_tr_b16 v[104:105], v196 offset:17472
ds_read_b64_tr_b16 v[106:107], v196 offset:21824
ds_read_b64_tr_b16 v[108:109], v196 offset:17536
ds_read_b64_tr_b16 v[110:111], v196 offset:21888
ds_read_b64_tr_b16 v[112:113], v196 offset:17600
ds_read_b64_tr_b16 v[114:115], v196 offset:21952
ds_read_b64_tr_b16 v[116:117], v196 offset:34816
ds_read_b64_tr_b16 v[118:119], v196 offset:39168
ds_read_b64_tr_b16 v[120:121], v196 offset:34880
ds_read_b64_tr_b16 v[122:123], v196 offset:39232
ds_read_b64_tr_b16 v[124:125], v196 offset:34944
ds_read_b64_tr_b16 v[126:127], v196 offset:39296
ds_read_b64_tr_b16 v[128:129], v196 offset:35008
ds_read_b64_tr_b16 v[130:131], v196 offset:39360
ds_read_b64_tr_b16 v[132:133], v196 offset:52224
ds_read_b64_tr_b16 v[134:135], v196 offset:56576
ds_read_b64_tr_b16 v[136:137], v196 offset:52288
ds_read_b64_tr_b16 v[138:139], v196 offset:56640
ds_read_b64_tr_b16 v[140:141], v196 offset:52352
ds_read_b64_tr_b16 v[142:143], v196 offset:56704
ds_read_b64_tr_b16 v[144:145], v196 offset:52416
ds_read_b64_tr_b16 v[146:147], v196 offset:56768
s_waitcnt lgkmcnt(15)
v_mfma_f32_32x32x16_bf16 v[12:27], v[84:87], v[148:151], v[12:27]
v_mfma_f32_32x32x16_bf16 v[28:43], v[88:91], v[148:151], v[28:43]
s_add_u32 s6, s13, 3670016
buffer_load_dwordx4 a[192:195], v2, s[52:55], s6 offen nt
v_mfma_f32_32x32x16_bf16 v[44:59], v[92:95], v[148:151], v[44:59]
v_mfma_f32_32x32x16_bf16 v[60:75], v[96:99], v[148:151], v[60:75]
s_add_u32 s6, s13, 3671040
buffer_load_dwordx4 a[196:199], v2, s[52:55], s6 offen nt
s_waitcnt lgkmcnt(15)
v_mfma_f32_32x32x16_bf16 v[12:27], v[100:103], v[152:155], v[12:27]
v_mfma_f32_32x32x16_bf16 v[28:43], v[104:107], v[152:155], v[28:43]
s_add_u32 s6, s13, 3672064
buffer_load_dwordx4 a[200:203], v2, s[52:55], s6 offen nt
v_mfma_f32_32x32x16_bf16 v[44:59], v[108:111], v[152:155], v[44:59]
v_mfma_f32_32x32x16_bf16 v[60:75], v[112:115], v[152:155], v[60:75]
s_add_u32 s6, s13, 3673088
buffer_load_dwordx4 a[204:207], v2, s[52:55], s6 offen nt
s_waitcnt lgkmcnt(8)
v_mfma_f32_32x32x16_bf16 v[12:27], v[116:119], v[156:159], v[12:27]
v_mfma_f32_32x32x16_bf16 v[28:43], v[120:123], v[156:159], v[28:43]
s_add_u32 s6, s13, 3801088
buffer_load_dwordx4 a[208:211], v2, s[52:55], s6 offen nt
v_mfma_f32_32x32x16_bf16 v[44:59], v[124:127], v[156:159], v[44:59]
v_mfma_f32_32x32x16_bf16 v[60:75], v[128:131], v[156:159], v[60:75]
s_add_u32 s6, s13, 3802112
buffer_load_dwordx4 a[212:215], v2, s[52:55], s6 offen nt
s_waitcnt lgkmcnt(0)
v_mfma_f32_32x32x16_bf16 v[12:27], v[132:135], v[160:163], v[12:27]
v_mfma_f32_32x32x16_bf16 v[28:43], v[136:139], v[160:163], v[28:43]
s_add_u32 s6, s13, 3803136
buffer_load_dwordx4 a[216:219], v2, s[52:55], s6 offen nt
v_mfma_f32_32x32x16_bf16 v[44:59], v[140:143], v[160:163], v[44:59]
v_mfma_f32_32x32x16_bf16 v[60:75], v[144:147], v[160:163], v[60:75]
s_add_u32 s6, s13, 3804160
buffer_load_dwordx4 a[220:223], v2, s[52:55], s6 offen nt
ds_read_b128 v[84:87], v195 offset:0
ds_read_b128 v[88:91], v195 offset:64
ds_read_b128 v[92:95], v195 offset:128
ds_read_b128 v[96:99], v195 offset:192
ds_read_b128 v[100:103], v195 offset:256
ds_read_b128 v[104:107], v195 offset:320
ds_read_b128 v[108:111], v195 offset:384
ds_read_b128 v[112:115], v195 offset:448
ds_read_b128 v[116:119], v195 offset:512
ds_read_b128 v[120:123], v195 offset:576
ds_read_b128 v[124:127], v195 offset:640
ds_read_b128 v[128:131], v195 offset:704
ds_read_b128 v[132:135], v195 offset:768
ds_read_b128 v[136:139], v195 offset:832
ds_read_b128 v[140:143], v195 offset:896
ds_read_b128 v[144:147], v195 offset:960
s_waitcnt lgkmcnt(15)
v_mfma_f32_16x16x32_bf16 v[76:79], v[84:87], a[0:3], 0
v_mfma_f32_16x16x32_bf16 v[80:83], v[84:87], a[64:67], 0
s_waitcnt lgkmcnt(14)
v_mfma_f32_16x16x32_bf16 v[76:79], v[88:91], a[4:7], v[76:79]
v_mfma_f32_16x16x32_bf16 v[80:83], v[88:91], a[68:71], v[80:83]
s_add_u32 s6, s13, 3932160
buffer_load_dwordx4 a[224:227], v10, s[52:55], s6 offen nt
s_waitcnt lgkmcnt(13)
v_mfma_f32_16x16x32_bf16 v[76:79], v[92:95], a[8:11], v[76:79]
v_mfma_f32_16x16x32_bf16 v[80:83], v[92:95], a[72:75], v[80:83]
s_waitcnt lgkmcnt(12)
v_mfma_f32_16x16x32_bf16 v[76:79], v[96:99], a[12:15], v[76:79]
v_mfma_f32_16x16x32_bf16 v[80:83], v[96:99], a[76:79], v[80:83]
s_add_u32 s6, s13, 3933184
buffer_load_dwordx4 a[228:231], v10, s[52:55], s6 offen nt
s_waitcnt lgkmcnt(11)
v_mfma_f32_16x16x32_bf16 v[76:79], v[100:103], a[16:19], v[76:79]
v_mfma_f32_16x16x32_bf16 v[80:83], v[100:103], a[80:83], v[80:83]
s_waitcnt lgkmcnt(10)
v_mfma_f32_16x16x32_bf16 v[76:79], v[104:107], a[20:23], v[76:79]
v_mfma_f32_16x16x32_bf16 v[80:83], v[104:107], a[84:87], v[80:83]
s_add_u32 s6, s13, 3934208
buffer_load_dwordx4 a[232:235], v10, s[52:55], s6 offen nt
s_waitcnt lgkmcnt(9)
v_mfma_f32_16x16x32_bf16 v[76:79], v[108:111], a[24:27], v[76:79]
v_mfma_f32_16x16x32_bf16 v[80:83], v[108:111], a[88:91], v[80:83]
s_waitcnt lgkmcnt(8)
v_mfma_f32_16x16x32_bf16 v[76:79], v[112:115], a[28:31], v[76:79]
v_mfma_f32_16x16x32_bf16 v[80:83], v[112:115], a[92:95], v[80:83]
s_add_u32 s6, s13, 3935232
buffer_load_dwordx4 a[236:239], v10, s[52:55], s6 offen nt
s_waitcnt lgkmcnt(7)
v_mfma_f32_16x16x32_bf16 v[76:79], v[116:119], a[32:35], v[76:79]
v_mfma_f32_16x16x32_bf16 v[80:83], v[116:119], a[96:99], v[80:83]
s_waitcnt lgkmcnt(6)
v_mfma_f32_16x16x32_bf16 v[76:79], v[120:123], a[36:39], v[76:79]
v_mfma_f32_16x16x32_bf16 v[80:83], v[120:123], a[100:103], v[80:83]
s_add_u32 s6, s13, 4063232
buffer_load_dwordx4 a[240:243], v10, s[52:55], s6 offen nt
s_waitcnt lgkmcnt(5)
v_mfma_f32_16x16x32_bf16 v[76:79], v[124:127], a[40:43], v[76:79]
v_mfma_f32_16x16x32_bf16 v[80:83], v[124:127], a[104:107], v[80:83]
s_waitcnt lgkmcnt(4)
v_mfma_f32_16x16x32_bf16 v[76:79], v[128:131], a[44:47], v[76:79]
v_mfma_f32_16x16x32_bf16 v[80:83], v[128:131], a[108:111], v[80:83]
s_add_u32 s6, s13, 4064256
buffer_load_dwordx4 a[244:247], v10, s[52:55], s6 offen nt
s_waitcnt lgkmcnt(3)
v_mfma_f32_16x16x32_bf16 v[76:79], v[132:135], a[48:51], v[76:79]
v_mfma_f32_16x16x32_bf16 v[80:83], v[132:135], a[112:115], v[80:83]
s_waitcnt lgkmcnt(2)
v_mfma_f32_16x16x32_bf16 v[76:79], v[136:139], a[52:55], v[76:79]
v_mfma_f32_16x16x32_bf16 v[80:83], v[136:139], a[116:119], v[80:83]
s_add_u32 s6, s13, 4065280
buffer_load_dwordx4 a[248:251], v10, s[52:55], s6 offen nt
s_waitcnt lgkmcnt(1)
v_mfma_f32_16x16x32_bf16 v[76:79], v[140:143], a[56:59], v[76:79]
v_mfma_f32_16x16x32_bf16 v[80:83], v[140:143], a[120:123], v[80:83]
s_waitcnt lgkmcnt(0)
v_mfma_f32_16x16x32_bf16 v[76:79], v[144:147], a[60:63], v[76:79]
v_mfma_f32_16x16x32_bf16 v[80:83], v[144:147], a[124:127], v[80:83]
s_add_u32 s6, s13, 4066304
buffer_load_dwordx4 a[252:255], v10, s[52:55], s6 offen nt
s_nop 4
v_max_f32 v190, v76, v77
v_max3_f32 v190, v190, v78, v79
v_mov_b32 v192, v190
s_nop 1
v_permlane16_swap_b32 v190, v192
v_max_f32 v190, v190, v192
v_mov_b32 v192, v190
s_nop 1
v_permlane32_swap_b32 v190, v192
v_max_f32 v190, v190, v192
ds_write_b32 v198, v190 offset:0
v_max_f32 v191, v80, v81
v_max3_f32 v191, v191, v82, v83
v_mov_b32 v192, v191
s_nop 1
v_permlane16_swap_b32 v191, v192
v_max_f32 v191, v191, v192
v_mov_b32 v192, v191
s_nop 1
v_permlane32_swap_b32 v191, v192
v_max_f32 v191, v191, v192
ds_write_b32 v198, v191 offset:256
s_waitcnt lgkmcnt(0)
s_barrier
ds_read_b128 v[164:167], v199
ds_read_b128 v[168:171], v199 offset:256
ds_read_b128 v[172:175], v200
s_waitcnt vmcnt(16)
ds_write_b128 v206, a[128:131] offset:0
ds_write_b128 v206, a[132:135] offset:1088
ds_write_b128 v206, a[136:139] offset:2176
ds_write_b128 v206, a[140:143] offset:3264
ds_write_b128 v206, a[144:147] offset:4352
ds_write_b128 v206, a[148:151] offset:5440
ds_write_b128 v206, a[152:155] offset:6528
ds_write_b128 v206, a[156:159] offset:7616
ds_write_b128 v206, a[160:163] offset:8704
ds_write_b128 v206, a[164:167] offset:9792
ds_write_b128 v206, a[168:171] offset:10880
ds_write_b128 v206, a[172:175] offset:11968
ds_write_b128 v206, a[176:179] offset:13056
ds_write_b128 v206, a[180:183] offset:14144
ds_write_b128 v206, a[184:187] offset:15232
ds_write_b128 v206, a[188:191] offset:16320
s_waitcnt lgkmcnt(15)
v_max_f32 v164, v164, v165
v_max3_f32 v164, v164, v166, v167
v_mul_f32 v164, v164, v185
v_max_f32 v164, v164, v176
v_sub_f32 v182, v176, v164
v_exp_f32 v182, v182
v_mov_b32 v176, v164
v_max_f32 v168, v168, v169
v_max3_f32 v168, v168, v170, v171
v_mul_f32 v168, v168, v185
v_max_f32 v168, v168, v177
v_sub_f32 v183, v177, v168
v_exp_f32 v183, v183
v_mov_b32 v177, v168
v_max_f32 v172, v172, v173
v_max3_f32 v172, v172, v174, v175
v_mul_f32 v172, v172, v185
v_max_f32 v172, v172, v178
v_sub_f32 v184, v178, v172
v_exp_f32 v184, v184
v_mov_b32 v178, v172
v_fma_f32 v76, v76, v185, -v176
v_fma_f32 v77, v77, v185, -v176
v_fma_f32 v78, v78, v185, -v176
v_fma_f32 v79, v79, v185, -v176
v_exp_f32 v76, v76
v_exp_f32 v77, v77
v_exp_f32 v78, v78
v_exp_f32 v79, v79
v_mul_f32 v180, v180, v182
v_cvt_pk_bf16_f32 v186, v76, v77
v_cvt_pk_bf16_f32 v187, v78, v79
ds_write_b64 v201, v[186:187] offset:0
v_add_f32 v180, v180, v76
v_add_f32 v180, v180, v77
v_add_f32 v180, v180, v78
v_add_f32 v180, v180, v79
v_fma_f32 v80, v80, v185, -v177
v_fma_f32 v81, v81, v185, -v177
v_fma_f32 v82, v82, v185, -v177
v_fma_f32 v83, v83, v185, -v177
v_exp_f32 v80, v80
v_exp_f32 v81, v81
v_exp_f32 v82, v82
v_exp_f32 v83, v83
v_mul_f32 v181, v181, v183
v_cvt_pk_bf16_f32 v188, v80, v81
v_cvt_pk_bf16_f32 v189, v82, v83
ds_write_b64 v201, v[188:189] offset:512
v_add_f32 v181, v181, v80
v_add_f32 v181, v181, v81
v_add_f32 v181, v181, v82
v_add_f32 v181, v181, v83
v_mul_f32 v12, v12, v184
v_mul_f32 v13, v13, v184
v_mul_f32 v14, v14, v184
v_mul_f32 v15, v15, v184
v_mul_f32 v16, v16, v184
v_mul_f32 v17, v17, v184
v_mul_f32 v18, v18, v184
v_mul_f32 v19, v19, v184
v_mul_f32 v20, v20, v184
v_mul_f32 v21, v21, v184
v_mul_f32 v22, v22, v184
v_mul_f32 v23, v23, v184
v_mul_f32 v24, v24, v184
v_mul_f32 v25, v25, v184
v_mul_f32 v26, v26, v184
v_mul_f32 v27, v27, v184
v_mul_f32 v28, v28, v184
v_mul_f32 v29, v29, v184
v_mul_f32 v30, v30, v184
v_mul_f32 v31, v31, v184
v_mul_f32 v32, v32, v184
v_mul_f32 v33, v33, v184
v_mul_f32 v34, v34, v184
v_mul_f32 v35, v35, v184
v_mul_f32 v36, v36, v184
v_mul_f32 v37, v37, v184
v_mul_f32 v38, v38, v184
v_mul_f32 v39, v39, v184
v_mul_f32 v40, v40, v184
v_mul_f32 v41, v41, v184
v_mul_f32 v42, v42, v184
v_mul_f32 v43, v43, v184
v_mul_f32 v44, v44, v184
v_mul_f32 v45, v45, v184
v_mul_f32 v46, v46, v184
v_mul_f32 v47, v47, v184
v_mul_f32 v48, v48, v184
v_mul_f32 v49, v49, v184
v_mul_f32 v50, v50, v184
v_mul_f32 v51, v51, v184
v_mul_f32 v52, v52, v184
v_mul_f32 v53, v53, v184
v_mul_f32 v54, v54, v184
v_mul_f32 v55, v55, v184
v_mul_f32 v56, v56, v184
v_mul_f32 v57, v57, v184
v_mul_f32 v58, v58, v184
v_mul_f32 v59, v59, v184
v_mul_f32 v60, v60, v184
v_mul_f32 v61, v61, v184
v_mul_f32 v62, v62, v184
v_mul_f32 v63, v63, v184
v_mul_f32 v64, v64, v184
v_mul_f32 v65, v65, v184
v_mul_f32 v66, v66, v184
v_mul_f32 v67, v67, v184
v_mul_f32 v68, v68, v184
v_mul_f32 v69, v69, v184
v_mul_f32 v70, v70, v184
v_mul_f32 v71, v71, v184
v_mul_f32 v72, v72, v184
v_mul_f32 v73, v73, v184
v_mul_f32 v74, v74, v184
v_mul_f32 v75, v75, v184
s_waitcnt lgkmcnt(0)
s_barrier
ds_read_b128 v[148:151], v202 offset:0
ds_read_b128 v[152:155], v202 offset:1024
ds_read_b128 v[156:159], v202 offset:2048
ds_read_b128 v[160:163], v202 offset:3072
ds_read_b64_tr_b16 v[84:85], v197 offset:0
ds_read_b64_tr_b16 v[86:87], v197 offset:4352
ds_read_b64_tr_b16 v[88:89], v197 offset:64
ds_read_b64_tr_b16 v[90:91], v197 offset:4416
ds_read_b64_tr_b16 v[92:93], v197 offset:128
ds_read_b64_tr_b16 v[94:95], v197 offset:4480
ds_read_b64_tr_b16 v[96:97], v197 offset:192
ds_read_b64_tr_b16 v[98:99], v197 offset:4544
ds_read_b64_tr_b16 v[100:101], v197 offset:17408
ds_read_b64_tr_b16 v[102:103], v197 offset:21760
ds_read_b64_tr_b16 v[104:105], v197 offset:17472
ds_read_b64_tr_b16 v[106:107], v197 offset:21824
ds_read_b64_tr_b16 v[108:109], v197 offset:17536
ds_read_b64_tr_b16 v[110:111], v197 offset:21888
ds_read_b64_tr_b16 v[112:113], v197 offset:17600
ds_read_b64_tr_b16 v[114:115], v197 offset:21952
ds_read_b64_tr_b16 v[116:117], v197 offset:34816
ds_read_b64_tr_b16 v[118:119], v197 offset:39168
ds_read_b64_tr_b16 v[120:121], v197 offset:34880
ds_read_b64_tr_b16 v[122:123], v197 offset:39232
ds_read_b64_tr_b16 v[124:125], v197 offset:34944
ds_read_b64_tr_b16 v[126:127], v197 offset:39296
ds_read_b64_tr_b16 v[128:129], v197 offset:35008
ds_read_b64_tr_b16 v[130:131], v197 offset:39360
ds_read_b64_tr_b16 v[132:133], v197 offset:52224
ds_read_b64_tr_b16 v[134:135], v197 offset:56576
ds_read_b64_tr_b16 v[136:137], v197 offset:52288
ds_read_b64_tr_b16 v[138:139], v197 offset:56640
ds_read_b64_tr_b16 v[140:141], v197 offset:52352
ds_read_b64_tr_b16 v[142:143], v197 offset:56704
ds_read_b64_tr_b16 v[144:145], v197 offset:52416
ds_read_b64_tr_b16 v[146:147], v197 offset:56768
s_waitcnt lgkmcnt(15)
v_mfma_f32_32x32x16_bf16 v[12:27], v[84:87], v[148:151], v[12:27]
v_mfma_f32_32x32x16_bf16 v[28:43], v[88:91], v[148:151], v[28:43]
v_mfma_f32_32x32x16_bf16 v[44:59], v[92:95], v[148:151], v[44:59]
v_mfma_f32_32x32x16_bf16 v[60:75], v[96:99], v[148:151], v[60:75]
s_waitcnt lgkmcnt(15)
v_mfma_f32_32x32x16_bf16 v[12:27], v[100:103], v[152:155], v[12:27]
v_mfma_f32_32x32x16_bf16 v[28:43], v[104:107], v[152:155], v[28:43]
v_mfma_f32_32x32x16_bf16 v[44:59], v[108:111], v[152:155], v[44:59]
v_mfma_f32_32x32x16_bf16 v[60:75], v[112:115], v[152:155], v[60:75]
s_waitcnt lgkmcnt(8)
v_mfma_f32_32x32x16_bf16 v[12:27], v[116:119], v[156:159], v[12:27]
v_mfma_f32_32x32x16_bf16 v[28:43], v[120:123], v[156:159], v[28:43]
v_mfma_f32_32x32x16_bf16 v[44:59], v[124:127], v[156:159], v[44:59]
v_mfma_f32_32x32x16_bf16 v[60:75], v[128:131], v[156:159], v[60:75]
s_waitcnt lgkmcnt(0)
v_mfma_f32_32x32x16_bf16 v[12:27], v[132:135], v[160:163], v[12:27]
v_mfma_f32_32x32x16_bf16 v[28:43], v[136:139], v[160:163], v[28:43]
v_mfma_f32_32x32x16_bf16 v[44:59], v[140:143], v[160:163], v[44:59]
v_mfma_f32_32x32x16_bf16 v[60:75], v[144:147], v[160:163], v[60:75]
ds_read_b128 v[84:87], v194 offset:0
ds_read_b128 v[88:91], v194 offset:64
ds_read_b128 v[92:95], v194 offset:128
ds_read_b128 v[96:99], v194 offset:192
ds_read_b128 v[100:103], v194 offset:256
ds_read_b128 v[104:107], v194 offset:320
ds_read_b128 v[108:111], v194 offset:384
ds_read_b128 v[112:115], v194 offset:448
ds_read_b128 v[116:119], v194 offset:512
ds_read_b128 v[120:123], v194 offset:576
ds_read_b128 v[124:127], v194 offset:640
ds_read_b128 v[128:131], v194 offset:704
ds_read_b128 v[132:135], v194 offset:768
ds_read_b128 v[136:139], v194 offset:832
ds_read_b128 v[140:143], v194 offset:896
ds_read_b128 v[144:147], v194 offset:960
s_waitcnt lgkmcnt(15)
v_mfma_f32_16x16x32_bf16 v[76:79], v[84:87], a[0:3], 0
v_mfma_f32_16x16x32_bf16 v[80:83], v[84:87], a[64:67], 0
s_waitcnt lgkmcnt(14)
v_mfma_f32_16x16x32_bf16 v[76:79], v[88:91], a[4:7], v[76:79]
v_mfma_f32_16x16x32_bf16 v[80:83], v[88:91], a[68:71], v[80:83]
s_waitcnt lgkmcnt(13)
v_mfma_f32_16x16x32_bf16 v[76:79], v[92:95], a[8:11], v[76:79]
v_mfma_f32_16x16x32_bf16 v[80:83], v[92:95], a[72:75], v[80:83]
s_waitcnt lgkmcnt(12)
v_mfma_f32_16x16x32_bf16 v[76:79], v[96:99], a[12:15], v[76:79]
v_mfma_f32_16x16x32_bf16 v[80:83], v[96:99], a[76:79], v[80:83]
s_waitcnt lgkmcnt(11)
v_mfma_f32_16x16x32_bf16 v[76:79], v[100:103], a[16:19], v[76:79]
v_mfma_f32_16x16x32_bf16 v[80:83], v[100:103], a[80:83], v[80:83]
s_waitcnt lgkmcnt(10)
v_mfma_f32_16x16x32_bf16 v[76:79], v[104:107], a[20:23], v[76:79]
v_mfma_f32_16x16x32_bf16 v[80:83], v[104:107], a[84:87], v[80:83]
s_waitcnt lgkmcnt(9)
v_mfma_f32_16x16x32_bf16 v[76:79], v[108:111], a[24:27], v[76:79]
v_mfma_f32_16x16x32_bf16 v[80:83], v[108:111], a[88:91], v[80:83]
s_waitcnt lgkmcnt(8)
v_mfma_f32_16x16x32_bf16 v[76:79], v[112:115], a[28:31], v[76:79]
v_mfma_f32_16x16x32_bf16 v[80:83], v[112:115], a[92:95], v[80:83]
s_waitcnt lgkmcnt(7)
v_mfma_f32_16x16x32_bf16 v[76:79], v[116:119], a[32:35], v[76:79]
v_mfma_f32_16x16x32_bf16 v[80:83], v[116:119], a[96:99], v[80:83]
s_waitcnt lgkmcnt(6)
v_mfma_f32_16x16x32_bf16 v[76:79], v[120:123], a[36:39], v[76:79]
v_mfma_f32_16x16x32_bf16 v[80:83], v[120:123], a[100:103], v[80:83]
s_waitcnt lgkmcnt(5)
v_mfma_f32_16x16x32_bf16 v[76:79], v[124:127], a[40:43], v[76:79]
v_mfma_f32_16x16x32_bf16 v[80:83], v[124:127], a[104:107], v[80:83]
s_waitcnt lgkmcnt(4)
v_mfma_f32_16x16x32_bf16 v[76:79], v[128:131], a[44:47], v[76:79]
v_mfma_f32_16x16x32_bf16 v[80:83], v[128:131], a[108:111], v[80:83]
s_waitcnt lgkmcnt(3)
v_mfma_f32_16x16x32_bf16 v[76:79], v[132:135], a[48:51], v[76:79]
v_mfma_f32_16x16x32_bf16 v[80:83], v[132:135], a[112:115], v[80:83]
s_waitcnt lgkmcnt(2)
v_mfma_f32_16x16x32_bf16 v[76:79], v[136:139], a[52:55], v[76:79]
v_mfma_f32_16x16x32_bf16 v[80:83], v[136:139], a[116:119], v[80:83]
s_waitcnt lgkmcnt(1)
v_mfma_f32_16x16x32_bf16 v[76:79], v[140:143], a[56:59], v[76:79]
v_mfma_f32_16x16x32_bf16 v[80:83], v[140:143], a[120:123], v[80:83]
s_waitcnt lgkmcnt(0)
v_mfma_f32_16x16x32_bf16 v[76:79], v[144:147], a[60:63], v[76:79]
v_mfma_f32_16x16x32_bf16 v[80:83], v[144:147], a[124:127], v[80:83]
s_nop 6
v_max_f32 v190, v76, v77
v_max3_f32 v190, v190, v78, v79
v_mov_b32 v192, v190
s_nop 1
v_permlane16_swap_b32 v190, v192
v_max_f32 v190, v190, v192
v_mov_b32 v192, v190
s_nop 1
v_permlane32_swap_b32 v190, v192
v_max_f32 v190, v190, v192
ds_write_b32 v198, v190 offset:0
v_max_f32 v191, v80, v81
v_max3_f32 v191, v191, v82, v83
v_mov_b32 v192, v191
s_nop 1
v_permlane16_swap_b32 v191, v192
v_max_f32 v191, v191, v192
v_mov_b32 v192, v191
s_nop 1
v_permlane32_swap_b32 v191, v192
v_max_f32 v191, v191, v192
ds_write_b32 v198, v191 offset:256
s_waitcnt lgkmcnt(0)
s_barrier
ds_read_b128 v[164:167], v199
ds_read_b128 v[168:171], v199 offset:256
ds_read_b128 v[172:175], v200
s_waitcnt vmcnt(0)
ds_write_b128 v207, a[192:195] offset:0
ds_write_b128 v207, a[196:199] offset:1088
ds_write_b128 v207, a[200:203] offset:2176
ds_write_b128 v207, a[204:207] offset:3264
ds_write_b128 v207, a[208:211] offset:4352
ds_write_b128 v207, a[212:215] offset:5440
ds_write_b128 v207, a[216:219] offset:6528
ds_write_b128 v207, a[220:223] offset:7616
ds_write_b128 v207, a[224:227] offset:8704
ds_write_b128 v207, a[228:231] offset:9792
ds_write_b128 v207, a[232:235] offset:10880
ds_write_b128 v207, a[236:239] offset:11968
ds_write_b128 v207, a[240:243] offset:13056
ds_write_b128 v207, a[244:247] offset:14144
ds_write_b128 v207, a[248:251] offset:15232
ds_write_b128 v207, a[252:255] offset:16320
s_waitcnt lgkmcnt(15)
v_max_f32 v164, v164, v165
v_max3_f32 v164, v164, v166, v167
v_mul_f32 v164, v164, v185
v_max_f32 v164, v164, v176
v_sub_f32 v182, v176, v164
v_exp_f32 v182, v182
v_mov_b32 v176, v164
v_max_f32 v168, v168, v169
v_max3_f32 v168, v168, v170, v171
v_mul_f32 v168, v168, v185
v_max_f32 v168, v168, v177
v_sub_f32 v183, v177, v168
v_exp_f32 v183, v183
v_mov_b32 v177, v168
v_max_f32 v172, v172, v173
v_max3_f32 v172, v172, v174, v175
v_mul_f32 v172, v172, v185
v_max_f32 v172, v172, v178
v_sub_f32 v184, v178, v172
v_exp_f32 v184, v184
v_mov_b32 v178, v172
v_fma_f32 v76, v76, v185, -v176
v_fma_f32 v77, v77, v185, -v176
v_fma_f32 v78, v78, v185, -v176
v_fma_f32 v79, v79, v185, -v176
v_exp_f32 v76, v76
v_exp_f32 v77, v77
v_exp_f32 v78, v78
v_exp_f32 v79, v79
v_mul_f32 v180, v180, v182
v_cvt_pk_bf16_f32 v186, v76, v77
v_cvt_pk_bf16_f32 v187, v78, v79
ds_write_b64 v201, v[186:187] offset:0
v_add_f32 v180, v180, v76
v_add_f32 v180, v180, v77
v_add_f32 v180, v180, v78
v_add_f32 v180, v180, v79
v_fma_f32 v80, v80, v185, -v177
v_fma_f32 v81, v81, v185, -v177
v_fma_f32 v82, v82, v185, -v177
v_fma_f32 v83, v83, v185, -v177
v_exp_f32 v80, v80
v_exp_f32 v81, v81
v_exp_f32 v82, v82
v_exp_f32 v83, v83
v_mul_f32 v181, v181, v183
v_cvt_pk_bf16_f32 v188, v80, v81
v_cvt_pk_bf16_f32 v189, v82, v83
ds_write_b64 v201, v[188:189] offset:512
v_add_f32 v181, v181, v80
v_add_f32 v181, v181, v81
v_add_f32 v181, v181, v82
v_add_f32 v181, v181, v83
v_mul_f32 v12, v12, v184
v_mul_f32 v13, v13, v184
v_mul_f32 v14, v14, v184
v_mul_f32 v15, v15, v184
v_mul_f32 v16, v16, v184
v_mul_f32 v17, v17, v184
v_mul_f32 v18, v18, v184
v_mul_f32 v19, v19, v184
v_mul_f32 v20, v20, v184
v_mul_f32 v21, v21, v184
v_mul_f32 v22, v22, v184
v_mul_f32 v23, v23, v184
v_mul_f32 v24, v24, v184
v_mul_f32 v25, v25, v184
v_mul_f32 v26, v26, v184
v_mul_f32 v27, v27, v184
v_mul_f32 v28, v28, v184
v_mul_f32 v29, v29, v184
v_mul_f32 v30, v30, v184
v_mul_f32 v31, v31, v184
v_mul_f32 v32, v32, v184
v_mul_f32 v33, v33, v184
v_mul_f32 v34, v34, v184
v_mul_f32 v35, v35, v184
v_mul_f32 v36, v36, v184
v_mul_f32 v37, v37, v184
v_mul_f32 v38, v38, v184
v_mul_f32 v39, v39, v184
v_mul_f32 v40, v40, v184
v_mul_f32 v41, v41, v184
v_mul_f32 v42, v42, v184
v_mul_f32 v43, v43, v184
v_mul_f32 v44, v44, v184
v_mul_f32 v45, v45, v184
v_mul_f32 v46, v46, v184
v_mul_f32 v47, v47, v184
v_mul_f32 v48, v48, v184
v_mul_f32 v49, v49, v184
v_mul_f32 v50, v50, v184
v_mul_f32 v51, v51, v184
v_mul_f32 v52, v52, v184
v_mul_f32 v53, v53, v184
v_mul_f32 v54, v54, v184
v_mul_f32 v55, v55, v184
v_mul_f32 v56, v56, v184
v_mul_f32 v57, v57, v184
v_mul_f32 v58, v58, v184
v_mul_f32 v59, v59, v184
v_mul_f32 v60, v60, v184
v_mul_f32 v61, v61, v184
v_mul_f32 v62, v62, v184
v_mul_f32 v63, v63, v184
v_mul_f32 v64, v64, v184
v_mul_f32 v65, v65, v184
v_mul_f32 v66, v66, v184
v_mul_f32 v67, v67, v184
v_mul_f32 v68, v68, v184
v_mul_f32 v69, v69, v184
v_mul_f32 v70, v70, v184
v_mul_f32 v71, v71, v184
v_mul_f32 v72, v72, v184
v_mul_f32 v73, v73, v184
v_mul_f32 v74, v74, v184
v_mul_f32 v75, v75, v184
s_waitcnt lgkmcnt(0)
s_barrier
ds_read_b128 v[148:151], v202 offset:0
ds_read_b128 v[152:155], v202 offset:1024
ds_read_b128 v[156:159], v202 offset:2048
ds_read_b128 v[160:163], v202 offset:3072
ds_read_b64_tr_b16 v[84:85], v196 offset:0
ds_read_b64_tr_b16 v[86:87], v196 offset:4352
ds_read_b64_tr_b16 v[88:89], v196 offset:64
ds_read_b64_tr_b16 v[90:91], v196 offset:4416
ds_read_b64_tr_b16 v[92:93], v196 offset:128
ds_read_b64_tr_b16 v[94:95], v196 offset:4480
ds_read_b64_tr_b16 v[96:97], v196 offset:192
ds_read_b64_tr_b16 v[98:99], v196 offset:4544
ds_read_b64_tr_b16 v[100:101], v196 offset:17408
ds_read_b64_tr_b16 v[102:103], v196 offset:21760
ds_read_b64_tr_b16 v[104:105], v196 offset:17472
ds_read_b64_tr_b16 v[106:107], v196 offset:21824
ds_read_b64_tr_b16 v[108:109], v196 offset:17536
ds_read_b64_tr_b16 v[110:111], v196 offset:21888
ds_read_b64_tr_b16 v[112:113], v196 offset:17600
ds_read_b64_tr_b16 v[114:115], v196 offset:21952
ds_read_b64_tr_b16 v[116:117], v196 offset:34816
ds_read_b64_tr_b16 v[118:119], v196 offset:39168
ds_read_b64_tr_b16 v[120:121], v196 offset:34880
ds_read_b64_tr_b16 v[122:123], v196 offset:39232
ds_read_b64_tr_b16 v[124:125], v196 offset:34944
ds_read_b64_tr_b16 v[126:127], v196 offset:39296
ds_read_b64_tr_b16 v[128:129], v196 offset:35008
ds_read_b64_tr_b16 v[130:131], v196 offset:39360
ds_read_b64_tr_b16 v[132:133], v196 offset:52224
ds_read_b64_tr_b16 v[134:135], v196 offset:56576
ds_read_b64_tr_b16 v[136:137], v196 offset:52288
ds_read_b64_tr_b16 v[138:139], v196 offset:56640
ds_read_b64_tr_b16 v[140:141], v196 offset:52352
ds_read_b64_tr_b16 v[142:143], v196 offset:56704
ds_read_b64_tr_b16 v[144:145], v196 offset:52416
ds_read_b64_tr_b16 v[146:147], v196 offset:56768
s_waitcnt lgkmcnt(15)
v_mfma_f32_32x32x16_bf16 v[12:27], v[84:87], v[148:151], v[12:27]
v_mfma_f32_32x32x16_bf16 v[28:43], v[88:91], v[148:151], v[28:43]
v_mfma_f32_32x32x16_bf16 v[44:59], v[92:95], v[148:151], v[44:59]
v_mfma_f32_32x32x16_bf16 v[60:75], v[96:99], v[148:151], v[60:75]
s_waitcnt lgkmcnt(15)
v_mfma_f32_32x32x16_bf16 v[12:27], v[100:103], v[152:155], v[12:27]
v_mfma_f32_32x32x16_bf16 v[28:43], v[104:107], v[152:155], v[28:43]
v_mfma_f32_32x32x16_bf16 v[44:59], v[108:111], v[152:155], v[44:59]
v_mfma_f32_32x32x16_bf16 v[60:75], v[112:115], v[152:155], v[60:75]
s_waitcnt lgkmcnt(8)
v_mfma_f32_32x32x16_bf16 v[12:27], v[116:119], v[156:159], v[12:27]
v_mfma_f32_32x32x16_bf16 v[28:43], v[120:123], v[156:159], v[28:43]
v_mfma_f32_32x32x16_bf16 v[44:59], v[124:127], v[156:159], v[44:59]
v_mfma_f32_32x32x16_bf16 v[60:75], v[128:131], v[156:159], v[60:75]
s_waitcnt lgkmcnt(0)
v_mfma_f32_32x32x16_bf16 v[12:27], v[132:135], v[160:163], v[12:27]
v_mfma_f32_32x32x16_bf16 v[28:43], v[136:139], v[160:163], v[28:43]
v_mfma_f32_32x32x16_bf16 v[44:59], v[140:143], v[160:163], v[44:59]
v_mfma_f32_32x32x16_bf16 v[60:75], v[144:147], v[160:163], v[60:75]
ds_read_b128 v[84:87], v195 offset:0
ds_read_b128 v[88:91], v195 offset:64
ds_read_b128 v[92:95], v195 offset:128
ds_read_b128 v[96:99], v195 offset:192
ds_read_b128 v[100:103], v195 offset:256
ds_read_b128 v[104:107], v195 offset:320
ds_read_b128 v[108:111], v195 offset:384
ds_read_b128 v[112:115], v195 offset:448
ds_read_b128 v[116:119], v195 offset:512
ds_read_b128 v[120:123], v195 offset:576
ds_read_b128 v[124:127], v195 offset:640
ds_read_b128 v[128:131], v195 offset:704
ds_read_b128 v[132:135], v195 offset:768
ds_read_b128 v[136:139], v195 offset:832
ds_read_b128 v[140:143], v195 offset:896
ds_read_b128 v[144:147], v195 offset:960
s_waitcnt lgkmcnt(15)
v_mfma_f32_16x16x32_bf16 v[76:79], v[84:87], a[0:3], 0
v_mfma_f32_16x16x32_bf16 v[80:83], v[84:87], a[64:67], 0
s_waitcnt lgkmcnt(14)
v_mfma_f32_16x16x32_bf16 v[76:79], v[88:91], a[4:7], v[76:79]
v_mfma_f32_16x16x32_bf16 v[80:83], v[88:91], a[68:71], v[80:83]
s_waitcnt lgkmcnt(13)
v_mfma_f32_16x16x32_bf16 v[76:79], v[92:95], a[8:11], v[76:79]
v_mfma_f32_16x16x32_bf16 v[80:83], v[92:95], a[72:75], v[80:83]
s_waitcnt lgkmcnt(12)
v_mfma_f32_16x16x32_bf16 v[76:79], v[96:99], a[12:15], v[76:79]
v_mfma_f32_16x16x32_bf16 v[80:83], v[96:99], a[76:79], v[80:83]
s_waitcnt lgkmcnt(11)
v_mfma_f32_16x16x32_bf16 v[76:79], v[100:103], a[16:19], v[76:79]
v_mfma_f32_16x16x32_bf16 v[80:83], v[100:103], a[80:83], v[80:83]
s_waitcnt lgkmcnt(10)
v_mfma_f32_16x16x32_bf16 v[76:79], v[104:107], a[20:23], v[76:79]
v_mfma_f32_16x16x32_bf16 v[80:83], v[104:107], a[84:87], v[80:83]
s_waitcnt lgkmcnt(9)
v_mfma_f32_16x16x32_bf16 v[76:79], v[108:111], a[24:27], v[76:79]
v_mfma_f32_16x16x32_bf16 v[80:83], v[108:111], a[88:91], v[80:83]
s_waitcnt lgkmcnt(8)
v_mfma_f32_16x16x32_bf16 v[76:79], v[112:115], a[28:31], v[76:79]
v_mfma_f32_16x16x32_bf16 v[80:83], v[112:115], a[92:95], v[80:83]
s_waitcnt lgkmcnt(7)
v_mfma_f32_16x16x32_bf16 v[76:79], v[116:119], a[32:35], v[76:79]
v_mfma_f32_16x16x32_bf16 v[80:83], v[116:119], a[96:99], v[80:83]
s_waitcnt lgkmcnt(6)
v_mfma_f32_16x16x32_bf16 v[76:79], v[120:123], a[36:39], v[76:79]
v_mfma_f32_16x16x32_bf16 v[80:83], v[120:123], a[100:103], v[80:83]
s_waitcnt lgkmcnt(5)
v_mfma_f32_16x16x32_bf16 v[76:79], v[124:127], a[40:43], v[76:79]
v_mfma_f32_16x16x32_bf16 v[80:83], v[124:127], a[104:107], v[80:83]
s_waitcnt lgkmcnt(4)
v_mfma_f32_16x16x32_bf16 v[76:79], v[128:131], a[44:47], v[76:79]
v_mfma_f32_16x16x32_bf16 v[80:83], v[128:131], a[108:111], v[80:83]
s_waitcnt lgkmcnt(3)
v_mfma_f32_16x16x32_bf16 v[76:79], v[132:135], a[48:51], v[76:79]
v_mfma_f32_16x16x32_bf16 v[80:83], v[132:135], a[112:115], v[80:83]
s_waitcnt lgkmcnt(2)
v_mfma_f32_16x16x32_bf16 v[76:79], v[136:139], a[52:55], v[76:79]
v_mfma_f32_16x16x32_bf16 v[80:83], v[136:139], a[116:119], v[80:83]
s_waitcnt lgkmcnt(1)
v_mfma_f32_16x16x32_bf16 v[76:79], v[140:143], a[56:59], v[76:79]
v_mfma_f32_16x16x32_bf16 v[80:83], v[140:143], a[120:123], v[80:83]
s_waitcnt lgkmcnt(0)
v_mfma_f32_16x16x32_bf16 v[76:79], v[144:147], a[60:63], v[76:79]
v_mfma_f32_16x16x32_bf16 v[80:83], v[144:147], a[124:127], v[80:83]
s_nop 6
v_max_f32 v190, v76, v77
v_max3_f32 v190, v190, v78, v79
v_mov_b32 v192, v190
s_nop 1
v_permlane16_swap_b32 v190, v192
v_max_f32 v190, v190, v192
v_mov_b32 v192, v190
s_nop 1
v_permlane32_swap_b32 v190, v192
v_max_f32 v190, v190, v192
ds_write_b32 v198, v190 offset:0
v_max_f32 v191, v80, v81
v_max3_f32 v191, v191, v82, v83
v_mov_b32 v192, v191
s_nop 1
v_permlane16_swap_b32 v191, v192
v_max_f32 v191, v191, v192
v_mov_b32 v192, v191
s_nop 1
v_permlane32_swap_b32 v191, v192
v_max_f32 v191, v191, v192
ds_write_b32 v198, v191 offset:256
s_waitcnt lgkmcnt(0)
s_barrier
ds_read_b128 v[164:167], v199
ds_read_b128 v[168:171], v199 offset:256
ds_read_b128 v[172:175], v200
s_waitcnt lgkmcnt(0)
v_max_f32 v164, v164, v165
v_max3_f32 v164, v164, v166, v167
v_mul_f32 v164, v164, v185
v_max_f32 v164, v164, v176
v_sub_f32 v182, v176, v164
v_exp_f32 v182, v182
v_mov_b32 v176, v164
v_max_f32 v168, v168, v169
v_max3_f32 v168, v168, v170, v171
v_mul_f32 v168, v168, v185
v_max_f32 v168, v168, v177
v_sub_f32 v183, v177, v168
v_exp_f32 v183, v183
v_mov_b32 v177, v168
v_max_f32 v172, v172, v173
v_max3_f32 v172, v172, v174, v175
v_mul_f32 v172, v172, v185
v_max_f32 v172, v172, v178
v_sub_f32 v184, v178, v172
v_exp_f32 v184, v184
v_mov_b32 v178, v172
v_fma_f32 v76, v76, v185, -v176
v_fma_f32 v77, v77, v185, -v176
v_fma_f32 v78, v78, v185, -v176
v_fma_f32 v79, v79, v185, -v176
v_exp_f32 v76, v76
v_exp_f32 v77, v77
v_exp_f32 v78, v78
v_exp_f32 v79, v79
v_mul_f32 v180, v180, v182
v_cvt_pk_bf16_f32 v186, v76, v77
v_cvt_pk_bf16_f32 v187, v78, v79
ds_write_b64 v201, v[186:187] offset:0
v_add_f32 v180, v180, v76
v_add_f32 v180, v180, v77
v_add_f32 v180, v180, v78
v_add_f32 v180, v180, v79
v_fma_f32 v80, v80, v185, -v177
v_fma_f32 v81, v81, v185, -v177
v_fma_f32 v82, v82, v185, -v177
v_fma_f32 v83, v83, v185, -v177
v_exp_f32 v80, v80
v_exp_f32 v81, v81
v_exp_f32 v82, v82
v_exp_f32 v83, v83
v_mul_f32 v181, v181, v183
v_cvt_pk_bf16_f32 v188, v80, v81
v_cvt_pk_bf16_f32 v189, v82, v83
ds_write_b64 v201, v[188:189] offset:512
v_add_f32 v181, v181, v80
v_add_f32 v181, v181, v81
v_add_f32 v181, v181, v82
v_add_f32 v181, v181, v83
v_mul_f32 v12, v12, v184
v_mul_f32 v13, v13, v184
v_mul_f32 v14, v14, v184
v_mul_f32 v15, v15, v184
v_mul_f32 v16, v16, v184
v_mul_f32 v17, v17, v184
v_mul_f32 v18, v18, v184
v_mul_f32 v19, v19, v184
v_mul_f32 v20, v20, v184
v_mul_f32 v21, v21, v184
v_mul_f32 v22, v22, v184
v_mul_f32 v23, v23, v184
v_mul_f32 v24, v24, v184
v_mul_f32 v25, v25, v184
v_mul_f32 v26, v26, v184
v_mul_f32 v27, v27, v184
v_mul_f32 v28, v28, v184
v_mul_f32 v29, v29, v184
v_mul_f32 v30, v30, v184
v_mul_f32 v31, v31, v184
v_mul_f32 v32, v32, v184
v_mul_f32 v33, v33, v184
v_mul_f32 v34, v34, v184
v_mul_f32 v35, v35, v184
v_mul_f32 v36, v36, v184
v_mul_f32 v37, v37, v184
v_mul_f32 v38, v38, v184
v_mul_f32 v39, v39, v184
v_mul_f32 v40, v40, v184
v_mul_f32 v41, v41, v184
v_mul_f32 v42, v42, v184
v_mul_f32 v43, v43, v184
v_mul_f32 v44, v44, v184
v_mul_f32 v45, v45, v184
v_mul_f32 v46, v46, v184
v_mul_f32 v47, v47, v184
v_mul_f32 v48, v48, v184
v_mul_f32 v49, v49, v184
v_mul_f32 v50, v50, v184
v_mul_f32 v51, v51, v184
v_mul_f32 v52, v52, v184
v_mul_f32 v53, v53, v184
v_mul_f32 v54, v54, v184
v_mul_f32 v55, v55, v184
v_mul_f32 v56, v56, v184
v_mul_f32 v57, v57, v184
v_mul_f32 v58, v58, v184
v_mul_f32 v59, v59, v184
v_mul_f32 v60, v60, v184
v_mul_f32 v61, v61, v184
v_mul_f32 v62, v62, v184
v_mul_f32 v63, v63, v184
v_mul_f32 v64, v64, v184
v_mul_f32 v65, v65, v184
v_mul_f32 v66, v66, v184
v_mul_f32 v67, v67, v184
v_mul_f32 v68, v68, v184
v_mul_f32 v69, v69, v184
v_mul_f32 v70, v70, v184
v_mul_f32 v71, v71, v184
v_mul_f32 v72, v72, v184
v_mul_f32 v73, v73, v184
v_mul_f32 v74, v74, v184
v_mul_f32 v75, v75, v184
s_waitcnt lgkmcnt(0)
s_barrier
ds_read_b128 v[148:151], v202 offset:0
ds_read_b128 v[152:155], v202 offset:1024
ds_read_b128 v[156:159], v202 offset:2048
ds_read_b128 v[160:163], v202 offset:3072
ds_read_b64_tr_b16 v[84:85], v197 offset:0
ds_read_b64_tr_b16 v[86:87], v197 offset:4352
ds_read_b64_tr_b16 v[88:89], v197 offset:64
ds_read_b64_tr_b16 v[90:91], v197 offset:4416
ds_read_b64_tr_b16 v[92:93], v197 offset:128
ds_read_b64_tr_b16 v[94:95], v197 offset:4480
ds_read_b64_tr_b16 v[96:97], v197 offset:192
ds_read_b64_tr_b16 v[98:99], v197 offset:4544
ds_read_b64_tr_b16 v[100:101], v197 offset:17408
ds_read_b64_tr_b16 v[102:103], v197 offset:21760
ds_read_b64_tr_b16 v[104:105], v197 offset:17472
ds_read_b64_tr_b16 v[106:107], v197 offset:21824
ds_read_b64_tr_b16 v[108:109], v197 offset:17536
ds_read_b64_tr_b16 v[110:111], v197 offset:21888
ds_read_b64_tr_b16 v[112:113], v197 offset:17600
ds_read_b64_tr_b16 v[114:115], v197 offset:21952
ds_read_b64_tr_b16 v[116:117], v197 offset:34816
ds_read_b64_tr_b16 v[118:119], v197 offset:39168
ds_read_b64_tr_b16 v[120:121], v197 offset:34880
ds_read_b64_tr_b16 v[122:123], v197 offset:39232
ds_read_b64_tr_b16 v[124:125], v197 offset:34944
ds_read_b64_tr_b16 v[126:127], v197 offset:39296
ds_read_b64_tr_b16 v[128:129], v197 offset:35008
ds_read_b64_tr_b16 v[130:131], v197 offset:39360
ds_read_b64_tr_b16 v[132:133], v197 offset:52224
ds_read_b64_tr_b16 v[134:135], v197 offset:56576
ds_read_b64_tr_b16 v[136:137], v197 offset:52288
ds_read_b64_tr_b16 v[138:139], v197 offset:56640
ds_read_b64_tr_b16 v[140:141], v197 offset:52352
ds_read_b64_tr_b16 v[142:143], v197 offset:56704
ds_read_b64_tr_b16 v[144:145], v197 offset:52416
ds_read_b64_tr_b16 v[146:147], v197 offset:56768
s_waitcnt lgkmcnt(15)
v_mfma_f32_32x32x16_bf16 v[12:27], v[84:87], v[148:151], v[12:27]
v_mfma_f32_32x32x16_bf16 v[28:43], v[88:91], v[148:151], v[28:43]
v_mfma_f32_32x32x16_bf16 v[44:59], v[92:95], v[148:151], v[44:59]
v_mfma_f32_32x32x16_bf16 v[60:75], v[96:99], v[148:151], v[60:75]
s_waitcnt lgkmcnt(15)
v_mfma_f32_32x32x16_bf16 v[12:27], v[100:103], v[152:155], v[12:27]
v_mfma_f32_32x32x16_bf16 v[28:43], v[104:107], v[152:155], v[28:43]
v_mfma_f32_32x32x16_bf16 v[44:59], v[108:111], v[152:155], v[44:59]
v_mfma_f32_32x32x16_bf16 v[60:75], v[112:115], v[152:155], v[60:75]
s_waitcnt lgkmcnt(8)
v_mfma_f32_32x32x16_bf16 v[12:27], v[116:119], v[156:159], v[12:27]
v_mfma_f32_32x32x16_bf16 v[28:43], v[120:123], v[156:159], v[28:43]
v_mfma_f32_32x32x16_bf16 v[44:59], v[124:127], v[156:159], v[44:59]
v_mfma_f32_32x32x16_bf16 v[60:75], v[128:131], v[156:159], v[60:75]
s_waitcnt lgkmcnt(0)
v_mfma_f32_32x32x16_bf16 v[12:27], v[132:135], v[160:163], v[12:27]
v_mfma_f32_32x32x16_bf16 v[28:43], v[136:139], v[160:163], v[28:43]
v_mfma_f32_32x32x16_bf16 v[44:59], v[140:143], v[160:163], v[44:59]
v_mfma_f32_32x32x16_bf16 v[60:75], v[144:147], v[160:163], v[60:75]
v_mov_b32 v192, v180
s_nop 1
v_permlane16_swap_b32 v180, v192
v_add_f32 v180, v180, v192
v_mov_b32 v192, v180
s_nop 1
v_permlane32_swap_b32 v180, v192
v_add_f32 v180, v180, v192
ds_write_b32 v198, v180 offset:512
v_mov_b32 v192, v181
s_nop 1
v_permlane16_swap_b32 v181, v192
v_add_f32 v181, v181, v192
v_mov_b32 v192, v181
s_nop 1
v_permlane32_swap_b32 v181, v192
v_add_f32 v181, v181, v192
ds_write_b32 v198, v181 offset:768
v_and_b32 v5, 31, v1
v_mul_u32_u24 v5, 1040, v5
v_lshrrev_b32 v6, 5, v1
v_lshl_add_u32 v5, v6, 3, v5
s_lshl_b32 s6, s3, 8
v_add_u32 v5, s6, v5
v_cvt_pk_bf16_f32 v84, v12, v13
v_cvt_pk_bf16_f32 v85, v14, v15
ds_write_b64 v5, v[84:85] offset:0
v_cvt_pk_bf16_f32 v86, v16, v17
v_cvt_pk_bf16_f32 v87, v18, v19
ds_write_b64 v5, v[86:87] offset:16
v_cvt_pk_bf16_f32 v88, v20, v21
v_cvt_pk_bf16_f32 v89, v22, v23
ds_write_b64 v5, v[88:89] offset:32
v_cvt_pk_bf16_f32 v90, v24, v25
v_cvt_pk_bf16_f32 v91, v26, v27
ds_write_b64 v5, v[90:91] offset:48
v_cvt_pk_bf16_f32 v92, v28, v29
v_cvt_pk_bf16_f32 v93, v30, v31
ds_write_b64 v5, v[92:93] offset:64
v_cvt_pk_bf16_f32 v94, v32, v33
v_cvt_pk_bf16_f32 v95, v34, v35
ds_write_b64 v5, v[94:95] offset:80
v_cvt_pk_bf16_f32 v96, v36, v37
v_cvt_pk_bf16_f32 v97, v38, v39
ds_write_b64 v5, v[96:97] offset:96
v_cvt_pk_bf16_f32 v98, v40, v41
v_cvt_pk_bf16_f32 v99, v42, v43
ds_write_b64 v5, v[98:99] offset:112
v_cvt_pk_bf16_f32 v100, v44, v45
v_cvt_pk_bf16_f32 v101, v46, v47
ds_write_b64 v5, v[100:101] offset:128
v_cvt_pk_bf16_f32 v102, v48, v49
v_cvt_pk_bf16_f32 v103, v50, v51
ds_write_b64 v5, v[102:103] offset:144
v_cvt_pk_bf16_f32 v104, v52, v53
v_cvt_pk_bf16_f32 v105, v54, v55
ds_write_b64 v5, v[104:105] offset:160
v_cvt_pk_bf16_f32 v106, v56, v57
v_cvt_pk_bf16_f32 v107, v58, v59
ds_write_b64 v5, v[106:107] offset:176
v_cvt_pk_bf16_f32 v108, v60, v61
v_cvt_pk_bf16_f32 v109, v62, v63
ds_write_b64 v5, v[108:109] offset:192
v_cvt_pk_bf16_f32 v110, v64, v65
v_cvt_pk_bf16_f32 v111, v66, v67
ds_write_b64 v5, v[110:111] offset:208
v_cvt_pk_bf16_f32 v112, v68, v69
v_cvt_pk_bf16_f32 v113, v70, v71
ds_write_b64 v5, v[112:113] offset:224
v_cvt_pk_bf16_f32 v114, v72, v73
v_cvt_pk_bf16_f32 v115, v74, v75
ds_write_b64 v5, v[114:115] offset:240
v_mov_b32 v11, 163824
v_mov_b32 v7, 0
ds_write_b32 v11, v7
s_waitcnt lgkmcnt(0)
s_barrier
s_mul_i32 s6, s3, 8320
v_add_u32 v5, s6, v2
ds_read_b128 v[116:119], v5 offset:0
ds_read_b128 v[120:123], v5 offset:1040
ds_read_b128 v[124:127], v5 offset:2080
ds_read_b128 v[128:131], v5 offset:3120
ds_read_b128 v[132:135], v5 offset:4160
ds_read_b128 v[136:139], v5 offset:5200
ds_read_b128 v[140:143], v5 offset:6240
ds_read_b128 v[144:147], v5 offset:7280
ds_read_b128 v[164:167], v200 offset:512
s_mul_i32 s7, s3, 524288
s_lshl_b32 s6, s80, 10
s_add_u32 s7, s7, s6
s_add_u32 s7, s7, 2097152
s_waitcnt lgkmcnt(8)
s_add_u32 s6, s7, 0
buffer_store_dwordx4 v[116:119], v2, s[64:67], s6 offen sc1
s_waitcnt lgkmcnt(7)
s_add_u32 s6, s7, 98304
buffer_store_dwordx4 v[120:123], v2, s[64:67], s6 offen sc1
s_waitcnt lgkmcnt(6)
s_add_u32 s6, s7, 131072
buffer_store_dwordx4 v[124:127], v2, s[64:67], s6 offen sc1
s_waitcnt lgkmcnt(5)
s_add_u32 s6, s7, 229376
buffer_store_dwordx4 v[128:131], v2, s[64:67], s6 offen sc1
s_waitcnt lgkmcnt(4)
s_add_u32 s6, s7, 262144
buffer_store_dwordx4 v[132:135], v2, s[64:67], s6 offen sc1
s_waitcnt lgkmcnt(3)
s_add_u32 s6, s7, 360448
buffer_store_dwordx4 v[136:139], v2, s[64:67], s6 offen sc1
s_waitcnt lgkmcnt(2)
s_add_u32 s6, s7, 393216
buffer_store_dwordx4 v[140:143], v2, s[64:67], s6 offen sc1
s_waitcnt lgkmcnt(1)
s_add_u32 s6, s7, 491520
buffer_store_dwordx4 v[144:147], v2, s[64:67], s6 offen sc1
s_waitcnt lgkmcnt(0)
v_add_f32 v164, v164, v165
v_add_f32 v166, v166, v167
v_add_f32 v187, v164, v166
v_mov_b32 v186, v178
v_lshlrev_b32 v5, 8, v1
s_mul_i32 s6, s80, 8
s_add_u32 s6, s6, 262144
v_min_u32 v186, -2, v186
v_min_u32 v187, -2, v187
s_waitcnt vmcnt(0)
s_barrier
s_cmp_lg_u32 s3, 0
s_cbranch_scc1 L_nops_41
s_mov_b64 exec, 0xffffffff
buffer_store_dwordx2 v[186:187], v5, s[64:67], s6 offen sc1
s_mov_b64 exec, -1
L_nops_41:
B_final:
s_cmp_eq_u32 s3, 3
s_cbranch_scc1 H_start
s_mov_b32 s14, s9
s_lshr_b32 s7, s3, 1
s_cmp_lg_u32 s3, 1
s_cbranch_scc1 L_w1_42
s_and_b32 s7, s9, 7
s_cmp_ge_u32 s7, 2
s_cbranch_scc1 B_end
s_lshr_b32 s14, s9, 3
s_add_u32 s14, s14, 64
L_w1_42:
s_mul_i32 s15, s14, 57
s_lshr_b32 s15, s15, 10
s_mul_i32 s6, s15, 18
s_sub_u32 s80, s14, s6
s_mul_i32 s81, s15, 73728
s_lshr_b32 s81, s81, s7
s_lshl_b32 s6, s80, 6
s_add_u32 s81, s81, s6
s_mul_i32 s6, s7, 1048576
s_add_u32 s81, s81, s6
s_add_u32 s81, s81, 4194304
v_lshrrev_b32 v5, 2, v1
v_and_b32 v6, 3, v1
v_mul_u32_u24 v44, 1152, v5
v_lshl_add_u32 v44, v6, 4, v44
v_bfe_u32 v5, v1, 2, 2
v_lshl_add_u32 v5, v5, 2, v6
v_lshrrev_b32 v46, 4, v1
v_lshl_add_u32 v45, v46, 6, v5
v_lshrrev_b32 v5, 1, v6
v_mul_u32_u24 v5, 142, v5
v_add_u32 v5, v5, v6
v_lshrrev_b32 v46, 2, v1
v_lshl_add_u32 v5, v46, 1, v5
s_lshr_b32 s6, s80, 2
s_mul_i32 s6, s6, 80
s_lshl_b32 s83, s80, 4
s_add_u32 s83, s83, s6
s_mul_i32 s6, s80, 288
s_sub_u32 s6, s6, 4480
s_cmp_ge_u32 s80, 16
s_cselect_b32 s83, s6, s83
s_cselect_b64 vcc, -1, 0
v_cndmask_b32 v45, v45, v5, vcc
v_lshlrev_b32 v45, 1, v45
s_lshl_b32 s83, s83, 1
s_mul_i32 s6, s15, 2304
s_add_u32 s83, s83, s6
s_mul_i32 s6, s7, 1152
s_add_u32 s83, s83, s6
v_and_b32 v6, 1, v1
v_lshlrev_b32 v6, 4, v6
v_mov_b32 v46, 0x3f80
v_lshlrev_b32 v46, v6, v46
v_bfe_u32 v6, v1, 1, 3
v_cmp_eq_u32 vcc, 0, v6
s_nop 1
v_cndmask_b32 v20, 0, v46, vcc
v_cmp_eq_u32 vcc, 1, v6
s_nop 1
v_cndmask_b32 v21, 0, v46, vcc
v_cmp_eq_u32 vcc, 2, v6
s_nop 1
v_cndmask_b32 v22, 0, v46, vcc
v_cmp_eq_u32 vcc, 3, v6
s_nop 1
v_cndmask_b32 v23, 0, v46, vcc
s_sub_u32 s6, s7, 1
s_mov_b32 s16, -1
s_mov_b32 s17, -1
s_mov_b32 s18, -1
s_mov_b32 s19, -1
s_mov_b32 s20, s6
s_mov_b32 s21, s6
s_mov_b32 s22, s6
s_mov_b32 s23, s6
v_mov_b32 v48, -1
v_mov_b32 v49, -1
v_mov_b32 v50, -1
v_mov_b32 v51, -1
v_mov_b32 v52, -1
v_mov_b32 v53, -1
v_mov_b32 v54, -1
v_mov_b32 v55, -1
v_mov_b32 v56, s6
v_mov_b32 v57, s6
v_mov_b32 v58, s6
v_mov_b32 v59, s6
v_mov_b32 v60, s6
v_mov_b32 v61, s6
v_mov_b32 v62, s6
v_mov_b32 v63, s6
v_mov_b32 v64, -1
v_mov_b32 v65, -1
v_mov_b32 v66, -1
v_mov_b32 v67, -1
v_mov_b32 v68, -1
v_mov_b32 v69, -1
v_mov_b32 v70, -1
v_mov_b32 v71, -1
v_mov_b32 v72, -1
v_mov_b32 v73, -1
v_mov_b32 v74, -1
v_mov_b32 v75, -1
v_mov_b32 v76, -1
v_mov_b32 v77, -1
v_mov_b32 v78, -1
v_mov_b32 v79, -1
v_mov_b32 v80, -1
v_mov_b32 v81, -1
v_mov_b32 v82, -1
v_mov_b32 v83, -1
v_mov_b32 v84, -1
v_mov_b32 v85, -1
v_mov_b32 v86, -1
v_mov_b32 v87, -1
v_mov_b32 v88, -1
v_mov_b32 v89, -1
v_mov_b32 v90, -1
v_mov_b32 v91, -1
v_mov_b32 v92, -1
v_mov_b32 v93, -1
v_mov_b32 v94, -1
v_mov_b32 v95, -1
s_add_u32 s24, s81, 0
s_add_u32 s25, s81, 18432
s_add_u32 s26, s81, 36864
s_add_u32 s27, s81, 55296
s_mov_b32 s7, 400000
v_lshrrev_b32 v5, 3, v1
v_mul_u32_u24 v5, 4608, v5
s_and_b32 s6, s20, 1
v_lshlrev_b32 v5, s6, v5
R_slow:
buffer_load_dword v46, v5, s[64:67], s81 offen sc1
s_waitcnt vmcnt(0)
v_cmp_ne_u32 vcc, -1, v46
s_bcnt1_i32_b64 s6, vcc
s_cmp_ge_u32 s6, 32
s_cbranch_scc1 R_pass
s_sleep 8
s_sub_u32 s7, s7, 1
s_cmp_lg_u32 s7, 1
s_cbranch_scc1 R_slow
R_pass:
s_mov_b64 exec, s[16:17]
s_cbranch_execz L_ld_43
buffer_load_dwordx4 v[64:67], v44, s[64:67], s24 offen sc1
L_ld_43:
s_mov_b64 exec, s[18:19]
s_cbranch_execz L_ld_44
buffer_load_dwordx4 v[68:71], v44, s[64:67], s25 offen sc1
L_ld_44:
s_mov_b64 exec, s[20:21]
s_cbranch_execz L_ld_45
buffer_load_dwordx4 v[72:75], v44, s[64:67], s26 offen sc1
L_ld_45:
s_mov_b64 exec, s[22:23]
s_cbranch_execz L_ld_46
buffer_load_dwordx4 v[76:79], v44, s[64:67], s27 offen sc1
L_ld_46:
s_mov_b64 exec, -1
s_waitcnt vmcnt(0)
s_cmp_eq_u64 s[16:17], 0
s_cbranch_scc1 L_ck_47
v_min_u32 v48, v48, v64
v_min_u32 v49, v49, v65
v_min_u32 v50, v50, v66
v_min_u32 v51, v51, v67
v_max3_u32 v46, v48, v49, v50
v_max_u32 v46, v46, v51
v_cmp_eq_u32 s[16:17], -1, v46
L_ck_47:
s_cmp_eq_u64 s[18:19], 0
s_cbranch_scc1 L_ck_48
v_min_u32 v52, v52, v68
v_min_u32 v53, v53, v69
v_min_u32 v54, v54, v70
v_min_u32 v55, v55, v71
v_max3_u32 v46, v52, v53, v54
v_max_u32 v46, v46, v55
v_cmp_eq_u32 s[18:19], -1, v46
L_ck_48:
s_cmp_eq_u64 s[20:21], 0
s_cbranch_scc1 L_ck_49
v_min_u32 v56, v56, v72
v_min_u32 v57, v57, v73
v_min_u32 v58, v58, v74
v_min_u32 v59, v59, v75
v_max3_u32 v46, v56, v57, v58
v_max_u32 v46, v46, v59
v_cmp_eq_u32 s[20:21], -1, v46
L_ck_49:
s_cmp_eq_u64 s[22:23], 0
s_cbranch_scc1 L_ck_50
v_min_u32 v60, v60, v76
v_min_u32 v61, v61, v77
v_min_u32 v62, v62, v78
v_min_u32 v63, v63, v79
v_max3_u32 v46, v60, v61, v62
v_max_u32 v46, v46, v63
v_cmp_eq_u32 s[22:23], -1, v46
L_ck_50:
s_or_b64 s[28:29], s[16:17], s[18:19]
s_or_b64 s[30:31], s[20:21], s[22:23]
s_or_b64 s[28:29], s[28:29], s[30:31]
s_cbranch_scc0 R_done
s_bcnt1_i32_b64 s6, s[16:17]
s_bcnt1_i32_b64 s28, s[18:19]
s_add_u32 s6, s6, s28
s_bcnt1_i32_b64 s28, s[20:21]
s_add_u32 s6, s6, s28
s_bcnt1_i32_b64 s28, s[22:23]
s_add_u32 s6, s6, s28
s_cmp_le_u32 s6, 48
s_cbranch_scc1 R_fast
s_sub_u32 s7, s7, 1
s_cmp_gt_u32 s7, 1
s_cbranch_scc1 R_pass
R_fast:
s_or_b64 exec, s[16:17], 1
buffer_load_dwordx4 v[64:67], v44, s[64:67], s24 offen sc1
s_or_b64 exec, s[18:19], 1
buffer_load_dwordx4 v[68:71], v44, s[64:67], s25 offen sc1
s_or_b64 exec, s[20:21], 1
buffer_load_dwordx4 v[72:75], v44, s[64:67], s26 offen sc1
s_or_b64 exec, s[22:23], 1
buffer_load_dwordx4 v[76:79], v44, s[64:67], s27 offen sc1
s_mov_b64 exec, -1
s_sleep 5
s_or_b64 exec, s[16:17], 1
buffer_load_dwordx4 v[80:83], v44, s[64:67], s24 offen sc1
s_or_b64 exec, s[18:19], 1
buffer_load_dwordx4 v[84:87], v44, s[64:67], s25 offen sc1
s_or_b64 exec, s[20:21], 1
buffer_load_dwordx4 v[88:91], v44, s[64:67], s26 offen sc1
s_or_b64 exec, s[22:23], 1
buffer_load_dwordx4 v[92:95], v44, s[64:67], s27 offen sc1
s_mov_b64 exec, -1
R_loop:
s_waitcnt vmcnt(4)
s_cmp_eq_u64 s[16:17], 0
s_cbranch_scc1 L_ck_51
v_min_u32 v48, v48, v64
v_min_u32 v49, v49, v65
v_min_u32 v50, v50, v66
v_min_u32 v51, v51, v67
v_max3_u32 v46, v48, v49, v50
v_max_u32 v46, v46, v51
v_cmp_eq_u32 s[16:17], -1, v46
L_ck_51:
s_cmp_eq_u64 s[18:19], 0
s_cbranch_scc1 L_ck_52
v_min_u32 v52, v52, v68
v_min_u32 v53, v53, v69
v_min_u32 v54, v54, v70
v_min_u32 v55, v55, v71
v_max3_u32 v46, v52, v53, v54
v_max_u32 v46, v46, v55
v_cmp_eq_u32 s[18:19], -1, v46
L_ck_52:
s_cmp_eq_u64 s[20:21], 0
s_cbranch_scc1 L_ck_53
v_min_u32 v56, v56, v72
v_min_u32 v57, v57, v73
v_min_u32 v58, v58, v74
v_min_u32 v59, v59, v75
v_max3_u32 v46, v56, v57, v58
v_max_u32 v46, v46, v59
v_cmp_eq_u32 s[20:21], -1, v46
L_ck_53:
s_cmp_eq_u64 s[22:23], 0
s_cbranch_scc1 L_ck_54
v_min_u32 v60, v60, v76
v_min_u32 v61, v61, v77
v_min_u32 v62, v62, v78
v_min_u32 v63, v63, v79
v_max3_u32 v46, v60, v61, v62
v_max_u32 v46, v46, v63
v_cmp_eq_u32 s[22:23], -1, v46
L_ck_54:
s_or_b64 s[28:29], s[16:17], s[18:19]
s_or_b64 s[30:31], s[20:21], s[22:23]
s_or_b64 s[28:29], s[28:29], s[30:31]
s_cbranch_scc0 R_done
s_or_b64 exec, s[16:17], 1
buffer_load_dwordx4 v[64:67], v44, s[64:67], s24 offen sc1
s_or_b64 exec, s[18:19], 1
buffer_load_dwordx4 v[68:71], v44, s[64:67], s25 offen sc1
s_or_b64 exec, s[20:21], 1
buffer_load_dwordx4 v[72:75], v44, s[64:67], s26 offen sc1
s_or_b64 exec, s[22:23], 1
buffer_load_dwordx4 v[76:79], v44, s[64:67], s27 offen sc1
s_mov_b64 exec, -1
s_waitcnt vmcnt(4)
s_cmp_eq_u64 s[16:17], 0
s_cbranch_scc1 L_ck_55
v_min_u32 v48, v48, v80
v_min_u32 v49, v49, v81
v_min_u32 v50, v50, v82
v_min_u32 v51, v51, v83
v_max3_u32 v46, v48, v49, v50
v_max_u32 v46, v46, v51
v_cmp_eq_u32 s[16:17], -1, v46
L_ck_55:
s_cmp_eq_u64 s[18:19], 0
s_cbranch_scc1 L_ck_56
v_min_u32 v52, v52, v84
v_min_u32 v53, v53, v85
v_min_u32 v54, v54, v86
v_min_u32 v55, v55, v87
v_max3_u32 v46, v52, v53, v54
v_max_u32 v46, v46, v55
v_cmp_eq_u32 s[18:19], -1, v46
L_ck_56:
s_cmp_eq_u64 s[20:21], 0
s_cbranch_scc1 L_ck_57
v_min_u32 v56, v56, v88
v_min_u32 v57, v57, v89
v_min_u32 v58, v58, v90
v_min_u32 v59, v59, v91
v_max3_u32 v46, v56, v57, v58
v_max_u32 v46, v46, v59
v_cmp_eq_u32 s[20:21], -1, v46
L_ck_57:
s_cmp_eq_u64 s[22:23], 0
s_cbranch_scc1 L_ck_58
v_min_u32 v60, v60, v92
v_min_u32 v61, v61, v93
v_min_u32 v62, v62, v94
v_min_u32 v63, v63, v95
v_max3_u32 v46, v60, v61, v62
v_max_u32 v46, v46, v63
v_cmp_eq_u32 s[22:23], -1, v46
L_ck_58:
s_or_b64 s[28:29], s[16:17], s[18:19]
s_or_b64 s[30:31], s[20:21], s[22:23]
s_or_b64 s[28:29], s[28:29], s[30:31]
s_cbranch_scc0 R_done
s_or_b64 exec, s[16:17], 1
buffer_load_dwordx4 v[80:83], v44, s[64:67], s24 offen sc1
s_or_b64 exec, s[18:19], 1
buffer_load_dwordx4 v[84:87], v44, s[64:67], s25 offen sc1
s_or_b64 exec, s[20:21], 1
buffer_load_dwordx4 v[88:91], v44, s[64:67], s26 offen sc1
s_or_b64 exec, s[22:23], 1
buffer_load_dwordx4 v[92:95], v44, s[64:67], s27 offen sc1
s_mov_b64 exec, -1
s_sub_u32 s7, s7, 1
s_cmp_gt_i32 s7, 0
s_cbranch_scc1 R_loop
R_done:
v_mfma_f32_16x16x32_bf16 v[12:15], v[20:23], v[48:51], 0
v_mfma_f32_16x16x32_bf16 v[12:15], v[20:23], v[52:55], v[12:15]
v_mfma_f32_16x16x32_bf16 v[12:15], v[20:23], v[56:59], v[12:15]
v_mfma_f32_16x16x32_bf16 v[12:15], v[20:23], v[60:63], v[12:15]
s_nop 7
v_add_f32_dpp v16, v12, v12 row_ror:8 row_mask:0xf bank_mask:0x3
v_add_f32_dpp v17, v13, v13 row_ror:8 row_mask:0xf bank_mask:0x3
v_add_f32_dpp v16, v14, v14 row_ror:8 row_mask:0xf bank_mask:0xc
v_add_f32_dpp v17, v15, v15 row_ror:8 row_mask:0xf bank_mask:0xc
s_nop 0
v_add_f32_dpp v46, v16, v16 row_shl:4 row_mask:0xf bank_mask:0x5
v_add_f32_dpp v46, v17, v17 row_shr:4 row_mask:0xf bank_mask:0xa
s_mov_b64 exec, 0xffffffff
v_cvt_pk_bf16_f32 v46, v46, v46
buffer_store_short v46, v45, s[72:75], s83 offen
s_mov_b64 exec, -1
s_cmp_lg_u32 s3, 0
s_cbranch_scc1 B_fin
ds_write_b32 v11, v11
s_waitcnt lgkmcnt(0)
B_fin:
B_end:
s_endpgm
H_start:
s_lshl_b32 s6, s8, 6
s_add_u32 s6, s6, s4
s_lshl_b32 s6, s6, 20
s_add_u32 s56, s20, s6
s_addc_u32 s57, s21, 0
s_mov_b32 s58, 34603008
s_mov_b32 s59, 0x20000
v_lshlrev_b32 v16, 7, v1
v_and_b32 v17, 4095, v16
v_add_u32 v16, 4096, v16
v_lshrrev_b32 v21, 5, v1
v_mul_u32_u24 v21, 20480, v21
v_add_u32 v17, v17, v21
s_and_b32 s6, s9, 56
v_and_b32 v19, 7, v1
v_add_u32 v19, s6, v19
v_mul_u32_u24 v19, 16, v19
v_add_u32 v19, 393216, v19
s_lshr_b32 s7, s4, 2
s_mul_i32 s7, s7, 4224
v_add_u32 v19, s7, v19
s_mov_b32 s16, 43
s_mov_b32 s17, 43
s_mov_b32 s18, 43
s_mov_b32 s31, 400000
buffer_load_dwordx3 v[12:14], v19, s[64:67], 0 offen sc1
s_waitcnt vmcnt(0)
H_loop:
v_med3_i32 v12, v12, -1, 31
v_med3_i32 v13, v13, -1, 31
v_med3_i32 v14, v14, -1, 31
v_add3_u32 v20, v12, v13, v14
s_nop 1
v_add_u32_dpp v20, v20, v20 row_ror:4 row_mask:0xf bank_mask:0xf
s_nop 1
v_add_u32_dpp v20, v20, v20 row_ror:2 row_mask:0xf bank_mask:0xf
s_nop 1
v_add_u32_dpp v20, v20, v20 row_ror:1 row_mask:0xf bank_mask:0xf
v_lshlrev_b32 v20, 3, v20
s_nop 0
v_readfirstlane_b32 s28, v20
v_readlane_b32 s20, v12, s9
v_readlane_b32 s21, v13, s9
v_readlane_b32 s22, v14, s9
buffer_load_dwordx3 v[12:14], v19, s[64:67], 0 offen sc1
s_mul_i32 s6, s20, 192
s_sub_i32 s24, s28, s6
s_mul_i32 s6, s16, 24
s_add_i32 s24, s24, s6
s_add_i32 s6, s16, -15
s_cmp_ge_i32 s6, s20
s_cselect_b32 s24, s24, -1048576
s_mul_i32 s6, s21, 192
s_sub_i32 s25, s28, s6
s_mul_i32 s6, s17, 24
s_add_i32 s25, s25, s6
s_add_i32 s6, s17, -15
s_cmp_ge_i32 s6, s21
s_cselect_b32 s25, s25, -1048576
s_mul_i32 s6, s22, 192
s_sub_i32 s26, s28, s6
s_mul_i32 s6, s18, 24
s_add_i32 s26, s26, s6
s_add_i32 s6, s18, -15
s_cmp_ge_i32 s6, s22
s_cselect_b32 s26, s26, -1048576
s_cmp_ge_i32 s24, s25
s_cselect_b32 s29, 0, 1
s_max_i32 s30, s24, s25
s_cmp_ge_i32 s30, s26
s_cselect_b32 s29, s29, 2
s_max_i32 s30, s30, s26
s_cmp_eq_i32 s30, -1048576
s_cbranch_scc1 H_end
s_sub_u32 s31, s31, 1
s_cmp_eq_u32 s31, 0
s_cbranch_scc1 H_end
s_cmp_lt_i32 s30, 1416
s_cbranch_scc1 H_idle
s_cmp_eq_u32 s29, 0
s_cselect_b32 s6, s16, s6
s_subb_u32 s16, s16, 0
s_cmp_eq_u32 s29, 1
s_cselect_b32 s6, s17, s6
s_subb_u32 s17, s17, 0
s_cmp_eq_u32 s29, 2
s_cselect_b32 s6, s18, s6
s_subb_u32 s18, s18, 0
s_mul_i32 s6, s6, 24576
s_sub_u32 s6, s6, 32768
s_cmp_eq_u32 s29, 2
s_cselect_b32 s7, 33554432, 0
s_add_u32 s6, s6, s7
s_cmp_eq_u32 s29, 1
s_cselect_b64 vcc, -1, 0
s_cselect_b32 s7, 25, 13
s_lshl_b32 s7, 1, s7
s_add_u32 s7, s7, s6
v_cndmask_b32 v18, v16, v17, vcc
buffer_load_dword v22, v18, s[56:59], s6 offen
buffer_load_dword v23, v18, s[56:59], s7 offen
s_waitcnt vmcnt(2)
s_branch H_loop
H_idle:
ds_read_b32 v21, v11
s_waitcnt vmcnt(0) lgkmcnt(0)
s_sleep 4
v_cmp_eq_u32 vcc, 0, v21
s_cbranch_vccnz H_loop
H_end:
s_branch B_end
.section .rodata,"a"
.p2align 6
.amdhsa_kernel concat_heads__mha_block_cached__compressed_kv_cla__decode_kernel
  .amdhsa_next_free_vgpr 512
  .amdhsa_next_free_sgpr 102
  .amdhsa_accum_offset 256
  .amdhsa_group_segment_fixed_size 0
  .amdhsa_kernarg_size 112
  .amdhsa_user_sgpr_count 2
  .amdhsa_user_sgpr_kernarg_segment_ptr 1
  .amdhsa_system_sgpr_workgroup_id_x 1
.end_amdhsa_kernel
```

```asm
; @launch grid=(256,1,1) block=(256,1,1) lds=163840
.amdgcn_target "amdgcn-amd-amdhsa--gfx950"
.text
.globl concat_heads__mha_block_cached__compressed_kv_cla__decode_kernel
.p2align 8
.type concat_heads__mha_block_cached__compressed_kv_cla__decode_kernel,@function
concat_heads__mha_block_cached__compressed_kv_cla__decode_kernel:
s_cmp_ge_u32 s2, 256
s_cbranch_scc1 L_exit
s_load_dwordx16 s[16:31], s[0:1], 0
s_load_dwordx8 s[32:39], s[0:1], 64
s_load_dwordx4 s[40:43], s[0:1], 96
v_lshrrev_b32 v1, 6, v0
s_nop 0
v_readfirstlane_b32 s3, v1
s_and_b32 s6, s2, 7
s_bfe_u32 s7, s2, 0x20003
s_lshl_b32 s4, s6, 2
s_add_u32 s4, s4, s7
s_lshr_b32 s5, s2, 5
s_cbranch_scc0 B_role
s_cmp_eq_u32 s5, 1
s_cbranch_scc1 D_role
A_role:
s_sub_u32 s8, s5, 2
s_cmp_ge_u32 s8, 3
s_cselect_b32 s9, 1, 0
s_cselect_b32 s6, 3, 0
s_sub_u32 s8, s8, s6
s_lshl_b32 s11, s8, 2
s_add_u32 s11, s11, s3
s_cmp_ge_u32 s11, 6
s_cselect_b32 s83, 1, 0
s_cselect_b32 s6, -1, 1
s_add_u32 s11, s11, s6
s_cmp_ge_u32 s11, 6
s_cselect_b32 s6, 6, 0
s_sub_u32 s11, s11, s6
s_lshl_b32 s10, s9, 1
s_add_u32 s10, s10, s83
v_and_b32 v1, 63, v0
v_lshlrev_b32 v2, 4, v1
s_sub_u32 s14, s11, 8
s_lshl_b32 s14, s14, 12
s_mov_b32 s13, s14
s_add_u32 s13, s13, 24576
s_min_u32 s12, s13, 2146435072
s_lshl_b32 s82, s10, 5
s_add_u32 s82, s82, s4
s_lshl_b32 s72, s82, 20
s_mov_b32 s54, 1048576
s_mov_b32 s55, 0x20000
s_waitcnt lgkmcnt(0)
s_add_u32 s52, s18, s72
s_addc_u32 s53, s19, 0
buffer_load_dwordx4 v[136:139], v2, s[52:55], s12 offen offset:0 nt
buffer_load_dwordx4 v[140:143], v2, s[52:55], s12 offen offset:1024 nt
buffer_load_dwordx4 v[144:147], v2, s[52:55], s12 offen offset:2048 nt
buffer_load_dwordx4 v[148:151], v2, s[52:55], s12 offen offset:3072 nt
s_add_u32 s13, s13, 24576
s_min_u32 s12, s13, 2146435072
buffer_load_dwordx4 v[152:155], v2, s[52:55], s12 offen offset:0 nt
buffer_load_dwordx4 v[156:159], v2, s[52:55], s12 offen offset:1024 nt
buffer_load_dwordx4 v[160:163], v2, s[52:55], s12 offen offset:2048 nt
buffer_load_dwordx4 v[164:167], v2, s[52:55], s12 offen offset:3072 nt
s_add_u32 s13, s13, 24576
s_min_u32 s12, s13, 2146435072
s_lshr_b32 s6, s2, 3
s_sub_u32 s6, s6, 8
s_lshl_b32 s6, s6, 2
s_add_u32 s6, s6, s3
s_mul_i32 s6, s6, 49152
s_and_b32 s7, s2, 7
s_lshl_b32 s7, s7, 10
s_add_u32 s75, s6, s7
s_mov_b32 s62, 4718592
s_mov_b32 s63, 0x20000
v_min_u32 v35, 47, v1
v_lshrrev_b32 v36, 3, v35
v_mul_u32_u24 v36, 7168, v36
v_lshl_add_u32 v36, v35, 7, v36
s_mov_b64 s[60:61], s[22:23]
buffer_load_dword v120, v36, s[60:63], s75 offen
s_mov_b32 s58, 1048576
s_mov_b32 s59, 0x20000
s_mul_i32 s6, s9, 2304
s_mul_i32 s7, s3, 288
s_add_u32 s73, s6, s7
s_sub_u32 s46, 4608, s73
s_mov_b32 s47, 0x20000
s_mul_i32 s6, s3, 1179648
s_lshl_b32 s7, s4, 8
s_add_u32 s74, s6, s7
s_sub_u32 s50, 4718592, s74
s_mov_b32 s51, 0x20000
v_lshrrev_b32 v5, 4, v1
v_and_b32 v6, 15, v1
v_mul_u32_u24 v3, 294912, v5
v_lshl_add_u32 v3, v6, 4, v3
v_mul_u32_u24 v4, 72, v5
v_lshrrev_b32 v6, 3, v6
v_mul_u32_u24 v6, 1152, v6
v_add_u32 v4, v4, v6
s_add_u32 s44, s16, s73
s_addc_u32 s45, s17, 0
buffer_load_dwordx4 v[40:43], v4, s[44:47], 0 offen offset:0
buffer_load_dwordx4 v[44:47], v4, s[44:47], 0 offen offset:16
buffer_load_dwordx4 v[48:51], v4, s[44:47], 0 offen offset:32
buffer_load_dwordx4 v[52:55], v4, s[44:47], 0 offen offset:48
buffer_load_dwordx2 v[56:57], v4, s[44:47], 0 offen offset:64
s_add_u32 s56, s20, s72
s_addc_u32 s57, s21, 0
s_add_u32 s48, s22, s74
s_addc_u32 s49, s23, 0
s_cmp_lg_u32 s8, 0
s_cbranch_scc1 L_nowq_1
s_waitcnt vmcnt(20)
s_mov_b32 s6, 0
buffer_load_dwordx4 a[96:99], v3, s[48:51], s6 offen
s_mov_b32 s6, 8192
buffer_load_dwordx4 a[100:103], v3, s[48:51], s6 offen
s_mov_b32 s6, 16384
buffer_load_dwordx4 a[104:107], v3, s[48:51], s6 offen
s_mov_b32 s6, 24576
buffer_load_dwordx4 a[108:111], v3, s[48:51], s6 offen
s_mov_b32 s6, 32768
buffer_load_dwordx4 a[112:115], v3, s[48:51], s6 offen
s_mov_b32 s6, 40960
buffer_load_dwordx4 a[116:119], v3, s[48:51], s6 offen
s_mov_b32 s6, 49152
buffer_load_dwordx4 a[120:123], v3, s[48:51], s6 offen
s_mov_b32 s6, 57344
buffer_load_dwordx4 a[124:127], v3, s[48:51], s6 offen
s_mov_b32 s6, 65536
buffer_load_dwordx4 a[128:131], v3, s[48:51], s6 offen
s_mov_b32 s6, 73728
buffer_load_dwordx4 a[132:135], v3, s[48:51], s6 offen
s_mov_b32 s6, 81920
buffer_load_dwordx4 a[136:139], v3, s[48:51], s6 offen
s_mov_b32 s6, 90112
buffer_load_dwordx4 a[140:143], v3, s[48:51], s6 offen
s_mov_b32 s6, 98304
buffer_load_dwordx4 a[144:147], v3, s[48:51], s6 offen
s_mov_b32 s6, 106496
buffer_load_dwordx4 a[148:151], v3, s[48:51], s6 offen
s_mov_b32 s6, 114688
buffer_load_dwordx4 a[152:155], v3, s[48:51], s6 offen
s_mov_b32 s6, 122880
buffer_load_dwordx4 a[156:159], v3, s[48:51], s6 offen
s_mov_b32 s6, 131072
buffer_load_dwordx4 a[160:163], v3, s[48:51], s6 offen
s_mov_b32 s6, 139264
buffer_load_dwordx4 a[164:167], v3, s[48:51], s6 offen
s_mov_b32 s6, 147456
buffer_load_dwordx4 a[168:171], v3, s[48:51], s6 offen
s_mov_b32 s6, 155648
buffer_load_dwordx4 a[172:175], v3, s[48:51], s6 offen
s_mov_b32 s6, 163840
buffer_load_dwordx4 a[176:179], v3, s[48:51], s6 offen
s_mov_b32 s6, 172032
buffer_load_dwordx4 a[180:183], v3, s[48:51], s6 offen
s_mov_b32 s6, 180224
buffer_load_dwordx4 a[184:187], v3, s[48:51], s6 offen
s_mov_b32 s6, 188416
buffer_load_dwordx4 a[188:191], v3, s[48:51], s6 offen
s_mov_b32 s6, 196608
buffer_load_dwordx4 a[192:195], v3, s[48:51], s6 offen
s_mov_b32 s6, 204800
buffer_load_dwordx4 a[196:199], v3, s[48:51], s6 offen
s_mov_b32 s6, 212992
buffer_load_dwordx4 a[200:203], v3, s[48:51], s6 offen
s_mov_b32 s6, 221184
buffer_load_dwordx4 a[204:207], v3, s[48:51], s6 offen
s_mov_b32 s6, 229376
buffer_load_dwordx4 a[208:211], v3, s[48:51], s6 offen
s_mov_b32 s6, 237568
buffer_load_dwordx4 a[212:215], v3, s[48:51], s6 offen
s_mov_b32 s6, 245760
buffer_load_dwordx4 a[216:219], v3, s[48:51], s6 offen
s_mov_b32 s6, 253952
buffer_load_dwordx4 a[220:223], v3, s[48:51], s6 offen
s_mov_b32 s6, 262144
buffer_load_dwordx4 a[224:227], v3, s[48:51], s6 offen
s_mov_b32 s6, 270336
buffer_load_dwordx4 a[228:231], v3, s[48:51], s6 offen
s_mov_b32 s6, 278528
buffer_load_dwordx4 a[232:235], v3, s[48:51], s6 offen
s_mov_b32 s6, 286720
buffer_load_dwordx4 a[236:239], v3, s[48:51], s6 offen
L_nowq_1:
s_waitcnt vmcnt(54)
buffer_load_dwordx4 v[168:171], v2, s[52:55], s12 offen offset:0 nt
buffer_load_dwordx4 v[172:175], v2, s[52:55], s12 offen offset:1024 nt
buffer_load_dwordx4 v[176:179], v2, s[52:55], s12 offen offset:2048 nt
buffer_load_dwordx4 v[180:183], v2, s[52:55], s12 offen offset:3072 nt
s_add_u32 s13, s13, 24576
s_min_u32 s12, s13, 2146435072
s_waitcnt vmcnt(54)
buffer_load_dwordx4 v[184:187], v2, s[52:55], s12 offen offset:0 nt
buffer_load_dwordx4 v[188:191], v2, s[52:55], s12 offen offset:1024 nt
buffer_load_dwordx4 v[192:195], v2, s[52:55], s12 offen offset:2048 nt
buffer_load_dwordx4 v[196:199], v2, s[52:55], s12 offen offset:3072 nt
s_add_u32 s13, s13, 24576
s_min_u32 s12, s13, 2146435072
s_waitcnt vmcnt(54)
buffer_load_dwordx4 v[200:203], v2, s[52:55], s12 offen offset:0 nt
buffer_load_dwordx4 v[204:207], v2, s[52:55], s12 offen offset:1024 nt
buffer_load_dwordx4 v[208:211], v2, s[52:55], s12 offen offset:2048 nt
buffer_load_dwordx4 v[212:215], v2, s[52:55], s12 offen offset:3072 nt
s_add_u32 s13, s13, 24576
s_min_u32 s12, s13, 2146435072
s_cmp_lg_u32 s8, 1
s_cbranch_scc1 L_nowq_2
s_waitcnt vmcnt(20)
s_mov_b32 s6, 0
buffer_load_dwordx4 a[96:99], v3, s[48:51], s6 offen
s_mov_b32 s6, 8192
buffer_load_dwordx4 a[100:103], v3, s[48:51], s6 offen
s_mov_b32 s6, 16384
buffer_load_dwordx4 a[104:107], v3, s[48:51], s6 offen
s_mov_b32 s6, 24576
buffer_load_dwordx4 a[108:111], v3, s[48:51], s6 offen
s_mov_b32 s6, 32768
buffer_load_dwordx4 a[112:115], v3, s[48:51], s6 offen
s_mov_b32 s6, 40960
buffer_load_dwordx4 a[116:119], v3, s[48:51], s6 offen
s_mov_b32 s6, 49152
buffer_load_dwordx4 a[120:123], v3, s[48:51], s6 offen
s_mov_b32 s6, 57344
buffer_load_dwordx4 a[124:127], v3, s[48:51], s6 offen
s_mov_b32 s6, 65536
buffer_load_dwordx4 a[128:131], v3, s[48:51], s6 offen
s_mov_b32 s6, 73728
buffer_load_dwordx4 a[132:135], v3, s[48:51], s6 offen
s_mov_b32 s6, 81920
buffer_load_dwordx4 a[136:139], v3, s[48:51], s6 offen
s_mov_b32 s6, 90112
buffer_load_dwordx4 a[140:143], v3, s[48:51], s6 offen
s_mov_b32 s6, 98304
buffer_load_dwordx4 a[144:147], v3, s[48:51], s6 offen
s_mov_b32 s6, 106496
buffer_load_dwordx4 a[148:151], v3, s[48:51], s6 offen
s_mov_b32 s6, 114688
buffer_load_dwordx4 a[152:155], v3, s[48:51], s6 offen
s_mov_b32 s6, 122880
buffer_load_dwordx4 a[156:159], v3, s[48:51], s6 offen
s_mov_b32 s6, 131072
buffer_load_dwordx4 a[160:163], v3, s[48:51], s6 offen
s_mov_b32 s6, 139264
buffer_load_dwordx4 a[164:167], v3, s[48:51], s6 offen
s_mov_b32 s6, 147456
buffer_load_dwordx4 a[168:171], v3, s[48:51], s6 offen
s_mov_b32 s6, 155648
buffer_load_dwordx4 a[172:175], v3, s[48:51], s6 offen
s_mov_b32 s6, 163840
buffer_load_dwordx4 a[176:179], v3, s[48:51], s6 offen
s_mov_b32 s6, 172032
buffer_load_dwordx4 a[180:183], v3, s[48:51], s6 offen
s_mov_b32 s6, 180224
buffer_load_dwordx4 a[184:187], v3, s[48:51], s6 offen
s_mov_b32 s6, 188416
buffer_load_dwordx4 a[188:191], v3, s[48:51], s6 offen
s_mov_b32 s6, 196608
buffer_load_dwordx4 a[192:195], v3, s[48:51], s6 offen
s_mov_b32 s6, 204800
buffer_load_dwordx4 a[196:199], v3, s[48:51], s6 offen
s_mov_b32 s6, 212992
buffer_load_dwordx4 a[200:203], v3, s[48:51], s6 offen
s_mov_b32 s6, 221184
buffer_load_dwordx4 a[204:207], v3, s[48:51], s6 offen
s_mov_b32 s6, 229376
buffer_load_dwordx4 a[208:211], v3, s[48:51], s6 offen
s_mov_b32 s6, 237568
buffer_load_dwordx4 a[212:215], v3, s[48:51], s6 offen
s_mov_b32 s6, 245760
buffer_load_dwordx4 a[216:219], v3, s[48:51], s6 offen
s_mov_b32 s6, 253952
buffer_load_dwordx4 a[220:223], v3, s[48:51], s6 offen
s_mov_b32 s6, 262144
buffer_load_dwordx4 a[224:227], v3, s[48:51], s6 offen
s_mov_b32 s6, 270336
buffer_load_dwordx4 a[228:231], v3, s[48:51], s6 offen
s_mov_b32 s6, 278528
buffer_load_dwordx4 a[232:235], v3, s[48:51], s6 offen
s_mov_b32 s6, 286720
buffer_load_dwordx4 a[236:239], v3, s[48:51], s6 offen
L_nowq_2:
s_waitcnt vmcnt(54)
buffer_load_dwordx4 v[216:219], v2, s[52:55], s12 offen offset:0 nt
buffer_load_dwordx4 v[220:223], v2, s[52:55], s12 offen offset:1024 nt
buffer_load_dwordx4 v[224:227], v2, s[52:55], s12 offen offset:2048 nt
buffer_load_dwordx4 v[228:231], v2, s[52:55], s12 offen offset:3072 nt
s_add_u32 s13, s13, 24576
s_min_u32 s12, s13, 2146435072
s_waitcnt vmcnt(54)
buffer_load_dwordx4 v[232:235], v2, s[52:55], s12 offen offset:0 nt
buffer_load_dwordx4 v[236:239], v2, s[52:55], s12 offen offset:1024 nt
buffer_load_dwordx4 v[240:243], v2, s[52:55], s12 offen offset:2048 nt
buffer_load_dwordx4 v[244:247], v2, s[52:55], s12 offen offset:3072 nt
s_add_u32 s13, s13, 24576
s_min_u32 s12, s13, 2146435072
s_waitcnt vmcnt(54)
s_add_u32 s34, s14, 24576
s_min_u32 s34, s34, 2146435072
buffer_load_dwordx4 a[0:3], v2, s[56:59], s34 offen offset:0 nt
buffer_load_dwordx4 a[4:7], v2, s[56:59], s34 offen offset:1024 nt
buffer_load_dwordx4 a[8:11], v2, s[56:59], s34 offen offset:2048 nt
buffer_load_dwordx4 a[12:15], v2, s[56:59], s34 offen offset:3072 nt
s_cmp_lg_u32 s8, 2
s_cbranch_scc1 L_nowq_3
s_waitcnt vmcnt(20)
s_mov_b32 s6, 0
buffer_load_dwordx4 a[96:99], v3, s[48:51], s6 offen
s_mov_b32 s6, 8192
buffer_load_dwordx4 a[100:103], v3, s[48:51], s6 offen
s_mov_b32 s6, 16384
buffer_load_dwordx4 a[104:107], v3, s[48:51], s6 offen
s_mov_b32 s6, 24576
buffer_load_dwordx4 a[108:111], v3, s[48:51], s6 offen
s_mov_b32 s6, 32768
buffer_load_dwordx4 a[112:115], v3, s[48:51], s6 offen
s_mov_b32 s6, 40960
buffer_load_dwordx4 a[116:119], v3, s[48:51], s6 offen
s_mov_b32 s6, 49152
buffer_load_dwordx4 a[120:123], v3, s[48:51], s6 offen
s_mov_b32 s6, 57344
buffer_load_dwordx4 a[124:127], v3, s[48:51], s6 offen
s_mov_b32 s6, 65536
buffer_load_dwordx4 a[128:131], v3, s[48:51], s6 offen
s_mov_b32 s6, 73728
buffer_load_dwordx4 a[132:135], v3, s[48:51], s6 offen
s_mov_b32 s6, 81920
buffer_load_dwordx4 a[136:139], v3, s[48:51], s6 offen
s_mov_b32 s6, 90112
buffer_load_dwordx4 a[140:143], v3, s[48:51], s6 offen
s_mov_b32 s6, 98304
buffer_load_dwordx4 a[144:147], v3, s[48:51], s6 offen
s_mov_b32 s6, 106496
buffer_load_dwordx4 a[148:151], v3, s[48:51], s6 offen
s_mov_b32 s6, 114688
buffer_load_dwordx4 a[152:155], v3, s[48:51], s6 offen
s_mov_b32 s6, 122880
buffer_load_dwordx4 a[156:159], v3, s[48:51], s6 offen
s_mov_b32 s6, 131072
buffer_load_dwordx4 a[160:163], v3, s[48:51], s6 offen
s_mov_b32 s6, 139264
buffer_load_dwordx4 a[164:167], v3, s[48:51], s6 offen
s_mov_b32 s6, 147456
buffer_load_dwordx4 a[168:171], v3, s[48:51], s6 offen
s_mov_b32 s6, 155648
buffer_load_dwordx4 a[172:175], v3, s[48:51], s6 offen
s_mov_b32 s6, 163840
buffer_load_dwordx4 a[176:179], v3, s[48:51], s6 offen
s_mov_b32 s6, 172032
buffer_load_dwordx4 a[180:183], v3, s[48:51], s6 offen
s_mov_b32 s6, 180224
buffer_load_dwordx4 a[184:187], v3, s[48:51], s6 offen
s_mov_b32 s6, 188416
buffer_load_dwordx4 a[188:191], v3, s[48:51], s6 offen
s_mov_b32 s6, 196608
buffer_load_dwordx4 a[192:195], v3, s[48:51], s6 offen
s_mov_b32 s6, 204800
buffer_load_dwordx4 a[196:199], v3, s[48:51], s6 offen
s_mov_b32 s6, 212992
buffer_load_dwordx4 a[200:203], v3, s[48:51], s6 offen
s_mov_b32 s6, 221184
buffer_load_dwordx4 a[204:207], v3, s[48:51], s6 offen
s_mov_b32 s6, 229376
buffer_load_dwordx4 a[208:211], v3, s[48:51], s6 offen
s_mov_b32 s6, 237568
buffer_load_dwordx4 a[212:215], v3, s[48:51], s6 offen
s_mov_b32 s6, 245760
buffer_load_dwordx4 a[216:219], v3, s[48:51], s6 offen
s_mov_b32 s6, 253952
buffer_load_dwordx4 a[220:223], v3, s[48:51], s6 offen
s_mov_b32 s6, 262144
buffer_load_dwordx4 a[224:227], v3, s[48:51], s6 offen
s_mov_b32 s6, 270336
buffer_load_dwordx4 a[228:231], v3, s[48:51], s6 offen
s_mov_b32 s6, 278528
buffer_load_dwordx4 a[232:235], v3, s[48:51], s6 offen
s_mov_b32 s6, 286720
buffer_load_dwordx4 a[236:239], v3, s[48:51], s6 offen
L_nowq_3:
s_mov_b32 s64, s42
s_mov_b32 s65, s43
s_mov_b32 s66, 16777216
s_mov_b32 s67, 0x20000
s_mov_b32 s68, s40
s_mov_b32 s69, s41
s_mov_b32 s70, 256
s_mov_b32 s71, 0x20000
s_mul_i32 s6, s4, 147456
s_add_u32 s60, s24, s6
s_addc_u32 s61, s25, 0
s_mov_b32 s62, 147456
s_mov_b32 s63, 0x20000
v_and_b32 v5, 1, v1
v_lshlrev_b32 v5, 4, v5
v_mov_b32 v6, 0xffff
v_lshlrev_b32 v5, v5, v6
v_bfe_u32 v6, v1, 1, 2
v_cmp_eq_u32 vcc, 0, v6
s_nop 1
v_cndmask_b32 v8, 0, v5, vcc
v_cmp_eq_u32 vcc, 1, v6
s_nop 1
v_cndmask_b32 v9, 0, v5, vcc
v_cmp_eq_u32 vcc, 2, v6
s_nop 1
v_cndmask_b32 v10, 0, v5, vcc
v_cmp_eq_u32 vcc, 3, v6
s_nop 1
v_cndmask_b32 v11, 0, v5, vcc
v_mov_b32 v5, 0x0c0c0c0c
s_mov_b32 s6, 0x01000100
s_mov_b32 s7, 0x03020302
v_bfi_b32 v12, v8, s6, v5
v_bfi_b32 v13, v9, s6, v5
v_bfi_b32 v14, v10, s6, v5
v_bfi_b32 v15, v11, s6, v5
v_bfi_b32 v16, v8, s7, v5
v_bfi_b32 v17, v9, s7, v5
v_bfi_b32 v18, v10, s7, v5
v_bfi_b32 v19, v11, s7, v5
v_mov_b32 v7, 0x3e0293ee
v_mov_b32 v86, 0xff800000
v_lshrrev_b32 v5, 4, v1
v_lshlrev_b32 v5, 3, v5
v_bfe_u32 v6, v1, 2, 2
v_add_u32 v5, v5, v6
v_mul_u32_u24 v5, 1152, v5
s_mul_i32 s6, s3, 288
v_add_u32 v5, s6, v5
v_and_b32 v6, 3, v1
v_lshl_add_u32 v88, v6, 5, v5
v_lshl_add_u32 v89, v6, 3, v5
v_add_u32 v89, 256, v89
v_bfe_u32 v6, v1, 3, 1
v_mul_u32_u24 v6, 2176, v6
v_sub_u32 v88, v88, v6
v_lshrrev_b32 v6, 4, v1
v_mul_u32_u24 v6, 4608, v6
v_sub_u32 v88, v88, v6
v_add_u32 v90, 73728, v88
v_add_u32 v91, 73728, v89
s_mul_i32 s82, s82, 64
s_add_u32 s82, s82, 327680
s_mov_b64 s[72:73], 0
s_cmp_ge_u32 s11, 2
s_cselect_b32 s74, 0x22222222, 0
s_mov_b32 s75, s74
s_mov_b32 s76, 0x44444444
s_mov_b32 s77, s76
s_mov_b32 s78, 0x88888888
s_mov_b32 s79, s78
v_bfe_u32 v5, v1, 4, 1
s_lshl_b32 s6, s9, 7
s_lshl_b32 s7, s4, 1
s_add_u32 s6, s6, s7
s_add_u32 s6, s6, s8
v_mul_u32_u24 v6, 63, v5
v_add_u32 v6, s6, v6
v_mul_u32_u24 v92, 1152, v6
v_add_u32 v92, 4194304, v92
v_sub_u32 v6, s8, v5
v_cmp_lt_u32 vcc, 1, v6
v_mov_b32 v6, 2146435072
s_nop 0
v_cndmask_b32 v92, v92, v6, vcc
v_and_b32 v35, 15, v1
v_lshl_add_u32 v92, v35, 4, v92
s_lshl_b32 s6, s3, 5
v_add_u32 v93, s6, v92
s_lshl_b32 s6, s3, 8
v_add_u32 v92, s6, v92
s_lshl_b32 s6, s8, 2
s_add_u32 s6, s6, 0
s_cmp_ge_u32 s6, 6
s_cselect_b32 s6, 1, 0
v_cmp_eq_u32 vcc, s6, v5
s_nop 1
v_cndmask_b32 v106, 0, 1.0, vcc
s_lshl_b32 s6, s8, 2
s_add_u32 s6, s6, 1
s_cmp_ge_u32 s6, 6
s_cselect_b32 s6, 1, 0
v_cmp_eq_u32 vcc, s6, v5
s_nop 1
v_cndmask_b32 v107, 0, 1.0, vcc
s_lshl_b32 s6, s8, 2
s_add_u32 s6, s6, 2
s_cmp_ge_u32 s6, 6
s_cselect_b32 s6, 1, 0
v_cmp_eq_u32 vcc, s6, v5
s_nop 1
v_cndmask_b32 v108, 0, 1.0, vcc
s_lshl_b32 s6, s8, 2
s_add_u32 s6, s6, 3
s_cmp_ge_u32 s6, 6
s_cselect_b32 s6, 1, 0
v_cmp_eq_u32 vcc, s6, v5
s_nop 1
v_cndmask_b32 v109, 0, 1.0, vcc
v_bfe_i32 v35, v1, 3, 1
v_and_b32 v35, 0xaaaaaaaa, v35
v_or_b32 v105, 0x44444444, v35
v_and_b32 v35, 15, v1
v_lshlrev_b32 v35, 4, v35
v_lshl_add_u32 v94, v5, 3, v35
s_lshl_b32 s6, s3, 8
s_add_u32 s6, s6, 151552
v_add_u32 v94, s6, v94
v_and_b32 v35, 3, v1
v_lshlrev_b32 v35, 8, v35
v_lshrrev_b32 v36, 4, v1
v_lshl_add_u32 v95, v36, 4, v35
v_add_u32 v95, 151552, v95
s_mul_i32 s15, s3, 36864
s_mov_b32 s80, 0x0
s_mov_b32 s81, 0
s_lshl_b32 s6, s4, 1
s_add_u32 s6, s6, s9
s_mul_i32 s6, s6, 4
s_add_u32 s6, s6, s8
s_lshl_b32 s6, s6, 2
s_add_u32 s6, s6, 393216
s_lshr_b32 s7, s4, 2
s_mul_i32 s7, s7, 4224
s_add_u32 s6, s6, s7
v_mov_b32 v118, 2146435072
v_mov_b32 v117, s6
v_cmp_eq_u32 vcc, 0, v0
s_nop 1
v_cndmask_b32 v118, v118, v117, vcc
v_mov_b32 v117, 3
v_and_b32 v35, 15, v1
v_lshlrev_b32 v35, 5, v35
v_lshl_add_u32 v36, v5, 4, v35
v_lshrrev_b32 v6, 5, v1
v_lshl_add_u32 v36, v6, 9, v36
s_lshl_b32 s6, s3, 10
s_add_u32 s6, s6, 147456
v_add_u32 v36, s6, v36
s_lshl_b32 s6, s83, 9
s_add_u32 s6, s6, 147456
v_add_u32 v35, s6, v35
s_waitcnt vmcnt(35)
v_perm_b32 v60, v40, v40, v12
v_perm_b32 v61, v40, v40, v13
v_perm_b32 v62, v40, v40, v14
v_perm_b32 v63, v40, v40, v15
s_nop 1
v_mfma_f32_16x16x32_bf16 v[20:23], v[60:63], a[96:99], 0
s_add_u32 s34, s14, 49152
s_min_u32 s34, s34, 2146435072
buffer_load_dwordx4 a[16:19], v2, s[56:59], s34 offen offset:0 nt
s_waitcnt vmcnt(35)
v_perm_b32 v64, v40, v40, v16
v_perm_b32 v65, v40, v40, v17
v_perm_b32 v66, v40, v40, v18
v_perm_b32 v67, v40, v40, v19
s_nop 1
v_mfma_f32_16x16x32_bf16 v[20:23], v[64:67], a[100:103], v[20:23]
buffer_load_dwordx4 a[20:23], v2, s[56:59], s34 offen offset:1024 nt
s_waitcnt vmcnt(35)
v_perm_b32 v68, v41, v41, v12
v_perm_b32 v69, v41, v41, v13
v_perm_b32 v70, v41, v41, v14
v_perm_b32 v71, v41, v41, v15
s_nop 1
v_mfma_f32_16x16x32_bf16 v[20:23], v[68:71], a[104:107], v[20:23]
buffer_load_dwordx4 a[24:27], v2, s[56:59], s34 offen offset:2048 nt
s_waitcnt vmcnt(35)
v_perm_b32 v72, v41, v41, v16
v_perm_b32 v73, v41, v41, v17
v_perm_b32 v74, v41, v41, v18
v_perm_b32 v75, v41, v41, v19
s_nop 1
v_mfma_f32_16x16x32_bf16 v[20:23], v[72:75], a[108:111], v[20:23]
buffer_load_dwordx4 a[28:31], v2, s[56:59], s34 offen offset:3072 nt
s_waitcnt vmcnt(35)
v_perm_b32 v60, v42, v42, v12
v_perm_b32 v61, v42, v42, v13
v_perm_b32 v62, v42, v42, v14
v_perm_b32 v63, v42, v42, v15
s_nop 1
v_mfma_f32_16x16x32_bf16 v[20:23], v[60:63], a[112:115], v[20:23]
s_add_u32 s34, s14, 73728
s_min_u32 s34, s34, 2146435072
buffer_load_dwordx4 a[32:35], v2, s[56:59], s34 offen offset:0 nt
s_waitcnt vmcnt(35)
v_perm_b32 v64, v42, v42, v16
v_perm_b32 v65, v42, v42, v17
v_perm_b32 v66, v42, v42, v18
v_perm_b32 v67, v42, v42, v19
s_nop 1
v_mfma_f32_16x16x32_bf16 v[20:23], v[64:67], a[116:119], v[20:23]
buffer_load_dwordx4 a[36:39], v2, s[56:59], s34 offen offset:1024 nt
s_waitcnt vmcnt(35)
v_perm_b32 v68, v43, v43, v12
v_perm_b32 v69, v43, v43, v13
v_perm_b32 v70, v43, v43, v14
v_perm_b32 v71, v43, v43, v15
s_nop 1
v_mfma_f32_16x16x32_bf16 v[20:23], v[68:71], a[120:123], v[20:23]
buffer_load_dwordx4 a[40:43], v2, s[56:59], s34 offen offset:2048 nt
s_waitcnt vmcnt(35)
v_perm_b32 v72, v43, v43, v16
v_perm_b32 v73, v43, v43, v17
v_perm_b32 v74, v43, v43, v18
v_perm_b32 v75, v43, v43, v19
s_nop 1
v_mfma_f32_16x16x32_bf16 v[20:23], v[72:75], a[124:127], v[20:23]
buffer_load_dwordx4 a[44:47], v2, s[56:59], s34 offen offset:3072 nt
s_waitcnt vmcnt(35)
v_perm_b32 v60, v44, v44, v12
v_perm_b32 v61, v44, v44, v13
v_perm_b32 v62, v44, v44, v14
v_perm_b32 v63, v44, v44, v15
s_nop 1
v_mfma_f32_16x16x32_bf16 v[20:23], v[60:63], a[128:131], v[20:23]
s_add_u32 s34, s14, 98304
s_min_u32 s34, s34, 2146435072
buffer_load_dwordx4 a[48:51], v2, s[56:59], s34 offen offset:0 nt
s_waitcnt vmcnt(35)
v_perm_b32 v64, v44, v44, v16
v_perm_b32 v65, v44, v44, v17
v_perm_b32 v66, v44, v44, v18
v_perm_b32 v67, v44, v44, v19
s_nop 1
v_mfma_f32_16x16x32_bf16 v[20:23], v[64:67], a[132:135], v[20:23]
buffer_load_dwordx4 a[52:55], v2, s[56:59], s34 offen offset:1024 nt
s_waitcnt vmcnt(35)
v_perm_b32 v68, v45, v45, v12
v_perm_b32 v69, v45, v45, v13
v_perm_b32 v70, v45, v45, v14
v_perm_b32 v71, v45, v45, v15
s_nop 1
v_mfma_f32_16x16x32_bf16 v[20:23], v[68:71], a[136:139], v[20:23]
buffer_load_dwordx4 a[56:59], v2, s[56:59], s34 offen offset:2048 nt
s_waitcnt vmcnt(35)
v_perm_b32 v72, v45, v45, v16
v_perm_b32 v73, v45, v45, v17
v_perm_b32 v74, v45, v45, v18
v_perm_b32 v75, v45, v45, v19
s_nop 1
v_mfma_f32_16x16x32_bf16 v[20:23], v[72:75], a[140:143], v[20:23]
buffer_load_dwordx4 a[60:63], v2, s[56:59], s34 offen offset:3072 nt
s_waitcnt vmcnt(35)
v_perm_b32 v60, v46, v46, v12
v_perm_b32 v61, v46, v46, v13
v_perm_b32 v62, v46, v46, v14
v_perm_b32 v63, v46, v46, v15
s_nop 1
v_mfma_f32_16x16x32_bf16 v[20:23], v[60:63], a[144:147], v[20:23]
s_add_u32 s34, s14, 122880
s_min_u32 s34, s34, 2146435072
buffer_load_dwordx4 a[64:67], v2, s[56:59], s34 offen offset:0 nt
s_waitcnt vmcnt(35)
v_perm_b32 v64, v46, v46, v16
v_perm_b32 v65, v46, v46, v17
v_perm_b32 v66, v46, v46, v18
v_perm_b32 v67, v46, v46, v19
s_nop 1
v_mfma_f32_16x16x32_bf16 v[20:23], v[64:67], a[148:151], v[20:23]
buffer_load_dwordx4 a[68:71], v2, s[56:59], s34 offen offset:1024 nt
s_waitcnt vmcnt(35)
v_perm_b32 v68, v47, v47, v12
v_perm_b32 v69, v47, v47, v13
v_perm_b32 v70, v47, v47, v14
v_perm_b32 v71, v47, v47, v15
s_nop 1
v_mfma_f32_16x16x32_bf16 v[20:23], v[68:71], a[152:155], v[20:23]
buffer_load_dwordx4 a[72:75], v2, s[56:59], s34 offen offset:2048 nt
s_waitcnt vmcnt(35)
v_perm_b32 v72, v47, v47, v16
v_perm_b32 v73, v47, v47, v17
v_perm_b32 v74, v47, v47, v18
v_perm_b32 v75, v47, v47, v19
s_nop 1
v_mfma_f32_16x16x32_bf16 v[20:23], v[72:75], a[156:159], v[20:23]
buffer_load_dwordx4 a[76:79], v2, s[56:59], s34 offen offset:3072 nt
s_waitcnt vmcnt(35)
v_perm_b32 v60, v48, v48, v12
v_perm_b32 v61, v48, v48, v13
v_perm_b32 v62, v48, v48, v14
v_perm_b32 v63, v48, v48, v15
s_nop 1
v_mfma_f32_16x16x32_bf16 v[20:23], v[60:63], a[160:163], v[20:23]
s_add_u32 s34, s14, 147456
s_min_u32 s34, s34, 2146435072
buffer_load_dwordx4 a[80:83], v2, s[56:59], s34 offen offset:0 nt
s_waitcnt vmcnt(35)
v_perm_b32 v64, v48, v48, v16
v_perm_b32 v65, v48, v48, v17
v_perm_b32 v66, v48, v48, v18
v_perm_b32 v67, v48, v48, v19
s_nop 1
v_mfma_f32_16x16x32_bf16 v[20:23], v[64:67], a[164:167], v[20:23]
buffer_load_dwordx4 a[84:87], v2, s[56:59], s34 offen offset:1024 nt
s_waitcnt vmcnt(35)
v_perm_b32 v68, v49, v49, v12
v_perm_b32 v69, v49, v49, v13
v_perm_b32 v70, v49, v49, v14
v_perm_b32 v71, v49, v49, v15
s_nop 1
v_mfma_f32_16x16x32_bf16 v[20:23], v[68:71], a[168:171], v[20:23]
buffer_load_dwordx4 a[88:91], v2, s[56:59], s34 offen offset:2048 nt
s_waitcnt vmcnt(35)
v_perm_b32 v72, v49, v49, v16
v_perm_b32 v73, v49, v49, v17
v_perm_b32 v74, v49, v49, v18
v_perm_b32 v75, v49, v49, v19
s_nop 1
v_mfma_f32_16x16x32_bf16 v[20:23], v[72:75], a[172:175], v[20:23]
buffer_load_dwordx4 a[92:95], v2, s[56:59], s34 offen offset:3072 nt
s_waitcnt vmcnt(35)
v_perm_b32 v60, v50, v50, v12
v_perm_b32 v61, v50, v50, v13
v_perm_b32 v62, v50, v50, v14
v_perm_b32 v63, v50, v50, v15
s_nop 1
v_mfma_f32_16x16x32_bf16 v[20:23], v[60:63], a[176:179], v[20:23]
s_add_u32 s34, s14, 172032
s_min_u32 s34, s34, 2146435072
buffer_load_dwordx4 a[240:243], v2, s[56:59], s34 offen offset:0 nt
s_waitcnt vmcnt(35)
v_perm_b32 v64, v50, v50, v16
v_perm_b32 v65, v50, v50, v17
v_perm_b32 v66, v50, v50, v18
v_perm_b32 v67, v50, v50, v19
s_nop 1
v_mfma_f32_16x16x32_bf16 v[20:23], v[64:67], a[180:183], v[20:23]
buffer_load_dwordx4 a[244:247], v2, s[56:59], s34 offen offset:1024 nt
s_waitcnt vmcnt(35)
v_perm_b32 v68, v51, v51, v12
v_perm_b32 v69, v51, v51, v13
v_perm_b32 v70, v51, v51, v14
v_perm_b32 v71, v51, v51, v15
s_nop 1
v_mfma_f32_16x16x32_bf16 v[20:23], v[68:71], a[184:187], v[20:23]
buffer_load_dwordx4 a[248:251], v2, s[56:59], s34 offen offset:2048 nt
s_waitcnt vmcnt(35)
v_perm_b32 v72, v51, v51, v16
v_perm_b32 v73, v51, v51, v17
v_perm_b32 v74, v51, v51, v18
v_perm_b32 v75, v51, v51, v19
s_nop 1
v_mfma_f32_16x16x32_bf16 v[20:23], v[72:75], a[188:191], v[20:23]
buffer_load_dwordx4 a[252:255], v2, s[56:59], s34 offen offset:3072 nt
s_waitcnt vmcnt(35)
v_perm_b32 v60, v52, v52, v12
v_perm_b32 v61, v52, v52, v13
v_perm_b32 v62, v52, v52, v14
v_perm_b32 v63, v52, v52, v15
s_nop 1
v_mfma_f32_16x16x32_bf16 v[20:23], v[60:63], a[192:195], v[20:23]
s_waitcnt vmcnt(34)
v_perm_b32 v64, v52, v52, v16
v_perm_b32 v65, v52, v52, v17
v_perm_b32 v66, v52, v52, v18
v_perm_b32 v67, v52, v52, v19
s_nop 1
v_mfma_f32_16x16x32_bf16 v[20:23], v[64:67], a[196:199], v[20:23]
s_waitcnt vmcnt(33)
v_perm_b32 v68, v53, v53, v12
v_perm_b32 v69, v53, v53, v13
v_perm_b32 v70, v53, v53, v14
v_perm_b32 v71, v53, v53, v15
s_nop 1
v_mfma_f32_16x16x32_bf16 v[20:23], v[68:71], a[200:203], v[20:23]
s_waitcnt vmcnt(32)
v_perm_b32 v72, v53, v53, v16
v_perm_b32 v73, v53, v53, v17
v_perm_b32 v74, v53, v53, v18
v_perm_b32 v75, v53, v53, v19
s_nop 1
v_mfma_f32_16x16x32_bf16 v[20:23], v[72:75], a[204:207], v[20:23]
s_waitcnt vmcnt(31)
v_perm_b32 v60, v54, v54, v12
v_perm_b32 v61, v54, v54, v13
v_perm_b32 v62, v54, v54, v14
v_perm_b32 v63, v54, v54, v15
s_nop 1
v_mfma_f32_16x16x32_bf16 v[20:23], v[60:63], a[208:211], v[20:23]
s_waitcnt vmcnt(30)
v_perm_b32 v64, v54, v54, v16
v_perm_b32 v65, v54, v54, v17
v_perm_b32 v66, v54, v54, v18
v_perm_b32 v67, v54, v54, v19
s_nop 1
v_mfma_f32_16x16x32_bf16 v[20:23], v[64:67], a[212:215], v[20:23]
s_waitcnt vmcnt(29)
v_perm_b32 v68, v55, v55, v12
v_perm_b32 v69, v55, v55, v13
v_perm_b32 v70, v55, v55, v14
v_perm_b32 v71, v55, v55, v15
s_nop 1
v_mfma_f32_16x16x32_bf16 v[20:23], v[68:71], a[216:219], v[20:23]
s_waitcnt vmcnt(28)
v_perm_b32 v72, v55, v55, v16
v_perm_b32 v73, v55, v55, v17
v_perm_b32 v74, v55, v55, v18
v_perm_b32 v75, v55, v55, v19
s_nop 1
v_mfma_f32_16x16x32_bf16 v[20:23], v[72:75], a[220:223], v[20:23]
s_waitcnt vmcnt(27)
v_perm_b32 v60, v56, v56, v12
v_perm_b32 v61, v56, v56, v13
v_perm_b32 v62, v56, v56, v14
v_perm_b32 v63, v56, v56, v15
s_nop 1
v_mfma_f32_16x16x32_bf16 v[20:23], v[60:63], a[224:227], v[20:23]
s_waitcnt vmcnt(26)
v_perm_b32 v64, v56, v56, v16
v_perm_b32 v65, v56, v56, v17
v_perm_b32 v66, v56, v56, v18
v_perm_b32 v67, v56, v56, v19
s_nop 1
v_mfma_f32_16x16x32_bf16 v[20:23], v[64:67], a[228:231], v[20:23]
s_waitcnt vmcnt(25)
v_perm_b32 v68, v57, v57, v12
v_perm_b32 v69, v57, v57, v13
v_perm_b32 v70, v57, v57, v14
v_perm_b32 v71, v57, v57, v15
s_nop 1
v_mfma_f32_16x16x32_bf16 v[20:23], v[68:71], a[232:235], v[20:23]
s_waitcnt vmcnt(24)
v_perm_b32 v72, v57, v57, v16
v_perm_b32 v73, v57, v57, v17
v_perm_b32 v74, v57, v57, v18
v_perm_b32 v75, v57, v57, v19
s_nop 1
v_mfma_f32_16x16x32_bf16 v[20:23], v[72:75], a[236:239], v[20:23]
s_nop 7
ds_write_b128 v36, v[20:23]
s_waitcnt lgkmcnt(0)
s_barrier
ds_read_b128 v[40:43], v35 offset:0
ds_read_b128 v[44:47], v35 offset:16
ds_read_b128 v[48:51], v35 offset:1024
ds_read_b128 v[52:55], v35 offset:1040
ds_read_b128 v[56:59], v35 offset:2048
ds_read_b128 v[60:63], v35 offset:2064
ds_read_b128 v[64:67], v35 offset:3072
ds_read_b128 v[68:71], v35 offset:3088
v_mov_b32 v20, 0
v_mov_b32 v21, 0
v_mov_b32 v22, 0
v_mov_b32 v23, 0
s_waitcnt lgkmcnt(0)
v_add_f32 v40, v40, v48
v_add_f32 v56, v56, v64
v_add_f32 v41, v41, v49
v_add_f32 v57, v57, v65
v_add_f32 v42, v42, v50
v_add_f32 v58, v58, v66
v_add_f32 v43, v43, v51
v_add_f32 v59, v59, v67
v_add_f32 v44, v44, v52
v_add_f32 v60, v60, v68
v_add_f32 v45, v45, v53
v_add_f32 v61, v61, v69
v_add_f32 v46, v46, v54
v_add_f32 v62, v62, v70
v_add_f32 v47, v47, v55
v_add_f32 v63, v63, v71
v_add_f32 v40, v40, v56
v_add_f32 v41, v41, v57
v_add_f32 v42, v42, v58
v_add_f32 v43, v43, v59
v_add_f32 v44, v44, v60
v_add_f32 v45, v45, v61
v_add_f32 v46, v46, v62
v_add_f32 v47, v47, v63
v_cvt_pk_bf16_f32 v24, v40, v41
v_cvt_pk_bf16_f32 v25, v42, v43
v_cvt_pk_bf16_f32 v26, v44, v45
v_cvt_pk_bf16_f32 v27, v46, v47
s_add_u32 s14, s14, 196608
K_loop:
s_cmp_lg_u32 s81, 8
s_cbranch_scc1 L_c0_4
buffer_load_dword v96, off, s[68:71], 0 offset:0 sc1
L_c0_4:
s_waitcnt vmcnt(28)
v_dot2_f32_bf16 v28, v120, v24, 0
v_dot2_f32_bf16 v29, v124, v24, 0
v_dot2_f32_bf16 v30, v128, v24, 0
v_dot2_f32_bf16 v31, v132, v24, 0
v_dot2_f32_bf16 v28, v121, v25, v28
v_dot2_f32_bf16 v29, v125, v25, v29
v_dot2_f32_bf16 v30, v129, v25, v30
v_dot2_f32_bf16 v31, v133, v25, v31
v_dot2_f32_bf16 v28, v122, v26, v28
v_dot2_f32_bf16 v29, v126, v26, v29
v_dot2_f32_bf16 v30, v130, v26, v30
v_dot2_f32_bf16 v31, v134, v26, v31
v_dot2_f32_bf16 v28, v123, v27, v28
v_dot2_f32_bf16 v29, v127, v27, v29
v_dot2_f32_bf16 v30, v131, v27, v30
v_dot2_f32_bf16 v31, v135, v27, v31
buffer_load_dwordx4 v[120:123], v2, s[52:55], s12 offen offset:0 nt
buffer_load_dwordx4 v[124:127], v2, s[52:55], s12 offen offset:1024 nt
buffer_load_dwordx4 v[128:131], v2, s[52:55], s12 offen offset:2048 nt
buffer_load_dwordx4 v[132:135], v2, s[52:55], s12 offen offset:3072 nt
s_add_u32 s13, s13, 24576
s_min_u32 s12, s13, 2146435072
s_cmp_ge_u32 s80, 36
s_cbranch_scc1 L_nodma_5
s_mov_b32 m0, s15
s_nop 0
buffer_load_dwordx4 v2, s[60:63], s15 offen  lds
s_add_u32 s15, s15, 1024
L_nodma_5:
s_add_u32 s80, s80, 1
v_add_f32_dpp v32, v28, v28 row_ror:8 row_mask:0xf bank_mask:0x3
v_add_f32_dpp v33, v29, v29 row_ror:8 row_mask:0xf bank_mask:0x3
v_add_f32_dpp v32, v30, v30 row_ror:8 row_mask:0xf bank_mask:0xc
v_add_f32_dpp v33, v31, v31 row_ror:8 row_mask:0xf bank_mask:0xc
s_nop 0
v_add_f32_dpp v34, v32, v32 row_half_mirror row_mask:0xf bank_mask:0x5
v_add_f32_dpp v34, v33, v33 row_half_mirror row_mask:0xf bank_mask:0xa
s_nop 1
v_add_f32_dpp v34, v34, v34 quad_perm:[1,0,3,2] row_mask:0xf bank_mask:0xf
s_nop 1
v_add_f32_dpp v34, v34, v34 quad_perm:[2,3,0,1] row_mask:0xf bank_mask:0xf
v_cndmask_b32 v86, v86, v34, s[72:73]
s_waitcnt vmcnt(28)
v_dot2_f32_bf16 v28, v136, v24, 0
v_dot2_f32_bf16 v29, v140, v24, 0
v_dot2_f32_bf16 v30, v144, v24, 0
v_dot2_f32_bf16 v31, v148, v24, 0
v_dot2_f32_bf16 v28, v137, v25, v28
v_dot2_f32_bf16 v29, v141, v25, v29
v_dot2_f32_bf16 v30, v145, v25, v30
v_dot2_f32_bf16 v31, v149, v25, v31
v_dot2_f32_bf16 v28, v138, v26, v28
v_dot2_f32_bf16 v29, v142, v26, v29
v_dot2_f32_bf16 v30, v146, v26, v30
v_dot2_f32_bf16 v31, v150, v26, v31
v_dot2_f32_bf16 v28, v139, v27, v28
v_dot2_f32_bf16 v29, v143, v27, v29
v_dot2_f32_bf16 v30, v147, v27, v30
v_dot2_f32_bf16 v31, v151, v27, v31
buffer_load_dwordx4 v[136:139], v2, s[52:55], s12 offen offset:0 nt
buffer_load_dwordx4 v[140:143], v2, s[52:55], s12 offen offset:1024 nt
buffer_load_dwordx4 v[144:147], v2, s[52:55], s12 offen offset:2048 nt
buffer_load_dwordx4 v[148:151], v2, s[52:55], s12 offen offset:3072 nt
s_add_u32 s13, s13, 24576
s_min_u32 s12, s13, 2146435072
s_cmp_ge_u32 s80, 36
s_cbranch_scc1 L_nodma_6
s_mov_b32 m0, s15
s_nop 0
buffer_load_dwordx4 v2, s[60:63], s15 offen  lds
s_add_u32 s15, s15, 1024
L_nodma_6:
s_add_u32 s80, s80, 1
v_add_f32_dpp v32, v28, v28 row_ror:8 row_mask:0xf bank_mask:0x3
v_add_f32_dpp v33, v29, v29 row_ror:8 row_mask:0xf bank_mask:0x3
v_add_f32_dpp v32, v30, v30 row_ror:8 row_mask:0xf bank_mask:0xc
v_add_f32_dpp v33, v31, v31 row_ror:8 row_mask:0xf bank_mask:0xc
s_nop 0
v_add_f32_dpp v34, v32, v32 row_half_mirror row_mask:0xf bank_mask:0x5
v_add_f32_dpp v34, v33, v33 row_half_mirror row_mask:0xf bank_mask:0xa
s_nop 1
v_add_f32_dpp v34, v34, v34 quad_perm:[1,0,3,2] row_mask:0xf bank_mask:0xf
s_nop 1
v_add_f32_dpp v34, v34, v34 quad_perm:[2,3,0,1] row_mask:0xf bank_mask:0xf
v_cndmask_b32 v86, v86, v34, s[74:75]
s_waitcnt vmcnt(28)
v_dot2_f32_bf16 v28, v152, v24, 0
v_dot2_f32_bf16 v29, v156, v24, 0
v_dot2_f32_bf16 v30, v160, v24, 0
v_dot2_f32_bf16 v31, v164, v24, 0
v_dot2_f32_bf16 v28, v153, v25, v28
v_dot2_f32_bf16 v29, v157, v25, v29
v_dot2_f32_bf16 v30, v161, v25, v30
v_dot2_f32_bf16 v31, v165, v25, v31
v_dot2_f32_bf16 v28, v154, v26, v28
v_dot2_f32_bf16 v29, v158, v26, v29
v_dot2_f32_bf16 v30, v162, v26, v30
v_dot2_f32_bf16 v31, v166, v26, v31
v_dot2_f32_bf16 v28, v155, v27, v28
v_dot2_f32_bf16 v29, v159, v27, v29
v_dot2_f32_bf16 v30, v163, v27, v30
v_dot2_f32_bf16 v31, v167, v27, v31
buffer_load_dwordx4 v[152:155], v2, s[52:55], s12 offen offset:0 nt
buffer_load_dwordx4 v[156:159], v2, s[52:55], s12 offen offset:1024 nt
buffer_load_dwordx4 v[160:163], v2, s[52:55], s12 offen offset:2048 nt
buffer_load_dwordx4 v[164:167], v2, s[52:55], s12 offen offset:3072 nt
s_add_u32 s13, s13, 24576
s_min_u32 s12, s13, 2146435072
s_cmp_ge_u32 s80, 36
s_cbranch_scc1 L_nodma_7
s_mov_b32 m0, s15
s_nop 0
buffer_load_dwordx4 v2, s[60:63], s15 offen  lds
s_add_u32 s15, s15, 1024
L_nodma_7:
s_add_u32 s80, s80, 1
v_add_f32_dpp v32, v28, v28 row_ror:8 row_mask:0xf bank_mask:0x3
v_add_f32_dpp v33, v29, v29 row_ror:8 row_mask:0xf bank_mask:0x3
v_add_f32_dpp v32, v30, v30 row_ror:8 row_mask:0xf bank_mask:0xc
v_add_f32_dpp v33, v31, v31 row_ror:8 row_mask:0xf bank_mask:0xc
s_nop 0
v_add_f32_dpp v34, v32, v32 row_half_mirror row_mask:0xf bank_mask:0x5
v_add_f32_dpp v34, v33, v33 row_half_mirror row_mask:0xf bank_mask:0xa
s_nop 1
v_add_f32_dpp v34, v34, v34 quad_perm:[1,0,3,2] row_mask:0xf bank_mask:0xf
s_nop 1
v_add_f32_dpp v34, v34, v34 quad_perm:[2,3,0,1] row_mask:0xf bank_mask:0xf
v_cndmask_b32 v86, v86, v34, s[76:77]
s_waitcnt vmcnt(28)
v_dot2_f32_bf16 v28, v168, v24, 0
v_dot2_f32_bf16 v29, v172, v24, 0
v_dot2_f32_bf16 v30, v176, v24, 0
v_dot2_f32_bf16 v31, v180, v24, 0
v_dot2_f32_bf16 v28, v169, v25, v28
v_dot2_f32_bf16 v29, v173, v25, v29
v_dot2_f32_bf16 v30, v177, v25, v30
v_dot2_f32_bf16 v31, v181, v25, v31
v_dot2_f32_bf16 v28, v170, v26, v28
v_dot2_f32_bf16 v29, v174, v26, v29
v_dot2_f32_bf16 v30, v178, v26, v30
v_dot2_f32_bf16 v31, v182, v26, v31
v_dot2_f32_bf16 v28, v171, v27, v28
v_dot2_f32_bf16 v29, v175, v27, v29
v_dot2_f32_bf16 v30, v179, v27, v30
v_dot2_f32_bf16 v31, v183, v27, v31
buffer_load_dwordx4 v[168:171], v2, s[52:55], s12 offen offset:0 nt
buffer_load_dwordx4 v[172:175], v2, s[52:55], s12 offen offset:1024 nt
buffer_load_dwordx4 v[176:179], v2, s[52:55], s12 offen offset:2048 nt
buffer_load_dwordx4 v[180:183], v2, s[52:55], s12 offen offset:3072 nt
s_add_u32 s13, s13, 24576
s_min_u32 s12, s13, 2146435072
s_cmp_ge_u32 s80, 36
s_cbranch_scc1 L_nodma_8
s_mov_b32 m0, s15
s_nop 0
buffer_load_dwordx4 v2, s[60:63], s15 offen  lds
s_add_u32 s15, s15, 1024
L_nodma_8:
s_add_u32 s80, s80, 1
v_add_f32_dpp v32, v28, v28 row_ror:8 row_mask:0xf bank_mask:0x3
v_add_f32_dpp v33, v29, v29 row_ror:8 row_mask:0xf bank_mask:0x3
v_add_f32_dpp v32, v30, v30 row_ror:8 row_mask:0xf bank_mask:0xc
v_add_f32_dpp v33, v31, v31 row_ror:8 row_mask:0xf bank_mask:0xc
s_nop 0
v_add_f32_dpp v34, v32, v32 row_half_mirror row_mask:0xf bank_mask:0x5
v_add_f32_dpp v34, v33, v33 row_half_mirror row_mask:0xf bank_mask:0xa
s_nop 1
v_add_f32_dpp v34, v34, v34 quad_perm:[1,0,3,2] row_mask:0xf bank_mask:0xf
s_nop 1
v_add_f32_dpp v34, v34, v34 quad_perm:[2,3,0,1] row_mask:0xf bank_mask:0xf
v_cndmask_b32 v86, v86, v34, s[78:79]
s_add_u32 s81, s81, 1
s_cmp_eq_u32 s81, 11
s_cbranch_scc1 A_mid
v_mov_b32 v76, v77
v_mov_b32 v77, v78
v_mov_b32 v78, v79
v_mov_b32 v79, v80
v_mov_b32 v80, v81
v_mov_b32 v81, v82
v_mov_b32 v82, v83
v_mov_b32 v83, v84
v_mov_b32 v84, v85
v_mov_b32 v85, v86
s_lshr_b64 s[72:73], s[76:77], 2
s_lshr_b64 s[74:75], s[76:77], 1
s_cmp_eq_u32 s81, 9
s_cselect_b32 s52, s56, s52
s_cselect_b32 s53, s57, s53
s_cselect_b32 s13, s14, s13
s_min_u32 s12, s13, 2146435072
s_waitcnt vmcnt(28)
v_dot2_f32_bf16 v28, v184, v24, 0
v_dot2_f32_bf16 v29, v188, v24, 0
v_dot2_f32_bf16 v30, v192, v24, 0
v_dot2_f32_bf16 v31, v196, v24, 0
v_dot2_f32_bf16 v28, v185, v25, v28
v_dot2_f32_bf16 v29, v189, v25, v29
v_dot2_f32_bf16 v30, v193, v25, v30
v_dot2_f32_bf16 v31, v197, v25, v31
v_dot2_f32_bf16 v28, v186, v26, v28
v_dot2_f32_bf16 v29, v190, v26, v29
v_dot2_f32_bf16 v30, v194, v26, v30
v_dot2_f32_bf16 v31, v198, v26, v31
v_dot2_f32_bf16 v28, v187, v27, v28
v_dot2_f32_bf16 v29, v191, v27, v29
v_dot2_f32_bf16 v30, v195, v27, v30
v_dot2_f32_bf16 v31, v199, v27, v31
buffer_load_dwordx4 v[184:187], v2, s[52:55], s12 offen offset:0 nt
buffer_load_dwordx4 v[188:191], v2, s[52:55], s12 offen offset:1024 nt
buffer_load_dwordx4 v[192:195], v2, s[52:55], s12 offen offset:2048 nt
buffer_load_dwordx4 v[196:199], v2, s[52:55], s12 offen offset:3072 nt
s_add_u32 s13, s13, 24576
s_min_u32 s12, s13, 2146435072
s_cmp_ge_u32 s80, 36
s_cbranch_scc1 L_nodma_9
s_mov_b32 m0, s15
s_nop 0
buffer_load_dwordx4 v2, s[60:63], s15 offen  lds
s_add_u32 s15, s15, 1024
L_nodma_9:
s_add_u32 s80, s80, 1
v_add_f32_dpp v32, v28, v28 row_ror:8 row_mask:0xf bank_mask:0x3
v_add_f32_dpp v33, v29, v29 row_ror:8 row_mask:0xf bank_mask:0x3
v_add_f32_dpp v32, v30, v30 row_ror:8 row_mask:0xf bank_mask:0xc
v_add_f32_dpp v33, v31, v31 row_ror:8 row_mask:0xf bank_mask:0xc
s_nop 0
v_add_f32_dpp v34, v32, v32 row_half_mirror row_mask:0xf bank_mask:0x5
v_add_f32_dpp v34, v33, v33 row_half_mirror row_mask:0xf bank_mask:0xa
s_nop 1
v_add_f32_dpp v34, v34, v34 quad_perm:[1,0,3,2] row_mask:0xf bank_mask:0xf
s_nop 1
v_add_f32_dpp v34, v34, v34 quad_perm:[2,3,0,1] row_mask:0xf bank_mask:0xf
v_cndmask_b32 v86, v86, v34, s[72:73]
s_waitcnt vmcnt(28)
v_dot2_f32_bf16 v28, v200, v24, 0
v_dot2_f32_bf16 v29, v204, v24, 0
v_dot2_f32_bf16 v30, v208, v24, 0
v_dot2_f32_bf16 v31, v212, v24, 0
v_dot2_f32_bf16 v28, v201, v25, v28
v_dot2_f32_bf16 v29, v205, v25, v29
v_dot2_f32_bf16 v30, v209, v25, v30
v_dot2_f32_bf16 v31, v213, v25, v31
v_dot2_f32_bf16 v28, v202, v26, v28
v_dot2_f32_bf16 v29, v206, v26, v29
v_dot2_f32_bf16 v30, v210, v26, v30
v_dot2_f32_bf16 v31, v214, v26, v31
v_dot2_f32_bf16 v28, v203, v27, v28
v_dot2_f32_bf16 v29, v207, v27, v29
v_dot2_f32_bf16 v30, v211, v27, v30
v_dot2_f32_bf16 v31, v215, v27, v31
buffer_load_dwordx4 v[200:203], v2, s[52:55], s12 offen offset:0 nt
buffer_load_dwordx4 v[204:207], v2, s[52:55], s12 offen offset:1024 nt
buffer_load_dwordx4 v[208:211], v2, s[52:55], s12 offen offset:2048 nt
buffer_load_dwordx4 v[212:215], v2, s[52:55], s12 offen offset:3072 nt
s_add_u32 s13, s13, 24576
s_min_u32 s12, s13, 2146435072
s_cmp_ge_u32 s80, 36
s_cbranch_scc1 L_nodma_10
s_mov_b32 m0, s15
s_nop 0
buffer_load_dwordx4 v2, s[60:63], s15 offen  lds
s_add_u32 s15, s15, 1024
L_nodma_10:
s_add_u32 s80, s80, 1
v_add_f32_dpp v32, v28, v28 row_ror:8 row_mask:0xf bank_mask:0x3
v_add_f32_dpp v33, v29, v29 row_ror:8 row_mask:0xf bank_mask:0x3
v_add_f32_dpp v32, v30, v30 row_ror:8 row_mask:0xf bank_mask:0xc
v_add_f32_dpp v33, v31, v31 row_ror:8 row_mask:0xf bank_mask:0xc
s_nop 0
v_add_f32_dpp v34, v32, v32 row_half_mirror row_mask:0xf bank_mask:0x5
v_add_f32_dpp v34, v33, v33 row_half_mirror row_mask:0xf bank_mask:0xa
s_nop 1
v_add_f32_dpp v34, v34, v34 quad_perm:[1,0,3,2] row_mask:0xf bank_mask:0xf
s_nop 1
v_add_f32_dpp v34, v34, v34 quad_perm:[2,3,0,1] row_mask:0xf bank_mask:0xf
v_cndmask_b32 v86, v86, v34, s[74:75]
s_waitcnt vmcnt(28)
v_dot2_f32_bf16 v28, v216, v24, 0
v_dot2_f32_bf16 v29, v220, v24, 0
v_dot2_f32_bf16 v30, v224, v24, 0
v_dot2_f32_bf16 v31, v228, v24, 0
v_dot2_f32_bf16 v28, v217, v25, v28
v_dot2_f32_bf16 v29, v221, v25, v29
v_dot2_f32_bf16 v30, v225, v25, v30
v_dot2_f32_bf16 v31, v229, v25, v31
v_dot2_f32_bf16 v28, v218, v26, v28
v_dot2_f32_bf16 v29, v222, v26, v29
v_dot2_f32_bf16 v30, v226, v26, v30
v_dot2_f32_bf16 v31, v230, v26, v31
v_dot2_f32_bf16 v28, v219, v27, v28
v_dot2_f32_bf16 v29, v223, v27, v29
v_dot2_f32_bf16 v30, v227, v27, v30
v_dot2_f32_bf16 v31, v231, v27, v31
buffer_load_dwordx4 v[216:219], v2, s[52:55], s12 offen offset:0 nt
buffer_load_dwordx4 v[220:223], v2, s[52:55], s12 offen offset:1024 nt
buffer_load_dwordx4 v[224:227], v2, s[52:55], s12 offen offset:2048 nt
buffer_load_dwordx4 v[228:231], v2, s[52:55], s12 offen offset:3072 nt
s_add_u32 s13, s13, 24576
s_min_u32 s12, s13, 2146435072
s_cmp_ge_u32 s80, 36
s_cbranch_scc1 L_nodma_11
s_mov_b32 m0, s15
s_nop 0
buffer_load_dwordx4 v2, s[60:63], s15 offen  lds
s_add_u32 s15, s15, 1024
L_nodma_11:
s_add_u32 s80, s80, 1
v_add_f32_dpp v32, v28, v28 row_ror:8 row_mask:0xf bank_mask:0x3
v_add_f32_dpp v33, v29, v29 row_ror:8 row_mask:0xf bank_mask:0x3
v_add_f32_dpp v32, v30, v30 row_ror:8 row_mask:0xf bank_mask:0xc
v_add_f32_dpp v33, v31, v31 row_ror:8 row_mask:0xf bank_mask:0xc
s_nop 0
v_add_f32_dpp v34, v32, v32 row_half_mirror row_mask:0xf bank_mask:0x5
v_add_f32_dpp v34, v33, v33 row_half_mirror row_mask:0xf bank_mask:0xa
s_nop 1
v_add_f32_dpp v34, v34, v34 quad_perm:[1,0,3,2] row_mask:0xf bank_mask:0xf
s_nop 1
v_add_f32_dpp v34, v34, v34 quad_perm:[2,3,0,1] row_mask:0xf bank_mask:0xf
v_cndmask_b32 v86, v86, v34, s[76:77]
s_waitcnt vmcnt(28)
v_dot2_f32_bf16 v28, v232, v24, 0
v_dot2_f32_bf16 v29, v236, v24, 0
v_dot2_f32_bf16 v30, v240, v24, 0
v_dot2_f32_bf16 v31, v244, v24, 0
v_dot2_f32_bf16 v28, v233, v25, v28
v_dot2_f32_bf16 v29, v237, v25, v29
v_dot2_f32_bf16 v30, v241, v25, v30
v_dot2_f32_bf16 v31, v245, v25, v31
v_dot2_f32_bf16 v28, v234, v26, v28
v_dot2_f32_bf16 v29, v238, v26, v29
v_dot2_f32_bf16 v30, v242, v26, v30
v_dot2_f32_bf16 v31, v246, v26, v31
v_dot2_f32_bf16 v28, v235, v27, v28
v_dot2_f32_bf16 v29, v239, v27, v29
v_dot2_f32_bf16 v30, v243, v27, v30
v_dot2_f32_bf16 v31, v247, v27, v31
buffer_load_dwordx4 v[232:235], v2, s[52:55], s12 offen offset:0 nt
buffer_load_dwordx4 v[236:239], v2, s[52:55], s12 offen offset:1024 nt
buffer_load_dwordx4 v[240:243], v2, s[52:55], s12 offen offset:2048 nt
buffer_load_dwordx4 v[244:247], v2, s[52:55], s12 offen offset:3072 nt
s_add_u32 s13, s13, 24576
s_min_u32 s12, s13, 2146435072
s_cmp_ge_u32 s80, 36
s_cbranch_scc1 L_nodma_12
s_mov_b32 m0, s15
s_nop 0
buffer_load_dwordx4 v2, s[60:63], s15 offen  lds
s_add_u32 s15, s15, 1024
L_nodma_12:
s_add_u32 s80, s80, 1
v_add_f32_dpp v32, v28, v28 row_ror:8 row_mask:0xf bank_mask:0x3
v_add_f32_dpp v33, v29, v29 row_ror:8 row_mask:0xf bank_mask:0x3
v_add_f32_dpp v32, v30, v30 row_ror:8 row_mask:0xf bank_mask:0xc
v_add_f32_dpp v33, v31, v31 row_ror:8 row_mask:0xf bank_mask:0xc
s_nop 0
v_add_f32_dpp v34, v32, v32 row_half_mirror row_mask:0xf bank_mask:0x5
v_add_f32_dpp v34, v33, v33 row_half_mirror row_mask:0xf bank_mask:0xa
s_nop 1
v_add_f32_dpp v34, v34, v34 quad_perm:[1,0,3,2] row_mask:0xf bank_mask:0xf
s_nop 1
v_add_f32_dpp v34, v34, v34 quad_perm:[2,3,0,1] row_mask:0xf bank_mask:0xf
v_cndmask_b32 v86, v86, v34, s[78:79]
s_add_u32 s81, s81, 1
v_mov_b32 v76, v77
v_mov_b32 v77, v78
v_mov_b32 v78, v79
v_mov_b32 v79, v80
v_mov_b32 v80, v81
v_mov_b32 v81, v82
v_mov_b32 v82, v83
v_mov_b32 v83, v84
v_mov_b32 v84, v85
v_mov_b32 v85, v86
s_branch K_loop
A_mid:
v_max3_f32 v35, v76, v77, v78
v_max3_f32 v35, v35, v79, v80
v_max3_f32 v35, v35, v81, v82
v_max3_f32 v35, v35, v83, v84
v_max3_f32 v35, v35, v85, v86
s_nop 1
v_max_f32_dpp v35, v35, v35 row_ror:8 row_mask:0xf bank_mask:0xf
s_nop 1
v_max_f32_dpp v35, v35, v35 row_ror:4 row_mask:0xf bank_mask:0xf
s_nop 1
v_max_f32_dpp v35, v35, v35 row_ror:2 row_mask:0xf bank_mask:0xf
s_nop 1
v_max_f32_dpp v35, v35, v35 row_ror:1 row_mask:0xf bank_mask:0xf
v_mov_b32 v36, v35
s_nop 1
v_permlane16_swap_b32 v35, v36
v_max_f32 v35, v35, v36
v_mov_b32 v36, v35
s_nop 1
v_permlane32_swap_b32 v35, v36
v_max_f32 v35, v35, v36
v_mul_f32 v32, v35, v7
v_fma_f32 v76, v76, v7, -v32
v_fma_f32 v77, v77, v7, -v32
v_fma_f32 v78, v78, v7, -v32
v_fma_f32 v79, v79, v7, -v32
v_fma_f32 v80, v80, v7, -v32
v_fma_f32 v81, v81, v7, -v32
v_fma_f32 v82, v82, v7, -v32
v_fma_f32 v83, v83, v7, -v32
v_fma_f32 v84, v84, v7, -v32
v_fma_f32 v85, v85, v7, -v32
v_fma_f32 v86, v86, v7, -v32
v_exp_f32 v76, v76
v_exp_f32 v77, v77
v_exp_f32 v78, v78
v_exp_f32 v79, v79
v_exp_f32 v80, v80
v_exp_f32 v81, v81
v_exp_f32 v82, v82
v_exp_f32 v83, v83
v_exp_f32 v84, v84
v_exp_f32 v85, v85
v_exp_f32 v86, v86
v_add_f32 v35, v76, v77
v_add_f32 v35, v35, v78
v_add_f32 v35, v35, v79
v_add_f32 v35, v35, v80
v_add_f32 v35, v35, v81
v_add_f32 v35, v35, v82
v_add_f32 v35, v35, v83
v_add_f32 v35, v35, v84
v_add_f32 v35, v35, v85
v_add_f32 v35, v35, v86
v_cvt_pk_bf16_f32 v76, v76, v76
v_cvt_pk_bf16_f32 v77, v77, v77
v_cvt_pk_bf16_f32 v78, v78, v78
v_cvt_pk_bf16_f32 v79, v79, v79
v_cvt_pk_bf16_f32 v80, v80, v80
v_cvt_pk_bf16_f32 v81, v81, v81
v_cvt_pk_bf16_f32 v82, v82, v82
v_cvt_pk_bf16_f32 v83, v83, v83
v_cvt_pk_bf16_f32 v84, v84, v84
v_cvt_pk_bf16_f32 v85, v85, v85
v_cvt_pk_bf16_f32 v86, v86, v86
v_add_f32_dpp v35, v35, v35 row_ror:8 row_mask:0xf bank_mask:0xf
s_nop 1
v_add_f32_dpp v35, v35, v35 row_ror:4 row_mask:0xf bank_mask:0xf
s_nop 1
v_add_f32_dpp v35, v35, v35 row_ror:2 row_mask:0xf bank_mask:0xf
s_nop 1
v_add_f32_dpp v35, v35, v35 row_ror:1 row_mask:0xf bank_mask:0xf
v_mov_b32 v36, v35
s_nop 1
v_permlane16_swap_b32 v35, v36
v_add_f32 v35, v35, v36
v_mov_b32 v36, v35
s_nop 1
v_permlane32_swap_b32 v35, v36
v_add_f32 v35, v35, v36
v_min_u32 v32, -2, v32
v_min_u32 v33, -2, v35
s_mov_b32 s7, 400000
L_ens_13:
v_readfirstlane_b32 s6, v96
s_cmp_ge_u32 s6, 32
s_cbranch_scc1 L_ensd_14
s_sleep 16
buffer_load_dword v96, off, s[68:71], 0 offset:0 sc1
s_waitcnt vmcnt(0)
s_sub_u32 s7, s7, 1
s_cmp_lg_u32 s7, 0
s_cbranch_scc1 L_ens_13
L_ensd_14:
s_lshl_b32 s6, s11, 3
s_add_u32 s6, s6, s82
s_mov_b64 exec, 1
buffer_store_dwordx2 v[32:33], off, s[64:67], s6 sc1
s_mov_b64 exec, -1
v_and_b32_dpp v60, v78, v8 row_newbcast:0 row_mask:0xf bank_mask:0xf
v_and_b32_dpp v61, v78, v9 row_newbcast:0 row_mask:0xf bank_mask:0xf
v_and_b32_dpp v62, v78, v10 row_newbcast:0 row_mask:0xf bank_mask:0xf
v_and_b32_dpp v63, v78, v11 row_newbcast:0 row_mask:0xf bank_mask:0xf
v_and_b32_dpp v64, v78, v8 row_newbcast:4 row_mask:0xf bank_mask:0xf
v_and_b32_dpp v65, v78, v9 row_newbcast:4 row_mask:0xf bank_mask:0xf
v_and_b32_dpp v66, v78, v10 row_newbcast:4 row_mask:0xf bank_mask:0xf
v_and_b32_dpp v67, v78, v11 row_newbcast:4 row_mask:0xf bank_mask:0xf
v_and_b32_dpp v68, v78, v8 row_newbcast:8 row_mask:0xf bank_mask:0xf
v_and_b32_dpp v69, v78, v9 row_newbcast:8 row_mask:0xf bank_mask:0xf
v_and_b32_dpp v70, v78, v10 row_newbcast:8 row_mask:0xf bank_mask:0xf
v_and_b32_dpp v71, v78, v11 row_newbcast:8 row_mask:0xf bank_mask:0xf
v_and_b32_dpp v72, v78, v8 row_newbcast:12 row_mask:0xf bank_mask:0xf
v_and_b32_dpp v73, v78, v9 row_newbcast:12 row_mask:0xf bank_mask:0xf
v_and_b32_dpp v74, v78, v10 row_newbcast:12 row_mask:0xf bank_mask:0xf
v_and_b32_dpp v75, v78, v11 row_newbcast:12 row_mask:0xf bank_mask:0xf
s_waitcnt vmcnt(29)
v_mfma_f32_16x16x32_bf16 v[20:23], v[60:63], v[184:187], v[20:23]
v_mfma_f32_16x16x32_bf16 v[20:23], v[64:67], v[188:191], v[20:23]
v_mfma_f32_16x16x32_bf16 v[20:23], v[68:71], v[192:195], v[20:23]
v_mfma_f32_16x16x32_bf16 v[20:23], v[72:75], v[196:199], v[20:23]
v_add_u32 v117, 1, v117
buffer_store_dword v117, v118, s[64:67], 0 offen
buffer_load_dwordx4 v[184:187], v2, s[52:55], s12 offen offset:0 nt
buffer_load_dwordx4 v[188:191], v2, s[52:55], s12 offen offset:1024 nt
buffer_load_dwordx4 v[192:195], v2, s[52:55], s12 offen offset:2048 nt
buffer_load_dwordx4 v[196:199], v2, s[52:55], s12 offen offset:3072 nt
s_add_u32 s13, s13, 24576
s_min_u32 s12, s13, 2146435072
v_and_b32_dpp v60, v78, v8 row_newbcast:1 row_mask:0xf bank_mask:0xf
v_and_b32_dpp v61, v78, v9 row_newbcast:1 row_mask:0xf bank_mask:0xf
v_and_b32_dpp v62, v78, v10 row_newbcast:1 row_mask:0xf bank_mask:0xf
v_and_b32_dpp v63, v78, v11 row_newbcast:1 row_mask:0xf bank_mask:0xf
v_and_b32_dpp v64, v78, v8 row_newbcast:5 row_mask:0xf bank_mask:0xf
v_and_b32_dpp v65, v78, v9 row_newbcast:5 row_mask:0xf bank_mask:0xf
v_and_b32_dpp v66, v78, v10 row_newbcast:5 row_mask:0xf bank_mask:0xf
v_and_b32_dpp v67, v78, v11 row_newbcast:5 row_mask:0xf bank_mask:0xf
v_and_b32_dpp v68, v78, v8 row_newbcast:9 row_mask:0xf bank_mask:0xf
v_and_b32_dpp v69, v78, v9 row_newbcast:9 row_mask:0xf bank_mask:0xf
v_and_b32_dpp v70, v78, v10 row_newbcast:9 row_mask:0xf bank_mask:0xf
v_and_b32_dpp v71, v78, v11 row_newbcast:9 row_mask:0xf bank_mask:0xf
v_and_b32_dpp v72, v78, v8 row_newbcast:13 row_mask:0xf bank_mask:0xf
v_and_b32_dpp v73, v78, v9 row_newbcast:13 row_mask:0xf bank_mask:0xf
v_and_b32_dpp v74, v78, v10 row_newbcast:13 row_mask:0xf bank_mask:0xf
v_and_b32_dpp v75, v78, v11 row_newbcast:13 row_mask:0xf bank_mask:0xf
s_waitcnt vmcnt(30)
v_mfma_f32_16x16x32_bf16 v[20:23], v[60:63], v[200:203], v[20:23]
v_mfma_f32_16x16x32_bf16 v[20:23], v[64:67], v[204:207], v[20:23]
v_mfma_f32_16x16x32_bf16 v[20:23], v[68:71], v[208:211], v[20:23]
v_mfma_f32_16x16x32_bf16 v[20:23], v[72:75], v[212:215], v[20:23]
v_add_u32 v117, 1, v117
buffer_store_dword v117, v118, s[64:67], 0 offen
buffer_load_dwordx4 v[200:203], v2, s[52:55], s12 offen offset:0 nt
buffer_load_dwordx4 v[204:207], v2, s[52:55], s12 offen offset:1024 nt
buffer_load_dwordx4 v[208:211], v2, s[52:55], s12 offen offset:2048 nt
buffer_load_dwordx4 v[212:215], v2, s[52:55], s12 offen offset:3072 nt
s_add_u32 s13, s13, 24576
s_min_u32 s12, s13, 2146435072
v_and_b32_dpp v60, v76, v8 row_newbcast:1 row_mask:0xf bank_mask:0xf
v_and_b32_dpp v61, v76, v9 row_newbcast:1 row_mask:0xf bank_mask:0xf
v_and_b32_dpp v62, v76, v10 row_newbcast:1 row_mask:0xf bank_mask:0xf
v_and_b32_dpp v63, v76, v11 row_newbcast:1 row_mask:0xf bank_mask:0xf
v_and_b32_dpp v64, v76, v8 row_newbcast:5 row_mask:0xf bank_mask:0xf
v_and_b32_dpp v65, v76, v9 row_newbcast:5 row_mask:0xf bank_mask:0xf
v_and_b32_dpp v66, v76, v10 row_newbcast:5 row_mask:0xf bank_mask:0xf
v_and_b32_dpp v67, v76, v11 row_newbcast:5 row_mask:0xf bank_mask:0xf
v_and_b32_dpp v68, v76, v8 row_newbcast:9 row_mask:0xf bank_mask:0xf
v_and_b32_dpp v69, v76, v9 row_newbcast:9 row_mask:0xf bank_mask:0xf
v_and_b32_dpp v70, v76, v10 row_newbcast:9 row_mask:0xf bank_mask:0xf
v_and_b32_dpp v71, v76, v11 row_newbcast:9 row_mask:0xf bank_mask:0xf
v_and_b32_dpp v72, v76, v8 row_newbcast:13 row_mask:0xf bank_mask:0xf
v_and_b32_dpp v73, v76, v9 row_newbcast:13 row_mask:0xf bank_mask:0xf
v_and_b32_dpp v74, v76, v10 row_newbcast:13 row_mask:0xf bank_mask:0xf
v_and_b32_dpp v75, v76, v11 row_newbcast:13 row_mask:0xf bank_mask:0xf
v_mfma_f32_16x16x32_bf16 v[20:23], v[60:63], a[0:3], v[20:23]
v_mfma_f32_16x16x32_bf16 v[20:23], v[64:67], a[4:7], v[20:23]
v_mfma_f32_16x16x32_bf16 v[20:23], v[68:71], a[8:11], v[20:23]
v_mfma_f32_16x16x32_bf16 v[20:23], v[72:75], a[12:15], v[20:23]
s_nop 3
v_and_b32_dpp v60, v78, v8 row_newbcast:2 row_mask:0xf bank_mask:0xf
v_and_b32_dpp v61, v78, v9 row_newbcast:2 row_mask:0xf bank_mask:0xf
v_and_b32_dpp v62, v78, v10 row_newbcast:2 row_mask:0xf bank_mask:0xf
v_and_b32_dpp v63, v78, v11 row_newbcast:2 row_mask:0xf bank_mask:0xf
v_and_b32_dpp v64, v78, v8 row_newbcast:6 row_mask:0xf bank_mask:0xf
v_and_b32_dpp v65, v78, v9 row_newbcast:6 row_mask:0xf bank_mask:0xf
v_and_b32_dpp v66, v78, v10 row_newbcast:6 row_mask:0xf bank_mask:0xf
v_and_b32_dpp v67, v78, v11 row_newbcast:6 row_mask:0xf bank_mask:0xf
v_and_b32_dpp v68, v78, v8 row_newbcast:10 row_mask:0xf bank_mask:0xf
v_and_b32_dpp v69, v78, v9 row_newbcast:10 row_mask:0xf bank_mask:0xf
v_and_b32_dpp v70, v78, v10 row_newbcast:10 row_mask:0xf bank_mask:0xf
v_and_b32_dpp v71, v78, v11 row_newbcast:10 row_mask:0xf bank_mask:0xf
v_and_b32_dpp v72, v78, v8 row_newbcast:14 row_mask:0xf bank_mask:0xf
v_and_b32_dpp v73, v78, v9 row_newbcast:14 row_mask:0xf bank_mask:0xf
v_and_b32_dpp v74, v78, v10 row_newbcast:14 row_mask:0xf bank_mask:0xf
v_and_b32_dpp v75, v78, v11 row_newbcast:14 row_mask:0xf bank_mask:0xf
s_waitcnt vmcnt(31)
v_mfma_f32_16x16x32_bf16 v[20:23], v[60:63], v[216:219], v[20:23]
v_mfma_f32_16x16x32_bf16 v[20:23], v[64:67], v[220:223], v[20:23]
v_mfma_f32_16x16x32_bf16 v[20:23], v[68:71], v[224:227], v[20:23]
v_mfma_f32_16x16x32_bf16 v[20:23], v[72:75], v[228:231], v[20:23]
v_add_u32 v117, 1, v117
buffer_store_dword v117, v118, s[64:67], 0 offen
buffer_load_dwordx4 v[216:219], v2, s[52:55], s12 offen offset:0 nt
buffer_load_dwordx4 v[220:223], v2, s[52:55], s12 offen offset:1024 nt
buffer_load_dwordx4 v[224:227], v2, s[52:55], s12 offen offset:2048 nt
buffer_load_dwordx4 v[228:231], v2, s[52:55], s12 offen offset:3072 nt
s_add_u32 s13, s13, 24576
s_min_u32 s12, s13, 2146435072
v_and_b32_dpp v60, v78, v8 row_newbcast:3 row_mask:0xf bank_mask:0xf
v_and_b32_dpp v61, v78, v9 row_newbcast:3 row_mask:0xf bank_mask:0xf
v_and_b32_dpp v62, v78, v10 row_newbcast:3 row_mask:0xf bank_mask:0xf
v_and_b32_dpp v63, v78, v11 row_newbcast:3 row_mask:0xf bank_mask:0xf
v_and_b32_dpp v64, v78, v8 row_newbcast:7 row_mask:0xf bank_mask:0xf
v_and_b32_dpp v65, v78, v9 row_newbcast:7 row_mask:0xf bank_mask:0xf
v_and_b32_dpp v66, v78, v10 row_newbcast:7 row_mask:0xf bank_mask:0xf
v_and_b32_dpp v67, v78, v11 row_newbcast:7 row_mask:0xf bank_mask:0xf
v_and_b32_dpp v68, v78, v8 row_newbcast:11 row_mask:0xf bank_mask:0xf
v_and_b32_dpp v69, v78, v9 row_newbcast:11 row_mask:0xf bank_mask:0xf
v_and_b32_dpp v70, v78, v10 row_newbcast:11 row_mask:0xf bank_mask:0xf
v_and_b32_dpp v71, v78, v11 row_newbcast:11 row_mask:0xf bank_mask:0xf
v_and_b32_dpp v72, v78, v8 row_newbcast:15 row_mask:0xf bank_mask:0xf
v_and_b32_dpp v73, v78, v9 row_newbcast:15 row_mask:0xf bank_mask:0xf
v_and_b32_dpp v74, v78, v10 row_newbcast:15 row_mask:0xf bank_mask:0xf
v_and_b32_dpp v75, v78, v11 row_newbcast:15 row_mask:0xf bank_mask:0xf
s_waitcnt vmcnt(32)
v_mfma_f32_16x16x32_bf16 v[20:23], v[60:63], v[232:235], v[20:23]
v_mfma_f32_16x16x32_bf16 v[20:23], v[64:67], v[236:239], v[20:23]
v_mfma_f32_16x16x32_bf16 v[20:23], v[68:71], v[240:243], v[20:23]
v_mfma_f32_16x16x32_bf16 v[20:23], v[72:75], v[244:247], v[20:23]
v_add_u32 v117, 1, v117
buffer_store_dword v117, v118, s[64:67], 0 offen
buffer_load_dwordx4 v[232:235], v2, s[52:55], s12 offen offset:0 nt
buffer_load_dwordx4 v[236:239], v2, s[52:55], s12 offen offset:1024 nt
buffer_load_dwordx4 v[240:243], v2, s[52:55], s12 offen offset:2048 nt
buffer_load_dwordx4 v[244:247], v2, s[52:55], s12 offen offset:3072 nt
s_add_u32 s13, s13, 24576
s_min_u32 s12, s13, 2146435072
s_barrier
ds_read_b64_tr_b16 a[96:97], v88 offset:0
ds_read_b64_tr_b16 a[98:99], v88 offset:2304
ds_read_b64_tr_b16 a[100:101], v88 offset:18432
ds_read_b64_tr_b16 a[102:103], v88 offset:20736
v_and_b32_dpp v60, v79, v8 row_newbcast:0 row_mask:0xf bank_mask:0xf
v_and_b32_dpp v61, v79, v9 row_newbcast:0 row_mask:0xf bank_mask:0xf
v_and_b32_dpp v62, v79, v10 row_newbcast:0 row_mask:0xf bank_mask:0xf
v_and_b32_dpp v63, v79, v11 row_newbcast:0 row_mask:0xf bank_mask:0xf
v_and_b32_dpp v64, v79, v8 row_newbcast:4 row_mask:0xf bank_mask:0xf
v_and_b32_dpp v65, v79, v9 row_newbcast:4 row_mask:0xf bank_mask:0xf
v_and_b32_dpp v66, v79, v10 row_newbcast:4 row_mask:0xf bank_mask:0xf
v_and_b32_dpp v67, v79, v11 row_newbcast:4 row_mask:0xf bank_mask:0xf
v_and_b32_dpp v68, v79, v8 row_newbcast:8 row_mask:0xf bank_mask:0xf
v_and_b32_dpp v69, v79, v9 row_newbcast:8 row_mask:0xf bank_mask:0xf
v_and_b32_dpp v70, v79, v10 row_newbcast:8 row_mask:0xf bank_mask:0xf
v_and_b32_dpp v71, v79, v11 row_newbcast:8 row_mask:0xf bank_mask:0xf
v_and_b32_dpp v72, v79, v8 row_newbcast:12 row_mask:0xf bank_mask:0xf
v_and_b32_dpp v73, v79, v9 row_newbcast:12 row_mask:0xf bank_mask:0xf
v_and_b32_dpp v74, v79, v10 row_newbcast:12 row_mask:0xf bank_mask:0xf
v_and_b32_dpp v75, v79, v11 row_newbcast:12 row_mask:0xf bank_mask:0xf
s_waitcnt vmcnt(33)
v_mfma_f32_16x16x32_bf16 v[20:23], v[60:63], v[120:123], v[20:23]
v_mfma_f32_16x16x32_bf16 v[20:23], v[64:67], v[124:127], v[20:23]
v_mfma_f32_16x16x32_bf16 v[20:23], v[68:71], v[128:131], v[20:23]
v_mfma_f32_16x16x32_bf16 v[20:23], v[72:75], v[132:135], v[20:23]
v_add_u32 v117, 1, v117
buffer_store_dword v117, v118, s[64:67], 0 offen
buffer_load_dwordx4 v[120:123], v2, s[52:55], s12 offen offset:0 nt
buffer_load_dwordx4 v[124:127], v2, s[52:55], s12 offen offset:1024 nt
buffer_load_dwordx4 v[128:131], v2, s[52:55], s12 offen offset:2048 nt
buffer_load_dwordx4 v[132:135], v2, s[52:55], s12 offen offset:3072 nt
s_add_u32 s13, s13, 24576
s_min_u32 s12, s13, 2146435072
ds_read_b64_tr_b16 a[104:105], v88 offset:36864
ds_read_b64_tr_b16 a[106:107], v88 offset:39168
ds_read_b64_tr_b16 a[108:109], v88 offset:55296
ds_read_b64_tr_b16 a[110:111], v88 offset:57600
v_and_b32_dpp v60, v79, v8 row_newbcast:1 row_mask:0xf bank_mask:0xf
v_and_b32_dpp v61, v79, v9 row_newbcast:1 row_mask:0xf bank_mask:0xf
v_and_b32_dpp v62, v79, v10 row_newbcast:1 row_mask:0xf bank_mask:0xf
v_and_b32_dpp v63, v79, v11 row_newbcast:1 row_mask:0xf bank_mask:0xf
v_and_b32_dpp v64, v79, v8 row_newbcast:5 row_mask:0xf bank_mask:0xf
v_and_b32_dpp v65, v79, v9 row_newbcast:5 row_mask:0xf bank_mask:0xf
v_and_b32_dpp v66, v79, v10 row_newbcast:5 row_mask:0xf bank_mask:0xf
v_and_b32_dpp v67, v79, v11 row_newbcast:5 row_mask:0xf bank_mask:0xf
v_and_b32_dpp v68, v79, v8 row_newbcast:9 row_mask:0xf bank_mask:0xf
v_and_b32_dpp v69, v79, v9 row_newbcast:9 row_mask:0xf bank_mask:0xf
v_and_b32_dpp v70, v79, v10 row_newbcast:9 row_mask:0xf bank_mask:0xf
v_and_b32_dpp v71, v79, v11 row_newbcast:9 row_mask:0xf bank_mask:0xf
v_and_b32_dpp v72, v79, v8 row_newbcast:13 row_mask:0xf bank_mask:0xf
v_and_b32_dpp v73, v79, v9 row_newbcast:13 row_mask:0xf bank_mask:0xf
v_and_b32_dpp v74, v79, v10 row_newbcast:13 row_mask:0xf bank_mask:0xf
v_and_b32_dpp v75, v79, v11 row_newbcast:13 row_mask:0xf bank_mask:0xf
s_waitcnt vmcnt(34)
v_mfma_f32_16x16x32_bf16 v[20:23], v[60:63], v[136:139], v[20:23]
v_mfma_f32_16x16x32_bf16 v[20:23], v[64:67], v[140:143], v[20:23]
v_mfma_f32_16x16x32_bf16 v[20:23], v[68:71], v[144:147], v[20:23]
v_mfma_f32_16x16x32_bf16 v[20:23], v[72:75], v[148:151], v[20:23]
v_add_u32 v117, 1, v117
buffer_store_dword v117, v118, s[64:67], 0 offen
buffer_load_dwordx4 v[136:139], v2, s[52:55], s12 offen offset:0 nt
buffer_load_dwordx4 v[140:143], v2, s[52:55], s12 offen offset:1024 nt
buffer_load_dwordx4 v[144:147], v2, s[52:55], s12 offen offset:2048 nt
buffer_load_dwordx4 v[148:151], v2, s[52:55], s12 offen offset:3072 nt
s_add_u32 s13, s13, 24576
s_min_u32 s12, s13, 2146435072
ds_read_b64_tr_b16 a[112:113], v90 offset:0
ds_read_b64_tr_b16 a[114:115], v90 offset:2304
ds_read_b64_tr_b16 a[116:117], v90 offset:18432
ds_read_b64_tr_b16 a[118:119], v90 offset:20736
v_and_b32_dpp v60, v76, v8 row_newbcast:2 row_mask:0xf bank_mask:0xf
v_and_b32_dpp v61, v76, v9 row_newbcast:2 row_mask:0xf bank_mask:0xf
v_and_b32_dpp v62, v76, v10 row_newbcast:2 row_mask:0xf bank_mask:0xf
v_and_b32_dpp v63, v76, v11 row_newbcast:2 row_mask:0xf bank_mask:0xf
v_and_b32_dpp v64, v76, v8 row_newbcast:6 row_mask:0xf bank_mask:0xf
v_and_b32_dpp v65, v76, v9 row_newbcast:6 row_mask:0xf bank_mask:0xf
v_and_b32_dpp v66, v76, v10 row_newbcast:6 row_mask:0xf bank_mask:0xf
v_and_b32_dpp v67, v76, v11 row_newbcast:6 row_mask:0xf bank_mask:0xf
v_and_b32_dpp v68, v76, v8 row_newbcast:10 row_mask:0xf bank_mask:0xf
v_and_b32_dpp v69, v76, v9 row_newbcast:10 row_mask:0xf bank_mask:0xf
v_and_b32_dpp v70, v76, v10 row_newbcast:10 row_mask:0xf bank_mask:0xf
v_and_b32_dpp v71, v76, v11 row_newbcast:10 row_mask:0xf bank_mask:0xf
v_and_b32_dpp v72, v76, v8 row_newbcast:14 row_mask:0xf bank_mask:0xf
v_and_b32_dpp v73, v76, v9 row_newbcast:14 row_mask:0xf bank_mask:0xf
v_and_b32_dpp v74, v76, v10 row_newbcast:14 row_mask:0xf bank_mask:0xf
v_and_b32_dpp v75, v76, v11 row_newbcast:14 row_mask:0xf bank_mask:0xf
v_mfma_f32_16x16x32_bf16 v[20:23], v[60:63], a[16:19], v[20:23]
v_mfma_f32_16x16x32_bf16 v[20:23], v[64:67], a[20:23], v[20:23]
v_mfma_f32_16x16x32_bf16 v[20:23], v[68:71], a[24:27], v[20:23]
v_mfma_f32_16x16x32_bf16 v[20:23], v[72:75], a[28:31], v[20:23]
s_nop 3
v_and_b32_dpp v60, v79, v8 row_newbcast:2 row_mask:0xf bank_mask:0xf
v_and_b32_dpp v61, v79, v9 row_newbcast:2 row_mask:0xf bank_mask:0xf
v_and_b32_dpp v62, v79, v10 row_newbcast:2 row_mask:0xf bank_mask:0xf
v_and_b32_dpp v63, v79, v11 row_newbcast:2 row_mask:0xf bank_mask:0xf
v_and_b32_dpp v64, v79, v8 row_newbcast:6 row_mask:0xf bank_mask:0xf
v_and_b32_dpp v65, v79, v9 row_newbcast:6 row_mask:0xf bank_mask:0xf
v_and_b32_dpp v66, v79, v10 row_newbcast:6 row_mask:0xf bank_mask:0xf
v_and_b32_dpp v67, v79, v11 row_newbcast:6 row_mask:0xf bank_mask:0xf
v_and_b32_dpp v68, v79, v8 row_newbcast:10 row_mask:0xf bank_mask:0xf
v_and_b32_dpp v69, v79, v9 row_newbcast:10 row_mask:0xf bank_mask:0xf
v_and_b32_dpp v70, v79, v10 row_newbcast:10 row_mask:0xf bank_mask:0xf
v_and_b32_dpp v71, v79, v11 row_newbcast:10 row_mask:0xf bank_mask:0xf
v_and_b32_dpp v72, v79, v8 row_newbcast:14 row_mask:0xf bank_mask:0xf
v_and_b32_dpp v73, v79, v9 row_newbcast:14 row_mask:0xf bank_mask:0xf
v_and_b32_dpp v74, v79, v10 row_newbcast:14 row_mask:0xf bank_mask:0xf
v_and_b32_dpp v75, v79, v11 row_newbcast:14 row_mask:0xf bank_mask:0xf
s_waitcnt vmcnt(35)
v_mfma_f32_16x16x32_bf16 v[20:23], v[60:63], v[152:155], v[20:23]
v_mfma_f32_16x16x32_bf16 v[20:23], v[64:67], v[156:159], v[20:23]
v_mfma_f32_16x16x32_bf16 v[20:23], v[68:71], v[160:163], v[20:23]
v_mfma_f32_16x16x32_bf16 v[20:23], v[72:75], v[164:167], v[20:23]
v_add_u32 v117, 1, v117
buffer_store_dword v117, v118, s[64:67], 0 offen
buffer_load_dwordx4 v[152:155], v2, s[52:55], s12 offen offset:0 nt
buffer_load_dwordx4 v[156:159], v2, s[52:55], s12 offen offset:1024 nt
buffer_load_dwordx4 v[160:163], v2, s[52:55], s12 offen offset:2048 nt
buffer_load_dwordx4 v[164:167], v2, s[52:55], s12 offen offset:3072 nt
s_add_u32 s13, s13, 24576
s_min_u32 s12, s13, 2146435072
ds_read_b64_tr_b16 a[120:121], v90 offset:36864
ds_read_b64_tr_b16 a[122:123], v90 offset:39168
ds_read_b64_tr_b16 a[124:125], v90 offset:55296
ds_read_b64_tr_b16 a[126:127], v90 offset:57600
v_and_b32_dpp v60, v79, v8 row_newbcast:3 row_mask:0xf bank_mask:0xf
v_and_b32_dpp v61, v79, v9 row_newbcast:3 row_mask:0xf bank_mask:0xf
v_and_b32_dpp v62, v79, v10 row_newbcast:3 row_mask:0xf bank_mask:0xf
v_and_b32_dpp v63, v79, v11 row_newbcast:3 row_mask:0xf bank_mask:0xf
v_and_b32_dpp v64, v79, v8 row_newbcast:7 row_mask:0xf bank_mask:0xf
v_and_b32_dpp v65, v79, v9 row_newbcast:7 row_mask:0xf bank_mask:0xf
v_and_b32_dpp v66, v79, v10 row_newbcast:7 row_mask:0xf bank_mask:0xf
v_and_b32_dpp v67, v79, v11 row_newbcast:7 row_mask:0xf bank_mask:0xf
v_and_b32_dpp v68, v79, v8 row_newbcast:11 row_mask:0xf bank_mask:0xf
v_and_b32_dpp v69, v79, v9 row_newbcast:11 row_mask:0xf bank_mask:0xf
v_and_b32_dpp v70, v79, v10 row_newbcast:11 row_mask:0xf bank_mask:0xf
v_and_b32_dpp v71, v79, v11 row_newbcast:11 row_mask:0xf bank_mask:0xf
v_and_b32_dpp v72, v79, v8 row_newbcast:15 row_mask:0xf bank_mask:0xf
v_and_b32_dpp v73, v79, v9 row_newbcast:15 row_mask:0xf bank_mask:0xf
v_and_b32_dpp v74, v79, v10 row_newbcast:15 row_mask:0xf bank_mask:0xf
v_and_b32_dpp v75, v79, v11 row_newbcast:15 row_mask:0xf bank_mask:0xf
s_waitcnt vmcnt(36)
v_mfma_f32_16x16x32_bf16 v[20:23], v[60:63], v[168:171], v[20:23]
v_mfma_f32_16x16x32_bf16 v[20:23], v[64:67], v[172:175], v[20:23]
v_mfma_f32_16x16x32_bf16 v[20:23], v[68:71], v[176:179], v[20:23]
v_mfma_f32_16x16x32_bf16 v[20:23], v[72:75], v[180:183], v[20:23]
v_add_u32 v117, 1, v117
buffer_store_dword v117, v118, s[64:67], 0 offen
buffer_load_dwordx4 v[168:171], v2, s[52:55], s12 offen offset:0 nt
buffer_load_dwordx4 v[172:175], v2, s[52:55], s12 offen offset:1024 nt
buffer_load_dwordx4 v[176:179], v2, s[52:55], s12 offen offset:2048 nt
buffer_load_dwordx4 v[180:183], v2, s[52:55], s12 offen offset:3072 nt
s_add_u32 s13, s13, 24576
s_min_u32 s12, s13, 2146435072
ds_read_b64_tr_b16 a[128:129], v88 offset:8
ds_read_b64_tr_b16 a[130:131], v88 offset:2312
ds_read_b64_tr_b16 a[132:133], v88 offset:18440
ds_read_b64_tr_b16 a[134:135], v88 offset:20744
v_and_b32_dpp v60, v80, v8 row_newbcast:0 row_mask:0xf bank_mask:0xf
v_and_b32_dpp v61, v80, v9 row_newbcast:0 row_mask:0xf bank_mask:0xf
v_and_b32_dpp v62, v80, v10 row_newbcast:0 row_mask:0xf bank_mask:0xf
v_and_b32_dpp v63, v80, v11 row_newbcast:0 row_mask:0xf bank_mask:0xf
v_and_b32_dpp v64, v80, v8 row_newbcast:4 row_mask:0xf bank_mask:0xf
v_and_b32_dpp v65, v80, v9 row_newbcast:4 row_mask:0xf bank_mask:0xf
v_and_b32_dpp v66, v80, v10 row_newbcast:4 row_mask:0xf bank_mask:0xf
v_and_b32_dpp v67, v80, v11 row_newbcast:4 row_mask:0xf bank_mask:0xf
v_and_b32_dpp v68, v80, v8 row_newbcast:8 row_mask:0xf bank_mask:0xf
v_and_b32_dpp v69, v80, v9 row_newbcast:8 row_mask:0xf bank_mask:0xf
v_and_b32_dpp v70, v80, v10 row_newbcast:8 row_mask:0xf bank_mask:0xf
v_and_b32_dpp v71, v80, v11 row_newbcast:8 row_mask:0xf bank_mask:0xf
v_and_b32_dpp v72, v80, v8 row_newbcast:12 row_mask:0xf bank_mask:0xf
v_and_b32_dpp v73, v80, v9 row_newbcast:12 row_mask:0xf bank_mask:0xf
v_and_b32_dpp v74, v80, v10 row_newbcast:12 row_mask:0xf bank_mask:0xf
v_and_b32_dpp v75, v80, v11 row_newbcast:12 row_mask:0xf bank_mask:0xf
s_waitcnt vmcnt(35)
v_mfma_f32_16x16x32_bf16 v[20:23], v[60:63], v[184:187], v[20:23]
v_mfma_f32_16x16x32_bf16 v[20:23], v[64:67], v[188:191], v[20:23]
v_mfma_f32_16x16x32_bf16 v[20:23], v[68:71], v[192:195], v[20:23]
v_mfma_f32_16x16x32_bf16 v[20:23], v[72:75], v[196:199], v[20:23]
v_add_u32 v117, 1, v117
buffer_store_dword v117, v118, s[64:67], 0 offen
buffer_load_dwordx4 v[184:187], v2, s[52:55], s12 offen offset:0 nt
buffer_load_dwordx4 v[188:191], v2, s[52:55], s12 offen offset:1024 nt
buffer_load_dwordx4 v[192:195], v2, s[52:55], s12 offen offset:2048 nt
buffer_load_dwordx4 v[196:199], v2, s[52:55], s12 offen offset:3072 nt
s_add_u32 s13, s13, 24576
s_min_u32 s12, s13, 2146435072
ds_read_b64_tr_b16 a[136:137], v88 offset:36872
ds_read_b64_tr_b16 a[138:139], v88 offset:39176
ds_read_b64_tr_b16 a[140:141], v88 offset:55304
ds_read_b64_tr_b16 a[142:143], v88 offset:57608
v_and_b32_dpp v60, v80, v8 row_newbcast:1 row_mask:0xf bank_mask:0xf
v_and_b32_dpp v61, v80, v9 row_newbcast:1 row_mask:0xf bank_mask:0xf
v_and_b32_dpp v62, v80, v10 row_newbcast:1 row_mask:0xf bank_mask:0xf
v_and_b32_dpp v63, v80, v11 row_newbcast:1 row_mask:0xf bank_mask:0xf
v_and_b32_dpp v64, v80, v8 row_newbcast:5 row_mask:0xf bank_mask:0xf
v_and_b32_dpp v65, v80, v9 row_newbcast:5 row_mask:0xf bank_mask:0xf
v_and_b32_dpp v66, v80, v10 row_newbcast:5 row_mask:0xf bank_mask:0xf
v_and_b32_dpp v67, v80, v11 row_newbcast:5 row_mask:0xf bank_mask:0xf
v_and_b32_dpp v68, v80, v8 row_newbcast:9 row_mask:0xf bank_mask:0xf
v_and_b32_dpp v69, v80, v9 row_newbcast:9 row_mask:0xf bank_mask:0xf
v_and_b32_dpp v70, v80, v10 row_newbcast:9 row_mask:0xf bank_mask:0xf
v_and_b32_dpp v71, v80, v11 row_newbcast:9 row_mask:0xf bank_mask:0xf
v_and_b32_dpp v72, v80, v8 row_newbcast:13 row_mask:0xf bank_mask:0xf
v_and_b32_dpp v73, v80, v9 row_newbcast:13 row_mask:0xf bank_mask:0xf
v_and_b32_dpp v74, v80, v10 row_newbcast:13 row_mask:0xf bank_mask:0xf
v_and_b32_dpp v75, v80, v11 row_newbcast:13 row_mask:0xf bank_mask:0xf
s_waitcnt vmcnt(35)
v_mfma_f32_16x16x32_bf16 v[20:23], v[60:63], v[200:203], v[20:23]
v_mfma_f32_16x16x32_bf16 v[20:23], v[64:67], v[204:207], v[20:23]
v_mfma_f32_16x16x32_bf16 v[20:23], v[68:71], v[208:211], v[20:23]
v_mfma_f32_16x16x32_bf16 v[20:23], v[72:75], v[212:215], v[20:23]
v_add_u32 v117, 1, v117
buffer_store_dword v117, v118, s[64:67], 0 offen
buffer_load_dwordx4 v[200:203], v2, s[52:55], s12 offen offset:0 nt
buffer_load_dwordx4 v[204:207], v2, s[52:55], s12 offen offset:1024 nt
buffer_load_dwordx4 v[208:211], v2, s[52:55], s12 offen offset:2048 nt
buffer_load_dwordx4 v[212:215], v2, s[52:55], s12 offen offset:3072 nt
s_add_u32 s13, s13, 24576
s_min_u32 s12, s13, 2146435072
ds_read_b64_tr_b16 a[144:145], v90 offset:8
ds_read_b64_tr_b16 a[146:147], v90 offset:2312
ds_read_b64_tr_b16 a[148:149], v90 offset:18440
ds_read_b64_tr_b16 a[150:151], v90 offset:20744
v_and_b32_dpp v60, v76, v8 row_newbcast:3 row_mask:0xf bank_mask:0xf
v_and_b32_dpp v61, v76, v9 row_newbcast:3 row_mask:0xf bank_mask:0xf
v_and_b32_dpp v62, v76, v10 row_newbcast:3 row_mask:0xf bank_mask:0xf
v_and_b32_dpp v63, v76, v11 row_newbcast:3 row_mask:0xf bank_mask:0xf
v_and_b32_dpp v64, v76, v8 row_newbcast:7 row_mask:0xf bank_mask:0xf
v_and_b32_dpp v65, v76, v9 row_newbcast:7 row_mask:0xf bank_mask:0xf
v_and_b32_dpp v66, v76, v10 row_newbcast:7 row_mask:0xf bank_mask:0xf
v_and_b32_dpp v67, v76, v11 row_newbcast:7 row_mask:0xf bank_mask:0xf
v_and_b32_dpp v68, v76, v8 row_newbcast:11 row_mask:0xf bank_mask:0xf
v_and_b32_dpp v69, v76, v9 row_newbcast:11 row_mask:0xf bank_mask:0xf
v_and_b32_dpp v70, v76, v10 row_newbcast:11 row_mask:0xf bank_mask:0xf
v_and_b32_dpp v71, v76, v11 row_newbcast:11 row_mask:0xf bank_mask:0xf
v_and_b32_dpp v72, v76, v8 row_newbcast:15 row_mask:0xf bank_mask:0xf
v_and_b32_dpp v73, v76, v9 row_newbcast:15 row_mask:0xf bank_mask:0xf
v_and_b32_dpp v74, v76, v10 row_newbcast:15 row_mask:0xf bank_mask:0xf
v_and_b32_dpp v75, v76, v11 row_newbcast:15 row_mask:0xf bank_mask:0xf
v_mfma_f32_16x16x32_bf16 v[20:23], v[60:63], a[32:35], v[20:23]
v_mfma_f32_16x16x32_bf16 v[20:23], v[64:67], a[36:39], v[20:23]
v_mfma_f32_16x16x32_bf16 v[20:23], v[68:71], a[40:43], v[20:23]
v_mfma_f32_16x16x32_bf16 v[20:23], v[72:75], a[44:47], v[20:23]
s_nop 3
v_and_b32_dpp v60, v80, v8 row_newbcast:2 row_mask:0xf bank_mask:0xf
v_and_b32_dpp v61, v80, v9 row_newbcast:2 row_mask:0xf bank_mask:0xf
v_and_b32_dpp v62, v80, v10 row_newbcast:2 row_mask:0xf bank_mask:0xf
v_and_b32_dpp v63, v80, v11 row_newbcast:2 row_mask:0xf bank_mask:0xf
v_and_b32_dpp v64, v80, v8 row_newbcast:6 row_mask:0xf bank_mask:0xf
v_and_b32_dpp v65, v80, v9 row_newbcast:6 row_mask:0xf bank_mask:0xf
v_and_b32_dpp v66, v80, v10 row_newbcast:6 row_mask:0xf bank_mask:0xf
v_and_b32_dpp v67, v80, v11 row_newbcast:6 row_mask:0xf bank_mask:0xf
v_and_b32_dpp v68, v80, v8 row_newbcast:10 row_mask:0xf bank_mask:0xf
v_and_b32_dpp v69, v80, v9 row_newbcast:10 row_mask:0xf bank_mask:0xf
v_and_b32_dpp v70, v80, v10 row_newbcast:10 row_mask:0xf bank_mask:0xf
v_and_b32_dpp v71, v80, v11 row_newbcast:10 row_mask:0xf bank_mask:0xf
v_and_b32_dpp v72, v80, v8 row_newbcast:14 row_mask:0xf bank_mask:0xf
v_and_b32_dpp v73, v80, v9 row_newbcast:14 row_mask:0xf bank_mask:0xf
v_and_b32_dpp v74, v80, v10 row_newbcast:14 row_mask:0xf bank_mask:0xf
v_and_b32_dpp v75, v80, v11 row_newbcast:14 row_mask:0xf bank_mask:0xf
s_waitcnt vmcnt(35)
v_mfma_f32_16x16x32_bf16 v[20:23], v[60:63], v[216:219], v[20:23]
v_mfma_f32_16x16x32_bf16 v[20:23], v[64:67], v[220:223], v[20:23]
v_mfma_f32_16x16x32_bf16 v[20:23], v[68:71], v[224:227], v[20:23]
v_mfma_f32_16x16x32_bf16 v[20:23], v[72:75], v[228:231], v[20:23]
v_add_u32 v117, 1, v117
buffer_store_dword v117, v118, s[64:67], 0 offen
buffer_load_dwordx4 v[216:219], v2, s[52:55], s12 offen offset:0 nt
buffer_load_dwordx4 v[220:223], v2, s[52:55], s12 offen offset:1024 nt
buffer_load_dwordx4 v[224:227], v2, s[52:55], s12 offen offset:2048 nt
buffer_load_dwordx4 v[228:231], v2, s[52:55], s12 offen offset:3072 nt
s_add_u32 s13, s13, 24576
s_min_u32 s12, s13, 2146435072
ds_read_b64_tr_b16 a[152:153], v90 offset:36872
ds_read_b64_tr_b16 a[154:155], v90 offset:39176
ds_read_b64_tr_b16 a[156:157], v90 offset:55304
ds_read_b64_tr_b16 a[158:159], v90 offset:57608
v_and_b32_dpp v60, v80, v8 row_newbcast:3 row_mask:0xf bank_mask:0xf
v_and_b32_dpp v61, v80, v9 row_newbcast:3 row_mask:0xf bank_mask:0xf
v_and_b32_dpp v62, v80, v10 row_newbcast:3 row_mask:0xf bank_mask:0xf
v_and_b32_dpp v63, v80, v11 row_newbcast:3 row_mask:0xf bank_mask:0xf
v_and_b32_dpp v64, v80, v8 row_newbcast:7 row_mask:0xf bank_mask:0xf
v_and_b32_dpp v65, v80, v9 row_newbcast:7 row_mask:0xf bank_mask:0xf
v_and_b32_dpp v66, v80, v10 row_newbcast:7 row_mask:0xf bank_mask:0xf
v_and_b32_dpp v67, v80, v11 row_newbcast:7 row_mask:0xf bank_mask:0xf
v_and_b32_dpp v68, v80, v8 row_newbcast:11 row_mask:0xf bank_mask:0xf
v_and_b32_dpp v69, v80, v9 row_newbcast:11 row_mask:0xf bank_mask:0xf
v_and_b32_dpp v70, v80, v10 row_newbcast:11 row_mask:0xf bank_mask:0xf
v_and_b32_dpp v71, v80, v11 row_newbcast:11 row_mask:0xf bank_mask:0xf
v_and_b32_dpp v72, v80, v8 row_newbcast:15 row_mask:0xf bank_mask:0xf
v_and_b32_dpp v73, v80, v9 row_newbcast:15 row_mask:0xf bank_mask:0xf
v_and_b32_dpp v74, v80, v10 row_newbcast:15 row_mask:0xf bank_mask:0xf
v_and_b32_dpp v75, v80, v11 row_newbcast:15 row_mask:0xf bank_mask:0xf
s_waitcnt vmcnt(35)
v_mfma_f32_16x16x32_bf16 v[20:23], v[60:63], v[232:235], v[20:23]
v_mfma_f32_16x16x32_bf16 v[20:23], v[64:67], v[236:239], v[20:23]
v_mfma_f32_16x16x32_bf16 v[20:23], v[68:71], v[240:243], v[20:23]
v_mfma_f32_16x16x32_bf16 v[20:23], v[72:75], v[244:247], v[20:23]
v_add_u32 v117, 1, v117
buffer_store_dword v117, v118, s[64:67], 0 offen
buffer_load_dwordx4 v[232:235], v2, s[52:55], s12 offen offset:0 nt
buffer_load_dwordx4 v[236:239], v2, s[52:55], s12 offen offset:1024 nt
buffer_load_dwordx4 v[240:243], v2, s[52:55], s12 offen offset:2048 nt
buffer_load_dwordx4 v[244:247], v2, s[52:55], s12 offen offset:3072 nt
s_add_u32 s13, s13, 24576
s_min_u32 s12, s13, 2146435072
ds_read_b64_tr_b16 a[160:161], v88 offset:16
ds_read_b64_tr_b16 a[162:163], v88 offset:2320
ds_read_b64_tr_b16 a[164:165], v88 offset:18448
ds_read_b64_tr_b16 a[166:167], v88 offset:20752
v_and_b32_dpp v60, v81, v8 row_newbcast:0 row_mask:0xf bank_mask:0xf
v_and_b32_dpp v61, v81, v9 row_newbcast:0 row_mask:0xf bank_mask:0xf
v_and_b32_dpp v62, v81, v10 row_newbcast:0 row_mask:0xf bank_mask:0xf
v_and_b32_dpp v63, v81, v11 row_newbcast:0 row_mask:0xf bank_mask:0xf
v_and_b32_dpp v64, v81, v8 row_newbcast:4 row_mask:0xf bank_mask:0xf
v_and_b32_dpp v65, v81, v9 row_newbcast:4 row_mask:0xf bank_mask:0xf
v_and_b32_dpp v66, v81, v10 row_newbcast:4 row_mask:0xf bank_mask:0xf
v_and_b32_dpp v67, v81, v11 row_newbcast:4 row_mask:0xf bank_mask:0xf
v_and_b32_dpp v68, v81, v8 row_newbcast:8 row_mask:0xf bank_mask:0xf
v_and_b32_dpp v69, v81, v9 row_newbcast:8 row_mask:0xf bank_mask:0xf
v_and_b32_dpp v70, v81, v10 row_newbcast:8 row_mask:0xf bank_mask:0xf
v_and_b32_dpp v71, v81, v11 row_newbcast:8 row_mask:0xf bank_mask:0xf
v_and_b32_dpp v72, v81, v8 row_newbcast:12 row_mask:0xf bank_mask:0xf
v_and_b32_dpp v73, v81, v9 row_newbcast:12 row_mask:0xf bank_mask:0xf
v_and_b32_dpp v74, v81, v10 row_newbcast:12 row_mask:0xf bank_mask:0xf
v_and_b32_dpp v75, v81, v11 row_newbcast:12 row_mask:0xf bank_mask:0xf
s_waitcnt vmcnt(35)
v_mfma_f32_16x16x32_bf16 v[20:23], v[60:63], v[120:123], v[20:23]
v_mfma_f32_16x16x32_bf16 v[20:23], v[64:67], v[124:127], v[20:23]
v_mfma_f32_16x16x32_bf16 v[20:23], v[68:71], v[128:131], v[20:23]
v_mfma_f32_16x16x32_bf16 v[20:23], v[72:75], v[132:135], v[20:23]
v_add_u32 v117, 1, v117
buffer_store_dword v117, v118, s[64:67], 0 offen
buffer_load_dwordx4 v[120:123], v2, s[52:55], s12 offen offset:0 nt
buffer_load_dwordx4 v[124:127], v2, s[52:55], s12 offen offset:1024 nt
buffer_load_dwordx4 v[128:131], v2, s[52:55], s12 offen offset:2048 nt
buffer_load_dwordx4 v[132:135], v2, s[52:55], s12 offen offset:3072 nt
s_add_u32 s13, s13, 24576
s_min_u32 s12, s13, 2146435072
ds_read_b64_tr_b16 a[168:169], v88 offset:36880
ds_read_b64_tr_b16 a[170:171], v88 offset:39184
ds_read_b64_tr_b16 a[172:173], v88 offset:55312
ds_read_b64_tr_b16 a[174:175], v88 offset:57616
v_and_b32_dpp v60, v81, v8 row_newbcast:1 row_mask:0xf bank_mask:0xf
v_and_b32_dpp v61, v81, v9 row_newbcast:1 row_mask:0xf bank_mask:0xf
v_and_b32_dpp v62, v81, v10 row_newbcast:1 row_mask:0xf bank_mask:0xf
v_and_b32_dpp v63, v81, v11 row_newbcast:1 row_mask:0xf bank_mask:0xf
v_and_b32_dpp v64, v81, v8 row_newbcast:5 row_mask:0xf bank_mask:0xf
v_and_b32_dpp v65, v81, v9 row_newbcast:5 row_mask:0xf bank_mask:0xf
v_and_b32_dpp v66, v81, v10 row_newbcast:5 row_mask:0xf bank_mask:0xf
v_and_b32_dpp v67, v81, v11 row_newbcast:5 row_mask:0xf bank_mask:0xf
v_and_b32_dpp v68, v81, v8 row_newbcast:9 row_mask:0xf bank_mask:0xf
v_and_b32_dpp v69, v81, v9 row_newbcast:9 row_mask:0xf bank_mask:0xf
v_and_b32_dpp v70, v81, v10 row_newbcast:9 row_mask:0xf bank_mask:0xf
v_and_b32_dpp v71, v81, v11 row_newbcast:9 row_mask:0xf bank_mask:0xf
v_and_b32_dpp v72, v81, v8 row_newbcast:13 row_mask:0xf bank_mask:0xf
v_and_b32_dpp v73, v81, v9 row_newbcast:13 row_mask:0xf bank_mask:0xf
v_and_b32_dpp v74, v81, v10 row_newbcast:13 row_mask:0xf bank_mask:0xf
v_and_b32_dpp v75, v81, v11 row_newbcast:13 row_mask:0xf bank_mask:0xf
s_waitcnt vmcnt(35)
v_mfma_f32_16x16x32_bf16 v[20:23], v[60:63], v[136:139], v[20:23]
v_mfma_f32_16x16x32_bf16 v[20:23], v[64:67], v[140:143], v[20:23]
v_mfma_f32_16x16x32_bf16 v[20:23], v[68:71], v[144:147], v[20:23]
v_mfma_f32_16x16x32_bf16 v[20:23], v[72:75], v[148:151], v[20:23]
v_add_u32 v117, 1, v117
buffer_store_dword v117, v118, s[64:67], 0 offen
buffer_load_dwordx4 v[136:139], v2, s[52:55], s12 offen offset:0 nt
buffer_load_dwordx4 v[140:143], v2, s[52:55], s12 offen offset:1024 nt
buffer_load_dwordx4 v[144:147], v2, s[52:55], s12 offen offset:2048 nt
buffer_load_dwordx4 v[148:151], v2, s[52:55], s12 offen offset:3072 nt
s_add_u32 s13, s13, 24576
s_min_u32 s12, s13, 2146435072
ds_read_b64_tr_b16 a[176:177], v90 offset:16
ds_read_b64_tr_b16 a[178:179], v90 offset:2320
ds_read_b64_tr_b16 a[180:181], v90 offset:18448
ds_read_b64_tr_b16 a[182:183], v90 offset:20752
v_and_b32_dpp v60, v77, v8 row_newbcast:0 row_mask:0xf bank_mask:0xf
v_and_b32_dpp v61, v77, v9 row_newbcast:0 row_mask:0xf bank_mask:0xf
v_and_b32_dpp v62, v77, v10 row_newbcast:0 row_mask:0xf bank_mask:0xf
v_and_b32_dpp v63, v77, v11 row_newbcast:0 row_mask:0xf bank_mask:0xf
v_and_b32_dpp v64, v77, v8 row_newbcast:4 row_mask:0xf bank_mask:0xf
v_and_b32_dpp v65, v77, v9 row_newbcast:4 row_mask:0xf bank_mask:0xf
v_and_b32_dpp v66, v77, v10 row_newbcast:4 row_mask:0xf bank_mask:0xf
v_and_b32_dpp v67, v77, v11 row_newbcast:4 row_mask:0xf bank_mask:0xf
v_and_b32_dpp v68, v77, v8 row_newbcast:8 row_mask:0xf bank_mask:0xf
v_and_b32_dpp v69, v77, v9 row_newbcast:8 row_mask:0xf bank_mask:0xf
v_and_b32_dpp v70, v77, v10 row_newbcast:8 row_mask:0xf bank_mask:0xf
v_and_b32_dpp v71, v77, v11 row_newbcast:8 row_mask:0xf bank_mask:0xf
v_and_b32_dpp v72, v77, v8 row_newbcast:12 row_mask:0xf bank_mask:0xf
v_and_b32_dpp v73, v77, v9 row_newbcast:12 row_mask:0xf bank_mask:0xf
v_and_b32_dpp v74, v77, v10 row_newbcast:12 row_mask:0xf bank_mask:0xf
v_and_b32_dpp v75, v77, v11 row_newbcast:12 row_mask:0xf bank_mask:0xf
v_mfma_f32_16x16x32_bf16 v[20:23], v[60:63], a[48:51], v[20:23]
v_mfma_f32_16x16x32_bf16 v[20:23], v[64:67], a[52:55], v[20:23]
v_mfma_f32_16x16x32_bf16 v[20:23], v[68:71], a[56:59], v[20:23]
v_mfma_f32_16x16x32_bf16 v[20:23], v[72:75], a[60:63], v[20:23]
s_nop 3
v_and_b32_dpp v60, v81, v8 row_newbcast:2 row_mask:0xf bank_mask:0xf
v_and_b32_dpp v61, v81, v9 row_newbcast:2 row_mask:0xf bank_mask:0xf
v_and_b32_dpp v62, v81, v10 row_newbcast:2 row_mask:0xf bank_mask:0xf
v_and_b32_dpp v63, v81, v11 row_newbcast:2 row_mask:0xf bank_mask:0xf
v_and_b32_dpp v64, v81, v8 row_newbcast:6 row_mask:0xf bank_mask:0xf
v_and_b32_dpp v65, v81, v9 row_newbcast:6 row_mask:0xf bank_mask:0xf
v_and_b32_dpp v66, v81, v10 row_newbcast:6 row_mask:0xf bank_mask:0xf
v_and_b32_dpp v67, v81, v11 row_newbcast:6 row_mask:0xf bank_mask:0xf
v_and_b32_dpp v68, v81, v8 row_newbcast:10 row_mask:0xf bank_mask:0xf
v_and_b32_dpp v69, v81, v9 row_newbcast:10 row_mask:0xf bank_mask:0xf
v_and_b32_dpp v70, v81, v10 row_newbcast:10 row_mask:0xf bank_mask:0xf
v_and_b32_dpp v71, v81, v11 row_newbcast:10 row_mask:0xf bank_mask:0xf
v_and_b32_dpp v72, v81, v8 row_newbcast:14 row_mask:0xf bank_mask:0xf
v_and_b32_dpp v73, v81, v9 row_newbcast:14 row_mask:0xf bank_mask:0xf
v_and_b32_dpp v74, v81, v10 row_newbcast:14 row_mask:0xf bank_mask:0xf
v_and_b32_dpp v75, v81, v11 row_newbcast:14 row_mask:0xf bank_mask:0xf
s_waitcnt vmcnt(35)
v_mfma_f32_16x16x32_bf16 v[20:23], v[60:63], v[152:155], v[20:23]
v_mfma_f32_16x16x32_bf16 v[20:23], v[64:67], v[156:159], v[20:23]
v_mfma_f32_16x16x32_bf16 v[20:23], v[68:71], v[160:163], v[20:23]
v_mfma_f32_16x16x32_bf16 v[20:23], v[72:75], v[164:167], v[20:23]
v_add_u32 v117, 1, v117
buffer_store_dword v117, v118, s[64:67], 0 offen
buffer_load_dwordx4 v[152:155], v2, s[52:55], s12 offen offset:0 nt
buffer_load_dwordx4 v[156:159], v2, s[52:55], s12 offen offset:1024 nt
buffer_load_dwordx4 v[160:163], v2, s[52:55], s12 offen offset:2048 nt
buffer_load_dwordx4 v[164:167], v2, s[52:55], s12 offen offset:3072 nt
s_add_u32 s13, s13, 24576
s_min_u32 s12, s13, 2146435072
ds_read_b64_tr_b16 a[184:185], v90 offset:36880
ds_read_b64_tr_b16 a[186:187], v90 offset:39184
ds_read_b64_tr_b16 a[188:189], v90 offset:55312
ds_read_b64_tr_b16 a[190:191], v90 offset:57616
v_and_b32_dpp v60, v81, v8 row_newbcast:3 row_mask:0xf bank_mask:0xf
v_and_b32_dpp v61, v81, v9 row_newbcast:3 row_mask:0xf bank_mask:0xf
v_and_b32_dpp v62, v81, v10 row_newbcast:3 row_mask:0xf bank_mask:0xf
v_and_b32_dpp v63, v81, v11 row_newbcast:3 row_mask:0xf bank_mask:0xf
v_and_b32_dpp v64, v81, v8 row_newbcast:7 row_mask:0xf bank_mask:0xf
v_and_b32_dpp v65, v81, v9 row_newbcast:7 row_mask:0xf bank_mask:0xf
v_and_b32_dpp v66, v81, v10 row_newbcast:7 row_mask:0xf bank_mask:0xf
v_and_b32_dpp v67, v81, v11 row_newbcast:7 row_mask:0xf bank_mask:0xf
v_and_b32_dpp v68, v81, v8 row_newbcast:11 row_mask:0xf bank_mask:0xf
v_and_b32_dpp v69, v81, v9 row_newbcast:11 row_mask:0xf bank_mask:0xf
v_and_b32_dpp v70, v81, v10 row_newbcast:11 row_mask:0xf bank_mask:0xf
v_and_b32_dpp v71, v81, v11 row_newbcast:11 row_mask:0xf bank_mask:0xf
v_and_b32_dpp v72, v81, v8 row_newbcast:15 row_mask:0xf bank_mask:0xf
v_and_b32_dpp v73, v81, v9 row_newbcast:15 row_mask:0xf bank_mask:0xf
v_and_b32_dpp v74, v81, v10 row_newbcast:15 row_mask:0xf bank_mask:0xf
v_and_b32_dpp v75, v81, v11 row_newbcast:15 row_mask:0xf bank_mask:0xf
s_waitcnt vmcnt(35)
v_mfma_f32_16x16x32_bf16 v[20:23], v[60:63], v[168:171], v[20:23]
v_mfma_f32_16x16x32_bf16 v[20:23], v[64:67], v[172:175], v[20:23]
v_mfma_f32_16x16x32_bf16 v[20:23], v[68:71], v[176:179], v[20:23]
v_mfma_f32_16x16x32_bf16 v[20:23], v[72:75], v[180:183], v[20:23]
v_add_u32 v117, 1, v117
buffer_store_dword v117, v118, s[64:67], 0 offen
buffer_load_dwordx4 v[168:171], v2, s[52:55], s12 offen offset:0 nt
buffer_load_dwordx4 v[172:175], v2, s[52:55], s12 offen offset:1024 nt
buffer_load_dwordx4 v[176:179], v2, s[52:55], s12 offen offset:2048 nt
buffer_load_dwordx4 v[180:183], v2, s[52:55], s12 offen offset:3072 nt
s_add_u32 s13, s13, 24576
s_min_u32 s12, s13, 2146435072
ds_read_b64_tr_b16 a[192:193], v88 offset:24
ds_read_b64_tr_b16 a[194:195], v88 offset:2328
ds_read_b64_tr_b16 a[196:197], v88 offset:18456
ds_read_b64_tr_b16 a[198:199], v88 offset:20760
v_and_b32_dpp v60, v82, v8 row_newbcast:0 row_mask:0xf bank_mask:0xf
v_and_b32_dpp v61, v82, v9 row_newbcast:0 row_mask:0xf bank_mask:0xf
v_and_b32_dpp v62, v82, v10 row_newbcast:0 row_mask:0xf bank_mask:0xf
v_and_b32_dpp v63, v82, v11 row_newbcast:0 row_mask:0xf bank_mask:0xf
v_and_b32_dpp v64, v82, v8 row_newbcast:4 row_mask:0xf bank_mask:0xf
v_and_b32_dpp v65, v82, v9 row_newbcast:4 row_mask:0xf bank_mask:0xf
v_and_b32_dpp v66, v82, v10 row_newbcast:4 row_mask:0xf bank_mask:0xf
v_and_b32_dpp v67, v82, v11 row_newbcast:4 row_mask:0xf bank_mask:0xf
v_and_b32_dpp v68, v82, v8 row_newbcast:8 row_mask:0xf bank_mask:0xf
v_and_b32_dpp v69, v82, v9 row_newbcast:8 row_mask:0xf bank_mask:0xf
v_and_b32_dpp v70, v82, v10 row_newbcast:8 row_mask:0xf bank_mask:0xf
v_and_b32_dpp v71, v82, v11 row_newbcast:8 row_mask:0xf bank_mask:0xf
v_and_b32_dpp v72, v82, v8 row_newbcast:12 row_mask:0xf bank_mask:0xf
v_and_b32_dpp v73, v82, v9 row_newbcast:12 row_mask:0xf bank_mask:0xf
v_and_b32_dpp v74, v82, v10 row_newbcast:12 row_mask:0xf bank_mask:0xf
v_and_b32_dpp v75, v82, v11 row_newbcast:12 row_mask:0xf bank_mask:0xf
s_waitcnt vmcnt(35)
v_mfma_f32_16x16x32_bf16 v[20:23], v[60:63], v[184:187], v[20:23]
v_mfma_f32_16x16x32_bf16 v[20:23], v[64:67], v[188:191], v[20:23]
v_mfma_f32_16x16x32_bf16 v[20:23], v[68:71], v[192:195], v[20:23]
v_mfma_f32_16x16x32_bf16 v[20:23], v[72:75], v[196:199], v[20:23]
v_add_u32 v117, 1, v117
buffer_store_dword v117, v118, s[64:67], 0 offen
buffer_load_dwordx4 v[184:187], v2, s[52:55], s12 offen offset:0 nt
buffer_load_dwordx4 v[188:191], v2, s[52:55], s12 offen offset:1024 nt
buffer_load_dwordx4 v[192:195], v2, s[52:55], s12 offen offset:2048 nt
buffer_load_dwordx4 v[196:199], v2, s[52:55], s12 offen offset:3072 nt
s_add_u32 s13, s13, 24576
s_min_u32 s12, s13, 2146435072
ds_read_b64_tr_b16 a[200:201], v88 offset:36888
ds_read_b64_tr_b16 a[202:203], v88 offset:39192
ds_read_b64_tr_b16 a[204:205], v88 offset:55320
ds_read_b64_tr_b16 a[206:207], v88 offset:57624
v_and_b32_dpp v60, v82, v8 row_newbcast:1 row_mask:0xf bank_mask:0xf
v_and_b32_dpp v61, v82, v9 row_newbcast:1 row_mask:0xf bank_mask:0xf
v_and_b32_dpp v62, v82, v10 row_newbcast:1 row_mask:0xf bank_mask:0xf
v_and_b32_dpp v63, v82, v11 row_newbcast:1 row_mask:0xf bank_mask:0xf
v_and_b32_dpp v64, v82, v8 row_newbcast:5 row_mask:0xf bank_mask:0xf
v_and_b32_dpp v65, v82, v9 row_newbcast:5 row_mask:0xf bank_mask:0xf
v_and_b32_dpp v66, v82, v10 row_newbcast:5 row_mask:0xf bank_mask:0xf
v_and_b32_dpp v67, v82, v11 row_newbcast:5 row_mask:0xf bank_mask:0xf
v_and_b32_dpp v68, v82, v8 row_newbcast:9 row_mask:0xf bank_mask:0xf
v_and_b32_dpp v69, v82, v9 row_newbcast:9 row_mask:0xf bank_mask:0xf
v_and_b32_dpp v70, v82, v10 row_newbcast:9 row_mask:0xf bank_mask:0xf
v_and_b32_dpp v71, v82, v11 row_newbcast:9 row_mask:0xf bank_mask:0xf
v_and_b32_dpp v72, v82, v8 row_newbcast:13 row_mask:0xf bank_mask:0xf
v_and_b32_dpp v73, v82, v9 row_newbcast:13 row_mask:0xf bank_mask:0xf
v_and_b32_dpp v74, v82, v10 row_newbcast:13 row_mask:0xf bank_mask:0xf
v_and_b32_dpp v75, v82, v11 row_newbcast:13 row_mask:0xf bank_mask:0xf
s_waitcnt vmcnt(35)
v_mfma_f32_16x16x32_bf16 v[20:23], v[60:63], v[200:203], v[20:23]
v_mfma_f32_16x16x32_bf16 v[20:23], v[64:67], v[204:207], v[20:23]
v_mfma_f32_16x16x32_bf16 v[20:23], v[68:71], v[208:211], v[20:23]
v_mfma_f32_16x16x32_bf16 v[20:23], v[72:75], v[212:215], v[20:23]
v_add_u32 v117, 1, v117
buffer_store_dword v117, v118, s[64:67], 0 offen
buffer_load_dwordx4 v[200:203], v2, s[52:55], s12 offen offset:0 nt
buffer_load_dwordx4 v[204:207], v2, s[52:55], s12 offen offset:1024 nt
buffer_load_dwordx4 v[208:211], v2, s[52:55], s12 offen offset:2048 nt
buffer_load_dwordx4 v[212:215], v2, s[52:55], s12 offen offset:3072 nt
s_add_u32 s13, s13, 24576
s_min_u32 s12, s13, 2146435072
ds_read_b64_tr_b16 a[208:209], v90 offset:24
ds_read_b64_tr_b16 a[210:211], v90 offset:2328
ds_read_b64_tr_b16 a[212:213], v90 offset:18456
ds_read_b64_tr_b16 a[214:215], v90 offset:20760
v_and_b32_dpp v60, v77, v8 row_newbcast:1 row_mask:0xf bank_mask:0xf
v_and_b32_dpp v61, v77, v9 row_newbcast:1 row_mask:0xf bank_mask:0xf
v_and_b32_dpp v62, v77, v10 row_newbcast:1 row_mask:0xf bank_mask:0xf
v_and_b32_dpp v63, v77, v11 row_newbcast:1 row_mask:0xf bank_mask:0xf
v_and_b32_dpp v64, v77, v8 row_newbcast:5 row_mask:0xf bank_mask:0xf
v_and_b32_dpp v65, v77, v9 row_newbcast:5 row_mask:0xf bank_mask:0xf
v_and_b32_dpp v66, v77, v10 row_newbcast:5 row_mask:0xf bank_mask:0xf
v_and_b32_dpp v67, v77, v11 row_newbcast:5 row_mask:0xf bank_mask:0xf
v_and_b32_dpp v68, v77, v8 row_newbcast:9 row_mask:0xf bank_mask:0xf
v_and_b32_dpp v69, v77, v9 row_newbcast:9 row_mask:0xf bank_mask:0xf
v_and_b32_dpp v70, v77, v10 row_newbcast:9 row_mask:0xf bank_mask:0xf
v_and_b32_dpp v71, v77, v11 row_newbcast:9 row_mask:0xf bank_mask:0xf
v_and_b32_dpp v72, v77, v8 row_newbcast:13 row_mask:0xf bank_mask:0xf
v_and_b32_dpp v73, v77, v9 row_newbcast:13 row_mask:0xf bank_mask:0xf
v_and_b32_dpp v74, v77, v10 row_newbcast:13 row_mask:0xf bank_mask:0xf
v_and_b32_dpp v75, v77, v11 row_newbcast:13 row_mask:0xf bank_mask:0xf
v_mfma_f32_16x16x32_bf16 v[20:23], v[60:63], a[64:67], v[20:23]
v_mfma_f32_16x16x32_bf16 v[20:23], v[64:67], a[68:71], v[20:23]
v_mfma_f32_16x16x32_bf16 v[20:23], v[68:71], a[72:75], v[20:23]
v_mfma_f32_16x16x32_bf16 v[20:23], v[72:75], a[76:79], v[20:23]
s_nop 3
v_and_b32_dpp v60, v82, v8 row_newbcast:2 row_mask:0xf bank_mask:0xf
v_and_b32_dpp v61, v82, v9 row_newbcast:2 row_mask:0xf bank_mask:0xf
v_and_b32_dpp v62, v82, v10 row_newbcast:2 row_mask:0xf bank_mask:0xf
v_and_b32_dpp v63, v82, v11 row_newbcast:2 row_mask:0xf bank_mask:0xf
v_and_b32_dpp v64, v82, v8 row_newbcast:6 row_mask:0xf bank_mask:0xf
v_and_b32_dpp v65, v82, v9 row_newbcast:6 row_mask:0xf bank_mask:0xf
v_and_b32_dpp v66, v82, v10 row_newbcast:6 row_mask:0xf bank_mask:0xf
v_and_b32_dpp v67, v82, v11 row_newbcast:6 row_mask:0xf bank_mask:0xf
v_and_b32_dpp v68, v82, v8 row_newbcast:10 row_mask:0xf bank_mask:0xf
v_and_b32_dpp v69, v82, v9 row_newbcast:10 row_mask:0xf bank_mask:0xf
v_and_b32_dpp v70, v82, v10 row_newbcast:10 row_mask:0xf bank_mask:0xf
v_and_b32_dpp v71, v82, v11 row_newbcast:10 row_mask:0xf bank_mask:0xf
v_and_b32_dpp v72, v82, v8 row_newbcast:14 row_mask:0xf bank_mask:0xf
v_and_b32_dpp v73, v82, v9 row_newbcast:14 row_mask:0xf bank_mask:0xf
v_and_b32_dpp v74, v82, v10 row_newbcast:14 row_mask:0xf bank_mask:0xf
v_and_b32_dpp v75, v82, v11 row_newbcast:14 row_mask:0xf bank_mask:0xf
s_waitcnt vmcnt(35)
v_mfma_f32_16x16x32_bf16 v[20:23], v[60:63], v[216:219], v[20:23]
v_mfma_f32_16x16x32_bf16 v[20:23], v[64:67], v[220:223], v[20:23]
v_mfma_f32_16x16x32_bf16 v[20:23], v[68:71], v[224:227], v[20:23]
v_mfma_f32_16x16x32_bf16 v[20:23], v[72:75], v[228:231], v[20:23]
v_add_u32 v117, 1, v117
buffer_store_dword v117, v118, s[64:67], 0 offen
buffer_load_dwordx4 v[216:219], v2, s[52:55], s12 offen offset:0 nt
buffer_load_dwordx4 v[220:223], v2, s[52:55], s12 offen offset:1024 nt
buffer_load_dwordx4 v[224:227], v2, s[52:55], s12 offen offset:2048 nt
buffer_load_dwordx4 v[228:231], v2, s[52:55], s12 offen offset:3072 nt
s_add_u32 s13, s13, 24576
s_min_u32 s12, s13, 2146435072
ds_read_b64_tr_b16 a[216:217], v90 offset:36888
ds_read_b64_tr_b16 a[218:219], v90 offset:39192
ds_read_b64_tr_b16 a[220:221], v90 offset:55320
ds_read_b64_tr_b16 a[222:223], v90 offset:57624
v_and_b32_dpp v60, v82, v8 row_newbcast:3 row_mask:0xf bank_mask:0xf
v_and_b32_dpp v61, v82, v9 row_newbcast:3 row_mask:0xf bank_mask:0xf
v_and_b32_dpp v62, v82, v10 row_newbcast:3 row_mask:0xf bank_mask:0xf
v_and_b32_dpp v63, v82, v11 row_newbcast:3 row_mask:0xf bank_mask:0xf
v_and_b32_dpp v64, v82, v8 row_newbcast:7 row_mask:0xf bank_mask:0xf
v_and_b32_dpp v65, v82, v9 row_newbcast:7 row_mask:0xf bank_mask:0xf
v_and_b32_dpp v66, v82, v10 row_newbcast:7 row_mask:0xf bank_mask:0xf
v_and_b32_dpp v67, v82, v11 row_newbcast:7 row_mask:0xf bank_mask:0xf
v_and_b32_dpp v68, v82, v8 row_newbcast:11 row_mask:0xf bank_mask:0xf
v_and_b32_dpp v69, v82, v9 row_newbcast:11 row_mask:0xf bank_mask:0xf
v_and_b32_dpp v70, v82, v10 row_newbcast:11 row_mask:0xf bank_mask:0xf
v_and_b32_dpp v71, v82, v11 row_newbcast:11 row_mask:0xf bank_mask:0xf
v_and_b32_dpp v72, v82, v8 row_newbcast:15 row_mask:0xf bank_mask:0xf
v_and_b32_dpp v73, v82, v9 row_newbcast:15 row_mask:0xf bank_mask:0xf
v_and_b32_dpp v74, v82, v10 row_newbcast:15 row_mask:0xf bank_mask:0xf
v_and_b32_dpp v75, v82, v11 row_newbcast:15 row_mask:0xf bank_mask:0xf
s_waitcnt vmcnt(35)
v_mfma_f32_16x16x32_bf16 v[20:23], v[60:63], v[232:235], v[20:23]
v_mfma_f32_16x16x32_bf16 v[20:23], v[64:67], v[236:239], v[20:23]
v_mfma_f32_16x16x32_bf16 v[20:23], v[68:71], v[240:243], v[20:23]
v_mfma_f32_16x16x32_bf16 v[20:23], v[72:75], v[244:247], v[20:23]
v_add_u32 v117, 1, v117
buffer_store_dword v117, v118, s[64:67], 0 offen
buffer_load_dwordx4 v[232:235], v2, s[52:55], s12 offen offset:0 nt
buffer_load_dwordx4 v[236:239], v2, s[52:55], s12 offen offset:1024 nt
buffer_load_dwordx4 v[240:243], v2, s[52:55], s12 offen offset:2048 nt
buffer_load_dwordx4 v[244:247], v2, s[52:55], s12 offen offset:3072 nt
s_add_u32 s13, s13, 24576
s_min_u32 s12, s13, 2146435072
ds_read_b64_tr_b16 a[224:225], v89 offset:0
ds_read_b64_tr_b16 a[226:227], v89 offset:4608
ds_read_b64_tr_b16 a[228:229], v89 offset:36864
ds_read_b64_tr_b16 a[230:231], v89 offset:41472
buffer_load_dwordx4 v[40:43], off, s[64:67], s82 offset:0 sc1
buffer_load_dwordx4 v[44:47], off, s[64:67], s82 offset:16 sc1
buffer_load_dwordx4 v[48:51], off, s[64:67], s82 offset:32 sc1
v_and_b32_dpp v60, v83, v8 row_newbcast:0 row_mask:0xf bank_mask:0xf
v_and_b32_dpp v61, v83, v9 row_newbcast:0 row_mask:0xf bank_mask:0xf
v_and_b32_dpp v62, v83, v10 row_newbcast:0 row_mask:0xf bank_mask:0xf
v_and_b32_dpp v63, v83, v11 row_newbcast:0 row_mask:0xf bank_mask:0xf
v_and_b32_dpp v64, v83, v8 row_newbcast:4 row_mask:0xf bank_mask:0xf
v_and_b32_dpp v65, v83, v9 row_newbcast:4 row_mask:0xf bank_mask:0xf
v_and_b32_dpp v66, v83, v10 row_newbcast:4 row_mask:0xf bank_mask:0xf
v_and_b32_dpp v67, v83, v11 row_newbcast:4 row_mask:0xf bank_mask:0xf
v_and_b32_dpp v68, v83, v8 row_newbcast:8 row_mask:0xf bank_mask:0xf
v_and_b32_dpp v69, v83, v9 row_newbcast:8 row_mask:0xf bank_mask:0xf
v_and_b32_dpp v70, v83, v10 row_newbcast:8 row_mask:0xf bank_mask:0xf
v_and_b32_dpp v71, v83, v11 row_newbcast:8 row_mask:0xf bank_mask:0xf
v_and_b32_dpp v72, v83, v8 row_newbcast:12 row_mask:0xf bank_mask:0xf
v_and_b32_dpp v73, v83, v9 row_newbcast:12 row_mask:0xf bank_mask:0xf
v_and_b32_dpp v74, v83, v10 row_newbcast:12 row_mask:0xf bank_mask:0xf
v_and_b32_dpp v75, v83, v11 row_newbcast:12 row_mask:0xf bank_mask:0xf
s_waitcnt vmcnt(38)
v_mfma_f32_16x16x32_bf16 v[20:23], v[60:63], v[120:123], v[20:23]
v_mfma_f32_16x16x32_bf16 v[20:23], v[64:67], v[124:127], v[20:23]
v_mfma_f32_16x16x32_bf16 v[20:23], v[68:71], v[128:131], v[20:23]
v_mfma_f32_16x16x32_bf16 v[20:23], v[72:75], v[132:135], v[20:23]
v_add_u32 v117, 1, v117
buffer_store_dword v117, v118, s[64:67], 0 offen
buffer_load_dwordx4 v[120:123], v2, s[52:55], s12 offen offset:0 nt
buffer_load_dwordx4 v[124:127], v2, s[52:55], s12 offen offset:1024 nt
buffer_load_dwordx4 v[128:131], v2, s[52:55], s12 offen offset:2048 nt
buffer_load_dwordx4 v[132:135], v2, s[52:55], s12 offen offset:3072 nt
s_add_u32 s13, s13, 24576
s_min_u32 s12, s13, 2146435072
ds_read_b64_tr_b16 a[232:233], v91 offset:0
ds_read_b64_tr_b16 a[234:235], v91 offset:4608
ds_read_b64_tr_b16 a[236:237], v91 offset:36864
ds_read_b64_tr_b16 a[238:239], v91 offset:41472
v_and_b32_dpp v60, v83, v8 row_newbcast:1 row_mask:0xf bank_mask:0xf
v_and_b32_dpp v61, v83, v9 row_newbcast:1 row_mask:0xf bank_mask:0xf
v_and_b32_dpp v62, v83, v10 row_newbcast:1 row_mask:0xf bank_mask:0xf
v_and_b32_dpp v63, v83, v11 row_newbcast:1 row_mask:0xf bank_mask:0xf
v_and_b32_dpp v64, v83, v8 row_newbcast:5 row_mask:0xf bank_mask:0xf
v_and_b32_dpp v65, v83, v9 row_newbcast:5 row_mask:0xf bank_mask:0xf
v_and_b32_dpp v66, v83, v10 row_newbcast:5 row_mask:0xf bank_mask:0xf
v_and_b32_dpp v67, v83, v11 row_newbcast:5 row_mask:0xf bank_mask:0xf
v_and_b32_dpp v68, v83, v8 row_newbcast:9 row_mask:0xf bank_mask:0xf
v_and_b32_dpp v69, v83, v9 row_newbcast:9 row_mask:0xf bank_mask:0xf
v_and_b32_dpp v70, v83, v10 row_newbcast:9 row_mask:0xf bank_mask:0xf
v_and_b32_dpp v71, v83, v11 row_newbcast:9 row_mask:0xf bank_mask:0xf
v_and_b32_dpp v72, v83, v8 row_newbcast:13 row_mask:0xf bank_mask:0xf
v_and_b32_dpp v73, v83, v9 row_newbcast:13 row_mask:0xf bank_mask:0xf
v_and_b32_dpp v74, v83, v10 row_newbcast:13 row_mask:0xf bank_mask:0xf
v_and_b32_dpp v75, v83, v11 row_newbcast:13 row_mask:0xf bank_mask:0xf
s_waitcnt vmcnt(38)
v_mfma_f32_16x16x32_bf16 v[20:23], v[60:63], v[136:139], v[20:23]
v_mfma_f32_16x16x32_bf16 v[20:23], v[64:67], v[140:143], v[20:23]
v_mfma_f32_16x16x32_bf16 v[20:23], v[68:71], v[144:147], v[20:23]
v_mfma_f32_16x16x32_bf16 v[20:23], v[72:75], v[148:151], v[20:23]
s_nop 3
v_and_b32_dpp v60, v83, v8 row_newbcast:2 row_mask:0xf bank_mask:0xf
v_and_b32_dpp v61, v83, v9 row_newbcast:2 row_mask:0xf bank_mask:0xf
v_and_b32_dpp v62, v83, v10 row_newbcast:2 row_mask:0xf bank_mask:0xf
v_and_b32_dpp v63, v83, v11 row_newbcast:2 row_mask:0xf bank_mask:0xf
v_and_b32_dpp v64, v83, v8 row_newbcast:6 row_mask:0xf bank_mask:0xf
v_and_b32_dpp v65, v83, v9 row_newbcast:6 row_mask:0xf bank_mask:0xf
v_and_b32_dpp v66, v83, v10 row_newbcast:6 row_mask:0xf bank_mask:0xf
v_and_b32_dpp v67, v83, v11 row_newbcast:6 row_mask:0xf bank_mask:0xf
v_and_b32_dpp v68, v83, v8 row_newbcast:10 row_mask:0xf bank_mask:0xf
v_and_b32_dpp v69, v83, v9 row_newbcast:10 row_mask:0xf bank_mask:0xf
v_and_b32_dpp v70, v83, v10 row_newbcast:10 row_mask:0xf bank_mask:0xf
v_and_b32_dpp v71, v83, v11 row_newbcast:10 row_mask:0xf bank_mask:0xf
v_and_b32_dpp v72, v83, v8 row_newbcast:14 row_mask:0xf bank_mask:0xf
v_and_b32_dpp v73, v83, v9 row_newbcast:14 row_mask:0xf bank_mask:0xf
v_and_b32_dpp v74, v83, v10 row_newbcast:14 row_mask:0xf bank_mask:0xf
v_and_b32_dpp v75, v83, v11 row_newbcast:14 row_mask:0xf bank_mask:0xf
s_waitcnt vmcnt(33)
v_mfma_f32_16x16x32_bf16 v[20:23], v[60:63], v[152:155], v[20:23]
v_mfma_f32_16x16x32_bf16 v[20:23], v[64:67], v[156:159], v[20:23]
v_mfma_f32_16x16x32_bf16 v[20:23], v[68:71], v[160:163], v[20:23]
v_mfma_f32_16x16x32_bf16 v[20:23], v[72:75], v[164:167], v[20:23]
v_add_u32 v117, 1, v117
buffer_store_dword v117, v118, s[64:67], 0 offen
buffer_load_dwordx4 v[136:139], v2, s[52:55], s12 offen offset:0 nt
buffer_load_dwordx4 v[140:143], v2, s[52:55], s12 offen offset:1024 nt
buffer_load_dwordx4 v[144:147], v2, s[52:55], s12 offen offset:2048 nt
buffer_load_dwordx4 v[148:151], v2, s[52:55], s12 offen offset:3072 nt
s_add_u32 s13, s13, 24576
s_min_u32 s12, s13, 2146435072
v_and_b32_dpp v60, v77, v8 row_newbcast:2 row_mask:0xf bank_mask:0xf
v_and_b32_dpp v61, v77, v9 row_newbcast:2 row_mask:0xf bank_mask:0xf
v_and_b32_dpp v62, v77, v10 row_newbcast:2 row_mask:0xf bank_mask:0xf
v_and_b32_dpp v63, v77, v11 row_newbcast:2 row_mask:0xf bank_mask:0xf
v_and_b32_dpp v64, v77, v8 row_newbcast:6 row_mask:0xf bank_mask:0xf
v_and_b32_dpp v65, v77, v9 row_newbcast:6 row_mask:0xf bank_mask:0xf
v_and_b32_dpp v66, v77, v10 row_newbcast:6 row_mask:0xf bank_mask:0xf
v_and_b32_dpp v67, v77, v11 row_newbcast:6 row_mask:0xf bank_mask:0xf
v_and_b32_dpp v68, v77, v8 row_newbcast:10 row_mask:0xf bank_mask:0xf
v_and_b32_dpp v69, v77, v9 row_newbcast:10 row_mask:0xf bank_mask:0xf
v_and_b32_dpp v70, v77, v10 row_newbcast:10 row_mask:0xf bank_mask:0xf
v_and_b32_dpp v71, v77, v11 row_newbcast:10 row_mask:0xf bank_mask:0xf
v_and_b32_dpp v72, v77, v8 row_newbcast:14 row_mask:0xf bank_mask:0xf
v_and_b32_dpp v73, v77, v9 row_newbcast:14 row_mask:0xf bank_mask:0xf
v_and_b32_dpp v74, v77, v10 row_newbcast:14 row_mask:0xf bank_mask:0xf
v_and_b32_dpp v75, v77, v11 row_newbcast:14 row_mask:0xf bank_mask:0xf
v_mfma_f32_16x16x32_bf16 v[20:23], v[60:63], a[80:83], v[20:23]
v_mfma_f32_16x16x32_bf16 v[20:23], v[64:67], a[84:87], v[20:23]
v_mfma_f32_16x16x32_bf16 v[20:23], v[68:71], a[88:91], v[20:23]
v_mfma_f32_16x16x32_bf16 v[20:23], v[72:75], a[92:95], v[20:23]
s_nop 3
v_and_b32_dpp v60, v83, v8 row_newbcast:3 row_mask:0xf bank_mask:0xf
v_and_b32_dpp v61, v83, v9 row_newbcast:3 row_mask:0xf bank_mask:0xf
v_and_b32_dpp v62, v83, v10 row_newbcast:3 row_mask:0xf bank_mask:0xf
v_and_b32_dpp v63, v83, v11 row_newbcast:3 row_mask:0xf bank_mask:0xf
v_and_b32_dpp v64, v83, v8 row_newbcast:7 row_mask:0xf bank_mask:0xf
v_and_b32_dpp v65, v83, v9 row_newbcast:7 row_mask:0xf bank_mask:0xf
v_and_b32_dpp v66, v83, v10 row_newbcast:7 row_mask:0xf bank_mask:0xf
v_and_b32_dpp v67, v83, v11 row_newbcast:7 row_mask:0xf bank_mask:0xf
v_and_b32_dpp v68, v83, v8 row_newbcast:11 row_mask:0xf bank_mask:0xf
v_and_b32_dpp v69, v83, v9 row_newbcast:11 row_mask:0xf bank_mask:0xf
v_and_b32_dpp v70, v83, v10 row_newbcast:11 row_mask:0xf bank_mask:0xf
v_and_b32_dpp v71, v83, v11 row_newbcast:11 row_mask:0xf bank_mask:0xf
v_and_b32_dpp v72, v83, v8 row_newbcast:15 row_mask:0xf bank_mask:0xf
v_and_b32_dpp v73, v83, v9 row_newbcast:15 row_mask:0xf bank_mask:0xf
v_and_b32_dpp v74, v83, v10 row_newbcast:15 row_mask:0xf bank_mask:0xf
v_and_b32_dpp v75, v83, v11 row_newbcast:15 row_mask:0xf bank_mask:0xf
s_waitcnt vmcnt(33)
v_mfma_f32_16x16x32_bf16 v[20:23], v[60:63], v[168:171], v[20:23]
v_mfma_f32_16x16x32_bf16 v[20:23], v[64:67], v[172:175], v[20:23]
v_mfma_f32_16x16x32_bf16 v[20:23], v[68:71], v[176:179], v[20:23]
v_mfma_f32_16x16x32_bf16 v[20:23], v[72:75], v[180:183], v[20:23]
s_nop 3
v_and_b32_dpp v60, v84, v8 row_newbcast:0 row_mask:0xf bank_mask:0xf
v_and_b32_dpp v61, v84, v9 row_newbcast:0 row_mask:0xf bank_mask:0xf
v_and_b32_dpp v62, v84, v10 row_newbcast:0 row_mask:0xf bank_mask:0xf
v_and_b32_dpp v63, v84, v11 row_newbcast:0 row_mask:0xf bank_mask:0xf
v_and_b32_dpp v64, v84, v8 row_newbcast:4 row_mask:0xf bank_mask:0xf
v_and_b32_dpp v65, v84, v9 row_newbcast:4 row_mask:0xf bank_mask:0xf
v_and_b32_dpp v66, v84, v10 row_newbcast:4 row_mask:0xf bank_mask:0xf
v_and_b32_dpp v67, v84, v11 row_newbcast:4 row_mask:0xf bank_mask:0xf
v_and_b32_dpp v68, v84, v8 row_newbcast:8 row_mask:0xf bank_mask:0xf
v_and_b32_dpp v69, v84, v9 row_newbcast:8 row_mask:0xf bank_mask:0xf
v_and_b32_dpp v70, v84, v10 row_newbcast:8 row_mask:0xf bank_mask:0xf
v_and_b32_dpp v71, v84, v11 row_newbcast:8 row_mask:0xf bank_mask:0xf
v_and_b32_dpp v72, v84, v8 row_newbcast:12 row_mask:0xf bank_mask:0xf
v_and_b32_dpp v73, v84, v9 row_newbcast:12 row_mask:0xf bank_mask:0xf
v_and_b32_dpp v74, v84, v10 row_newbcast:12 row_mask:0xf bank_mask:0xf
v_and_b32_dpp v75, v84, v11 row_newbcast:12 row_mask:0xf bank_mask:0xf
s_waitcnt vmcnt(28)
v_mfma_f32_16x16x32_bf16 v[20:23], v[60:63], v[184:187], v[20:23]
v_mfma_f32_16x16x32_bf16 v[20:23], v[64:67], v[188:191], v[20:23]
v_mfma_f32_16x16x32_bf16 v[20:23], v[68:71], v[192:195], v[20:23]
v_mfma_f32_16x16x32_bf16 v[20:23], v[72:75], v[196:199], v[20:23]
v_add_u32 v117, 1, v117
buffer_store_dword v117, v118, s[64:67], 0 offen
buffer_load_dwordx4 v[152:155], v2, s[52:55], s12 offen offset:0 nt
buffer_load_dwordx4 v[156:159], v2, s[52:55], s12 offen offset:1024 nt
buffer_load_dwordx4 v[160:163], v2, s[52:55], s12 offen offset:2048 nt
buffer_load_dwordx4 v[164:167], v2, s[52:55], s12 offen offset:3072 nt
s_add_u32 s13, s13, 24576
s_min_u32 s12, s13, 2146435072
v_and_b32_dpp v60, v84, v8 row_newbcast:1 row_mask:0xf bank_mask:0xf
v_and_b32_dpp v61, v84, v9 row_newbcast:1 row_mask:0xf bank_mask:0xf
v_and_b32_dpp v62, v84, v10 row_newbcast:1 row_mask:0xf bank_mask:0xf
v_and_b32_dpp v63, v84, v11 row_newbcast:1 row_mask:0xf bank_mask:0xf
v_and_b32_dpp v64, v84, v8 row_newbcast:5 row_mask:0xf bank_mask:0xf
v_and_b32_dpp v65, v84, v9 row_newbcast:5 row_mask:0xf bank_mask:0xf
v_and_b32_dpp v66, v84, v10 row_newbcast:5 row_mask:0xf bank_mask:0xf
v_and_b32_dpp v67, v84, v11 row_newbcast:5 row_mask:0xf bank_mask:0xf
v_and_b32_dpp v68, v84, v8 row_newbcast:9 row_mask:0xf bank_mask:0xf
v_and_b32_dpp v69, v84, v9 row_newbcast:9 row_mask:0xf bank_mask:0xf
v_and_b32_dpp v70, v84, v10 row_newbcast:9 row_mask:0xf bank_mask:0xf
v_and_b32_dpp v71, v84, v11 row_newbcast:9 row_mask:0xf bank_mask:0xf
v_and_b32_dpp v72, v84, v8 row_newbcast:13 row_mask:0xf bank_mask:0xf
v_and_b32_dpp v73, v84, v9 row_newbcast:13 row_mask:0xf bank_mask:0xf
v_and_b32_dpp v74, v84, v10 row_newbcast:13 row_mask:0xf bank_mask:0xf
v_and_b32_dpp v75, v84, v11 row_newbcast:13 row_mask:0xf bank_mask:0xf
s_waitcnt vmcnt(28)
v_mfma_f32_16x16x32_bf16 v[20:23], v[60:63], v[200:203], v[20:23]
v_mfma_f32_16x16x32_bf16 v[20:23], v[64:67], v[204:207], v[20:23]
v_mfma_f32_16x16x32_bf16 v[20:23], v[68:71], v[208:211], v[20:23]
v_mfma_f32_16x16x32_bf16 v[20:23], v[72:75], v[212:215], v[20:23]
s_nop 3
v_and_b32_dpp v60, v84, v8 row_newbcast:2 row_mask:0xf bank_mask:0xf
v_and_b32_dpp v61, v84, v9 row_newbcast:2 row_mask:0xf bank_mask:0xf
v_and_b32_dpp v62, v84, v10 row_newbcast:2 row_mask:0xf bank_mask:0xf
v_and_b32_dpp v63, v84, v11 row_newbcast:2 row_mask:0xf bank_mask:0xf
v_and_b32_dpp v64, v84, v8 row_newbcast:6 row_mask:0xf bank_mask:0xf
v_and_b32_dpp v65, v84, v9 row_newbcast:6 row_mask:0xf bank_mask:0xf
v_and_b32_dpp v66, v84, v10 row_newbcast:6 row_mask:0xf bank_mask:0xf
v_and_b32_dpp v67, v84, v11 row_newbcast:6 row_mask:0xf bank_mask:0xf
v_and_b32_dpp v68, v84, v8 row_newbcast:10 row_mask:0xf bank_mask:0xf
v_and_b32_dpp v69, v84, v9 row_newbcast:10 row_mask:0xf bank_mask:0xf
v_and_b32_dpp v70, v84, v10 row_newbcast:10 row_mask:0xf bank_mask:0xf
v_and_b32_dpp v71, v84, v11 row_newbcast:10 row_mask:0xf bank_mask:0xf
v_and_b32_dpp v72, v84, v8 row_newbcast:14 row_mask:0xf bank_mask:0xf
v_and_b32_dpp v73, v84, v9 row_newbcast:14 row_mask:0xf bank_mask:0xf
v_and_b32_dpp v74, v84, v10 row_newbcast:14 row_mask:0xf bank_mask:0xf
v_and_b32_dpp v75, v84, v11 row_newbcast:14 row_mask:0xf bank_mask:0xf
s_waitcnt vmcnt(23)
v_mfma_f32_16x16x32_bf16 v[20:23], v[60:63], v[216:219], v[20:23]
v_mfma_f32_16x16x32_bf16 v[20:23], v[64:67], v[220:223], v[20:23]
v_mfma_f32_16x16x32_bf16 v[20:23], v[68:71], v[224:227], v[20:23]
v_mfma_f32_16x16x32_bf16 v[20:23], v[72:75], v[228:231], v[20:23]
v_add_u32 v117, 1, v117
buffer_store_dword v117, v118, s[64:67], 0 offen
buffer_load_dwordx4 v[168:171], v2, s[52:55], s12 offen offset:0 nt
buffer_load_dwordx4 v[172:175], v2, s[52:55], s12 offen offset:1024 nt
buffer_load_dwordx4 v[176:179], v2, s[52:55], s12 offen offset:2048 nt
buffer_load_dwordx4 v[180:183], v2, s[52:55], s12 offen offset:3072 nt
s_add_u32 s13, s13, 24576
s_min_u32 s12, s13, 2146435072
v_and_b32_dpp v60, v84, v8 row_newbcast:3 row_mask:0xf bank_mask:0xf
v_and_b32_dpp v61, v84, v9 row_newbcast:3 row_mask:0xf bank_mask:0xf
v_and_b32_dpp v62, v84, v10 row_newbcast:3 row_mask:0xf bank_mask:0xf
v_and_b32_dpp v63, v84, v11 row_newbcast:3 row_mask:0xf bank_mask:0xf
v_and_b32_dpp v64, v84, v8 row_newbcast:7 row_mask:0xf bank_mask:0xf
v_and_b32_dpp v65, v84, v9 row_newbcast:7 row_mask:0xf bank_mask:0xf
v_and_b32_dpp v66, v84, v10 row_newbcast:7 row_mask:0xf bank_mask:0xf
v_and_b32_dpp v67, v84, v11 row_newbcast:7 row_mask:0xf bank_mask:0xf
v_and_b32_dpp v68, v84, v8 row_newbcast:11 row_mask:0xf bank_mask:0xf
v_and_b32_dpp v69, v84, v9 row_newbcast:11 row_mask:0xf bank_mask:0xf
v_and_b32_dpp v70, v84, v10 row_newbcast:11 row_mask:0xf bank_mask:0xf
v_and_b32_dpp v71, v84, v11 row_newbcast:11 row_mask:0xf bank_mask:0xf
v_and_b32_dpp v72, v84, v8 row_newbcast:15 row_mask:0xf bank_mask:0xf
v_and_b32_dpp v73, v84, v9 row_newbcast:15 row_mask:0xf bank_mask:0xf
v_and_b32_dpp v74, v84, v10 row_newbcast:15 row_mask:0xf bank_mask:0xf
v_and_b32_dpp v75, v84, v11 row_newbcast:15 row_mask:0xf bank_mask:0xf
s_waitcnt vmcnt(23)
v_mfma_f32_16x16x32_bf16 v[20:23], v[60:63], v[232:235], v[20:23]
v_mfma_f32_16x16x32_bf16 v[20:23], v[64:67], v[236:239], v[20:23]
v_mfma_f32_16x16x32_bf16 v[20:23], v[68:71], v[240:243], v[20:23]
v_mfma_f32_16x16x32_bf16 v[20:23], v[72:75], v[244:247], v[20:23]
s_nop 3
v_and_b32_dpp v60, v85, v8 row_newbcast:0 row_mask:0xf bank_mask:0xf
v_and_b32_dpp v61, v85, v9 row_newbcast:0 row_mask:0xf bank_mask:0xf
v_and_b32_dpp v62, v85, v10 row_newbcast:0 row_mask:0xf bank_mask:0xf
v_and_b32_dpp v63, v85, v11 row_newbcast:0 row_mask:0xf bank_mask:0xf
v_and_b32_dpp v64, v85, v8 row_newbcast:4 row_mask:0xf bank_mask:0xf
v_and_b32_dpp v65, v85, v9 row_newbcast:4 row_mask:0xf bank_mask:0xf
v_and_b32_dpp v66, v85, v10 row_newbcast:4 row_mask:0xf bank_mask:0xf
v_and_b32_dpp v67, v85, v11 row_newbcast:4 row_mask:0xf bank_mask:0xf
v_and_b32_dpp v68, v85, v8 row_newbcast:8 row_mask:0xf bank_mask:0xf
v_and_b32_dpp v69, v85, v9 row_newbcast:8 row_mask:0xf bank_mask:0xf
v_and_b32_dpp v70, v85, v10 row_newbcast:8 row_mask:0xf bank_mask:0xf
v_and_b32_dpp v71, v85, v11 row_newbcast:8 row_mask:0xf bank_mask:0xf
v_and_b32_dpp v72, v85, v8 row_newbcast:12 row_mask:0xf bank_mask:0xf
v_and_b32_dpp v73, v85, v9 row_newbcast:12 row_mask:0xf bank_mask:0xf
v_and_b32_dpp v74, v85, v10 row_newbcast:12 row_mask:0xf bank_mask:0xf
v_and_b32_dpp v75, v85, v11 row_newbcast:12 row_mask:0xf bank_mask:0xf
s_waitcnt vmcnt(15)
v_mfma_f32_16x16x32_bf16 v[20:23], v[60:63], v[120:123], v[20:23]
v_mfma_f32_16x16x32_bf16 v[20:23], v[64:67], v[124:127], v[20:23]
v_mfma_f32_16x16x32_bf16 v[20:23], v[68:71], v[128:131], v[20:23]
v_mfma_f32_16x16x32_bf16 v[20:23], v[72:75], v[132:135], v[20:23]
v_add_u32 v117, 1, v117
buffer_store_dword v117, v118, s[64:67], 0 offen
buffer_load_dwordx4 v[184:187], v2, s[52:55], s12 offen offset:0 nt
buffer_load_dwordx4 v[188:191], v2, s[52:55], s12 offen offset:1024 nt
buffer_load_dwordx4 v[192:195], v2, s[52:55], s12 offen offset:2048 nt
buffer_load_dwordx4 v[196:199], v2, s[52:55], s12 offen offset:3072 nt
s_add_u32 s13, s13, 24576
s_min_u32 s12, s13, 2146435072
s_mov_b32 s7, 400000
A_ev2_chk:
v_max3_u32 v35, v40, v41, v42
v_max3_u32 v35, v35, v43, v44
v_max3_u32 v35, v35, v45, v46
v_max3_u32 v35, v35, v47, v48
v_max3_u32 v35, v35, v49, v50
v_max_u32 v35, v35, v51
v_cmp_eq_u32 vcc, -1, v35
s_cbranch_vccz A_ev2_ok
buffer_load_dwordx4 v[40:43], off, s[64:67], s82 offset:0 sc1
buffer_load_dwordx4 v[44:47], off, s[64:67], s82 offset:16 sc1
buffer_load_dwordx4 v[48:51], off, s[64:67], s82 offset:32 sc1
s_waitcnt vmcnt(0)
s_sub_u32 s7, s7, 1
s_cmp_lg_u32 s7, 0
s_cbranch_scc1 A_ev2_chk
A_ev2_ok:
v_max3_f32 v35, v40, v42, v44
v_max3_f32 v36, v46, v48, v50
v_max_f32 v35, v35, v36
v_sub_f32 v40, v40, v35
v_sub_f32 v42, v42, v35
v_sub_f32 v44, v44, v35
v_sub_f32 v46, v46, v35
v_sub_f32 v48, v48, v35
v_sub_f32 v50, v50, v35
v_sub_f32 v37, v32, v35
v_exp_f32 v40, v40
v_exp_f32 v42, v42
v_exp_f32 v44, v44
v_exp_f32 v46, v46
v_exp_f32 v48, v48
v_exp_f32 v50, v50
v_exp_f32 v37, v37
v_mul_f32 v35, v40, v41
v_fma_f32 v35, v42, v43, v35
v_fma_f32 v35, v44, v45, v35
v_fma_f32 v35, v46, v47, v35
v_fma_f32 v35, v48, v49, v35
v_fma_f32 v35, v50, v51, v35
v_rcp_f32 v35, v35
s_nop 0
v_mul_f32 v37, v37, v35
v_and_b32_dpp v60, v85, v8 row_newbcast:1 row_mask:0xf bank_mask:0xf
v_and_b32_dpp v61, v85, v9 row_newbcast:1 row_mask:0xf bank_mask:0xf
v_and_b32_dpp v62, v85, v10 row_newbcast:1 row_mask:0xf bank_mask:0xf
v_and_b32_dpp v63, v85, v11 row_newbcast:1 row_mask:0xf bank_mask:0xf
v_and_b32_dpp v64, v85, v8 row_newbcast:5 row_mask:0xf bank_mask:0xf
v_and_b32_dpp v65, v85, v9 row_newbcast:5 row_mask:0xf bank_mask:0xf
v_and_b32_dpp v66, v85, v10 row_newbcast:5 row_mask:0xf bank_mask:0xf
v_and_b32_dpp v67, v85, v11 row_newbcast:5 row_mask:0xf bank_mask:0xf
v_and_b32_dpp v68, v85, v8 row_newbcast:9 row_mask:0xf bank_mask:0xf
v_and_b32_dpp v69, v85, v9 row_newbcast:9 row_mask:0xf bank_mask:0xf
v_and_b32_dpp v70, v85, v10 row_newbcast:9 row_mask:0xf bank_mask:0xf
v_and_b32_dpp v71, v85, v11 row_newbcast:9 row_mask:0xf bank_mask:0xf
v_and_b32_dpp v72, v85, v8 row_newbcast:13 row_mask:0xf bank_mask:0xf
v_and_b32_dpp v73, v85, v9 row_newbcast:13 row_mask:0xf bank_mask:0xf
v_and_b32_dpp v74, v85, v10 row_newbcast:13 row_mask:0xf bank_mask:0xf
v_and_b32_dpp v75, v85, v11 row_newbcast:13 row_mask:0xf bank_mask:0xf
s_waitcnt vmcnt(15)
v_mfma_f32_16x16x32_bf16 v[20:23], v[60:63], v[136:139], v[20:23]
v_mfma_f32_16x16x32_bf16 v[20:23], v[64:67], v[140:143], v[20:23]
v_mfma_f32_16x16x32_bf16 v[20:23], v[68:71], v[144:147], v[20:23]
v_mfma_f32_16x16x32_bf16 v[20:23], v[72:75], v[148:151], v[20:23]
v_add_u32 v117, 1, v117
buffer_store_dword v117, v118, s[64:67], 0 offen
buffer_load_dwordx4 v[200:203], v2, s[52:55], s12 offen offset:0 nt
buffer_load_dwordx4 v[204:207], v2, s[52:55], s12 offen offset:1024 nt
buffer_load_dwordx4 v[208:211], v2, s[52:55], s12 offen offset:2048 nt
buffer_load_dwordx4 v[212:215], v2, s[52:55], s12 offen offset:3072 nt
s_add_u32 s13, s13, 24576
s_min_u32 s12, s13, 2146435072
v_and_b32_dpp v60, v77, v8 row_newbcast:3 row_mask:0xf bank_mask:0xf
v_and_b32_dpp v61, v77, v9 row_newbcast:3 row_mask:0xf bank_mask:0xf
v_and_b32_dpp v62, v77, v10 row_newbcast:3 row_mask:0xf bank_mask:0xf
v_and_b32_dpp v63, v77, v11 row_newbcast:3 row_mask:0xf bank_mask:0xf
v_and_b32_dpp v64, v77, v8 row_newbcast:7 row_mask:0xf bank_mask:0xf
v_and_b32_dpp v65, v77, v9 row_newbcast:7 row_mask:0xf bank_mask:0xf
v_and_b32_dpp v66, v77, v10 row_newbcast:7 row_mask:0xf bank_mask:0xf
v_and_b32_dpp v67, v77, v11 row_newbcast:7 row_mask:0xf bank_mask:0xf
v_and_b32_dpp v68, v77, v8 row_newbcast:11 row_mask:0xf bank_mask:0xf
v_and_b32_dpp v69, v77, v9 row_newbcast:11 row_mask:0xf bank_mask:0xf
v_and_b32_dpp v70, v77, v10 row_newbcast:11 row_mask:0xf bank_mask:0xf
v_and_b32_dpp v71, v77, v11 row_newbcast:11 row_mask:0xf bank_mask:0xf
v_and_b32_dpp v72, v77, v8 row_newbcast:15 row_mask:0xf bank_mask:0xf
v_and_b32_dpp v73, v77, v9 row_newbcast:15 row_mask:0xf bank_mask:0xf
v_and_b32_dpp v74, v77, v10 row_newbcast:15 row_mask:0xf bank_mask:0xf
v_and_b32_dpp v75, v77, v11 row_newbcast:15 row_mask:0xf bank_mask:0xf
v_mfma_f32_16x16x32_bf16 v[20:23], v[60:63], a[240:243], v[20:23]
v_mfma_f32_16x16x32_bf16 v[20:23], v[64:67], a[244:247], v[20:23]
v_mfma_f32_16x16x32_bf16 v[20:23], v[68:71], a[248:251], v[20:23]
v_mfma_f32_16x16x32_bf16 v[20:23], v[72:75], a[252:255], v[20:23]
s_nop 3
v_and_b32_dpp v60, v85, v8 row_newbcast:2 row_mask:0xf bank_mask:0xf
v_and_b32_dpp v61, v85, v9 row_newbcast:2 row_mask:0xf bank_mask:0xf
v_and_b32_dpp v62, v85, v10 row_newbcast:2 row_mask:0xf bank_mask:0xf
v_and_b32_dpp v63, v85, v11 row_newbcast:2 row_mask:0xf bank_mask:0xf
v_and_b32_dpp v64, v85, v8 row_newbcast:6 row_mask:0xf bank_mask:0xf
v_and_b32_dpp v65, v85, v9 row_newbcast:6 row_mask:0xf bank_mask:0xf
v_and_b32_dpp v66, v85, v10 row_newbcast:6 row_mask:0xf bank_mask:0xf
v_and_b32_dpp v67, v85, v11 row_newbcast:6 row_mask:0xf bank_mask:0xf
v_and_b32_dpp v68, v85, v8 row_newbcast:10 row_mask:0xf bank_mask:0xf
v_and_b32_dpp v69, v85, v9 row_newbcast:10 row_mask:0xf bank_mask:0xf
v_and_b32_dpp v70, v85, v10 row_newbcast:10 row_mask:0xf bank_mask:0xf
v_and_b32_dpp v71, v85, v11 row_newbcast:10 row_mask:0xf bank_mask:0xf
v_and_b32_dpp v72, v85, v8 row_newbcast:14 row_mask:0xf bank_mask:0xf
v_and_b32_dpp v73, v85, v9 row_newbcast:14 row_mask:0xf bank_mask:0xf
v_and_b32_dpp v74, v85, v10 row_newbcast:14 row_mask:0xf bank_mask:0xf
v_and_b32_dpp v75, v85, v11 row_newbcast:14 row_mask:0xf bank_mask:0xf
s_waitcnt vmcnt(15)
v_mfma_f32_16x16x32_bf16 v[20:23], v[60:63], v[152:155], v[20:23]
v_mfma_f32_16x16x32_bf16 v[20:23], v[64:67], v[156:159], v[20:23]
v_mfma_f32_16x16x32_bf16 v[20:23], v[68:71], v[160:163], v[20:23]
v_mfma_f32_16x16x32_bf16 v[20:23], v[72:75], v[164:167], v[20:23]
v_add_u32 v117, 1, v117
buffer_store_dword v117, v118, s[64:67], 0 offen
buffer_load_dwordx4 v[216:219], v2, s[52:55], s12 offen offset:0 nt
buffer_load_dwordx4 v[220:223], v2, s[52:55], s12 offen offset:1024 nt
buffer_load_dwordx4 v[224:227], v2, s[52:55], s12 offen offset:2048 nt
buffer_load_dwordx4 v[228:231], v2, s[52:55], s12 offen offset:3072 nt
s_add_u32 s13, s13, 24576
s_min_u32 s12, s13, 2146435072
v_and_b32_dpp v60, v85, v8 row_newbcast:3 row_mask:0xf bank_mask:0xf
v_and_b32_dpp v61, v85, v9 row_newbcast:3 row_mask:0xf bank_mask:0xf
v_and_b32_dpp v62, v85, v10 row_newbcast:3 row_mask:0xf bank_mask:0xf
v_and_b32_dpp v63, v85, v11 row_newbcast:3 row_mask:0xf bank_mask:0xf
v_and_b32_dpp v64, v85, v8 row_newbcast:7 row_mask:0xf bank_mask:0xf
v_and_b32_dpp v65, v85, v9 row_newbcast:7 row_mask:0xf bank_mask:0xf
v_and_b32_dpp v66, v85, v10 row_newbcast:7 row_mask:0xf bank_mask:0xf
v_and_b32_dpp v67, v85, v11 row_newbcast:7 row_mask:0xf bank_mask:0xf
v_and_b32_dpp v68, v85, v8 row_newbcast:11 row_mask:0xf bank_mask:0xf
v_and_b32_dpp v69, v85, v9 row_newbcast:11 row_mask:0xf bank_mask:0xf
v_and_b32_dpp v70, v85, v10 row_newbcast:11 row_mask:0xf bank_mask:0xf
v_and_b32_dpp v71, v85, v11 row_newbcast:11 row_mask:0xf bank_mask:0xf
v_and_b32_dpp v72, v85, v8 row_newbcast:15 row_mask:0xf bank_mask:0xf
v_and_b32_dpp v73, v85, v9 row_newbcast:15 row_mask:0xf bank_mask:0xf
v_and_b32_dpp v74, v85, v10 row_newbcast:15 row_mask:0xf bank_mask:0xf
v_and_b32_dpp v75, v85, v11 row_newbcast:15 row_mask:0xf bank_mask:0xf
s_waitcnt vmcnt(15)
v_mfma_f32_16x16x32_bf16 v[20:23], v[60:63], v[168:171], v[20:23]
v_mfma_f32_16x16x32_bf16 v[20:23], v[64:67], v[172:175], v[20:23]
v_mfma_f32_16x16x32_bf16 v[20:23], v[68:71], v[176:179], v[20:23]
v_mfma_f32_16x16x32_bf16 v[20:23], v[72:75], v[180:183], v[20:23]
v_add_u32 v117, 1, v117
buffer_store_dword v117, v118, s[64:67], 0 offen
buffer_load_dwordx4 v[232:235], v2, s[52:55], s12 offen offset:0 nt
buffer_load_dwordx4 v[236:239], v2, s[52:55], s12 offen offset:1024 nt
buffer_load_dwordx4 v[240:243], v2, s[52:55], s12 offen offset:2048 nt
buffer_load_dwordx4 v[244:247], v2, s[52:55], s12 offen offset:3072 nt
s_add_u32 s13, s13, 24576
s_min_u32 s12, s13, 2146435072
v_mov_b32 v40, 0
v_mov_b32 v41, 0
v_mov_b32 v42, 0
v_mov_b32 v43, 0
v_mov_b32 v44, 0
v_mov_b32 v45, 0
v_mov_b32 v46, 0
v_mov_b32 v47, 0
v_mov_b32 v48, 0
v_mov_b32 v49, 0
v_mov_b32 v50, 0
v_mov_b32 v51, 0
v_mov_b32 v52, 0
v_mov_b32 v53, 0
v_mov_b32 v54, 0
v_mov_b32 v55, 0
v_and_b32_dpp v120, v86, v8 row_newbcast:0 row_mask:0xf bank_mask:0xf
v_and_b32_dpp v121, v86, v9 row_newbcast:0 row_mask:0xf bank_mask:0xf
v_and_b32_dpp v122, v86, v10 row_newbcast:0 row_mask:0xf bank_mask:0xf
v_and_b32_dpp v123, v86, v11 row_newbcast:0 row_mask:0xf bank_mask:0xf
v_and_b32_dpp v124, v86, v8 row_newbcast:4 row_mask:0xf bank_mask:0xf
v_and_b32_dpp v125, v86, v9 row_newbcast:4 row_mask:0xf bank_mask:0xf
v_and_b32_dpp v126, v86, v10 row_newbcast:4 row_mask:0xf bank_mask:0xf
v_and_b32_dpp v127, v86, v11 row_newbcast:4 row_mask:0xf bank_mask:0xf
v_and_b32_dpp v128, v86, v8 row_newbcast:8 row_mask:0xf bank_mask:0xf
v_and_b32_dpp v129, v86, v9 row_newbcast:8 row_mask:0xf bank_mask:0xf
v_and_b32_dpp v130, v86, v10 row_newbcast:8 row_mask:0xf bank_mask:0xf
v_and_b32_dpp v131, v86, v11 row_newbcast:8 row_mask:0xf bank_mask:0xf
v_and_b32_dpp v132, v86, v8 row_newbcast:12 row_mask:0xf bank_mask:0xf
v_and_b32_dpp v133, v86, v9 row_newbcast:12 row_mask:0xf bank_mask:0xf
v_and_b32_dpp v134, v86, v10 row_newbcast:12 row_mask:0xf bank_mask:0xf
v_and_b32_dpp v135, v86, v11 row_newbcast:12 row_mask:0xf bank_mask:0xf
v_and_b32_dpp v136, v86, v8 row_newbcast:1 row_mask:0xf bank_mask:0xf
v_and_b32_dpp v137, v86, v9 row_newbcast:1 row_mask:0xf bank_mask:0xf
v_and_b32_dpp v138, v86, v10 row_newbcast:1 row_mask:0xf bank_mask:0xf
v_and_b32_dpp v139, v86, v11 row_newbcast:1 row_mask:0xf bank_mask:0xf
v_and_b32_dpp v140, v86, v8 row_newbcast:5 row_mask:0xf bank_mask:0xf
v_and_b32_dpp v141, v86, v9 row_newbcast:5 row_mask:0xf bank_mask:0xf
v_and_b32_dpp v142, v86, v10 row_newbcast:5 row_mask:0xf bank_mask:0xf
v_and_b32_dpp v143, v86, v11 row_newbcast:5 row_mask:0xf bank_mask:0xf
v_and_b32_dpp v144, v86, v8 row_newbcast:9 row_mask:0xf bank_mask:0xf
v_and_b32_dpp v145, v86, v9 row_newbcast:9 row_mask:0xf bank_mask:0xf
v_and_b32_dpp v146, v86, v10 row_newbcast:9 row_mask:0xf bank_mask:0xf
v_and_b32_dpp v147, v86, v11 row_newbcast:9 row_mask:0xf bank_mask:0xf
v_and_b32_dpp v148, v86, v8 row_newbcast:13 row_mask:0xf bank_mask:0xf
v_and_b32_dpp v149, v86, v9 row_newbcast:13 row_mask:0xf bank_mask:0xf
v_and_b32_dpp v150, v86, v10 row_newbcast:13 row_mask:0xf bank_mask:0xf
v_and_b32_dpp v151, v86, v11 row_newbcast:13 row_mask:0xf bank_mask:0xf
v_and_b32_dpp v152, v86, v8 row_newbcast:2 row_mask:0xf bank_mask:0xf
v_and_b32_dpp v153, v86, v9 row_newbcast:2 row_mask:0xf bank_mask:0xf
v_and_b32_dpp v154, v86, v10 row_newbcast:2 row_mask:0xf bank_mask:0xf
v_and_b32_dpp v155, v86, v11 row_newbcast:2 row_mask:0xf bank_mask:0xf
v_and_b32_dpp v156, v86, v8 row_newbcast:6 row_mask:0xf bank_mask:0xf
v_and_b32_dpp v157, v86, v9 row_newbcast:6 row_mask:0xf bank_mask:0xf
v_and_b32_dpp v158, v86, v10 row_newbcast:6 row_mask:0xf bank_mask:0xf
v_and_b32_dpp v159, v86, v11 row_newbcast:6 row_mask:0xf bank_mask:0xf
v_and_b32_dpp v160, v86, v8 row_newbcast:10 row_mask:0xf bank_mask:0xf
v_and_b32_dpp v161, v86, v9 row_newbcast:10 row_mask:0xf bank_mask:0xf
v_and_b32_dpp v162, v86, v10 row_newbcast:10 row_mask:0xf bank_mask:0xf
v_and_b32_dpp v163, v86, v11 row_newbcast:10 row_mask:0xf bank_mask:0xf
v_and_b32_dpp v164, v86, v8 row_newbcast:14 row_mask:0xf bank_mask:0xf
v_and_b32_dpp v165, v86, v9 row_newbcast:14 row_mask:0xf bank_mask:0xf
v_and_b32_dpp v166, v86, v10 row_newbcast:14 row_mask:0xf bank_mask:0xf
v_and_b32_dpp v167, v86, v11 row_newbcast:14 row_mask:0xf bank_mask:0xf
v_and_b32_dpp v168, v86, v8 row_newbcast:3 row_mask:0xf bank_mask:0xf
v_and_b32_dpp v169, v86, v9 row_newbcast:3 row_mask:0xf bank_mask:0xf
v_and_b32_dpp v170, v86, v10 row_newbcast:3 row_mask:0xf bank_mask:0xf
v_and_b32_dpp v171, v86, v11 row_newbcast:3 row_mask:0xf bank_mask:0xf
v_and_b32_dpp v172, v86, v8 row_newbcast:7 row_mask:0xf bank_mask:0xf
v_and_b32_dpp v173, v86, v9 row_newbcast:7 row_mask:0xf bank_mask:0xf
v_and_b32_dpp v174, v86, v10 row_newbcast:7 row_mask:0xf bank_mask:0xf
v_and_b32_dpp v175, v86, v11 row_newbcast:7 row_mask:0xf bank_mask:0xf
v_and_b32_dpp v176, v86, v8 row_newbcast:11 row_mask:0xf bank_mask:0xf
v_and_b32_dpp v177, v86, v9 row_newbcast:11 row_mask:0xf bank_mask:0xf
v_and_b32_dpp v178, v86, v10 row_newbcast:11 row_mask:0xf bank_mask:0xf
v_and_b32_dpp v179, v86, v11 row_newbcast:11 row_mask:0xf bank_mask:0xf
v_and_b32_dpp v180, v86, v8 row_newbcast:15 row_mask:0xf bank_mask:0xf
v_and_b32_dpp v181, v86, v9 row_newbcast:15 row_mask:0xf bank_mask:0xf
v_and_b32_dpp v182, v86, v10 row_newbcast:15 row_mask:0xf bank_mask:0xf
v_and_b32_dpp v183, v86, v11 row_newbcast:15 row_mask:0xf bank_mask:0xf
s_waitcnt vmcnt(15)
v_mfma_f32_16x16x32_bf16 v[20:23], v[120:123], v[184:187], v[20:23]
v_mfma_f32_16x16x32_bf16 v[20:23], v[124:127], v[188:191], v[20:23]
v_mfma_f32_16x16x32_bf16 v[20:23], v[128:131], v[192:195], v[20:23]
v_mfma_f32_16x16x32_bf16 v[20:23], v[132:135], v[196:199], v[20:23]
s_waitcnt vmcnt(10)
v_mfma_f32_16x16x32_bf16 v[20:23], v[136:139], v[200:203], v[20:23]
v_mfma_f32_16x16x32_bf16 v[20:23], v[140:143], v[204:207], v[20:23]
v_mfma_f32_16x16x32_bf16 v[20:23], v[144:147], v[208:211], v[20:23]
v_mfma_f32_16x16x32_bf16 v[20:23], v[148:151], v[212:215], v[20:23]
s_waitcnt vmcnt(5)
v_mfma_f32_16x16x32_bf16 v[20:23], v[152:155], v[216:219], v[20:23]
v_mfma_f32_16x16x32_bf16 v[20:23], v[156:159], v[220:223], v[20:23]
v_mfma_f32_16x16x32_bf16 v[20:23], v[160:163], v[224:227], v[20:23]
v_mfma_f32_16x16x32_bf16 v[20:23], v[164:167], v[228:231], v[20:23]
s_waitcnt vmcnt(3)
v_mfma_f32_16x16x32_bf16 v[20:23], v[168:171], v[232:235], v[20:23]
s_waitcnt vmcnt(2)
v_mfma_f32_16x16x32_bf16 v[20:23], v[172:175], v[236:239], v[20:23]
s_waitcnt vmcnt(1)
v_mfma_f32_16x16x32_bf16 v[20:23], v[176:179], v[240:243], v[20:23]
s_waitcnt vmcnt(0)
v_mfma_f32_16x16x32_bf16 v[20:23], v[180:183], v[244:247], v[20:23]
A_tail:
s_nop 7
v_mul_f32 v20, v20, v37
v_mul_f32 v21, v21, v37
v_mul_f32 v22, v22, v37
v_mul_f32 v23, v23, v37
v_cvt_pk_bf16_f32 v28, v20, v21
v_cvt_pk_bf16_f32 v29, v22, v23
ds_write_b64 v94, v[28:29]
s_waitcnt lgkmcnt(0)
s_barrier
ds_read_b128 a[0:3], v95 offset:0
ds_read_b128 a[4:7], v95 offset:64
ds_read_b128 a[8:11], v95 offset:128
ds_read_b128 a[12:15], v95 offset:192
s_waitcnt lgkmcnt(3)
v_mfma_f32_16x16x32_bf16 v[72:75], a[0:3], a[224:227], 0
s_waitcnt lgkmcnt(2)
v_mfma_f32_16x16x32_bf16 v[72:75], a[4:7], a[228:231], v[72:75]
s_waitcnt lgkmcnt(1)
v_mfma_f32_16x16x32_bf16 v[72:75], a[8:11], a[232:235], v[72:75]
s_waitcnt lgkmcnt(0)
v_mfma_f32_16x16x32_bf16 v[72:75], a[12:15], a[236:239], v[72:75]
v_smfmac_f32_16x16x64_bf16 v[40:43], a[0:3], a[96:103], v105
v_smfmac_f32_16x16x64_bf16 v[40:43], a[4:7], a[104:111], v105
v_smfmac_f32_16x16x64_bf16 v[40:43], a[8:11], a[112:119], v105
v_smfmac_f32_16x16x64_bf16 v[40:43], a[12:15], a[120:127], v105
v_smfmac_f32_16x16x64_bf16 v[44:47], a[0:3], a[128:135], v105
v_smfmac_f32_16x16x64_bf16 v[44:47], a[4:7], a[136:143], v105
v_smfmac_f32_16x16x64_bf16 v[44:47], a[8:11], a[144:151], v105
v_smfmac_f32_16x16x64_bf16 v[44:47], a[12:15], a[152:159], v105
v_pk_mul_f32 v[102:103], v[106:107], v[72:73]
v_pk_fma_f32 v[102:103], v[108:109], v[74:75], v[102:103]
v_smfmac_f32_16x16x64_bf16 v[48:51], a[0:3], a[160:167], v105
v_add_f32 v114, v102, v103
v_pk_mul_f32 v[102:103], v[106:107], v[40:41]
v_smfmac_f32_16x16x64_bf16 v[48:51], a[4:7], a[168:175], v105
v_pk_fma_f32 v[102:103], v[108:109], v[42:43], v[102:103]
v_mov_b32_dpp v29, v114 row_shl:2 row_mask:0xf bank_mask:0xf
v_smfmac_f32_16x16x64_bf16 v[48:51], a[8:11], a[176:183], v105
v_cvt_pk_bf16_f32 v28, v114, v29
v_min_u32 v28, -2, v28
v_smfmac_f32_16x16x64_bf16 v[48:51], a[12:15], a[184:191], v105
v_add_f32 v98, v102, v103
v_pk_mul_f32 v[102:103], v[106:107], v[44:45]
v_smfmac_f32_16x16x64_bf16 v[52:55], a[0:3], a[192:199], v105
v_mov_b32_dpp v29, v28 row_shl:4 row_mask:0xf bank_mask:0xf
v_mov_b32_dpp v30, v28 row_shl:8 row_mask:0xf bank_mask:0xf
v_smfmac_f32_16x16x64_bf16 v[52:55], a[4:7], a[200:207], v105
v_mov_b32_dpp v31, v28 row_shl:12 row_mask:0xf bank_mask:0xf
s_mov_b64 exec, 0x00030003
buffer_store_dwordx4 v[28:31], v93, s[64:67], 0 offen offset:1024 sc1
s_mov_b64 exec, -1
v_smfmac_f32_16x16x64_bf16 v[52:55], a[8:11], a[208:215], v105
v_pk_fma_f32 v[102:103], v[108:109], v[46:47], v[102:103]
v_add_f32 v99, v102, v103
v_smfmac_f32_16x16x64_bf16 v[52:55], a[12:15], a[216:223], v105
v_cvt_pk_bf16_f32 v110, v98, v99
v_min_u32 v110, -2, v110
v_pk_mul_f32 v[102:103], v[106:107], v[48:49]
v_pk_fma_f32 v[102:103], v[108:109], v[50:51], v[102:103]
v_add_f32 v100, v102, v103
v_permlane32_swap_b32 v110, v112
s_nop 1
v_pk_mul_f32 v[102:103], v[106:107], v[52:53]
v_pk_fma_f32 v[102:103], v[108:109], v[54:55], v[102:103]
v_add_f32 v101, v102, v103
v_cvt_pk_bf16_f32 v111, v100, v101
v_min_u32 v111, -2, v111
s_nop 1
v_permlane32_swap_b32 v111, v113
s_mov_b64 exec, 0xffffffff
buffer_store_dwordx4 v[110:113], v92, s[64:67], 0 offen sc1
s_mov_b64 exec, -1
s_endpgm
L_exit:
s_endpgm
B_role:
s_mov_b32 s8, s5
s_lshl_b32 s9, s4, 1
s_add_u32 s9, s9, s8
v_and_b32 v1, 63, v0
v_lshlrev_b32 v2, 4, v1
v_lshrrev_b32 v9, 4, v1
v_and_b32 v8, 15, v1
v_mul_u32_u24 v3, 294912, v9
v_lshl_add_u32 v3, v8, 4, v3
v_mul_u32_u24 v4, 72, v9
v_lshrrev_b32 v6, 3, v8
v_mul_u32_u24 v6, 1152, v6
v_add_u32 v4, v4, v6
v_lshlrev_b32 v238, 17, v9
v_lshl_add_u32 v238, v8, 4, v238
s_waitcnt lgkmcnt(0)
s_mul_i32 s6, s3, 288
s_sub_u32 s7, 4608, s6
s_add_u32 s44, s26, s6
s_addc_u32 s45, s27, 0
s_mov_b32 s46, s7
s_mov_b32 s47, 0x20000
s_mul_i32 s6, s3, 1179648
s_lshl_b32 s7, s4, 8
s_add_u32 s6, s6, s7
s_sub_u32 s7, 4718592, s6
s_add_u32 s48, s30, s6
s_addc_u32 s49, s31, 0
s_mov_b32 s50, s7
s_mov_b32 s51, 0x20000
buffer_load_dwordx4 v[24:27], v4, s[44:47], 0 offen offset:0
buffer_load_dwordx4 v[28:31], v4, s[44:47], 0 offen offset:16
buffer_load_dwordx4 v[32:35], v4, s[44:47], 0 offen offset:32
buffer_load_dwordx4 v[36:39], v4, s[44:47], 0 offen offset:48
buffer_load_dwordx2 v[40:41], v4, s[44:47], 0 offen offset:64
buffer_load_dwordx4 v[44:47], v4, s[44:47], 0 offen offset:2304
buffer_load_dwordx4 v[48:51], v4, s[44:47], 0 offen offset:2320
buffer_load_dwordx4 v[52:55], v4, s[44:47], 0 offen offset:2336
buffer_load_dwordx4 v[56:59], v4, s[44:47], 0 offen offset:2352
buffer_load_dwordx2 v[60:61], v4, s[44:47], 0 offen offset:2368
s_mov_b32 s6, 0
buffer_load_dwordx4 a[96:99], v3, s[48:51], s6 offen nt
s_mov_b32 s6, 8192
buffer_load_dwordx4 a[100:103], v3, s[48:51], s6 offen nt
s_mov_b32 s6, 16384
buffer_load_dwordx4 a[104:107], v3, s[48:51], s6 offen nt
s_mov_b32 s6, 24576
buffer_load_dwordx4 a[108:111], v3, s[48:51], s6 offen nt
s_mov_b32 s6, 32768
buffer_load_dwordx4 a[112:115], v3, s[48:51], s6 offen nt
s_mov_b32 s6, 40960
buffer_load_dwordx4 a[116:119], v3, s[48:51], s6 offen nt
s_mov_b32 s6, 49152
buffer_load_dwordx4 a[120:123], v3, s[48:51], s6 offen nt
s_mov_b32 s6, 57344
buffer_load_dwordx4 a[124:127], v3, s[48:51], s6 offen nt
s_mov_b32 s6, 65536
buffer_load_dwordx4 a[128:131], v3, s[48:51], s6 offen nt
s_mov_b32 s6, 73728
buffer_load_dwordx4 a[132:135], v3, s[48:51], s6 offen nt
s_mov_b32 s6, 81920
buffer_load_dwordx4 a[136:139], v3, s[48:51], s6 offen nt
s_mov_b32 s6, 90112
buffer_load_dwordx4 a[140:143], v3, s[48:51], s6 offen nt
s_mov_b32 s6, 98304
buffer_load_dwordx4 a[144:147], v3, s[48:51], s6 offen nt
s_mov_b32 s6, 106496
buffer_load_dwordx4 a[148:151], v3, s[48:51], s6 offen nt
s_mov_b32 s6, 114688
buffer_load_dwordx4 a[152:155], v3, s[48:51], s6 offen nt
s_mov_b32 s6, 122880
buffer_load_dwordx4 a[156:159], v3, s[48:51], s6 offen nt
s_mov_b32 s6, 131072
buffer_load_dwordx4 a[160:163], v3, s[48:51], s6 offen nt
s_mov_b32 s6, 139264
buffer_load_dwordx4 a[164:167], v3, s[48:51], s6 offen nt
s_mov_b32 s6, 147456
buffer_load_dwordx4 a[168:171], v3, s[48:51], s6 offen nt
s_mov_b32 s6, 155648
buffer_load_dwordx4 a[172:175], v3, s[48:51], s6 offen nt
s_mov_b32 s6, 163840
buffer_load_dwordx4 a[176:179], v3, s[48:51], s6 offen nt
s_mov_b32 s6, 172032
buffer_load_dwordx4 a[180:183], v3, s[48:51], s6 offen nt
s_mov_b32 s6, 180224
buffer_load_dwordx4 a[184:187], v3, s[48:51], s6 offen nt
s_mov_b32 s6, 188416
buffer_load_dwordx4 a[188:191], v3, s[48:51], s6 offen nt
s_mov_b32 s6, 196608
buffer_load_dwordx4 a[192:195], v3, s[48:51], s6 offen nt
s_mov_b32 s6, 204800
buffer_load_dwordx4 a[196:199], v3, s[48:51], s6 offen nt
s_mov_b32 s6, 212992
buffer_load_dwordx4 a[200:203], v3, s[48:51], s6 offen nt
s_mov_b32 s6, 221184
buffer_load_dwordx4 a[204:207], v3, s[48:51], s6 offen nt
s_mov_b32 s6, 229376
buffer_load_dwordx4 a[208:211], v3, s[48:51], s6 offen nt
s_mov_b32 s6, 237568
buffer_load_dwordx4 a[212:215], v3, s[48:51], s6 offen nt
s_mov_b32 s6, 245760
buffer_load_dwordx4 a[216:219], v3, s[48:51], s6 offen nt
s_mov_b32 s6, 253952
buffer_load_dwordx4 a[220:223], v3, s[48:51], s6 offen nt
s_mov_b32 s6, 262144
buffer_load_dwordx4 a[224:227], v3, s[48:51], s6 offen nt
s_mov_b32 s6, 270336
buffer_load_dwordx4 a[228:231], v3, s[48:51], s6 offen nt
s_mov_b32 s6, 278528
buffer_load_dwordx4 a[232:235], v3, s[48:51], s6 offen nt
s_mov_b32 s6, 286720
buffer_load_dwordx4 a[236:239], v3, s[48:51], s6 offen nt
s_lshl_b32 s6, s3, 20
s_lshl_b32 s7, s4, 8
s_add_u32 s6, s6, s7
s_sub_u32 s7, 4194304, s6
s_add_u32 s76, s32, s6
s_addc_u32 s77, s33, 0
s_mov_b32 s78, s7
s_mov_b32 s79, 0x20000
s_add_u32 s52, s34, s6
s_addc_u32 s53, s35, 0
s_mov_b32 s54, s7
s_mov_b32 s55, 0x20000
s_mov_b32 s6, 0
buffer_load_dwordx4 v[88:91], v238, s[76:79], s6 offen nt
s_mov_b32 s6, 8192
buffer_load_dwordx4 v[92:95], v238, s[76:79], s6 offen nt
s_mov_b32 s6, 16384
buffer_load_dwordx4 v[96:99], v238, s[76:79], s6 offen nt
s_mov_b32 s6, 24576
buffer_load_dwordx4 v[100:103], v238, s[76:79], s6 offen nt
s_mov_b32 s6, 32768
buffer_load_dwordx4 v[104:107], v238, s[76:79], s6 offen nt
s_mov_b32 s6, 40960
buffer_load_dwordx4 v[108:111], v238, s[76:79], s6 offen nt
s_mov_b32 s6, 49152
buffer_load_dwordx4 v[112:115], v238, s[76:79], s6 offen nt
s_mov_b32 s6, 57344
buffer_load_dwordx4 v[116:119], v238, s[76:79], s6 offen nt
s_mov_b32 s6, 65536
buffer_load_dwordx4 v[120:123], v238, s[76:79], s6 offen nt
s_mov_b32 s6, 73728
buffer_load_dwordx4 v[124:127], v238, s[76:79], s6 offen nt
s_mov_b32 s6, 81920
buffer_load_dwordx4 v[128:131], v238, s[76:79], s6 offen nt
s_mov_b32 s6, 90112
buffer_load_dwordx4 v[132:135], v238, s[76:79], s6 offen nt
s_mov_b32 s64, s42
s_mov_b32 s65, s43
s_mov_b32 s66, 16777216
s_mov_b32 s67, 0x20000
s_mov_b32 s68, s40
s_mov_b32 s69, s41
s_mov_b32 s70, 256
s_mov_b32 s71, 0x20000
s_mov_b32 s72, s38
s_mov_b32 s73, s39
s_mov_b32 s74, 9216
s_mov_b32 s75, 0x20000
s_mul_i32 s6, s4, 147456
s_add_u32 s60, s36, s6
s_addc_u32 s61, s37, 0
s_mov_b32 s62, 147456
s_mov_b32 s63, 0x20000
v_and_b32 v5, 1, v1
v_lshlrev_b32 v5, 4, v5
v_mov_b32 v6, 0xffff
v_lshlrev_b32 v5, v5, v6
v_bfe_u32 v6, v1, 1, 2
v_cmp_eq_u32 vcc, 0, v6
s_nop 1
v_cndmask_b32 v12, 0, v5, vcc
v_cmp_eq_u32 vcc, 1, v6
s_nop 1
v_cndmask_b32 v13, 0, v5, vcc
v_cmp_eq_u32 vcc, 2, v6
s_nop 1
v_cndmask_b32 v14, 0, v5, vcc
v_cmp_eq_u32 vcc, 3, v6
s_nop 1
v_cndmask_b32 v15, 0, v5, vcc
v_mov_b32 v5, 0x0c0c0c0c
s_mov_b32 s6, 0x01000100
s_mov_b32 s7, 0x03020302
v_bfi_b32 v16, v12, s6, v5
v_bfi_b32 v17, v13, s6, v5
v_bfi_b32 v18, v14, s6, v5
v_bfi_b32 v19, v15, s6, v5
v_bfi_b32 v20, v12, s7, v5
v_bfi_b32 v21, v13, s7, v5
v_bfi_b32 v22, v14, s7, v5
v_bfi_b32 v23, v15, s7, v5
v_lshrrev_b32 v5, 4, v1
v_lshlrev_b32 v5, 3, v5
v_bfe_u32 v6, v1, 2, 2
v_add_u32 v5, v5, v6
v_mul_u32_u24 v5, 1152, v5
s_mul_i32 s6, s3, 288
v_add_u32 v5, s6, v5
v_and_b32 v6, 3, v1
v_lshl_add_u32 v240, v6, 5, v5
v_lshl_add_u32 v241, v6, 3, v5
v_add_u32 v241, 256, v241
v_add_u32 v242, 73728, v240
v_add_u32 v243, 73728, v241
s_mul_i32 s12, s3, 36864
s_waitcnt vmcnt(47)
v_perm_b32 v64, v24, v24, v16
v_perm_b32 v65, v24, v24, v17
v_perm_b32 v66, v24, v24, v18
v_perm_b32 v67, v24, v24, v19
s_nop 1
v_mfma_f32_16x16x32_bf16 v[80:83], v[64:67], a[96:99], 0
v_perm_b32 v68, v44, v44, v16
v_perm_b32 v69, v44, v44, v17
v_perm_b32 v70, v44, v44, v18
v_perm_b32 v71, v44, v44, v19
s_nop 1
v_mfma_f32_16x16x32_bf16 v[84:87], v[68:71], a[96:99], 0
s_mov_b32 s6, 98304
buffer_load_dwordx4 v[136:139], v238, s[76:79], s6 offen nt
s_waitcnt vmcnt(47)
v_perm_b32 v72, v24, v24, v20
v_perm_b32 v73, v24, v24, v21
v_perm_b32 v74, v24, v24, v22
v_perm_b32 v75, v24, v24, v23
s_nop 1
v_mfma_f32_16x16x32_bf16 v[80:83], v[72:75], a[100:103], v[80:83]
v_perm_b32 v76, v44, v44, v20
v_perm_b32 v77, v44, v44, v21
v_perm_b32 v78, v44, v44, v22
v_perm_b32 v79, v44, v44, v23
s_nop 1
v_mfma_f32_16x16x32_bf16 v[84:87], v[76:79], a[100:103], v[84:87]
s_mov_b32 s6, 106496
buffer_load_dwordx4 v[140:143], v238, s[76:79], s6 offen nt
s_waitcnt vmcnt(47)
v_perm_b32 v64, v25, v25, v16
v_perm_b32 v65, v25, v25, v17
v_perm_b32 v66, v25, v25, v18
v_perm_b32 v67, v25, v25, v19
s_nop 1
v_mfma_f32_16x16x32_bf16 v[80:83], v[64:67], a[104:107], v[80:83]
v_perm_b32 v68, v45, v45, v16
v_perm_b32 v69, v45, v45, v17
v_perm_b32 v70, v45, v45, v18
v_perm_b32 v71, v45, v45, v19
s_nop 1
v_mfma_f32_16x16x32_bf16 v[84:87], v[68:71], a[104:107], v[84:87]
s_mov_b32 s6, 114688
buffer_load_dwordx4 v[144:147], v238, s[76:79], s6 offen nt
s_waitcnt vmcnt(47)
v_perm_b32 v72, v25, v25, v20
v_perm_b32 v73, v25, v25, v21
v_perm_b32 v74, v25, v25, v22
v_perm_b32 v75, v25, v25, v23
s_nop 1
v_mfma_f32_16x16x32_bf16 v[80:83], v[72:75], a[108:111], v[80:83]
v_perm_b32 v76, v45, v45, v20
v_perm_b32 v77, v45, v45, v21
v_perm_b32 v78, v45, v45, v22
v_perm_b32 v79, v45, v45, v23
s_nop 1
v_mfma_f32_16x16x32_bf16 v[84:87], v[76:79], a[108:111], v[84:87]
s_mov_b32 s6, 122880
buffer_load_dwordx4 v[148:151], v238, s[76:79], s6 offen nt
s_waitcnt vmcnt(47)
v_perm_b32 v64, v26, v26, v16
v_perm_b32 v65, v26, v26, v17
v_perm_b32 v66, v26, v26, v18
v_perm_b32 v67, v26, v26, v19
s_nop 1
v_mfma_f32_16x16x32_bf16 v[80:83], v[64:67], a[112:115], v[80:83]
v_perm_b32 v68, v46, v46, v16
v_perm_b32 v69, v46, v46, v17
v_perm_b32 v70, v46, v46, v18
v_perm_b32 v71, v46, v46, v19
s_nop 1
v_mfma_f32_16x16x32_bf16 v[84:87], v[68:71], a[112:115], v[84:87]
s_mov_b32 s6, 524288
buffer_load_dwordx4 v[152:155], v238, s[76:79], s6 offen nt
s_waitcnt vmcnt(47)
v_perm_b32 v72, v26, v26, v20
v_perm_b32 v73, v26, v26, v21
v_perm_b32 v74, v26, v26, v22
v_perm_b32 v75, v26, v26, v23
s_nop 1
v_mfma_f32_16x16x32_bf16 v[80:83], v[72:75], a[116:119], v[80:83]
v_perm_b32 v76, v46, v46, v20
v_perm_b32 v77, v46, v46, v21
v_perm_b32 v78, v46, v46, v22
v_perm_b32 v79, v46, v46, v23
s_nop 1
v_mfma_f32_16x16x32_bf16 v[84:87], v[76:79], a[116:119], v[84:87]
s_mov_b32 s6, 532480
buffer_load_dwordx4 v[156:159], v238, s[76:79], s6 offen nt
s_waitcnt vmcnt(47)
v_perm_b32 v64, v27, v27, v16
v_perm_b32 v65, v27, v27, v17
v_perm_b32 v66, v27, v27, v18
v_perm_b32 v67, v27, v27, v19
s_nop 1
v_mfma_f32_16x16x32_bf16 v[80:83], v[64:67], a[120:123], v[80:83]
v_perm_b32 v68, v47, v47, v16
v_perm_b32 v69, v47, v47, v17
v_perm_b32 v70, v47, v47, v18
v_perm_b32 v71, v47, v47, v19
s_nop 1
v_mfma_f32_16x16x32_bf16 v[84:87], v[68:71], a[120:123], v[84:87]
s_mov_b32 s6, 540672
buffer_load_dwordx4 v[160:163], v238, s[76:79], s6 offen nt
s_waitcnt vmcnt(47)
v_perm_b32 v72, v27, v27, v20
v_perm_b32 v73, v27, v27, v21
v_perm_b32 v74, v27, v27, v22
v_perm_b32 v75, v27, v27, v23
s_nop 1
v_mfma_f32_16x16x32_bf16 v[80:83], v[72:75], a[124:127], v[80:83]
v_perm_b32 v76, v47, v47, v20
v_perm_b32 v77, v47, v47, v21
v_perm_b32 v78, v47, v47, v22
v_perm_b32 v79, v47, v47, v23
s_nop 1
v_mfma_f32_16x16x32_bf16 v[84:87], v[76:79], a[124:127], v[84:87]
s_mov_b32 s6, 548864
buffer_load_dwordx4 v[164:167], v238, s[76:79], s6 offen nt
s_waitcnt vmcnt(47)
v_perm_b32 v64, v28, v28, v16
v_perm_b32 v65, v28, v28, v17
v_perm_b32 v66, v28, v28, v18
v_perm_b32 v67, v28, v28, v19
s_nop 1
v_mfma_f32_16x16x32_bf16 v[80:83], v[64:67], a[128:131], v[80:83]
v_perm_b32 v68, v48, v48, v16
v_perm_b32 v69, v48, v48, v17
v_perm_b32 v70, v48, v48, v18
v_perm_b32 v71, v48, v48, v19
s_nop 1
v_mfma_f32_16x16x32_bf16 v[84:87], v[68:71], a[128:131], v[84:87]
s_mov_b32 s6, 557056
buffer_load_dwordx4 v[168:171], v238, s[76:79], s6 offen nt
s_waitcnt vmcnt(47)
v_perm_b32 v72, v28, v28, v20
v_perm_b32 v73, v28, v28, v21
v_perm_b32 v74, v28, v28, v22
v_perm_b32 v75, v28, v28, v23
s_nop 1
v_mfma_f32_16x16x32_bf16 v[80:83], v[72:75], a[132:135], v[80:83]
v_perm_b32 v76, v48, v48, v20
v_perm_b32 v77, v48, v48, v21
v_perm_b32 v78, v48, v48, v22
v_perm_b32 v79, v48, v48, v23
s_nop 1
v_mfma_f32_16x16x32_bf16 v[84:87], v[76:79], a[132:135], v[84:87]
s_mov_b32 s6, 565248
buffer_load_dwordx4 v[172:175], v238, s[76:79], s6 offen nt
s_waitcnt vmcnt(47)
v_perm_b32 v64, v29, v29, v16
v_perm_b32 v65, v29, v29, v17
v_perm_b32 v66, v29, v29, v18
v_perm_b32 v67, v29, v29, v19
s_nop 1
v_mfma_f32_16x16x32_bf16 v[80:83], v[64:67], a[136:139], v[80:83]
v_perm_b32 v68, v49, v49, v16
v_perm_b32 v69, v49, v49, v17
v_perm_b32 v70, v49, v49, v18
v_perm_b32 v71, v49, v49, v19
s_nop 1
v_mfma_f32_16x16x32_bf16 v[84:87], v[68:71], a[136:139], v[84:87]
s_mov_b32 s6, 573440
buffer_load_dwordx4 v[176:179], v238, s[76:79], s6 offen nt
s_waitcnt vmcnt(47)
v_perm_b32 v72, v29, v29, v20
v_perm_b32 v73, v29, v29, v21
v_perm_b32 v74, v29, v29, v22
v_perm_b32 v75, v29, v29, v23
s_nop 1
v_mfma_f32_16x16x32_bf16 v[80:83], v[72:75], a[140:143], v[80:83]
v_perm_b32 v76, v49, v49, v20
v_perm_b32 v77, v49, v49, v21
v_perm_b32 v78, v49, v49, v22
v_perm_b32 v79, v49, v49, v23
s_nop 1
v_mfma_f32_16x16x32_bf16 v[84:87], v[76:79], a[140:143], v[84:87]
s_mov_b32 s6, 581632
buffer_load_dwordx4 v[180:183], v238, s[76:79], s6 offen nt
s_waitcnt vmcnt(47)
v_perm_b32 v64, v30, v30, v16
v_perm_b32 v65, v30, v30, v17
v_perm_b32 v66, v30, v30, v18
v_perm_b32 v67, v30, v30, v19
s_nop 1
v_mfma_f32_16x16x32_bf16 v[80:83], v[64:67], a[144:147], v[80:83]
v_perm_b32 v68, v50, v50, v16
v_perm_b32 v69, v50, v50, v17
v_perm_b32 v70, v50, v50, v18
v_perm_b32 v71, v50, v50, v19
s_nop 1
v_mfma_f32_16x16x32_bf16 v[84:87], v[68:71], a[144:147], v[84:87]
s_mov_b32 s6, 589824
buffer_load_dwordx4 v[184:187], v238, s[76:79], s6 offen nt
s_waitcnt vmcnt(47)
v_perm_b32 v72, v30, v30, v20
v_perm_b32 v73, v30, v30, v21
v_perm_b32 v74, v30, v30, v22
v_perm_b32 v75, v30, v30, v23
s_nop 1
v_mfma_f32_16x16x32_bf16 v[80:83], v[72:75], a[148:151], v[80:83]
v_perm_b32 v76, v50, v50, v20
v_perm_b32 v77, v50, v50, v21
v_perm_b32 v78, v50, v50, v22
v_perm_b32 v79, v50, v50, v23
s_nop 1
v_mfma_f32_16x16x32_bf16 v[84:87], v[76:79], a[148:151], v[84:87]
s_mov_b32 s6, 598016
buffer_load_dwordx4 v[188:191], v238, s[76:79], s6 offen nt
s_waitcnt vmcnt(47)
v_perm_b32 v64, v31, v31, v16
v_perm_b32 v65, v31, v31, v17
v_perm_b32 v66, v31, v31, v18
v_perm_b32 v67, v31, v31, v19
s_nop 1
v_mfma_f32_16x16x32_bf16 v[80:83], v[64:67], a[152:155], v[80:83]
v_perm_b32 v68, v51, v51, v16
v_perm_b32 v69, v51, v51, v17
v_perm_b32 v70, v51, v51, v18
v_perm_b32 v71, v51, v51, v19
s_nop 1
v_mfma_f32_16x16x32_bf16 v[84:87], v[68:71], a[152:155], v[84:87]
s_mov_b32 s6, 606208
buffer_load_dwordx4 v[192:195], v238, s[76:79], s6 offen nt
s_waitcnt vmcnt(47)
v_perm_b32 v72, v31, v31, v20
v_perm_b32 v73, v31, v31, v21
v_perm_b32 v74, v31, v31, v22
v_perm_b32 v75, v31, v31, v23
s_nop 1
v_mfma_f32_16x16x32_bf16 v[80:83], v[72:75], a[156:159], v[80:83]
v_perm_b32 v76, v51, v51, v20
v_perm_b32 v77, v51, v51, v21
v_perm_b32 v78, v51, v51, v22
v_perm_b32 v79, v51, v51, v23
s_nop 1
v_mfma_f32_16x16x32_bf16 v[84:87], v[76:79], a[156:159], v[84:87]
s_mov_b32 s6, 614400
buffer_load_dwordx4 v[196:199], v238, s[76:79], s6 offen nt
s_waitcnt vmcnt(47)
v_perm_b32 v64, v32, v32, v16
v_perm_b32 v65, v32, v32, v17
v_perm_b32 v66, v32, v32, v18
v_perm_b32 v67, v32, v32, v19
s_nop 1
v_mfma_f32_16x16x32_bf16 v[80:83], v[64:67], a[160:163], v[80:83]
v_perm_b32 v68, v52, v52, v16
v_perm_b32 v69, v52, v52, v17
v_perm_b32 v70, v52, v52, v18
v_perm_b32 v71, v52, v52, v19
s_nop 1
v_mfma_f32_16x16x32_bf16 v[84:87], v[68:71], a[160:163], v[84:87]
s_mov_b32 s6, 622592
buffer_load_dwordx4 v[200:203], v238, s[76:79], s6 offen nt
s_waitcnt vmcnt(47)
v_perm_b32 v72, v32, v32, v20
v_perm_b32 v73, v32, v32, v21
v_perm_b32 v74, v32, v32, v22
v_perm_b32 v75, v32, v32, v23
s_nop 1
v_mfma_f32_16x16x32_bf16 v[80:83], v[72:75], a[164:167], v[80:83]
v_perm_b32 v76, v52, v52, v20
v_perm_b32 v77, v52, v52, v21
v_perm_b32 v78, v52, v52, v22
v_perm_b32 v79, v52, v52, v23
s_nop 1
v_mfma_f32_16x16x32_bf16 v[84:87], v[76:79], a[164:167], v[84:87]
s_mov_b32 s6, 630784
buffer_load_dwordx4 v[204:207], v238, s[76:79], s6 offen nt
s_waitcnt vmcnt(47)
v_perm_b32 v64, v33, v33, v16
v_perm_b32 v65, v33, v33, v17
v_perm_b32 v66, v33, v33, v18
v_perm_b32 v67, v33, v33, v19
s_nop 1
v_mfma_f32_16x16x32_bf16 v[80:83], v[64:67], a[168:171], v[80:83]
v_perm_b32 v68, v53, v53, v16
v_perm_b32 v69, v53, v53, v17
v_perm_b32 v70, v53, v53, v18
v_perm_b32 v71, v53, v53, v19
s_nop 1
v_mfma_f32_16x16x32_bf16 v[84:87], v[68:71], a[168:171], v[84:87]
s_mov_b32 s6, 638976
buffer_load_dwordx4 v[208:211], v238, s[76:79], s6 offen nt
s_waitcnt vmcnt(47)
v_perm_b32 v72, v33, v33, v20
v_perm_b32 v73, v33, v33, v21
v_perm_b32 v74, v33, v33, v22
v_perm_b32 v75, v33, v33, v23
s_nop 1
v_mfma_f32_16x16x32_bf16 v[80:83], v[72:75], a[172:175], v[80:83]
v_perm_b32 v76, v53, v53, v20
v_perm_b32 v77, v53, v53, v21
v_perm_b32 v78, v53, v53, v22
v_perm_b32 v79, v53, v53, v23
s_nop 1
v_mfma_f32_16x16x32_bf16 v[84:87], v[76:79], a[172:175], v[84:87]
s_mov_b32 s6, 647168
buffer_load_dwordx4 v[212:215], v238, s[76:79], s6 offen nt
s_waitcnt vmcnt(47)
v_perm_b32 v64, v34, v34, v16
v_perm_b32 v65, v34, v34, v17
v_perm_b32 v66, v34, v34, v18
v_perm_b32 v67, v34, v34, v19
s_nop 1
v_mfma_f32_16x16x32_bf16 v[80:83], v[64:67], a[176:179], v[80:83]
v_perm_b32 v68, v54, v54, v16
v_perm_b32 v69, v54, v54, v17
v_perm_b32 v70, v54, v54, v18
v_perm_b32 v71, v54, v54, v19
s_nop 1
v_mfma_f32_16x16x32_bf16 v[84:87], v[68:71], a[176:179], v[84:87]
buffer_load_dword v11, off, s[68:71], 0 offset:0 sc1
s_waitcnt vmcnt(47)
v_perm_b32 v72, v34, v34, v20
v_perm_b32 v73, v34, v34, v21
v_perm_b32 v74, v34, v34, v22
v_perm_b32 v75, v34, v34, v23
s_nop 1
v_mfma_f32_16x16x32_bf16 v[80:83], v[72:75], a[180:183], v[80:83]
v_perm_b32 v76, v54, v54, v20
v_perm_b32 v77, v54, v54, v21
v_perm_b32 v78, v54, v54, v22
v_perm_b32 v79, v54, v54, v23
s_nop 1
v_mfma_f32_16x16x32_bf16 v[84:87], v[76:79], a[180:183], v[84:87]
s_waitcnt vmcnt(46)
v_perm_b32 v64, v35, v35, v16
v_perm_b32 v65, v35, v35, v17
v_perm_b32 v66, v35, v35, v18
v_perm_b32 v67, v35, v35, v19
s_nop 1
v_mfma_f32_16x16x32_bf16 v[80:83], v[64:67], a[184:187], v[80:83]
v_perm_b32 v68, v55, v55, v16
v_perm_b32 v69, v55, v55, v17
v_perm_b32 v70, v55, v55, v18
v_perm_b32 v71, v55, v55, v19
s_nop 1
v_mfma_f32_16x16x32_bf16 v[84:87], v[68:71], a[184:187], v[84:87]
s_waitcnt vmcnt(45)
v_perm_b32 v72, v35, v35, v20
v_perm_b32 v73, v35, v35, v21
v_perm_b32 v74, v35, v35, v22
v_perm_b32 v75, v35, v35, v23
s_nop 1
v_mfma_f32_16x16x32_bf16 v[80:83], v[72:75], a[188:191], v[80:83]
v_perm_b32 v76, v55, v55, v20
v_perm_b32 v77, v55, v55, v21
v_perm_b32 v78, v55, v55, v22
v_perm_b32 v79, v55, v55, v23
s_nop 1
v_mfma_f32_16x16x32_bf16 v[84:87], v[76:79], a[188:191], v[84:87]
s_waitcnt vmcnt(44)
v_perm_b32 v64, v36, v36, v16
v_perm_b32 v65, v36, v36, v17
v_perm_b32 v66, v36, v36, v18
v_perm_b32 v67, v36, v36, v19
s_nop 1
v_mfma_f32_16x16x32_bf16 v[80:83], v[64:67], a[192:195], v[80:83]
v_perm_b32 v68, v56, v56, v16
v_perm_b32 v69, v56, v56, v17
v_perm_b32 v70, v56, v56, v18
v_perm_b32 v71, v56, v56, v19
s_nop 1
v_mfma_f32_16x16x32_bf16 v[84:87], v[68:71], a[192:195], v[84:87]
s_waitcnt vmcnt(43)
v_perm_b32 v72, v36, v36, v20
v_perm_b32 v73, v36, v36, v21
v_perm_b32 v74, v36, v36, v22
v_perm_b32 v75, v36, v36, v23
s_nop 1
v_mfma_f32_16x16x32_bf16 v[80:83], v[72:75], a[196:199], v[80:83]
v_perm_b32 v76, v56, v56, v20
v_perm_b32 v77, v56, v56, v21
v_perm_b32 v78, v56, v56, v22
v_perm_b32 v79, v56, v56, v23
s_nop 1
v_mfma_f32_16x16x32_bf16 v[84:87], v[76:79], a[196:199], v[84:87]
s_waitcnt vmcnt(42)
v_perm_b32 v64, v37, v37, v16
v_perm_b32 v65, v37, v37, v17
v_perm_b32 v66, v37, v37, v18
v_perm_b32 v67, v37, v37, v19
s_nop 1
v_mfma_f32_16x16x32_bf16 v[80:83], v[64:67], a[200:203], v[80:83]
v_perm_b32 v68, v57, v57, v16
v_perm_b32 v69, v57, v57, v17
v_perm_b32 v70, v57, v57, v18
v_perm_b32 v71, v57, v57, v19
s_nop 1
v_mfma_f32_16x16x32_bf16 v[84:87], v[68:71], a[200:203], v[84:87]
s_waitcnt vmcnt(41)
v_perm_b32 v72, v37, v37, v20
v_perm_b32 v73, v37, v37, v21
v_perm_b32 v74, v37, v37, v22
v_perm_b32 v75, v37, v37, v23
s_nop 1
v_mfma_f32_16x16x32_bf16 v[80:83], v[72:75], a[204:207], v[80:83]
v_perm_b32 v76, v57, v57, v20
v_perm_b32 v77, v57, v57, v21
v_perm_b32 v78, v57, v57, v22
v_perm_b32 v79, v57, v57, v23
s_nop 1
v_mfma_f32_16x16x32_bf16 v[84:87], v[76:79], a[204:207], v[84:87]
s_waitcnt vmcnt(40)
v_perm_b32 v64, v38, v38, v16
v_perm_b32 v65, v38, v38, v17
v_perm_b32 v66, v38, v38, v18
v_perm_b32 v67, v38, v38, v19
s_nop 1
v_mfma_f32_16x16x32_bf16 v[80:83], v[64:67], a[208:211], v[80:83]
v_perm_b32 v68, v58, v58, v16
v_perm_b32 v69, v58, v58, v17
v_perm_b32 v70, v58, v58, v18
v_perm_b32 v71, v58, v58, v19
s_nop 1
v_mfma_f32_16x16x32_bf16 v[84:87], v[68:71], a[208:211], v[84:87]
s_waitcnt vmcnt(39)
v_perm_b32 v72, v38, v38, v20
v_perm_b32 v73, v38, v38, v21
v_perm_b32 v74, v38, v38, v22
v_perm_b32 v75, v38, v38, v23
s_nop 1
v_mfma_f32_16x16x32_bf16 v[80:83], v[72:75], a[212:215], v[80:83]
v_perm_b32 v76, v58, v58, v20
v_perm_b32 v77, v58, v58, v21
v_perm_b32 v78, v58, v58, v22
v_perm_b32 v79, v58, v58, v23
s_nop 1
v_mfma_f32_16x16x32_bf16 v[84:87], v[76:79], a[212:215], v[84:87]
s_waitcnt vmcnt(38)
v_perm_b32 v64, v39, v39, v16
v_perm_b32 v65, v39, v39, v17
v_perm_b32 v66, v39, v39, v18
v_perm_b32 v67, v39, v39, v19
s_nop 1
v_mfma_f32_16x16x32_bf16 v[80:83], v[64:67], a[216:219], v[80:83]
v_perm_b32 v68, v59, v59, v16
v_perm_b32 v69, v59, v59, v17
v_perm_b32 v70, v59, v59, v18
v_perm_b32 v71, v59, v59, v19
s_nop 1
v_mfma_f32_16x16x32_bf16 v[84:87], v[68:71], a[216:219], v[84:87]
s_waitcnt vmcnt(37)
v_perm_b32 v72, v39, v39, v20
v_perm_b32 v73, v39, v39, v21
v_perm_b32 v74, v39, v39, v22
v_perm_b32 v75, v39, v39, v23
s_nop 1
v_mfma_f32_16x16x32_bf16 v[80:83], v[72:75], a[220:223], v[80:83]
v_perm_b32 v76, v59, v59, v20
v_perm_b32 v77, v59, v59, v21
v_perm_b32 v78, v59, v59, v22
v_perm_b32 v79, v59, v59, v23
s_nop 1
v_mfma_f32_16x16x32_bf16 v[84:87], v[76:79], a[220:223], v[84:87]
s_waitcnt vmcnt(36)
v_perm_b32 v64, v40, v40, v16
v_perm_b32 v65, v40, v40, v17
v_perm_b32 v66, v40, v40, v18
v_perm_b32 v67, v40, v40, v19
s_nop 1
v_mfma_f32_16x16x32_bf16 v[80:83], v[64:67], a[224:227], v[80:83]
v_perm_b32 v68, v60, v60, v16
v_perm_b32 v69, v60, v60, v17
v_perm_b32 v70, v60, v60, v18
v_perm_b32 v71, v60, v60, v19
s_nop 1
v_mfma_f32_16x16x32_bf16 v[84:87], v[68:71], a[224:227], v[84:87]
s_waitcnt vmcnt(35)
v_perm_b32 v72, v40, v40, v20
v_perm_b32 v73, v40, v40, v21
v_perm_b32 v74, v40, v40, v22
v_perm_b32 v75, v40, v40, v23
s_nop 1
v_mfma_f32_16x16x32_bf16 v[80:83], v[72:75], a[228:231], v[80:83]
v_perm_b32 v76, v60, v60, v20
v_perm_b32 v77, v60, v60, v21
v_perm_b32 v78, v60, v60, v22
v_perm_b32 v79, v60, v60, v23
s_nop 1
v_mfma_f32_16x16x32_bf16 v[84:87], v[76:79], a[228:231], v[84:87]
s_waitcnt vmcnt(34)
v_perm_b32 v64, v41, v41, v16
v_perm_b32 v65, v41, v41, v17
v_perm_b32 v66, v41, v41, v18
v_perm_b32 v67, v41, v41, v19
s_nop 1
v_mfma_f32_16x16x32_bf16 v[80:83], v[64:67], a[232:235], v[80:83]
v_perm_b32 v68, v61, v61, v16
v_perm_b32 v69, v61, v61, v17
v_perm_b32 v70, v61, v61, v18
v_perm_b32 v71, v61, v61, v19
s_nop 1
v_mfma_f32_16x16x32_bf16 v[84:87], v[68:71], a[232:235], v[84:87]
s_waitcnt vmcnt(33)
v_perm_b32 v72, v41, v41, v20
v_perm_b32 v73, v41, v41, v21
v_perm_b32 v74, v41, v41, v22
v_perm_b32 v75, v41, v41, v23
s_nop 1
v_mfma_f32_16x16x32_bf16 v[80:83], v[72:75], a[236:239], v[80:83]
v_perm_b32 v76, v61, v61, v20
v_perm_b32 v77, v61, v61, v21
v_perm_b32 v78, v61, v61, v22
v_perm_b32 v79, v61, v61, v23
s_nop 1
v_mfma_f32_16x16x32_bf16 v[84:87], v[76:79], a[236:239], v[84:87]
v_lshlrev_b32 v5, 5, v8
v_and_b32 v6, 1, v9
v_lshl_add_u32 v6, v6, 4, v5
v_lshrrev_b32 v7, 5, v1
v_lshl_add_u32 v6, v7, 9, v6
s_lshl_b32 s6, s3, 11
s_add_u32 s6, s6, 147456
v_add_u32 v6, s6, v6
ds_write_b128 v6, v[80:83]
ds_write_b128 v6, v[84:87] offset:1024
v_add_u32 v5, 147456, v5
s_waitcnt lgkmcnt(0)
s_barrier
ds_read_b128 v[24:27], v5 offset:0
ds_read_b128 v[28:31], v5 offset:16
ds_read_b128 v[32:35], v5 offset:2048
ds_read_b128 v[36:39], v5 offset:2064
ds_read_b128 v[40:43], v5 offset:4096
ds_read_b128 v[44:47], v5 offset:4112
ds_read_b128 v[48:51], v5 offset:6144
ds_read_b128 v[52:55], v5 offset:6160
s_waitcnt lgkmcnt(0)
v_add_f32 v24, v24, v32
v_add_f32 v40, v40, v48
v_add_f32 v25, v25, v33
v_add_f32 v41, v41, v49
v_add_f32 v26, v26, v34
v_add_f32 v42, v42, v50
v_add_f32 v27, v27, v35
v_add_f32 v43, v43, v51
v_add_f32 v28, v28, v36
v_add_f32 v44, v44, v52
v_add_f32 v29, v29, v37
v_add_f32 v45, v45, v53
v_add_f32 v30, v30, v38
v_add_f32 v46, v46, v54
v_add_f32 v31, v31, v39
v_add_f32 v47, v47, v55
v_add_f32 v24, v24, v40
v_add_f32 v25, v25, v41
v_add_f32 v26, v26, v42
v_add_f32 v27, v27, v43
v_add_f32 v28, v28, v44
v_add_f32 v29, v29, v45
v_add_f32 v30, v30, v46
v_add_f32 v31, v31, v47
v_cvt_pk_bf16_f32 v216, v24, v25
v_cvt_pk_bf16_f32 v217, v26, v27
v_cvt_pk_bf16_f32 v218, v28, v29
v_cvt_pk_bf16_f32 v219, v30, v31
ds_read_b128 v[24:27], v5 offset:512
ds_read_b128 v[28:31], v5 offset:528
ds_read_b128 v[32:35], v5 offset:2560
ds_read_b128 v[36:39], v5 offset:2576
ds_read_b128 v[40:43], v5 offset:4608
ds_read_b128 v[44:47], v5 offset:4624
ds_read_b128 v[48:51], v5 offset:6656
ds_read_b128 v[52:55], v5 offset:6672
s_waitcnt lgkmcnt(0)
v_add_f32 v24, v24, v32
v_add_f32 v40, v40, v48
v_add_f32 v25, v25, v33
v_add_f32 v41, v41, v49
v_add_f32 v26, v26, v34
v_add_f32 v42, v42, v50
v_add_f32 v27, v27, v35
v_add_f32 v43, v43, v51
v_add_f32 v28, v28, v36
v_add_f32 v44, v44, v52
v_add_f32 v29, v29, v37
v_add_f32 v45, v45, v53
v_add_f32 v30, v30, v38
v_add_f32 v46, v46, v54
v_add_f32 v31, v31, v39
v_add_f32 v47, v47, v55
v_add_f32 v24, v24, v40
v_add_f32 v25, v25, v41
v_add_f32 v26, v26, v42
v_add_f32 v27, v27, v43
v_add_f32 v28, v28, v44
v_add_f32 v29, v29, v45
v_add_f32 v30, v30, v46
v_add_f32 v31, v31, v47
v_cvt_pk_bf16_f32 v220, v24, v25
v_cvt_pk_bf16_f32 v221, v26, v27
v_cvt_pk_bf16_f32 v222, v28, v29
v_cvt_pk_bf16_f32 v223, v30, v31
ds_read_b128 v[24:27], v5 offset:1024
ds_read_b128 v[28:31], v5 offset:1040
ds_read_b128 v[32:35], v5 offset:3072
ds_read_b128 v[36:39], v5 offset:3088
ds_read_b128 v[40:43], v5 offset:5120
ds_read_b128 v[44:47], v5 offset:5136
ds_read_b128 v[48:51], v5 offset:7168
ds_read_b128 v[52:55], v5 offset:7184
s_waitcnt lgkmcnt(0)
v_add_f32 v24, v24, v32
v_add_f32 v40, v40, v48
v_add_f32 v25, v25, v33
v_add_f32 v41, v41, v49
v_add_f32 v26, v26, v34
v_add_f32 v42, v42, v50
v_add_f32 v27, v27, v35
v_add_f32 v43, v43, v51
v_add_f32 v28, v28, v36
v_add_f32 v44, v44, v52
v_add_f32 v29, v29, v37
v_add_f32 v45, v45, v53
v_add_f32 v30, v30, v38
v_add_f32 v46, v46, v54
v_add_f32 v31, v31, v39
v_add_f32 v47, v47, v55
v_add_f32 v24, v24, v40
v_add_f32 v25, v25, v41
v_add_f32 v26, v26, v42
v_add_f32 v27, v27, v43
v_add_f32 v28, v28, v44
v_add_f32 v29, v29, v45
v_add_f32 v30, v30, v46
v_add_f32 v31, v31, v47
v_cvt_pk_bf16_f32 v224, v24, v25
v_cvt_pk_bf16_f32 v225, v26, v27
v_cvt_pk_bf16_f32 v226, v28, v29
v_cvt_pk_bf16_f32 v227, v30, v31
ds_read_b128 v[24:27], v5 offset:1536
ds_read_b128 v[28:31], v5 offset:1552
ds_read_b128 v[32:35], v5 offset:3584
ds_read_b128 v[36:39], v5 offset:3600
ds_read_b128 v[40:43], v5 offset:5632
ds_read_b128 v[44:47], v5 offset:5648
ds_read_b128 v[48:51], v5 offset:7680
ds_read_b128 v[52:55], v5 offset:7696
s_waitcnt lgkmcnt(0)
v_add_f32 v24, v24, v32
v_add_f32 v40, v40, v48
v_add_f32 v25, v25, v33
v_add_f32 v41, v41, v49
v_add_f32 v26, v26, v34
v_add_f32 v42, v42, v50
v_add_f32 v27, v27, v35
v_add_f32 v43, v43, v51
v_add_f32 v28, v28, v36
v_add_f32 v44, v44, v52
v_add_f32 v29, v29, v37
v_add_f32 v45, v45, v53
v_add_f32 v30, v30, v38
v_add_f32 v46, v46, v54
v_add_f32 v31, v31, v39
v_add_f32 v47, v47, v55
v_add_f32 v24, v24, v40
v_add_f32 v25, v25, v41
v_add_f32 v26, v26, v42
v_add_f32 v27, v27, v43
v_add_f32 v28, v28, v44
v_add_f32 v29, v29, v45
v_add_f32 v30, v30, v46
v_add_f32 v31, v31, v47
v_cvt_pk_bf16_f32 v228, v24, v25
v_cvt_pk_bf16_f32 v229, v26, v27
v_cvt_pk_bf16_f32 v230, v28, v29
v_cvt_pk_bf16_f32 v231, v30, v31
v_bfe_u32 v5, v1, 2, 2
v_mul_u32_u24 v5, 32768, v5
v_lshl_add_u32 v5, v9, 5, v5
v_and_b32 v6, 1, v1
v_lshl_add_u32 v5, v6, 4, v5
v_bfe_u32 v7, v1, 1, 1
v_lshl_add_u32 v5, v7, 7, v5
s_waitcnt vmcnt(32)
v_dot2_f32_bf16 v232, v88, v216, 0
v_dot2_f32_bf16 v233, v88, v220, 0
v_dot2_f32_bf16 v234, v88, v224, 0
v_dot2_f32_bf16 v235, v88, v228, 0
v_dot2_f32_bf16 v232, v89, v217, v232
v_dot2_f32_bf16 v233, v89, v221, v233
v_dot2_f32_bf16 v234, v89, v225, v234
v_dot2_f32_bf16 v235, v89, v229, v235
v_dot2_f32_bf16 v232, v90, v218, v232
v_dot2_f32_bf16 v233, v90, v222, v233
v_dot2_f32_bf16 v234, v90, v226, v234
v_dot2_f32_bf16 v235, v90, v230, v235
v_dot2_f32_bf16 v232, v91, v219, v232
v_dot2_f32_bf16 v233, v91, v223, v233
v_dot2_f32_bf16 v234, v91, v227, v234
v_dot2_f32_bf16 v235, v91, v231, v235
v_add_f32_dpp v236, v232, v232 row_ror:8 row_mask:0xf bank_mask:0x3
v_add_f32_dpp v237, v233, v233 row_ror:8 row_mask:0xf bank_mask:0x3
v_add_f32_dpp v236, v234, v234 row_ror:8 row_mask:0xf bank_mask:0xc
v_add_f32_dpp v237, v235, v235 row_ror:8 row_mask:0xf bank_mask:0xc
s_nop 0
v_add_f32_dpp v64, v236, v236 row_half_mirror row_mask:0xf bank_mask:0x5
v_add_f32_dpp v64, v237, v237 row_half_mirror row_mask:0xf bank_mask:0xa
s_nop 1
v_add_f32_dpp v64, v64, v64 quad_perm:[1,0,3,2] row_mask:0xf bank_mask:0xf
s_nop 1
v_add_f32_dpp v64, v64, v64 quad_perm:[2,3,0,1] row_mask:0xf bank_mask:0xf
s_waitcnt vmcnt(31)
v_dot2_f32_bf16 v232, v92, v216, 0
v_dot2_f32_bf16 v233, v92, v220, 0
v_dot2_f32_bf16 v234, v92, v224, 0
v_dot2_f32_bf16 v235, v92, v228, 0
v_dot2_f32_bf16 v232, v93, v217, v232
v_dot2_f32_bf16 v233, v93, v221, v233
v_dot2_f32_bf16 v234, v93, v225, v234
v_dot2_f32_bf16 v235, v93, v229, v235
v_dot2_f32_bf16 v232, v94, v218, v232
v_dot2_f32_bf16 v233, v94, v222, v233
v_dot2_f32_bf16 v234, v94, v226, v234
v_dot2_f32_bf16 v235, v94, v230, v235
v_dot2_f32_bf16 v232, v95, v219, v232
v_dot2_f32_bf16 v233, v95, v223, v233
v_dot2_f32_bf16 v234, v95, v227, v234
v_dot2_f32_bf16 v235, v95, v231, v235
v_add_f32_dpp v236, v232, v232 row_ror:8 row_mask:0xf bank_mask:0x3
v_add_f32_dpp v237, v233, v233 row_ror:8 row_mask:0xf bank_mask:0x3
v_add_f32_dpp v236, v234, v234 row_ror:8 row_mask:0xf bank_mask:0xc
v_add_f32_dpp v237, v235, v235 row_ror:8 row_mask:0xf bank_mask:0xc
s_nop 0
v_add_f32_dpp v65, v236, v236 row_half_mirror row_mask:0xf bank_mask:0x5
v_add_f32_dpp v65, v237, v237 row_half_mirror row_mask:0xf bank_mask:0xa
s_nop 1
v_add_f32_dpp v65, v65, v65 quad_perm:[1,0,3,2] row_mask:0xf bank_mask:0xf
s_nop 1
v_add_f32_dpp v65, v65, v65 quad_perm:[2,3,0,1] row_mask:0xf bank_mask:0xf
s_waitcnt vmcnt(30)
v_dot2_f32_bf16 v232, v96, v216, 0
v_dot2_f32_bf16 v233, v96, v220, 0
v_dot2_f32_bf16 v234, v96, v224, 0
v_dot2_f32_bf16 v235, v96, v228, 0
v_dot2_f32_bf16 v232, v97, v217, v232
v_dot2_f32_bf16 v233, v97, v221, v233
v_dot2_f32_bf16 v234, v97, v225, v234
v_dot2_f32_bf16 v235, v97, v229, v235
v_dot2_f32_bf16 v232, v98, v218, v232
v_dot2_f32_bf16 v233, v98, v222, v233
v_dot2_f32_bf16 v234, v98, v226, v234
v_dot2_f32_bf16 v235, v98, v230, v235
v_dot2_f32_bf16 v232, v99, v219, v232
v_dot2_f32_bf16 v233, v99, v223, v233
v_dot2_f32_bf16 v234, v99, v227, v234
v_dot2_f32_bf16 v235, v99, v231, v235
v_add_f32_dpp v236, v232, v232 row_ror:8 row_mask:0xf bank_mask:0x3
v_add_f32_dpp v237, v233, v233 row_ror:8 row_mask:0xf bank_mask:0x3
v_add_f32_dpp v236, v234, v234 row_ror:8 row_mask:0xf bank_mask:0xc
v_add_f32_dpp v237, v235, v235 row_ror:8 row_mask:0xf bank_mask:0xc
s_nop 0
v_add_f32_dpp v66, v236, v236 row_half_mirror row_mask:0xf bank_mask:0x5
v_add_f32_dpp v66, v237, v237 row_half_mirror row_mask:0xf bank_mask:0xa
s_nop 1
v_add_f32_dpp v66, v66, v66 quad_perm:[1,0,3,2] row_mask:0xf bank_mask:0xf
s_nop 1
v_add_f32_dpp v66, v66, v66 quad_perm:[2,3,0,1] row_mask:0xf bank_mask:0xf
s_waitcnt vmcnt(29)
v_dot2_f32_bf16 v232, v100, v216, 0
v_dot2_f32_bf16 v233, v100, v220, 0
v_dot2_f32_bf16 v234, v100, v224, 0
v_dot2_f32_bf16 v235, v100, v228, 0
v_dot2_f32_bf16 v232, v101, v217, v232
v_dot2_f32_bf16 v233, v101, v221, v233
v_dot2_f32_bf16 v234, v101, v225, v234
v_dot2_f32_bf16 v235, v101, v229, v235
v_dot2_f32_bf16 v232, v102, v218, v232
v_dot2_f32_bf16 v233, v102, v222, v233
v_dot2_f32_bf16 v234, v102, v226, v234
v_dot2_f32_bf16 v235, v102, v230, v235
v_dot2_f32_bf16 v232, v103, v219, v232
v_dot2_f32_bf16 v233, v103, v223, v233
v_dot2_f32_bf16 v234, v103, v227, v234
v_dot2_f32_bf16 v235, v103, v231, v235
v_add_f32_dpp v236, v232, v232 row_ror:8 row_mask:0xf bank_mask:0x3
v_add_f32_dpp v237, v233, v233 row_ror:8 row_mask:0xf bank_mask:0x3
v_add_f32_dpp v236, v234, v234 row_ror:8 row_mask:0xf bank_mask:0xc
v_add_f32_dpp v237, v235, v235 row_ror:8 row_mask:0xf bank_mask:0xc
s_nop 0
v_add_f32_dpp v67, v236, v236 row_half_mirror row_mask:0xf bank_mask:0x5
v_add_f32_dpp v67, v237, v237 row_half_mirror row_mask:0xf bank_mask:0xa
s_nop 1
v_add_f32_dpp v67, v67, v67 quad_perm:[1,0,3,2] row_mask:0xf bank_mask:0xf
s_nop 1
v_add_f32_dpp v67, v67, v67 quad_perm:[2,3,0,1] row_mask:0xf bank_mask:0xf
s_waitcnt vmcnt(28)
v_dot2_f32_bf16 v232, v104, v216, 0
v_dot2_f32_bf16 v233, v104, v220, 0
v_dot2_f32_bf16 v234, v104, v224, 0
v_dot2_f32_bf16 v235, v104, v228, 0
v_dot2_f32_bf16 v232, v105, v217, v232
v_dot2_f32_bf16 v233, v105, v221, v233
v_dot2_f32_bf16 v234, v105, v225, v234
v_dot2_f32_bf16 v235, v105, v229, v235
v_dot2_f32_bf16 v232, v106, v218, v232
v_dot2_f32_bf16 v233, v106, v222, v233
v_dot2_f32_bf16 v234, v106, v226, v234
v_dot2_f32_bf16 v235, v106, v230, v235
v_dot2_f32_bf16 v232, v107, v219, v232
v_dot2_f32_bf16 v233, v107, v223, v233
v_dot2_f32_bf16 v234, v107, v227, v234
v_dot2_f32_bf16 v235, v107, v231, v235
v_add_f32_dpp v236, v232, v232 row_ror:8 row_mask:0xf bank_mask:0x3
v_add_f32_dpp v237, v233, v233 row_ror:8 row_mask:0xf bank_mask:0x3
v_add_f32_dpp v236, v234, v234 row_ror:8 row_mask:0xf bank_mask:0xc
v_add_f32_dpp v237, v235, v235 row_ror:8 row_mask:0xf bank_mask:0xc
s_nop 0
v_add_f32_dpp v68, v236, v236 row_half_mirror row_mask:0xf bank_mask:0x5
v_add_f32_dpp v68, v237, v237 row_half_mirror row_mask:0xf bank_mask:0xa
s_nop 1
v_add_f32_dpp v68, v68, v68 quad_perm:[1,0,3,2] row_mask:0xf bank_mask:0xf
s_nop 1
v_add_f32_dpp v68, v68, v68 quad_perm:[2,3,0,1] row_mask:0xf bank_mask:0xf
s_waitcnt vmcnt(27)
v_dot2_f32_bf16 v232, v108, v216, 0
v_dot2_f32_bf16 v233, v108, v220, 0
v_dot2_f32_bf16 v234, v108, v224, 0
v_dot2_f32_bf16 v235, v108, v228, 0
v_dot2_f32_bf16 v232, v109, v217, v232
v_dot2_f32_bf16 v233, v109, v221, v233
v_dot2_f32_bf16 v234, v109, v225, v234
v_dot2_f32_bf16 v235, v109, v229, v235
v_dot2_f32_bf16 v232, v110, v218, v232
v_dot2_f32_bf16 v233, v110, v222, v233
v_dot2_f32_bf16 v234, v110, v226, v234
v_dot2_f32_bf16 v235, v110, v230, v235
v_dot2_f32_bf16 v232, v111, v219, v232
v_dot2_f32_bf16 v233, v111, v223, v233
v_dot2_f32_bf16 v234, v111, v227, v234
v_dot2_f32_bf16 v235, v111, v231, v235
v_add_f32_dpp v236, v232, v232 row_ror:8 row_mask:0xf bank_mask:0x3
v_add_f32_dpp v237, v233, v233 row_ror:8 row_mask:0xf bank_mask:0x3
v_add_f32_dpp v236, v234, v234 row_ror:8 row_mask:0xf bank_mask:0xc
v_add_f32_dpp v237, v235, v235 row_ror:8 row_mask:0xf bank_mask:0xc
s_nop 0
v_add_f32_dpp v69, v236, v236 row_half_mirror row_mask:0xf bank_mask:0x5
v_add_f32_dpp v69, v237, v237 row_half_mirror row_mask:0xf bank_mask:0xa
s_nop 1
v_add_f32_dpp v69, v69, v69 quad_perm:[1,0,3,2] row_mask:0xf bank_mask:0xf
s_nop 1
v_add_f32_dpp v69, v69, v69 quad_perm:[2,3,0,1] row_mask:0xf bank_mask:0xf
s_waitcnt vmcnt(26)
v_dot2_f32_bf16 v232, v112, v216, 0
v_dot2_f32_bf16 v233, v112, v220, 0
v_dot2_f32_bf16 v234, v112, v224, 0
v_dot2_f32_bf16 v235, v112, v228, 0
v_dot2_f32_bf16 v232, v113, v217, v232
v_dot2_f32_bf16 v233, v113, v221, v233
v_dot2_f32_bf16 v234, v113, v225, v234
v_dot2_f32_bf16 v235, v113, v229, v235
v_dot2_f32_bf16 v232, v114, v218, v232
v_dot2_f32_bf16 v233, v114, v222, v233
v_dot2_f32_bf16 v234, v114, v226, v234
v_dot2_f32_bf16 v235, v114, v230, v235
v_dot2_f32_bf16 v232, v115, v219, v232
v_dot2_f32_bf16 v233, v115, v223, v233
v_dot2_f32_bf16 v234, v115, v227, v234
v_dot2_f32_bf16 v235, v115, v231, v235
v_add_f32_dpp v236, v232, v232 row_ror:8 row_mask:0xf bank_mask:0x3
v_add_f32_dpp v237, v233, v233 row_ror:8 row_mask:0xf bank_mask:0x3
v_add_f32_dpp v236, v234, v234 row_ror:8 row_mask:0xf bank_mask:0xc
v_add_f32_dpp v237, v235, v235 row_ror:8 row_mask:0xf bank_mask:0xc
s_nop 0
v_add_f32_dpp v70, v236, v236 row_half_mirror row_mask:0xf bank_mask:0x5
v_add_f32_dpp v70, v237, v237 row_half_mirror row_mask:0xf bank_mask:0xa
s_nop 1
v_add_f32_dpp v70, v70, v70 quad_perm:[1,0,3,2] row_mask:0xf bank_mask:0xf
s_nop 1
v_add_f32_dpp v70, v70, v70 quad_perm:[2,3,0,1] row_mask:0xf bank_mask:0xf
s_waitcnt vmcnt(25)
v_dot2_f32_bf16 v232, v116, v216, 0
v_dot2_f32_bf16 v233, v116, v220, 0
v_dot2_f32_bf16 v234, v116, v224, 0
v_dot2_f32_bf16 v235, v116, v228, 0
v_dot2_f32_bf16 v232, v117, v217, v232
v_dot2_f32_bf16 v233, v117, v221, v233
v_dot2_f32_bf16 v234, v117, v225, v234
v_dot2_f32_bf16 v235, v117, v229, v235
v_dot2_f32_bf16 v232, v118, v218, v232
v_dot2_f32_bf16 v233, v118, v222, v233
v_dot2_f32_bf16 v234, v118, v226, v234
v_dot2_f32_bf16 v235, v118, v230, v235
v_dot2_f32_bf16 v232, v119, v219, v232
v_dot2_f32_bf16 v233, v119, v223, v233
v_dot2_f32_bf16 v234, v119, v227, v234
v_dot2_f32_bf16 v235, v119, v231, v235
v_add_f32_dpp v236, v232, v232 row_ror:8 row_mask:0xf bank_mask:0x3
v_add_f32_dpp v237, v233, v233 row_ror:8 row_mask:0xf bank_mask:0x3
v_add_f32_dpp v236, v234, v234 row_ror:8 row_mask:0xf bank_mask:0xc
v_add_f32_dpp v237, v235, v235 row_ror:8 row_mask:0xf bank_mask:0xc
s_nop 0
v_add_f32_dpp v71, v236, v236 row_half_mirror row_mask:0xf bank_mask:0x5
v_add_f32_dpp v71, v237, v237 row_half_mirror row_mask:0xf bank_mask:0xa
s_nop 1
v_add_f32_dpp v71, v71, v71 quad_perm:[1,0,3,2] row_mask:0xf bank_mask:0xf
s_nop 1
v_add_f32_dpp v71, v71, v71 quad_perm:[2,3,0,1] row_mask:0xf bank_mask:0xf
s_waitcnt vmcnt(24)
v_dot2_f32_bf16 v232, v120, v216, 0
v_dot2_f32_bf16 v233, v120, v220, 0
v_dot2_f32_bf16 v234, v120, v224, 0
v_dot2_f32_bf16 v235, v120, v228, 0
v_dot2_f32_bf16 v232, v121, v217, v232
v_dot2_f32_bf16 v233, v121, v221, v233
v_dot2_f32_bf16 v234, v121, v225, v234
v_dot2_f32_bf16 v235, v121, v229, v235
v_dot2_f32_bf16 v232, v122, v218, v232
v_dot2_f32_bf16 v233, v122, v222, v233
v_dot2_f32_bf16 v234, v122, v226, v234
v_dot2_f32_bf16 v235, v122, v230, v235
v_dot2_f32_bf16 v232, v123, v219, v232
v_dot2_f32_bf16 v233, v123, v223, v233
v_dot2_f32_bf16 v234, v123, v227, v234
v_dot2_f32_bf16 v235, v123, v231, v235
v_add_f32_dpp v236, v232, v232 row_ror:8 row_mask:0xf bank_mask:0x3
v_add_f32_dpp v237, v233, v233 row_ror:8 row_mask:0xf bank_mask:0x3
v_add_f32_dpp v236, v234, v234 row_ror:8 row_mask:0xf bank_mask:0xc
v_add_f32_dpp v237, v235, v235 row_ror:8 row_mask:0xf bank_mask:0xc
s_nop 0
v_add_f32_dpp v72, v236, v236 row_half_mirror row_mask:0xf bank_mask:0x5
v_add_f32_dpp v72, v237, v237 row_half_mirror row_mask:0xf bank_mask:0xa
s_nop 1
v_add_f32_dpp v72, v72, v72 quad_perm:[1,0,3,2] row_mask:0xf bank_mask:0xf
s_nop 1
v_add_f32_dpp v72, v72, v72 quad_perm:[2,3,0,1] row_mask:0xf bank_mask:0xf
s_waitcnt vmcnt(23)
v_dot2_f32_bf16 v232, v124, v216, 0
v_dot2_f32_bf16 v233, v124, v220, 0
v_dot2_f32_bf16 v234, v124, v224, 0
v_dot2_f32_bf16 v235, v124, v228, 0
v_dot2_f32_bf16 v232, v125, v217, v232
v_dot2_f32_bf16 v233, v125, v221, v233
v_dot2_f32_bf16 v234, v125, v225, v234
v_dot2_f32_bf16 v235, v125, v229, v235
v_dot2_f32_bf16 v232, v126, v218, v232
v_dot2_f32_bf16 v233, v126, v222, v233
v_dot2_f32_bf16 v234, v126, v226, v234
v_dot2_f32_bf16 v235, v126, v230, v235
v_dot2_f32_bf16 v232, v127, v219, v232
v_dot2_f32_bf16 v233, v127, v223, v233
v_dot2_f32_bf16 v234, v127, v227, v234
v_dot2_f32_bf16 v235, v127, v231, v235
v_add_f32_dpp v236, v232, v232 row_ror:8 row_mask:0xf bank_mask:0x3
v_add_f32_dpp v237, v233, v233 row_ror:8 row_mask:0xf bank_mask:0x3
v_add_f32_dpp v236, v234, v234 row_ror:8 row_mask:0xf bank_mask:0xc
v_add_f32_dpp v237, v235, v235 row_ror:8 row_mask:0xf bank_mask:0xc
s_nop 0
v_add_f32_dpp v73, v236, v236 row_half_mirror row_mask:0xf bank_mask:0x5
v_add_f32_dpp v73, v237, v237 row_half_mirror row_mask:0xf bank_mask:0xa
s_nop 1
v_add_f32_dpp v73, v73, v73 quad_perm:[1,0,3,2] row_mask:0xf bank_mask:0xf
s_nop 1
v_add_f32_dpp v73, v73, v73 quad_perm:[2,3,0,1] row_mask:0xf bank_mask:0xf
s_waitcnt vmcnt(22)
v_dot2_f32_bf16 v232, v128, v216, 0
v_dot2_f32_bf16 v233, v128, v220, 0
v_dot2_f32_bf16 v234, v128, v224, 0
v_dot2_f32_bf16 v235, v128, v228, 0
v_dot2_f32_bf16 v232, v129, v217, v232
v_dot2_f32_bf16 v233, v129, v221, v233
v_dot2_f32_bf16 v234, v129, v225, v234
v_dot2_f32_bf16 v235, v129, v229, v235
v_dot2_f32_bf16 v232, v130, v218, v232
v_dot2_f32_bf16 v233, v130, v222, v233
v_dot2_f32_bf16 v234, v130, v226, v234
v_dot2_f32_bf16 v235, v130, v230, v235
v_dot2_f32_bf16 v232, v131, v219, v232
v_dot2_f32_bf16 v233, v131, v223, v233
v_dot2_f32_bf16 v234, v131, v227, v234
v_dot2_f32_bf16 v235, v131, v231, v235
v_add_f32_dpp v236, v232, v232 row_ror:8 row_mask:0xf bank_mask:0x3
v_add_f32_dpp v237, v233, v233 row_ror:8 row_mask:0xf bank_mask:0x3
v_add_f32_dpp v236, v234, v234 row_ror:8 row_mask:0xf bank_mask:0xc
v_add_f32_dpp v237, v235, v235 row_ror:8 row_mask:0xf bank_mask:0xc
s_nop 0
v_add_f32_dpp v74, v236, v236 row_half_mirror row_mask:0xf bank_mask:0x5
v_add_f32_dpp v74, v237, v237 row_half_mirror row_mask:0xf bank_mask:0xa
s_nop 1
v_add_f32_dpp v74, v74, v74 quad_perm:[1,0,3,2] row_mask:0xf bank_mask:0xf
s_nop 1
v_add_f32_dpp v74, v74, v74 quad_perm:[2,3,0,1] row_mask:0xf bank_mask:0xf
s_waitcnt vmcnt(21)
v_dot2_f32_bf16 v232, v132, v216, 0
v_dot2_f32_bf16 v233, v132, v220, 0
v_dot2_f32_bf16 v234, v132, v224, 0
v_dot2_f32_bf16 v235, v132, v228, 0
v_dot2_f32_bf16 v232, v133, v217, v232
v_dot2_f32_bf16 v233, v133, v221, v233
v_dot2_f32_bf16 v234, v133, v225, v234
v_dot2_f32_bf16 v235, v133, v229, v235
v_dot2_f32_bf16 v232, v134, v218, v232
v_dot2_f32_bf16 v233, v134, v222, v233
v_dot2_f32_bf16 v234, v134, v226, v234
v_dot2_f32_bf16 v235, v134, v230, v235
v_dot2_f32_bf16 v232, v135, v219, v232
v_dot2_f32_bf16 v233, v135, v223, v233
v_dot2_f32_bf16 v234, v135, v227, v234
v_dot2_f32_bf16 v235, v135, v231, v235
v_add_f32_dpp v236, v232, v232 row_ror:8 row_mask:0xf bank_mask:0x3
v_add_f32_dpp v237, v233, v233 row_ror:8 row_mask:0xf bank_mask:0x3
v_add_f32_dpp v236, v234, v234 row_ror:8 row_mask:0xf bank_mask:0xc
v_add_f32_dpp v237, v235, v235 row_ror:8 row_mask:0xf bank_mask:0xc
s_nop 0
v_add_f32_dpp v75, v236, v236 row_half_mirror row_mask:0xf bank_mask:0x5
v_add_f32_dpp v75, v237, v237 row_half_mirror row_mask:0xf bank_mask:0xa
s_nop 1
v_add_f32_dpp v75, v75, v75 quad_perm:[1,0,3,2] row_mask:0xf bank_mask:0xf
s_nop 1
v_add_f32_dpp v75, v75, v75 quad_perm:[2,3,0,1] row_mask:0xf bank_mask:0xf
s_waitcnt vmcnt(20)
v_dot2_f32_bf16 v232, v136, v216, 0
v_dot2_f32_bf16 v233, v136, v220, 0
v_dot2_f32_bf16 v234, v136, v224, 0
v_dot2_f32_bf16 v235, v136, v228, 0
v_dot2_f32_bf16 v232, v137, v217, v232
v_dot2_f32_bf16 v233, v137, v221, v233
v_dot2_f32_bf16 v234, v137, v225, v234
v_dot2_f32_bf16 v235, v137, v229, v235
v_dot2_f32_bf16 v232, v138, v218, v232
v_dot2_f32_bf16 v233, v138, v222, v233
v_dot2_f32_bf16 v234, v138, v226, v234
v_dot2_f32_bf16 v235, v138, v230, v235
v_dot2_f32_bf16 v232, v139, v219, v232
v_dot2_f32_bf16 v233, v139, v223, v233
v_dot2_f32_bf16 v234, v139, v227, v234
v_dot2_f32_bf16 v235, v139, v231, v235
v_add_f32_dpp v236, v232, v232 row_ror:8 row_mask:0xf bank_mask:0x3
v_add_f32_dpp v237, v233, v233 row_ror:8 row_mask:0xf bank_mask:0x3
v_add_f32_dpp v236, v234, v234 row_ror:8 row_mask:0xf bank_mask:0xc
v_add_f32_dpp v237, v235, v235 row_ror:8 row_mask:0xf bank_mask:0xc
s_nop 0
v_add_f32_dpp v76, v236, v236 row_half_mirror row_mask:0xf bank_mask:0x5
v_add_f32_dpp v76, v237, v237 row_half_mirror row_mask:0xf bank_mask:0xa
s_nop 1
v_add_f32_dpp v76, v76, v76 quad_perm:[1,0,3,2] row_mask:0xf bank_mask:0xf
s_nop 1
v_add_f32_dpp v76, v76, v76 quad_perm:[2,3,0,1] row_mask:0xf bank_mask:0xf
s_waitcnt vmcnt(19)
v_dot2_f32_bf16 v232, v140, v216, 0
v_dot2_f32_bf16 v233, v140, v220, 0
v_dot2_f32_bf16 v234, v140, v224, 0
v_dot2_f32_bf16 v235, v140, v228, 0
v_dot2_f32_bf16 v232, v141, v217, v232
v_dot2_f32_bf16 v233, v141, v221, v233
v_dot2_f32_bf16 v234, v141, v225, v234
v_dot2_f32_bf16 v235, v141, v229, v235
v_dot2_f32_bf16 v232, v142, v218, v232
v_dot2_f32_bf16 v233, v142, v222, v233
v_dot2_f32_bf16 v234, v142, v226, v234
v_dot2_f32_bf16 v235, v142, v230, v235
v_dot2_f32_bf16 v232, v143, v219, v232
v_dot2_f32_bf16 v233, v143, v223, v233
v_dot2_f32_bf16 v234, v143, v227, v234
v_dot2_f32_bf16 v235, v143, v231, v235
v_add_f32_dpp v236, v232, v232 row_ror:8 row_mask:0xf bank_mask:0x3
v_add_f32_dpp v237, v233, v233 row_ror:8 row_mask:0xf bank_mask:0x3
v_add_f32_dpp v236, v234, v234 row_ror:8 row_mask:0xf bank_mask:0xc
v_add_f32_dpp v237, v235, v235 row_ror:8 row_mask:0xf bank_mask:0xc
s_nop 0
v_add_f32_dpp v77, v236, v236 row_half_mirror row_mask:0xf bank_mask:0x5
v_add_f32_dpp v77, v237, v237 row_half_mirror row_mask:0xf bank_mask:0xa
s_nop 1
v_add_f32_dpp v77, v77, v77 quad_perm:[1,0,3,2] row_mask:0xf bank_mask:0xf
s_nop 1
v_add_f32_dpp v77, v77, v77 quad_perm:[2,3,0,1] row_mask:0xf bank_mask:0xf
s_waitcnt vmcnt(18)
v_dot2_f32_bf16 v232, v144, v216, 0
v_dot2_f32_bf16 v233, v144, v220, 0
v_dot2_f32_bf16 v234, v144, v224, 0
v_dot2_f32_bf16 v235, v144, v228, 0
v_dot2_f32_bf16 v232, v145, v217, v232
v_dot2_f32_bf16 v233, v145, v221, v233
v_dot2_f32_bf16 v234, v145, v225, v234
v_dot2_f32_bf16 v235, v145, v229, v235
v_dot2_f32_bf16 v232, v146, v218, v232
v_dot2_f32_bf16 v233, v146, v222, v233
v_dot2_f32_bf16 v234, v146, v226, v234
v_dot2_f32_bf16 v235, v146, v230, v235
v_dot2_f32_bf16 v232, v147, v219, v232
v_dot2_f32_bf16 v233, v147, v223, v233
v_dot2_f32_bf16 v234, v147, v227, v234
v_dot2_f32_bf16 v235, v147, v231, v235
v_add_f32_dpp v236, v232, v232 row_ror:8 row_mask:0xf bank_mask:0x3
v_add_f32_dpp v237, v233, v233 row_ror:8 row_mask:0xf bank_mask:0x3
v_add_f32_dpp v236, v234, v234 row_ror:8 row_mask:0xf bank_mask:0xc
v_add_f32_dpp v237, v235, v235 row_ror:8 row_mask:0xf bank_mask:0xc
s_nop 0
v_add_f32_dpp v78, v236, v236 row_half_mirror row_mask:0xf bank_mask:0x5
v_add_f32_dpp v78, v237, v237 row_half_mirror row_mask:0xf bank_mask:0xa
s_nop 1
v_add_f32_dpp v78, v78, v78 quad_perm:[1,0,3,2] row_mask:0xf bank_mask:0xf
s_nop 1
v_add_f32_dpp v78, v78, v78 quad_perm:[2,3,0,1] row_mask:0xf bank_mask:0xf
s_waitcnt vmcnt(17)
v_dot2_f32_bf16 v232, v148, v216, 0
v_dot2_f32_bf16 v233, v148, v220, 0
v_dot2_f32_bf16 v234, v148, v224, 0
v_dot2_f32_bf16 v235, v148, v228, 0
v_dot2_f32_bf16 v232, v149, v217, v232
v_dot2_f32_bf16 v233, v149, v221, v233
v_dot2_f32_bf16 v234, v149, v225, v234
v_dot2_f32_bf16 v235, v149, v229, v235
v_dot2_f32_bf16 v232, v150, v218, v232
v_dot2_f32_bf16 v233, v150, v222, v233
v_dot2_f32_bf16 v234, v150, v226, v234
v_dot2_f32_bf16 v235, v150, v230, v235
v_dot2_f32_bf16 v232, v151, v219, v232
v_dot2_f32_bf16 v233, v151, v223, v233
v_dot2_f32_bf16 v234, v151, v227, v234
v_dot2_f32_bf16 v235, v151, v231, v235
v_add_f32_dpp v236, v232, v232 row_ror:8 row_mask:0xf bank_mask:0x3
v_add_f32_dpp v237, v233, v233 row_ror:8 row_mask:0xf bank_mask:0x3
v_add_f32_dpp v236, v234, v234 row_ror:8 row_mask:0xf bank_mask:0xc
v_add_f32_dpp v237, v235, v235 row_ror:8 row_mask:0xf bank_mask:0xc
s_nop 0
v_add_f32_dpp v79, v236, v236 row_half_mirror row_mask:0xf bank_mask:0x5
v_add_f32_dpp v79, v237, v237 row_half_mirror row_mask:0xf bank_mask:0xa
s_nop 1
v_add_f32_dpp v79, v79, v79 quad_perm:[1,0,3,2] row_mask:0xf bank_mask:0xf
s_nop 1
v_add_f32_dpp v79, v79, v79 quad_perm:[2,3,0,1] row_mask:0xf bank_mask:0xf
v_cvt_pk_bf16_f32 v24, v64, v65
v_cvt_pk_bf16_f32 v25, v66, v67
v_cvt_pk_bf16_f32 v26, v68, v69
v_cvt_pk_bf16_f32 v27, v70, v71
v_cvt_pk_bf16_f32 v28, v72, v73
v_cvt_pk_bf16_f32 v29, v74, v75
v_cvt_pk_bf16_f32 v30, v76, v77
v_cvt_pk_bf16_f32 v31, v78, v79
v_cmp_eq_u32 vcc, 1, v6
s_nop 1
v_cndmask_b32 v244, v24, v28, vcc
v_cndmask_b32 v245, v25, v29, vcc
v_cndmask_b32 v246, v26, v30, vcc
v_cndmask_b32 v247, v27, v31, vcc
s_waitcnt vmcnt(16)
v_dot2_f32_bf16 v232, v152, v216, 0
v_dot2_f32_bf16 v233, v152, v220, 0
v_dot2_f32_bf16 v234, v152, v224, 0
v_dot2_f32_bf16 v235, v152, v228, 0
v_dot2_f32_bf16 v232, v153, v217, v232
v_dot2_f32_bf16 v233, v153, v221, v233
v_dot2_f32_bf16 v234, v153, v225, v234
v_dot2_f32_bf16 v235, v153, v229, v235
v_dot2_f32_bf16 v232, v154, v218, v232
v_dot2_f32_bf16 v233, v154, v222, v233
v_dot2_f32_bf16 v234, v154, v226, v234
v_dot2_f32_bf16 v235, v154, v230, v235
v_dot2_f32_bf16 v232, v155, v219, v232
v_dot2_f32_bf16 v233, v155, v223, v233
v_dot2_f32_bf16 v234, v155, v227, v234
v_dot2_f32_bf16 v235, v155, v231, v235
v_add_f32_dpp v236, v232, v232 row_ror:8 row_mask:0xf bank_mask:0x3
v_add_f32_dpp v237, v233, v233 row_ror:8 row_mask:0xf bank_mask:0x3
v_add_f32_dpp v236, v234, v234 row_ror:8 row_mask:0xf bank_mask:0xc
v_add_f32_dpp v237, v235, v235 row_ror:8 row_mask:0xf bank_mask:0xc
s_nop 0
v_add_f32_dpp v64, v236, v236 row_half_mirror row_mask:0xf bank_mask:0x5
v_add_f32_dpp v64, v237, v237 row_half_mirror row_mask:0xf bank_mask:0xa
s_nop 1
v_add_f32_dpp v64, v64, v64 quad_perm:[1,0,3,2] row_mask:0xf bank_mask:0xf
s_nop 1
v_add_f32_dpp v64, v64, v64 quad_perm:[2,3,0,1] row_mask:0xf bank_mask:0xf
s_waitcnt vmcnt(15)
v_dot2_f32_bf16 v232, v156, v216, 0
v_dot2_f32_bf16 v233, v156, v220, 0
v_dot2_f32_bf16 v234, v156, v224, 0
v_dot2_f32_bf16 v235, v156, v228, 0
v_dot2_f32_bf16 v232, v157, v217, v232
v_dot2_f32_bf16 v233, v157, v221, v233
v_dot2_f32_bf16 v234, v157, v225, v234
v_dot2_f32_bf16 v235, v157, v229, v235
v_dot2_f32_bf16 v232, v158, v218, v232
v_dot2_f32_bf16 v233, v158, v222, v233
v_dot2_f32_bf16 v234, v158, v226, v234
v_dot2_f32_bf16 v235, v158, v230, v235
v_dot2_f32_bf16 v232, v159, v219, v232
v_dot2_f32_bf16 v233, v159, v223, v233
v_dot2_f32_bf16 v234, v159, v227, v234
v_dot2_f32_bf16 v235, v159, v231, v235
v_add_f32_dpp v236, v232, v232 row_ror:8 row_mask:0xf bank_mask:0x3
v_add_f32_dpp v237, v233, v233 row_ror:8 row_mask:0xf bank_mask:0x3
v_add_f32_dpp v236, v234, v234 row_ror:8 row_mask:0xf bank_mask:0xc
v_add_f32_dpp v237, v235, v235 row_ror:8 row_mask:0xf bank_mask:0xc
s_nop 0
v_add_f32_dpp v65, v236, v236 row_half_mirror row_mask:0xf bank_mask:0x5
v_add_f32_dpp v65, v237, v237 row_half_mirror row_mask:0xf bank_mask:0xa
s_nop 1
v_add_f32_dpp v65, v65, v65 quad_perm:[1,0,3,2] row_mask:0xf bank_mask:0xf
s_nop 1
v_add_f32_dpp v65, v65, v65 quad_perm:[2,3,0,1] row_mask:0xf bank_mask:0xf
s_waitcnt vmcnt(14)
v_dot2_f32_bf16 v232, v160, v216, 0
v_dot2_f32_bf16 v233, v160, v220, 0
v_dot2_f32_bf16 v234, v160, v224, 0
v_dot2_f32_bf16 v235, v160, v228, 0
v_dot2_f32_bf16 v232, v161, v217, v232
v_dot2_f32_bf16 v233, v161, v221, v233
v_dot2_f32_bf16 v234, v161, v225, v234
v_dot2_f32_bf16 v235, v161, v229, v235
v_dot2_f32_bf16 v232, v162, v218, v232
v_dot2_f32_bf16 v233, v162, v222, v233
v_dot2_f32_bf16 v234, v162, v226, v234
v_dot2_f32_bf16 v235, v162, v230, v235
v_dot2_f32_bf16 v232, v163, v219, v232
v_dot2_f32_bf16 v233, v163, v223, v233
v_dot2_f32_bf16 v234, v163, v227, v234
v_dot2_f32_bf16 v235, v163, v231, v235
v_add_f32_dpp v236, v232, v232 row_ror:8 row_mask:0xf bank_mask:0x3
v_add_f32_dpp v237, v233, v233 row_ror:8 row_mask:0xf bank_mask:0x3
v_add_f32_dpp v236, v234, v234 row_ror:8 row_mask:0xf bank_mask:0xc
v_add_f32_dpp v237, v235, v235 row_ror:8 row_mask:0xf bank_mask:0xc
s_nop 0
v_add_f32_dpp v66, v236, v236 row_half_mirror row_mask:0xf bank_mask:0x5
v_add_f32_dpp v66, v237, v237 row_half_mirror row_mask:0xf bank_mask:0xa
s_nop 1
v_add_f32_dpp v66, v66, v66 quad_perm:[1,0,3,2] row_mask:0xf bank_mask:0xf
s_nop 1
v_add_f32_dpp v66, v66, v66 quad_perm:[2,3,0,1] row_mask:0xf bank_mask:0xf
s_waitcnt vmcnt(13)
v_dot2_f32_bf16 v232, v164, v216, 0
v_dot2_f32_bf16 v233, v164, v220, 0
v_dot2_f32_bf16 v234, v164, v224, 0
v_dot2_f32_bf16 v235, v164, v228, 0
v_dot2_f32_bf16 v232, v165, v217, v232
v_dot2_f32_bf16 v233, v165, v221, v233
v_dot2_f32_bf16 v234, v165, v225, v234
v_dot2_f32_bf16 v235, v165, v229, v235
v_dot2_f32_bf16 v232, v166, v218, v232
v_dot2_f32_bf16 v233, v166, v222, v233
v_dot2_f32_bf16 v234, v166, v226, v234
v_dot2_f32_bf16 v235, v166, v230, v235
v_dot2_f32_bf16 v232, v167, v219, v232
v_dot2_f32_bf16 v233, v167, v223, v233
v_dot2_f32_bf16 v234, v167, v227, v234
v_dot2_f32_bf16 v235, v167, v231, v235
v_add_f32_dpp v236, v232, v232 row_ror:8 row_mask:0xf bank_mask:0x3
v_add_f32_dpp v237, v233, v233 row_ror:8 row_mask:0xf bank_mask:0x3
v_add_f32_dpp v236, v234, v234 row_ror:8 row_mask:0xf bank_mask:0xc
v_add_f32_dpp v237, v235, v235 row_ror:8 row_mask:0xf bank_mask:0xc
s_nop 0
v_add_f32_dpp v67, v236, v236 row_half_mirror row_mask:0xf bank_mask:0x5
v_add_f32_dpp v67, v237, v237 row_half_mirror row_mask:0xf bank_mask:0xa
s_nop 1
v_add_f32_dpp v67, v67, v67 quad_perm:[1,0,3,2] row_mask:0xf bank_mask:0xf
s_nop 1
v_add_f32_dpp v67, v67, v67 quad_perm:[2,3,0,1] row_mask:0xf bank_mask:0xf
s_waitcnt vmcnt(12)
v_dot2_f32_bf16 v232, v168, v216, 0
v_dot2_f32_bf16 v233, v168, v220, 0
v_dot2_f32_bf16 v234, v168, v224, 0
v_dot2_f32_bf16 v235, v168, v228, 0
v_dot2_f32_bf16 v232, v169, v217, v232
v_dot2_f32_bf16 v233, v169, v221, v233
v_dot2_f32_bf16 v234, v169, v225, v234
v_dot2_f32_bf16 v235, v169, v229, v235
v_dot2_f32_bf16 v232, v170, v218, v232
v_dot2_f32_bf16 v233, v170, v222, v233
v_dot2_f32_bf16 v234, v170, v226, v234
v_dot2_f32_bf16 v235, v170, v230, v235
v_dot2_f32_bf16 v232, v171, v219, v232
v_dot2_f32_bf16 v233, v171, v223, v233
v_dot2_f32_bf16 v234, v171, v227, v234
v_dot2_f32_bf16 v235, v171, v231, v235
v_add_f32_dpp v236, v232, v232 row_ror:8 row_mask:0xf bank_mask:0x3
v_add_f32_dpp v237, v233, v233 row_ror:8 row_mask:0xf bank_mask:0x3
v_add_f32_dpp v236, v234, v234 row_ror:8 row_mask:0xf bank_mask:0xc
v_add_f32_dpp v237, v235, v235 row_ror:8 row_mask:0xf bank_mask:0xc
s_nop 0
v_add_f32_dpp v68, v236, v236 row_half_mirror row_mask:0xf bank_mask:0x5
v_add_f32_dpp v68, v237, v237 row_half_mirror row_mask:0xf bank_mask:0xa
s_nop 1
v_add_f32_dpp v68, v68, v68 quad_perm:[1,0,3,2] row_mask:0xf bank_mask:0xf
s_nop 1
v_add_f32_dpp v68, v68, v68 quad_perm:[2,3,0,1] row_mask:0xf bank_mask:0xf
s_waitcnt vmcnt(11)
v_dot2_f32_bf16 v232, v172, v216, 0
v_dot2_f32_bf16 v233, v172, v220, 0
v_dot2_f32_bf16 v234, v172, v224, 0
v_dot2_f32_bf16 v235, v172, v228, 0
v_dot2_f32_bf16 v232, v173, v217, v232
v_dot2_f32_bf16 v233, v173, v221, v233
v_dot2_f32_bf16 v234, v173, v225, v234
v_dot2_f32_bf16 v235, v173, v229, v235
v_dot2_f32_bf16 v232, v174, v218, v232
v_dot2_f32_bf16 v233, v174, v222, v233
v_dot2_f32_bf16 v234, v174, v226, v234
v_dot2_f32_bf16 v235, v174, v230, v235
v_dot2_f32_bf16 v232, v175, v219, v232
v_dot2_f32_bf16 v233, v175, v223, v233
v_dot2_f32_bf16 v234, v175, v227, v234
v_dot2_f32_bf16 v235, v175, v231, v235
v_add_f32_dpp v236, v232, v232 row_ror:8 row_mask:0xf bank_mask:0x3
v_add_f32_dpp v237, v233, v233 row_ror:8 row_mask:0xf bank_mask:0x3
v_add_f32_dpp v236, v234, v234 row_ror:8 row_mask:0xf bank_mask:0xc
v_add_f32_dpp v237, v235, v235 row_ror:8 row_mask:0xf bank_mask:0xc
s_nop 0
v_add_f32_dpp v69, v236, v236 row_half_mirror row_mask:0xf bank_mask:0x5
v_add_f32_dpp v69, v237, v237 row_half_mirror row_mask:0xf bank_mask:0xa
s_nop 1
v_add_f32_dpp v69, v69, v69 quad_perm:[1,0,3,2] row_mask:0xf bank_mask:0xf
s_nop 1
v_add_f32_dpp v69, v69, v69 quad_perm:[2,3,0,1] row_mask:0xf bank_mask:0xf
s_waitcnt vmcnt(10)
v_dot2_f32_bf16 v232, v176, v216, 0
v_dot2_f32_bf16 v233, v176, v220, 0
v_dot2_f32_bf16 v234, v176, v224, 0
v_dot2_f32_bf16 v235, v176, v228, 0
v_dot2_f32_bf16 v232, v177, v217, v232
v_dot2_f32_bf16 v233, v177, v221, v233
v_dot2_f32_bf16 v234, v177, v225, v234
v_dot2_f32_bf16 v235, v177, v229, v235
v_dot2_f32_bf16 v232, v178, v218, v232
v_dot2_f32_bf16 v233, v178, v222, v233
v_dot2_f32_bf16 v234, v178, v226, v234
v_dot2_f32_bf16 v235, v178, v230, v235
v_dot2_f32_bf16 v232, v179, v219, v232
v_dot2_f32_bf16 v233, v179, v223, v233
v_dot2_f32_bf16 v234, v179, v227, v234
v_dot2_f32_bf16 v235, v179, v231, v235
v_add_f32_dpp v236, v232, v232 row_ror:8 row_mask:0xf bank_mask:0x3
v_add_f32_dpp v237, v233, v233 row_ror:8 row_mask:0xf bank_mask:0x3
v_add_f32_dpp v236, v234, v234 row_ror:8 row_mask:0xf bank_mask:0xc
v_add_f32_dpp v237, v235, v235 row_ror:8 row_mask:0xf bank_mask:0xc
s_nop 0
v_add_f32_dpp v70, v236, v236 row_half_mirror row_mask:0xf bank_mask:0x5
v_add_f32_dpp v70, v237, v237 row_half_mirror row_mask:0xf bank_mask:0xa
s_nop 1
v_add_f32_dpp v70, v70, v70 quad_perm:[1,0,3,2] row_mask:0xf bank_mask:0xf
s_nop 1
v_add_f32_dpp v70, v70, v70 quad_perm:[2,3,0,1] row_mask:0xf bank_mask:0xf
s_waitcnt vmcnt(9)
v_dot2_f32_bf16 v232, v180, v216, 0
v_dot2_f32_bf16 v233, v180, v220, 0
v_dot2_f32_bf16 v234, v180, v224, 0
v_dot2_f32_bf16 v235, v180, v228, 0
v_dot2_f32_bf16 v232, v181, v217, v232
v_dot2_f32_bf16 v233, v181, v221, v233
v_dot2_f32_bf16 v234, v181, v225, v234
v_dot2_f32_bf16 v235, v181, v229, v235
v_dot2_f32_bf16 v232, v182, v218, v232
v_dot2_f32_bf16 v233, v182, v222, v233
v_dot2_f32_bf16 v234, v182, v226, v234
v_dot2_f32_bf16 v235, v182, v230, v235
v_dot2_f32_bf16 v232, v183, v219, v232
v_dot2_f32_bf16 v233, v183, v223, v233
v_dot2_f32_bf16 v234, v183, v227, v234
v_dot2_f32_bf16 v235, v183, v231, v235
v_add_f32_dpp v236, v232, v232 row_ror:8 row_mask:0xf bank_mask:0x3
v_add_f32_dpp v237, v233, v233 row_ror:8 row_mask:0xf bank_mask:0x3
v_add_f32_dpp v236, v234, v234 row_ror:8 row_mask:0xf bank_mask:0xc
v_add_f32_dpp v237, v235, v235 row_ror:8 row_mask:0xf bank_mask:0xc
s_nop 0
v_add_f32_dpp v71, v236, v236 row_half_mirror row_mask:0xf bank_mask:0x5
v_add_f32_dpp v71, v237, v237 row_half_mirror row_mask:0xf bank_mask:0xa
s_nop 1
v_add_f32_dpp v71, v71, v71 quad_perm:[1,0,3,2] row_mask:0xf bank_mask:0xf
s_nop 1
v_add_f32_dpp v71, v71, v71 quad_perm:[2,3,0,1] row_mask:0xf bank_mask:0xf
s_waitcnt vmcnt(8)
v_dot2_f32_bf16 v232, v184, v216, 0
v_dot2_f32_bf16 v233, v184, v220, 0
v_dot2_f32_bf16 v234, v184, v224, 0
v_dot2_f32_bf16 v235, v184, v228, 0
v_dot2_f32_bf16 v232, v185, v217, v232
v_dot2_f32_bf16 v233, v185, v221, v233
v_dot2_f32_bf16 v234, v185, v225, v234
v_dot2_f32_bf16 v235, v185, v229, v235
v_dot2_f32_bf16 v232, v186, v218, v232
v_dot2_f32_bf16 v233, v186, v222, v233
v_dot2_f32_bf16 v234, v186, v226, v234
v_dot2_f32_bf16 v235, v186, v230, v235
v_dot2_f32_bf16 v232, v187, v219, v232
v_dot2_f32_bf16 v233, v187, v223, v233
v_dot2_f32_bf16 v234, v187, v227, v234
v_dot2_f32_bf16 v235, v187, v231, v235
v_add_f32_dpp v236, v232, v232 row_ror:8 row_mask:0xf bank_mask:0x3
v_add_f32_dpp v237, v233, v233 row_ror:8 row_mask:0xf bank_mask:0x3
v_add_f32_dpp v236, v234, v234 row_ror:8 row_mask:0xf bank_mask:0xc
v_add_f32_dpp v237, v235, v235 row_ror:8 row_mask:0xf bank_mask:0xc
s_nop 0
v_add_f32_dpp v72, v236, v236 row_half_mirror row_mask:0xf bank_mask:0x5
v_add_f32_dpp v72, v237, v237 row_half_mirror row_mask:0xf bank_mask:0xa
s_nop 1
v_add_f32_dpp v72, v72, v72 quad_perm:[1,0,3,2] row_mask:0xf bank_mask:0xf
s_nop 1
v_add_f32_dpp v72, v72, v72 quad_perm:[2,3,0,1] row_mask:0xf bank_mask:0xf
s_waitcnt vmcnt(7)
v_dot2_f32_bf16 v232, v188, v216, 0
v_dot2_f32_bf16 v233, v188, v220, 0
v_dot2_f32_bf16 v234, v188, v224, 0
v_dot2_f32_bf16 v235, v188, v228, 0
v_dot2_f32_bf16 v232, v189, v217, v232
v_dot2_f32_bf16 v233, v189, v221, v233
v_dot2_f32_bf16 v234, v189, v225, v234
v_dot2_f32_bf16 v235, v189, v229, v235
v_dot2_f32_bf16 v232, v190, v218, v232
v_dot2_f32_bf16 v233, v190, v222, v233
v_dot2_f32_bf16 v234, v190, v226, v234
v_dot2_f32_bf16 v235, v190, v230, v235
v_dot2_f32_bf16 v232, v191, v219, v232
v_dot2_f32_bf16 v233, v191, v223, v233
v_dot2_f32_bf16 v234, v191, v227, v234
v_dot2_f32_bf16 v235, v191, v231, v235
v_add_f32_dpp v236, v232, v232 row_ror:8 row_mask:0xf bank_mask:0x3
v_add_f32_dpp v237, v233, v233 row_ror:8 row_mask:0xf bank_mask:0x3
v_add_f32_dpp v236, v234, v234 row_ror:8 row_mask:0xf bank_mask:0xc
v_add_f32_dpp v237, v235, v235 row_ror:8 row_mask:0xf bank_mask:0xc
s_nop 0
v_add_f32_dpp v73, v236, v236 row_half_mirror row_mask:0xf bank_mask:0x5
v_add_f32_dpp v73, v237, v237 row_half_mirror row_mask:0xf bank_mask:0xa
s_nop 1
v_add_f32_dpp v73, v73, v73 quad_perm:[1,0,3,2] row_mask:0xf bank_mask:0xf
s_nop 1
v_add_f32_dpp v73, v73, v73 quad_perm:[2,3,0,1] row_mask:0xf bank_mask:0xf
s_waitcnt vmcnt(6)
v_dot2_f32_bf16 v232, v192, v216, 0
v_dot2_f32_bf16 v233, v192, v220, 0
v_dot2_f32_bf16 v234, v192, v224, 0
v_dot2_f32_bf16 v235, v192, v228, 0
v_dot2_f32_bf16 v232, v193, v217, v232
v_dot2_f32_bf16 v233, v193, v221, v233
v_dot2_f32_bf16 v234, v193, v225, v234
v_dot2_f32_bf16 v235, v193, v229, v235
v_dot2_f32_bf16 v232, v194, v218, v232
v_dot2_f32_bf16 v233, v194, v222, v233
v_dot2_f32_bf16 v234, v194, v226, v234
v_dot2_f32_bf16 v235, v194, v230, v235
v_dot2_f32_bf16 v232, v195, v219, v232
v_dot2_f32_bf16 v233, v195, v223, v233
v_dot2_f32_bf16 v234, v195, v227, v234
v_dot2_f32_bf16 v235, v195, v231, v235
v_add_f32_dpp v236, v232, v232 row_ror:8 row_mask:0xf bank_mask:0x3
v_add_f32_dpp v237, v233, v233 row_ror:8 row_mask:0xf bank_mask:0x3
v_add_f32_dpp v236, v234, v234 row_ror:8 row_mask:0xf bank_mask:0xc
v_add_f32_dpp v237, v235, v235 row_ror:8 row_mask:0xf bank_mask:0xc
s_nop 0
v_add_f32_dpp v74, v236, v236 row_half_mirror row_mask:0xf bank_mask:0x5
v_add_f32_dpp v74, v237, v237 row_half_mirror row_mask:0xf bank_mask:0xa
s_nop 1
v_add_f32_dpp v74, v74, v74 quad_perm:[1,0,3,2] row_mask:0xf bank_mask:0xf
s_nop 1
v_add_f32_dpp v74, v74, v74 quad_perm:[2,3,0,1] row_mask:0xf bank_mask:0xf
s_waitcnt vmcnt(5)
v_dot2_f32_bf16 v232, v196, v216, 0
v_dot2_f32_bf16 v233, v196, v220, 0
v_dot2_f32_bf16 v234, v196, v224, 0
v_dot2_f32_bf16 v235, v196, v228, 0
v_dot2_f32_bf16 v232, v197, v217, v232
v_dot2_f32_bf16 v233, v197, v221, v233
v_dot2_f32_bf16 v234, v197, v225, v234
v_dot2_f32_bf16 v235, v197, v229, v235
v_dot2_f32_bf16 v232, v198, v218, v232
v_dot2_f32_bf16 v233, v198, v222, v233
v_dot2_f32_bf16 v234, v198, v226, v234
v_dot2_f32_bf16 v235, v198, v230, v235
v_dot2_f32_bf16 v232, v199, v219, v232
v_dot2_f32_bf16 v233, v199, v223, v233
v_dot2_f32_bf16 v234, v199, v227, v234
v_dot2_f32_bf16 v235, v199, v231, v235
v_add_f32_dpp v236, v232, v232 row_ror:8 row_mask:0xf bank_mask:0x3
v_add_f32_dpp v237, v233, v233 row_ror:8 row_mask:0xf bank_mask:0x3
v_add_f32_dpp v236, v234, v234 row_ror:8 row_mask:0xf bank_mask:0xc
v_add_f32_dpp v237, v235, v235 row_ror:8 row_mask:0xf bank_mask:0xc
s_nop 0
v_add_f32_dpp v75, v236, v236 row_half_mirror row_mask:0xf bank_mask:0x5
v_add_f32_dpp v75, v237, v237 row_half_mirror row_mask:0xf bank_mask:0xa
s_nop 1
v_add_f32_dpp v75, v75, v75 quad_perm:[1,0,3,2] row_mask:0xf bank_mask:0xf
s_nop 1
v_add_f32_dpp v75, v75, v75 quad_perm:[2,3,0,1] row_mask:0xf bank_mask:0xf
s_waitcnt vmcnt(4)
v_dot2_f32_bf16 v232, v200, v216, 0
v_dot2_f32_bf16 v233, v200, v220, 0
v_dot2_f32_bf16 v234, v200, v224, 0
v_dot2_f32_bf16 v235, v200, v228, 0
v_dot2_f32_bf16 v232, v201, v217, v232
v_dot2_f32_bf16 v233, v201, v221, v233
v_dot2_f32_bf16 v234, v201, v225, v234
v_dot2_f32_bf16 v235, v201, v229, v235
v_dot2_f32_bf16 v232, v202, v218, v232
v_dot2_f32_bf16 v233, v202, v222, v233
v_dot2_f32_bf16 v234, v202, v226, v234
v_dot2_f32_bf16 v235, v202, v230, v235
v_dot2_f32_bf16 v232, v203, v219, v232
v_dot2_f32_bf16 v233, v203, v223, v233
v_dot2_f32_bf16 v234, v203, v227, v234
v_dot2_f32_bf16 v235, v203, v231, v235
v_add_f32_dpp v236, v232, v232 row_ror:8 row_mask:0xf bank_mask:0x3
v_add_f32_dpp v237, v233, v233 row_ror:8 row_mask:0xf bank_mask:0x3
v_add_f32_dpp v236, v234, v234 row_ror:8 row_mask:0xf bank_mask:0xc
v_add_f32_dpp v237, v235, v235 row_ror:8 row_mask:0xf bank_mask:0xc
s_nop 0
v_add_f32_dpp v76, v236, v236 row_half_mirror row_mask:0xf bank_mask:0x5
v_add_f32_dpp v76, v237, v237 row_half_mirror row_mask:0xf bank_mask:0xa
s_nop 1
v_add_f32_dpp v76, v76, v76 quad_perm:[1,0,3,2] row_mask:0xf bank_mask:0xf
s_nop 1
v_add_f32_dpp v76, v76, v76 quad_perm:[2,3,0,1] row_mask:0xf bank_mask:0xf
s_waitcnt vmcnt(3)
v_dot2_f32_bf16 v232, v204, v216, 0
v_dot2_f32_bf16 v233, v204, v220, 0
v_dot2_f32_bf16 v234, v204, v224, 0
v_dot2_f32_bf16 v235, v204, v228, 0
v_dot2_f32_bf16 v232, v205, v217, v232
v_dot2_f32_bf16 v233, v205, v221, v233
v_dot2_f32_bf16 v234, v205, v225, v234
v_dot2_f32_bf16 v235, v205, v229, v235
v_dot2_f32_bf16 v232, v206, v218, v232
v_dot2_f32_bf16 v233, v206, v222, v233
v_dot2_f32_bf16 v234, v206, v226, v234
v_dot2_f32_bf16 v235, v206, v230, v235
v_dot2_f32_bf16 v232, v207, v219, v232
v_dot2_f32_bf16 v233, v207, v223, v233
v_dot2_f32_bf16 v234, v207, v227, v234
v_dot2_f32_bf16 v235, v207, v231, v235
v_add_f32_dpp v236, v232, v232 row_ror:8 row_mask:0xf bank_mask:0x3
v_add_f32_dpp v237, v233, v233 row_ror:8 row_mask:0xf bank_mask:0x3
v_add_f32_dpp v236, v234, v234 row_ror:8 row_mask:0xf bank_mask:0xc
v_add_f32_dpp v237, v235, v235 row_ror:8 row_mask:0xf bank_mask:0xc
s_nop 0
v_add_f32_dpp v77, v236, v236 row_half_mirror row_mask:0xf bank_mask:0x5
v_add_f32_dpp v77, v237, v237 row_half_mirror row_mask:0xf bank_mask:0xa
s_nop 1
v_add_f32_dpp v77, v77, v77 quad_perm:[1,0,3,2] row_mask:0xf bank_mask:0xf
s_nop 1
v_add_f32_dpp v77, v77, v77 quad_perm:[2,3,0,1] row_mask:0xf bank_mask:0xf
s_waitcnt vmcnt(2)
v_dot2_f32_bf16 v232, v208, v216, 0
v_dot2_f32_bf16 v233, v208, v220, 0
v_dot2_f32_bf16 v234, v208, v224, 0
v_dot2_f32_bf16 v235, v208, v228, 0
v_dot2_f32_bf16 v232, v209, v217, v232
v_dot2_f32_bf16 v233, v209, v221, v233
v_dot2_f32_bf16 v234, v209, v225, v234
v_dot2_f32_bf16 v235, v209, v229, v235
v_dot2_f32_bf16 v232, v210, v218, v232
v_dot2_f32_bf16 v233, v210, v222, v233
v_dot2_f32_bf16 v234, v210, v226, v234
v_dot2_f32_bf16 v235, v210, v230, v235
v_dot2_f32_bf16 v232, v211, v219, v232
v_dot2_f32_bf16 v233, v211, v223, v233
v_dot2_f32_bf16 v234, v211, v227, v234
v_dot2_f32_bf16 v235, v211, v231, v235
v_add_f32_dpp v236, v232, v232 row_ror:8 row_mask:0xf bank_mask:0x3
v_add_f32_dpp v237, v233, v233 row_ror:8 row_mask:0xf bank_mask:0x3
v_add_f32_dpp v236, v234, v234 row_ror:8 row_mask:0xf bank_mask:0xc
v_add_f32_dpp v237, v235, v235 row_ror:8 row_mask:0xf bank_mask:0xc
s_nop 0
v_add_f32_dpp v78, v236, v236 row_half_mirror row_mask:0xf bank_mask:0x5
v_add_f32_dpp v78, v237, v237 row_half_mirror row_mask:0xf bank_mask:0xa
s_nop 1
v_add_f32_dpp v78, v78, v78 quad_perm:[1,0,3,2] row_mask:0xf bank_mask:0xf
s_nop 1
v_add_f32_dpp v78, v78, v78 quad_perm:[2,3,0,1] row_mask:0xf bank_mask:0xf
s_waitcnt vmcnt(1)
v_dot2_f32_bf16 v232, v212, v216, 0
v_dot2_f32_bf16 v233, v212, v220, 0
v_dot2_f32_bf16 v234, v212, v224, 0
v_dot2_f32_bf16 v235, v212, v228, 0
v_dot2_f32_bf16 v232, v213, v217, v232
v_dot2_f32_bf16 v233, v213, v221, v233
v_dot2_f32_bf16 v234, v213, v225, v234
v_dot2_f32_bf16 v235, v213, v229, v235
v_dot2_f32_bf16 v232, v214, v218, v232
v_dot2_f32_bf16 v233, v214, v222, v233
v_dot2_f32_bf16 v234, v214, v226, v234
v_dot2_f32_bf16 v235, v214, v230, v235
v_dot2_f32_bf16 v232, v215, v219, v232
v_dot2_f32_bf16 v233, v215, v223, v233
v_dot2_f32_bf16 v234, v215, v227, v234
v_dot2_f32_bf16 v235, v215, v231, v235
v_add_f32_dpp v236, v232, v232 row_ror:8 row_mask:0xf bank_mask:0x3
v_add_f32_dpp v237, v233, v233 row_ror:8 row_mask:0xf bank_mask:0x3
v_add_f32_dpp v236, v234, v234 row_ror:8 row_mask:0xf bank_mask:0xc
v_add_f32_dpp v237, v235, v235 row_ror:8 row_mask:0xf bank_mask:0xc
s_nop 0
v_add_f32_dpp v79, v236, v236 row_half_mirror row_mask:0xf bank_mask:0x5
v_add_f32_dpp v79, v237, v237 row_half_mirror row_mask:0xf bank_mask:0xa
s_nop 1
v_add_f32_dpp v79, v79, v79 quad_perm:[1,0,3,2] row_mask:0xf bank_mask:0xf
s_nop 1
v_add_f32_dpp v79, v79, v79 quad_perm:[2,3,0,1] row_mask:0xf bank_mask:0xf
v_cvt_pk_bf16_f32 v24, v64, v65
v_cvt_pk_bf16_f32 v25, v66, v67
v_cvt_pk_bf16_f32 v26, v68, v69
v_cvt_pk_bf16_f32 v27, v70, v71
v_cvt_pk_bf16_f32 v28, v72, v73
v_cvt_pk_bf16_f32 v29, v74, v75
v_cvt_pk_bf16_f32 v30, v76, v77
v_cvt_pk_bf16_f32 v31, v78, v79
v_cmp_eq_u32 vcc, 1, v6
s_nop 1
v_cndmask_b32 v248, v24, v28, vcc
v_cndmask_b32 v249, v25, v29, vcc
v_cndmask_b32 v250, v26, v30, vcc
v_cndmask_b32 v251, v27, v31, vcc
v_cmp_eq_u32 vcc, 1, v7
s_nop 1
v_cndmask_b32 v244, v244, v248, vcc
v_cndmask_b32 v245, v245, v249, vcc
v_cndmask_b32 v246, v246, v250, vcc
v_cndmask_b32 v247, v247, v251, vcc
v_min_u32 v244, -2, v244
v_min_u32 v245, -2, v245
v_min_u32 v246, -2, v246
v_min_u32 v247, -2, v247
s_waitcnt vmcnt(0)
s_mov_b32 s7, 400000
L_ens_15:
v_readfirstlane_b32 s6, v11
s_cmp_ge_u32 s6, 32
s_cbranch_scc1 L_ensd_16
s_sleep 16
buffer_load_dword v11, off, s[68:71], 0 offset:0 sc1
s_waitcnt vmcnt(0)
s_sub_u32 s7, s7, 1
s_cmp_lg_u32 s7, 0
s_cbranch_scc1 L_ens_15
L_ensd_16:
s_lshl_b32 s6, s4, 10
s_lshl_b32 s7, s3, 8
s_add_u32 s6, s6, s7
s_add_u32 s6, s6, 0
buffer_store_dwordx4 v[244:247], v5, s[64:67], s6 offen sc1
s_mov_b32 m0, s12
s_nop 0
buffer_load_dwordx4 v2, s[60:63], s12 offen offset:0 nt lds
buffer_load_dwordx4 v2, s[60:63], s12 offen offset:1024 nt lds
buffer_load_dwordx4 v2, s[60:63], s12 offen offset:2048 nt lds
s_waitcnt vmcnt(3)
buffer_load_dwordx4 v2, s[60:63], s12 offen offset:3072 nt lds
s_add_u32 s12, s12, 4096
s_mov_b32 m0, s12
s_waitcnt vmcnt(3)
buffer_load_dwordx4 v2, s[60:63], s12 offen offset:0 nt lds
s_waitcnt vmcnt(3)
buffer_load_dwordx4 v2, s[60:63], s12 offen offset:1024 nt lds
s_waitcnt vmcnt(3)
buffer_load_dwordx4 v2, s[60:63], s12 offen offset:2048 nt lds
s_waitcnt vmcnt(3)
buffer_load_dwordx4 v2, s[60:63], s12 offen offset:3072 nt lds
s_add_u32 s12, s12, 4096
s_mov_b32 m0, s12
s_waitcnt vmcnt(3)
buffer_load_dwordx4 v2, s[60:63], s12 offen offset:0 nt lds
s_waitcnt vmcnt(3)
buffer_load_dwordx4 v2, s[60:63], s12 offen offset:1024 nt lds
s_waitcnt vmcnt(3)
buffer_load_dwordx4 v2, s[60:63], s12 offen offset:2048 nt lds
s_waitcnt vmcnt(3)
buffer_load_dwordx4 v2, s[60:63], s12 offen offset:3072 nt lds
s_add_u32 s12, s12, 4096
s_mov_b32 m0, s12
s_waitcnt vmcnt(3)
buffer_load_dwordx4 v2, s[60:63], s12 offen offset:0 nt lds
s_waitcnt vmcnt(3)
buffer_load_dwordx4 v2, s[60:63], s12 offen offset:1024 nt lds
s_waitcnt vmcnt(3)
buffer_load_dwordx4 v2, s[60:63], s12 offen offset:2048 nt lds
s_waitcnt vmcnt(3)
buffer_load_dwordx4 v2, s[60:63], s12 offen offset:3072 nt lds
s_add_u32 s12, s12, 4096
s_mov_b32 m0, s12
s_waitcnt vmcnt(3)
buffer_load_dwordx4 v2, s[60:63], s12 offen offset:0 nt lds
s_waitcnt vmcnt(3)
buffer_load_dwordx4 v2, s[60:63], s12 offen offset:1024 nt lds
s_waitcnt vmcnt(3)
buffer_load_dwordx4 v2, s[60:63], s12 offen offset:2048 nt lds
s_waitcnt vmcnt(3)
buffer_load_dwordx4 v2, s[60:63], s12 offen offset:3072 nt lds
s_add_u32 s12, s12, 4096
s_mov_b32 m0, s12
s_waitcnt vmcnt(3)
buffer_load_dwordx4 v2, s[60:63], s12 offen offset:0 nt lds
s_waitcnt vmcnt(3)
buffer_load_dwordx4 v2, s[60:63], s12 offen offset:1024 nt lds
s_waitcnt vmcnt(3)
buffer_load_dwordx4 v2, s[60:63], s12 offen offset:2048 nt lds
s_waitcnt vmcnt(3)
buffer_load_dwordx4 v2, s[60:63], s12 offen offset:3072 nt lds
s_add_u32 s12, s12, 4096
s_mov_b32 m0, s12
s_waitcnt vmcnt(3)
buffer_load_dwordx4 v2, s[60:63], s12 offen offset:0 nt lds
s_waitcnt vmcnt(3)
buffer_load_dwordx4 v2, s[60:63], s12 offen offset:1024 nt lds
s_waitcnt vmcnt(3)
buffer_load_dwordx4 v2, s[60:63], s12 offen offset:2048 nt lds
s_waitcnt vmcnt(3)
buffer_load_dwordx4 v2, s[60:63], s12 offen offset:3072 nt lds
s_add_u32 s12, s12, 4096
s_mov_b32 m0, s12
s_waitcnt vmcnt(3)
buffer_load_dwordx4 v2, s[60:63], s12 offen offset:0 nt lds
s_waitcnt vmcnt(3)
buffer_load_dwordx4 v2, s[60:63], s12 offen offset:1024 nt lds
s_waitcnt vmcnt(3)
buffer_load_dwordx4 v2, s[60:63], s12 offen offset:2048 nt lds
s_waitcnt vmcnt(3)
buffer_load_dwordx4 v2, s[60:63], s12 offen offset:3072 nt lds
s_add_u32 s12, s12, 4096
s_mov_b32 m0, s12
s_waitcnt vmcnt(3)
buffer_load_dwordx4 v2, s[60:63], s12 offen offset:0 nt lds
s_waitcnt vmcnt(3)
buffer_load_dwordx4 v2, s[60:63], s12 offen offset:1024 nt lds
s_waitcnt vmcnt(3)
buffer_load_dwordx4 v2, s[60:63], s12 offen offset:2048 nt lds
s_waitcnt vmcnt(3)
buffer_load_dwordx4 v2, s[60:63], s12 offen offset:3072 nt lds
v_lshlrev_b32 v238, 18, v9
v_lshl_add_u32 v238, v8, 4, v238
s_mov_b32 s6, 0
s_waitcnt vmcnt(3)
buffer_load_dwordx4 v[88:91], v238, s[52:55], s6 offen nt
s_mov_b32 s6, 8192
s_waitcnt vmcnt(3)
buffer_load_dwordx4 v[92:95], v238, s[52:55], s6 offen nt
s_mov_b32 s6, 16384
s_waitcnt vmcnt(3)
buffer_load_dwordx4 v[96:99], v238, s[52:55], s6 offen nt
s_mov_b32 s6, 24576
s_waitcnt vmcnt(3)
buffer_load_dwordx4 v[100:103], v238, s[52:55], s6 offen nt
s_mov_b32 s6, 32768
s_waitcnt vmcnt(3)
buffer_load_dwordx4 v[104:107], v238, s[52:55], s6 offen nt
s_mov_b32 s6, 40960
s_waitcnt vmcnt(3)
buffer_load_dwordx4 v[108:111], v238, s[52:55], s6 offen nt
s_mov_b32 s6, 49152
s_waitcnt vmcnt(3)
buffer_load_dwordx4 v[112:115], v238, s[52:55], s6 offen nt
s_mov_b32 s6, 57344
s_waitcnt vmcnt(3)
buffer_load_dwordx4 v[116:119], v238, s[52:55], s6 offen nt
s_mov_b32 s6, 65536
s_waitcnt vmcnt(3)
buffer_load_dwordx4 v[120:123], v238, s[52:55], s6 offen nt
s_mov_b32 s6, 73728
s_waitcnt vmcnt(3)
buffer_load_dwordx4 v[124:127], v238, s[52:55], s6 offen nt
s_mov_b32 s6, 81920
s_waitcnt vmcnt(3)
buffer_load_dwordx4 v[128:131], v238, s[52:55], s6 offen nt
s_mov_b32 s6, 90112
s_waitcnt vmcnt(3)
buffer_load_dwordx4 v[132:135], v238, s[52:55], s6 offen nt
s_mov_b32 s6, 98304
s_waitcnt vmcnt(3)
buffer_load_dwordx4 v[136:139], v238, s[52:55], s6 offen nt
s_mov_b32 s6, 106496
s_waitcnt vmcnt(3)
buffer_load_dwordx4 v[140:143], v238, s[52:55], s6 offen nt
s_mov_b32 s6, 114688
s_waitcnt vmcnt(3)
buffer_load_dwordx4 v[144:147], v238, s[52:55], s6 offen nt
s_mov_b32 s6, 122880
s_waitcnt vmcnt(3)
buffer_load_dwordx4 v[148:151], v238, s[52:55], s6 offen nt
s_mov_b32 s6, 131072
s_waitcnt vmcnt(3)
buffer_load_dwordx4 v[152:155], v238, s[52:55], s6 offen nt
s_mov_b32 s6, 139264
s_waitcnt vmcnt(3)
buffer_load_dwordx4 v[156:159], v238, s[52:55], s6 offen nt
s_mov_b32 s6, 147456
s_waitcnt vmcnt(3)
buffer_load_dwordx4 v[160:163], v238, s[52:55], s6 offen nt
s_mov_b32 s6, 155648
s_waitcnt vmcnt(3)
buffer_load_dwordx4 v[164:167], v238, s[52:55], s6 offen nt
s_mov_b32 s6, 163840
s_waitcnt vmcnt(3)
buffer_load_dwordx4 v[168:171], v238, s[52:55], s6 offen nt
s_mov_b32 s6, 172032
s_waitcnt vmcnt(3)
buffer_load_dwordx4 v[172:175], v238, s[52:55], s6 offen nt
s_mov_b32 s6, 180224
s_waitcnt vmcnt(3)
buffer_load_dwordx4 v[176:179], v238, s[52:55], s6 offen nt
s_mov_b32 s6, 188416
s_waitcnt vmcnt(3)
buffer_load_dwordx4 v[180:183], v238, s[52:55], s6 offen nt
s_mov_b32 s6, 196608
s_waitcnt vmcnt(3)
buffer_load_dwordx4 v[184:187], v238, s[52:55], s6 offen nt
s_mov_b32 s6, 204800
s_waitcnt vmcnt(3)
buffer_load_dwordx4 v[188:191], v238, s[52:55], s6 offen nt
s_mov_b32 s6, 212992
s_waitcnt vmcnt(3)
buffer_load_dwordx4 v[192:195], v238, s[52:55], s6 offen nt
s_mov_b32 s6, 221184
s_waitcnt vmcnt(3)
buffer_load_dwordx4 v[196:199], v238, s[52:55], s6 offen nt
s_mov_b32 s6, 229376
s_waitcnt vmcnt(3)
buffer_load_dwordx4 v[200:203], v238, s[52:55], s6 offen nt
s_mov_b32 s6, 237568
s_waitcnt vmcnt(3)
buffer_load_dwordx4 v[204:207], v238, s[52:55], s6 offen nt
s_mov_b32 s6, 245760
s_waitcnt vmcnt(3)
buffer_load_dwordx4 v[208:211], v238, s[52:55], s6 offen nt
s_mov_b32 s6, 253952
s_waitcnt vmcnt(3)
buffer_load_dwordx4 v[212:215], v238, s[52:55], s6 offen nt
v_mov_b32 v11, 163824
v_mov_b32 v7, 0
ds_write_b32 v11, v7
s_waitcnt lgkmcnt(0)
s_barrier
ds_read_b64_tr_b16 a[96:97], v240 offset:0
ds_read_b64_tr_b16 a[98:99], v240 offset:4608
ds_read_b64_tr_b16 a[100:101], v240 offset:36864
ds_read_b64_tr_b16 a[102:103], v240 offset:41472
ds_read_b64_tr_b16 a[104:105], v242 offset:0
ds_read_b64_tr_b16 a[106:107], v242 offset:4608
ds_read_b64_tr_b16 a[108:109], v242 offset:36864
ds_read_b64_tr_b16 a[110:111], v242 offset:41472
ds_read_b64_tr_b16 a[112:113], v240 offset:8
ds_read_b64_tr_b16 a[114:115], v240 offset:4616
ds_read_b64_tr_b16 a[116:117], v240 offset:36872
ds_read_b64_tr_b16 a[118:119], v240 offset:41480
ds_read_b64_tr_b16 a[120:121], v242 offset:8
ds_read_b64_tr_b16 a[122:123], v242 offset:4616
ds_read_b64_tr_b16 a[124:125], v242 offset:36872
ds_read_b64_tr_b16 a[126:127], v242 offset:41480
ds_read_b64_tr_b16 a[128:129], v240 offset:16
ds_read_b64_tr_b16 a[130:131], v240 offset:4624
ds_read_b64_tr_b16 a[132:133], v240 offset:36880
ds_read_b64_tr_b16 a[134:135], v240 offset:41488
ds_read_b64_tr_b16 a[136:137], v242 offset:16
ds_read_b64_tr_b16 a[138:139], v242 offset:4624
ds_read_b64_tr_b16 a[140:141], v242 offset:36880
ds_read_b64_tr_b16 a[142:143], v242 offset:41488
ds_read_b64_tr_b16 a[144:145], v240 offset:24
ds_read_b64_tr_b16 a[146:147], v240 offset:4632
ds_read_b64_tr_b16 a[148:149], v240 offset:36888
ds_read_b64_tr_b16 a[150:151], v240 offset:41496
ds_read_b64_tr_b16 a[152:153], v242 offset:24
ds_read_b64_tr_b16 a[154:155], v242 offset:4632
ds_read_b64_tr_b16 a[156:157], v242 offset:36888
ds_read_b64_tr_b16 a[158:159], v242 offset:41496
ds_read_b64_tr_b16 a[160:161], v240 offset:128
ds_read_b64_tr_b16 a[162:163], v240 offset:4736
ds_read_b64_tr_b16 a[164:165], v240 offset:36992
ds_read_b64_tr_b16 a[166:167], v240 offset:41600
ds_read_b64_tr_b16 a[168:169], v242 offset:128
ds_read_b64_tr_b16 a[170:171], v242 offset:4736
ds_read_b64_tr_b16 a[172:173], v242 offset:36992
ds_read_b64_tr_b16 a[174:175], v242 offset:41600
ds_read_b64_tr_b16 a[176:177], v240 offset:136
ds_read_b64_tr_b16 a[178:179], v240 offset:4744
ds_read_b64_tr_b16 a[180:181], v240 offset:37000
ds_read_b64_tr_b16 a[182:183], v240 offset:41608
ds_read_b64_tr_b16 a[184:185], v242 offset:136
ds_read_b64_tr_b16 a[186:187], v242 offset:4744
ds_read_b64_tr_b16 a[188:189], v242 offset:37000
ds_read_b64_tr_b16 a[190:191], v242 offset:41608
ds_read_b64_tr_b16 a[192:193], v240 offset:144
ds_read_b64_tr_b16 a[194:195], v240 offset:4752
ds_read_b64_tr_b16 a[196:197], v240 offset:37008
ds_read_b64_tr_b16 a[198:199], v240 offset:41616
ds_read_b64_tr_b16 a[200:201], v242 offset:144
ds_read_b64_tr_b16 a[202:203], v242 offset:4752
ds_read_b64_tr_b16 a[204:205], v242 offset:37008
ds_read_b64_tr_b16 a[206:207], v242 offset:41616
ds_read_b64_tr_b16 a[208:209], v240 offset:152
ds_read_b64_tr_b16 a[210:211], v240 offset:4760
ds_read_b64_tr_b16 a[212:213], v240 offset:37016
ds_read_b64_tr_b16 a[214:215], v240 offset:41624
ds_read_b64_tr_b16 a[216:217], v242 offset:152
ds_read_b64_tr_b16 a[218:219], v242 offset:4760
ds_read_b64_tr_b16 a[220:221], v242 offset:37016
ds_read_b64_tr_b16 a[222:223], v242 offset:41624
ds_read_b64_tr_b16 a[224:225], v241 offset:0
ds_read_b64_tr_b16 a[226:227], v241 offset:4608
ds_read_b64_tr_b16 a[228:229], v241 offset:36864
ds_read_b64_tr_b16 a[230:231], v241 offset:41472
ds_read_b64_tr_b16 a[232:233], v243 offset:0
ds_read_b64_tr_b16 a[234:235], v243 offset:4608
ds_read_b64_tr_b16 a[236:237], v243 offset:36864
ds_read_b64_tr_b16 a[238:239], v243 offset:41472
v_and_b32 v6, 7, v1
v_mul_u32_u24 v6, 8, v6
s_lshl_b32 s6, s4, 8
s_mul_i32 s7, s3, 64
s_add_u32 s6, s6, s7
s_add_u32 s15, s6, 262144
s_mov_b32 s7, 400000
P_poll:
buffer_load_dwordx2 v[232:233], v6, s[64:67], s15 offen sc1
s_waitcnt vmcnt(0)
v_max_u32 v234, v232, v233
v_cmp_eq_u32 vcc, -1, v234
s_cbranch_vccz P_ok
s_sleep 16
s_sub_u32 s7, s7, 1
s_cmp_lg_u32 s7, 0
s_cbranch_scc1 P_poll
P_ok:
s_lshr_b32 s6, s4, 3
s_mul_i32 s6, s6, 524288
s_bitcmp1_b32 s4, 0
s_cselect_b32 s7, 98304, 0
s_add_u32 s6, s6, s7
s_bitcmp1_b32 s4, 1
s_cselect_b32 s7, 131072, 0
s_add_u32 s6, s6, s7
s_bitcmp1_b32 s4, 2
s_cselect_b32 s7, 262144, 0
s_add_u32 s6, s6, s7
s_lshl_b32 s7, s3, 13
s_add_u32 s6, s6, s7
s_add_u32 s6, s6, 2097152
buffer_load_dwordx4 v[24:27], v2, s[64:67], s6 offen offset:0 sc1
buffer_load_dwordx4 v[28:31], v2, s[64:67], s6 offen offset:1024 sc1
buffer_load_dwordx4 v[32:35], v2, s[64:67], s6 offen offset:2048 sc1
buffer_load_dwordx4 v[36:39], v2, s[64:67], s6 offen offset:3072 sc1
s_add_u32 s6, s6, 4096
buffer_load_dwordx4 v[40:43], v2, s[64:67], s6 offen offset:0 sc1
buffer_load_dwordx4 v[44:47], v2, s[64:67], s6 offen offset:1024 sc1
buffer_load_dwordx4 v[48:51], v2, s[64:67], s6 offen offset:2048 sc1
buffer_load_dwordx4 v[52:55], v2, s[64:67], s6 offen offset:3072 sc1
v_mov_b32 v234, v232
s_nop 1
v_max_f32_dpp v234, v234, v234 row_ror:4 row_mask:0xf bank_mask:0xf
s_nop 1
v_max_f32_dpp v234, v234, v234 row_ror:2 row_mask:0xf bank_mask:0xf
s_nop 1
v_max_f32_dpp v234, v234, v234 row_ror:1 row_mask:0xf bank_mask:0xf
v_sub_f32 v232, v232, v234
v_exp_f32 v232, v232
s_nop 0
v_mul_f32 v235, v232, v233
s_nop 1
v_add_f32_dpp v235, v235, v235 row_ror:4 row_mask:0xf bank_mask:0xf
s_nop 1
v_add_f32_dpp v235, v235, v235 row_ror:2 row_mask:0xf bank_mask:0xf
s_nop 1
v_add_f32_dpp v235, v235, v235 row_ror:1 row_mask:0xf bank_mask:0xf
v_rcp_f32 v235, v235
s_nop 0
v_mul_f32 v232, v232, v235
s_nop 0
v_readlane_b32 s26, v232, 0
v_readlane_b32 s27, v232, 1
v_readlane_b32 s28, v232, 2
v_readlane_b32 s29, v232, 3
v_readlane_b32 s30, v232, 4
v_readlane_b32 s31, v232, 5
v_readlane_b32 s32, v232, 6
v_readlane_b32 s33, v232, 7
s_mul_i32 s6, s3, 1040
s_add_u32 s6, s6, 147456
v_add_u32 v5, s6, v2
v_lshrrev_b32 v6, 3, v8
v_mul_u32_u24 v6, 1040, v6
v_lshl_add_u32 v6, v9, 6, v6
s_lshl_b32 s6, s3, 8
s_add_u32 s6, s6, 147456
v_add_u32 v6, s6, v6
s_waitcnt vmcnt(7)
v_lshlrev_b32 v244, 16, v24
v_and_b32 v245, 0xffff0000, v24
v_lshlrev_b32 v246, 16, v25
v_and_b32 v247, 0xffff0000, v25
v_lshlrev_b32 v248, 16, v26
v_and_b32 v249, 0xffff0000, v26
v_lshlrev_b32 v250, 16, v27
v_and_b32 v251, 0xffff0000, v27
v_mul_f32 v216, s26, v244
v_mul_f32 v217, s26, v245
v_mul_f32 v218, s26, v246
v_mul_f32 v219, s26, v247
v_mul_f32 v220, s26, v248
v_mul_f32 v221, s26, v249
v_mul_f32 v222, s26, v250
v_mul_f32 v223, s26, v251
s_waitcnt vmcnt(6)
v_lshlrev_b32 v244, 16, v28
v_and_b32 v245, 0xffff0000, v28
v_lshlrev_b32 v246, 16, v29
v_and_b32 v247, 0xffff0000, v29
v_lshlrev_b32 v248, 16, v30
v_and_b32 v249, 0xffff0000, v30
v_lshlrev_b32 v250, 16, v31
v_and_b32 v251, 0xffff0000, v31
v_fma_f32 v216, v244, s27, v216
v_fma_f32 v217, v245, s27, v217
v_fma_f32 v218, v246, s27, v218
v_fma_f32 v219, v247, s27, v219
v_fma_f32 v220, v248, s27, v220
v_fma_f32 v221, v249, s27, v221
v_fma_f32 v222, v250, s27, v222
v_fma_f32 v223, v251, s27, v223
s_waitcnt vmcnt(5)
v_lshlrev_b32 v244, 16, v32
v_and_b32 v245, 0xffff0000, v32
v_lshlrev_b32 v246, 16, v33
v_and_b32 v247, 0xffff0000, v33
v_lshlrev_b32 v248, 16, v34
v_and_b32 v249, 0xffff0000, v34
v_lshlrev_b32 v250, 16, v35
v_and_b32 v251, 0xffff0000, v35
v_fma_f32 v216, v244, s28, v216
v_fma_f32 v217, v245, s28, v217
v_fma_f32 v218, v246, s28, v218
v_fma_f32 v219, v247, s28, v219
v_fma_f32 v220, v248, s28, v220
v_fma_f32 v221, v249, s28, v221
v_fma_f32 v222, v250, s28, v222
v_fma_f32 v223, v251, s28, v223
s_waitcnt vmcnt(4)
v_lshlrev_b32 v244, 16, v36
v_and_b32 v245, 0xffff0000, v36
v_lshlrev_b32 v246, 16, v37
v_and_b32 v247, 0xffff0000, v37
v_lshlrev_b32 v248, 16, v38
v_and_b32 v249, 0xffff0000, v38
v_lshlrev_b32 v250, 16, v39
v_and_b32 v251, 0xffff0000, v39
v_fma_f32 v216, v244, s29, v216
v_fma_f32 v217, v245, s29, v217
v_fma_f32 v218, v246, s29, v218
v_fma_f32 v219, v247, s29, v219
v_fma_f32 v220, v248, s29, v220
v_fma_f32 v221, v249, s29, v221
v_fma_f32 v222, v250, s29, v222
v_fma_f32 v223, v251, s29, v223
s_waitcnt vmcnt(3)
v_lshlrev_b32 v244, 16, v40
v_and_b32 v245, 0xffff0000, v40
v_lshlrev_b32 v246, 16, v41
v_and_b32 v247, 0xffff0000, v41
v_lshlrev_b32 v248, 16, v42
v_and_b32 v249, 0xffff0000, v42
v_lshlrev_b32 v250, 16, v43
v_and_b32 v251, 0xffff0000, v43
v_fma_f32 v216, v244, s30, v216
v_fma_f32 v217, v245, s30, v217
v_fma_f32 v218, v246, s30, v218
v_fma_f32 v219, v247, s30, v219
v_fma_f32 v220, v248, s30, v220
v_fma_f32 v221, v249, s30, v221
v_fma_f32 v222, v250, s30, v222
v_fma_f32 v223, v251, s30, v223
s_waitcnt vmcnt(2)
v_lshlrev_b32 v244, 16, v44
v_and_b32 v245, 0xffff0000, v44
v_lshlrev_b32 v246, 16, v45
v_and_b32 v247, 0xffff0000, v45
v_lshlrev_b32 v248, 16, v46
v_and_b32 v249, 0xffff0000, v46
v_lshlrev_b32 v250, 16, v47
v_and_b32 v251, 0xffff0000, v47
v_fma_f32 v216, v244, s31, v216
v_fma_f32 v217, v245, s31, v217
v_fma_f32 v218, v246, s31, v218
v_fma_f32 v219, v247, s31, v219
v_fma_f32 v220, v248, s31, v220
v_fma_f32 v221, v249, s31, v221
v_fma_f32 v222, v250, s31, v222
v_fma_f32 v223, v251, s31, v223
s_waitcnt vmcnt(1)
v_lshlrev_b32 v244, 16, v48
v_and_b32 v245, 0xffff0000, v48
v_lshlrev_b32 v246, 16, v49
v_and_b32 v247, 0xffff0000, v49
v_lshlrev_b32 v248, 16, v50
v_and_b32 v249, 0xffff0000, v50
v_lshlrev_b32 v250, 16, v51
v_and_b32 v251, 0xffff0000, v51
v_fma_f32 v216, v244, s32, v216
v_fma_f32 v217, v245, s32, v217
v_fma_f32 v218, v246, s32, v218
v_fma_f32 v219, v247, s32, v219
v_fma_f32 v220, v248, s32, v220
v_fma_f32 v221, v249, s32, v221
v_fma_f32 v222, v250, s32, v222
v_fma_f32 v223, v251, s32, v223
s_waitcnt vmcnt(0)
v_lshlrev_b32 v244, 16, v52
v_and_b32 v245, 0xffff0000, v52
v_lshlrev_b32 v246, 16, v53
v_and_b32 v247, 0xffff0000, v53
v_lshlrev_b32 v248, 16, v54
v_and_b32 v249, 0xffff0000, v54
v_lshlrev_b32 v250, 16, v55
v_and_b32 v251, 0xffff0000, v55
v_fma_f32 v216, v244, s33, v216
v_fma_f32 v217, v245, s33, v217
v_fma_f32 v218, v246, s33, v218
v_fma_f32 v219, v247, s33, v219
v_fma_f32 v220, v248, s33, v220
v_fma_f32 v221, v249, s33, v221
v_fma_f32 v222, v250, s33, v222
v_fma_f32 v223, v251, s33, v223
v_cvt_pk_bf16_f32 v224, v216, v217
v_cvt_pk_bf16_f32 v225, v218, v219
v_cvt_pk_bf16_f32 v226, v220, v221
v_cvt_pk_bf16_f32 v227, v222, v223
ds_write_b128 v5, v[224:227]
s_waitcnt lgkmcnt(0)
s_barrier
ds_read_b128 v[24:27], v6 offset:0
ds_read_b128 v[44:47], v6 offset:2080
ds_read_b128 v[28:31], v6 offset:16
ds_read_b128 v[48:51], v6 offset:2096
ds_read_b128 v[32:35], v6 offset:32
ds_read_b128 v[52:55], v6 offset:2112
ds_read_b128 v[36:39], v6 offset:48
ds_read_b128 v[56:59], v6 offset:2128
v_lshrrev_b32 v5, 5, v1
v_mul_u32_u24 v5, 1088, v5
v_lshl_add_u32 v5, v8, 4, v5
v_and_b32 v7, 1, v9
v_lshl_add_u32 v5, v7, 3, v5
s_mul_i32 s6, s3, 272
s_add_u32 s6, s6, 155648
v_add_u32 v5, s6, v5
v_mul_u32_u24 v7, 272, v8
v_lshl_add_u32 v7, v9, 4, v7
v_add_u32 v7, 155648, v7
s_waitcnt lgkmcnt(0)
v_perm_b32 v64, v24, v24, v16
v_perm_b32 v65, v24, v24, v17
v_perm_b32 v66, v24, v24, v18
v_perm_b32 v67, v24, v24, v19
s_nop 1
v_mfma_f32_16x16x32_bf16 v[80:83], v[64:67], v[88:91], 0
v_perm_b32 v68, v44, v44, v16
v_perm_b32 v69, v44, v44, v17
v_perm_b32 v70, v44, v44, v18
v_perm_b32 v71, v44, v44, v19
s_nop 1
v_mfma_f32_16x16x32_bf16 v[84:87], v[68:71], v[88:91], 0
v_perm_b32 v72, v24, v24, v20
v_perm_b32 v73, v24, v24, v21
v_perm_b32 v74, v24, v24, v22
v_perm_b32 v75, v24, v24, v23
s_nop 1
v_mfma_f32_16x16x32_bf16 v[80:83], v[72:75], v[92:95], v[80:83]
v_perm_b32 v76, v44, v44, v20
v_perm_b32 v77, v44, v44, v21
v_perm_b32 v78, v44, v44, v22
v_perm_b32 v79, v44, v44, v23
s_nop 1
v_mfma_f32_16x16x32_bf16 v[84:87], v[76:79], v[92:95], v[84:87]
v_perm_b32 v64, v25, v25, v16
v_perm_b32 v65, v25, v25, v17
v_perm_b32 v66, v25, v25, v18
v_perm_b32 v67, v25, v25, v19
s_nop 1
v_mfma_f32_16x16x32_bf16 v[80:83], v[64:67], v[96:99], v[80:83]
v_perm_b32 v68, v45, v45, v16
v_perm_b32 v69, v45, v45, v17
v_perm_b32 v70, v45, v45, v18
v_perm_b32 v71, v45, v45, v19
s_nop 1
v_mfma_f32_16x16x32_bf16 v[84:87], v[68:71], v[96:99], v[84:87]
v_perm_b32 v72, v25, v25, v20
v_perm_b32 v73, v25, v25, v21
v_perm_b32 v74, v25, v25, v22
v_perm_b32 v75, v25, v25, v23
s_nop 1
v_mfma_f32_16x16x32_bf16 v[80:83], v[72:75], v[100:103], v[80:83]
v_perm_b32 v76, v45, v45, v20
v_perm_b32 v77, v45, v45, v21
v_perm_b32 v78, v45, v45, v22
v_perm_b32 v79, v45, v45, v23
s_nop 1
v_mfma_f32_16x16x32_bf16 v[84:87], v[76:79], v[100:103], v[84:87]
v_perm_b32 v64, v26, v26, v16
v_perm_b32 v65, v26, v26, v17
v_perm_b32 v66, v26, v26, v18
v_perm_b32 v67, v26, v26, v19
s_nop 1
v_mfma_f32_16x16x32_bf16 v[80:83], v[64:67], v[104:107], v[80:83]
v_perm_b32 v68, v46, v46, v16
v_perm_b32 v69, v46, v46, v17
v_perm_b32 v70, v46, v46, v18
v_perm_b32 v71, v46, v46, v19
s_nop 1
v_mfma_f32_16x16x32_bf16 v[84:87], v[68:71], v[104:107], v[84:87]
v_perm_b32 v72, v26, v26, v20
v_perm_b32 v73, v26, v26, v21
v_perm_b32 v74, v26, v26, v22
v_perm_b32 v75, v26, v26, v23
s_nop 1
v_mfma_f32_16x16x32_bf16 v[80:83], v[72:75], v[108:111], v[80:83]
v_perm_b32 v76, v46, v46, v20
v_perm_b32 v77, v46, v46, v21
v_perm_b32 v78, v46, v46, v22
v_perm_b32 v79, v46, v46, v23
s_nop 1
v_mfma_f32_16x16x32_bf16 v[84:87], v[76:79], v[108:111], v[84:87]
v_perm_b32 v64, v27, v27, v16
v_perm_b32 v65, v27, v27, v17
v_perm_b32 v66, v27, v27, v18
v_perm_b32 v67, v27, v27, v19
s_nop 1
v_mfma_f32_16x16x32_bf16 v[80:83], v[64:67], v[112:115], v[80:83]
v_perm_b32 v68, v47, v47, v16
v_perm_b32 v69, v47, v47, v17
v_perm_b32 v70, v47, v47, v18
v_perm_b32 v71, v47, v47, v19
s_nop 1
v_mfma_f32_16x16x32_bf16 v[84:87], v[68:71], v[112:115], v[84:87]
v_perm_b32 v72, v27, v27, v20
v_perm_b32 v73, v27, v27, v21
v_perm_b32 v74, v27, v27, v22
v_perm_b32 v75, v27, v27, v23
s_nop 1
v_mfma_f32_16x16x32_bf16 v[80:83], v[72:75], v[116:119], v[80:83]
v_perm_b32 v76, v47, v47, v20
v_perm_b32 v77, v47, v47, v21
v_perm_b32 v78, v47, v47, v22
v_perm_b32 v79, v47, v47, v23
s_nop 1
v_mfma_f32_16x16x32_bf16 v[84:87], v[76:79], v[116:119], v[84:87]
v_perm_b32 v64, v28, v28, v16
v_perm_b32 v65, v28, v28, v17
v_perm_b32 v66, v28, v28, v18
v_perm_b32 v67, v28, v28, v19
s_nop 1
v_mfma_f32_16x16x32_bf16 v[80:83], v[64:67], v[120:123], v[80:83]
v_perm_b32 v68, v48, v48, v16
v_perm_b32 v69, v48, v48, v17
v_perm_b32 v70, v48, v48, v18
v_perm_b32 v71, v48, v48, v19
s_nop 1
v_mfma_f32_16x16x32_bf16 v[84:87], v[68:71], v[120:123], v[84:87]
v_perm_b32 v72, v28, v28, v20
v_perm_b32 v73, v28, v28, v21
v_perm_b32 v74, v28, v28, v22
v_perm_b32 v75, v28, v28, v23
s_nop 1
v_mfma_f32_16x16x32_bf16 v[80:83], v[72:75], v[124:127], v[80:83]
v_perm_b32 v76, v48, v48, v20
v_perm_b32 v77, v48, v48, v21
v_perm_b32 v78, v48, v48, v22
v_perm_b32 v79, v48, v48, v23
s_nop 1
v_mfma_f32_16x16x32_bf16 v[84:87], v[76:79], v[124:127], v[84:87]
v_perm_b32 v64, v29, v29, v16
v_perm_b32 v65, v29, v29, v17
v_perm_b32 v66, v29, v29, v18
v_perm_b32 v67, v29, v29, v19
s_nop 1
v_mfma_f32_16x16x32_bf16 v[80:83], v[64:67], v[128:131], v[80:83]
v_perm_b32 v68, v49, v49, v16
v_perm_b32 v69, v49, v49, v17
v_perm_b32 v70, v49, v49, v18
v_perm_b32 v71, v49, v49, v19
s_nop 1
v_mfma_f32_16x16x32_bf16 v[84:87], v[68:71], v[128:131], v[84:87]
v_perm_b32 v72, v29, v29, v20
v_perm_b32 v73, v29, v29, v21
v_perm_b32 v74, v29, v29, v22
v_perm_b32 v75, v29, v29, v23
s_nop 1
v_mfma_f32_16x16x32_bf16 v[80:83], v[72:75], v[132:135], v[80:83]
v_perm_b32 v76, v49, v49, v20
v_perm_b32 v77, v49, v49, v21
v_perm_b32 v78, v49, v49, v22
v_perm_b32 v79, v49, v49, v23
s_nop 1
v_mfma_f32_16x16x32_bf16 v[84:87], v[76:79], v[132:135], v[84:87]
v_perm_b32 v64, v30, v30, v16
v_perm_b32 v65, v30, v30, v17
v_perm_b32 v66, v30, v30, v18
v_perm_b32 v67, v30, v30, v19
s_nop 1
v_mfma_f32_16x16x32_bf16 v[80:83], v[64:67], v[136:139], v[80:83]
v_perm_b32 v68, v50, v50, v16
v_perm_b32 v69, v50, v50, v17
v_perm_b32 v70, v50, v50, v18
v_perm_b32 v71, v50, v50, v19
s_nop 1
v_mfma_f32_16x16x32_bf16 v[84:87], v[68:71], v[136:139], v[84:87]
v_perm_b32 v72, v30, v30, v20
v_perm_b32 v73, v30, v30, v21
v_perm_b32 v74, v30, v30, v22
v_perm_b32 v75, v30, v30, v23
s_nop 1
v_mfma_f32_16x16x32_bf16 v[80:83], v[72:75], v[140:143], v[80:83]
v_perm_b32 v76, v50, v50, v20
v_perm_b32 v77, v50, v50, v21
v_perm_b32 v78, v50, v50, v22
v_perm_b32 v79, v50, v50, v23
s_nop 1
v_mfma_f32_16x16x32_bf16 v[84:87], v[76:79], v[140:143], v[84:87]
v_perm_b32 v64, v31, v31, v16
v_perm_b32 v65, v31, v31, v17
v_perm_b32 v66, v31, v31, v18
v_perm_b32 v67, v31, v31, v19
s_nop 1
v_mfma_f32_16x16x32_bf16 v[80:83], v[64:67], v[144:147], v[80:83]
v_perm_b32 v68, v51, v51, v16
v_perm_b32 v69, v51, v51, v17
v_perm_b32 v70, v51, v51, v18
v_perm_b32 v71, v51, v51, v19
s_nop 1
v_mfma_f32_16x16x32_bf16 v[84:87], v[68:71], v[144:147], v[84:87]
v_perm_b32 v72, v31, v31, v20
v_perm_b32 v73, v31, v31, v21
v_perm_b32 v74, v31, v31, v22
v_perm_b32 v75, v31, v31, v23
s_nop 1
v_mfma_f32_16x16x32_bf16 v[80:83], v[72:75], v[148:151], v[80:83]
v_perm_b32 v76, v51, v51, v20
v_perm_b32 v77, v51, v51, v21
v_perm_b32 v78, v51, v51, v22
v_perm_b32 v79, v51, v51, v23
s_nop 1
v_mfma_f32_16x16x32_bf16 v[84:87], v[76:79], v[148:151], v[84:87]
v_perm_b32 v64, v32, v32, v16
v_perm_b32 v65, v32, v32, v17
v_perm_b32 v66, v32, v32, v18
v_perm_b32 v67, v32, v32, v19
s_nop 1
v_mfma_f32_16x16x32_bf16 v[80:83], v[64:67], v[152:155], v[80:83]
v_perm_b32 v68, v52, v52, v16
v_perm_b32 v69, v52, v52, v17
v_perm_b32 v70, v52, v52, v18
v_perm_b32 v71, v52, v52, v19
s_nop 1
v_mfma_f32_16x16x32_bf16 v[84:87], v[68:71], v[152:155], v[84:87]
v_perm_b32 v72, v32, v32, v20
v_perm_b32 v73, v32, v32, v21
v_perm_b32 v74, v32, v32, v22
v_perm_b32 v75, v32, v32, v23
s_nop 1
v_mfma_f32_16x16x32_bf16 v[80:83], v[72:75], v[156:159], v[80:83]
v_perm_b32 v76, v52, v52, v20
v_perm_b32 v77, v52, v52, v21
v_perm_b32 v78, v52, v52, v22
v_perm_b32 v79, v52, v52, v23
s_nop 1
v_mfma_f32_16x16x32_bf16 v[84:87], v[76:79], v[156:159], v[84:87]
v_perm_b32 v64, v33, v33, v16
v_perm_b32 v65, v33, v33, v17
v_perm_b32 v66, v33, v33, v18
v_perm_b32 v67, v33, v33, v19
s_nop 1
v_mfma_f32_16x16x32_bf16 v[80:83], v[64:67], v[160:163], v[80:83]
v_perm_b32 v68, v53, v53, v16
v_perm_b32 v69, v53, v53, v17
v_perm_b32 v70, v53, v53, v18
v_perm_b32 v71, v53, v53, v19
s_nop 1
v_mfma_f32_16x16x32_bf16 v[84:87], v[68:71], v[160:163], v[84:87]
v_perm_b32 v72, v33, v33, v20
v_perm_b32 v73, v33, v33, v21
v_perm_b32 v74, v33, v33, v22
v_perm_b32 v75, v33, v33, v23
s_nop 1
v_mfma_f32_16x16x32_bf16 v[80:83], v[72:75], v[164:167], v[80:83]
v_perm_b32 v76, v53, v53, v20
v_perm_b32 v77, v53, v53, v21
v_perm_b32 v78, v53, v53, v22
v_perm_b32 v79, v53, v53, v23
s_nop 1
v_mfma_f32_16x16x32_bf16 v[84:87], v[76:79], v[164:167], v[84:87]
v_perm_b32 v64, v34, v34, v16
v_perm_b32 v65, v34, v34, v17
v_perm_b32 v66, v34, v34, v18
v_perm_b32 v67, v34, v34, v19
s_nop 1
v_mfma_f32_16x16x32_bf16 v[80:83], v[64:67], v[168:171], v[80:83]
v_perm_b32 v68, v54, v54, v16
v_perm_b32 v69, v54, v54, v17
v_perm_b32 v70, v54, v54, v18
v_perm_b32 v71, v54, v54, v19
s_nop 1
v_mfma_f32_16x16x32_bf16 v[84:87], v[68:71], v[168:171], v[84:87]
v_perm_b32 v72, v34, v34, v20
v_perm_b32 v73, v34, v34, v21
v_perm_b32 v74, v34, v34, v22
v_perm_b32 v75, v34, v34, v23
s_nop 1
v_mfma_f32_16x16x32_bf16 v[80:83], v[72:75], v[172:175], v[80:83]
v_perm_b32 v76, v54, v54, v20
v_perm_b32 v77, v54, v54, v21
v_perm_b32 v78, v54, v54, v22
v_perm_b32 v79, v54, v54, v23
s_nop 1
v_mfma_f32_16x16x32_bf16 v[84:87], v[76:79], v[172:175], v[84:87]
v_perm_b32 v64, v35, v35, v16
v_perm_b32 v65, v35, v35, v17
v_perm_b32 v66, v35, v35, v18
v_perm_b32 v67, v35, v35, v19
s_nop 1
v_mfma_f32_16x16x32_bf16 v[80:83], v[64:67], v[176:179], v[80:83]
v_perm_b32 v68, v55, v55, v16
v_perm_b32 v69, v55, v55, v17
v_perm_b32 v70, v55, v55, v18
v_perm_b32 v71, v55, v55, v19
s_nop 1
v_mfma_f32_16x16x32_bf16 v[84:87], v[68:71], v[176:179], v[84:87]
v_perm_b32 v72, v35, v35, v20
v_perm_b32 v73, v35, v35, v21
v_perm_b32 v74, v35, v35, v22
v_perm_b32 v75, v35, v35, v23
s_nop 1
v_mfma_f32_16x16x32_bf16 v[80:83], v[72:75], v[180:183], v[80:83]
v_perm_b32 v76, v55, v55, v20
v_perm_b32 v77, v55, v55, v21
v_perm_b32 v78, v55, v55, v22
v_perm_b32 v79, v55, v55, v23
s_nop 1
v_mfma_f32_16x16x32_bf16 v[84:87], v[76:79], v[180:183], v[84:87]
v_perm_b32 v64, v36, v36, v16
v_perm_b32 v65, v36, v36, v17
v_perm_b32 v66, v36, v36, v18
v_perm_b32 v67, v36, v36, v19
s_nop 1
v_mfma_f32_16x16x32_bf16 v[80:83], v[64:67], v[184:187], v[80:83]
v_perm_b32 v68, v56, v56, v16
v_perm_b32 v69, v56, v56, v17
v_perm_b32 v70, v56, v56, v18
v_perm_b32 v71, v56, v56, v19
s_nop 1
v_mfma_f32_16x16x32_bf16 v[84:87], v[68:71], v[184:187], v[84:87]
v_perm_b32 v72, v36, v36, v20
v_perm_b32 v73, v36, v36, v21
v_perm_b32 v74, v36, v36, v22
v_perm_b32 v75, v36, v36, v23
s_nop 1
v_mfma_f32_16x16x32_bf16 v[80:83], v[72:75], v[188:191], v[80:83]
v_perm_b32 v76, v56, v56, v20
v_perm_b32 v77, v56, v56, v21
v_perm_b32 v78, v56, v56, v22
v_perm_b32 v79, v56, v56, v23
s_nop 1
v_mfma_f32_16x16x32_bf16 v[84:87], v[76:79], v[188:191], v[84:87]
v_perm_b32 v64, v37, v37, v16
v_perm_b32 v65, v37, v37, v17
v_perm_b32 v66, v37, v37, v18
v_perm_b32 v67, v37, v37, v19
s_nop 1
v_mfma_f32_16x16x32_bf16 v[80:83], v[64:67], v[192:195], v[80:83]
v_perm_b32 v68, v57, v57, v16
v_perm_b32 v69, v57, v57, v17
v_perm_b32 v70, v57, v57, v18
v_perm_b32 v71, v57, v57, v19
s_nop 1
v_mfma_f32_16x16x32_bf16 v[84:87], v[68:71], v[192:195], v[84:87]
v_perm_b32 v72, v37, v37, v20
v_perm_b32 v73, v37, v37, v21
v_perm_b32 v74, v37, v37, v22
v_perm_b32 v75, v37, v37, v23
s_nop 1
v_mfma_f32_16x16x32_bf16 v[80:83], v[72:75], v[196:199], v[80:83]
v_perm_b32 v76, v57, v57, v20
v_perm_b32 v77, v57, v57, v21
v_perm_b32 v78, v57, v57, v22
v_perm_b32 v79, v57, v57, v23
s_nop 1
v_mfma_f32_16x16x32_bf16 v[84:87], v[76:79], v[196:199], v[84:87]
v_perm_b32 v64, v38, v38, v16
v_perm_b32 v65, v38, v38, v17
v_perm_b32 v66, v38, v38, v18
v_perm_b32 v67, v38, v38, v19
s_nop 1
v_mfma_f32_16x16x32_bf16 v[80:83], v[64:67], v[200:203], v[80:83]
v_perm_b32 v68, v58, v58, v16
v_perm_b32 v69, v58, v58, v17
v_perm_b32 v70, v58, v58, v18
v_perm_b32 v71, v58, v58, v19
s_nop 1
v_mfma_f32_16x16x32_bf16 v[84:87], v[68:71], v[200:203], v[84:87]
v_perm_b32 v72, v38, v38, v20
v_perm_b32 v73, v38, v38, v21
v_perm_b32 v74, v38, v38, v22
v_perm_b32 v75, v38, v38, v23
s_nop 1
v_mfma_f32_16x16x32_bf16 v[80:83], v[72:75], v[204:207], v[80:83]
v_perm_b32 v76, v58, v58, v20
v_perm_b32 v77, v58, v58, v21
v_perm_b32 v78, v58, v58, v22
v_perm_b32 v79, v58, v58, v23
s_nop 1
v_mfma_f32_16x16x32_bf16 v[84:87], v[76:79], v[204:207], v[84:87]
v_perm_b32 v64, v39, v39, v16
v_perm_b32 v65, v39, v39, v17
v_perm_b32 v66, v39, v39, v18
v_perm_b32 v67, v39, v39, v19
s_nop 1
v_mfma_f32_16x16x32_bf16 v[80:83], v[64:67], v[208:211], v[80:83]
v_perm_b32 v68, v59, v59, v16
v_perm_b32 v69, v59, v59, v17
v_perm_b32 v70, v59, v59, v18
v_perm_b32 v71, v59, v59, v19
s_nop 1
v_mfma_f32_16x16x32_bf16 v[84:87], v[68:71], v[208:211], v[84:87]
v_perm_b32 v72, v39, v39, v20
v_perm_b32 v73, v39, v39, v21
v_perm_b32 v74, v39, v39, v22
v_perm_b32 v75, v39, v39, v23
s_nop 1
v_mfma_f32_16x16x32_bf16 v[80:83], v[72:75], v[212:215], v[80:83]
v_perm_b32 v76, v59, v59, v20
v_perm_b32 v77, v59, v59, v21
v_perm_b32 v78, v59, v59, v22
v_perm_b32 v79, v59, v59, v23
s_nop 1
v_mfma_f32_16x16x32_bf16 v[84:87], v[76:79], v[212:215], v[84:87]
s_nop 0
v_cvt_pk_bf16_f32 v244, v80, v81
v_cvt_pk_bf16_f32 v245, v82, v83
ds_write_b64 v5, v[244:245] offset:0
s_nop 3
v_cvt_pk_bf16_f32 v246, v84, v85
v_cvt_pk_bf16_f32 v247, v86, v87
ds_write_b64 v5, v[246:247] offset:2176
s_waitcnt lgkmcnt(0)
s_barrier
ds_read_b128 v[64:67], v7 offset:0
ds_read_b128 v[68:71], v7 offset:64
ds_read_b128 v[72:75], v7 offset:128
ds_read_b128 v[76:79], v7 offset:192
v_mul_u32_u24 v5, 36864, v9
v_lshl_add_u32 v5, v8, 4, v5
s_mul_i32 s6, s4, 1152
s_add_u32 s6, s6, 5242880
s_lshl_b32 s7, s3, 5
v_add_u32 v6, s7, v5
s_lshl_b32 s7, s3, 8
v_add_u32 v5, s7, v5
s_waitcnt lgkmcnt(0)
v_mfma_f32_16x16x32_bf16 v[24:27], v[64:67], a[96:99], 0
v_mfma_f32_16x16x32_bf16 v[24:27], v[68:71], a[100:103], v[24:27]
v_mfma_f32_16x16x32_bf16 v[24:27], v[72:75], a[104:107], v[24:27]
v_mfma_f32_16x16x32_bf16 v[24:27], v[76:79], a[108:111], v[24:27]
v_mfma_f32_16x16x32_bf16 v[28:31], v[64:67], a[112:115], 0
v_mfma_f32_16x16x32_bf16 v[28:31], v[68:71], a[116:119], v[28:31]
v_mfma_f32_16x16x32_bf16 v[28:31], v[72:75], a[120:123], v[28:31]
v_mfma_f32_16x16x32_bf16 v[28:31], v[76:79], a[124:127], v[28:31]
v_mfma_f32_16x16x32_bf16 v[32:35], v[64:67], a[128:131], 0
v_mfma_f32_16x16x32_bf16 v[32:35], v[68:71], a[132:135], v[32:35]
v_mfma_f32_16x16x32_bf16 v[32:35], v[72:75], a[136:139], v[32:35]
v_mfma_f32_16x16x32_bf16 v[32:35], v[76:79], a[140:143], v[32:35]
v_mfma_f32_16x16x32_bf16 v[36:39], v[64:67], a[144:147], 0
v_mfma_f32_16x16x32_bf16 v[36:39], v[68:71], a[148:151], v[36:39]
v_mfma_f32_16x16x32_bf16 v[36:39], v[72:75], a[152:155], v[36:39]
v_mfma_f32_16x16x32_bf16 v[36:39], v[76:79], a[156:159], v[36:39]
v_mfma_f32_16x16x32_bf16 v[40:43], v[64:67], a[160:163], 0
v_mfma_f32_16x16x32_bf16 v[40:43], v[68:71], a[164:167], v[40:43]
v_mfma_f32_16x16x32_bf16 v[40:43], v[72:75], a[168:171], v[40:43]
v_mfma_f32_16x16x32_bf16 v[40:43], v[76:79], a[172:175], v[40:43]
v_mfma_f32_16x16x32_bf16 v[44:47], v[64:67], a[176:179], 0
v_mfma_f32_16x16x32_bf16 v[44:47], v[68:71], a[180:183], v[44:47]
v_mfma_f32_16x16x32_bf16 v[44:47], v[72:75], a[184:187], v[44:47]
v_mfma_f32_16x16x32_bf16 v[44:47], v[76:79], a[188:191], v[44:47]
v_mfma_f32_16x16x32_bf16 v[48:51], v[64:67], a[192:195], 0
v_mfma_f32_16x16x32_bf16 v[48:51], v[68:71], a[196:199], v[48:51]
v_mfma_f32_16x16x32_bf16 v[48:51], v[72:75], a[200:203], v[48:51]
v_mfma_f32_16x16x32_bf16 v[48:51], v[76:79], a[204:207], v[48:51]
v_mfma_f32_16x16x32_bf16 v[52:55], v[64:67], a[208:211], 0
v_mfma_f32_16x16x32_bf16 v[52:55], v[68:71], a[212:215], v[52:55]
v_mfma_f32_16x16x32_bf16 v[52:55], v[72:75], a[216:219], v[52:55]
v_mfma_f32_16x16x32_bf16 v[52:55], v[76:79], a[220:223], v[52:55]
v_mfma_f32_16x16x32_bf16 v[56:59], v[64:67], a[224:227], 0
v_mfma_f32_16x16x32_bf16 v[56:59], v[68:71], a[228:231], v[56:59]
v_mfma_f32_16x16x32_bf16 v[56:59], v[72:75], a[232:235], v[56:59]
v_mfma_f32_16x16x32_bf16 v[56:59], v[76:79], a[236:239], v[56:59]
v_add_f32 v24, v24, v25
v_add_f32 v26, v26, v27
v_add_f32 v216, v24, v26
v_min_u32 v216, -2, v216
v_add_f32 v28, v28, v29
v_add_f32 v30, v30, v31
v_add_f32 v217, v28, v30
v_min_u32 v217, -2, v217
v_add_f32 v32, v32, v33
v_add_f32 v34, v34, v35
v_add_f32 v218, v32, v34
v_min_u32 v218, -2, v218
v_add_f32 v36, v36, v37
v_add_f32 v38, v38, v39
v_add_f32 v219, v36, v38
v_min_u32 v219, -2, v219
v_add_f32 v40, v40, v41
v_add_f32 v42, v42, v43
v_add_f32 v220, v40, v42
v_min_u32 v220, -2, v220
v_add_f32 v44, v44, v45
v_add_f32 v46, v46, v47
v_add_f32 v221, v44, v46
v_min_u32 v221, -2, v221
v_add_f32 v48, v48, v49
v_add_f32 v50, v50, v51
v_add_f32 v222, v48, v50
v_min_u32 v222, -2, v222
v_add_f32 v52, v52, v53
v_add_f32 v54, v54, v55
v_add_f32 v223, v52, v54
v_min_u32 v223, -2, v223
v_add_f32 v56, v56, v57
v_add_f32 v58, v58, v59
v_add_f32 v224, v56, v58
v_min_u32 v224, -2, v224
v_cvt_pk_bf16_f32 v216, v216, v217
v_min_u32 v216, -2, v216
v_cvt_pk_bf16_f32 v217, v218, v219
v_min_u32 v217, -2, v217
v_cvt_pk_bf16_f32 v218, v220, v221
v_min_u32 v218, -2, v218
v_cvt_pk_bf16_f32 v219, v222, v223
v_min_u32 v219, -2, v219
buffer_store_dwordx4 v[216:219], v5, s[64:67], s6 offen sc1
v_mov_b32_dpp v229, v224 row_shl:2 row_mask:0xf bank_mask:0xf
v_cvt_pk_bf16_f32 v228, v224, v229
v_min_u32 v228, -2, v228
s_nop 1
v_mov_b32_dpp v229, v228 row_shl:4 row_mask:0xf bank_mask:0xf
v_mov_b32_dpp v230, v228 row_shl:8 row_mask:0xf bank_mask:0xf
v_mov_b32_dpp v231, v228 row_shl:12 row_mask:0xf bank_mask:0xf
s_mov_b32 exec_lo, 0x00030003
s_mov_b32 exec_hi, 196611
buffer_store_dwordx4 v[228:231], v6, s[64:67], s6 offen offset:1024 sc1
s_mov_b64 exec, -1
s_nop 1
s_branch B_final
D_role:
s_mov_b32 s8, s5
s_lshl_b32 s9, s4, 1
s_add_u32 s9, s9, s8
v_and_b32 v1, 63, v0
v_lshlrev_b32 v2, 4, v1
v_lshrrev_b32 v9, 4, v1
v_and_b32 v8, 15, v1
s_lshr_b32 s10, s4, 3
s_lshr_b32 s80, s4, 0
s_and_b32 s11, s80, 7
v_xor_b32 v10, 32, v2
v_mov_b32 v76, -1
v_mov_b32 v77, -1
v_mov_b32 v78, -1
v_mov_b32 v79, -1
s_waitcnt lgkmcnt(0)
s_mov_b32 s64, s42
s_mov_b32 s65, s43
s_mov_b32 s66, 16777216
s_mov_b32 s67, 0x20000
s_lshl_b32 s6, s10, 22
s_add_u32 s52, s28, s6
s_addc_u32 s53, s29, 0
s_mov_b32 s54, 4194304
s_mov_b32 s55, 0x20000
s_cmp_eq_u32 s3, 3
s_cbranch_scc1 L_clr3_17
s_mul_i32 s6, s4, 9216
s_mul_i32 s7, s3, 4608
s_add_u32 s6, s6, s7
s_add_u32 s6, s6, 4194304
s_mul_i32 s7, s4, 4608
s_add_u32 s7, s7, 5242880
s_cmp_eq_u32 s3, 2
s_cselect_b32 s6, s7, s6
buffer_store_dwordx4 v[76:79], v2, s[64:67], s6 offen offset:0 sc1
buffer_store_dwordx4 v[76:79], v2, s[64:67], s6 offen offset:1024 sc1
buffer_store_dwordx4 v[76:79], v2, s[64:67], s6 offen offset:2048 sc1
buffer_store_dwordx4 v[76:79], v2, s[64:67], s6 offen offset:3072 sc1
s_add_u32 s6, s6, 4096
s_mov_b64 exec, 0xffffffff
buffer_store_dwordx4 v[76:79], v2, s[64:67], s6 offen offset:0 sc1
s_mov_b64 exec, -1
s_branch L_clrd_18
L_clr3_17:
s_mul_i32 s6, s4, 4096
s_add_u32 s6, s6, 0
buffer_store_dwordx4 v[76:79], v2, s[64:67], s6 offen offset:0 sc1
buffer_store_dwordx4 v[76:79], v2, s[64:67], s6 offen offset:1024 sc1
buffer_store_dwordx4 v[76:79], v2, s[64:67], s6 offen offset:2048 sc1
buffer_store_dwordx4 v[76:79], v2, s[64:67], s6 offen offset:3072 sc1
s_mov_b64 exec, 0xffff
s_mul_i32 s6, s4, 256
s_mul_i32 s7, s4, 256
s_add_u32 s7, s7, 327680
s_add_u32 s6, s6, 262144
v_lshrrev_b32 v6, 2, v1
v_mul_u32_u24 v6, 0, v6
v_add_u32 v6, v6, v2
buffer_store_dwordx4 v[76:79], v2, s[64:67], s6 offen sc1
buffer_store_dwordx4 v[76:79], v6, s[64:67], s7 offen sc1
s_mov_b64 exec, 3
s_mul_i32 s6, s4, 32
s_add_u32 s6, s6, 393216
s_lshr_b32 s7, s4, 2
s_mul_i32 s7, s7, 4224
s_add_u32 s6, s6, s7
v_mul_u32_u24 v5, 16, v1
buffer_store_dwordx4 v[76:79], v5, s[64:67], s6 offen sc1
s_mov_b64 exec, -1
L_clrd_18:
s_mov_b32 s68, s40
s_mov_b32 s69, s41
s_mov_b32 s70, 256
s_mov_b32 s71, 0x20000
s_mov_b32 s72, s38
s_mov_b32 s73, s39
s_mov_b32 s74, 9216
s_mov_b32 s75, 0x20000
s_mul_i32 s12, s3, 17408
s_lshl_b32 s13, s11, 2
s_add_u32 s13, s13, s3
s_lshl_b32 s13, s13, 12
s_add_u32 m0, s12, 0
s_add_u32 s6, s13, 0
buffer_load_dwordx4 v2, s[52:55], s6 offen nt lds
s_add_u32 m0, s12, 1088
s_add_u32 s6, s13, 1024
buffer_load_dwordx4 v2, s[52:55], s6 offen nt lds
s_add_u32 m0, s12, 2176
s_add_u32 s6, s13, 2048
buffer_load_dwordx4 v2, s[52:55], s6 offen nt lds
s_add_u32 m0, s12, 3264
s_add_u32 s6, s13, 3072
buffer_load_dwordx4 v2, s[52:55], s6 offen nt lds
s_add_u32 m0, s12, 4352
s_add_u32 s6, s13, 131072
buffer_load_dwordx4 v2, s[52:55], s6 offen nt lds
s_add_u32 m0, s12, 5440
s_add_u32 s6, s13, 132096
buffer_load_dwordx4 v2, s[52:55], s6 offen nt lds
s_add_u32 m0, s12, 6528
s_add_u32 s6, s13, 133120
buffer_load_dwordx4 v2, s[52:55], s6 offen nt lds
s_add_u32 m0, s12, 7616
s_add_u32 s6, s13, 134144
buffer_load_dwordx4 v2, s[52:55], s6 offen nt lds
s_waitcnt vmcnt(8)
s_barrier
s_cmp_lg_u32 s3, 0
s_cbranch_scc1 D_nosig
v_mov_b32 v7, 1
s_mov_b64 exec, 1
buffer_atomic_add v7, off, s[68:71], 0 offset:0
s_mov_b64 exec, -1
D_nosig:
s_add_u32 m0, s12, 8704
s_add_u32 s6, s13, 262144
s_waitcnt vmcnt(5)
buffer_load_dwordx4 v10, s[52:55], s6 offen nt lds
s_add_u32 m0, s12, 9792
s_add_u32 s6, s13, 263168
s_waitcnt vmcnt(5)
buffer_load_dwordx4 v10, s[52:55], s6 offen nt lds
s_add_u32 m0, s12, 10880
s_add_u32 s6, s13, 264192
s_waitcnt vmcnt(5)
buffer_load_dwordx4 v10, s[52:55], s6 offen nt lds
s_add_u32 m0, s12, 11968
s_add_u32 s6, s13, 265216
s_waitcnt vmcnt(5)
buffer_load_dwordx4 v10, s[52:55], s6 offen nt lds
s_add_u32 m0, s12, 13056
s_add_u32 s6, s13, 393216
s_waitcnt vmcnt(5)
buffer_load_dwordx4 v10, s[52:55], s6 offen nt lds
s_add_u32 m0, s12, 14144
s_add_u32 s6, s13, 394240
s_waitcnt vmcnt(5)
buffer_load_dwordx4 v10, s[52:55], s6 offen nt lds
s_add_u32 m0, s12, 15232
s_add_u32 s6, s13, 395264
s_waitcnt vmcnt(5)
buffer_load_dwordx4 v10, s[52:55], s6 offen nt lds
s_add_u32 m0, s12, 16320
s_add_u32 s6, s13, 396288
s_waitcnt vmcnt(5)
buffer_load_dwordx4 v10, s[52:55], s6 offen nt lds
s_add_u32 m0, s12, 69632
s_add_u32 s6, s13, 524288
s_waitcnt vmcnt(5)
buffer_load_dwordx4 v2, s[52:55], s6 offen nt lds
s_add_u32 m0, s12, 70720
s_add_u32 s6, s13, 525312
s_waitcnt vmcnt(5)
buffer_load_dwordx4 v2, s[52:55], s6 offen nt lds
s_add_u32 m0, s12, 71808
s_add_u32 s6, s13, 526336
s_waitcnt vmcnt(5)
buffer_load_dwordx4 v2, s[52:55], s6 offen nt lds
s_add_u32 m0, s12, 72896
s_add_u32 s6, s13, 527360
s_waitcnt vmcnt(5)
buffer_load_dwordx4 v2, s[52:55], s6 offen nt lds
s_add_u32 m0, s12, 73984
s_add_u32 s6, s13, 655360
s_waitcnt vmcnt(5)
buffer_load_dwordx4 v2, s[52:55], s6 offen nt lds
s_add_u32 m0, s12, 75072
s_add_u32 s6, s13, 656384
s_waitcnt vmcnt(5)
buffer_load_dwordx4 v2, s[52:55], s6 offen nt lds
s_add_u32 m0, s12, 76160
s_add_u32 s6, s13, 657408
s_waitcnt vmcnt(5)
buffer_load_dwordx4 v2, s[52:55], s6 offen nt lds
s_add_u32 m0, s12, 77248
s_add_u32 s6, s13, 658432
s_waitcnt vmcnt(5)
buffer_load_dwordx4 v2, s[52:55], s6 offen nt lds
s_add_u32 m0, s12, 78336
s_add_u32 s6, s13, 786432
s_waitcnt vmcnt(5)
buffer_load_dwordx4 v10, s[52:55], s6 offen nt lds
s_add_u32 m0, s12, 79424
s_add_u32 s6, s13, 787456
s_waitcnt vmcnt(5)
buffer_load_dwordx4 v10, s[52:55], s6 offen nt lds
s_add_u32 m0, s12, 80512
s_add_u32 s6, s13, 788480
s_waitcnt vmcnt(5)
buffer_load_dwordx4 v10, s[52:55], s6 offen nt lds
s_add_u32 m0, s12, 81600
s_add_u32 s6, s13, 789504
s_waitcnt vmcnt(5)
buffer_load_dwordx4 v10, s[52:55], s6 offen nt lds
s_add_u32 m0, s12, 82688
s_add_u32 s6, s13, 917504
s_waitcnt vmcnt(5)
buffer_load_dwordx4 v10, s[52:55], s6 offen nt lds
s_add_u32 m0, s12, 83776
s_add_u32 s6, s13, 918528
s_waitcnt vmcnt(5)
buffer_load_dwordx4 v10, s[52:55], s6 offen nt lds
s_add_u32 m0, s12, 84864
s_add_u32 s6, s13, 919552
s_waitcnt vmcnt(5)
buffer_load_dwordx4 v10, s[52:55], s6 offen nt lds
s_add_u32 m0, s12, 85952
s_add_u32 s6, s13, 920576
s_waitcnt vmcnt(5)
buffer_load_dwordx4 v10, s[52:55], s6 offen nt lds
s_add_u32 s6, s13, 1048576
s_waitcnt vmcnt(5)
buffer_load_dwordx4 a[128:131], v2, s[52:55], s6 offen nt
s_add_u32 s6, s13, 1049600
s_waitcnt vmcnt(5)
buffer_load_dwordx4 a[132:135], v2, s[52:55], s6 offen nt
s_add_u32 s6, s13, 1050624
s_waitcnt vmcnt(5)
buffer_load_dwordx4 a[136:139], v2, s[52:55], s6 offen nt
s_add_u32 s6, s13, 1051648
s_waitcnt vmcnt(5)
buffer_load_dwordx4 a[140:143], v2, s[52:55], s6 offen nt
s_add_u32 s6, s13, 1179648
s_waitcnt vmcnt(5)
buffer_load_dwordx4 a[144:147], v2, s[52:55], s6 offen nt
s_add_u32 s6, s13, 1180672
s_waitcnt vmcnt(5)
buffer_load_dwordx4 a[148:151], v2, s[52:55], s6 offen nt
s_add_u32 s6, s13, 1181696
s_waitcnt vmcnt(5)
buffer_load_dwordx4 a[152:155], v2, s[52:55], s6 offen nt
s_add_u32 s6, s13, 1182720
s_waitcnt vmcnt(5)
buffer_load_dwordx4 a[156:159], v2, s[52:55], s6 offen nt
s_add_u32 s6, s13, 1310720
s_waitcnt vmcnt(5)
buffer_load_dwordx4 a[160:163], v10, s[52:55], s6 offen nt
s_add_u32 s6, s13, 1311744
s_waitcnt vmcnt(5)
buffer_load_dwordx4 a[164:167], v10, s[52:55], s6 offen nt
s_add_u32 s6, s13, 1312768
s_waitcnt vmcnt(5)
buffer_load_dwordx4 a[168:171], v10, s[52:55], s6 offen nt
s_add_u32 s6, s13, 1313792
s_waitcnt vmcnt(5)
buffer_load_dwordx4 a[172:175], v10, s[52:55], s6 offen nt
s_add_u32 s6, s13, 1441792
s_waitcnt vmcnt(5)
buffer_load_dwordx4 a[176:179], v10, s[52:55], s6 offen nt
s_add_u32 s6, s13, 1442816
s_waitcnt vmcnt(5)
buffer_load_dwordx4 a[180:183], v10, s[52:55], s6 offen nt
s_add_u32 s6, s13, 1443840
s_waitcnt vmcnt(5)
buffer_load_dwordx4 a[184:187], v10, s[52:55], s6 offen nt
s_add_u32 s6, s13, 1444864
s_waitcnt vmcnt(5)
buffer_load_dwordx4 a[188:191], v10, s[52:55], s6 offen nt
s_add_u32 s6, s13, 1572864
s_waitcnt vmcnt(5)
buffer_load_dwordx4 a[192:195], v2, s[52:55], s6 offen nt
s_add_u32 s6, s13, 1573888
s_waitcnt vmcnt(5)
buffer_load_dwordx4 a[196:199], v2, s[52:55], s6 offen nt
s_add_u32 s6, s13, 1574912
s_waitcnt vmcnt(5)
buffer_load_dwordx4 a[200:203], v2, s[52:55], s6 offen nt
s_add_u32 s6, s13, 1575936
s_waitcnt vmcnt(5)
buffer_load_dwordx4 a[204:207], v2, s[52:55], s6 offen nt
s_add_u32 s6, s13, 1703936
s_waitcnt vmcnt(5)
buffer_load_dwordx4 a[208:211], v2, s[52:55], s6 offen nt
s_add_u32 s6, s13, 1704960
s_waitcnt vmcnt(5)
buffer_load_dwordx4 a[212:215], v2, s[52:55], s6 offen nt
s_add_u32 s6, s13, 1705984
s_waitcnt vmcnt(5)
buffer_load_dwordx4 a[216:219], v2, s[52:55], s6 offen nt
s_add_u32 s6, s13, 1707008
s_waitcnt vmcnt(5)
buffer_load_dwordx4 a[220:223], v2, s[52:55], s6 offen nt
s_add_u32 s6, s13, 1835008
s_waitcnt vmcnt(5)
buffer_load_dwordx4 a[224:227], v10, s[52:55], s6 offen nt
s_add_u32 s6, s13, 1836032
s_waitcnt vmcnt(5)
buffer_load_dwordx4 a[228:231], v10, s[52:55], s6 offen nt
s_add_u32 s6, s13, 1837056
s_waitcnt vmcnt(5)
buffer_load_dwordx4 a[232:235], v10, s[52:55], s6 offen nt
s_add_u32 s6, s13, 1838080
s_waitcnt vmcnt(5)
buffer_load_dwordx4 a[236:239], v10, s[52:55], s6 offen nt
s_add_u32 s6, s13, 1966080
s_waitcnt vmcnt(5)
buffer_load_dwordx4 a[240:243], v10, s[52:55], s6 offen nt
s_add_u32 s6, s13, 1967104
s_waitcnt vmcnt(5)
buffer_load_dwordx4 a[244:247], v10, s[52:55], s6 offen nt
s_add_u32 s6, s13, 1968128
s_waitcnt vmcnt(5)
buffer_load_dwordx4 a[248:251], v10, s[52:55], s6 offen nt
s_add_u32 s6, s13, 1969152
s_waitcnt vmcnt(5)
buffer_load_dwordx4 a[252:255], v10, s[52:55], s6 offen nt
buffer_load_dword v11, off, s[68:71], 0 offset:0 sc1
s_lshl_b32 s14, s10, 3
s_add_u32 s14, s14, s3
s_mul_i32 s14, s14, 4096
s_add_u32 s14, s14, 0
s_add_u32 s15, s14, 16384
s_lshl_b32 s6, s3, 4
v_add_u32 v5, s6, v8
v_mul_u32_u24 v5, 1088, v5
v_lshrrev_b32 v6, 3, v8
v_lshlrev_b32 v6, 1, v6
v_xor_b32 v6, v6, v9
v_lshl_add_u32 v194, v6, 4, v5
v_add_u32 v195, 69632, v194
v_lshrrev_b32 v5, 5, v1
v_lshlrev_b32 v5, 3, v5
v_bfe_u32 v6, v1, 2, 2
v_add_u32 v5, v5, v6
v_mul_u32_u24 v5, 1088, v5
v_lshrrev_b32 v6, 1, v9
v_xor_b32 v6, v6, v9
v_and_b32 v6, 1, v6
v_lshl_add_u32 v5, v6, 5, v5
v_and_b32 v6, 3, v1
v_lshl_add_u32 v5, v6, 3, v5
s_lshl_b32 s6, s3, 8
v_add_u32 v196, s6, v5
v_add_u32 v197, 69632, v196
v_lshlrev_b32 v199, 4, v8
v_add_u32 v199, 160256, v199
s_lshl_b32 s6, s3, 2
v_add_u32 v198, s6, v199
v_and_b32 v5, 31, v1
v_lshlrev_b32 v200, 4, v5
v_add_u32 v200, 160256, v200
v_lshlrev_b32 v202, 5, v5
v_lshrrev_b32 v6, 5, v1
v_lshl_add_u32 v202, v6, 4, v202
v_add_u32 v202, 156160, v202
v_lshlrev_b32 v201, 5, v8
v_lshl_add_u32 v201, v9, 3, v201
s_lshl_b32 s6, s3, 10
s_add_u32 s6, s6, 156160
v_add_u32 v201, s6, v201
v_mul_u32_u24 v203, 1056, v8
v_lshl_add_u32 v203, v9, 4, v203
v_add_u32 v203, 139264, v203
s_mul_i32 s6, s3, 4224
s_add_u32 s6, s6, 139264
v_add_u32 v204, s6, v2
v_add_u32 v206, s12, v2
v_add_u32 v207, 69632, v206
v_mov_b32 v185, 0x3e0293ee
v_mov_b32 v176, 0xff800000
v_mov_b32 v177, 0xff800000
v_mov_b32 v178, 0xff800000
v_mov_b32 v180, 0
v_mov_b32 v181, 0
s_waitcnt vmcnt(0)
s_mov_b32 s7, 400000
L_ens_19:
v_readfirstlane_b32 s6, v11
s_cmp_ge_u32 s6, 32
s_cbranch_scc1 L_ensd_20
s_sleep 16
buffer_load_dword v11, off, s[68:71], 0 offset:0 sc1
s_waitcnt vmcnt(0)
s_sub_u32 s7, s7, 1
s_cmp_lg_u32 s7, 0
s_cbranch_scc1 L_ens_19
L_ensd_20:
s_mov_b32 s7, 400000
v_and_b32 v5, 3, v1
v_bfe_u32 v6, v1, 2, 1
v_mul_u32_u24 v6, 16384, v6
v_lshl_add_u32 v5, v5, 10, v6
Q_slow:
buffer_load_dword v192, v5, s[64:67], s14 offen offset:768 sc1
s_waitcnt vmcnt(0)
v_cmp_eq_u32 vcc, -1, v192
s_cbranch_vccz Q_chk
s_sleep 8
s_sub_u32 s7, s7, 1
s_cmp_lg_u32 s7, 1
s_cbranch_scc1 Q_slow
Q_chk:
buffer_load_dwordx4 v[84:87], v2, s[64:67], s14 offen offset:0 sc1
buffer_load_dwordx4 v[88:91], v2, s[64:67], s14 offen offset:1024 sc1
buffer_load_dwordx4 v[92:95], v2, s[64:67], s14 offen offset:2048 sc1
buffer_load_dwordx4 v[96:99], v2, s[64:67], s14 offen offset:3072 sc1
buffer_load_dwordx4 v[100:103], v2, s[64:67], s15 offen offset:0 sc1
buffer_load_dwordx4 v[104:107], v2, s[64:67], s15 offen offset:1024 sc1
buffer_load_dwordx4 v[108:111], v2, s[64:67], s15 offen offset:2048 sc1
buffer_load_dwordx4 v[112:115], v2, s[64:67], s15 offen offset:3072 sc1
s_waitcnt vmcnt(0)
v_max3_u32 v192, v84, v85, v86
v_max3_u32 v192, v192, v87, v88
v_max3_u32 v192, v192, v89, v90
v_max3_u32 v192, v192, v91, v92
v_max3_u32 v192, v192, v93, v94
v_max3_u32 v192, v192, v95, v96
v_max3_u32 v192, v192, v97, v98
v_max3_u32 v192, v192, v99, v100
v_max3_u32 v192, v192, v101, v102
v_max3_u32 v192, v192, v103, v104
v_max3_u32 v192, v192, v105, v106
v_max3_u32 v192, v192, v107, v108
v_max3_u32 v192, v192, v109, v110
v_max3_u32 v192, v192, v111, v112
v_max3_u32 v192, v192, v113, v114
v_max_u32 v192, v192, v115
v_cmp_eq_u32 vcc, -1, v192
s_cbranch_vccz Q_ok
s_sleep 16
s_sub_u32 s7, s7, 1
s_cmp_lg_u32 s7, 0
s_cbranch_scc1 Q_chk
Q_ok:
ds_write_b128 v204, v[84:87] offset:0
ds_write_b128 v204, v[88:91] offset:1056
ds_write_b128 v204, v[92:95] offset:2112
ds_write_b128 v204, v[96:99] offset:3168
s_waitcnt lgkmcnt(0)
s_barrier
ds_read_b128 a[0:3], v203 offset:0
ds_read_b128 a[4:7], v203 offset:64
ds_read_b128 a[8:11], v203 offset:128
ds_read_b128 a[12:15], v203 offset:192
ds_read_b128 a[16:19], v203 offset:256
ds_read_b128 a[20:23], v203 offset:320
ds_read_b128 a[24:27], v203 offset:384
ds_read_b128 a[28:31], v203 offset:448
ds_read_b128 a[32:35], v203 offset:512
ds_read_b128 a[36:39], v203 offset:576
ds_read_b128 a[40:43], v203 offset:640
ds_read_b128 a[44:47], v203 offset:704
ds_read_b128 a[48:51], v203 offset:768
ds_read_b128 a[52:55], v203 offset:832
ds_read_b128 a[56:59], v203 offset:896
ds_read_b128 a[60:63], v203 offset:960
s_waitcnt lgkmcnt(0)
s_barrier
ds_write_b128 v204, v[100:103] offset:0
ds_write_b128 v204, v[104:107] offset:1056
ds_write_b128 v204, v[108:111] offset:2112
ds_write_b128 v204, v[112:115] offset:3168
s_waitcnt lgkmcnt(0)
s_barrier
ds_read_b128 a[64:67], v203 offset:0
ds_read_b128 a[68:71], v203 offset:64
ds_read_b128 a[72:75], v203 offset:128
ds_read_b128 a[76:79], v203 offset:192
ds_read_b128 a[80:83], v203 offset:256
ds_read_b128 a[84:87], v203 offset:320
ds_read_b128 a[88:91], v203 offset:384
ds_read_b128 a[92:95], v203 offset:448
ds_read_b128 a[96:99], v203 offset:512
ds_read_b128 a[100:103], v203 offset:576
ds_read_b128 a[104:107], v203 offset:640
ds_read_b128 a[108:111], v203 offset:704
ds_read_b128 a[112:115], v203 offset:768
ds_read_b128 a[116:119], v203 offset:832
ds_read_b128 a[120:123], v203 offset:896
ds_read_b128 a[124:127], v203 offset:960
s_waitcnt lgkmcnt(0)
s_mov_b32 s81, 4
ds_read_b128 v[84:87], v194 offset:0
ds_read_b128 v[88:91], v194 offset:64
ds_read_b128 v[92:95], v194 offset:128
ds_read_b128 v[96:99], v194 offset:192
ds_read_b128 v[100:103], v194 offset:256
ds_read_b128 v[104:107], v194 offset:320
ds_read_b128 v[108:111], v194 offset:384
ds_read_b128 v[112:115], v194 offset:448
ds_read_b128 v[116:119], v194 offset:512
ds_read_b128 v[120:123], v194 offset:576
ds_read_b128 v[124:127], v194 offset:640
ds_read_b128 v[128:131], v194 offset:704
ds_read_b128 v[132:135], v194 offset:768
ds_read_b128 v[136:139], v194 offset:832
ds_read_b128 v[140:143], v194 offset:896
ds_read_b128 v[144:147], v194 offset:960
s_waitcnt lgkmcnt(15)
v_mfma_f32_16x16x32_bf16 v[76:79], v[84:87], a[0:3], 0
v_mfma_f32_16x16x32_bf16 v[80:83], v[84:87], a[64:67], 0
s_waitcnt lgkmcnt(14)
v_mfma_f32_16x16x32_bf16 v[76:79], v[88:91], a[4:7], v[76:79]
v_mfma_f32_16x16x32_bf16 v[80:83], v[88:91], a[68:71], v[80:83]
s_waitcnt lgkmcnt(13)
v_mfma_f32_16x16x32_bf16 v[76:79], v[92:95], a[8:11], v[76:79]
v_mfma_f32_16x16x32_bf16 v[80:83], v[92:95], a[72:75], v[80:83]
s_waitcnt lgkmcnt(12)
v_mfma_f32_16x16x32_bf16 v[76:79], v[96:99], a[12:15], v[76:79]
v_mfma_f32_16x16x32_bf16 v[80:83], v[96:99], a[76:79], v[80:83]
s_waitcnt lgkmcnt(11)
v_mfma_f32_16x16x32_bf16 v[76:79], v[100:103], a[16:19], v[76:79]
v_mfma_f32_16x16x32_bf16 v[80:83], v[100:103], a[80:83], v[80:83]
s_waitcnt lgkmcnt(10)
v_mfma_f32_16x16x32_bf16 v[76:79], v[104:107], a[20:23], v[76:79]
v_mfma_f32_16x16x32_bf16 v[80:83], v[104:107], a[84:87], v[80:83]
s_waitcnt lgkmcnt(9)
v_mfma_f32_16x16x32_bf16 v[76:79], v[108:111], a[24:27], v[76:79]
v_mfma_f32_16x16x32_bf16 v[80:83], v[108:111], a[88:91], v[80:83]
s_waitcnt lgkmcnt(8)
v_mfma_f32_16x16x32_bf16 v[76:79], v[112:115], a[28:31], v[76:79]
v_mfma_f32_16x16x32_bf16 v[80:83], v[112:115], a[92:95], v[80:83]
s_waitcnt lgkmcnt(7)
v_mfma_f32_16x16x32_bf16 v[76:79], v[116:119], a[32:35], v[76:79]
v_mfma_f32_16x16x32_bf16 v[80:83], v[116:119], a[96:99], v[80:83]
s_waitcnt lgkmcnt(6)
v_mfma_f32_16x16x32_bf16 v[76:79], v[120:123], a[36:39], v[76:79]
v_mfma_f32_16x16x32_bf16 v[80:83], v[120:123], a[100:103], v[80:83]
s_waitcnt lgkmcnt(5)
v_mfma_f32_16x16x32_bf16 v[76:79], v[124:127], a[40:43], v[76:79]
v_mfma_f32_16x16x32_bf16 v[80:83], v[124:127], a[104:107], v[80:83]
s_waitcnt lgkmcnt(4)
v_mfma_f32_16x16x32_bf16 v[76:79], v[128:131], a[44:47], v[76:79]
v_mfma_f32_16x16x32_bf16 v[80:83], v[128:131], a[108:111], v[80:83]
s_waitcnt lgkmcnt(3)
v_mfma_f32_16x16x32_bf16 v[76:79], v[132:135], a[48:51], v[76:79]
v_mfma_f32_16x16x32_bf16 v[80:83], v[132:135], a[112:115], v[80:83]
s_waitcnt lgkmcnt(2)
v_mfma_f32_16x16x32_bf16 v[76:79], v[136:139], a[52:55], v[76:79]
v_mfma_f32_16x16x32_bf16 v[80:83], v[136:139], a[116:119], v[80:83]
s_waitcnt lgkmcnt(1)
v_mfma_f32_16x16x32_bf16 v[76:79], v[140:143], a[56:59], v[76:79]
v_mfma_f32_16x16x32_bf16 v[80:83], v[140:143], a[120:123], v[80:83]
s_waitcnt lgkmcnt(0)
v_mfma_f32_16x16x32_bf16 v[76:79], v[144:147], a[60:63], v[76:79]
v_mfma_f32_16x16x32_bf16 v[80:83], v[144:147], a[124:127], v[80:83]
s_nop 6
v_max_f32 v190, v76, v77
v_max3_f32 v190, v190, v78, v79
v_mov_b32 v192, v190
s_nop 1
v_permlane16_swap_b32 v190, v192
v_max_f32 v190, v190, v192
v_mov_b32 v192, v190
s_nop 1
v_permlane32_swap_b32 v190, v192
v_max_f32 v190, v190, v192
ds_write_b32 v198, v190 offset:0
v_max_f32 v191, v80, v81
v_max3_f32 v191, v191, v82, v83
v_mov_b32 v192, v191
s_nop 1
v_permlane16_swap_b32 v191, v192
v_max_f32 v191, v191, v192
v_mov_b32 v192, v191
s_nop 1
v_permlane32_swap_b32 v191, v192
v_max_f32 v191, v191, v192
ds_write_b32 v198, v191 offset:256
s_waitcnt lgkmcnt(0)
s_barrier
ds_read_b128 v[164:167], v199
ds_read_b128 v[168:171], v199 offset:256
ds_read_b128 v[172:175], v200
s_waitcnt lgkmcnt(0)
v_max_f32 v164, v164, v165
v_max3_f32 v164, v164, v166, v167
v_mul_f32 v164, v164, v185
v_max_f32 v164, v164, v176
v_sub_f32 v182, v176, v164
v_exp_f32 v182, v182
v_mov_b32 v176, v164
v_max_f32 v168, v168, v169
v_max3_f32 v168, v168, v170, v171
v_mul_f32 v168, v168, v185
v_max_f32 v168, v168, v177
v_sub_f32 v183, v177, v168
v_exp_f32 v183, v183
v_mov_b32 v177, v168
v_max_f32 v172, v172, v173
v_max3_f32 v172, v172, v174, v175
v_mul_f32 v172, v172, v185
v_max_f32 v172, v172, v178
v_sub_f32 v184, v178, v172
v_exp_f32 v184, v184
v_mov_b32 v178, v172
v_fma_f32 v76, v76, v185, -v176
v_fma_f32 v77, v77, v185, -v176
v_fma_f32 v78, v78, v185, -v176
v_fma_f32 v79, v79, v185, -v176
v_exp_f32 v76, v76
v_exp_f32 v77, v77
v_exp_f32 v78, v78
v_exp_f32 v79, v79
v_mul_f32 v180, v180, v182
v_cvt_pk_bf16_f32 v186, v76, v77
v_cvt_pk_bf16_f32 v187, v78, v79
ds_write_b64 v201, v[186:187] offset:0
v_add_f32 v180, v180, v76
v_add_f32 v180, v180, v77
v_add_f32 v180, v180, v78
v_add_f32 v180, v180, v79
v_fma_f32 v80, v80, v185, -v177
v_fma_f32 v81, v81, v185, -v177
v_fma_f32 v82, v82, v185, -v177
v_fma_f32 v83, v83, v185, -v177
v_exp_f32 v80, v80
v_exp_f32 v81, v81
v_exp_f32 v82, v82
v_exp_f32 v83, v83
v_mul_f32 v181, v181, v183
v_cvt_pk_bf16_f32 v188, v80, v81
v_cvt_pk_bf16_f32 v189, v82, v83
ds_write_b64 v201, v[188:189] offset:512
v_add_f32 v181, v181, v80
v_add_f32 v181, v181, v81
v_add_f32 v181, v181, v82
v_add_f32 v181, v181, v83
s_waitcnt lgkmcnt(0)
s_barrier
ds_read_b128 v[148:151], v202 offset:0
ds_read_b128 v[152:155], v202 offset:1024
ds_read_b128 v[156:159], v202 offset:2048
ds_read_b128 v[160:163], v202 offset:3072
ds_read_b64_tr_b16 v[84:85], v196 offset:0
ds_read_b64_tr_b16 v[86:87], v196 offset:4352
ds_read_b64_tr_b16 v[88:89], v196 offset:64
ds_read_b64_tr_b16 v[90:91], v196 offset:4416
ds_read_b64_tr_b16 v[92:93], v196 offset:128
ds_read_b64_tr_b16 v[94:95], v196 offset:4480
ds_read_b64_tr_b16 v[96:97], v196 offset:192
ds_read_b64_tr_b16 v[98:99], v196 offset:4544
ds_read_b64_tr_b16 v[100:101], v196 offset:17408
ds_read_b64_tr_b16 v[102:103], v196 offset:21760
ds_read_b64_tr_b16 v[104:105], v196 offset:17472
ds_read_b64_tr_b16 v[106:107], v196 offset:21824
ds_read_b64_tr_b16 v[108:109], v196 offset:17536
ds_read_b64_tr_b16 v[110:111], v196 offset:21888
ds_read_b64_tr_b16 v[112:113], v196 offset:17600
ds_read_b64_tr_b16 v[114:115], v196 offset:21952
ds_read_b64_tr_b16 v[116:117], v196 offset:34816
ds_read_b64_tr_b16 v[118:119], v196 offset:39168
ds_read_b64_tr_b16 v[120:121], v196 offset:34880
ds_read_b64_tr_b16 v[122:123], v196 offset:39232
ds_read_b64_tr_b16 v[124:125], v196 offset:34944
ds_read_b64_tr_b16 v[126:127], v196 offset:39296
ds_read_b64_tr_b16 v[128:129], v196 offset:35008
ds_read_b64_tr_b16 v[130:131], v196 offset:39360
ds_read_b64_tr_b16 v[132:133], v196 offset:52224
ds_read_b64_tr_b16 v[134:135], v196 offset:56576
ds_read_b64_tr_b16 v[136:137], v196 offset:52288
ds_read_b64_tr_b16 v[138:139], v196 offset:56640
ds_read_b64_tr_b16 v[140:141], v196 offset:52352
ds_read_b64_tr_b16 v[142:143], v196 offset:56704
ds_read_b64_tr_b16 v[144:145], v196 offset:52416
ds_read_b64_tr_b16 v[146:147], v196 offset:56768
s_waitcnt lgkmcnt(15)
v_mfma_f32_32x32x16_bf16 v[12:27], v[84:87], v[148:151], 0
v_mfma_f32_32x32x16_bf16 v[28:43], v[88:91], v[148:151], 0
v_mfma_f32_32x32x16_bf16 v[44:59], v[92:95], v[148:151], 0
v_mfma_f32_32x32x16_bf16 v[60:75], v[96:99], v[148:151], 0
s_waitcnt lgkmcnt(15)
v_mfma_f32_32x32x16_bf16 v[12:27], v[100:103], v[152:155], v[12:27]
v_mfma_f32_32x32x16_bf16 v[28:43], v[104:107], v[152:155], v[28:43]
v_mfma_f32_32x32x16_bf16 v[44:59], v[108:111], v[152:155], v[44:59]
v_mfma_f32_32x32x16_bf16 v[60:75], v[112:115], v[152:155], v[60:75]
s_waitcnt lgkmcnt(8)
v_mfma_f32_32x32x16_bf16 v[12:27], v[116:119], v[156:159], v[12:27]
v_mfma_f32_32x32x16_bf16 v[28:43], v[120:123], v[156:159], v[28:43]
v_mfma_f32_32x32x16_bf16 v[44:59], v[124:127], v[156:159], v[44:59]
v_mfma_f32_32x32x16_bf16 v[60:75], v[128:131], v[156:159], v[60:75]
s_waitcnt lgkmcnt(0)
v_mfma_f32_32x32x16_bf16 v[12:27], v[132:135], v[160:163], v[12:27]
v_mfma_f32_32x32x16_bf16 v[28:43], v[136:139], v[160:163], v[28:43]
v_mfma_f32_32x32x16_bf16 v[44:59], v[140:143], v[160:163], v[44:59]
v_mfma_f32_32x32x16_bf16 v[60:75], v[144:147], v[160:163], v[60:75]
ds_read_b128 v[84:87], v195 offset:0
ds_read_b128 v[88:91], v195 offset:64
ds_read_b128 v[92:95], v195 offset:128
ds_read_b128 v[96:99], v195 offset:192
ds_read_b128 v[100:103], v195 offset:256
ds_read_b128 v[104:107], v195 offset:320
ds_read_b128 v[108:111], v195 offset:384
ds_read_b128 v[112:115], v195 offset:448
ds_read_b128 v[116:119], v195 offset:512
ds_read_b128 v[120:123], v195 offset:576
ds_read_b128 v[124:127], v195 offset:640
ds_read_b128 v[128:131], v195 offset:704
ds_read_b128 v[132:135], v195 offset:768
ds_read_b128 v[136:139], v195 offset:832
ds_read_b128 v[140:143], v195 offset:896
ds_read_b128 v[144:147], v195 offset:960
s_waitcnt lgkmcnt(15)
v_mfma_f32_16x16x32_bf16 v[76:79], v[84:87], a[0:3], 0
v_mfma_f32_16x16x32_bf16 v[80:83], v[84:87], a[64:67], 0
s_waitcnt lgkmcnt(14)
v_mfma_f32_16x16x32_bf16 v[76:79], v[88:91], a[4:7], v[76:79]
v_mfma_f32_16x16x32_bf16 v[80:83], v[88:91], a[68:71], v[80:83]
s_waitcnt lgkmcnt(13)
v_mfma_f32_16x16x32_bf16 v[76:79], v[92:95], a[8:11], v[76:79]
v_mfma_f32_16x16x32_bf16 v[80:83], v[92:95], a[72:75], v[80:83]
s_waitcnt lgkmcnt(12)
v_mfma_f32_16x16x32_bf16 v[76:79], v[96:99], a[12:15], v[76:79]
v_mfma_f32_16x16x32_bf16 v[80:83], v[96:99], a[76:79], v[80:83]
s_waitcnt lgkmcnt(11)
v_mfma_f32_16x16x32_bf16 v[76:79], v[100:103], a[16:19], v[76:79]
v_mfma_f32_16x16x32_bf16 v[80:83], v[100:103], a[80:83], v[80:83]
s_waitcnt lgkmcnt(10)
v_mfma_f32_16x16x32_bf16 v[76:79], v[104:107], a[20:23], v[76:79]
v_mfma_f32_16x16x32_bf16 v[80:83], v[104:107], a[84:87], v[80:83]
s_waitcnt lgkmcnt(9)
v_mfma_f32_16x16x32_bf16 v[76:79], v[108:111], a[24:27], v[76:79]
v_mfma_f32_16x16x32_bf16 v[80:83], v[108:111], a[88:91], v[80:83]
s_waitcnt lgkmcnt(8)
v_mfma_f32_16x16x32_bf16 v[76:79], v[112:115], a[28:31], v[76:79]
v_mfma_f32_16x16x32_bf16 v[80:83], v[112:115], a[92:95], v[80:83]
s_waitcnt lgkmcnt(7)
v_mfma_f32_16x16x32_bf16 v[76:79], v[116:119], a[32:35], v[76:79]
v_mfma_f32_16x16x32_bf16 v[80:83], v[116:119], a[96:99], v[80:83]
s_waitcnt lgkmcnt(6)
v_mfma_f32_16x16x32_bf16 v[76:79], v[120:123], a[36:39], v[76:79]
v_mfma_f32_16x16x32_bf16 v[80:83], v[120:123], a[100:103], v[80:83]
s_waitcnt lgkmcnt(5)
v_mfma_f32_16x16x32_bf16 v[76:79], v[124:127], a[40:43], v[76:79]
v_mfma_f32_16x16x32_bf16 v[80:83], v[124:127], a[104:107], v[80:83]
s_waitcnt lgkmcnt(4)
v_mfma_f32_16x16x32_bf16 v[76:79], v[128:131], a[44:47], v[76:79]
v_mfma_f32_16x16x32_bf16 v[80:83], v[128:131], a[108:111], v[80:83]
s_waitcnt lgkmcnt(3)
v_mfma_f32_16x16x32_bf16 v[76:79], v[132:135], a[48:51], v[76:79]
v_mfma_f32_16x16x32_bf16 v[80:83], v[132:135], a[112:115], v[80:83]
s_waitcnt lgkmcnt(2)
v_mfma_f32_16x16x32_bf16 v[76:79], v[136:139], a[52:55], v[76:79]
v_mfma_f32_16x16x32_bf16 v[80:83], v[136:139], a[116:119], v[80:83]
s_waitcnt lgkmcnt(1)
v_mfma_f32_16x16x32_bf16 v[76:79], v[140:143], a[56:59], v[76:79]
v_mfma_f32_16x16x32_bf16 v[80:83], v[140:143], a[120:123], v[80:83]
s_waitcnt lgkmcnt(0)
v_mfma_f32_16x16x32_bf16 v[76:79], v[144:147], a[60:63], v[76:79]
v_mfma_f32_16x16x32_bf16 v[80:83], v[144:147], a[124:127], v[80:83]
s_nop 6
v_max_f32 v190, v76, v77
v_max3_f32 v190, v190, v78, v79
v_mov_b32 v192, v190
s_nop 1
v_permlane16_swap_b32 v190, v192
v_max_f32 v190, v190, v192
v_mov_b32 v192, v190
s_nop 1
v_permlane32_swap_b32 v190, v192
v_max_f32 v190, v190, v192
ds_write_b32 v198, v190 offset:0
v_max_f32 v191, v80, v81
v_max3_f32 v191, v191, v82, v83
v_mov_b32 v192, v191
s_nop 1
v_permlane16_swap_b32 v191, v192
v_max_f32 v191, v191, v192
v_mov_b32 v192, v191
s_nop 1
v_permlane32_swap_b32 v191, v192
v_max_f32 v191, v191, v192
ds_write_b32 v198, v191 offset:256
s_waitcnt lgkmcnt(0)
s_barrier
ds_read_b128 v[164:167], v199
ds_read_b128 v[168:171], v199 offset:256
ds_read_b128 v[172:175], v200
ds_write_b128 v206, a[128:131] offset:0
ds_write_b128 v206, a[132:135] offset:1088
ds_write_b128 v206, a[136:139] offset:2176
ds_write_b128 v206, a[140:143] offset:3264
ds_write_b128 v206, a[144:147] offset:4352
ds_write_b128 v206, a[148:151] offset:5440
ds_write_b128 v206, a[152:155] offset:6528
ds_write_b128 v206, a[156:159] offset:7616
ds_write_b128 v206, a[160:163] offset:8704
ds_write_b128 v206, a[164:167] offset:9792
ds_write_b128 v206, a[168:171] offset:10880
ds_write_b128 v206, a[172:175] offset:11968
ds_write_b128 v206, a[176:179] offset:13056
ds_write_b128 v206, a[180:183] offset:14144
ds_write_b128 v206, a[184:187] offset:15232
ds_write_b128 v206, a[188:191] offset:16320
s_waitcnt lgkmcnt(15)
v_max_f32 v164, v164, v165
v_max3_f32 v164, v164, v166, v167
v_mul_f32 v164, v164, v185
v_max_f32 v164, v164, v176
v_sub_f32 v182, v176, v164
v_exp_f32 v182, v182
v_mov_b32 v176, v164
v_max_f32 v168, v168, v169
v_max3_f32 v168, v168, v170, v171
v_mul_f32 v168, v168, v185
v_max_f32 v168, v168, v177
v_sub_f32 v183, v177, v168
v_exp_f32 v183, v183
v_mov_b32 v177, v168
v_max_f32 v172, v172, v173
v_max3_f32 v172, v172, v174, v175
v_mul_f32 v172, v172, v185
v_max_f32 v172, v172, v178
v_sub_f32 v184, v178, v172
v_exp_f32 v184, v184
v_mov_b32 v178, v172
v_fma_f32 v76, v76, v185, -v176
v_fma_f32 v77, v77, v185, -v176
v_fma_f32 v78, v78, v185, -v176
v_fma_f32 v79, v79, v185, -v176
v_exp_f32 v76, v76
v_exp_f32 v77, v77
v_exp_f32 v78, v78
v_exp_f32 v79, v79
v_mul_f32 v180, v180, v182
v_cvt_pk_bf16_f32 v186, v76, v77
v_cvt_pk_bf16_f32 v187, v78, v79
ds_write_b64 v201, v[186:187] offset:0
v_add_f32 v180, v180, v76
v_add_f32 v180, v180, v77
v_add_f32 v180, v180, v78
v_add_f32 v180, v180, v79
v_fma_f32 v80, v80, v185, -v177
v_fma_f32 v81, v81, v185, -v177
v_fma_f32 v82, v82, v185, -v177
v_fma_f32 v83, v83, v185, -v177
v_exp_f32 v80, v80
v_exp_f32 v81, v81
v_exp_f32 v82, v82
v_exp_f32 v83, v83
v_mul_f32 v181, v181, v183
v_cvt_pk_bf16_f32 v188, v80, v81
v_cvt_pk_bf16_f32 v189, v82, v83
ds_write_b64 v201, v[188:189] offset:512
v_add_f32 v181, v181, v80
v_add_f32 v181, v181, v81
v_add_f32 v181, v181, v82
v_add_f32 v181, v181, v83
v_mul_f32 v12, v12, v184
v_mul_f32 v13, v13, v184
v_mul_f32 v14, v14, v184
v_mul_f32 v15, v15, v184
v_mul_f32 v16, v16, v184
v_mul_f32 v17, v17, v184
v_mul_f32 v18, v18, v184
v_mul_f32 v19, v19, v184
v_mul_f32 v20, v20, v184
v_mul_f32 v21, v21, v184
v_mul_f32 v22, v22, v184
v_mul_f32 v23, v23, v184
v_mul_f32 v24, v24, v184
v_mul_f32 v25, v25, v184
v_mul_f32 v26, v26, v184
v_mul_f32 v27, v27, v184
v_mul_f32 v28, v28, v184
v_mul_f32 v29, v29, v184
v_mul_f32 v30, v30, v184
v_mul_f32 v31, v31, v184
v_mul_f32 v32, v32, v184
v_mul_f32 v33, v33, v184
v_mul_f32 v34, v34, v184
v_mul_f32 v35, v35, v184
v_mul_f32 v36, v36, v184
v_mul_f32 v37, v37, v184
v_mul_f32 v38, v38, v184
v_mul_f32 v39, v39, v184
v_mul_f32 v40, v40, v184
v_mul_f32 v41, v41, v184
v_mul_f32 v42, v42, v184
v_mul_f32 v43, v43, v184
v_mul_f32 v44, v44, v184
v_mul_f32 v45, v45, v184
v_mul_f32 v46, v46, v184
v_mul_f32 v47, v47, v184
v_mul_f32 v48, v48, v184
v_mul_f32 v49, v49, v184
v_mul_f32 v50, v50, v184
v_mul_f32 v51, v51, v184
v_mul_f32 v52, v52, v184
v_mul_f32 v53, v53, v184
v_mul_f32 v54, v54, v184
v_mul_f32 v55, v55, v184
v_mul_f32 v56, v56, v184
v_mul_f32 v57, v57, v184
v_mul_f32 v58, v58, v184
v_mul_f32 v59, v59, v184
v_mul_f32 v60, v60, v184
v_mul_f32 v61, v61, v184
v_mul_f32 v62, v62, v184
v_mul_f32 v63, v63, v184
v_mul_f32 v64, v64, v184
v_mul_f32 v65, v65, v184
v_mul_f32 v66, v66, v184
v_mul_f32 v67, v67, v184
v_mul_f32 v68, v68, v184
v_mul_f32 v69, v69, v184
v_mul_f32 v70, v70, v184
v_mul_f32 v71, v71, v184
v_mul_f32 v72, v72, v184
v_mul_f32 v73, v73, v184
v_mul_f32 v74, v74, v184
v_mul_f32 v75, v75, v184
s_waitcnt lgkmcnt(0)
s_barrier
ds_read_b128 v[148:151], v202 offset:0
ds_read_b128 v[152:155], v202 offset:1024
ds_read_b128 v[156:159], v202 offset:2048
ds_read_b128 v[160:163], v202 offset:3072
ds_read_b64_tr_b16 v[84:85], v197 offset:0
ds_read_b64_tr_b16 v[86:87], v197 offset:4352
ds_read_b64_tr_b16 v[88:89], v197 offset:64
ds_read_b64_tr_b16 v[90:91], v197 offset:4416
ds_read_b64_tr_b16 v[92:93], v197 offset:128
ds_read_b64_tr_b16 v[94:95], v197 offset:4480
ds_read_b64_tr_b16 v[96:97], v197 offset:192
ds_read_b64_tr_b16 v[98:99], v197 offset:4544
ds_read_b64_tr_b16 v[100:101], v197 offset:17408
ds_read_b64_tr_b16 v[102:103], v197 offset:21760
ds_read_b64_tr_b16 v[104:105], v197 offset:17472
ds_read_b64_tr_b16 v[106:107], v197 offset:21824
ds_read_b64_tr_b16 v[108:109], v197 offset:17536
ds_read_b64_tr_b16 v[110:111], v197 offset:21888
ds_read_b64_tr_b16 v[112:113], v197 offset:17600
ds_read_b64_tr_b16 v[114:115], v197 offset:21952
ds_read_b64_tr_b16 v[116:117], v197 offset:34816
ds_read_b64_tr_b16 v[118:119], v197 offset:39168
ds_read_b64_tr_b16 v[120:121], v197 offset:34880
ds_read_b64_tr_b16 v[122:123], v197 offset:39232
ds_read_b64_tr_b16 v[124:125], v197 offset:34944
ds_read_b64_tr_b16 v[126:127], v197 offset:39296
ds_read_b64_tr_b16 v[128:129], v197 offset:35008
ds_read_b64_tr_b16 v[130:131], v197 offset:39360
ds_read_b64_tr_b16 v[132:133], v197 offset:52224
ds_read_b64_tr_b16 v[134:135], v197 offset:56576
ds_read_b64_tr_b16 v[136:137], v197 offset:52288
ds_read_b64_tr_b16 v[138:139], v197 offset:56640
ds_read_b64_tr_b16 v[140:141], v197 offset:52352
ds_read_b64_tr_b16 v[142:143], v197 offset:56704
ds_read_b64_tr_b16 v[144:145], v197 offset:52416
ds_read_b64_tr_b16 v[146:147], v197 offset:56768
s_waitcnt lgkmcnt(15)
v_mfma_f32_32x32x16_bf16 v[12:27], v[84:87], v[148:151], v[12:27]
v_mfma_f32_32x32x16_bf16 v[28:43], v[88:91], v[148:151], v[28:43]
s_add_u32 s6, s13, 2097152
buffer_load_dwordx4 a[128:131], v2, s[52:55], s6 offen nt
v_mfma_f32_32x32x16_bf16 v[44:59], v[92:95], v[148:151], v[44:59]
v_mfma_f32_32x32x16_bf16 v[60:75], v[96:99], v[148:151], v[60:75]
s_add_u32 s6, s13, 2098176
buffer_load_dwordx4 a[132:135], v2, s[52:55], s6 offen nt
s_waitcnt lgkmcnt(15)
v_mfma_f32_32x32x16_bf16 v[12:27], v[100:103], v[152:155], v[12:27]
v_mfma_f32_32x32x16_bf16 v[28:43], v[104:107], v[152:155], v[28:43]
s_add_u32 s6, s13, 2099200
buffer_load_dwordx4 a[136:139], v2, s[52:55], s6 offen nt
v_mfma_f32_32x32x16_bf16 v[44:59], v[108:111], v[152:155], v[44:59]
v_mfma_f32_32x32x16_bf16 v[60:75], v[112:115], v[152:155], v[60:75]
s_add_u32 s6, s13, 2100224
buffer_load_dwordx4 a[140:143], v2, s[52:55], s6 offen nt
s_waitcnt lgkmcnt(8)
v_mfma_f32_32x32x16_bf16 v[12:27], v[116:119], v[156:159], v[12:27]
v_mfma_f32_32x32x16_bf16 v[28:43], v[120:123], v[156:159], v[28:43]
s_add_u32 s6, s13, 2228224
buffer_load_dwordx4 a[144:147], v2, s[52:55], s6 offen nt
v_mfma_f32_32x32x16_bf16 v[44:59], v[124:127], v[156:159], v[44:59]
v_mfma_f32_32x32x16_bf16 v[60:75], v[128:131], v[156:159], v[60:75]
s_add_u32 s6, s13, 2229248
buffer_load_dwordx4 a[148:151], v2, s[52:55], s6 offen nt
s_waitcnt lgkmcnt(0)
v_mfma_f32_32x32x16_bf16 v[12:27], v[132:135], v[160:163], v[12:27]
v_mfma_f32_32x32x16_bf16 v[28:43], v[136:139], v[160:163], v[28:43]
s_add_u32 s6, s13, 2230272
buffer_load_dwordx4 a[152:155], v2, s[52:55], s6 offen nt
v_mfma_f32_32x32x16_bf16 v[44:59], v[140:143], v[160:163], v[44:59]
v_mfma_f32_32x32x16_bf16 v[60:75], v[144:147], v[160:163], v[60:75]
s_add_u32 s6, s13, 2231296
buffer_load_dwordx4 a[156:159], v2, s[52:55], s6 offen nt
ds_read_b128 v[84:87], v194 offset:0
ds_read_b128 v[88:91], v194 offset:64
ds_read_b128 v[92:95], v194 offset:128
ds_read_b128 v[96:99], v194 offset:192
ds_read_b128 v[100:103], v194 offset:256
ds_read_b128 v[104:107], v194 offset:320
ds_read_b128 v[108:111], v194 offset:384
ds_read_b128 v[112:115], v194 offset:448
ds_read_b128 v[116:119], v194 offset:512
ds_read_b128 v[120:123], v194 offset:576
ds_read_b128 v[124:127], v194 offset:640
ds_read_b128 v[128:131], v194 offset:704
ds_read_b128 v[132:135], v194 offset:768
ds_read_b128 v[136:139], v194 offset:832
ds_read_b128 v[140:143], v194 offset:896
ds_read_b128 v[144:147], v194 offset:960
s_waitcnt lgkmcnt(15)
v_mfma_f32_16x16x32_bf16 v[76:79], v[84:87], a[0:3], 0
v_mfma_f32_16x16x32_bf16 v[80:83], v[84:87], a[64:67], 0
s_waitcnt lgkmcnt(14)
v_mfma_f32_16x16x32_bf16 v[76:79], v[88:91], a[4:7], v[76:79]
v_mfma_f32_16x16x32_bf16 v[80:83], v[88:91], a[68:71], v[80:83]
s_add_u32 s6, s13, 2359296
buffer_load_dwordx4 a[160:163], v10, s[52:55], s6 offen nt
s_waitcnt lgkmcnt(13)
v_mfma_f32_16x16x32_bf16 v[76:79], v[92:95], a[8:11], v[76:79]
v_mfma_f32_16x16x32_bf16 v[80:83], v[92:95], a[72:75], v[80:83]
s_waitcnt lgkmcnt(12)
v_mfma_f32_16x16x32_bf16 v[76:79], v[96:99], a[12:15], v[76:79]
v_mfma_f32_16x16x32_bf16 v[80:83], v[96:99], a[76:79], v[80:83]
s_add_u32 s6, s13, 2360320
buffer_load_dwordx4 a[164:167], v10, s[52:55], s6 offen nt
s_waitcnt lgkmcnt(11)
v_mfma_f32_16x16x32_bf16 v[76:79], v[100:103], a[16:19], v[76:79]
v_mfma_f32_16x16x32_bf16 v[80:83], v[100:103], a[80:83], v[80:83]
s_waitcnt lgkmcnt(10)
v_mfma_f32_16x16x32_bf16 v[76:79], v[104:107], a[20:23], v[76:79]
v_mfma_f32_16x16x32_bf16 v[80:83], v[104:107], a[84:87], v[80:83]
s_add_u32 s6, s13, 2361344
buffer_load_dwordx4 a[168:171], v10, s[52:55], s6 offen nt
s_waitcnt lgkmcnt(9)
v_mfma_f32_16x16x32_bf16 v[76:79], v[108:111], a[24:27], v[76:79]
v_mfma_f32_16x16x32_bf16 v[80:83], v[108:111], a[88:91], v[80:83]
s_waitcnt lgkmcnt(8)
v_mfma_f32_16x16x32_bf16 v[76:79], v[112:115], a[28:31], v[76:79]
v_mfma_f32_16x16x32_bf16 v[80:83], v[112:115], a[92:95], v[80:83]
s_add_u32 s6, s13, 2362368
buffer_load_dwordx4 a[172:175], v10, s[52:55], s6 offen nt
s_waitcnt lgkmcnt(7)
v_mfma_f32_16x16x32_bf16 v[76:79], v[116:119], a[32:35], v[76:79]
v_mfma_f32_16x16x32_bf16 v[80:83], v[116:119], a[96:99], v[80:83]
s_waitcnt lgkmcnt(6)
v_mfma_f32_16x16x32_bf16 v[76:79], v[120:123], a[36:39], v[76:79]
v_mfma_f32_16x16x32_bf16 v[80:83], v[120:123], a[100:103], v[80:83]
s_add_u32 s6, s13, 2490368
buffer_load_dwordx4 a[176:179], v10, s[52:55], s6 offen nt
s_waitcnt lgkmcnt(5)
v_mfma_f32_16x16x32_bf16 v[76:79], v[124:127], a[40:43], v[76:79]
v_mfma_f32_16x16x32_bf16 v[80:83], v[124:127], a[104:107], v[80:83]
s_waitcnt lgkmcnt(4)
v_mfma_f32_16x16x32_bf16 v[76:79], v[128:131], a[44:47], v[76:79]
v_mfma_f32_16x16x32_bf16 v[80:83], v[128:131], a[108:111], v[80:83]
s_add_u32 s6, s13, 2491392
buffer_load_dwordx4 a[180:183], v10, s[52:55], s6 offen nt
s_waitcnt lgkmcnt(3)
v_mfma_f32_16x16x32_bf16 v[76:79], v[132:135], a[48:51], v[76:79]
v_mfma_f32_16x16x32_bf16 v[80:83], v[132:135], a[112:115], v[80:83]
s_waitcnt lgkmcnt(2)
v_mfma_f32_16x16x32_bf16 v[76:79], v[136:139], a[52:55], v[76:79]
v_mfma_f32_16x16x32_bf16 v[80:83], v[136:139], a[116:119], v[80:83]
s_add_u32 s6, s13, 2492416
buffer_load_dwordx4 a[184:187], v10, s[52:55], s6 offen nt
s_waitcnt lgkmcnt(1)
v_mfma_f32_16x16x32_bf16 v[76:79], v[140:143], a[56:59], v[76:79]
v_mfma_f32_16x16x32_bf16 v[80:83], v[140:143], a[120:123], v[80:83]
s_waitcnt lgkmcnt(0)
v_mfma_f32_16x16x32_bf16 v[76:79], v[144:147], a[60:63], v[76:79]
v_mfma_f32_16x16x32_bf16 v[80:83], v[144:147], a[124:127], v[80:83]
s_add_u32 s6, s13, 2493440
buffer_load_dwordx4 a[188:191], v10, s[52:55], s6 offen nt
s_nop 4
v_max_f32 v190, v76, v77
v_max3_f32 v190, v190, v78, v79
v_mov_b32 v192, v190
s_nop 1
v_permlane16_swap_b32 v190, v192
v_max_f32 v190, v190, v192
v_mov_b32 v192, v190
s_nop 1
v_permlane32_swap_b32 v190, v192
v_max_f32 v190, v190, v192
ds_write_b32 v198, v190 offset:0
v_max_f32 v191, v80, v81
v_max3_f32 v191, v191, v82, v83
v_mov_b32 v192, v191
s_nop 1
v_permlane16_swap_b32 v191, v192
v_max_f32 v191, v191, v192
v_mov_b32 v192, v191
s_nop 1
v_permlane32_swap_b32 v191, v192
v_max_f32 v191, v191, v192
ds_write_b32 v198, v191 offset:256
s_waitcnt lgkmcnt(0)
s_barrier
ds_read_b128 v[164:167], v199
ds_read_b128 v[168:171], v199 offset:256
ds_read_b128 v[172:175], v200
ds_write_b128 v207, a[192:195] offset:0
ds_write_b128 v207, a[196:199] offset:1088
ds_write_b128 v207, a[200:203] offset:2176
ds_write_b128 v207, a[204:207] offset:3264
ds_write_b128 v207, a[208:211] offset:4352
ds_write_b128 v207, a[212:215] offset:5440
ds_write_b128 v207, a[216:219] offset:6528
ds_write_b128 v207, a[220:223] offset:7616
ds_write_b128 v207, a[224:227] offset:8704
ds_write_b128 v207, a[228:231] offset:9792
ds_write_b128 v207, a[232:235] offset:10880
ds_write_b128 v207, a[236:239] offset:11968
ds_write_b128 v207, a[240:243] offset:13056
ds_write_b128 v207, a[244:247] offset:14144
ds_write_b128 v207, a[248:251] offset:15232
ds_write_b128 v207, a[252:255] offset:16320
s_waitcnt lgkmcnt(15)
v_max_f32 v164, v164, v165
v_max3_f32 v164, v164, v166, v167
v_mul_f32 v164, v164, v185
v_max_f32 v164, v164, v176
v_sub_f32 v182, v176, v164
v_exp_f32 v182, v182
v_mov_b32 v176, v164
v_max_f32 v168, v168, v169
v_max3_f32 v168, v168, v170, v171
v_mul_f32 v168, v168, v185
v_max_f32 v168, v168, v177
v_sub_f32 v183, v177, v168
v_exp_f32 v183, v183
v_mov_b32 v177, v168
v_max_f32 v172, v172, v173
v_max3_f32 v172, v172, v174, v175
v_mul_f32 v172, v172, v185
v_max_f32 v172, v172, v178
v_sub_f32 v184, v178, v172
v_exp_f32 v184, v184
v_mov_b32 v178, v172
v_fma_f32 v76, v76, v185, -v176
v_fma_f32 v77, v77, v185, -v176
v_fma_f32 v78, v78, v185, -v176
v_fma_f32 v79, v79, v185, -v176
v_exp_f32 v76, v76
v_exp_f32 v77, v77
v_exp_f32 v78, v78
v_exp_f32 v79, v79
v_mul_f32 v180, v180, v182
v_cvt_pk_bf16_f32 v186, v76, v77
v_cvt_pk_bf16_f32 v187, v78, v79
ds_write_b64 v201, v[186:187] offset:0
v_add_f32 v180, v180, v76
v_add_f32 v180, v180, v77
v_add_f32 v180, v180, v78
v_add_f32 v180, v180, v79
v_fma_f32 v80, v80, v185, -v177
v_fma_f32 v81, v81, v185, -v177
v_fma_f32 v82, v82, v185, -v177
v_fma_f32 v83, v83, v185, -v177
v_exp_f32 v80, v80
v_exp_f32 v81, v81
v_exp_f32 v82, v82
v_exp_f32 v83, v83
v_mul_f32 v181, v181, v183
v_cvt_pk_bf16_f32 v188, v80, v81
v_cvt_pk_bf16_f32 v189, v82, v83
ds_write_b64 v201, v[188:189] offset:512
v_add_f32 v181, v181, v80
v_add_f32 v181, v181, v81
v_add_f32 v181, v181, v82
v_add_f32 v181, v181, v83
v_mul_f32 v12, v12, v184
v_mul_f32 v13, v13, v184
v_mul_f32 v14, v14, v184
v_mul_f32 v15, v15, v184
v_mul_f32 v16, v16, v184
v_mul_f32 v17, v17, v184
v_mul_f32 v18, v18, v184
v_mul_f32 v19, v19, v184
v_mul_f32 v20, v20, v184
v_mul_f32 v21, v21, v184
v_mul_f32 v22, v22, v184
v_mul_f32 v23, v23, v184
v_mul_f32 v24, v24, v184
v_mul_f32 v25, v25, v184
v_mul_f32 v26, v26, v184
v_mul_f32 v27, v27, v184
v_mul_f32 v28, v28, v184
v_mul_f32 v29, v29, v184
v_mul_f32 v30, v30, v184
v_mul_f32 v31, v31, v184
v_mul_f32 v32, v32, v184
v_mul_f32 v33, v33, v184
v_mul_f32 v34, v34, v184
v_mul_f32 v35, v35, v184
v_mul_f32 v36, v36, v184
v_mul_f32 v37, v37, v184
v_mul_f32 v38, v38, v184
v_mul_f32 v39, v39, v184
v_mul_f32 v40, v40, v184
v_mul_f32 v41, v41, v184
v_mul_f32 v42, v42, v184
v_mul_f32 v43, v43, v184
v_mul_f32 v44, v44, v184
v_mul_f32 v45, v45, v184
v_mul_f32 v46, v46, v184
v_mul_f32 v47, v47, v184
v_mul_f32 v48, v48, v184
v_mul_f32 v49, v49, v184
v_mul_f32 v50, v50, v184
v_mul_f32 v51, v51, v184
v_mul_f32 v52, v52, v184
v_mul_f32 v53, v53, v184
v_mul_f32 v54, v54, v184
v_mul_f32 v55, v55, v184
v_mul_f32 v56, v56, v184
v_mul_f32 v57, v57, v184
v_mul_f32 v58, v58, v184
v_mul_f32 v59, v59, v184
v_mul_f32 v60, v60, v184
v_mul_f32 v61, v61, v184
v_mul_f32 v62, v62, v184
v_mul_f32 v63, v63, v184
v_mul_f32 v64, v64, v184
v_mul_f32 v65, v65, v184
v_mul_f32 v66, v66, v184
v_mul_f32 v67, v67, v184
v_mul_f32 v68, v68, v184
v_mul_f32 v69, v69, v184
v_mul_f32 v70, v70, v184
v_mul_f32 v71, v71, v184
v_mul_f32 v72, v72, v184
v_mul_f32 v73, v73, v184
v_mul_f32 v74, v74, v184
v_mul_f32 v75, v75, v184
s_waitcnt lgkmcnt(0)
s_barrier
ds_read_b128 v[148:151], v202 offset:0
ds_read_b128 v[152:155], v202 offset:1024
ds_read_b128 v[156:159], v202 offset:2048
ds_read_b128 v[160:163], v202 offset:3072
ds_read_b64_tr_b16 v[84:85], v196 offset:0
ds_read_b64_tr_b16 v[86:87], v196 offset:4352
ds_read_b64_tr_b16 v[88:89], v196 offset:64
ds_read_b64_tr_b16 v[90:91], v196 offset:4416
ds_read_b64_tr_b16 v[92:93], v196 offset:128
ds_read_b64_tr_b16 v[94:95], v196 offset:4480
ds_read_b64_tr_b16 v[96:97], v196 offset:192
ds_read_b64_tr_b16 v[98:99], v196 offset:4544
ds_read_b64_tr_b16 v[100:101], v196 offset:17408
ds_read_b64_tr_b16 v[102:103], v196 offset:21760
ds_read_b64_tr_b16 v[104:105], v196 offset:17472
ds_read_b64_tr_b16 v[106:107], v196 offset:21824
ds_read_b64_tr_b16 v[108:109], v196 offset:17536
ds_read_b64_tr_b16 v[110:111], v196 offset:21888
ds_read_b64_tr_b16 v[112:113], v196 offset:17600
ds_read_b64_tr_b16 v[114:115], v196 offset:21952
ds_read_b64_tr_b16 v[116:117], v196 offset:34816
ds_read_b64_tr_b16 v[118:119], v196 offset:39168
ds_read_b64_tr_b16 v[120:121], v196 offset:34880
ds_read_b64_tr_b16 v[122:123], v196 offset:39232
ds_read_b64_tr_b16 v[124:125], v196 offset:34944
ds_read_b64_tr_b16 v[126:127], v196 offset:39296
ds_read_b64_tr_b16 v[128:129], v196 offset:35008
ds_read_b64_tr_b16 v[130:131], v196 offset:39360
ds_read_b64_tr_b16 v[132:133], v196 offset:52224
ds_read_b64_tr_b16 v[134:135], v196 offset:56576
ds_read_b64_tr_b16 v[136:137], v196 offset:52288
ds_read_b64_tr_b16 v[138:139], v196 offset:56640
ds_read_b64_tr_b16 v[140:141], v196 offset:52352
ds_read_b64_tr_b16 v[142:143], v196 offset:56704
ds_read_b64_tr_b16 v[144:145], v196 offset:52416
ds_read_b64_tr_b16 v[146:147], v196 offset:56768
s_waitcnt lgkmcnt(15)
v_mfma_f32_32x32x16_bf16 v[12:27], v[84:87], v[148:151], v[12:27]
v_mfma_f32_32x32x16_bf16 v[28:43], v[88:91], v[148:151], v[28:43]
s_add_u32 s6, s13, 2621440
buffer_load_dwordx4 a[192:195], v2, s[52:55], s6 offen nt
v_mfma_f32_32x32x16_bf16 v[44:59], v[92:95], v[148:151], v[44:59]
v_mfma_f32_32x32x16_bf16 v[60:75], v[96:99], v[148:151], v[60:75]
s_add_u32 s6, s13, 2622464
buffer_load_dwordx4 a[196:199], v2, s[52:55], s6 offen nt
s_waitcnt lgkmcnt(15)
v_mfma_f32_32x32x16_bf16 v[12:27], v[100:103], v[152:155], v[12:27]
v_mfma_f32_32x32x16_bf16 v[28:43], v[104:107], v[152:155], v[28:43]
s_add_u32 s6, s13, 2623488
buffer_load_dwordx4 a[200:203], v2, s[52:55], s6 offen nt
v_mfma_f32_32x32x16_bf16 v[44:59], v[108:111], v[152:155], v[44:59]
v_mfma_f32_32x32x16_bf16 v[60:75], v[112:115], v[152:155], v[60:75]
s_add_u32 s6, s13, 2624512
buffer_load_dwordx4 a[204:207], v2, s[52:55], s6 offen nt
s_waitcnt lgkmcnt(8)
v_mfma_f32_32x32x16_bf16 v[12:27], v[116:119], v[156:159], v[12:27]
v_mfma_f32_32x32x16_bf16 v[28:43], v[120:123], v[156:159], v[28:43]
s_add_u32 s6, s13, 2752512
buffer_load_dwordx4 a[208:211], v2, s[52:55], s6 offen nt
v_mfma_f32_32x32x16_bf16 v[44:59], v[124:127], v[156:159], v[44:59]
v_mfma_f32_32x32x16_bf16 v[60:75], v[128:131], v[156:159], v[60:75]
s_add_u32 s6, s13, 2753536
buffer_load_dwordx4 a[212:215], v2, s[52:55], s6 offen nt
s_waitcnt lgkmcnt(0)
v_mfma_f32_32x32x16_bf16 v[12:27], v[132:135], v[160:163], v[12:27]
v_mfma_f32_32x32x16_bf16 v[28:43], v[136:139], v[160:163], v[28:43]
s_add_u32 s6, s13, 2754560
buffer_load_dwordx4 a[216:219], v2, s[52:55], s6 offen nt
v_mfma_f32_32x32x16_bf16 v[44:59], v[140:143], v[160:163], v[44:59]
v_mfma_f32_32x32x16_bf16 v[60:75], v[144:147], v[160:163], v[60:75]
s_add_u32 s6, s13, 2755584
buffer_load_dwordx4 a[220:223], v2, s[52:55], s6 offen nt
ds_read_b128 v[84:87], v195 offset:0
ds_read_b128 v[88:91], v195 offset:64
ds_read_b128 v[92:95], v195 offset:128
ds_read_b128 v[96:99], v195 offset:192
ds_read_b128 v[100:103], v195 offset:256
ds_read_b128 v[104:107], v195 offset:320
ds_read_b128 v[108:111], v195 offset:384
ds_read_b128 v[112:115], v195 offset:448
ds_read_b128 v[116:119], v195 offset:512
ds_read_b128 v[120:123], v195 offset:576
ds_read_b128 v[124:127], v195 offset:640
ds_read_b128 v[128:131], v195 offset:704
ds_read_b128 v[132:135], v195 offset:768
ds_read_b128 v[136:139], v195 offset:832
ds_read_b128 v[140:143], v195 offset:896
ds_read_b128 v[144:147], v195 offset:960
s_waitcnt lgkmcnt(15)
v_mfma_f32_16x16x32_bf16 v[76:79], v[84:87], a[0:3], 0
v_mfma_f32_16x16x32_bf16 v[80:83], v[84:87], a[64:67], 0
s_waitcnt lgkmcnt(14)
v_mfma_f32_16x16x32_bf16 v[76:79], v[88:91], a[4:7], v[76:79]
v_mfma_f32_16x16x32_bf16 v[80:83], v[88:91], a[68:71], v[80:83]
s_add_u32 s6, s13, 2883584
buffer_load_dwordx4 a[224:227], v10, s[52:55], s6 offen nt
s_waitcnt lgkmcnt(13)
v_mfma_f32_16x16x32_bf16 v[76:79], v[92:95], a[8:11], v[76:79]
v_mfma_f32_16x16x32_bf16 v[80:83], v[92:95], a[72:75], v[80:83]
s_waitcnt lgkmcnt(12)
v_mfma_f32_16x16x32_bf16 v[76:79], v[96:99], a[12:15], v[76:79]
v_mfma_f32_16x16x32_bf16 v[80:83], v[96:99], a[76:79], v[80:83]
s_add_u32 s6, s13, 2884608
buffer_load_dwordx4 a[228:231], v10, s[52:55], s6 offen nt
s_waitcnt lgkmcnt(11)
v_mfma_f32_16x16x32_bf16 v[76:79], v[100:103], a[16:19], v[76:79]
v_mfma_f32_16x16x32_bf16 v[80:83], v[100:103], a[80:83], v[80:83]
s_waitcnt lgkmcnt(10)
v_mfma_f32_16x16x32_bf16 v[76:79], v[104:107], a[20:23], v[76:79]
v_mfma_f32_16x16x32_bf16 v[80:83], v[104:107], a[84:87], v[80:83]
s_add_u32 s6, s13, 2885632
buffer_load_dwordx4 a[232:235], v10, s[52:55], s6 offen nt
s_waitcnt lgkmcnt(9)
v_mfma_f32_16x16x32_bf16 v[76:79], v[108:111], a[24:27], v[76:79]
v_mfma_f32_16x16x32_bf16 v[80:83], v[108:111], a[88:91], v[80:83]
s_waitcnt lgkmcnt(8)
v_mfma_f32_16x16x32_bf16 v[76:79], v[112:115], a[28:31], v[76:79]
v_mfma_f32_16x16x32_bf16 v[80:83], v[112:115], a[92:95], v[80:83]
s_add_u32 s6, s13, 2886656
buffer_load_dwordx4 a[236:239], v10, s[52:55], s6 offen nt
s_waitcnt lgkmcnt(7)
v_mfma_f32_16x16x32_bf16 v[76:79], v[116:119], a[32:35], v[76:79]
v_mfma_f32_16x16x32_bf16 v[80:83], v[116:119], a[96:99], v[80:83]
s_waitcnt lgkmcnt(6)
v_mfma_f32_16x16x32_bf16 v[76:79], v[120:123], a[36:39], v[76:79]
v_mfma_f32_16x16x32_bf16 v[80:83], v[120:123], a[100:103], v[80:83]
s_add_u32 s6, s13, 3014656
buffer_load_dwordx4 a[240:243], v10, s[52:55], s6 offen nt
s_waitcnt lgkmcnt(5)
v_mfma_f32_16x16x32_bf16 v[76:79], v[124:127], a[40:43], v[76:79]
v_mfma_f32_16x16x32_bf16 v[80:83], v[124:127], a[104:107], v[80:83]
s_waitcnt lgkmcnt(4)
v_mfma_f32_16x16x32_bf16 v[76:79], v[128:131], a[44:47], v[76:79]
v_mfma_f32_16x16x32_bf16 v[80:83], v[128:131], a[108:111], v[80:83]
s_add_u32 s6, s13, 3015680
buffer_load_dwordx4 a[244:247], v10, s[52:55], s6 offen nt
s_waitcnt lgkmcnt(3)
v_mfma_f32_16x16x32_bf16 v[76:79], v[132:135], a[48:51], v[76:79]
v_mfma_f32_16x16x32_bf16 v[80:83], v[132:135], a[112:115], v[80:83]
s_waitcnt lgkmcnt(2)
v_mfma_f32_16x16x32_bf16 v[76:79], v[136:139], a[52:55], v[76:79]
v_mfma_f32_16x16x32_bf16 v[80:83], v[136:139], a[116:119], v[80:83]
s_add_u32 s6, s13, 3016704
buffer_load_dwordx4 a[248:251], v10, s[52:55], s6 offen nt
s_waitcnt lgkmcnt(1)
v_mfma_f32_16x16x32_bf16 v[76:79], v[140:143], a[56:59], v[76:79]
v_mfma_f32_16x16x32_bf16 v[80:83], v[140:143], a[120:123], v[80:83]
s_waitcnt lgkmcnt(0)
v_mfma_f32_16x16x32_bf16 v[76:79], v[144:147], a[60:63], v[76:79]
v_mfma_f32_16x16x32_bf16 v[80:83], v[144:147], a[124:127], v[80:83]
s_add_u32 s6, s13, 3017728
buffer_load_dwordx4 a[252:255], v10, s[52:55], s6 offen nt
s_nop 4
v_max_f32 v190, v76, v77
v_max3_f32 v190, v190, v78, v79
v_mov_b32 v192, v190
s_nop 1
v_permlane16_swap_b32 v190, v192
v_max_f32 v190, v190, v192
v_mov_b32 v192, v190
s_nop 1
v_permlane32_swap_b32 v190, v192
v_max_f32 v190, v190, v192
ds_write_b32 v198, v190 offset:0
v_max_f32 v191, v80, v81
v_max3_f32 v191, v191, v82, v83
v_mov_b32 v192, v191
s_nop 1
v_permlane16_swap_b32 v191, v192
v_max_f32 v191, v191, v192
v_mov_b32 v192, v191
s_nop 1
v_permlane32_swap_b32 v191, v192
v_max_f32 v191, v191, v192
ds_write_b32 v198, v191 offset:256
s_waitcnt lgkmcnt(0)
s_barrier
ds_read_b128 v[164:167], v199
ds_read_b128 v[168:171], v199 offset:256
ds_read_b128 v[172:175], v200
s_waitcnt vmcnt(16)
ds_write_b128 v206, a[128:131] offset:0
ds_write_b128 v206, a[132:135] offset:1088
ds_write_b128 v206, a[136:139] offset:2176
ds_write_b128 v206, a[140:143] offset:3264
ds_write_b128 v206, a[144:147] offset:4352
ds_write_b128 v206, a[148:151] offset:5440
ds_write_b128 v206, a[152:155] offset:6528
ds_write_b128 v206, a[156:159] offset:7616
ds_write_b128 v206, a[160:163] offset:8704
ds_write_b128 v206, a[164:167] offset:9792
ds_write_b128 v206, a[168:171] offset:10880
ds_write_b128 v206, a[172:175] offset:11968
ds_write_b128 v206, a[176:179] offset:13056
ds_write_b128 v206, a[180:183] offset:14144
ds_write_b128 v206, a[184:187] offset:15232
ds_write_b128 v206, a[188:191] offset:16320
s_waitcnt lgkmcnt(15)
v_max_f32 v164, v164, v165
v_max3_f32 v164, v164, v166, v167
v_mul_f32 v164, v164, v185
v_max_f32 v164, v164, v176
v_sub_f32 v182, v176, v164
v_exp_f32 v182, v182
v_mov_b32 v176, v164
v_max_f32 v168, v168, v169
v_max3_f32 v168, v168, v170, v171
v_mul_f32 v168, v168, v185
v_max_f32 v168, v168, v177
v_sub_f32 v183, v177, v168
v_exp_f32 v183, v183
v_mov_b32 v177, v168
v_max_f32 v172, v172, v173
v_max3_f32 v172, v172, v174, v175
v_mul_f32 v172, v172, v185
v_max_f32 v172, v172, v178
v_sub_f32 v184, v178, v172
v_exp_f32 v184, v184
v_mov_b32 v178, v172
v_fma_f32 v76, v76, v185, -v176
v_fma_f32 v77, v77, v185, -v176
v_fma_f32 v78, v78, v185, -v176
v_fma_f32 v79, v79, v185, -v176
v_exp_f32 v76, v76
v_exp_f32 v77, v77
v_exp_f32 v78, v78
v_exp_f32 v79, v79
v_mul_f32 v180, v180, v182
v_cvt_pk_bf16_f32 v186, v76, v77
v_cvt_pk_bf16_f32 v187, v78, v79
ds_write_b64 v201, v[186:187] offset:0
v_add_f32 v180, v180, v76
v_add_f32 v180, v180, v77
v_add_f32 v180, v180, v78
v_add_f32 v180, v180, v79
v_fma_f32 v80, v80, v185, -v177
v_fma_f32 v81, v81, v185, -v177
v_fma_f32 v82, v82, v185, -v177
v_fma_f32 v83, v83, v185, -v177
v_exp_f32 v80, v80
v_exp_f32 v81, v81
v_exp_f32 v82, v82
v_exp_f32 v83, v83
v_mul_f32 v181, v181, v183
v_cvt_pk_bf16_f32 v188, v80, v81
v_cvt_pk_bf16_f32 v189, v82, v83
ds_write_b64 v201, v[188:189] offset:512
v_add_f32 v181, v181, v80
v_add_f32 v181, v181, v81
v_add_f32 v181, v181, v82
v_add_f32 v181, v181, v83
v_mul_f32 v12, v12, v184
v_mul_f32 v13, v13, v184
v_mul_f32 v14, v14, v184
v_mul_f32 v15, v15, v184
v_mul_f32 v16, v16, v184
v_mul_f32 v17, v17, v184
v_mul_f32 v18, v18, v184
v_mul_f32 v19, v19, v184
v_mul_f32 v20, v20, v184
v_mul_f32 v21, v21, v184
v_mul_f32 v22, v22, v184
v_mul_f32 v23, v23, v184
v_mul_f32 v24, v24, v184
v_mul_f32 v25, v25, v184
v_mul_f32 v26, v26, v184
v_mul_f32 v27, v27, v184
v_mul_f32 v28, v28, v184
v_mul_f32 v29, v29, v184
v_mul_f32 v30, v30, v184
v_mul_f32 v31, v31, v184
v_mul_f32 v32, v32, v184
v_mul_f32 v33, v33, v184
v_mul_f32 v34, v34, v184
v_mul_f32 v35, v35, v184
v_mul_f32 v36, v36, v184
v_mul_f32 v37, v37, v184
v_mul_f32 v38, v38, v184
v_mul_f32 v39, v39, v184
v_mul_f32 v40, v40, v184
v_mul_f32 v41, v41, v184
v_mul_f32 v42, v42, v184
v_mul_f32 v43, v43, v184
v_mul_f32 v44, v44, v184
v_mul_f32 v45, v45, v184
v_mul_f32 v46, v46, v184
v_mul_f32 v47, v47, v184
v_mul_f32 v48, v48, v184
v_mul_f32 v49, v49, v184
v_mul_f32 v50, v50, v184
v_mul_f32 v51, v51, v184
v_mul_f32 v52, v52, v184
v_mul_f32 v53, v53, v184
v_mul_f32 v54, v54, v184
v_mul_f32 v55, v55, v184
v_mul_f32 v56, v56, v184
v_mul_f32 v57, v57, v184
v_mul_f32 v58, v58, v184
v_mul_f32 v59, v59, v184
v_mul_f32 v60, v60, v184
v_mul_f32 v61, v61, v184
v_mul_f32 v62, v62, v184
v_mul_f32 v63, v63, v184
v_mul_f32 v64, v64, v184
v_mul_f32 v65, v65, v184
v_mul_f32 v66, v66, v184
v_mul_f32 v67, v67, v184
v_mul_f32 v68, v68, v184
v_mul_f32 v69, v69, v184
v_mul_f32 v70, v70, v184
v_mul_f32 v71, v71, v184
v_mul_f32 v72, v72, v184
v_mul_f32 v73, v73, v184
v_mul_f32 v74, v74, v184
v_mul_f32 v75, v75, v184
s_waitcnt lgkmcnt(0)
s_barrier
ds_read_b128 v[148:151], v202 offset:0
ds_read_b128 v[152:155], v202 offset:1024
ds_read_b128 v[156:159], v202 offset:2048
ds_read_b128 v[160:163], v202 offset:3072
ds_read_b64_tr_b16 v[84:85], v197 offset:0
ds_read_b64_tr_b16 v[86:87], v197 offset:4352
ds_read_b64_tr_b16 v[88:89], v197 offset:64
ds_read_b64_tr_b16 v[90:91], v197 offset:4416
ds_read_b64_tr_b16 v[92:93], v197 offset:128
ds_read_b64_tr_b16 v[94:95], v197 offset:4480
ds_read_b64_tr_b16 v[96:97], v197 offset:192
ds_read_b64_tr_b16 v[98:99], v197 offset:4544
ds_read_b64_tr_b16 v[100:101], v197 offset:17408
ds_read_b64_tr_b16 v[102:103], v197 offset:21760
ds_read_b64_tr_b16 v[104:105], v197 offset:17472
ds_read_b64_tr_b16 v[106:107], v197 offset:21824
ds_read_b64_tr_b16 v[108:109], v197 offset:17536
ds_read_b64_tr_b16 v[110:111], v197 offset:21888
ds_read_b64_tr_b16 v[112:113], v197 offset:17600
ds_read_b64_tr_b16 v[114:115], v197 offset:21952
ds_read_b64_tr_b16 v[116:117], v197 offset:34816
ds_read_b64_tr_b16 v[118:119], v197 offset:39168
ds_read_b64_tr_b16 v[120:121], v197 offset:34880
ds_read_b64_tr_b16 v[122:123], v197 offset:39232
ds_read_b64_tr_b16 v[124:125], v197 offset:34944
ds_read_b64_tr_b16 v[126:127], v197 offset:39296
ds_read_b64_tr_b16 v[128:129], v197 offset:35008
ds_read_b64_tr_b16 v[130:131], v197 offset:39360
ds_read_b64_tr_b16 v[132:133], v197 offset:52224
ds_read_b64_tr_b16 v[134:135], v197 offset:56576
ds_read_b64_tr_b16 v[136:137], v197 offset:52288
ds_read_b64_tr_b16 v[138:139], v197 offset:56640
ds_read_b64_tr_b16 v[140:141], v197 offset:52352
ds_read_b64_tr_b16 v[142:143], v197 offset:56704
ds_read_b64_tr_b16 v[144:145], v197 offset:52416
ds_read_b64_tr_b16 v[146:147], v197 offset:56768
s_waitcnt lgkmcnt(15)
v_mfma_f32_32x32x16_bf16 v[12:27], v[84:87], v[148:151], v[12:27]
v_mfma_f32_32x32x16_bf16 v[28:43], v[88:91], v[148:151], v[28:43]
s_add_u32 s6, s13, 3145728
buffer_load_dwordx4 a[128:131], v2, s[52:55], s6 offen nt
v_mfma_f32_32x32x16_bf16 v[44:59], v[92:95], v[148:151], v[44:59]
v_mfma_f32_32x32x16_bf16 v[60:75], v[96:99], v[148:151], v[60:75]
s_add_u32 s6, s13, 3146752
buffer_load_dwordx4 a[132:135], v2, s[52:55], s6 offen nt
s_waitcnt lgkmcnt(15)
v_mfma_f32_32x32x16_bf16 v[12:27], v[100:103], v[152:155], v[12:27]
v_mfma_f32_32x32x16_bf16 v[28:43], v[104:107], v[152:155], v[28:43]
s_add_u32 s6, s13, 3147776
buffer_load_dwordx4 a[136:139], v2, s[52:55], s6 offen nt
v_mfma_f32_32x32x16_bf16 v[44:59], v[108:111], v[152:155], v[44:59]
v_mfma_f32_32x32x16_bf16 v[60:75], v[112:115], v[152:155], v[60:75]
s_add_u32 s6, s13, 3148800
buffer_load_dwordx4 a[140:143], v2, s[52:55], s6 offen nt
s_waitcnt lgkmcnt(8)
v_mfma_f32_32x32x16_bf16 v[12:27], v[116:119], v[156:159], v[12:27]
v_mfma_f32_32x32x16_bf16 v[28:43], v[120:123], v[156:159], v[28:43]
s_add_u32 s6, s13, 3276800
buffer_load_dwordx4 a[144:147], v2, s[52:55], s6 offen nt
v_mfma_f32_32x32x16_bf16 v[44:59], v[124:127], v[156:159], v[44:59]
v_mfma_f32_32x32x16_bf16 v[60:75], v[128:131], v[156:159], v[60:75]
s_add_u32 s6, s13, 3277824
buffer_load_dwordx4 a[148:151], v2, s[52:55], s6 offen nt
s_waitcnt lgkmcnt(0)
v_mfma_f32_32x32x16_bf16 v[12:27], v[132:135], v[160:163], v[12:27]
v_mfma_f32_32x32x16_bf16 v[28:43], v[136:139], v[160:163], v[28:43]
s_add_u32 s6, s13, 3278848
buffer_load_dwordx4 a[152:155], v2, s[52:55], s6 offen nt
v_mfma_f32_32x32x16_bf16 v[44:59], v[140:143], v[160:163], v[44:59]
v_mfma_f32_32x32x16_bf16 v[60:75], v[144:147], v[160:163], v[60:75]
s_add_u32 s6, s13, 3279872
buffer_load_dwordx4 a[156:159], v2, s[52:55], s6 offen nt
ds_read_b128 v[84:87], v194 offset:0
ds_read_b128 v[88:91], v194 offset:64
ds_read_b128 v[92:95], v194 offset:128
ds_read_b128 v[96:99], v194 offset:192
ds_read_b128 v[100:103], v194 offset:256
ds_read_b128 v[104:107], v194 offset:320
ds_read_b128 v[108:111], v194 offset:384
ds_read_b128 v[112:115], v194 offset:448
ds_read_b128 v[116:119], v194 offset:512
ds_read_b128 v[120:123], v194 offset:576
ds_read_b128 v[124:127], v194 offset:640
ds_read_b128 v[128:131], v194 offset:704
ds_read_b128 v[132:135], v194 offset:768
ds_read_b128 v[136:139], v194 offset:832
ds_read_b128 v[140:143], v194 offset:896
ds_read_b128 v[144:147], v194 offset:960
s_waitcnt lgkmcnt(15)
v_mfma_f32_16x16x32_bf16 v[76:79], v[84:87], a[0:3], 0
v_mfma_f32_16x16x32_bf16 v[80:83], v[84:87], a[64:67], 0
s_waitcnt lgkmcnt(14)
v_mfma_f32_16x16x32_bf16 v[76:79], v[88:91], a[4:7], v[76:79]
v_mfma_f32_16x16x32_bf16 v[80:83], v[88:91], a[68:71], v[80:83]
s_add_u32 s6, s13, 3407872
buffer_load_dwordx4 a[160:163], v10, s[52:55], s6 offen nt
s_waitcnt lgkmcnt(13)
v_mfma_f32_16x16x32_bf16 v[76:79], v[92:95], a[8:11], v[76:79]
v_mfma_f32_16x16x32_bf16 v[80:83], v[92:95], a[72:75], v[80:83]
s_waitcnt lgkmcnt(12)
v_mfma_f32_16x16x32_bf16 v[76:79], v[96:99], a[12:15], v[76:79]
v_mfma_f32_16x16x32_bf16 v[80:83], v[96:99], a[76:79], v[80:83]
s_add_u32 s6, s13, 3408896
buffer_load_dwordx4 a[164:167], v10, s[52:55], s6 offen nt
s_waitcnt lgkmcnt(11)
v_mfma_f32_16x16x32_bf16 v[76:79], v[100:103], a[16:19], v[76:79]
v_mfma_f32_16x16x32_bf16 v[80:83], v[100:103], a[80:83], v[80:83]
s_waitcnt lgkmcnt(10)
v_mfma_f32_16x16x32_bf16 v[76:79], v[104:107], a[20:23], v[76:79]
v_mfma_f32_16x16x32_bf16 v[80:83], v[104:107], a[84:87], v[80:83]
s_add_u32 s6, s13, 3409920
buffer_load_dwordx4 a[168:171], v10, s[52:55], s6 offen nt
s_waitcnt lgkmcnt(9)
v_mfma_f32_16x16x32_bf16 v[76:79], v[108:111], a[24:27], v[76:79]
v_mfma_f32_16x16x32_bf16 v[80:83], v[108:111], a[88:91], v[80:83]
s_waitcnt lgkmcnt(8)
v_mfma_f32_16x16x32_bf16 v[76:79], v[112:115], a[28:31], v[76:79]
v_mfma_f32_16x16x32_bf16 v[80:83], v[112:115], a[92:95], v[80:83]
s_add_u32 s6, s13, 3410944
buffer_load_dwordx4 a[172:175], v10, s[52:55], s6 offen nt
s_waitcnt lgkmcnt(7)
v_mfma_f32_16x16x32_bf16 v[76:79], v[116:119], a[32:35], v[76:79]
v_mfma_f32_16x16x32_bf16 v[80:83], v[116:119], a[96:99], v[80:83]
s_waitcnt lgkmcnt(6)
v_mfma_f32_16x16x32_bf16 v[76:79], v[120:123], a[36:39], v[76:79]
v_mfma_f32_16x16x32_bf16 v[80:83], v[120:123], a[100:103], v[80:83]
s_add_u32 s6, s13, 3538944
buffer_load_dwordx4 a[176:179], v10, s[52:55], s6 offen nt
s_waitcnt lgkmcnt(5)
v_mfma_f32_16x16x32_bf16 v[76:79], v[124:127], a[40:43], v[76:79]
v_mfma_f32_16x16x32_bf16 v[80:83], v[124:127], a[104:107], v[80:83]
s_waitcnt lgkmcnt(4)
v_mfma_f32_16x16x32_bf16 v[76:79], v[128:131], a[44:47], v[76:79]
v_mfma_f32_16x16x32_bf16 v[80:83], v[128:131], a[108:111], v[80:83]
s_add_u32 s6, s13, 3539968
buffer_load_dwordx4 a[180:183], v10, s[52:55], s6 offen nt
s_waitcnt lgkmcnt(3)
v_mfma_f32_16x16x32_bf16 v[76:79], v[132:135], a[48:51], v[76:79]
v_mfma_f32_16x16x32_bf16 v[80:83], v[132:135], a[112:115], v[80:83]
s_waitcnt lgkmcnt(2)
v_mfma_f32_16x16x32_bf16 v[76:79], v[136:139], a[52:55], v[76:79]
v_mfma_f32_16x16x32_bf16 v[80:83], v[136:139], a[116:119], v[80:83]
s_add_u32 s6, s13, 3540992
buffer_load_dwordx4 a[184:187], v10, s[52:55], s6 offen nt
s_waitcnt lgkmcnt(1)
v_mfma_f32_16x16x32_bf16 v[76:79], v[140:143], a[56:59], v[76:79]
v_mfma_f32_16x16x32_bf16 v[80:83], v[140:143], a[120:123], v[80:83]
s_waitcnt lgkmcnt(0)
v_mfma_f32_16x16x32_bf16 v[76:79], v[144:147], a[60:63], v[76:79]
v_mfma_f32_16x16x32_bf16 v[80:83], v[144:147], a[124:127], v[80:83]
s_add_u32 s6, s13, 3542016
buffer_load_dwordx4 a[188:191], v10, s[52:55], s6 offen nt
s_nop 4
v_max_f32 v190, v76, v77
v_max3_f32 v190, v190, v78, v79
v_mov_b32 v192, v190
s_nop 1
v_permlane16_swap_b32 v190, v192
v_max_f32 v190, v190, v192
v_mov_b32 v192, v190
s_nop 1
v_permlane32_swap_b32 v190, v192
v_max_f32 v190, v190, v192
ds_write_b32 v198, v190 offset:0
v_max_f32 v191, v80, v81
v_max3_f32 v191, v191, v82, v83
v_mov_b32 v192, v191
s_nop 1
v_permlane16_swap_b32 v191, v192
v_max_f32 v191, v191, v192
v_mov_b32 v192, v191
s_nop 1
v_permlane32_swap_b32 v191, v192
v_max_f32 v191, v191, v192
ds_write_b32 v198, v191 offset:256
s_waitcnt lgkmcnt(0)
s_barrier
ds_read_b128 v[164:167], v199
ds_read_b128 v[168:171], v199 offset:256
ds_read_b128 v[172:175], v200
s_waitcnt vmcnt(16)
ds_write_b128 v207, a[192:195] offset:0
ds_write_b128 v207, a[196:199] offset:1088
ds_write_b128 v207, a[200:203] offset:2176
ds_write_b128 v207, a[204:207] offset:3264
ds_write_b128 v207, a[208:211] offset:4352
ds_write_b128 v207, a[212:215] offset:5440
ds_write_b128 v207, a[216:219] offset:6528
ds_write_b128 v207, a[220:223] offset:7616
ds_write_b128 v207, a[224:227] offset:8704
ds_write_b128 v207, a[228:231] offset:9792
ds_write_b128 v207, a[232:235] offset:10880
ds_write_b128 v207, a[236:239] offset:11968
ds_write_b128 v207, a[240:243] offset:13056
ds_write_b128 v207, a[244:247] offset:14144
ds_write_b128 v207, a[248:251] offset:15232
ds_write_b128 v207, a[252:255] offset:16320
s_waitcnt lgkmcnt(15)
v_max_f32 v164, v164, v165
v_max3_f32 v164, v164, v166, v167
v_mul_f32 v164, v164, v185
v_max_f32 v164, v164, v176
v_sub_f32 v182, v176, v164
v_exp_f32 v182, v182
v_mov_b32 v176, v164
v_max_f32 v168, v168, v169
v_max3_f32 v168, v168, v170, v171
v_mul_f32 v168, v168, v185
v_max_f32 v168, v168, v177
v_sub_f32 v183, v177, v168
v_exp_f32 v183, v183
v_mov_b32 v177, v168
v_max_f32 v172, v172, v173
v_max3_f32 v172, v172, v174, v175
v_mul_f32 v172, v172, v185
v_max_f32 v172, v172, v178
v_sub_f32 v184, v178, v172
v_exp_f32 v184, v184
v_mov_b32 v178, v172
v_fma_f32 v76, v76, v185, -v176
v_fma_f32 v77, v77, v185, -v176
v_fma_f32 v78, v78, v185, -v176
v_fma_f32 v79, v79, v185, -v176
v_exp_f32 v76, v76
v_exp_f32 v77, v77
v_exp_f32 v78, v78
v_exp_f32 v79, v79
v_mul_f32 v180, v180, v182
v_cvt_pk_bf16_f32 v186, v76, v77
v_cvt_pk_bf16_f32 v187, v78, v79
ds_write_b64 v201, v[186:187] offset:0
v_add_f32 v180, v180, v76
v_add_f32 v180, v180, v77
v_add_f32 v180, v180, v78
v_add_f32 v180, v180, v79
v_fma_f32 v80, v80, v185, -v177
v_fma_f32 v81, v81, v185, -v177
v_fma_f32 v82, v82, v185, -v177
v_fma_f32 v83, v83, v185, -v177
v_exp_f32 v80, v80
v_exp_f32 v81, v81
v_exp_f32 v82, v82
v_exp_f32 v83, v83
v_mul_f32 v181, v181, v183
v_cvt_pk_bf16_f32 v188, v80, v81
v_cvt_pk_bf16_f32 v189, v82, v83
ds_write_b64 v201, v[188:189] offset:512
v_add_f32 v181, v181, v80
v_add_f32 v181, v181, v81
v_add_f32 v181, v181, v82
v_add_f32 v181, v181, v83
v_mul_f32 v12, v12, v184
v_mul_f32 v13, v13, v184
v_mul_f32 v14, v14, v184
v_mul_f32 v15, v15, v184
v_mul_f32 v16, v16, v184
v_mul_f32 v17, v17, v184
v_mul_f32 v18, v18, v184
v_mul_f32 v19, v19, v184
v_mul_f32 v20, v20, v184
v_mul_f32 v21, v21, v184
v_mul_f32 v22, v22, v184
v_mul_f32 v23, v23, v184
v_mul_f32 v24, v24, v184
v_mul_f32 v25, v25, v184
v_mul_f32 v26, v26, v184
v_mul_f32 v27, v27, v184
v_mul_f32 v28, v28, v184
v_mul_f32 v29, v29, v184
v_mul_f32 v30, v30, v184
v_mul_f32 v31, v31, v184
v_mul_f32 v32, v32, v184
v_mul_f32 v33, v33, v184
v_mul_f32 v34, v34, v184
v_mul_f32 v35, v35, v184
v_mul_f32 v36, v36, v184
v_mul_f32 v37, v37, v184
v_mul_f32 v38, v38, v184
v_mul_f32 v39, v39, v184
v_mul_f32 v40, v40, v184
v_mul_f32 v41, v41, v184
v_mul_f32 v42, v42, v184
v_mul_f32 v43, v43, v184
v_mul_f32 v44, v44, v184
v_mul_f32 v45, v45, v184
v_mul_f32 v46, v46, v184
v_mul_f32 v47, v47, v184
v_mul_f32 v48, v48, v184
v_mul_f32 v49, v49, v184
v_mul_f32 v50, v50, v184
v_mul_f32 v51, v51, v184
v_mul_f32 v52, v52, v184
v_mul_f32 v53, v53, v184
v_mul_f32 v54, v54, v184
v_mul_f32 v55, v55, v184
v_mul_f32 v56, v56, v184
v_mul_f32 v57, v57, v184
v_mul_f32 v58, v58, v184
v_mul_f32 v59, v59, v184
v_mul_f32 v60, v60, v184
v_mul_f32 v61, v61, v184
v_mul_f32 v62, v62, v184
v_mul_f32 v63, v63, v184
v_mul_f32 v64, v64, v184
v_mul_f32 v65, v65, v184
v_mul_f32 v66, v66, v184
v_mul_f32 v67, v67, v184
v_mul_f32 v68, v68, v184
v_mul_f32 v69, v69, v184
v_mul_f32 v70, v70, v184
v_mul_f32 v71, v71, v184
v_mul_f32 v72, v72, v184
v_mul_f32 v73, v73, v184
v_mul_f32 v74, v74, v184
v_mul_f32 v75, v75, v184
s_waitcnt lgkmcnt(0)
s_barrier
ds_read_b128 v[148:151], v202 offset:0
ds_read_b128 v[152:155], v202 offset:1024
ds_read_b128 v[156:159], v202 offset:2048
ds_read_b128 v[160:163], v202 offset:3072
ds_read_b64_tr_b16 v[84:85], v196 offset:0
ds_read_b64_tr_b16 v[86:87], v196 offset:4352
ds_read_b64_tr_b16 v[88:89], v196 offset:64
ds_read_b64_tr_b16 v[90:91], v196 offset:4416
ds_read_b64_tr_b16 v[92:93], v196 offset:128
ds_read_b64_tr_b16 v[94:95], v196 offset:4480
ds_read_b64_tr_b16 v[96:97], v196 offset:192
ds_read_b64_tr_b16 v[98:99], v196 offset:4544
ds_read_b64_tr_b16 v[100:101], v196 offset:17408
ds_read_b64_tr_b16 v[102:103], v196 offset:21760
ds_read_b64_tr_b16 v[104:105], v196 offset:17472
ds_read_b64_tr_b16 v[106:107], v196 offset:21824
ds_read_b64_tr_b16 v[108:109], v196 offset:17536
ds_read_b64_tr_b16 v[110:111], v196 offset:21888
ds_read_b64_tr_b16 v[112:113], v196 offset:17600
ds_read_b64_tr_b16 v[114:115], v196 offset:21952
ds_read_b64_tr_b16 v[116:117], v196 offset:34816
ds_read_b64_tr_b16 v[118:119], v196 offset:39168
ds_read_b64_tr_b16 v[120:121], v196 offset:34880
ds_read_b64_tr_b16 v[122:123], v196 offset:39232
ds_read_b64_tr_b16 v[124:125], v196 offset:34944
ds_read_b64_tr_b16 v[126:127], v196 offset:39296
ds_read_b64_tr_b16 v[128:129], v196 offset:35008
ds_read_b64_tr_b16 v[130:131], v196 offset:39360
ds_read_b64_tr_b16 v[132:133], v196 offset:52224
ds_read_b64_tr_b16 v[134:135], v196 offset:56576
ds_read_b64_tr_b16 v[136:137], v196 offset:52288
ds_read_b64_tr_b16 v[138:139], v196 offset:56640
ds_read_b64_tr_b16 v[140:141], v196 offset:52352
ds_read_b64_tr_b16 v[142:143], v196 offset:56704
ds_read_b64_tr_b16 v[144:145], v196 offset:52416
ds_read_b64_tr_b16 v[146:147], v196 offset:56768
s_waitcnt lgkmcnt(15)
v_mfma_f32_32x32x16_bf16 v[12:27], v[84:87], v[148:151], v[12:27]
v_mfma_f32_32x32x16_bf16 v[28:43], v[88:91], v[148:151], v[28:43]
s_add_u32 s6, s13, 3670016
buffer_load_dwordx4 a[192:195], v2, s[52:55], s6 offen nt
v_mfma_f32_32x32x16_bf16 v[44:59], v[92:95], v[148:151], v[44:59]
v_mfma_f32_32x32x16_bf16 v[60:75], v[96:99], v[148:151], v[60:75]
s_add_u32 s6, s13, 3671040
buffer_load_dwordx4 a[196:199], v2, s[52:55], s6 offen nt
s_waitcnt lgkmcnt(15)
v_mfma_f32_32x32x16_bf16 v[12:27], v[100:103], v[152:155], v[12:27]
v_mfma_f32_32x32x16_bf16 v[28:43], v[104:107], v[152:155], v[28:43]
s_add_u32 s6, s13, 3672064
buffer_load_dwordx4 a[200:203], v2, s[52:55], s6 offen nt
v_mfma_f32_32x32x16_bf16 v[44:59], v[108:111], v[152:155], v[44:59]
v_mfma_f32_32x32x16_bf16 v[60:75], v[112:115], v[152:155], v[60:75]
s_add_u32 s6, s13, 3673088
buffer_load_dwordx4 a[204:207], v2, s[52:55], s6 offen nt
s_waitcnt lgkmcnt(8)
v_mfma_f32_32x32x16_bf16 v[12:27], v[116:119], v[156:159], v[12:27]
v_mfma_f32_32x32x16_bf16 v[28:43], v[120:123], v[156:159], v[28:43]
s_add_u32 s6, s13, 3801088
buffer_load_dwordx4 a[208:211], v2, s[52:55], s6 offen nt
v_mfma_f32_32x32x16_bf16 v[44:59], v[124:127], v[156:159], v[44:59]
v_mfma_f32_32x32x16_bf16 v[60:75], v[128:131], v[156:159], v[60:75]
s_add_u32 s6, s13, 3802112
buffer_load_dwordx4 a[212:215], v2, s[52:55], s6 offen nt
s_waitcnt lgkmcnt(0)
v_mfma_f32_32x32x16_bf16 v[12:27], v[132:135], v[160:163], v[12:27]
v_mfma_f32_32x32x16_bf16 v[28:43], v[136:139], v[160:163], v[28:43]
s_add_u32 s6, s13, 3803136
buffer_load_dwordx4 a[216:219], v2, s[52:55], s6 offen nt
v_mfma_f32_32x32x16_bf16 v[44:59], v[140:143], v[160:163], v[44:59]
v_mfma_f32_32x32x16_bf16 v[60:75], v[144:147], v[160:163], v[60:75]
s_add_u32 s6, s13, 3804160
buffer_load_dwordx4 a[220:223], v2, s[52:55], s6 offen nt
ds_read_b128 v[84:87], v195 offset:0
ds_read_b128 v[88:91], v195 offset:64
ds_read_b128 v[92:95], v195 offset:128
ds_read_b128 v[96:99], v195 offset:192
ds_read_b128 v[100:103], v195 offset:256
ds_read_b128 v[104:107], v195 offset:320
ds_read_b128 v[108:111], v195 offset:384
ds_read_b128 v[112:115], v195 offset:448
ds_read_b128 v[116:119], v195 offset:512
ds_read_b128 v[120:123], v195 offset:576
ds_read_b128 v[124:127], v195 offset:640
ds_read_b128 v[128:131], v195 offset:704
ds_read_b128 v[132:135], v195 offset:768
ds_read_b128 v[136:139], v195 offset:832
ds_read_b128 v[140:143], v195 offset:896
ds_read_b128 v[144:147], v195 offset:960
s_waitcnt lgkmcnt(15)
v_mfma_f32_16x16x32_bf16 v[76:79], v[84:87], a[0:3], 0
v_mfma_f32_16x16x32_bf16 v[80:83], v[84:87], a[64:67], 0
s_waitcnt lgkmcnt(14)
v_mfma_f32_16x16x32_bf16 v[76:79], v[88:91], a[4:7], v[76:79]
v_mfma_f32_16x16x32_bf16 v[80:83], v[88:91], a[68:71], v[80:83]
s_add_u32 s6, s13, 3932160
buffer_load_dwordx4 a[224:227], v10, s[52:55], s6 offen nt
s_waitcnt lgkmcnt(13)
v_mfma_f32_16x16x32_bf16 v[76:79], v[92:95], a[8:11], v[76:79]
v_mfma_f32_16x16x32_bf16 v[80:83], v[92:95], a[72:75], v[80:83]
s_waitcnt lgkmcnt(12)
v_mfma_f32_16x16x32_bf16 v[76:79], v[96:99], a[12:15], v[76:79]
v_mfma_f32_16x16x32_bf16 v[80:83], v[96:99], a[76:79], v[80:83]
s_add_u32 s6, s13, 3933184
buffer_load_dwordx4 a[228:231], v10, s[52:55], s6 offen nt
s_waitcnt lgkmcnt(11)
v_mfma_f32_16x16x32_bf16 v[76:79], v[100:103], a[16:19], v[76:79]
v_mfma_f32_16x16x32_bf16 v[80:83], v[100:103], a[80:83], v[80:83]
s_waitcnt lgkmcnt(10)
v_mfma_f32_16x16x32_bf16 v[76:79], v[104:107], a[20:23], v[76:79]
v_mfma_f32_16x16x32_bf16 v[80:83], v[104:107], a[84:87], v[80:83]
s_add_u32 s6, s13, 3934208
buffer_load_dwordx4 a[232:235], v10, s[52:55], s6 offen nt
s_waitcnt lgkmcnt(9)
v_mfma_f32_16x16x32_bf16 v[76:79], v[108:111], a[24:27], v[76:79]
v_mfma_f32_16x16x32_bf16 v[80:83], v[108:111], a[88:91], v[80:83]
s_waitcnt lgkmcnt(8)
v_mfma_f32_16x16x32_bf16 v[76:79], v[112:115], a[28:31], v[76:79]
v_mfma_f32_16x16x32_bf16 v[80:83], v[112:115], a[92:95], v[80:83]
s_add_u32 s6, s13, 3935232
buffer_load_dwordx4 a[236:239], v10, s[52:55], s6 offen nt
s_waitcnt lgkmcnt(7)
v_mfma_f32_16x16x32_bf16 v[76:79], v[116:119], a[32:35], v[76:79]
v_mfma_f32_16x16x32_bf16 v[80:83], v[116:119], a[96:99], v[80:83]
s_waitcnt lgkmcnt(6)
v_mfma_f32_16x16x32_bf16 v[76:79], v[120:123], a[36:39], v[76:79]
v_mfma_f32_16x16x32_bf16 v[80:83], v[120:123], a[100:103], v[80:83]
s_add_u32 s6, s13, 4063232
buffer_load_dwordx4 a[240:243], v10, s[52:55], s6 offen nt
s_waitcnt lgkmcnt(5)
v_mfma_f32_16x16x32_bf16 v[76:79], v[124:127], a[40:43], v[76:79]
v_mfma_f32_16x16x32_bf16 v[80:83], v[124:127], a[104:107], v[80:83]
s_waitcnt lgkmcnt(4)
v_mfma_f32_16x16x32_bf16 v[76:79], v[128:131], a[44:47], v[76:79]
v_mfma_f32_16x16x32_bf16 v[80:83], v[128:131], a[108:111], v[80:83]
s_add_u32 s6, s13, 4064256
buffer_load_dwordx4 a[244:247], v10, s[52:55], s6 offen nt
s_waitcnt lgkmcnt(3)
v_mfma_f32_16x16x32_bf16 v[76:79], v[132:135], a[48:51], v[76:79]
v_mfma_f32_16x16x32_bf16 v[80:83], v[132:135], a[112:115], v[80:83]
s_waitcnt lgkmcnt(2)
v_mfma_f32_16x16x32_bf16 v[76:79], v[136:139], a[52:55], v[76:79]
v_mfma_f32_16x16x32_bf16 v[80:83], v[136:139], a[116:119], v[80:83]
s_add_u32 s6, s13, 4065280
buffer_load_dwordx4 a[248:251], v10, s[52:55], s6 offen nt
s_waitcnt lgkmcnt(1)
v_mfma_f32_16x16x32_bf16 v[76:79], v[140:143], a[56:59], v[76:79]
v_mfma_f32_16x16x32_bf16 v[80:83], v[140:143], a[120:123], v[80:83]
s_waitcnt lgkmcnt(0)
v_mfma_f32_16x16x32_bf16 v[76:79], v[144:147], a[60:63], v[76:79]
v_mfma_f32_16x16x32_bf16 v[80:83], v[144:147], a[124:127], v[80:83]
s_add_u32 s6, s13, 4066304
buffer_load_dwordx4 a[252:255], v10, s[52:55], s6 offen nt
s_nop 4
v_max_f32 v190, v76, v77
v_max3_f32 v190, v190, v78, v79
v_mov_b32 v192, v190
s_nop 1
v_permlane16_swap_b32 v190, v192
v_max_f32 v190, v190, v192
v_mov_b32 v192, v190
s_nop 1
v_permlane32_swap_b32 v190, v192
v_max_f32 v190, v190, v192
ds_write_b32 v198, v190 offset:0
v_max_f32 v191, v80, v81
v_max3_f32 v191, v191, v82, v83
v_mov_b32 v192, v191
s_nop 1
v_permlane16_swap_b32 v191, v192
v_max_f32 v191, v191, v192
v_mov_b32 v192, v191
s_nop 1
v_permlane32_swap_b32 v191, v192
v_max_f32 v191, v191, v192
ds_write_b32 v198, v191 offset:256
s_waitcnt lgkmcnt(0)
s_barrier
ds_read_b128 v[164:167], v199
ds_read_b128 v[168:171], v199 offset:256
ds_read_b128 v[172:175], v200
s_waitcnt vmcnt(16)
ds_write_b128 v206, a[128:131] offset:0
ds_write_b128 v206, a[132:135] offset:1088
ds_write_b128 v206, a[136:139] offset:2176
ds_write_b128 v206, a[140:143] offset:3264
ds_write_b128 v206, a[144:147] offset:4352
ds_write_b128 v206, a[148:151] offset:5440
ds_write_b128 v206, a[152:155] offset:6528
ds_write_b128 v206, a[156:159] offset:7616
ds_write_b128 v206, a[160:163] offset:8704
ds_write_b128 v206, a[164:167] offset:9792
ds_write_b128 v206, a[168:171] offset:10880
ds_write_b128 v206, a[172:175] offset:11968
ds_write_b128 v206, a[176:179] offset:13056
ds_write_b128 v206, a[180:183] offset:14144
ds_write_b128 v206, a[184:187] offset:15232
ds_write_b128 v206, a[188:191] offset:16320
s_waitcnt lgkmcnt(15)
v_max_f32 v164, v164, v165
v_max3_f32 v164, v164, v166, v167
v_mul_f32 v164, v164, v185
v_max_f32 v164, v164, v176
v_sub_f32 v182, v176, v164
v_exp_f32 v182, v182
v_mov_b32 v176, v164
v_max_f32 v168, v168, v169
v_max3_f32 v168, v168, v170, v171
v_mul_f32 v168, v168, v185
v_max_f32 v168, v168, v177
v_sub_f32 v183, v177, v168
v_exp_f32 v183, v183
v_mov_b32 v177, v168
v_max_f32 v172, v172, v173
v_max3_f32 v172, v172, v174, v175
v_mul_f32 v172, v172, v185
v_max_f32 v172, v172, v178
v_sub_f32 v184, v178, v172
v_exp_f32 v184, v184
v_mov_b32 v178, v172
v_fma_f32 v76, v76, v185, -v176
v_fma_f32 v77, v77, v185, -v176
v_fma_f32 v78, v78, v185, -v176
v_fma_f32 v79, v79, v185, -v176
v_exp_f32 v76, v76
v_exp_f32 v77, v77
v_exp_f32 v78, v78
v_exp_f32 v79, v79
v_mul_f32 v180, v180, v182
v_cvt_pk_bf16_f32 v186, v76, v77
v_cvt_pk_bf16_f32 v187, v78, v79
ds_write_b64 v201, v[186:187] offset:0
v_add_f32 v180, v180, v76
v_add_f32 v180, v180, v77
v_add_f32 v180, v180, v78
v_add_f32 v180, v180, v79
v_fma_f32 v80, v80, v185, -v177
v_fma_f32 v81, v81, v185, -v177
v_fma_f32 v82, v82, v185, -v177
v_fma_f32 v83, v83, v185, -v177
v_exp_f32 v80, v80
v_exp_f32 v81, v81
v_exp_f32 v82, v82
v_exp_f32 v83, v83
v_mul_f32 v181, v181, v183
v_cvt_pk_bf16_f32 v188, v80, v81
v_cvt_pk_bf16_f32 v189, v82, v83
ds_write_b64 v201, v[188:189] offset:512
v_add_f32 v181, v181, v80
v_add_f32 v181, v181, v81
v_add_f32 v181, v181, v82
v_add_f32 v181, v181, v83
v_mul_f32 v12, v12, v184
v_mul_f32 v13, v13, v184
v_mul_f32 v14, v14, v184
v_mul_f32 v15, v15, v184
v_mul_f32 v16, v16, v184
v_mul_f32 v17, v17, v184
v_mul_f32 v18, v18, v184
v_mul_f32 v19, v19, v184
v_mul_f32 v20, v20, v184
v_mul_f32 v21, v21, v184
v_mul_f32 v22, v22, v184
v_mul_f32 v23, v23, v184
v_mul_f32 v24, v24, v184
v_mul_f32 v25, v25, v184
v_mul_f32 v26, v26, v184
v_mul_f32 v27, v27, v184
v_mul_f32 v28, v28, v184
v_mul_f32 v29, v29, v184
v_mul_f32 v30, v30, v184
v_mul_f32 v31, v31, v184
v_mul_f32 v32, v32, v184
v_mul_f32 v33, v33, v184
v_mul_f32 v34, v34, v184
v_mul_f32 v35, v35, v184
v_mul_f32 v36, v36, v184
v_mul_f32 v37, v37, v184
v_mul_f32 v38, v38, v184
v_mul_f32 v39, v39, v184
v_mul_f32 v40, v40, v184
v_mul_f32 v41, v41, v184
v_mul_f32 v42, v42, v184
v_mul_f32 v43, v43, v184
v_mul_f32 v44, v44, v184
v_mul_f32 v45, v45, v184
v_mul_f32 v46, v46, v184
v_mul_f32 v47, v47, v184
v_mul_f32 v48, v48, v184
v_mul_f32 v49, v49, v184
v_mul_f32 v50, v50, v184
v_mul_f32 v51, v51, v184
v_mul_f32 v52, v52, v184
v_mul_f32 v53, v53, v184
v_mul_f32 v54, v54, v184
v_mul_f32 v55, v55, v184
v_mul_f32 v56, v56, v184
v_mul_f32 v57, v57, v184
v_mul_f32 v58, v58, v184
v_mul_f32 v59, v59, v184
v_mul_f32 v60, v60, v184
v_mul_f32 v61, v61, v184
v_mul_f32 v62, v62, v184
v_mul_f32 v63, v63, v184
v_mul_f32 v64, v64, v184
v_mul_f32 v65, v65, v184
v_mul_f32 v66, v66, v184
v_mul_f32 v67, v67, v184
v_mul_f32 v68, v68, v184
v_mul_f32 v69, v69, v184
v_mul_f32 v70, v70, v184
v_mul_f32 v71, v71, v184
v_mul_f32 v72, v72, v184
v_mul_f32 v73, v73, v184
v_mul_f32 v74, v74, v184
v_mul_f32 v75, v75, v184
s_waitcnt lgkmcnt(0)
s_barrier
ds_read_b128 v[148:151], v202 offset:0
ds_read_b128 v[152:155], v202 offset:1024
ds_read_b128 v[156:159], v202 offset:2048
ds_read_b128 v[160:163], v202 offset:3072
ds_read_b64_tr_b16 v[84:85], v197 offset:0
ds_read_b64_tr_b16 v[86:87], v197 offset:4352
ds_read_b64_tr_b16 v[88:89], v197 offset:64
ds_read_b64_tr_b16 v[90:91], v197 offset:4416
ds_read_b64_tr_b16 v[92:93], v197 offset:128
ds_read_b64_tr_b16 v[94:95], v197 offset:4480
ds_read_b64_tr_b16 v[96:97], v197 offset:192
ds_read_b64_tr_b16 v[98:99], v197 offset:4544
ds_read_b64_tr_b16 v[100:101], v197 offset:17408
ds_read_b64_tr_b16 v[102:103], v197 offset:21760
ds_read_b64_tr_b16 v[104:105], v197 offset:17472
ds_read_b64_tr_b16 v[106:107], v197 offset:21824
ds_read_b64_tr_b16 v[108:109], v197 offset:17536
ds_read_b64_tr_b16 v[110:111], v197 offset:21888
ds_read_b64_tr_b16 v[112:113], v197 offset:17600
ds_read_b64_tr_b16 v[114:115], v197 offset:21952
ds_read_b64_tr_b16 v[116:117], v197 offset:34816
ds_read_b64_tr_b16 v[118:119], v197 offset:39168
ds_read_b64_tr_b16 v[120:121], v197 offset:34880
ds_read_b64_tr_b16 v[122:123], v197 offset:39232
ds_read_b64_tr_b16 v[124:125], v197 offset:34944
ds_read_b64_tr_b16 v[126:127], v197 offset:39296
ds_read_b64_tr_b16 v[128:129], v197 offset:35008
ds_read_b64_tr_b16 v[130:131], v197 offset:39360
ds_read_b64_tr_b16 v[132:133], v197 offset:52224
ds_read_b64_tr_b16 v[134:135], v197 offset:56576
ds_read_b64_tr_b16 v[136:137], v197 offset:52288
ds_read_b64_tr_b16 v[138:139], v197 offset:56640
ds_read_b64_tr_b16 v[140:141], v197 offset:52352
ds_read_b64_tr_b16 v[142:143], v197 offset:56704
ds_read_b64_tr_b16 v[144:145], v197 offset:52416
ds_read_b64_tr_b16 v[146:147], v197 offset:56768
s_waitcnt lgkmcnt(15)
v_mfma_f32_32x32x16_bf16 v[12:27], v[84:87], v[148:151], v[12:27]
v_mfma_f32_32x32x16_bf16 v[28:43], v[88:91], v[148:151], v[28:43]
v_mfma_f32_32x32x16_bf16 v[44:59], v[92:95], v[148:151], v[44:59]
v_mfma_f32_32x32x16_bf16 v[60:75], v[96:99], v[148:151], v[60:75]
s_waitcnt lgkmcnt(15)
v_mfma_f32_32x32x16_bf16 v[12:27], v[100:103], v[152:155], v[12:27]
v_mfma_f32_32x32x16_bf16 v[28:43], v[104:107], v[152:155], v[28:43]
v_mfma_f32_32x32x16_bf16 v[44:59], v[108:111], v[152:155], v[44:59]
v_mfma_f32_32x32x16_bf16 v[60:75], v[112:115], v[152:155], v[60:75]
s_waitcnt lgkmcnt(8)
v_mfma_f32_32x32x16_bf16 v[12:27], v[116:119], v[156:159], v[12:27]
v_mfma_f32_32x32x16_bf16 v[28:43], v[120:123], v[156:159], v[28:43]
v_mfma_f32_32x32x16_bf16 v[44:59], v[124:127], v[156:159], v[44:59]
v_mfma_f32_32x32x16_bf16 v[60:75], v[128:131], v[156:159], v[60:75]
s_waitcnt lgkmcnt(0)
v_mfma_f32_32x32x16_bf16 v[12:27], v[132:135], v[160:163], v[12:27]
v_mfma_f32_32x32x16_bf16 v[28:43], v[136:139], v[160:163], v[28:43]
v_mfma_f32_32x32x16_bf16 v[44:59], v[140:143], v[160:163], v[44:59]
v_mfma_f32_32x32x16_bf16 v[60:75], v[144:147], v[160:163], v[60:75]
ds_read_b128 v[84:87], v194 offset:0
ds_read_b128 v[88:91], v194 offset:64
ds_read_b128 v[92:95], v194 offset:128
ds_read_b128 v[96:99], v194 offset:192
ds_read_b128 v[100:103], v194 offset:256
ds_read_b128 v[104:107], v194 offset:320
ds_read_b128 v[108:111], v194 offset:384
ds_read_b128 v[112:115], v194 offset:448
ds_read_b128 v[116:119], v194 offset:512
ds_read_b128 v[120:123], v194 offset:576
ds_read_b128 v[124:127], v194 offset:640
ds_read_b128 v[128:131], v194 offset:704
ds_read_b128 v[132:135], v194 offset:768
ds_read_b128 v[136:139], v194 offset:832
ds_read_b128 v[140:143], v194 offset:896
ds_read_b128 v[144:147], v194 offset:960
s_waitcnt lgkmcnt(15)
v_mfma_f32_16x16x32_bf16 v[76:79], v[84:87], a[0:3], 0
v_mfma_f32_16x16x32_bf16 v[80:83], v[84:87], a[64:67], 0
s_waitcnt lgkmcnt(14)
v_mfma_f32_16x16x32_bf16 v[76:79], v[88:91], a[4:7], v[76:79]
v_mfma_f32_16x16x32_bf16 v[80:83], v[88:91], a[68:71], v[80:83]
s_waitcnt lgkmcnt(13)
v_mfma_f32_16x16x32_bf16 v[76:79], v[92:95], a[8:11], v[76:79]
v_mfma_f32_16x16x32_bf16 v[80:83], v[92:95], a[72:75], v[80:83]
s_waitcnt lgkmcnt(12)
v_mfma_f32_16x16x32_bf16 v[76:79], v[96:99], a[12:15], v[76:79]
v_mfma_f32_16x16x32_bf16 v[80:83], v[96:99], a[76:79], v[80:83]
s_waitcnt lgkmcnt(11)
v_mfma_f32_16x16x32_bf16 v[76:79], v[100:103], a[16:19], v[76:79]
v_mfma_f32_16x16x32_bf16 v[80:83], v[100:103], a[80:83], v[80:83]
s_waitcnt lgkmcnt(10)
v_mfma_f32_16x16x32_bf16 v[76:79], v[104:107], a[20:23], v[76:79]
v_mfma_f32_16x16x32_bf16 v[80:83], v[104:107], a[84:87], v[80:83]
s_waitcnt lgkmcnt(9)
v_mfma_f32_16x16x32_bf16 v[76:79], v[108:111], a[24:27], v[76:79]
v_mfma_f32_16x16x32_bf16 v[80:83], v[108:111], a[88:91], v[80:83]
s_waitcnt lgkmcnt(8)
v_mfma_f32_16x16x32_bf16 v[76:79], v[112:115], a[28:31], v[76:79]
v_mfma_f32_16x16x32_bf16 v[80:83], v[112:115], a[92:95], v[80:83]
s_waitcnt lgkmcnt(7)
v_mfma_f32_16x16x32_bf16 v[76:79], v[116:119], a[32:35], v[76:79]
v_mfma_f32_16x16x32_bf16 v[80:83], v[116:119], a[96:99], v[80:83]
s_waitcnt lgkmcnt(6)
v_mfma_f32_16x16x32_bf16 v[76:79], v[120:123], a[36:39], v[76:79]
v_mfma_f32_16x16x32_bf16 v[80:83], v[120:123], a[100:103], v[80:83]
s_waitcnt lgkmcnt(5)
v_mfma_f32_16x16x32_bf16 v[76:79], v[124:127], a[40:43], v[76:79]
v_mfma_f32_16x16x32_bf16 v[80:83], v[124:127], a[104:107], v[80:83]
s_waitcnt lgkmcnt(4)
v_mfma_f32_16x16x32_bf16 v[76:79], v[128:131], a[44:47], v[76:79]
v_mfma_f32_16x16x32_bf16 v[80:83], v[128:131], a[108:111], v[80:83]
s_waitcnt lgkmcnt(3)
v_mfma_f32_16x16x32_bf16 v[76:79], v[132:135], a[48:51], v[76:79]
v_mfma_f32_16x16x32_bf16 v[80:83], v[132:135], a[112:115], v[80:83]
s_waitcnt lgkmcnt(2)
v_mfma_f32_16x16x32_bf16 v[76:79], v[136:139], a[52:55], v[76:79]
v_mfma_f32_16x16x32_bf16 v[80:83], v[136:139], a[116:119], v[80:83]
s_waitcnt lgkmcnt(1)
v_mfma_f32_16x16x32_bf16 v[76:79], v[140:143], a[56:59], v[76:79]
v_mfma_f32_16x16x32_bf16 v[80:83], v[140:143], a[120:123], v[80:83]
s_waitcnt lgkmcnt(0)
v_mfma_f32_16x16x32_bf16 v[76:79], v[144:147], a[60:63], v[76:79]
v_mfma_f32_16x16x32_bf16 v[80:83], v[144:147], a[124:127], v[80:83]
s_nop 6
v_max_f32 v190, v76, v77
v_max3_f32 v190, v190, v78, v79
v_mov_b32 v192, v190
s_nop 1
v_permlane16_swap_b32 v190, v192
v_max_f32 v190, v190, v192
v_mov_b32 v192, v190
s_nop 1
v_permlane32_swap_b32 v190, v192
v_max_f32 v190, v190, v192
ds_write_b32 v198, v190 offset:0
v_max_f32 v191, v80, v81
v_max3_f32 v191, v191, v82, v83
v_mov_b32 v192, v191
s_nop 1
v_permlane16_swap_b32 v191, v192
v_max_f32 v191, v191, v192
v_mov_b32 v192, v191
s_nop 1
v_permlane32_swap_b32 v191, v192
v_max_f32 v191, v191, v192
ds_write_b32 v198, v191 offset:256
s_waitcnt lgkmcnt(0)
s_barrier
ds_read_b128 v[164:167], v199
ds_read_b128 v[168:171], v199 offset:256
ds_read_b128 v[172:175], v200
s_waitcnt vmcnt(0)
ds_write_b128 v207, a[192:195] offset:0
ds_write_b128 v207, a[196:199] offset:1088
ds_write_b128 v207, a[200:203] offset:2176
ds_write_b128 v207, a[204:207] offset:3264
ds_write_b128 v207, a[208:211] offset:4352
ds_write_b128 v207, a[212:215] offset:5440
ds_write_b128 v207, a[216:219] offset:6528
ds_write_b128 v207, a[220:223] offset:7616
ds_write_b128 v207, a[224:227] offset:8704
ds_write_b128 v207, a[228:231] offset:9792
ds_write_b128 v207, a[232:235] offset:10880
ds_write_b128 v207, a[236:239] offset:11968
ds_write_b128 v207, a[240:243] offset:13056
ds_write_b128 v207, a[244:247] offset:14144
ds_write_b128 v207, a[248:251] offset:15232
ds_write_b128 v207, a[252:255] offset:16320
s_waitcnt lgkmcnt(15)
v_max_f32 v164, v164, v165
v_max3_f32 v164, v164, v166, v167
v_mul_f32 v164, v164, v185
v_max_f32 v164, v164, v176
v_sub_f32 v182, v176, v164
v_exp_f32 v182, v182
v_mov_b32 v176, v164
v_max_f32 v168, v168, v169
v_max3_f32 v168, v168, v170, v171
v_mul_f32 v168, v168, v185
v_max_f32 v168, v168, v177
v_sub_f32 v183, v177, v168
v_exp_f32 v183, v183
v_mov_b32 v177, v168
v_max_f32 v172, v172, v173
v_max3_f32 v172, v172, v174, v175
v_mul_f32 v172, v172, v185
v_max_f32 v172, v172, v178
v_sub_f32 v184, v178, v172
v_exp_f32 v184, v184
v_mov_b32 v178, v172
v_fma_f32 v76, v76, v185, -v176
v_fma_f32 v77, v77, v185, -v176
v_fma_f32 v78, v78, v185, -v176
v_fma_f32 v79, v79, v185, -v176
v_exp_f32 v76, v76
v_exp_f32 v77, v77
v_exp_f32 v78, v78
v_exp_f32 v79, v79
v_mul_f32 v180, v180, v182
v_cvt_pk_bf16_f32 v186, v76, v77
v_cvt_pk_bf16_f32 v187, v78, v79
ds_write_b64 v201, v[186:187] offset:0
v_add_f32 v180, v180, v76
v_add_f32 v180, v180, v77
v_add_f32 v180, v180, v78
v_add_f32 v180, v180, v79
v_fma_f32 v80, v80, v185, -v177
v_fma_f32 v81, v81, v185, -v177
v_fma_f32 v82, v82, v185, -v177
v_fma_f32 v83, v83, v185, -v177
v_exp_f32 v80, v80
v_exp_f32 v81, v81
v_exp_f32 v82, v82
v_exp_f32 v83, v83
v_mul_f32 v181, v181, v183
v_cvt_pk_bf16_f32 v188, v80, v81
v_cvt_pk_bf16_f32 v189, v82, v83
ds_write_b64 v201, v[188:189] offset:512
v_add_f32 v181, v181, v80
v_add_f32 v181, v181, v81
v_add_f32 v181, v181, v82
v_add_f32 v181, v181, v83
v_mul_f32 v12, v12, v184
v_mul_f32 v13, v13, v184
v_mul_f32 v14, v14, v184
v_mul_f32 v15, v15, v184
v_mul_f32 v16, v16, v184
v_mul_f32 v17, v17, v184
v_mul_f32 v18, v18, v184
v_mul_f32 v19, v19, v184
v_mul_f32 v20, v20, v184
v_mul_f32 v21, v21, v184
v_mul_f32 v22, v22, v184
v_mul_f32 v23, v23, v184
v_mul_f32 v24, v24, v184
v_mul_f32 v25, v25, v184
v_mul_f32 v26, v26, v184
v_mul_f32 v27, v27, v184
v_mul_f32 v28, v28, v184
v_mul_f32 v29, v29, v184
v_mul_f32 v30, v30, v184
v_mul_f32 v31, v31, v184
v_mul_f32 v32, v32, v184
v_mul_f32 v33, v33, v184
v_mul_f32 v34, v34, v184
v_mul_f32 v35, v35, v184
v_mul_f32 v36, v36, v184
v_mul_f32 v37, v37, v184
v_mul_f32 v38, v38, v184
v_mul_f32 v39, v39, v184
v_mul_f32 v40, v40, v184
v_mul_f32 v41, v41, v184
v_mul_f32 v42, v42, v184
v_mul_f32 v43, v43, v184
v_mul_f32 v44, v44, v184
v_mul_f32 v45, v45, v184
v_mul_f32 v46, v46, v184
v_mul_f32 v47, v47, v184
v_mul_f32 v48, v48, v184
v_mul_f32 v49, v49, v184
v_mul_f32 v50, v50, v184
v_mul_f32 v51, v51, v184
v_mul_f32 v52, v52, v184
v_mul_f32 v53, v53, v184
v_mul_f32 v54, v54, v184
v_mul_f32 v55, v55, v184
v_mul_f32 v56, v56, v184
v_mul_f32 v57, v57, v184
v_mul_f32 v58, v58, v184
v_mul_f32 v59, v59, v184
v_mul_f32 v60, v60, v184
v_mul_f32 v61, v61, v184
v_mul_f32 v62, v62, v184
v_mul_f32 v63, v63, v184
v_mul_f32 v64, v64, v184
v_mul_f32 v65, v65, v184
v_mul_f32 v66, v66, v184
v_mul_f32 v67, v67, v184
v_mul_f32 v68, v68, v184
v_mul_f32 v69, v69, v184
v_mul_f32 v70, v70, v184
v_mul_f32 v71, v71, v184
v_mul_f32 v72, v72, v184
v_mul_f32 v73, v73, v184
v_mul_f32 v74, v74, v184
v_mul_f32 v75, v75, v184
s_waitcnt lgkmcnt(0)
s_barrier
ds_read_b128 v[148:151], v202 offset:0
ds_read_b128 v[152:155], v202 offset:1024
ds_read_b128 v[156:159], v202 offset:2048
ds_read_b128 v[160:163], v202 offset:3072
ds_read_b64_tr_b16 v[84:85], v196 offset:0
ds_read_b64_tr_b16 v[86:87], v196 offset:4352
ds_read_b64_tr_b16 v[88:89], v196 offset:64
ds_read_b64_tr_b16 v[90:91], v196 offset:4416
ds_read_b64_tr_b16 v[92:93], v196 offset:128
ds_read_b64_tr_b16 v[94:95], v196 offset:4480
ds_read_b64_tr_b16 v[96:97], v196 offset:192
ds_read_b64_tr_b16 v[98:99], v196 offset:4544
ds_read_b64_tr_b16 v[100:101], v196 offset:17408
ds_read_b64_tr_b16 v[102:103], v196 offset:21760
ds_read_b64_tr_b16 v[104:105], v196 offset:17472
ds_read_b64_tr_b16 v[106:107], v196 offset:21824
ds_read_b64_tr_b16 v[108:109], v196 offset:17536
ds_read_b64_tr_b16 v[110:111], v196 offset:21888
ds_read_b64_tr_b16 v[112:113], v196 offset:17600
ds_read_b64_tr_b16 v[114:115], v196 offset:21952
ds_read_b64_tr_b16 v[116:117], v196 offset:34816
ds_read_b64_tr_b16 v[118:119], v196 offset:39168
ds_read_b64_tr_b16 v[120:121], v196 offset:34880
ds_read_b64_tr_b16 v[122:123], v196 offset:39232
ds_read_b64_tr_b16 v[124:125], v196 offset:34944
ds_read_b64_tr_b16 v[126:127], v196 offset:39296
ds_read_b64_tr_b16 v[128:129], v196 offset:35008
ds_read_b64_tr_b16 v[130:131], v196 offset:39360
ds_read_b64_tr_b16 v[132:133], v196 offset:52224
ds_read_b64_tr_b16 v[134:135], v196 offset:56576
ds_read_b64_tr_b16 v[136:137], v196 offset:52288
ds_read_b64_tr_b16 v[138:139], v196 offset:56640
ds_read_b64_tr_b16 v[140:141], v196 offset:52352
ds_read_b64_tr_b16 v[142:143], v196 offset:56704
ds_read_b64_tr_b16 v[144:145], v196 offset:52416
ds_read_b64_tr_b16 v[146:147], v196 offset:56768
s_waitcnt lgkmcnt(15)
v_mfma_f32_32x32x16_bf16 v[12:27], v[84:87], v[148:151], v[12:27]
v_mfma_f32_32x32x16_bf16 v[28:43], v[88:91], v[148:151], v[28:43]
v_mfma_f32_32x32x16_bf16 v[44:59], v[92:95], v[148:151], v[44:59]
v_mfma_f32_32x32x16_bf16 v[60:75], v[96:99], v[148:151], v[60:75]
s_waitcnt lgkmcnt(15)
v_mfma_f32_32x32x16_bf16 v[12:27], v[100:103], v[152:155], v[12:27]
v_mfma_f32_32x32x16_bf16 v[28:43], v[104:107], v[152:155], v[28:43]
v_mfma_f32_32x32x16_bf16 v[44:59], v[108:111], v[152:155], v[44:59]
v_mfma_f32_32x32x16_bf16 v[60:75], v[112:115], v[152:155], v[60:75]
s_waitcnt lgkmcnt(8)
v_mfma_f32_32x32x16_bf16 v[12:27], v[116:119], v[156:159], v[12:27]
v_mfma_f32_32x32x16_bf16 v[28:43], v[120:123], v[156:159], v[28:43]
v_mfma_f32_32x32x16_bf16 v[44:59], v[124:127], v[156:159], v[44:59]
v_mfma_f32_32x32x16_bf16 v[60:75], v[128:131], v[156:159], v[60:75]
s_waitcnt lgkmcnt(0)
v_mfma_f32_32x32x16_bf16 v[12:27], v[132:135], v[160:163], v[12:27]
v_mfma_f32_32x32x16_bf16 v[28:43], v[136:139], v[160:163], v[28:43]
v_mfma_f32_32x32x16_bf16 v[44:59], v[140:143], v[160:163], v[44:59]
v_mfma_f32_32x32x16_bf16 v[60:75], v[144:147], v[160:163], v[60:75]
ds_read_b128 v[84:87], v195 offset:0
ds_read_b128 v[88:91], v195 offset:64
ds_read_b128 v[92:95], v195 offset:128
ds_read_b128 v[96:99], v195 offset:192
ds_read_b128 v[100:103], v195 offset:256
ds_read_b128 v[104:107], v195 offset:320
ds_read_b128 v[108:111], v195 offset:384
ds_read_b128 v[112:115], v195 offset:448
ds_read_b128 v[116:119], v195 offset:512
ds_read_b128 v[120:123], v195 offset:576
ds_read_b128 v[124:127], v195 offset:640
ds_read_b128 v[128:131], v195 offset:704
ds_read_b128 v[132:135], v195 offset:768
ds_read_b128 v[136:139], v195 offset:832
ds_read_b128 v[140:143], v195 offset:896
ds_read_b128 v[144:147], v195 offset:960
s_waitcnt lgkmcnt(15)
v_mfma_f32_16x16x32_bf16 v[76:79], v[84:87], a[0:3], 0
v_mfma_f32_16x16x32_bf16 v[80:83], v[84:87], a[64:67], 0
s_waitcnt lgkmcnt(14)
v_mfma_f32_16x16x32_bf16 v[76:79], v[88:91], a[4:7], v[76:79]
v_mfma_f32_16x16x32_bf16 v[80:83], v[88:91], a[68:71], v[80:83]
s_waitcnt lgkmcnt(13)
v_mfma_f32_16x16x32_bf16 v[76:79], v[92:95], a[8:11], v[76:79]
v_mfma_f32_16x16x32_bf16 v[80:83], v[92:95], a[72:75], v[80:83]
s_waitcnt lgkmcnt(12)
v_mfma_f32_16x16x32_bf16 v[76:79], v[96:99], a[12:15], v[76:79]
v_mfma_f32_16x16x32_bf16 v[80:83], v[96:99], a[76:79], v[80:83]
s_waitcnt lgkmcnt(11)
v_mfma_f32_16x16x32_bf16 v[76:79], v[100:103], a[16:19], v[76:79]
v_mfma_f32_16x16x32_bf16 v[80:83], v[100:103], a[80:83], v[80:83]
s_waitcnt lgkmcnt(10)
v_mfma_f32_16x16x32_bf16 v[76:79], v[104:107], a[20:23], v[76:79]
v_mfma_f32_16x16x32_bf16 v[80:83], v[104:107], a[84:87], v[80:83]
s_waitcnt lgkmcnt(9)
v_mfma_f32_16x16x32_bf16 v[76:79], v[108:111], a[24:27], v[76:79]
v_mfma_f32_16x16x32_bf16 v[80:83], v[108:111], a[88:91], v[80:83]
s_waitcnt lgkmcnt(8)
v_mfma_f32_16x16x32_bf16 v[76:79], v[112:115], a[28:31], v[76:79]
v_mfma_f32_16x16x32_bf16 v[80:83], v[112:115], a[92:95], v[80:83]
s_waitcnt lgkmcnt(7)
v_mfma_f32_16x16x32_bf16 v[76:79], v[116:119], a[32:35], v[76:79]
v_mfma_f32_16x16x32_bf16 v[80:83], v[116:119], a[96:99], v[80:83]
s_waitcnt lgkmcnt(6)
v_mfma_f32_16x16x32_bf16 v[76:79], v[120:123], a[36:39], v[76:79]
v_mfma_f32_16x16x32_bf16 v[80:83], v[120:123], a[100:103], v[80:83]
s_waitcnt lgkmcnt(5)
v_mfma_f32_16x16x32_bf16 v[76:79], v[124:127], a[40:43], v[76:79]
v_mfma_f32_16x16x32_bf16 v[80:83], v[124:127], a[104:107], v[80:83]
s_waitcnt lgkmcnt(4)
v_mfma_f32_16x16x32_bf16 v[76:79], v[128:131], a[44:47], v[76:79]
v_mfma_f32_16x16x32_bf16 v[80:83], v[128:131], a[108:111], v[80:83]
s_waitcnt lgkmcnt(3)
v_mfma_f32_16x16x32_bf16 v[76:79], v[132:135], a[48:51], v[76:79]
v_mfma_f32_16x16x32_bf16 v[80:83], v[132:135], a[112:115], v[80:83]
s_waitcnt lgkmcnt(2)
v_mfma_f32_16x16x32_bf16 v[76:79], v[136:139], a[52:55], v[76:79]
v_mfma_f32_16x16x32_bf16 v[80:83], v[136:139], a[116:119], v[80:83]
s_waitcnt lgkmcnt(1)
v_mfma_f32_16x16x32_bf16 v[76:79], v[140:143], a[56:59], v[76:79]
v_mfma_f32_16x16x32_bf16 v[80:83], v[140:143], a[120:123], v[80:83]
s_waitcnt lgkmcnt(0)
v_mfma_f32_16x16x32_bf16 v[76:79], v[144:147], a[60:63], v[76:79]
v_mfma_f32_16x16x32_bf16 v[80:83], v[144:147], a[124:127], v[80:83]
s_nop 6
v_max_f32 v190, v76, v77
v_max3_f32 v190, v190, v78, v79
v_mov_b32 v192, v190
s_nop 1
v_permlane16_swap_b32 v190, v192
v_max_f32 v190, v190, v192
v_mov_b32 v192, v190
s_nop 1
v_permlane32_swap_b32 v190, v192
v_max_f32 v190, v190, v192
ds_write_b32 v198, v190 offset:0
v_max_f32 v191, v80, v81
v_max3_f32 v191, v191, v82, v83
v_mov_b32 v192, v191
s_nop 1
v_permlane16_swap_b32 v191, v192
v_max_f32 v191, v191, v192
v_mov_b32 v192, v191
s_nop 1
v_permlane32_swap_b32 v191, v192
v_max_f32 v191, v191, v192
ds_write_b32 v198, v191 offset:256
s_waitcnt lgkmcnt(0)
s_barrier
ds_read_b128 v[164:167], v199
ds_read_b128 v[168:171], v199 offset:256
ds_read_b128 v[172:175], v200
s_waitcnt lgkmcnt(0)
v_max_f32 v164, v164, v165
v_max3_f32 v164, v164, v166, v167
v_mul_f32 v164, v164, v185
v_max_f32 v164, v164, v176
v_sub_f32 v182, v176, v164
v_exp_f32 v182, v182
v_mov_b32 v176, v164
v_max_f32 v168, v168, v169
v_max3_f32 v168, v168, v170, v171
v_mul_f32 v168, v168, v185
v_max_f32 v168, v168, v177
v_sub_f32 v183, v177, v168
v_exp_f32 v183, v183
v_mov_b32 v177, v168
v_max_f32 v172, v172, v173
v_max3_f32 v172, v172, v174, v175
v_mul_f32 v172, v172, v185
v_max_f32 v172, v172, v178
v_sub_f32 v184, v178, v172
v_exp_f32 v184, v184
v_mov_b32 v178, v172
v_fma_f32 v76, v76, v185, -v176
v_fma_f32 v77, v77, v185, -v176
v_fma_f32 v78, v78, v185, -v176
v_fma_f32 v79, v79, v185, -v176
v_exp_f32 v76, v76
v_exp_f32 v77, v77
v_exp_f32 v78, v78
v_exp_f32 v79, v79
v_mul_f32 v180, v180, v182
v_cvt_pk_bf16_f32 v186, v76, v77
v_cvt_pk_bf16_f32 v187, v78, v79
ds_write_b64 v201, v[186:187] offset:0
v_add_f32 v180, v180, v76
v_add_f32 v180, v180, v77
v_add_f32 v180, v180, v78
v_add_f32 v180, v180, v79
v_fma_f32 v80, v80, v185, -v177
v_fma_f32 v81, v81, v185, -v177
v_fma_f32 v82, v82, v185, -v177
v_fma_f32 v83, v83, v185, -v177
v_exp_f32 v80, v80
v_exp_f32 v81, v81
v_exp_f32 v82, v82
v_exp_f32 v83, v83
v_mul_f32 v181, v181, v183
v_cvt_pk_bf16_f32 v188, v80, v81
v_cvt_pk_bf16_f32 v189, v82, v83
ds_write_b64 v201, v[188:189] offset:512
v_add_f32 v181, v181, v80
v_add_f32 v181, v181, v81
v_add_f32 v181, v181, v82
v_add_f32 v181, v181, v83
v_mul_f32 v12, v12, v184
v_mul_f32 v13, v13, v184
v_mul_f32 v14, v14, v184
v_mul_f32 v15, v15, v184
v_mul_f32 v16, v16, v184
v_mul_f32 v17, v17, v184
v_mul_f32 v18, v18, v184
v_mul_f32 v19, v19, v184
v_mul_f32 v20, v20, v184
v_mul_f32 v21, v21, v184
v_mul_f32 v22, v22, v184
v_mul_f32 v23, v23, v184
v_mul_f32 v24, v24, v184
v_mul_f32 v25, v25, v184
v_mul_f32 v26, v26, v184
v_mul_f32 v27, v27, v184
v_mul_f32 v28, v28, v184
v_mul_f32 v29, v29, v184
v_mul_f32 v30, v30, v184
v_mul_f32 v31, v31, v184
v_mul_f32 v32, v32, v184
v_mul_f32 v33, v33, v184
v_mul_f32 v34, v34, v184
v_mul_f32 v35, v35, v184
v_mul_f32 v36, v36, v184
v_mul_f32 v37, v37, v184
v_mul_f32 v38, v38, v184
v_mul_f32 v39, v39, v184
v_mul_f32 v40, v40, v184
v_mul_f32 v41, v41, v184
v_mul_f32 v42, v42, v184
v_mul_f32 v43, v43, v184
v_mul_f32 v44, v44, v184
v_mul_f32 v45, v45, v184
v_mul_f32 v46, v46, v184
v_mul_f32 v47, v47, v184
v_mul_f32 v48, v48, v184
v_mul_f32 v49, v49, v184
v_mul_f32 v50, v50, v184
v_mul_f32 v51, v51, v184
v_mul_f32 v52, v52, v184
v_mul_f32 v53, v53, v184
v_mul_f32 v54, v54, v184
v_mul_f32 v55, v55, v184
v_mul_f32 v56, v56, v184
v_mul_f32 v57, v57, v184
v_mul_f32 v58, v58, v184
v_mul_f32 v59, v59, v184
v_mul_f32 v60, v60, v184
v_mul_f32 v61, v61, v184
v_mul_f32 v62, v62, v184
v_mul_f32 v63, v63, v184
v_mul_f32 v64, v64, v184
v_mul_f32 v65, v65, v184
v_mul_f32 v66, v66, v184
v_mul_f32 v67, v67, v184
v_mul_f32 v68, v68, v184
v_mul_f32 v69, v69, v184
v_mul_f32 v70, v70, v184
v_mul_f32 v71, v71, v184
v_mul_f32 v72, v72, v184
v_mul_f32 v73, v73, v184
v_mul_f32 v74, v74, v184
v_mul_f32 v75, v75, v184
s_waitcnt lgkmcnt(0)
s_barrier
ds_read_b128 v[148:151], v202 offset:0
ds_read_b128 v[152:155], v202 offset:1024
ds_read_b128 v[156:159], v202 offset:2048
ds_read_b128 v[160:163], v202 offset:3072
ds_read_b64_tr_b16 v[84:85], v197 offset:0
ds_read_b64_tr_b16 v[86:87], v197 offset:4352
ds_read_b64_tr_b16 v[88:89], v197 offset:64
ds_read_b64_tr_b16 v[90:91], v197 offset:4416
ds_read_b64_tr_b16 v[92:93], v197 offset:128
ds_read_b64_tr_b16 v[94:95], v197 offset:4480
ds_read_b64_tr_b16 v[96:97], v197 offset:192
ds_read_b64_tr_b16 v[98:99], v197 offset:4544
ds_read_b64_tr_b16 v[100:101], v197 offset:17408
ds_read_b64_tr_b16 v[102:103], v197 offset:21760
ds_read_b64_tr_b16 v[104:105], v197 offset:17472
ds_read_b64_tr_b16 v[106:107], v197 offset:21824
ds_read_b64_tr_b16 v[108:109], v197 offset:17536
ds_read_b64_tr_b16 v[110:111], v197 offset:21888
ds_read_b64_tr_b16 v[112:113], v197 offset:17600
ds_read_b64_tr_b16 v[114:115], v197 offset:21952
ds_read_b64_tr_b16 v[116:117], v197 offset:34816
ds_read_b64_tr_b16 v[118:119], v197 offset:39168
ds_read_b64_tr_b16 v[120:121], v197 offset:34880
ds_read_b64_tr_b16 v[122:123], v197 offset:39232
ds_read_b64_tr_b16 v[124:125], v197 offset:34944
ds_read_b64_tr_b16 v[126:127], v197 offset:39296
ds_read_b64_tr_b16 v[128:129], v197 offset:35008
ds_read_b64_tr_b16 v[130:131], v197 offset:39360
ds_read_b64_tr_b16 v[132:133], v197 offset:52224
ds_read_b64_tr_b16 v[134:135], v197 offset:56576
ds_read_b64_tr_b16 v[136:137], v197 offset:52288
ds_read_b64_tr_b16 v[138:139], v197 offset:56640
ds_read_b64_tr_b16 v[140:141], v197 offset:52352
ds_read_b64_tr_b16 v[142:143], v197 offset:56704
ds_read_b64_tr_b16 v[144:145], v197 offset:52416
ds_read_b64_tr_b16 v[146:147], v197 offset:56768
s_waitcnt lgkmcnt(15)
v_mfma_f32_32x32x16_bf16 v[12:27], v[84:87], v[148:151], v[12:27]
v_mfma_f32_32x32x16_bf16 v[28:43], v[88:91], v[148:151], v[28:43]
v_mfma_f32_32x32x16_bf16 v[44:59], v[92:95], v[148:151], v[44:59]
v_mfma_f32_32x32x16_bf16 v[60:75], v[96:99], v[148:151], v[60:75]
s_waitcnt lgkmcnt(15)
v_mfma_f32_32x32x16_bf16 v[12:27], v[100:103], v[152:155], v[12:27]
v_mfma_f32_32x32x16_bf16 v[28:43], v[104:107], v[152:155], v[28:43]
v_mfma_f32_32x32x16_bf16 v[44:59], v[108:111], v[152:155], v[44:59]
v_mfma_f32_32x32x16_bf16 v[60:75], v[112:115], v[152:155], v[60:75]
s_waitcnt lgkmcnt(8)
v_mfma_f32_32x32x16_bf16 v[12:27], v[116:119], v[156:159], v[12:27]
v_mfma_f32_32x32x16_bf16 v[28:43], v[120:123], v[156:159], v[28:43]
v_mfma_f32_32x32x16_bf16 v[44:59], v[124:127], v[156:159], v[44:59]
v_mfma_f32_32x32x16_bf16 v[60:75], v[128:131], v[156:159], v[60:75]
s_waitcnt lgkmcnt(0)
v_mfma_f32_32x32x16_bf16 v[12:27], v[132:135], v[160:163], v[12:27]
v_mfma_f32_32x32x16_bf16 v[28:43], v[136:139], v[160:163], v[28:43]
v_mfma_f32_32x32x16_bf16 v[44:59], v[140:143], v[160:163], v[44:59]
v_mfma_f32_32x32x16_bf16 v[60:75], v[144:147], v[160:163], v[60:75]
v_mov_b32 v192, v180
s_nop 1
v_permlane16_swap_b32 v180, v192
v_add_f32 v180, v180, v192
v_mov_b32 v192, v180
s_nop 1
v_permlane32_swap_b32 v180, v192
v_add_f32 v180, v180, v192
ds_write_b32 v198, v180 offset:512
v_mov_b32 v192, v181
s_nop 1
v_permlane16_swap_b32 v181, v192
v_add_f32 v181, v181, v192
v_mov_b32 v192, v181
s_nop 1
v_permlane32_swap_b32 v181, v192
v_add_f32 v181, v181, v192
ds_write_b32 v198, v181 offset:768
v_and_b32 v5, 31, v1
v_mul_u32_u24 v5, 1040, v5
v_lshrrev_b32 v6, 5, v1
v_lshl_add_u32 v5, v6, 3, v5
s_lshl_b32 s6, s3, 8
v_add_u32 v5, s6, v5
v_cvt_pk_bf16_f32 v84, v12, v13
v_cvt_pk_bf16_f32 v85, v14, v15
ds_write_b64 v5, v[84:85] offset:0
v_cvt_pk_bf16_f32 v86, v16, v17
v_cvt_pk_bf16_f32 v87, v18, v19
ds_write_b64 v5, v[86:87] offset:16
v_cvt_pk_bf16_f32 v88, v20, v21
v_cvt_pk_bf16_f32 v89, v22, v23
ds_write_b64 v5, v[88:89] offset:32
v_cvt_pk_bf16_f32 v90, v24, v25
v_cvt_pk_bf16_f32 v91, v26, v27
ds_write_b64 v5, v[90:91] offset:48
v_cvt_pk_bf16_f32 v92, v28, v29
v_cvt_pk_bf16_f32 v93, v30, v31
ds_write_b64 v5, v[92:93] offset:64
v_cvt_pk_bf16_f32 v94, v32, v33
v_cvt_pk_bf16_f32 v95, v34, v35
ds_write_b64 v5, v[94:95] offset:80
v_cvt_pk_bf16_f32 v96, v36, v37
v_cvt_pk_bf16_f32 v97, v38, v39
ds_write_b64 v5, v[96:97] offset:96
v_cvt_pk_bf16_f32 v98, v40, v41
v_cvt_pk_bf16_f32 v99, v42, v43
ds_write_b64 v5, v[98:99] offset:112
v_cvt_pk_bf16_f32 v100, v44, v45
v_cvt_pk_bf16_f32 v101, v46, v47
ds_write_b64 v5, v[100:101] offset:128
v_cvt_pk_bf16_f32 v102, v48, v49
v_cvt_pk_bf16_f32 v103, v50, v51
ds_write_b64 v5, v[102:103] offset:144
v_cvt_pk_bf16_f32 v104, v52, v53
v_cvt_pk_bf16_f32 v105, v54, v55
ds_write_b64 v5, v[104:105] offset:160
v_cvt_pk_bf16_f32 v106, v56, v57
v_cvt_pk_bf16_f32 v107, v58, v59
ds_write_b64 v5, v[106:107] offset:176
v_cvt_pk_bf16_f32 v108, v60, v61
v_cvt_pk_bf16_f32 v109, v62, v63
ds_write_b64 v5, v[108:109] offset:192
v_cvt_pk_bf16_f32 v110, v64, v65
v_cvt_pk_bf16_f32 v111, v66, v67
ds_write_b64 v5, v[110:111] offset:208
v_cvt_pk_bf16_f32 v112, v68, v69
v_cvt_pk_bf16_f32 v113, v70, v71
ds_write_b64 v5, v[112:113] offset:224
v_cvt_pk_bf16_f32 v114, v72, v73
v_cvt_pk_bf16_f32 v115, v74, v75
ds_write_b64 v5, v[114:115] offset:240
v_mov_b32 v11, 163824
v_mov_b32 v7, 0
ds_write_b32 v11, v7
s_waitcnt lgkmcnt(0)
s_barrier
s_mul_i32 s6, s3, 8320
v_add_u32 v5, s6, v2
ds_read_b128 v[116:119], v5 offset:0
ds_read_b128 v[120:123], v5 offset:1040
ds_read_b128 v[124:127], v5 offset:2080
ds_read_b128 v[128:131], v5 offset:3120
ds_read_b128 v[132:135], v5 offset:4160
ds_read_b128 v[136:139], v5 offset:5200
ds_read_b128 v[140:143], v5 offset:6240
ds_read_b128 v[144:147], v5 offset:7280
ds_read_b128 v[164:167], v200 offset:512
s_mul_i32 s7, s3, 524288
s_lshl_b32 s6, s80, 10
s_add_u32 s7, s7, s6
s_add_u32 s7, s7, 2097152
s_waitcnt lgkmcnt(8)
s_add_u32 s6, s7, 0
buffer_store_dwordx4 v[116:119], v2, s[64:67], s6 offen sc1
s_waitcnt lgkmcnt(7)
s_add_u32 s6, s7, 98304
buffer_store_dwordx4 v[120:123], v2, s[64:67], s6 offen sc1
s_waitcnt lgkmcnt(6)
s_add_u32 s6, s7, 131072
buffer_store_dwordx4 v[124:127], v2, s[64:67], s6 offen sc1
s_waitcnt lgkmcnt(5)
s_add_u32 s6, s7, 229376
buffer_store_dwordx4 v[128:131], v2, s[64:67], s6 offen sc1
s_waitcnt lgkmcnt(4)
s_add_u32 s6, s7, 262144
buffer_store_dwordx4 v[132:135], v2, s[64:67], s6 offen sc1
s_waitcnt lgkmcnt(3)
s_add_u32 s6, s7, 360448
buffer_store_dwordx4 v[136:139], v2, s[64:67], s6 offen sc1
s_waitcnt lgkmcnt(2)
s_add_u32 s6, s7, 393216
buffer_store_dwordx4 v[140:143], v2, s[64:67], s6 offen sc1
s_waitcnt lgkmcnt(1)
s_add_u32 s6, s7, 491520
buffer_store_dwordx4 v[144:147], v2, s[64:67], s6 offen sc1
s_waitcnt lgkmcnt(0)
v_add_f32 v164, v164, v165
v_add_f32 v166, v166, v167
v_add_f32 v187, v164, v166
v_mov_b32 v186, v178
v_lshlrev_b32 v5, 8, v1
s_mul_i32 s6, s80, 8
s_add_u32 s6, s6, 262144
v_min_u32 v186, -2, v186
v_min_u32 v187, -2, v187
s_waitcnt vmcnt(0)
s_barrier
s_cmp_lg_u32 s3, 0
s_cbranch_scc1 L_nops_21
s_mov_b64 exec, 0xffffffff
buffer_store_dwordx2 v[186:187], v5, s[64:67], s6 offen sc1
s_mov_b64 exec, -1
L_nops_21:
B_final:
s_cmp_eq_u32 s3, 3
s_cbranch_scc1 H_start
s_mov_b32 s14, s9
s_lshr_b32 s7, s3, 1
s_cmp_lg_u32 s3, 1
s_cbranch_scc1 L_w1_22
s_and_b32 s7, s9, 7
s_cmp_ge_u32 s7, 2
s_cbranch_scc1 B_end
s_lshr_b32 s14, s9, 3
s_add_u32 s14, s14, 64
L_w1_22:
s_mul_i32 s15, s14, 57
s_lshr_b32 s15, s15, 10
s_mul_i32 s6, s15, 18
s_sub_u32 s80, s14, s6
s_mul_i32 s81, s15, 73728
s_lshr_b32 s81, s81, s7
s_lshl_b32 s6, s80, 6
s_add_u32 s81, s81, s6
s_mul_i32 s6, s7, 1048576
s_add_u32 s81, s81, s6
s_add_u32 s81, s81, 4194304
v_lshrrev_b32 v5, 2, v1
v_and_b32 v6, 3, v1
v_mul_u32_u24 v44, 1152, v5
v_lshl_add_u32 v44, v6, 4, v44
v_bfe_u32 v5, v1, 2, 2
v_lshl_add_u32 v5, v5, 2, v6
v_lshrrev_b32 v46, 4, v1
v_lshl_add_u32 v45, v46, 6, v5
v_lshrrev_b32 v5, 1, v6
v_mul_u32_u24 v5, 142, v5
v_add_u32 v5, v5, v6
v_lshrrev_b32 v46, 2, v1
v_lshl_add_u32 v5, v46, 1, v5
s_lshr_b32 s6, s80, 2
s_mul_i32 s6, s6, 80
s_lshl_b32 s83, s80, 4
s_add_u32 s83, s83, s6
s_mul_i32 s6, s80, 288
s_sub_u32 s6, s6, 4480
s_cmp_ge_u32 s80, 16
s_cselect_b32 s83, s6, s83
s_cselect_b64 vcc, -1, 0
v_cndmask_b32 v45, v45, v5, vcc
v_lshlrev_b32 v45, 1, v45
s_lshl_b32 s83, s83, 1
s_mul_i32 s6, s15, 2304
s_add_u32 s83, s83, s6
s_mul_i32 s6, s7, 1152
s_add_u32 s83, s83, s6
v_and_b32 v6, 1, v1
v_lshlrev_b32 v6, 4, v6
v_mov_b32 v46, 0x3f80
v_lshlrev_b32 v46, v6, v46
v_bfe_u32 v6, v1, 1, 3
v_cmp_eq_u32 vcc, 0, v6
s_nop 1
v_cndmask_b32 v20, 0, v46, vcc
v_cmp_eq_u32 vcc, 1, v6
s_nop 1
v_cndmask_b32 v21, 0, v46, vcc
v_cmp_eq_u32 vcc, 2, v6
s_nop 1
v_cndmask_b32 v22, 0, v46, vcc
v_cmp_eq_u32 vcc, 3, v6
s_nop 1
v_cndmask_b32 v23, 0, v46, vcc
s_sub_u32 s6, s7, 1
s_mov_b32 s16, -1
s_mov_b32 s17, -1
s_mov_b32 s18, -1
s_mov_b32 s19, -1
s_mov_b32 s20, s6
s_mov_b32 s21, s6
s_mov_b32 s22, s6
s_mov_b32 s23, s6
v_mov_b32 v48, -1
v_mov_b32 v49, -1
v_mov_b32 v50, -1
v_mov_b32 v51, -1
v_mov_b32 v52, -1
v_mov_b32 v53, -1
v_mov_b32 v54, -1
v_mov_b32 v55, -1
v_mov_b32 v56, s6
v_mov_b32 v57, s6
v_mov_b32 v58, s6
v_mov_b32 v59, s6
v_mov_b32 v60, s6
v_mov_b32 v61, s6
v_mov_b32 v62, s6
v_mov_b32 v63, s6
v_mov_b32 v64, -1
v_mov_b32 v65, -1
v_mov_b32 v66, -1
v_mov_b32 v67, -1
v_mov_b32 v68, -1
v_mov_b32 v69, -1
v_mov_b32 v70, -1
v_mov_b32 v71, -1
v_mov_b32 v72, -1
v_mov_b32 v73, -1
v_mov_b32 v74, -1
v_mov_b32 v75, -1
v_mov_b32 v76, -1
v_mov_b32 v77, -1
v_mov_b32 v78, -1
v_mov_b32 v79, -1
v_mov_b32 v80, -1
v_mov_b32 v81, -1
v_mov_b32 v82, -1
v_mov_b32 v83, -1
v_mov_b32 v84, -1
v_mov_b32 v85, -1
v_mov_b32 v86, -1
v_mov_b32 v87, -1
v_mov_b32 v88, -1
v_mov_b32 v89, -1
v_mov_b32 v90, -1
v_mov_b32 v91, -1
v_mov_b32 v92, -1
v_mov_b32 v93, -1
v_mov_b32 v94, -1
v_mov_b32 v95, -1
s_add_u32 s24, s81, 0
s_add_u32 s25, s81, 18432
s_add_u32 s26, s81, 36864
s_add_u32 s27, s81, 55296
s_mov_b32 s7, 400000
v_lshrrev_b32 v5, 3, v1
v_mul_u32_u24 v5, 4608, v5
s_and_b32 s6, s20, 1
v_lshlrev_b32 v5, s6, v5
R_slow:
buffer_load_dword v46, v5, s[64:67], s81 offen sc1
s_waitcnt vmcnt(0)
v_cmp_ne_u32 vcc, -1, v46
s_bcnt1_i32_b64 s6, vcc
s_cmp_ge_u32 s6, 32
s_cbranch_scc1 R_pass
s_sleep 8
s_sub_u32 s7, s7, 1
s_cmp_lg_u32 s7, 1
s_cbranch_scc1 R_slow
R_pass:
s_mov_b64 exec, s[16:17]
s_cbranch_execz L_ld_23
buffer_load_dwordx4 v[64:67], v44, s[64:67], s24 offen sc1
L_ld_23:
s_mov_b64 exec, s[18:19]
s_cbranch_execz L_ld_24
buffer_load_dwordx4 v[68:71], v44, s[64:67], s25 offen sc1
L_ld_24:
s_mov_b64 exec, s[20:21]
s_cbranch_execz L_ld_25
buffer_load_dwordx4 v[72:75], v44, s[64:67], s26 offen sc1
L_ld_25:
s_mov_b64 exec, s[22:23]
s_cbranch_execz L_ld_26
buffer_load_dwordx4 v[76:79], v44, s[64:67], s27 offen sc1
L_ld_26:
s_mov_b64 exec, -1
s_waitcnt vmcnt(0)
s_cmp_eq_u64 s[16:17], 0
s_cbranch_scc1 L_ck_27
v_min_u32 v48, v48, v64
v_min_u32 v49, v49, v65
v_min_u32 v50, v50, v66
v_min_u32 v51, v51, v67
v_max3_u32 v46, v48, v49, v50
v_max_u32 v46, v46, v51
v_cmp_eq_u32 s[16:17], -1, v46
L_ck_27:
s_cmp_eq_u64 s[18:19], 0
s_cbranch_scc1 L_ck_28
v_min_u32 v52, v52, v68
v_min_u32 v53, v53, v69
v_min_u32 v54, v54, v70
v_min_u32 v55, v55, v71
v_max3_u32 v46, v52, v53, v54
v_max_u32 v46, v46, v55
v_cmp_eq_u32 s[18:19], -1, v46
L_ck_28:
s_cmp_eq_u64 s[20:21], 0
s_cbranch_scc1 L_ck_29
v_min_u32 v56, v56, v72
v_min_u32 v57, v57, v73
v_min_u32 v58, v58, v74
v_min_u32 v59, v59, v75
v_max3_u32 v46, v56, v57, v58
v_max_u32 v46, v46, v59
v_cmp_eq_u32 s[20:21], -1, v46
L_ck_29:
s_cmp_eq_u64 s[22:23], 0
s_cbranch_scc1 L_ck_30
v_min_u32 v60, v60, v76
v_min_u32 v61, v61, v77
v_min_u32 v62, v62, v78
v_min_u32 v63, v63, v79
v_max3_u32 v46, v60, v61, v62
v_max_u32 v46, v46, v63
v_cmp_eq_u32 s[22:23], -1, v46
L_ck_30:
s_or_b64 s[28:29], s[16:17], s[18:19]
s_or_b64 s[30:31], s[20:21], s[22:23]
s_or_b64 s[28:29], s[28:29], s[30:31]
s_cbranch_scc0 R_done
s_bcnt1_i32_b64 s6, s[16:17]
s_bcnt1_i32_b64 s28, s[18:19]
s_add_u32 s6, s6, s28
s_bcnt1_i32_b64 s28, s[20:21]
s_add_u32 s6, s6, s28
s_bcnt1_i32_b64 s28, s[22:23]
s_add_u32 s6, s6, s28
s_cmp_le_u32 s6, 48
s_cbranch_scc1 R_fast
s_sub_u32 s7, s7, 1
s_cmp_gt_u32 s7, 1
s_cbranch_scc1 R_pass
R_fast:
s_or_b64 exec, s[16:17], 1
buffer_load_dwordx4 v[64:67], v44, s[64:67], s24 offen sc1
s_or_b64 exec, s[18:19], 1
buffer_load_dwordx4 v[68:71], v44, s[64:67], s25 offen sc1
s_or_b64 exec, s[20:21], 1
buffer_load_dwordx4 v[72:75], v44, s[64:67], s26 offen sc1
s_or_b64 exec, s[22:23], 1
buffer_load_dwordx4 v[76:79], v44, s[64:67], s27 offen sc1
s_mov_b64 exec, -1
s_sleep 5
s_or_b64 exec, s[16:17], 1
buffer_load_dwordx4 v[80:83], v44, s[64:67], s24 offen sc1
s_or_b64 exec, s[18:19], 1
buffer_load_dwordx4 v[84:87], v44, s[64:67], s25 offen sc1
s_or_b64 exec, s[20:21], 1
buffer_load_dwordx4 v[88:91], v44, s[64:67], s26 offen sc1
s_or_b64 exec, s[22:23], 1
buffer_load_dwordx4 v[92:95], v44, s[64:67], s27 offen sc1
s_mov_b64 exec, -1
R_loop:
s_waitcnt vmcnt(4)
s_cmp_eq_u64 s[16:17], 0
s_cbranch_scc1 L_ck_31
v_min_u32 v48, v48, v64
v_min_u32 v49, v49, v65
v_min_u32 v50, v50, v66
v_min_u32 v51, v51, v67
v_max3_u32 v46, v48, v49, v50
v_max_u32 v46, v46, v51
v_cmp_eq_u32 s[16:17], -1, v46
L_ck_31:
s_cmp_eq_u64 s[18:19], 0
s_cbranch_scc1 L_ck_32
v_min_u32 v52, v52, v68
v_min_u32 v53, v53, v69
v_min_u32 v54, v54, v70
v_min_u32 v55, v55, v71
v_max3_u32 v46, v52, v53, v54
v_max_u32 v46, v46, v55
v_cmp_eq_u32 s[18:19], -1, v46
L_ck_32:
s_cmp_eq_u64 s[20:21], 0
s_cbranch_scc1 L_ck_33
v_min_u32 v56, v56, v72
v_min_u32 v57, v57, v73
v_min_u32 v58, v58, v74
v_min_u32 v59, v59, v75
v_max3_u32 v46, v56, v57, v58
v_max_u32 v46, v46, v59
v_cmp_eq_u32 s[20:21], -1, v46
L_ck_33:
s_cmp_eq_u64 s[22:23], 0
s_cbranch_scc1 L_ck_34
v_min_u32 v60, v60, v76
v_min_u32 v61, v61, v77
v_min_u32 v62, v62, v78
v_min_u32 v63, v63, v79
v_max3_u32 v46, v60, v61, v62
v_max_u32 v46, v46, v63
v_cmp_eq_u32 s[22:23], -1, v46
L_ck_34:
s_or_b64 s[28:29], s[16:17], s[18:19]
s_or_b64 s[30:31], s[20:21], s[22:23]
s_or_b64 s[28:29], s[28:29], s[30:31]
s_cbranch_scc0 R_done
s_or_b64 exec, s[16:17], 1
buffer_load_dwordx4 v[64:67], v44, s[64:67], s24 offen sc1
s_or_b64 exec, s[18:19], 1
buffer_load_dwordx4 v[68:71], v44, s[64:67], s25 offen sc1
s_or_b64 exec, s[20:21], 1
buffer_load_dwordx4 v[72:75], v44, s[64:67], s26 offen sc1
s_or_b64 exec, s[22:23], 1
buffer_load_dwordx4 v[76:79], v44, s[64:67], s27 offen sc1
s_mov_b64 exec, -1
s_waitcnt vmcnt(4)
s_cmp_eq_u64 s[16:17], 0
s_cbranch_scc1 L_ck_35
v_min_u32 v48, v48, v80
v_min_u32 v49, v49, v81
v_min_u32 v50, v50, v82
v_min_u32 v51, v51, v83
v_max3_u32 v46, v48, v49, v50
v_max_u32 v46, v46, v51
v_cmp_eq_u32 s[16:17], -1, v46
L_ck_35:
s_cmp_eq_u64 s[18:19], 0
s_cbranch_scc1 L_ck_36
v_min_u32 v52, v52, v84
v_min_u32 v53, v53, v85
v_min_u32 v54, v54, v86
v_min_u32 v55, v55, v87
v_max3_u32 v46, v52, v53, v54
v_max_u32 v46, v46, v55
v_cmp_eq_u32 s[18:19], -1, v46
L_ck_36:
s_cmp_eq_u64 s[20:21], 0
s_cbranch_scc1 L_ck_37
v_min_u32 v56, v56, v88
v_min_u32 v57, v57, v89
v_min_u32 v58, v58, v90
v_min_u32 v59, v59, v91
v_max3_u32 v46, v56, v57, v58
v_max_u32 v46, v46, v59
v_cmp_eq_u32 s[20:21], -1, v46
L_ck_37:
s_cmp_eq_u64 s[22:23], 0
s_cbranch_scc1 L_ck_38
v_min_u32 v60, v60, v92
v_min_u32 v61, v61, v93
v_min_u32 v62, v62, v94
v_min_u32 v63, v63, v95
v_max3_u32 v46, v60, v61, v62
v_max_u32 v46, v46, v63
v_cmp_eq_u32 s[22:23], -1, v46
L_ck_38:
s_or_b64 s[28:29], s[16:17], s[18:19]
s_or_b64 s[30:31], s[20:21], s[22:23]
s_or_b64 s[28:29], s[28:29], s[30:31]
s_cbranch_scc0 R_done
s_or_b64 exec, s[16:17], 1
buffer_load_dwordx4 v[80:83], v44, s[64:67], s24 offen sc1
s_or_b64 exec, s[18:19], 1
buffer_load_dwordx4 v[84:87], v44, s[64:67], s25 offen sc1
s_or_b64 exec, s[20:21], 1
buffer_load_dwordx4 v[88:91], v44, s[64:67], s26 offen sc1
s_or_b64 exec, s[22:23], 1
buffer_load_dwordx4 v[92:95], v44, s[64:67], s27 offen sc1
s_mov_b64 exec, -1
s_sub_u32 s7, s7, 1
s_cmp_gt_i32 s7, 0
s_cbranch_scc1 R_loop
R_done:
v_mfma_f32_16x16x32_bf16 v[12:15], v[20:23], v[48:51], 0
v_mfma_f32_16x16x32_bf16 v[12:15], v[20:23], v[52:55], v[12:15]
v_mfma_f32_16x16x32_bf16 v[12:15], v[20:23], v[56:59], v[12:15]
v_mfma_f32_16x16x32_bf16 v[12:15], v[20:23], v[60:63], v[12:15]
s_nop 7
v_add_f32_dpp v16, v12, v12 row_ror:8 row_mask:0xf bank_mask:0x3
v_add_f32_dpp v17, v13, v13 row_ror:8 row_mask:0xf bank_mask:0x3
v_add_f32_dpp v16, v14, v14 row_ror:8 row_mask:0xf bank_mask:0xc
v_add_f32_dpp v17, v15, v15 row_ror:8 row_mask:0xf bank_mask:0xc
s_nop 0
v_add_f32_dpp v46, v16, v16 row_shl:4 row_mask:0xf bank_mask:0x5
v_add_f32_dpp v46, v17, v17 row_shr:4 row_mask:0xf bank_mask:0xa
s_mov_b64 exec, 0xffffffff
v_cvt_pk_bf16_f32 v46, v46, v46
buffer_store_short v46, v45, s[72:75], s83 offen
s_mov_b64 exec, -1
s_cmp_lg_u32 s3, 0
s_cbranch_scc1 B_fin
ds_write_b32 v11, v11
s_waitcnt lgkmcnt(0)
B_fin:
B_end:
s_endpgm
H_start:
s_lshl_b32 s6, s8, 6
s_add_u32 s6, s6, s4
s_lshl_b32 s6, s6, 20
s_add_u32 s56, s20, s6
s_addc_u32 s57, s21, 0
s_mov_b32 s58, 34603008
s_mov_b32 s59, 0x20000
v_lshlrev_b32 v16, 7, v1
v_and_b32 v17, 4095, v16
v_add_u32 v16, 4096, v16
v_lshrrev_b32 v21, 5, v1
v_mul_u32_u24 v21, 20480, v21
v_add_u32 v17, v17, v21
s_and_b32 s6, s9, 56
v_and_b32 v19, 7, v1
v_add_u32 v19, s6, v19
v_mul_u32_u24 v19, 16, v19
v_add_u32 v19, 393216, v19
s_lshr_b32 s7, s4, 2
s_mul_i32 s7, s7, 4224
v_add_u32 v19, s7, v19
s_mov_b32 s16, 43
s_mov_b32 s17, 43
s_mov_b32 s18, 43
s_mov_b32 s31, 400000
buffer_load_dwordx3 v[12:14], v19, s[64:67], 0 offen sc1
s_waitcnt vmcnt(0)
H_loop:
v_med3_i32 v12, v12, -1, 31
v_med3_i32 v13, v13, -1, 31
v_med3_i32 v14, v14, -1, 31
v_add3_u32 v20, v12, v13, v14
s_nop 1
v_add_u32_dpp v20, v20, v20 row_ror:4 row_mask:0xf bank_mask:0xf
s_nop 1
v_add_u32_dpp v20, v20, v20 row_ror:2 row_mask:0xf bank_mask:0xf
s_nop 1
v_add_u32_dpp v20, v20, v20 row_ror:1 row_mask:0xf bank_mask:0xf
v_lshlrev_b32 v20, 3, v20
s_nop 0
v_readfirstlane_b32 s28, v20
v_readlane_b32 s20, v12, s9
v_readlane_b32 s21, v13, s9
v_readlane_b32 s22, v14, s9
buffer_load_dwordx3 v[12:14], v19, s[64:67], 0 offen sc1
s_mul_i32 s6, s20, 192
s_sub_i32 s24, s28, s6
s_mul_i32 s6, s16, 24
s_add_i32 s24, s24, s6
s_add_i32 s6, s16, -15
s_cmp_ge_i32 s6, s20
s_cselect_b32 s24, s24, -1048576
s_mul_i32 s6, s21, 192
s_sub_i32 s25, s28, s6
s_mul_i32 s6, s17, 24
s_add_i32 s25, s25, s6
s_add_i32 s6, s17, -15
s_cmp_ge_i32 s6, s21
s_cselect_b32 s25, s25, -1048576
s_mul_i32 s6, s22, 192
s_sub_i32 s26, s28, s6
s_mul_i32 s6, s18, 24
s_add_i32 s26, s26, s6
s_add_i32 s6, s18, -15
s_cmp_ge_i32 s6, s22
s_cselect_b32 s26, s26, -1048576
s_cmp_ge_i32 s24, s25
s_cselect_b32 s29, 0, 1
s_max_i32 s30, s24, s25
s_cmp_ge_i32 s30, s26
s_cselect_b32 s29, s29, 2
s_max_i32 s30, s30, s26
s_cmp_eq_i32 s30, -1048576
s_cbranch_scc1 H_end
s_sub_u32 s31, s31, 1
s_cmp_eq_u32 s31, 0
s_cbranch_scc1 H_end
s_cmp_lt_i32 s30, 1416
s_cbranch_scc1 H_idle
s_cmp_eq_u32 s29, 0
s_cselect_b32 s6, s16, s6
s_subb_u32 s16, s16, 0
s_cmp_eq_u32 s29, 1
s_cselect_b32 s6, s17, s6
s_subb_u32 s17, s17, 0
s_cmp_eq_u32 s29, 2
s_cselect_b32 s6, s18, s6
s_subb_u32 s18, s18, 0
s_mul_i32 s6, s6, 24576
s_sub_u32 s6, s6, 32768
s_cmp_eq_u32 s29, 2
s_cselect_b32 s7, 33554432, 0
s_add_u32 s6, s6, s7
s_cmp_eq_u32 s29, 1
s_cselect_b64 vcc, -1, 0
s_cselect_b32 s7, 25, 13
s_lshl_b32 s7, 1, s7
s_add_u32 s7, s7, s6
v_cndmask_b32 v18, v16, v17, vcc
buffer_load_dword v22, v18, s[56:59], s6 offen
buffer_load_dword v23, v18, s[56:59], s7 offen
s_waitcnt vmcnt(2)
s_branch H_loop
H_idle:
ds_read_b32 v21, v11
s_waitcnt vmcnt(0) lgkmcnt(0)
s_sleep 4
v_cmp_eq_u32 vcc, 0, v21
s_cbranch_vccnz H_loop
H_end:
s_branch B_end
.section .rodata,"a"
.p2align 6
.amdhsa_kernel concat_heads__mha_block_cached__compressed_kv_cla__decode_kernel
  .amdhsa_next_free_vgpr 512
  .amdhsa_next_free_sgpr 102
  .amdhsa_accum_offset 256
  .amdhsa_group_segment_fixed_size 0
  .amdhsa_kernarg_size 112
  .amdhsa_user_sgpr_count 2
  .amdhsa_user_sgpr_kernarg_segment_ptr 1
  .amdhsa_system_sgpr_workgroup_id_x 1
.end_amdhsa_kernel
```

```asm
; @launch grid=(256,1,1) block=(256,1,1) lds=163840
.amdgcn_target "amdgcn-amd-amdhsa--gfx950"
.text
.globl concat_heads__mha_block_cached__compressed_kv_cla__decode_kernel
.p2align 8
.type concat_heads__mha_block_cached__compressed_kv_cla__decode_kernel,@function
concat_heads__mha_block_cached__compressed_kv_cla__decode_kernel:
s_cmpk_ge_u32 s2, 256
s_cbranch_scc1 L_exit
s_load_dwordx16 s[16:31], s[0:1], 0
v_lshrrev_b32 v1, 6, v0
s_nop 0
v_readfirstlane_b32 s3, v1
s_and_b32 s6, s2, 7
s_bfe_u32 s7, s2, 0x20003
s_lshl_b32 s4, s6, 2
s_add_u32 s4, s4, s7
s_lshr_b32 s5, s2, 5
s_cbranch_scc0 B_role
s_cmp_eq_u32 s5, 1
s_cbranch_scc1 D_role
A_role:
s_sub_u32 s8, s5, 2
s_lshl2_add_u32 s6, s8, s3
s_mul_i32 s10, s6, 43
s_lshr_b32 s10, s10, 8
s_mul_i32 s7, s10, 6
s_sub_u32 s11, s6, s7
s_and_b32 s83, s10, 1
s_cselect_b32 s7, 5, 1
s_add_u32 s11, s11, s7
s_cmp_ge_u32 s11, 6
s_cselect_b32 s6, 6, 0
s_sub_u32 s11, s11, s6
v_and_b32 v1, 63, v0
v_lshlrev_b32 v2, 4, v1
s_sub_u32 s14, s11, 8
s_lshl_b32 s14, s14, 12
s_mov_b32 s13, s14
s_add_u32 s13, s13, 24576
s_min_u32 s12, s13, 2146435072
s_lshl_b32 s82, s10, 5
s_add_u32 s82, s82, s4
s_lshl_b32 s72, s82, 20
s_lshl_b32 s54, 1, 20
s_lshl_b32 s55, 1, 17
s_waitcnt lgkmcnt(0)
s_add_u32 s52, s18, s72
s_addc_u32 s53, s19, 0
buffer_load_dwordx4 v[136:139], v2, s[52:55], s12 offen offset:0 nt
buffer_load_dwordx4 v[140:143], v2, s[52:55], s12 offen offset:1024 nt
buffer_load_dwordx4 v[144:147], v2, s[52:55], s12 offen offset:2048 nt
buffer_load_dwordx4 v[148:151], v2, s[52:55], s12 offen offset:3072 nt
s_add_u32 s13, s13, 24576
s_min_u32 s12, s13, 2146435072
buffer_load_dwordx4 v[152:155], v2, s[52:55], s12 offen offset:0 nt
buffer_load_dwordx4 v[156:159], v2, s[52:55], s12 offen offset:1024 nt
buffer_load_dwordx4 v[160:163], v2, s[52:55], s12 offen offset:2048 nt
buffer_load_dwordx4 v[164:167], v2, s[52:55], s12 offen offset:3072 nt
s_add_u32 s13, s13, 24576
s_min_u32 s12, s13, 2146435072
s_lshr_b32 s6, s2, 3
s_sub_u32 s6, s6, 8
s_lshl_b32 s6, s6, 2
s_add_u32 s6, s6, s3
s_mul_i32 s6, s6, 49152
s_and_b32 s7, s2, 7
s_lshl_b32 s7, s7, 10
s_add_u32 s75, s6, s7
s_mov_b32 s62, 4718592
s_mov_b32 s63, 0x20000
v_min_u32 v35, 47, v1
v_lshrrev_b32 v36, 3, v35
v_mul_u32_u24 v36, 7168, v36
v_lshl_add_u32 v36, v35, 7, v36
s_mov_b64 s[60:61], s[22:23]
buffer_load_dword v120, v36, s[60:63], s75 offen
s_lshr_b32 s9, s10, 1
s_mul_i32 s6, s9, 3
s_sub_u32 s8, s8, s6
s_mov_b32 s58, 1048576
s_mov_b32 s59, 0x20000
s_mul_i32 s6, s9, 2304
s_mul_i32 s7, s3, 288
s_add_u32 s73, s6, s7
s_sub_u32 s46, 4608, s73
s_mov_b32 s47, 0x20000
s_mul_i32 s6, s3, 1179648
s_lshl_b32 s7, s4, 8
s_add_u32 s74, s6, s7
s_sub_u32 s50, 4718592, s74
s_mov_b32 s51, 0x20000
v_lshrrev_b32 v5, 4, v1
v_and_b32 v6, 15, v1
v_mul_u32_u24 v3, 294912, v5
v_lshl_add_u32 v3, v6, 4, v3
v_mul_u32_u24 v4, 72, v5
v_lshrrev_b32 v6, 3, v6
v_mul_u32_u24 v6, 1152, v6
v_add_u32 v4, v4, v6
s_load_dwordx4 s[40:43], s[0:1], 96
s_add_u32 s44, s16, s73
s_addc_u32 s45, s17, 0
buffer_load_dwordx4 v[40:43], v4, s[44:47], 0 offen offset:0
buffer_load_dwordx4 v[44:47], v4, s[44:47], 0 offen offset:16
buffer_load_dwordx4 v[48:51], v4, s[44:47], 0 offen offset:32
buffer_load_dwordx4 v[52:55], v4, s[44:47], 0 offen offset:48
buffer_load_dwordx2 v[56:57], v4, s[44:47], 0 offen offset:64
s_add_u32 s56, s20, s72
s_addc_u32 s57, s21, 0
s_add_u32 s48, s22, s74
s_addc_u32 s49, s23, 0
s_cmp_lg_u32 s8, 0
s_cbranch_scc1 L_nowq_1
s_waitcnt vmcnt(20)
s_mov_b32 s6, 0
buffer_load_dwordx4 a[96:99], v3, s[48:51], s6 offen
s_mov_b32 s6, 8192
buffer_load_dwordx4 a[100:103], v3, s[48:51], s6 offen
s_mov_b32 s6, 16384
buffer_load_dwordx4 a[104:107], v3, s[48:51], s6 offen
s_mov_b32 s6, 24576
buffer_load_dwordx4 a[108:111], v3, s[48:51], s6 offen
s_mov_b32 s6, 32768
buffer_load_dwordx4 a[112:115], v3, s[48:51], s6 offen
s_mov_b32 s6, 40960
buffer_load_dwordx4 a[116:119], v3, s[48:51], s6 offen
s_mov_b32 s6, 49152
buffer_load_dwordx4 a[120:123], v3, s[48:51], s6 offen
s_mov_b32 s6, 57344
buffer_load_dwordx4 a[124:127], v3, s[48:51], s6 offen
s_mov_b32 s6, 65536
buffer_load_dwordx4 a[128:131], v3, s[48:51], s6 offen
s_mov_b32 s6, 73728
buffer_load_dwordx4 a[132:135], v3, s[48:51], s6 offen
s_mov_b32 s6, 81920
buffer_load_dwordx4 a[136:139], v3, s[48:51], s6 offen
s_mov_b32 s6, 90112
buffer_load_dwordx4 a[140:143], v3, s[48:51], s6 offen
s_mov_b32 s6, 98304
buffer_load_dwordx4 a[144:147], v3, s[48:51], s6 offen
s_mov_b32 s6, 106496
buffer_load_dwordx4 a[148:151], v3, s[48:51], s6 offen
s_mov_b32 s6, 114688
buffer_load_dwordx4 a[152:155], v3, s[48:51], s6 offen
s_mov_b32 s6, 122880
buffer_load_dwordx4 a[156:159], v3, s[48:51], s6 offen
s_mov_b32 s6, 131072
buffer_load_dwordx4 a[160:163], v3, s[48:51], s6 offen
s_mov_b32 s6, 139264
buffer_load_dwordx4 a[164:167], v3, s[48:51], s6 offen
s_mov_b32 s6, 147456
buffer_load_dwordx4 a[168:171], v3, s[48:51], s6 offen
s_mov_b32 s6, 155648
buffer_load_dwordx4 a[172:175], v3, s[48:51], s6 offen
s_mov_b32 s6, 163840
buffer_load_dwordx4 a[176:179], v3, s[48:51], s6 offen
s_mov_b32 s6, 172032
buffer_load_dwordx4 a[180:183], v3, s[48:51], s6 offen
s_mov_b32 s6, 180224
buffer_load_dwordx4 a[184:187], v3, s[48:51], s6 offen
s_mov_b32 s6, 188416
buffer_load_dwordx4 a[188:191], v3, s[48:51], s6 offen
s_mov_b32 s6, 196608
buffer_load_dwordx4 a[192:195], v3, s[48:51], s6 offen
s_mov_b32 s6, 204800
buffer_load_dwordx4 a[196:199], v3, s[48:51], s6 offen
s_mov_b32 s6, 212992
buffer_load_dwordx4 a[200:203], v3, s[48:51], s6 offen
s_mov_b32 s6, 221184
buffer_load_dwordx4 a[204:207], v3, s[48:51], s6 offen
s_mov_b32 s6, 229376
buffer_load_dwordx4 a[208:211], v3, s[48:51], s6 offen
s_mov_b32 s6, 237568
buffer_load_dwordx4 a[212:215], v3, s[48:51], s6 offen
s_mov_b32 s6, 245760
buffer_load_dwordx4 a[216:219], v3, s[48:51], s6 offen
s_mov_b32 s6, 253952
buffer_load_dwordx4 a[220:223], v3, s[48:51], s6 offen
s_mov_b32 s6, 262144
buffer_load_dwordx4 a[224:227], v3, s[48:51], s6 offen
s_mov_b32 s6, 270336
buffer_load_dwordx4 a[228:231], v3, s[48:51], s6 offen
s_mov_b32 s6, 278528
buffer_load_dwordx4 a[232:235], v3, s[48:51], s6 offen
s_mov_b32 s6, 286720
buffer_load_dwordx4 a[236:239], v3, s[48:51], s6 offen
L_nowq_1:
s_waitcnt vmcnt(54)
buffer_load_dwordx4 v[168:171], v2, s[52:55], s12 offen offset:0 nt
buffer_load_dwordx4 v[172:175], v2, s[52:55], s12 offen offset:1024 nt
buffer_load_dwordx4 v[176:179], v2, s[52:55], s12 offen offset:2048 nt
buffer_load_dwordx4 v[180:183], v2, s[52:55], s12 offen offset:3072 nt
s_add_u32 s13, s13, 24576
s_min_u32 s12, s13, 2146435072
s_waitcnt vmcnt(54)
buffer_load_dwordx4 v[184:187], v2, s[52:55], s12 offen offset:0 nt
buffer_load_dwordx4 v[188:191], v2, s[52:55], s12 offen offset:1024 nt
buffer_load_dwordx4 v[192:195], v2, s[52:55], s12 offen offset:2048 nt
buffer_load_dwordx4 v[196:199], v2, s[52:55], s12 offen offset:3072 nt
s_add_u32 s13, s13, 24576
s_min_u32 s12, s13, 2146435072
s_waitcnt vmcnt(54)
buffer_load_dwordx4 v[200:203], v2, s[52:55], s12 offen offset:0 nt
buffer_load_dwordx4 v[204:207], v2, s[52:55], s12 offen offset:1024 nt
buffer_load_dwordx4 v[208:211], v2, s[52:55], s12 offen offset:2048 nt
buffer_load_dwordx4 v[212:215], v2, s[52:55], s12 offen offset:3072 nt
s_add_u32 s13, s13, 24576
s_min_u32 s12, s13, 2146435072
s_cmp_lg_u32 s8, 1
s_cbranch_scc1 L_nowq_2
s_waitcnt vmcnt(20)
s_mov_b32 s6, 0
buffer_load_dwordx4 a[96:99], v3, s[48:51], s6 offen
s_mov_b32 s6, 8192
buffer_load_dwordx4 a[100:103], v3, s[48:51], s6 offen
s_mov_b32 s6, 16384
buffer_load_dwordx4 a[104:107], v3, s[48:51], s6 offen
s_mov_b32 s6, 24576
buffer_load_dwordx4 a[108:111], v3, s[48:51], s6 offen
s_mov_b32 s6, 32768
buffer_load_dwordx4 a[112:115], v3, s[48:51], s6 offen
s_mov_b32 s6, 40960
buffer_load_dwordx4 a[116:119], v3, s[48:51], s6 offen
s_mov_b32 s6, 49152
buffer_load_dwordx4 a[120:123], v3, s[48:51], s6 offen
s_mov_b32 s6, 57344
buffer_load_dwordx4 a[124:127], v3, s[48:51], s6 offen
s_mov_b32 s6, 65536
buffer_load_dwordx4 a[128:131], v3, s[48:51], s6 offen
s_mov_b32 s6, 73728
buffer_load_dwordx4 a[132:135], v3, s[48:51], s6 offen
s_mov_b32 s6, 81920
buffer_load_dwordx4 a[136:139], v3, s[48:51], s6 offen
s_mov_b32 s6, 90112
buffer_load_dwordx4 a[140:143], v3, s[48:51], s6 offen
s_mov_b32 s6, 98304
buffer_load_dwordx4 a[144:147], v3, s[48:51], s6 offen
s_mov_b32 s6, 106496
buffer_load_dwordx4 a[148:151], v3, s[48:51], s6 offen
s_mov_b32 s6, 114688
buffer_load_dwordx4 a[152:155], v3, s[48:51], s6 offen
s_mov_b32 s6, 122880
buffer_load_dwordx4 a[156:159], v3, s[48:51], s6 offen
s_mov_b32 s6, 131072
buffer_load_dwordx4 a[160:163], v3, s[48:51], s6 offen
s_mov_b32 s6, 139264
buffer_load_dwordx4 a[164:167], v3, s[48:51], s6 offen
s_mov_b32 s6, 147456
buffer_load_dwordx4 a[168:171], v3, s[48:51], s6 offen
s_mov_b32 s6, 155648
buffer_load_dwordx4 a[172:175], v3, s[48:51], s6 offen
s_mov_b32 s6, 163840
buffer_load_dwordx4 a[176:179], v3, s[48:51], s6 offen
s_mov_b32 s6, 172032
buffer_load_dwordx4 a[180:183], v3, s[48:51], s6 offen
s_mov_b32 s6, 180224
buffer_load_dwordx4 a[184:187], v3, s[48:51], s6 offen
s_mov_b32 s6, 188416
buffer_load_dwordx4 a[188:191], v3, s[48:51], s6 offen
s_mov_b32 s6, 196608
buffer_load_dwordx4 a[192:195], v3, s[48:51], s6 offen
s_mov_b32 s6, 204800
buffer_load_dwordx4 a[196:199], v3, s[48:51], s6 offen
s_mov_b32 s6, 212992
buffer_load_dwordx4 a[200:203], v3, s[48:51], s6 offen
s_mov_b32 s6, 221184
buffer_load_dwordx4 a[204:207], v3, s[48:51], s6 offen
s_mov_b32 s6, 229376
buffer_load_dwordx4 a[208:211], v3, s[48:51], s6 offen
s_mov_b32 s6, 237568
buffer_load_dwordx4 a[212:215], v3, s[48:51], s6 offen
s_mov_b32 s6, 245760
buffer_load_dwordx4 a[216:219], v3, s[48:51], s6 offen
s_mov_b32 s6, 253952
buffer_load_dwordx4 a[220:223], v3, s[48:51], s6 offen
s_mov_b32 s6, 262144
buffer_load_dwordx4 a[224:227], v3, s[48:51], s6 offen
s_mov_b32 s6, 270336
buffer_load_dwordx4 a[228:231], v3, s[48:51], s6 offen
s_mov_b32 s6, 278528
buffer_load_dwordx4 a[232:235], v3, s[48:51], s6 offen
s_mov_b32 s6, 286720
buffer_load_dwordx4 a[236:239], v3, s[48:51], s6 offen
L_nowq_2:
s_waitcnt vmcnt(54)
buffer_load_dwordx4 v[216:219], v2, s[52:55], s12 offen offset:0 nt
buffer_load_dwordx4 v[220:223], v2, s[52:55], s12 offen offset:1024 nt
buffer_load_dwordx4 v[224:227], v2, s[52:55], s12 offen offset:2048 nt
buffer_load_dwordx4 v[228:231], v2, s[52:55], s12 offen offset:3072 nt
s_add_u32 s13, s13, 24576
s_min_u32 s12, s13, 2146435072
s_waitcnt vmcnt(54)
buffer_load_dwordx4 v[232:235], v2, s[52:55], s12 offen offset:0 nt
buffer_load_dwordx4 v[236:239], v2, s[52:55], s12 offen offset:1024 nt
buffer_load_dwordx4 v[240:243], v2, s[52:55], s12 offen offset:2048 nt
buffer_load_dwordx4 v[244:247], v2, s[52:55], s12 offen offset:3072 nt
s_add_u32 s13, s13, 24576
s_min_u32 s12, s13, 2146435072
s_waitcnt vmcnt(54)
s_add_u32 s34, s14, 24576
s_min_u32 s34, s34, 2146435072
buffer_load_dwordx4 a[0:3], v2, s[56:59], s34 offen offset:0 nt
buffer_load_dwordx4 a[4:7], v2, s[56:59], s34 offen offset:1024 nt
buffer_load_dwordx4 a[8:11], v2, s[56:59], s34 offen offset:2048 nt
buffer_load_dwordx4 a[12:15], v2, s[56:59], s34 offen offset:3072 nt
s_cmp_lg_u32 s8, 2
s_cbranch_scc1 L_nowq_3
s_waitcnt vmcnt(20)
s_mov_b32 s6, 0
buffer_load_dwordx4 a[96:99], v3, s[48:51], s6 offen
s_mov_b32 s6, 8192
buffer_load_dwordx4 a[100:103], v3, s[48:51], s6 offen
s_mov_b32 s6, 16384
buffer_load_dwordx4 a[104:107], v3, s[48:51], s6 offen
s_mov_b32 s6, 24576
buffer_load_dwordx4 a[108:111], v3, s[48:51], s6 offen
s_mov_b32 s6, 32768
buffer_load_dwordx4 a[112:115], v3, s[48:51], s6 offen
s_mov_b32 s6, 40960
buffer_load_dwordx4 a[116:119], v3, s[48:51], s6 offen
s_mov_b32 s6, 49152
buffer_load_dwordx4 a[120:123], v3, s[48:51], s6 offen
s_mov_b32 s6, 57344
buffer_load_dwordx4 a[124:127], v3, s[48:51], s6 offen
s_mov_b32 s6, 65536
buffer_load_dwordx4 a[128:131], v3, s[48:51], s6 offen
s_mov_b32 s6, 73728
buffer_load_dwordx4 a[132:135], v3, s[48:51], s6 offen
s_mov_b32 s6, 81920
buffer_load_dwordx4 a[136:139], v3, s[48:51], s6 offen
s_mov_b32 s6, 90112
buffer_load_dwordx4 a[140:143], v3, s[48:51], s6 offen
s_mov_b32 s6, 98304
buffer_load_dwordx4 a[144:147], v3, s[48:51], s6 offen
s_mov_b32 s6, 106496
buffer_load_dwordx4 a[148:151], v3, s[48:51], s6 offen
s_mov_b32 s6, 114688
buffer_load_dwordx4 a[152:155], v3, s[48:51], s6 offen
s_mov_b32 s6, 122880
buffer_load_dwordx4 a[156:159], v3, s[48:51], s6 offen
s_mov_b32 s6, 131072
buffer_load_dwordx4 a[160:163], v3, s[48:51], s6 offen
s_mov_b32 s6, 139264
buffer_load_dwordx4 a[164:167], v3, s[48:51], s6 offen
s_mov_b32 s6, 147456
buffer_load_dwordx4 a[168:171], v3, s[48:51], s6 offen
s_mov_b32 s6, 155648
buffer_load_dwordx4 a[172:175], v3, s[48:51], s6 offen
s_mov_b32 s6, 163840
buffer_load_dwordx4 a[176:179], v3, s[48:51], s6 offen
s_mov_b32 s6, 172032
buffer_load_dwordx4 a[180:183], v3, s[48:51], s6 offen
s_mov_b32 s6, 180224
buffer_load_dwordx4 a[184:187], v3, s[48:51], s6 offen
s_mov_b32 s6, 188416
buffer_load_dwordx4 a[188:191], v3, s[48:51], s6 offen
s_mov_b32 s6, 196608
buffer_load_dwordx4 a[192:195], v3, s[48:51], s6 offen
s_mov_b32 s6, 204800
buffer_load_dwordx4 a[196:199], v3, s[48:51], s6 offen
s_mov_b32 s6, 212992
buffer_load_dwordx4 a[200:203], v3, s[48:51], s6 offen
s_mov_b32 s6, 221184
buffer_load_dwordx4 a[204:207], v3, s[48:51], s6 offen
s_mov_b32 s6, 229376
buffer_load_dwordx4 a[208:211], v3, s[48:51], s6 offen
s_mov_b32 s6, 237568
buffer_load_dwordx4 a[212:215], v3, s[48:51], s6 offen
s_mov_b32 s6, 245760
buffer_load_dwordx4 a[216:219], v3, s[48:51], s6 offen
s_mov_b32 s6, 253952
buffer_load_dwordx4 a[220:223], v3, s[48:51], s6 offen
s_mov_b32 s6, 262144
buffer_load_dwordx4 a[224:227], v3, s[48:51], s6 offen
s_mov_b32 s6, 270336
buffer_load_dwordx4 a[228:231], v3, s[48:51], s6 offen
s_mov_b32 s6, 278528
buffer_load_dwordx4 a[232:235], v3, s[48:51], s6 offen
s_mov_b32 s6, 286720
buffer_load_dwordx4 a[236:239], v3, s[48:51], s6 offen
L_nowq_3:
s_waitcnt lgkmcnt(0)
s_mov_b32 s64, s42
s_mov_b32 s65, s43
s_mov_b32 s66, 16777216
s_mov_b32 s67, 0x20000
s_mov_b32 s68, s40
s_mov_b32 s69, s41
s_mov_b32 s70, 256
s_mov_b32 s71, 0x20000
s_mul_i32 s6, s4, 147456
s_add_u32 s60, s24, s6
s_addc_u32 s61, s25, 0
s_mov_b32 s62, 147456
s_mov_b32 s63, 0x20000
v_and_b32 v5, 1, v1
v_lshlrev_b32 v5, 4, v5
v_mov_b32 v6, 0xffff
v_lshlrev_b32 v5, v5, v6
v_bfe_u32 v6, v1, 1, 2
v_cmp_eq_u32 vcc, 0, v6
s_nop 1
v_cndmask_b32 v8, 0, v5, vcc
v_cmp_eq_u32 vcc, 1, v6
s_nop 1
v_cndmask_b32 v9, 0, v5, vcc
v_cmp_eq_u32 vcc, 2, v6
s_nop 1
v_cndmask_b32 v10, 0, v5, vcc
v_cmp_eq_u32 vcc, 3, v6
s_nop 1
v_cndmask_b32 v11, 0, v5, vcc
v_mov_b32 v5, 0x0c0c0c0c
s_mov_b32 s6, 0x01000100
s_mov_b32 s7, 0x03020302
v_bfi_b32 v12, v8, s6, v5
v_bfi_b32 v13, v9, s6, v5
v_bfi_b32 v14, v10, s6, v5
v_bfi_b32 v15, v11, s6, v5
v_bfi_b32 v16, v8, s7, v5
v_bfi_b32 v17, v9, s7, v5
v_bfi_b32 v18, v10, s7, v5
v_bfi_b32 v19, v11, s7, v5
v_mov_b32 v7, 0x3e0293ee
v_mov_b32 v86, 0xff800000
v_lshrrev_b32 v5, 4, v1
v_lshlrev_b32 v5, 3, v5
v_bfe_u32 v6, v1, 2, 2
v_add_u32 v5, v5, v6
v_mul_u32_u24 v5, 1152, v5
s_mul_i32 s6, s3, 288
v_add_u32 v5, s6, v5
v_and_b32 v6, 3, v1
v_lshl_add_u32 v88, v6, 5, v5
v_lshl_add_u32 v89, v6, 3, v5
v_add_u32 v89, 256, v89
v_bfe_u32 v6, v1, 3, 1
v_mul_u32_u24 v6, 2176, v6
v_sub_u32 v88, v88, v6
v_lshrrev_b32 v6, 4, v1
v_mul_u32_u24 v6, 4608, v6
v_sub_u32 v88, v88, v6
v_add_u32 v90, 73728, v88
v_add_u32 v91, 73728, v89
s_mul_i32 s82, s82, 64
s_add_u32 s82, s82, 327680
s_mov_b64 s[72:73], 0
s_cmp_ge_u32 s11, 2
s_cselect_b32 s74, 0x22222222, 0
s_mov_b32 s75, s74
s_mov_b32 s76, 0x44444444
s_mov_b32 s77, s76
s_mov_b32 s78, 0x88888888
s_mov_b32 s79, s78
v_bfe_u32 v5, v1, 4, 1
s_lshl_b32 s6, s9, 7
s_lshl_b32 s7, s4, 1
s_add_u32 s6, s6, s7
s_add_u32 s6, s6, s8
v_mul_u32_u24 v6, 63, v5
v_add_u32 v6, s6, v6
v_mul_u32_u24 v92, 1152, v6
v_add_u32 v92, 4194304, v92
v_sub_u32 v6, s8, v5
v_cmp_lt_u32 vcc, 1, v6
v_mov_b32 v6, 2146435072
s_nop 0
v_cndmask_b32 v92, v92, v6, vcc
v_and_b32 v35, 15, v1
v_lshl_add_u32 v92, v35, 4, v92
s_lshl_b32 s6, s3, 5
v_add_u32 v93, s6, v92
s_lshl_b32 s6, s3, 8
v_add_u32 v92, s6, v92
s_lshl_b32 s6, s8, 2
s_add_u32 s6, s6, 0
s_cmp_ge_u32 s6, 6
s_cselect_b32 s6, 1, 0
v_cmp_eq_u32 vcc, s6, v5
s_nop 1
v_cndmask_b32 v106, 0, 1.0, vcc
s_lshl_b32 s6, s8, 2
s_add_u32 s6, s6, 1
s_cmp_ge_u32 s6, 6
s_cselect_b32 s6, 1, 0
v_cmp_eq_u32 vcc, s6, v5
s_nop 1
v_cndmask_b32 v107, 0, 1.0, vcc
s_lshl_b32 s6, s8, 2
s_add_u32 s6, s6, 2
s_cmp_ge_u32 s6, 6
s_cselect_b32 s6, 1, 0
v_cmp_eq_u32 vcc, s6, v5
s_nop 1
v_cndmask_b32 v108, 0, 1.0, vcc
s_lshl_b32 s6, s8, 2
s_add_u32 s6, s6, 3
s_cmp_ge_u32 s6, 6
s_cselect_b32 s6, 1, 0
v_cmp_eq_u32 vcc, s6, v5
s_nop 1
v_cndmask_b32 v109, 0, 1.0, vcc
v_bfe_i32 v35, v1, 3, 1
v_and_b32 v35, 0xaaaaaaaa, v35
v_or_b32 v105, 0x44444444, v35
v_and_b32 v35, 15, v1
v_lshlrev_b32 v35, 4, v35
v_lshl_add_u32 v94, v5, 3, v35
s_lshl_b32 s6, s3, 8
s_add_u32 s6, s6, 151552
v_add_u32 v94, s6, v94
v_and_b32 v35, 3, v1
v_lshlrev_b32 v35, 8, v35
v_lshrrev_b32 v36, 4, v1
v_lshl_add_u32 v95, v36, 4, v35
v_add_u32 v95, 151552, v95
s_mul_i32 s15, s3, 36864
s_mov_b32 s80, 0x0
s_mov_b32 s81, 0
s_lshl_b32 s6, s4, 1
s_add_u32 s6, s6, s9
s_mul_i32 s6, s6, 4
s_add_u32 s6, s6, s8
s_lshl_b32 s6, s6, 2
s_add_u32 s6, s6, 393216
s_lshr_b32 s7, s4, 2
s_mul_i32 s7, s7, 4224
s_add_u32 s6, s6, s7
v_mov_b32 v118, 2146435072
v_mov_b32 v117, s6
v_cmp_eq_u32 vcc, 0, v0
s_nop 1
v_cndmask_b32 v118, v118, v117, vcc
v_mov_b32 v117, 3
v_and_b32 v35, 15, v1
v_lshlrev_b32 v35, 5, v35
v_lshl_add_u32 v36, v5, 4, v35
v_lshrrev_b32 v6, 5, v1
v_lshl_add_u32 v36, v6, 9, v36
s_lshl_b32 s6, s3, 10
s_add_u32 s6, s6, 147456
v_add_u32 v36, s6, v36
s_lshl_b32 s6, s83, 9
s_add_u32 s6, s6, 147456
v_add_u32 v35, s6, v35
s_waitcnt vmcnt(35)
v_perm_b32 v60, v40, v40, v12
v_perm_b32 v61, v40, v40, v13
v_perm_b32 v62, v40, v40, v14
v_perm_b32 v63, v40, v40, v15
s_nop 1
v_mfma_f32_16x16x32_bf16 v[20:23], v[60:63], a[96:99], 0
s_add_u32 s34, s14, 49152
s_min_u32 s34, s34, 2146435072
buffer_load_dwordx4 a[16:19], v2, s[56:59], s34 offen offset:0 nt
s_waitcnt vmcnt(35)
v_perm_b32 v64, v40, v40, v16
v_perm_b32 v65, v40, v40, v17
v_perm_b32 v66, v40, v40, v18
v_perm_b32 v67, v40, v40, v19
s_nop 1
v_mfma_f32_16x16x32_bf16 v[20:23], v[64:67], a[100:103], v[20:23]
buffer_load_dwordx4 a[20:23], v2, s[56:59], s34 offen offset:1024 nt
s_waitcnt vmcnt(35)
v_perm_b32 v68, v41, v41, v12
v_perm_b32 v69, v41, v41, v13
v_perm_b32 v70, v41, v41, v14
v_perm_b32 v71, v41, v41, v15
s_nop 1
v_mfma_f32_16x16x32_bf16 v[20:23], v[68:71], a[104:107], v[20:23]
buffer_load_dwordx4 a[24:27], v2, s[56:59], s34 offen offset:2048 nt
s_waitcnt vmcnt(35)
v_perm_b32 v72, v41, v41, v16
v_perm_b32 v73, v41, v41, v17
v_perm_b32 v74, v41, v41, v18
v_perm_b32 v75, v41, v41, v19
s_nop 1
v_mfma_f32_16x16x32_bf16 v[20:23], v[72:75], a[108:111], v[20:23]
buffer_load_dwordx4 a[28:31], v2, s[56:59], s34 offen offset:3072 nt
s_waitcnt vmcnt(35)
v_perm_b32 v60, v42, v42, v12
v_perm_b32 v61, v42, v42, v13
v_perm_b32 v62, v42, v42, v14
v_perm_b32 v63, v42, v42, v15
s_nop 1
v_mfma_f32_16x16x32_bf16 v[20:23], v[60:63], a[112:115], v[20:23]
s_add_u32 s34, s14, 73728
s_min_u32 s34, s34, 2146435072
buffer_load_dwordx4 a[32:35], v2, s[56:59], s34 offen offset:0 nt
s_waitcnt vmcnt(35)
v_perm_b32 v64, v42, v42, v16
v_perm_b32 v65, v42, v42, v17
v_perm_b32 v66, v42, v42, v18
v_perm_b32 v67, v42, v42, v19
s_nop 1
v_mfma_f32_16x16x32_bf16 v[20:23], v[64:67], a[116:119], v[20:23]
buffer_load_dwordx4 a[36:39], v2, s[56:59], s34 offen offset:1024 nt
s_waitcnt vmcnt(35)
v_perm_b32 v68, v43, v43, v12
v_perm_b32 v69, v43, v43, v13
v_perm_b32 v70, v43, v43, v14
v_perm_b32 v71, v43, v43, v15
s_nop 1
v_mfma_f32_16x16x32_bf16 v[20:23], v[68:71], a[120:123], v[20:23]
buffer_load_dwordx4 a[40:43], v2, s[56:59], s34 offen offset:2048 nt
s_waitcnt vmcnt(35)
v_perm_b32 v72, v43, v43, v16
v_perm_b32 v73, v43, v43, v17
v_perm_b32 v74, v43, v43, v18
v_perm_b32 v75, v43, v43, v19
s_nop 1
v_mfma_f32_16x16x32_bf16 v[20:23], v[72:75], a[124:127], v[20:23]
buffer_load_dwordx4 a[44:47], v2, s[56:59], s34 offen offset:3072 nt
s_waitcnt vmcnt(35)
v_perm_b32 v60, v44, v44, v12
v_perm_b32 v61, v44, v44, v13
v_perm_b32 v62, v44, v44, v14
v_perm_b32 v63, v44, v44, v15
s_nop 1
v_mfma_f32_16x16x32_bf16 v[20:23], v[60:63], a[128:131], v[20:23]
s_add_u32 s34, s14, 98304
s_min_u32 s34, s34, 2146435072
buffer_load_dwordx4 a[48:51], v2, s[56:59], s34 offen offset:0 nt
s_waitcnt vmcnt(35)
v_perm_b32 v64, v44, v44, v16
v_perm_b32 v65, v44, v44, v17
v_perm_b32 v66, v44, v44, v18
v_perm_b32 v67, v44, v44, v19
s_nop 1
v_mfma_f32_16x16x32_bf16 v[20:23], v[64:67], a[132:135], v[20:23]
buffer_load_dwordx4 a[52:55], v2, s[56:59], s34 offen offset:1024 nt
s_waitcnt vmcnt(35)
v_perm_b32 v68, v45, v45, v12
v_perm_b32 v69, v45, v45, v13
v_perm_b32 v70, v45, v45, v14
v_perm_b32 v71, v45, v45, v15
s_nop 1
v_mfma_f32_16x16x32_bf16 v[20:23], v[68:71], a[136:139], v[20:23]
buffer_load_dwordx4 a[56:59], v2, s[56:59], s34 offen offset:2048 nt
s_waitcnt vmcnt(35)
v_perm_b32 v72, v45, v45, v16
v_perm_b32 v73, v45, v45, v17
v_perm_b32 v74, v45, v45, v18
v_perm_b32 v75, v45, v45, v19
s_nop 1
v_mfma_f32_16x16x32_bf16 v[20:23], v[72:75], a[140:143], v[20:23]
buffer_load_dwordx4 a[60:63], v2, s[56:59], s34 offen offset:3072 nt
s_waitcnt vmcnt(35)
v_perm_b32 v60, v46, v46, v12
v_perm_b32 v61, v46, v46, v13
v_perm_b32 v62, v46, v46, v14
v_perm_b32 v63, v46, v46, v15
s_nop 1
v_mfma_f32_16x16x32_bf16 v[20:23], v[60:63], a[144:147], v[20:23]
s_add_u32 s34, s14, 122880
s_min_u32 s34, s34, 2146435072
buffer_load_dwordx4 a[64:67], v2, s[56:59], s34 offen offset:0 nt
s_waitcnt vmcnt(35)
v_perm_b32 v64, v46, v46, v16
v_perm_b32 v65, v46, v46, v17
v_perm_b32 v66, v46, v46, v18
v_perm_b32 v67, v46, v46, v19
s_nop 1
v_mfma_f32_16x16x32_bf16 v[20:23], v[64:67], a[148:151], v[20:23]
buffer_load_dwordx4 a[68:71], v2, s[56:59], s34 offen offset:1024 nt
s_waitcnt vmcnt(35)
v_perm_b32 v68, v47, v47, v12
v_perm_b32 v69, v47, v47, v13
v_perm_b32 v70, v47, v47, v14
v_perm_b32 v71, v47, v47, v15
s_nop 1
v_mfma_f32_16x16x32_bf16 v[20:23], v[68:71], a[152:155], v[20:23]
buffer_load_dwordx4 a[72:75], v2, s[56:59], s34 offen offset:2048 nt
s_waitcnt vmcnt(35)
v_perm_b32 v72, v47, v47, v16
v_perm_b32 v73, v47, v47, v17
v_perm_b32 v74, v47, v47, v18
v_perm_b32 v75, v47, v47, v19
s_nop 1
v_mfma_f32_16x16x32_bf16 v[20:23], v[72:75], a[156:159], v[20:23]
buffer_load_dwordx4 a[76:79], v2, s[56:59], s34 offen offset:3072 nt
s_waitcnt vmcnt(35)
v_perm_b32 v60, v48, v48, v12
v_perm_b32 v61, v48, v48, v13
v_perm_b32 v62, v48, v48, v14
v_perm_b32 v63, v48, v48, v15
s_nop 1
v_mfma_f32_16x16x32_bf16 v[20:23], v[60:63], a[160:163], v[20:23]
s_add_u32 s34, s14, 147456
s_min_u32 s34, s34, 2146435072
buffer_load_dwordx4 a[80:83], v2, s[56:59], s34 offen offset:0 nt
s_waitcnt vmcnt(35)
v_perm_b32 v64, v48, v48, v16
v_perm_b32 v65, v48, v48, v17
v_perm_b32 v66, v48, v48, v18
v_perm_b32 v67, v48, v48, v19
s_nop 1
v_mfma_f32_16x16x32_bf16 v[20:23], v[64:67], a[164:167], v[20:23]
buffer_load_dwordx4 a[84:87], v2, s[56:59], s34 offen offset:1024 nt
s_waitcnt vmcnt(35)
v_perm_b32 v68, v49, v49, v12
v_perm_b32 v69, v49, v49, v13
v_perm_b32 v70, v49, v49, v14
v_perm_b32 v71, v49, v49, v15
s_nop 1
v_mfma_f32_16x16x32_bf16 v[20:23], v[68:71], a[168:171], v[20:23]
buffer_load_dwordx4 a[88:91], v2, s[56:59], s34 offen offset:2048 nt
s_waitcnt vmcnt(35)
v_perm_b32 v72, v49, v49, v16
v_perm_b32 v73, v49, v49, v17
v_perm_b32 v74, v49, v49, v18
v_perm_b32 v75, v49, v49, v19
s_nop 1
v_mfma_f32_16x16x32_bf16 v[20:23], v[72:75], a[172:175], v[20:23]
buffer_load_dwordx4 a[92:95], v2, s[56:59], s34 offen offset:3072 nt
s_waitcnt vmcnt(35)
v_perm_b32 v60, v50, v50, v12
v_perm_b32 v61, v50, v50, v13
v_perm_b32 v62, v50, v50, v14
v_perm_b32 v63, v50, v50, v15
s_nop 1
v_mfma_f32_16x16x32_bf16 v[20:23], v[60:63], a[176:179], v[20:23]
s_add_u32 s34, s14, 172032
s_min_u32 s34, s34, 2146435072
buffer_load_dwordx4 a[240:243], v2, s[56:59], s34 offen offset:0 nt
s_waitcnt vmcnt(35)
v_perm_b32 v64, v50, v50, v16
v_perm_b32 v65, v50, v50, v17
v_perm_b32 v66, v50, v50, v18
v_perm_b32 v67, v50, v50, v19
s_nop 1
v_mfma_f32_16x16x32_bf16 v[20:23], v[64:67], a[180:183], v[20:23]
buffer_load_dwordx4 a[244:247], v2, s[56:59], s34 offen offset:1024 nt
s_waitcnt vmcnt(35)
v_perm_b32 v68, v51, v51, v12
v_perm_b32 v69, v51, v51, v13
v_perm_b32 v70, v51, v51, v14
v_perm_b32 v71, v51, v51, v15
s_nop 1
v_mfma_f32_16x16x32_bf16 v[20:23], v[68:71], a[184:187], v[20:23]
buffer_load_dwordx4 a[248:251], v2, s[56:59], s34 offen offset:2048 nt
s_waitcnt vmcnt(35)
v_perm_b32 v72, v51, v51, v16
v_perm_b32 v73, v51, v51, v17
v_perm_b32 v74, v51, v51, v18
v_perm_b32 v75, v51, v51, v19
s_nop 1
v_mfma_f32_16x16x32_bf16 v[20:23], v[72:75], a[188:191], v[20:23]
buffer_load_dwordx4 a[252:255], v2, s[56:59], s34 offen offset:3072 nt
s_waitcnt vmcnt(35)
v_perm_b32 v60, v52, v52, v12
v_perm_b32 v61, v52, v52, v13
v_perm_b32 v62, v52, v52, v14
v_perm_b32 v63, v52, v52, v15
s_nop 1
v_mfma_f32_16x16x32_bf16 v[20:23], v[60:63], a[192:195], v[20:23]
s_waitcnt vmcnt(34)
v_perm_b32 v64, v52, v52, v16
v_perm_b32 v65, v52, v52, v17
v_perm_b32 v66, v52, v52, v18
v_perm_b32 v67, v52, v52, v19
s_nop 1
v_mfma_f32_16x16x32_bf16 v[20:23], v[64:67], a[196:199], v[20:23]
s_waitcnt vmcnt(33)
v_perm_b32 v68, v53, v53, v12
v_perm_b32 v69, v53, v53, v13
v_perm_b32 v70, v53, v53, v14
v_perm_b32 v71, v53, v53, v15
s_nop 1
v_mfma_f32_16x16x32_bf16 v[20:23], v[68:71], a[200:203], v[20:23]
s_waitcnt vmcnt(32)
v_perm_b32 v72, v53, v53, v16
v_perm_b32 v73, v53, v53, v17
v_perm_b32 v74, v53, v53, v18
v_perm_b32 v75, v53, v53, v19
s_nop 1
v_mfma_f32_16x16x32_bf16 v[20:23], v[72:75], a[204:207], v[20:23]
s_waitcnt vmcnt(31)
v_perm_b32 v60, v54, v54, v12
v_perm_b32 v61, v54, v54, v13
v_perm_b32 v62, v54, v54, v14
v_perm_b32 v63, v54, v54, v15
s_nop 1
v_mfma_f32_16x16x32_bf16 v[20:23], v[60:63], a[208:211], v[20:23]
s_waitcnt vmcnt(30)
v_perm_b32 v64, v54, v54, v16
v_perm_b32 v65, v54, v54, v17
v_perm_b32 v66, v54, v54, v18
v_perm_b32 v67, v54, v54, v19
s_nop 1
v_mfma_f32_16x16x32_bf16 v[20:23], v[64:67], a[212:215], v[20:23]
s_waitcnt vmcnt(29)
v_perm_b32 v68, v55, v55, v12
v_perm_b32 v69, v55, v55, v13
v_perm_b32 v70, v55, v55, v14
v_perm_b32 v71, v55, v55, v15
s_nop 1
v_mfma_f32_16x16x32_bf16 v[20:23], v[68:71], a[216:219], v[20:23]
s_waitcnt vmcnt(28)
v_perm_b32 v72, v55, v55, v16
v_perm_b32 v73, v55, v55, v17
v_perm_b32 v74, v55, v55, v18
v_perm_b32 v75, v55, v55, v19
s_nop 1
v_mfma_f32_16x16x32_bf16 v[20:23], v[72:75], a[220:223], v[20:23]
s_waitcnt vmcnt(27)
v_perm_b32 v60, v56, v56, v12
v_perm_b32 v61, v56, v56, v13
v_perm_b32 v62, v56, v56, v14
v_perm_b32 v63, v56, v56, v15
s_nop 1
v_mfma_f32_16x16x32_bf16 v[20:23], v[60:63], a[224:227], v[20:23]
s_waitcnt vmcnt(26)
v_perm_b32 v64, v56, v56, v16
v_perm_b32 v65, v56, v56, v17
v_perm_b32 v66, v56, v56, v18
v_perm_b32 v67, v56, v56, v19
s_nop 1
v_mfma_f32_16x16x32_bf16 v[20:23], v[64:67], a[228:231], v[20:23]
s_waitcnt vmcnt(25)
v_perm_b32 v68, v57, v57, v12
v_perm_b32 v69, v57, v57, v13
v_perm_b32 v70, v57, v57, v14
v_perm_b32 v71, v57, v57, v15
s_nop 1
v_mfma_f32_16x16x32_bf16 v[20:23], v[68:71], a[232:235], v[20:23]
s_waitcnt vmcnt(24)
v_perm_b32 v72, v57, v57, v16
v_perm_b32 v73, v57, v57, v17
v_perm_b32 v74, v57, v57, v18
v_perm_b32 v75, v57, v57, v19
s_nop 1
v_mfma_f32_16x16x32_bf16 v[20:23], v[72:75], a[236:239], v[20:23]
s_nop 7
ds_write_b128 v36, v[20:23]
s_waitcnt lgkmcnt(0)
s_barrier
ds_read_b128 v[40:43], v35 offset:0
ds_read_b128 v[44:47], v35 offset:16
ds_read_b128 v[48:51], v35 offset:1024
ds_read_b128 v[52:55], v35 offset:1040
ds_read_b128 v[56:59], v35 offset:2048
ds_read_b128 v[60:63], v35 offset:2064
ds_read_b128 v[64:67], v35 offset:3072
ds_read_b128 v[68:71], v35 offset:3088
v_mov_b32 v20, 0
v_mov_b32 v21, 0
v_mov_b32 v22, 0
v_mov_b32 v23, 0
s_waitcnt lgkmcnt(0)
v_add_f32 v40, v40, v48
v_add_f32 v56, v56, v64
v_add_f32 v41, v41, v49
v_add_f32 v57, v57, v65
v_add_f32 v42, v42, v50
v_add_f32 v58, v58, v66
v_add_f32 v43, v43, v51
v_add_f32 v59, v59, v67
v_add_f32 v44, v44, v52
v_add_f32 v60, v60, v68
v_add_f32 v45, v45, v53
v_add_f32 v61, v61, v69
v_add_f32 v46, v46, v54
v_add_f32 v62, v62, v70
v_add_f32 v47, v47, v55
v_add_f32 v63, v63, v71
v_add_f32 v40, v40, v56
v_add_f32 v41, v41, v57
v_add_f32 v42, v42, v58
v_add_f32 v43, v43, v59
v_add_f32 v44, v44, v60
v_add_f32 v45, v45, v61
v_add_f32 v46, v46, v62
v_add_f32 v47, v47, v63
v_cvt_pk_bf16_f32 v24, v40, v41
v_cvt_pk_bf16_f32 v25, v42, v43
v_cvt_pk_bf16_f32 v26, v44, v45
v_cvt_pk_bf16_f32 v27, v46, v47
s_add_u32 s14, s14, 196608
K_loop:
s_cmp_lg_u32 s81, 8
s_cbranch_scc1 L_c0_4
buffer_load_dword v96, off, s[68:71], 0 offset:0 sc1
L_c0_4:
s_waitcnt vmcnt(28)
v_dot2_f32_bf16 v28, v120, v24, 0
v_dot2_f32_bf16 v29, v124, v24, 0
v_dot2_f32_bf16 v30, v128, v24, 0
v_dot2_f32_bf16 v31, v132, v24, 0
v_dot2_f32_bf16 v28, v121, v25, v28
v_dot2_f32_bf16 v29, v125, v25, v29
v_dot2_f32_bf16 v30, v129, v25, v30
v_dot2_f32_bf16 v31, v133, v25, v31
v_dot2_f32_bf16 v28, v122, v26, v28
v_dot2_f32_bf16 v29, v126, v26, v29
v_dot2_f32_bf16 v30, v130, v26, v30
v_dot2_f32_bf16 v31, v134, v26, v31
v_dot2_f32_bf16 v28, v123, v27, v28
v_dot2_f32_bf16 v29, v127, v27, v29
v_dot2_f32_bf16 v30, v131, v27, v30
v_dot2_f32_bf16 v31, v135, v27, v31
buffer_load_dwordx4 v[120:123], v2, s[52:55], s12 offen offset:0 nt
buffer_load_dwordx4 v[124:127], v2, s[52:55], s12 offen offset:1024 nt
buffer_load_dwordx4 v[128:131], v2, s[52:55], s12 offen offset:2048 nt
buffer_load_dwordx4 v[132:135], v2, s[52:55], s12 offen offset:3072 nt
s_add_u32 s13, s13, 24576
s_min_u32 s12, s13, 2146435072
s_cmp_ge_u32 s80, 36
s_cbranch_scc1 L_nodma_5
s_mov_b32 m0, s15
s_nop 0
buffer_load_dwordx4 v2, s[60:63], s15 offen  lds
s_add_u32 s15, s15, 1024
L_nodma_5:
s_add_u32 s80, s80, 1
v_add_f32_dpp v32, v28, v28 row_ror:8 row_mask:0xf bank_mask:0x3
v_add_f32_dpp v33, v29, v29 row_ror:8 row_mask:0xf bank_mask:0x3
v_add_f32_dpp v32, v30, v30 row_ror:8 row_mask:0xf bank_mask:0xc
v_add_f32_dpp v33, v31, v31 row_ror:8 row_mask:0xf bank_mask:0xc
s_nop 0
v_add_f32_dpp v34, v32, v32 row_half_mirror row_mask:0xf bank_mask:0x5
v_add_f32_dpp v34, v33, v33 row_half_mirror row_mask:0xf bank_mask:0xa
s_nop 1
v_add_f32_dpp v34, v34, v34 quad_perm:[1,0,3,2] row_mask:0xf bank_mask:0xf
s_nop 1
v_add_f32_dpp v34, v34, v34 quad_perm:[2,3,0,1] row_mask:0xf bank_mask:0xf
v_cndmask_b32 v86, v86, v34, s[72:73]
s_waitcnt vmcnt(28)
v_dot2_f32_bf16 v28, v136, v24, 0
v_dot2_f32_bf16 v29, v140, v24, 0
v_dot2_f32_bf16 v30, v144, v24, 0
v_dot2_f32_bf16 v31, v148, v24, 0
v_dot2_f32_bf16 v28, v137, v25, v28
v_dot2_f32_bf16 v29, v141, v25, v29
v_dot2_f32_bf16 v30, v145, v25, v30
v_dot2_f32_bf16 v31, v149, v25, v31
v_dot2_f32_bf16 v28, v138, v26, v28
v_dot2_f32_bf16 v29, v142, v26, v29
v_dot2_f32_bf16 v30, v146, v26, v30
v_dot2_f32_bf16 v31, v150, v26, v31
v_dot2_f32_bf16 v28, v139, v27, v28
v_dot2_f32_bf16 v29, v143, v27, v29
v_dot2_f32_bf16 v30, v147, v27, v30
v_dot2_f32_bf16 v31, v151, v27, v31
buffer_load_dwordx4 v[136:139], v2, s[52:55], s12 offen offset:0 nt
buffer_load_dwordx4 v[140:143], v2, s[52:55], s12 offen offset:1024 nt
buffer_load_dwordx4 v[144:147], v2, s[52:55], s12 offen offset:2048 nt
buffer_load_dwordx4 v[148:151], v2, s[52:55], s12 offen offset:3072 nt
s_add_u32 s13, s13, 24576
s_min_u32 s12, s13, 2146435072
s_cmp_ge_u32 s80, 36
s_cbranch_scc1 L_nodma_6
s_mov_b32 m0, s15
s_nop 0
buffer_load_dwordx4 v2, s[60:63], s15 offen  lds
s_add_u32 s15, s15, 1024
L_nodma_6:
s_add_u32 s80, s80, 1
v_add_f32_dpp v32, v28, v28 row_ror:8 row_mask:0xf bank_mask:0x3
v_add_f32_dpp v33, v29, v29 row_ror:8 row_mask:0xf bank_mask:0x3
v_add_f32_dpp v32, v30, v30 row_ror:8 row_mask:0xf bank_mask:0xc
v_add_f32_dpp v33, v31, v31 row_ror:8 row_mask:0xf bank_mask:0xc
s_nop 0
v_add_f32_dpp v34, v32, v32 row_half_mirror row_mask:0xf bank_mask:0x5
v_add_f32_dpp v34, v33, v33 row_half_mirror row_mask:0xf bank_mask:0xa
s_nop 1
v_add_f32_dpp v34, v34, v34 quad_perm:[1,0,3,2] row_mask:0xf bank_mask:0xf
s_nop 1
v_add_f32_dpp v34, v34, v34 quad_perm:[2,3,0,1] row_mask:0xf bank_mask:0xf
v_cndmask_b32 v86, v86, v34, s[74:75]
s_waitcnt vmcnt(28)
v_dot2_f32_bf16 v28, v152, v24, 0
v_dot2_f32_bf16 v29, v156, v24, 0
v_dot2_f32_bf16 v30, v160, v24, 0
v_dot2_f32_bf16 v31, v164, v24, 0
v_dot2_f32_bf16 v28, v153, v25, v28
v_dot2_f32_bf16 v29, v157, v25, v29
v_dot2_f32_bf16 v30, v161, v25, v30
v_dot2_f32_bf16 v31, v165, v25, v31
v_dot2_f32_bf16 v28, v154, v26, v28
v_dot2_f32_bf16 v29, v158, v26, v29
v_dot2_f32_bf16 v30, v162, v26, v30
v_dot2_f32_bf16 v31, v166, v26, v31
v_dot2_f32_bf16 v28, v155, v27, v28
v_dot2_f32_bf16 v29, v159, v27, v29
v_dot2_f32_bf16 v30, v163, v27, v30
v_dot2_f32_bf16 v31, v167, v27, v31
buffer_load_dwordx4 v[152:155], v2, s[52:55], s12 offen offset:0 nt
buffer_load_dwordx4 v[156:159], v2, s[52:55], s12 offen offset:1024 nt
buffer_load_dwordx4 v[160:163], v2, s[52:55], s12 offen offset:2048 nt
buffer_load_dwordx4 v[164:167], v2, s[52:55], s12 offen offset:3072 nt
s_add_u32 s13, s13, 24576
s_min_u32 s12, s13, 2146435072
s_cmp_ge_u32 s80, 36
s_cbranch_scc1 L_nodma_7
s_mov_b32 m0, s15
s_nop 0
buffer_load_dwordx4 v2, s[60:63], s15 offen  lds
s_add_u32 s15, s15, 1024
L_nodma_7:
s_add_u32 s80, s80, 1
v_add_f32_dpp v32, v28, v28 row_ror:8 row_mask:0xf bank_mask:0x3
v_add_f32_dpp v33, v29, v29 row_ror:8 row_mask:0xf bank_mask:0x3
v_add_f32_dpp v32, v30, v30 row_ror:8 row_mask:0xf bank_mask:0xc
v_add_f32_dpp v33, v31, v31 row_ror:8 row_mask:0xf bank_mask:0xc
s_nop 0
v_add_f32_dpp v34, v32, v32 row_half_mirror row_mask:0xf bank_mask:0x5
v_add_f32_dpp v34, v33, v33 row_half_mirror row_mask:0xf bank_mask:0xa
s_nop 1
v_add_f32_dpp v34, v34, v34 quad_perm:[1,0,3,2] row_mask:0xf bank_mask:0xf
s_nop 1
v_add_f32_dpp v34, v34, v34 quad_perm:[2,3,0,1] row_mask:0xf bank_mask:0xf
v_cndmask_b32 v86, v86, v34, s[76:77]
s_waitcnt vmcnt(28)
v_dot2_f32_bf16 v28, v168, v24, 0
v_dot2_f32_bf16 v29, v172, v24, 0
v_dot2_f32_bf16 v30, v176, v24, 0
v_dot2_f32_bf16 v31, v180, v24, 0
v_dot2_f32_bf16 v28, v169, v25, v28
v_dot2_f32_bf16 v29, v173, v25, v29
v_dot2_f32_bf16 v30, v177, v25, v30
v_dot2_f32_bf16 v31, v181, v25, v31
v_dot2_f32_bf16 v28, v170, v26, v28
v_dot2_f32_bf16 v29, v174, v26, v29
v_dot2_f32_bf16 v30, v178, v26, v30
v_dot2_f32_bf16 v31, v182, v26, v31
v_dot2_f32_bf16 v28, v171, v27, v28
v_dot2_f32_bf16 v29, v175, v27, v29
v_dot2_f32_bf16 v30, v179, v27, v30
v_dot2_f32_bf16 v31, v183, v27, v31
buffer_load_dwordx4 v[168:171], v2, s[52:55], s12 offen offset:0 nt
buffer_load_dwordx4 v[172:175], v2, s[52:55], s12 offen offset:1024 nt
buffer_load_dwordx4 v[176:179], v2, s[52:55], s12 offen offset:2048 nt
buffer_load_dwordx4 v[180:183], v2, s[52:55], s12 offen offset:3072 nt
s_add_u32 s13, s13, 24576
s_min_u32 s12, s13, 2146435072
s_cmp_ge_u32 s80, 36
s_cbranch_scc1 L_nodma_8
s_mov_b32 m0, s15
s_nop 0
buffer_load_dwordx4 v2, s[60:63], s15 offen  lds
s_add_u32 s15, s15, 1024
L_nodma_8:
s_add_u32 s80, s80, 1
v_add_f32_dpp v32, v28, v28 row_ror:8 row_mask:0xf bank_mask:0x3
v_add_f32_dpp v33, v29, v29 row_ror:8 row_mask:0xf bank_mask:0x3
v_add_f32_dpp v32, v30, v30 row_ror:8 row_mask:0xf bank_mask:0xc
v_add_f32_dpp v33, v31, v31 row_ror:8 row_mask:0xf bank_mask:0xc
s_nop 0
v_add_f32_dpp v34, v32, v32 row_half_mirror row_mask:0xf bank_mask:0x5
v_add_f32_dpp v34, v33, v33 row_half_mirror row_mask:0xf bank_mask:0xa
s_nop 1
v_add_f32_dpp v34, v34, v34 quad_perm:[1,0,3,2] row_mask:0xf bank_mask:0xf
s_nop 1
v_add_f32_dpp v34, v34, v34 quad_perm:[2,3,0,1] row_mask:0xf bank_mask:0xf
v_cndmask_b32 v86, v86, v34, s[78:79]
s_add_u32 s81, s81, 1
s_cmp_eq_u32 s81, 11
s_cbranch_scc1 A_mid
v_mov_b32 v76, v77
v_mov_b32 v77, v78
v_mov_b32 v78, v79
v_mov_b32 v79, v80
v_mov_b32 v80, v81
v_mov_b32 v81, v82
v_mov_b32 v82, v83
v_mov_b32 v83, v84
v_mov_b32 v84, v85
v_mov_b32 v85, v86
s_lshr_b64 s[72:73], s[76:77], 2
s_lshr_b64 s[74:75], s[76:77], 1
s_cmp_eq_u32 s81, 9
s_cselect_b32 s52, s56, s52
s_cselect_b32 s53, s57, s53
s_cselect_b32 s13, s14, s13
s_min_u32 s12, s13, 2146435072
s_waitcnt vmcnt(28)
v_dot2_f32_bf16 v28, v184, v24, 0
v_dot2_f32_bf16 v29, v188, v24, 0
v_dot2_f32_bf16 v30, v192, v24, 0
v_dot2_f32_bf16 v31, v196, v24, 0
v_dot2_f32_bf16 v28, v185, v25, v28
v_dot2_f32_bf16 v29, v189, v25, v29
v_dot2_f32_bf16 v30, v193, v25, v30
v_dot2_f32_bf16 v31, v197, v25, v31
v_dot2_f32_bf16 v28, v186, v26, v28
v_dot2_f32_bf16 v29, v190, v26, v29
v_dot2_f32_bf16 v30, v194, v26, v30
v_dot2_f32_bf16 v31, v198, v26, v31
v_dot2_f32_bf16 v28, v187, v27, v28
v_dot2_f32_bf16 v29, v191, v27, v29
v_dot2_f32_bf16 v30, v195, v27, v30
v_dot2_f32_bf16 v31, v199, v27, v31
buffer_load_dwordx4 v[184:187], v2, s[52:55], s12 offen offset:0 nt
buffer_load_dwordx4 v[188:191], v2, s[52:55], s12 offen offset:1024 nt
buffer_load_dwordx4 v[192:195], v2, s[52:55], s12 offen offset:2048 nt
buffer_load_dwordx4 v[196:199], v2, s[52:55], s12 offen offset:3072 nt
s_add_u32 s13, s13, 24576
s_min_u32 s12, s13, 2146435072
s_cmp_ge_u32 s80, 36
s_cbranch_scc1 L_nodma_9
s_mov_b32 m0, s15
s_nop 0
buffer_load_dwordx4 v2, s[60:63], s15 offen  lds
s_add_u32 s15, s15, 1024
L_nodma_9:
s_add_u32 s80, s80, 1
v_add_f32_dpp v32, v28, v28 row_ror:8 row_mask:0xf bank_mask:0x3
v_add_f32_dpp v33, v29, v29 row_ror:8 row_mask:0xf bank_mask:0x3
v_add_f32_dpp v32, v30, v30 row_ror:8 row_mask:0xf bank_mask:0xc
v_add_f32_dpp v33, v31, v31 row_ror:8 row_mask:0xf bank_mask:0xc
s_nop 0
v_add_f32_dpp v34, v32, v32 row_half_mirror row_mask:0xf bank_mask:0x5
v_add_f32_dpp v34, v33, v33 row_half_mirror row_mask:0xf bank_mask:0xa
s_nop 1
v_add_f32_dpp v34, v34, v34 quad_perm:[1,0,3,2] row_mask:0xf bank_mask:0xf
s_nop 1
v_add_f32_dpp v34, v34, v34 quad_perm:[2,3,0,1] row_mask:0xf bank_mask:0xf
v_cndmask_b32 v86, v86, v34, s[72:73]
s_waitcnt vmcnt(28)
v_dot2_f32_bf16 v28, v200, v24, 0
v_dot2_f32_bf16 v29, v204, v24, 0
v_dot2_f32_bf16 v30, v208, v24, 0
v_dot2_f32_bf16 v31, v212, v24, 0
v_dot2_f32_bf16 v28, v201, v25, v28
v_dot2_f32_bf16 v29, v205, v25, v29
v_dot2_f32_bf16 v30, v209, v25, v30
v_dot2_f32_bf16 v31, v213, v25, v31
v_dot2_f32_bf16 v28, v202, v26, v28
v_dot2_f32_bf16 v29, v206, v26, v29
v_dot2_f32_bf16 v30, v210, v26, v30
v_dot2_f32_bf16 v31, v214, v26, v31
v_dot2_f32_bf16 v28, v203, v27, v28
v_dot2_f32_bf16 v29, v207, v27, v29
v_dot2_f32_bf16 v30, v211, v27, v30
v_dot2_f32_bf16 v31, v215, v27, v31
buffer_load_dwordx4 v[200:203], v2, s[52:55], s12 offen offset:0 nt
buffer_load_dwordx4 v[204:207], v2, s[52:55], s12 offen offset:1024 nt
buffer_load_dwordx4 v[208:211], v2, s[52:55], s12 offen offset:2048 nt
buffer_load_dwordx4 v[212:215], v2, s[52:55], s12 offen offset:3072 nt
s_add_u32 s13, s13, 24576
s_min_u32 s12, s13, 2146435072
s_cmp_ge_u32 s80, 36
s_cbranch_scc1 L_nodma_10
s_mov_b32 m0, s15
s_nop 0
buffer_load_dwordx4 v2, s[60:63], s15 offen  lds
s_add_u32 s15, s15, 1024
L_nodma_10:
s_add_u32 s80, s80, 1
v_add_f32_dpp v32, v28, v28 row_ror:8 row_mask:0xf bank_mask:0x3
v_add_f32_dpp v33, v29, v29 row_ror:8 row_mask:0xf bank_mask:0x3
v_add_f32_dpp v32, v30, v30 row_ror:8 row_mask:0xf bank_mask:0xc
v_add_f32_dpp v33, v31, v31 row_ror:8 row_mask:0xf bank_mask:0xc
s_nop 0
v_add_f32_dpp v34, v32, v32 row_half_mirror row_mask:0xf bank_mask:0x5
v_add_f32_dpp v34, v33, v33 row_half_mirror row_mask:0xf bank_mask:0xa
s_nop 1
v_add_f32_dpp v34, v34, v34 quad_perm:[1,0,3,2] row_mask:0xf bank_mask:0xf
s_nop 1
v_add_f32_dpp v34, v34, v34 quad_perm:[2,3,0,1] row_mask:0xf bank_mask:0xf
v_cndmask_b32 v86, v86, v34, s[74:75]
s_waitcnt vmcnt(28)
v_dot2_f32_bf16 v28, v216, v24, 0
v_dot2_f32_bf16 v29, v220, v24, 0
v_dot2_f32_bf16 v30, v224, v24, 0
v_dot2_f32_bf16 v31, v228, v24, 0
v_dot2_f32_bf16 v28, v217, v25, v28
v_dot2_f32_bf16 v29, v221, v25, v29
v_dot2_f32_bf16 v30, v225, v25, v30
v_dot2_f32_bf16 v31, v229, v25, v31
v_dot2_f32_bf16 v28, v218, v26, v28
v_dot2_f32_bf16 v29, v222, v26, v29
v_dot2_f32_bf16 v30, v226, v26, v30
v_dot2_f32_bf16 v31, v230, v26, v31
v_dot2_f32_bf16 v28, v219, v27, v28
v_dot2_f32_bf16 v29, v223, v27, v29
v_dot2_f32_bf16 v30, v227, v27, v30
v_dot2_f32_bf16 v31, v231, v27, v31
buffer_load_dwordx4 v[216:219], v2, s[52:55], s12 offen offset:0 nt
buffer_load_dwordx4 v[220:223], v2, s[52:55], s12 offen offset:1024 nt
buffer_load_dwordx4 v[224:227], v2, s[52:55], s12 offen offset:2048 nt
buffer_load_dwordx4 v[228:231], v2, s[52:55], s12 offen offset:3072 nt
s_add_u32 s13, s13, 24576
s_min_u32 s12, s13, 2146435072
s_cmp_ge_u32 s80, 36
s_cbranch_scc1 L_nodma_11
s_mov_b32 m0, s15
s_nop 0
buffer_load_dwordx4 v2, s[60:63], s15 offen  lds
s_add_u32 s15, s15, 1024
L_nodma_11:
s_add_u32 s80, s80, 1
v_add_f32_dpp v32, v28, v28 row_ror:8 row_mask:0xf bank_mask:0x3
v_add_f32_dpp v33, v29, v29 row_ror:8 row_mask:0xf bank_mask:0x3
v_add_f32_dpp v32, v30, v30 row_ror:8 row_mask:0xf bank_mask:0xc
v_add_f32_dpp v33, v31, v31 row_ror:8 row_mask:0xf bank_mask:0xc
s_nop 0
v_add_f32_dpp v34, v32, v32 row_half_mirror row_mask:0xf bank_mask:0x5
v_add_f32_dpp v34, v33, v33 row_half_mirror row_mask:0xf bank_mask:0xa
s_nop 1
v_add_f32_dpp v34, v34, v34 quad_perm:[1,0,3,2] row_mask:0xf bank_mask:0xf
s_nop 1
v_add_f32_dpp v34, v34, v34 quad_perm:[2,3,0,1] row_mask:0xf bank_mask:0xf
v_cndmask_b32 v86, v86, v34, s[76:77]
s_waitcnt vmcnt(28)
v_dot2_f32_bf16 v28, v232, v24, 0
v_dot2_f32_bf16 v29, v236, v24, 0
v_dot2_f32_bf16 v30, v240, v24, 0
v_dot2_f32_bf16 v31, v244, v24, 0
v_dot2_f32_bf16 v28, v233, v25, v28
v_dot2_f32_bf16 v29, v237, v25, v29
v_dot2_f32_bf16 v30, v241, v25, v30
v_dot2_f32_bf16 v31, v245, v25, v31
v_dot2_f32_bf16 v28, v234, v26, v28
v_dot2_f32_bf16 v29, v238, v26, v29
v_dot2_f32_bf16 v30, v242, v26, v30
v_dot2_f32_bf16 v31, v246, v26, v31
v_dot2_f32_bf16 v28, v235, v27, v28
v_dot2_f32_bf16 v29, v239, v27, v29
v_dot2_f32_bf16 v30, v243, v27, v30
v_dot2_f32_bf16 v31, v247, v27, v31
buffer_load_dwordx4 v[232:235], v2, s[52:55], s12 offen offset:0 nt
buffer_load_dwordx4 v[236:239], v2, s[52:55], s12 offen offset:1024 nt
buffer_load_dwordx4 v[240:243], v2, s[52:55], s12 offen offset:2048 nt
buffer_load_dwordx4 v[244:247], v2, s[52:55], s12 offen offset:3072 nt
s_add_u32 s13, s13, 24576
s_min_u32 s12, s13, 2146435072
s_cmp_ge_u32 s80, 36
s_cbranch_scc1 L_nodma_12
s_mov_b32 m0, s15
s_nop 0
buffer_load_dwordx4 v2, s[60:63], s15 offen  lds
s_add_u32 s15, s15, 1024
L_nodma_12:
s_add_u32 s80, s80, 1
v_add_f32_dpp v32, v28, v28 row_ror:8 row_mask:0xf bank_mask:0x3
v_add_f32_dpp v33, v29, v29 row_ror:8 row_mask:0xf bank_mask:0x3
v_add_f32_dpp v32, v30, v30 row_ror:8 row_mask:0xf bank_mask:0xc
v_add_f32_dpp v33, v31, v31 row_ror:8 row_mask:0xf bank_mask:0xc
s_nop 0
v_add_f32_dpp v34, v32, v32 row_half_mirror row_mask:0xf bank_mask:0x5
v_add_f32_dpp v34, v33, v33 row_half_mirror row_mask:0xf bank_mask:0xa
s_nop 1
v_add_f32_dpp v34, v34, v34 quad_perm:[1,0,3,2] row_mask:0xf bank_mask:0xf
s_nop 1
v_add_f32_dpp v34, v34, v34 quad_perm:[2,3,0,1] row_mask:0xf bank_mask:0xf
v_cndmask_b32 v86, v86, v34, s[78:79]
s_add_u32 s81, s81, 1
v_mov_b32 v76, v77
v_mov_b32 v77, v78
v_mov_b32 v78, v79
v_mov_b32 v79, v80
v_mov_b32 v80, v81
v_mov_b32 v81, v82
v_mov_b32 v82, v83
v_mov_b32 v83, v84
v_mov_b32 v84, v85
v_mov_b32 v85, v86
s_branch K_loop
A_mid:
v_max3_f32 v35, v76, v77, v78
v_max3_f32 v35, v35, v79, v80
v_max3_f32 v35, v35, v81, v82
v_max3_f32 v35, v35, v83, v84
v_max3_f32 v35, v35, v85, v86
s_nop 1
v_max_f32_dpp v35, v35, v35 row_ror:8 row_mask:0xf bank_mask:0xf
s_nop 1
v_max_f32_dpp v35, v35, v35 row_ror:4 row_mask:0xf bank_mask:0xf
s_nop 1
v_max_f32_dpp v35, v35, v35 row_ror:2 row_mask:0xf bank_mask:0xf
s_nop 1
v_max_f32_dpp v35, v35, v35 row_ror:1 row_mask:0xf bank_mask:0xf
v_mov_b32 v36, v35
s_nop 1
v_permlane16_swap_b32 v35, v36
v_max_f32 v35, v35, v36
v_mov_b32 v36, v35
s_nop 1
v_permlane32_swap_b32 v35, v36
v_max_f32 v35, v35, v36
v_mul_f32 v32, v35, v7
v_fma_f32 v76, v76, v7, -v32
v_fma_f32 v77, v77, v7, -v32
v_fma_f32 v78, v78, v7, -v32
v_fma_f32 v79, v79, v7, -v32
v_fma_f32 v80, v80, v7, -v32
v_fma_f32 v81, v81, v7, -v32
v_fma_f32 v82, v82, v7, -v32
v_fma_f32 v83, v83, v7, -v32
v_fma_f32 v84, v84, v7, -v32
v_fma_f32 v85, v85, v7, -v32
v_fma_f32 v86, v86, v7, -v32
v_exp_f32 v76, v76
v_exp_f32 v77, v77
v_exp_f32 v78, v78
v_exp_f32 v79, v79
v_exp_f32 v80, v80
v_exp_f32 v81, v81
v_exp_f32 v82, v82
v_exp_f32 v83, v83
v_exp_f32 v84, v84
v_exp_f32 v85, v85
v_exp_f32 v86, v86
v_add_f32 v35, v76, v77
v_add_f32 v35, v35, v78
v_add_f32 v35, v35, v79
v_add_f32 v35, v35, v80
v_add_f32 v35, v35, v81
v_add_f32 v35, v35, v82
v_add_f32 v35, v35, v83
v_add_f32 v35, v35, v84
v_add_f32 v35, v35, v85
v_add_f32 v35, v35, v86
v_cvt_pk_bf16_f32 v76, v76, v76
v_cvt_pk_bf16_f32 v77, v77, v77
v_cvt_pk_bf16_f32 v78, v78, v78
v_cvt_pk_bf16_f32 v79, v79, v79
v_cvt_pk_bf16_f32 v80, v80, v80
v_cvt_pk_bf16_f32 v81, v81, v81
v_cvt_pk_bf16_f32 v82, v82, v82
v_cvt_pk_bf16_f32 v83, v83, v83
v_cvt_pk_bf16_f32 v84, v84, v84
v_cvt_pk_bf16_f32 v85, v85, v85
v_cvt_pk_bf16_f32 v86, v86, v86
v_add_f32_dpp v35, v35, v35 row_ror:8 row_mask:0xf bank_mask:0xf
s_nop 1
v_add_f32_dpp v35, v35, v35 row_ror:4 row_mask:0xf bank_mask:0xf
s_nop 1
v_add_f32_dpp v35, v35, v35 row_ror:2 row_mask:0xf bank_mask:0xf
s_nop 1
v_add_f32_dpp v35, v35, v35 row_ror:1 row_mask:0xf bank_mask:0xf
v_mov_b32 v36, v35
s_nop 1
v_permlane16_swap_b32 v35, v36
v_add_f32 v35, v35, v36
v_mov_b32 v36, v35
s_nop 1
v_permlane32_swap_b32 v35, v36
v_add_f32 v35, v35, v36
v_min_u32 v32, -2, v32
v_min_u32 v33, -2, v35
s_mov_b32 s7, 400000
L_ens_13:
v_readfirstlane_b32 s6, v96
s_cmp_ge_u32 s6, 32
s_cbranch_scc1 L_ensd_14
s_sleep 16
buffer_load_dword v96, off, s[68:71], 0 offset:0 sc1
s_waitcnt vmcnt(0)
s_sub_u32 s7, s7, 1
s_cmp_lg_u32 s7, 0
s_cbranch_scc1 L_ens_13
L_ensd_14:
s_lshl_b32 s6, s11, 3
s_add_u32 s6, s6, s82
s_mov_b64 exec, 1
buffer_store_dwordx2 v[32:33], off, s[64:67], s6 sc1
s_mov_b64 exec, -1
v_and_b32_dpp v60, v78, v8 row_newbcast:0 row_mask:0xf bank_mask:0xf
v_and_b32_dpp v61, v78, v9 row_newbcast:0 row_mask:0xf bank_mask:0xf
v_and_b32_dpp v62, v78, v10 row_newbcast:0 row_mask:0xf bank_mask:0xf
v_and_b32_dpp v63, v78, v11 row_newbcast:0 row_mask:0xf bank_mask:0xf
v_and_b32_dpp v64, v78, v8 row_newbcast:4 row_mask:0xf bank_mask:0xf
v_and_b32_dpp v65, v78, v9 row_newbcast:4 row_mask:0xf bank_mask:0xf
v_and_b32_dpp v66, v78, v10 row_newbcast:4 row_mask:0xf bank_mask:0xf
v_and_b32_dpp v67, v78, v11 row_newbcast:4 row_mask:0xf bank_mask:0xf
v_and_b32_dpp v68, v78, v8 row_newbcast:8 row_mask:0xf bank_mask:0xf
v_and_b32_dpp v69, v78, v9 row_newbcast:8 row_mask:0xf bank_mask:0xf
v_and_b32_dpp v70, v78, v10 row_newbcast:8 row_mask:0xf bank_mask:0xf
v_and_b32_dpp v71, v78, v11 row_newbcast:8 row_mask:0xf bank_mask:0xf
v_and_b32_dpp v72, v78, v8 row_newbcast:12 row_mask:0xf bank_mask:0xf
v_and_b32_dpp v73, v78, v9 row_newbcast:12 row_mask:0xf bank_mask:0xf
v_and_b32_dpp v74, v78, v10 row_newbcast:12 row_mask:0xf bank_mask:0xf
v_and_b32_dpp v75, v78, v11 row_newbcast:12 row_mask:0xf bank_mask:0xf
s_waitcnt vmcnt(29)
v_mfma_f32_16x16x32_bf16 v[20:23], v[60:63], v[184:187], v[20:23]
v_mfma_f32_16x16x32_bf16 v[20:23], v[64:67], v[188:191], v[20:23]
v_mfma_f32_16x16x32_bf16 v[20:23], v[68:71], v[192:195], v[20:23]
v_mfma_f32_16x16x32_bf16 v[20:23], v[72:75], v[196:199], v[20:23]
v_add_u32 v117, 1, v117
buffer_store_dword v117, v118, s[64:67], 0 offen
buffer_load_dwordx4 v[184:187], v2, s[52:55], s12 offen offset:0 nt
buffer_load_dwordx4 v[188:191], v2, s[52:55], s12 offen offset:1024 nt
buffer_load_dwordx4 v[192:195], v2, s[52:55], s12 offen offset:2048 nt
buffer_load_dwordx4 v[196:199], v2, s[52:55], s12 offen offset:3072 nt
s_add_u32 s13, s13, 24576
s_min_u32 s12, s13, 2146435072
v_and_b32_dpp v60, v78, v8 row_newbcast:1 row_mask:0xf bank_mask:0xf
v_and_b32_dpp v61, v78, v9 row_newbcast:1 row_mask:0xf bank_mask:0xf
v_and_b32_dpp v62, v78, v10 row_newbcast:1 row_mask:0xf bank_mask:0xf
v_and_b32_dpp v63, v78, v11 row_newbcast:1 row_mask:0xf bank_mask:0xf
v_and_b32_dpp v64, v78, v8 row_newbcast:5 row_mask:0xf bank_mask:0xf
v_and_b32_dpp v65, v78, v9 row_newbcast:5 row_mask:0xf bank_mask:0xf
v_and_b32_dpp v66, v78, v10 row_newbcast:5 row_mask:0xf bank_mask:0xf
v_and_b32_dpp v67, v78, v11 row_newbcast:5 row_mask:0xf bank_mask:0xf
v_and_b32_dpp v68, v78, v8 row_newbcast:9 row_mask:0xf bank_mask:0xf
v_and_b32_dpp v69, v78, v9 row_newbcast:9 row_mask:0xf bank_mask:0xf
v_and_b32_dpp v70, v78, v10 row_newbcast:9 row_mask:0xf bank_mask:0xf
v_and_b32_dpp v71, v78, v11 row_newbcast:9 row_mask:0xf bank_mask:0xf
v_and_b32_dpp v72, v78, v8 row_newbcast:13 row_mask:0xf bank_mask:0xf
v_and_b32_dpp v73, v78, v9 row_newbcast:13 row_mask:0xf bank_mask:0xf
v_and_b32_dpp v74, v78, v10 row_newbcast:13 row_mask:0xf bank_mask:0xf
v_and_b32_dpp v75, v78, v11 row_newbcast:13 row_mask:0xf bank_mask:0xf
s_waitcnt vmcnt(30)
v_mfma_f32_16x16x32_bf16 v[20:23], v[60:63], v[200:203], v[20:23]
v_mfma_f32_16x16x32_bf16 v[20:23], v[64:67], v[204:207], v[20:23]
v_mfma_f32_16x16x32_bf16 v[20:23], v[68:71], v[208:211], v[20:23]
v_mfma_f32_16x16x32_bf16 v[20:23], v[72:75], v[212:215], v[20:23]
v_add_u32 v117, 1, v117
buffer_store_dword v117, v118, s[64:67], 0 offen
buffer_load_dwordx4 v[200:203], v2, s[52:55], s12 offen offset:0 nt
buffer_load_dwordx4 v[204:207], v2, s[52:55], s12 offen offset:1024 nt
buffer_load_dwordx4 v[208:211], v2, s[52:55], s12 offen offset:2048 nt
buffer_load_dwordx4 v[212:215], v2, s[52:55], s12 offen offset:3072 nt
s_add_u32 s13, s13, 24576
s_min_u32 s12, s13, 2146435072
v_and_b32_dpp v60, v76, v8 row_newbcast:1 row_mask:0xf bank_mask:0xf
v_and_b32_dpp v61, v76, v9 row_newbcast:1 row_mask:0xf bank_mask:0xf
v_and_b32_dpp v62, v76, v10 row_newbcast:1 row_mask:0xf bank_mask:0xf
v_and_b32_dpp v63, v76, v11 row_newbcast:1 row_mask:0xf bank_mask:0xf
v_and_b32_dpp v64, v76, v8 row_newbcast:5 row_mask:0xf bank_mask:0xf
v_and_b32_dpp v65, v76, v9 row_newbcast:5 row_mask:0xf bank_mask:0xf
v_and_b32_dpp v66, v76, v10 row_newbcast:5 row_mask:0xf bank_mask:0xf
v_and_b32_dpp v67, v76, v11 row_newbcast:5 row_mask:0xf bank_mask:0xf
v_and_b32_dpp v68, v76, v8 row_newbcast:9 row_mask:0xf bank_mask:0xf
v_and_b32_dpp v69, v76, v9 row_newbcast:9 row_mask:0xf bank_mask:0xf
v_and_b32_dpp v70, v76, v10 row_newbcast:9 row_mask:0xf bank_mask:0xf
v_and_b32_dpp v71, v76, v11 row_newbcast:9 row_mask:0xf bank_mask:0xf
v_and_b32_dpp v72, v76, v8 row_newbcast:13 row_mask:0xf bank_mask:0xf
v_and_b32_dpp v73, v76, v9 row_newbcast:13 row_mask:0xf bank_mask:0xf
v_and_b32_dpp v74, v76, v10 row_newbcast:13 row_mask:0xf bank_mask:0xf
v_and_b32_dpp v75, v76, v11 row_newbcast:13 row_mask:0xf bank_mask:0xf
v_mfma_f32_16x16x32_bf16 v[20:23], v[60:63], a[0:3], v[20:23]
v_mfma_f32_16x16x32_bf16 v[20:23], v[64:67], a[4:7], v[20:23]
v_mfma_f32_16x16x32_bf16 v[20:23], v[68:71], a[8:11], v[20:23]
v_mfma_f32_16x16x32_bf16 v[20:23], v[72:75], a[12:15], v[20:23]
s_nop 3
v_and_b32_dpp v60, v78, v8 row_newbcast:2 row_mask:0xf bank_mask:0xf
v_and_b32_dpp v61, v78, v9 row_newbcast:2 row_mask:0xf bank_mask:0xf
v_and_b32_dpp v62, v78, v10 row_newbcast:2 row_mask:0xf bank_mask:0xf
v_and_b32_dpp v63, v78, v11 row_newbcast:2 row_mask:0xf bank_mask:0xf
v_and_b32_dpp v64, v78, v8 row_newbcast:6 row_mask:0xf bank_mask:0xf
v_and_b32_dpp v65, v78, v9 row_newbcast:6 row_mask:0xf bank_mask:0xf
v_and_b32_dpp v66, v78, v10 row_newbcast:6 row_mask:0xf bank_mask:0xf
v_and_b32_dpp v67, v78, v11 row_newbcast:6 row_mask:0xf bank_mask:0xf
v_and_b32_dpp v68, v78, v8 row_newbcast:10 row_mask:0xf bank_mask:0xf
v_and_b32_dpp v69, v78, v9 row_newbcast:10 row_mask:0xf bank_mask:0xf
v_and_b32_dpp v70, v78, v10 row_newbcast:10 row_mask:0xf bank_mask:0xf
v_and_b32_dpp v71, v78, v11 row_newbcast:10 row_mask:0xf bank_mask:0xf
v_and_b32_dpp v72, v78, v8 row_newbcast:14 row_mask:0xf bank_mask:0xf
v_and_b32_dpp v73, v78, v9 row_newbcast:14 row_mask:0xf bank_mask:0xf
v_and_b32_dpp v74, v78, v10 row_newbcast:14 row_mask:0xf bank_mask:0xf
v_and_b32_dpp v75, v78, v11 row_newbcast:14 row_mask:0xf bank_mask:0xf
s_waitcnt vmcnt(31)
v_mfma_f32_16x16x32_bf16 v[20:23], v[60:63], v[216:219], v[20:23]
v_mfma_f32_16x16x32_bf16 v[20:23], v[64:67], v[220:223], v[20:23]
v_mfma_f32_16x16x32_bf16 v[20:23], v[68:71], v[224:227], v[20:23]
v_mfma_f32_16x16x32_bf16 v[20:23], v[72:75], v[228:231], v[20:23]
v_add_u32 v117, 1, v117
buffer_store_dword v117, v118, s[64:67], 0 offen
buffer_load_dwordx4 v[216:219], v2, s[52:55], s12 offen offset:0 nt
buffer_load_dwordx4 v[220:223], v2, s[52:55], s12 offen offset:1024 nt
buffer_load_dwordx4 v[224:227], v2, s[52:55], s12 offen offset:2048 nt
buffer_load_dwordx4 v[228:231], v2, s[52:55], s12 offen offset:3072 nt
s_add_u32 s13, s13, 24576
s_min_u32 s12, s13, 2146435072
v_and_b32_dpp v60, v78, v8 row_newbcast:3 row_mask:0xf bank_mask:0xf
v_and_b32_dpp v61, v78, v9 row_newbcast:3 row_mask:0xf bank_mask:0xf
v_and_b32_dpp v62, v78, v10 row_newbcast:3 row_mask:0xf bank_mask:0xf
v_and_b32_dpp v63, v78, v11 row_newbcast:3 row_mask:0xf bank_mask:0xf
v_and_b32_dpp v64, v78, v8 row_newbcast:7 row_mask:0xf bank_mask:0xf
v_and_b32_dpp v65, v78, v9 row_newbcast:7 row_mask:0xf bank_mask:0xf
v_and_b32_dpp v66, v78, v10 row_newbcast:7 row_mask:0xf bank_mask:0xf
v_and_b32_dpp v67, v78, v11 row_newbcast:7 row_mask:0xf bank_mask:0xf
v_and_b32_dpp v68, v78, v8 row_newbcast:11 row_mask:0xf bank_mask:0xf
v_and_b32_dpp v69, v78, v9 row_newbcast:11 row_mask:0xf bank_mask:0xf
v_and_b32_dpp v70, v78, v10 row_newbcast:11 row_mask:0xf bank_mask:0xf
v_and_b32_dpp v71, v78, v11 row_newbcast:11 row_mask:0xf bank_mask:0xf
v_and_b32_dpp v72, v78, v8 row_newbcast:15 row_mask:0xf bank_mask:0xf
v_and_b32_dpp v73, v78, v9 row_newbcast:15 row_mask:0xf bank_mask:0xf
v_and_b32_dpp v74, v78, v10 row_newbcast:15 row_mask:0xf bank_mask:0xf
v_and_b32_dpp v75, v78, v11 row_newbcast:15 row_mask:0xf bank_mask:0xf
s_waitcnt vmcnt(32)
v_mfma_f32_16x16x32_bf16 v[20:23], v[60:63], v[232:235], v[20:23]
v_mfma_f32_16x16x32_bf16 v[20:23], v[64:67], v[236:239], v[20:23]
v_mfma_f32_16x16x32_bf16 v[20:23], v[68:71], v[240:243], v[20:23]
v_mfma_f32_16x16x32_bf16 v[20:23], v[72:75], v[244:247], v[20:23]
v_add_u32 v117, 1, v117
buffer_store_dword v117, v118, s[64:67], 0 offen
buffer_load_dwordx4 v[232:235], v2, s[52:55], s12 offen offset:0 nt
buffer_load_dwordx4 v[236:239], v2, s[52:55], s12 offen offset:1024 nt
buffer_load_dwordx4 v[240:243], v2, s[52:55], s12 offen offset:2048 nt
buffer_load_dwordx4 v[244:247], v2, s[52:55], s12 offen offset:3072 nt
s_add_u32 s13, s13, 24576
s_min_u32 s12, s13, 2146435072
s_barrier
ds_read_b64_tr_b16 a[96:97], v88 offset:0
ds_read_b64_tr_b16 a[98:99], v88 offset:2304
ds_read_b64_tr_b16 a[100:101], v88 offset:18432
ds_read_b64_tr_b16 a[102:103], v88 offset:20736
v_and_b32_dpp v60, v79, v8 row_newbcast:0 row_mask:0xf bank_mask:0xf
v_and_b32_dpp v61, v79, v9 row_newbcast:0 row_mask:0xf bank_mask:0xf
v_and_b32_dpp v62, v79, v10 row_newbcast:0 row_mask:0xf bank_mask:0xf
v_and_b32_dpp v63, v79, v11 row_newbcast:0 row_mask:0xf bank_mask:0xf
v_and_b32_dpp v64, v79, v8 row_newbcast:4 row_mask:0xf bank_mask:0xf
v_and_b32_dpp v65, v79, v9 row_newbcast:4 row_mask:0xf bank_mask:0xf
v_and_b32_dpp v66, v79, v10 row_newbcast:4 row_mask:0xf bank_mask:0xf
v_and_b32_dpp v67, v79, v11 row_newbcast:4 row_mask:0xf bank_mask:0xf
v_and_b32_dpp v68, v79, v8 row_newbcast:8 row_mask:0xf bank_mask:0xf
v_and_b32_dpp v69, v79, v9 row_newbcast:8 row_mask:0xf bank_mask:0xf
v_and_b32_dpp v70, v79, v10 row_newbcast:8 row_mask:0xf bank_mask:0xf
v_and_b32_dpp v71, v79, v11 row_newbcast:8 row_mask:0xf bank_mask:0xf
v_and_b32_dpp v72, v79, v8 row_newbcast:12 row_mask:0xf bank_mask:0xf
v_and_b32_dpp v73, v79, v9 row_newbcast:12 row_mask:0xf bank_mask:0xf
v_and_b32_dpp v74, v79, v10 row_newbcast:12 row_mask:0xf bank_mask:0xf
v_and_b32_dpp v75, v79, v11 row_newbcast:12 row_mask:0xf bank_mask:0xf
s_waitcnt vmcnt(33)
v_mfma_f32_16x16x32_bf16 v[20:23], v[60:63], v[120:123], v[20:23]
v_mfma_f32_16x16x32_bf16 v[20:23], v[64:67], v[124:127], v[20:23]
v_mfma_f32_16x16x32_bf16 v[20:23], v[68:71], v[128:131], v[20:23]
v_mfma_f32_16x16x32_bf16 v[20:23], v[72:75], v[132:135], v[20:23]
v_add_u32 v117, 1, v117
buffer_store_dword v117, v118, s[64:67], 0 offen
buffer_load_dwordx4 v[120:123], v2, s[52:55], s12 offen offset:0 nt
buffer_load_dwordx4 v[124:127], v2, s[52:55], s12 offen offset:1024 nt
buffer_load_dwordx4 v[128:131], v2, s[52:55], s12 offen offset:2048 nt
buffer_load_dwordx4 v[132:135], v2, s[52:55], s12 offen offset:3072 nt
s_add_u32 s13, s13, 24576
s_min_u32 s12, s13, 2146435072
ds_read_b64_tr_b16 a[104:105], v88 offset:36864
ds_read_b64_tr_b16 a[106:107], v88 offset:39168
ds_read_b64_tr_b16 a[108:109], v88 offset:55296
ds_read_b64_tr_b16 a[110:111], v88 offset:57600
v_and_b32_dpp v60, v79, v8 row_newbcast:1 row_mask:0xf bank_mask:0xf
v_and_b32_dpp v61, v79, v9 row_newbcast:1 row_mask:0xf bank_mask:0xf
v_and_b32_dpp v62, v79, v10 row_newbcast:1 row_mask:0xf bank_mask:0xf
v_and_b32_dpp v63, v79, v11 row_newbcast:1 row_mask:0xf bank_mask:0xf
v_and_b32_dpp v64, v79, v8 row_newbcast:5 row_mask:0xf bank_mask:0xf
v_and_b32_dpp v65, v79, v9 row_newbcast:5 row_mask:0xf bank_mask:0xf
v_and_b32_dpp v66, v79, v10 row_newbcast:5 row_mask:0xf bank_mask:0xf
v_and_b32_dpp v67, v79, v11 row_newbcast:5 row_mask:0xf bank_mask:0xf
v_and_b32_dpp v68, v79, v8 row_newbcast:9 row_mask:0xf bank_mask:0xf
v_and_b32_dpp v69, v79, v9 row_newbcast:9 row_mask:0xf bank_mask:0xf
v_and_b32_dpp v70, v79, v10 row_newbcast:9 row_mask:0xf bank_mask:0xf
v_and_b32_dpp v71, v79, v11 row_newbcast:9 row_mask:0xf bank_mask:0xf
v_and_b32_dpp v72, v79, v8 row_newbcast:13 row_mask:0xf bank_mask:0xf
v_and_b32_dpp v73, v79, v9 row_newbcast:13 row_mask:0xf bank_mask:0xf
v_and_b32_dpp v74, v79, v10 row_newbcast:13 row_mask:0xf bank_mask:0xf
v_and_b32_dpp v75, v79, v11 row_newbcast:13 row_mask:0xf bank_mask:0xf
s_waitcnt vmcnt(34)
v_mfma_f32_16x16x32_bf16 v[20:23], v[60:63], v[136:139], v[20:23]
v_mfma_f32_16x16x32_bf16 v[20:23], v[64:67], v[140:143], v[20:23]
v_mfma_f32_16x16x32_bf16 v[20:23], v[68:71], v[144:147], v[20:23]
v_mfma_f32_16x16x32_bf16 v[20:23], v[72:75], v[148:151], v[20:23]
v_add_u32 v117, 1, v117
buffer_store_dword v117, v118, s[64:67], 0 offen
buffer_load_dwordx4 v[136:139], v2, s[52:55], s12 offen offset:0 nt
buffer_load_dwordx4 v[140:143], v2, s[52:55], s12 offen offset:1024 nt
buffer_load_dwordx4 v[144:147], v2, s[52:55], s12 offen offset:2048 nt
buffer_load_dwordx4 v[148:151], v2, s[52:55], s12 offen offset:3072 nt
s_add_u32 s13, s13, 24576
s_min_u32 s12, s13, 2146435072
ds_read_b64_tr_b16 a[112:113], v90 offset:0
ds_read_b64_tr_b16 a[114:115], v90 offset:2304
ds_read_b64_tr_b16 a[116:117], v90 offset:18432
ds_read_b64_tr_b16 a[118:119], v90 offset:20736
v_and_b32_dpp v60, v76, v8 row_newbcast:2 row_mask:0xf bank_mask:0xf
v_and_b32_dpp v61, v76, v9 row_newbcast:2 row_mask:0xf bank_mask:0xf
v_and_b32_dpp v62, v76, v10 row_newbcast:2 row_mask:0xf bank_mask:0xf
v_and_b32_dpp v63, v76, v11 row_newbcast:2 row_mask:0xf bank_mask:0xf
v_and_b32_dpp v64, v76, v8 row_newbcast:6 row_mask:0xf bank_mask:0xf
v_and_b32_dpp v65, v76, v9 row_newbcast:6 row_mask:0xf bank_mask:0xf
v_and_b32_dpp v66, v76, v10 row_newbcast:6 row_mask:0xf bank_mask:0xf
v_and_b32_dpp v67, v76, v11 row_newbcast:6 row_mask:0xf bank_mask:0xf
v_and_b32_dpp v68, v76, v8 row_newbcast:10 row_mask:0xf bank_mask:0xf
v_and_b32_dpp v69, v76, v9 row_newbcast:10 row_mask:0xf bank_mask:0xf
v_and_b32_dpp v70, v76, v10 row_newbcast:10 row_mask:0xf bank_mask:0xf
v_and_b32_dpp v71, v76, v11 row_newbcast:10 row_mask:0xf bank_mask:0xf
v_and_b32_dpp v72, v76, v8 row_newbcast:14 row_mask:0xf bank_mask:0xf
v_and_b32_dpp v73, v76, v9 row_newbcast:14 row_mask:0xf bank_mask:0xf
v_and_b32_dpp v74, v76, v10 row_newbcast:14 row_mask:0xf bank_mask:0xf
v_and_b32_dpp v75, v76, v11 row_newbcast:14 row_mask:0xf bank_mask:0xf
v_mfma_f32_16x16x32_bf16 v[20:23], v[60:63], a[16:19], v[20:23]
v_mfma_f32_16x16x32_bf16 v[20:23], v[64:67], a[20:23], v[20:23]
v_mfma_f32_16x16x32_bf16 v[20:23], v[68:71], a[24:27], v[20:23]
v_mfma_f32_16x16x32_bf16 v[20:23], v[72:75], a[28:31], v[20:23]
s_nop 3
v_and_b32_dpp v60, v79, v8 row_newbcast:2 row_mask:0xf bank_mask:0xf
v_and_b32_dpp v61, v79, v9 row_newbcast:2 row_mask:0xf bank_mask:0xf
v_and_b32_dpp v62, v79, v10 row_newbcast:2 row_mask:0xf bank_mask:0xf
v_and_b32_dpp v63, v79, v11 row_newbcast:2 row_mask:0xf bank_mask:0xf
v_and_b32_dpp v64, v79, v8 row_newbcast:6 row_mask:0xf bank_mask:0xf
v_and_b32_dpp v65, v79, v9 row_newbcast:6 row_mask:0xf bank_mask:0xf
v_and_b32_dpp v66, v79, v10 row_newbcast:6 row_mask:0xf bank_mask:0xf
v_and_b32_dpp v67, v79, v11 row_newbcast:6 row_mask:0xf bank_mask:0xf
v_and_b32_dpp v68, v79, v8 row_newbcast:10 row_mask:0xf bank_mask:0xf
v_and_b32_dpp v69, v79, v9 row_newbcast:10 row_mask:0xf bank_mask:0xf
v_and_b32_dpp v70, v79, v10 row_newbcast:10 row_mask:0xf bank_mask:0xf
v_and_b32_dpp v71, v79, v11 row_newbcast:10 row_mask:0xf bank_mask:0xf
v_and_b32_dpp v72, v79, v8 row_newbcast:14 row_mask:0xf bank_mask:0xf
v_and_b32_dpp v73, v79, v9 row_newbcast:14 row_mask:0xf bank_mask:0xf
v_and_b32_dpp v74, v79, v10 row_newbcast:14 row_mask:0xf bank_mask:0xf
v_and_b32_dpp v75, v79, v11 row_newbcast:14 row_mask:0xf bank_mask:0xf
s_waitcnt vmcnt(35)
v_mfma_f32_16x16x32_bf16 v[20:23], v[60:63], v[152:155], v[20:23]
v_mfma_f32_16x16x32_bf16 v[20:23], v[64:67], v[156:159], v[20:23]
v_mfma_f32_16x16x32_bf16 v[20:23], v[68:71], v[160:163], v[20:23]
v_mfma_f32_16x16x32_bf16 v[20:23], v[72:75], v[164:167], v[20:23]
v_add_u32 v117, 1, v117
buffer_store_dword v117, v118, s[64:67], 0 offen
buffer_load_dwordx4 v[152:155], v2, s[52:55], s12 offen offset:0 nt
buffer_load_dwordx4 v[156:159], v2, s[52:55], s12 offen offset:1024 nt
buffer_load_dwordx4 v[160:163], v2, s[52:55], s12 offen offset:2048 nt
buffer_load_dwordx4 v[164:167], v2, s[52:55], s12 offen offset:3072 nt
s_add_u32 s13, s13, 24576
s_min_u32 s12, s13, 2146435072
ds_read_b64_tr_b16 a[120:121], v90 offset:36864
ds_read_b64_tr_b16 a[122:123], v90 offset:39168
ds_read_b64_tr_b16 a[124:125], v90 offset:55296
ds_read_b64_tr_b16 a[126:127], v90 offset:57600
v_and_b32_dpp v60, v79, v8 row_newbcast:3 row_mask:0xf bank_mask:0xf
v_and_b32_dpp v61, v79, v9 row_newbcast:3 row_mask:0xf bank_mask:0xf
v_and_b32_dpp v62, v79, v10 row_newbcast:3 row_mask:0xf bank_mask:0xf
v_and_b32_dpp v63, v79, v11 row_newbcast:3 row_mask:0xf bank_mask:0xf
v_and_b32_dpp v64, v79, v8 row_newbcast:7 row_mask:0xf bank_mask:0xf
v_and_b32_dpp v65, v79, v9 row_newbcast:7 row_mask:0xf bank_mask:0xf
v_and_b32_dpp v66, v79, v10 row_newbcast:7 row_mask:0xf bank_mask:0xf
v_and_b32_dpp v67, v79, v11 row_newbcast:7 row_mask:0xf bank_mask:0xf
v_and_b32_dpp v68, v79, v8 row_newbcast:11 row_mask:0xf bank_mask:0xf
v_and_b32_dpp v69, v79, v9 row_newbcast:11 row_mask:0xf bank_mask:0xf
v_and_b32_dpp v70, v79, v10 row_newbcast:11 row_mask:0xf bank_mask:0xf
v_and_b32_dpp v71, v79, v11 row_newbcast:11 row_mask:0xf bank_mask:0xf
v_and_b32_dpp v72, v79, v8 row_newbcast:15 row_mask:0xf bank_mask:0xf
v_and_b32_dpp v73, v79, v9 row_newbcast:15 row_mask:0xf bank_mask:0xf
v_and_b32_dpp v74, v79, v10 row_newbcast:15 row_mask:0xf bank_mask:0xf
v_and_b32_dpp v75, v79, v11 row_newbcast:15 row_mask:0xf bank_mask:0xf
s_waitcnt vmcnt(36)
v_mfma_f32_16x16x32_bf16 v[20:23], v[60:63], v[168:171], v[20:23]
v_mfma_f32_16x16x32_bf16 v[20:23], v[64:67], v[172:175], v[20:23]
v_mfma_f32_16x16x32_bf16 v[20:23], v[68:71], v[176:179], v[20:23]
v_mfma_f32_16x16x32_bf16 v[20:23], v[72:75], v[180:183], v[20:23]
v_add_u32 v117, 1, v117
buffer_store_dword v117, v118, s[64:67], 0 offen
buffer_load_dwordx4 v[168:171], v2, s[52:55], s12 offen offset:0 nt
buffer_load_dwordx4 v[172:175], v2, s[52:55], s12 offen offset:1024 nt
buffer_load_dwordx4 v[176:179], v2, s[52:55], s12 offen offset:2048 nt
buffer_load_dwordx4 v[180:183], v2, s[52:55], s12 offen offset:3072 nt
s_add_u32 s13, s13, 24576
s_min_u32 s12, s13, 2146435072
ds_read_b64_tr_b16 a[128:129], v88 offset:8
ds_read_b64_tr_b16 a[130:131], v88 offset:2312
ds_read_b64_tr_b16 a[132:133], v88 offset:18440
ds_read_b64_tr_b16 a[134:135], v88 offset:20744
v_and_b32_dpp v60, v80, v8 row_newbcast:0 row_mask:0xf bank_mask:0xf
v_and_b32_dpp v61, v80, v9 row_newbcast:0 row_mask:0xf bank_mask:0xf
v_and_b32_dpp v62, v80, v10 row_newbcast:0 row_mask:0xf bank_mask:0xf
v_and_b32_dpp v63, v80, v11 row_newbcast:0 row_mask:0xf bank_mask:0xf
v_and_b32_dpp v64, v80, v8 row_newbcast:4 row_mask:0xf bank_mask:0xf
v_and_b32_dpp v65, v80, v9 row_newbcast:4 row_mask:0xf bank_mask:0xf
v_and_b32_dpp v66, v80, v10 row_newbcast:4 row_mask:0xf bank_mask:0xf
v_and_b32_dpp v67, v80, v11 row_newbcast:4 row_mask:0xf bank_mask:0xf
v_and_b32_dpp v68, v80, v8 row_newbcast:8 row_mask:0xf bank_mask:0xf
v_and_b32_dpp v69, v80, v9 row_newbcast:8 row_mask:0xf bank_mask:0xf
v_and_b32_dpp v70, v80, v10 row_newbcast:8 row_mask:0xf bank_mask:0xf
v_and_b32_dpp v71, v80, v11 row_newbcast:8 row_mask:0xf bank_mask:0xf
v_and_b32_dpp v72, v80, v8 row_newbcast:12 row_mask:0xf bank_mask:0xf
v_and_b32_dpp v73, v80, v9 row_newbcast:12 row_mask:0xf bank_mask:0xf
v_and_b32_dpp v74, v80, v10 row_newbcast:12 row_mask:0xf bank_mask:0xf
v_and_b32_dpp v75, v80, v11 row_newbcast:12 row_mask:0xf bank_mask:0xf
s_waitcnt vmcnt(35)
v_mfma_f32_16x16x32_bf16 v[20:23], v[60:63], v[184:187], v[20:23]
v_mfma_f32_16x16x32_bf16 v[20:23], v[64:67], v[188:191], v[20:23]
v_mfma_f32_16x16x32_bf16 v[20:23], v[68:71], v[192:195], v[20:23]
v_mfma_f32_16x16x32_bf16 v[20:23], v[72:75], v[196:199], v[20:23]
v_add_u32 v117, 1, v117
buffer_store_dword v117, v118, s[64:67], 0 offen
buffer_load_dwordx4 v[184:187], v2, s[52:55], s12 offen offset:0 nt
buffer_load_dwordx4 v[188:191], v2, s[52:55], s12 offen offset:1024 nt
buffer_load_dwordx4 v[192:195], v2, s[52:55], s12 offen offset:2048 nt
buffer_load_dwordx4 v[196:199], v2, s[52:55], s12 offen offset:3072 nt
s_add_u32 s13, s13, 24576
s_min_u32 s12, s13, 2146435072
ds_read_b64_tr_b16 a[136:137], v88 offset:36872
ds_read_b64_tr_b16 a[138:139], v88 offset:39176
ds_read_b64_tr_b16 a[140:141], v88 offset:55304
ds_read_b64_tr_b16 a[142:143], v88 offset:57608
v_and_b32_dpp v60, v80, v8 row_newbcast:1 row_mask:0xf bank_mask:0xf
v_and_b32_dpp v61, v80, v9 row_newbcast:1 row_mask:0xf bank_mask:0xf
v_and_b32_dpp v62, v80, v10 row_newbcast:1 row_mask:0xf bank_mask:0xf
v_and_b32_dpp v63, v80, v11 row_newbcast:1 row_mask:0xf bank_mask:0xf
v_and_b32_dpp v64, v80, v8 row_newbcast:5 row_mask:0xf bank_mask:0xf
v_and_b32_dpp v65, v80, v9 row_newbcast:5 row_mask:0xf bank_mask:0xf
v_and_b32_dpp v66, v80, v10 row_newbcast:5 row_mask:0xf bank_mask:0xf
v_and_b32_dpp v67, v80, v11 row_newbcast:5 row_mask:0xf bank_mask:0xf
v_and_b32_dpp v68, v80, v8 row_newbcast:9 row_mask:0xf bank_mask:0xf
v_and_b32_dpp v69, v80, v9 row_newbcast:9 row_mask:0xf bank_mask:0xf
v_and_b32_dpp v70, v80, v10 row_newbcast:9 row_mask:0xf bank_mask:0xf
v_and_b32_dpp v71, v80, v11 row_newbcast:9 row_mask:0xf bank_mask:0xf
v_and_b32_dpp v72, v80, v8 row_newbcast:13 row_mask:0xf bank_mask:0xf
v_and_b32_dpp v73, v80, v9 row_newbcast:13 row_mask:0xf bank_mask:0xf
v_and_b32_dpp v74, v80, v10 row_newbcast:13 row_mask:0xf bank_mask:0xf
v_and_b32_dpp v75, v80, v11 row_newbcast:13 row_mask:0xf bank_mask:0xf
s_waitcnt vmcnt(35)
v_mfma_f32_16x16x32_bf16 v[20:23], v[60:63], v[200:203], v[20:23]
v_mfma_f32_16x16x32_bf16 v[20:23], v[64:67], v[204:207], v[20:23]
v_mfma_f32_16x16x32_bf16 v[20:23], v[68:71], v[208:211], v[20:23]
v_mfma_f32_16x16x32_bf16 v[20:23], v[72:75], v[212:215], v[20:23]
v_add_u32 v117, 1, v117
buffer_store_dword v117, v118, s[64:67], 0 offen
buffer_load_dwordx4 v[200:203], v2, s[52:55], s12 offen offset:0 nt
buffer_load_dwordx4 v[204:207], v2, s[52:55], s12 offen offset:1024 nt
buffer_load_dwordx4 v[208:211], v2, s[52:55], s12 offen offset:2048 nt
buffer_load_dwordx4 v[212:215], v2, s[52:55], s12 offen offset:3072 nt
s_add_u32 s13, s13, 24576
s_min_u32 s12, s13, 2146435072
ds_read_b64_tr_b16 a[144:145], v90 offset:8
ds_read_b64_tr_b16 a[146:147], v90 offset:2312
ds_read_b64_tr_b16 a[148:149], v90 offset:18440
ds_read_b64_tr_b16 a[150:151], v90 offset:20744
v_and_b32_dpp v60, v76, v8 row_newbcast:3 row_mask:0xf bank_mask:0xf
v_and_b32_dpp v61, v76, v9 row_newbcast:3 row_mask:0xf bank_mask:0xf
v_and_b32_dpp v62, v76, v10 row_newbcast:3 row_mask:0xf bank_mask:0xf
v_and_b32_dpp v63, v76, v11 row_newbcast:3 row_mask:0xf bank_mask:0xf
v_and_b32_dpp v64, v76, v8 row_newbcast:7 row_mask:0xf bank_mask:0xf
v_and_b32_dpp v65, v76, v9 row_newbcast:7 row_mask:0xf bank_mask:0xf
v_and_b32_dpp v66, v76, v10 row_newbcast:7 row_mask:0xf bank_mask:0xf
v_and_b32_dpp v67, v76, v11 row_newbcast:7 row_mask:0xf bank_mask:0xf
v_and_b32_dpp v68, v76, v8 row_newbcast:11 row_mask:0xf bank_mask:0xf
v_and_b32_dpp v69, v76, v9 row_newbcast:11 row_mask:0xf bank_mask:0xf
v_and_b32_dpp v70, v76, v10 row_newbcast:11 row_mask:0xf bank_mask:0xf
v_and_b32_dpp v71, v76, v11 row_newbcast:11 row_mask:0xf bank_mask:0xf
v_and_b32_dpp v72, v76, v8 row_newbcast:15 row_mask:0xf bank_mask:0xf
v_and_b32_dpp v73, v76, v9 row_newbcast:15 row_mask:0xf bank_mask:0xf
v_and_b32_dpp v74, v76, v10 row_newbcast:15 row_mask:0xf bank_mask:0xf
v_and_b32_dpp v75, v76, v11 row_newbcast:15 row_mask:0xf bank_mask:0xf
v_mfma_f32_16x16x32_bf16 v[20:23], v[60:63], a[32:35], v[20:23]
v_mfma_f32_16x16x32_bf16 v[20:23], v[64:67], a[36:39], v[20:23]
v_mfma_f32_16x16x32_bf16 v[20:23], v[68:71], a[40:43], v[20:23]
v_mfma_f32_16x16x32_bf16 v[20:23], v[72:75], a[44:47], v[20:23]
s_nop 3
v_and_b32_dpp v60, v80, v8 row_newbcast:2 row_mask:0xf bank_mask:0xf
v_and_b32_dpp v61, v80, v9 row_newbcast:2 row_mask:0xf bank_mask:0xf
v_and_b32_dpp v62, v80, v10 row_newbcast:2 row_mask:0xf bank_mask:0xf
v_and_b32_dpp v63, v80, v11 row_newbcast:2 row_mask:0xf bank_mask:0xf
v_and_b32_dpp v64, v80, v8 row_newbcast:6 row_mask:0xf bank_mask:0xf
v_and_b32_dpp v65, v80, v9 row_newbcast:6 row_mask:0xf bank_mask:0xf
v_and_b32_dpp v66, v80, v10 row_newbcast:6 row_mask:0xf bank_mask:0xf
v_and_b32_dpp v67, v80, v11 row_newbcast:6 row_mask:0xf bank_mask:0xf
v_and_b32_dpp v68, v80, v8 row_newbcast:10 row_mask:0xf bank_mask:0xf
v_and_b32_dpp v69, v80, v9 row_newbcast:10 row_mask:0xf bank_mask:0xf
v_and_b32_dpp v70, v80, v10 row_newbcast:10 row_mask:0xf bank_mask:0xf
v_and_b32_dpp v71, v80, v11 row_newbcast:10 row_mask:0xf bank_mask:0xf
v_and_b32_dpp v72, v80, v8 row_newbcast:14 row_mask:0xf bank_mask:0xf
v_and_b32_dpp v73, v80, v9 row_newbcast:14 row_mask:0xf bank_mask:0xf
v_and_b32_dpp v74, v80, v10 row_newbcast:14 row_mask:0xf bank_mask:0xf
v_and_b32_dpp v75, v80, v11 row_newbcast:14 row_mask:0xf bank_mask:0xf
s_waitcnt vmcnt(35)
v_mfma_f32_16x16x32_bf16 v[20:23], v[60:63], v[216:219], v[20:23]
v_mfma_f32_16x16x32_bf16 v[20:23], v[64:67], v[220:223], v[20:23]
v_mfma_f32_16x16x32_bf16 v[20:23], v[68:71], v[224:227], v[20:23]
v_mfma_f32_16x16x32_bf16 v[20:23], v[72:75], v[228:231], v[20:23]
v_add_u32 v117, 1, v117
buffer_store_dword v117, v118, s[64:67], 0 offen
buffer_load_dwordx4 v[216:219], v2, s[52:55], s12 offen offset:0 nt
buffer_load_dwordx4 v[220:223], v2, s[52:55], s12 offen offset:1024 nt
buffer_load_dwordx4 v[224:227], v2, s[52:55], s12 offen offset:2048 nt
buffer_load_dwordx4 v[228:231], v2, s[52:55], s12 offen offset:3072 nt
s_add_u32 s13, s13, 24576
s_min_u32 s12, s13, 2146435072
ds_read_b64_tr_b16 a[152:153], v90 offset:36872
ds_read_b64_tr_b16 a[154:155], v90 offset:39176
ds_read_b64_tr_b16 a[156:157], v90 offset:55304
ds_read_b64_tr_b16 a[158:159], v90 offset:57608
v_and_b32_dpp v60, v80, v8 row_newbcast:3 row_mask:0xf bank_mask:0xf
v_and_b32_dpp v61, v80, v9 row_newbcast:3 row_mask:0xf bank_mask:0xf
v_and_b32_dpp v62, v80, v10 row_newbcast:3 row_mask:0xf bank_mask:0xf
v_and_b32_dpp v63, v80, v11 row_newbcast:3 row_mask:0xf bank_mask:0xf
v_and_b32_dpp v64, v80, v8 row_newbcast:7 row_mask:0xf bank_mask:0xf
v_and_b32_dpp v65, v80, v9 row_newbcast:7 row_mask:0xf bank_mask:0xf
v_and_b32_dpp v66, v80, v10 row_newbcast:7 row_mask:0xf bank_mask:0xf
v_and_b32_dpp v67, v80, v11 row_newbcast:7 row_mask:0xf bank_mask:0xf
v_and_b32_dpp v68, v80, v8 row_newbcast:11 row_mask:0xf bank_mask:0xf
v_and_b32_dpp v69, v80, v9 row_newbcast:11 row_mask:0xf bank_mask:0xf
v_and_b32_dpp v70, v80, v10 row_newbcast:11 row_mask:0xf bank_mask:0xf
v_and_b32_dpp v71, v80, v11 row_newbcast:11 row_mask:0xf bank_mask:0xf
v_and_b32_dpp v72, v80, v8 row_newbcast:15 row_mask:0xf bank_mask:0xf
v_and_b32_dpp v73, v80, v9 row_newbcast:15 row_mask:0xf bank_mask:0xf
v_and_b32_dpp v74, v80, v10 row_newbcast:15 row_mask:0xf bank_mask:0xf
v_and_b32_dpp v75, v80, v11 row_newbcast:15 row_mask:0xf bank_mask:0xf
s_waitcnt vmcnt(35)
v_mfma_f32_16x16x32_bf16 v[20:23], v[60:63], v[232:235], v[20:23]
v_mfma_f32_16x16x32_bf16 v[20:23], v[64:67], v[236:239], v[20:23]
v_mfma_f32_16x16x32_bf16 v[20:23], v[68:71], v[240:243], v[20:23]
v_mfma_f32_16x16x32_bf16 v[20:23], v[72:75], v[244:247], v[20:23]
v_add_u32 v117, 1, v117
buffer_store_dword v117, v118, s[64:67], 0 offen
buffer_load_dwordx4 v[232:235], v2, s[52:55], s12 offen offset:0 nt
buffer_load_dwordx4 v[236:239], v2, s[52:55], s12 offen offset:1024 nt
buffer_load_dwordx4 v[240:243], v2, s[52:55], s12 offen offset:2048 nt
buffer_load_dwordx4 v[244:247], v2, s[52:55], s12 offen offset:3072 nt
s_add_u32 s13, s13, 24576
s_min_u32 s12, s13, 2146435072
ds_read_b64_tr_b16 a[160:161], v88 offset:16
ds_read_b64_tr_b16 a[162:163], v88 offset:2320
ds_read_b64_tr_b16 a[164:165], v88 offset:18448
ds_read_b64_tr_b16 a[166:167], v88 offset:20752
v_and_b32_dpp v60, v81, v8 row_newbcast:0 row_mask:0xf bank_mask:0xf
v_and_b32_dpp v61, v81, v9 row_newbcast:0 row_mask:0xf bank_mask:0xf
v_and_b32_dpp v62, v81, v10 row_newbcast:0 row_mask:0xf bank_mask:0xf
v_and_b32_dpp v63, v81, v11 row_newbcast:0 row_mask:0xf bank_mask:0xf
v_and_b32_dpp v64, v81, v8 row_newbcast:4 row_mask:0xf bank_mask:0xf
v_and_b32_dpp v65, v81, v9 row_newbcast:4 row_mask:0xf bank_mask:0xf
v_and_b32_dpp v66, v81, v10 row_newbcast:4 row_mask:0xf bank_mask:0xf
v_and_b32_dpp v67, v81, v11 row_newbcast:4 row_mask:0xf bank_mask:0xf
v_and_b32_dpp v68, v81, v8 row_newbcast:8 row_mask:0xf bank_mask:0xf
v_and_b32_dpp v69, v81, v9 row_newbcast:8 row_mask:0xf bank_mask:0xf
v_and_b32_dpp v70, v81, v10 row_newbcast:8 row_mask:0xf bank_mask:0xf
v_and_b32_dpp v71, v81, v11 row_newbcast:8 row_mask:0xf bank_mask:0xf
v_and_b32_dpp v72, v81, v8 row_newbcast:12 row_mask:0xf bank_mask:0xf
v_and_b32_dpp v73, v81, v9 row_newbcast:12 row_mask:0xf bank_mask:0xf
v_and_b32_dpp v74, v81, v10 row_newbcast:12 row_mask:0xf bank_mask:0xf
v_and_b32_dpp v75, v81, v11 row_newbcast:12 row_mask:0xf bank_mask:0xf
s_waitcnt vmcnt(35)
v_mfma_f32_16x16x32_bf16 v[20:23], v[60:63], v[120:123], v[20:23]
v_mfma_f32_16x16x32_bf16 v[20:23], v[64:67], v[124:127], v[20:23]
v_mfma_f32_16x16x32_bf16 v[20:23], v[68:71], v[128:131], v[20:23]
v_mfma_f32_16x16x32_bf16 v[20:23], v[72:75], v[132:135], v[20:23]
v_add_u32 v117, 1, v117
buffer_store_dword v117, v118, s[64:67], 0 offen
buffer_load_dwordx4 v[120:123], v2, s[52:55], s12 offen offset:0 nt
buffer_load_dwordx4 v[124:127], v2, s[52:55], s12 offen offset:1024 nt
buffer_load_dwordx4 v[128:131], v2, s[52:55], s12 offen offset:2048 nt
buffer_load_dwordx4 v[132:135], v2, s[52:55], s12 offen offset:3072 nt
s_add_u32 s13, s13, 24576
s_min_u32 s12, s13, 2146435072
ds_read_b64_tr_b16 a[168:169], v88 offset:36880
ds_read_b64_tr_b16 a[170:171], v88 offset:39184
ds_read_b64_tr_b16 a[172:173], v88 offset:55312
ds_read_b64_tr_b16 a[174:175], v88 offset:57616
v_and_b32_dpp v60, v81, v8 row_newbcast:1 row_mask:0xf bank_mask:0xf
v_and_b32_dpp v61, v81, v9 row_newbcast:1 row_mask:0xf bank_mask:0xf
v_and_b32_dpp v62, v81, v10 row_newbcast:1 row_mask:0xf bank_mask:0xf
v_and_b32_dpp v63, v81, v11 row_newbcast:1 row_mask:0xf bank_mask:0xf
v_and_b32_dpp v64, v81, v8 row_newbcast:5 row_mask:0xf bank_mask:0xf
v_and_b32_dpp v65, v81, v9 row_newbcast:5 row_mask:0xf bank_mask:0xf
v_and_b32_dpp v66, v81, v10 row_newbcast:5 row_mask:0xf bank_mask:0xf
v_and_b32_dpp v67, v81, v11 row_newbcast:5 row_mask:0xf bank_mask:0xf
v_and_b32_dpp v68, v81, v8 row_newbcast:9 row_mask:0xf bank_mask:0xf
v_and_b32_dpp v69, v81, v9 row_newbcast:9 row_mask:0xf bank_mask:0xf
v_and_b32_dpp v70, v81, v10 row_newbcast:9 row_mask:0xf bank_mask:0xf
v_and_b32_dpp v71, v81, v11 row_newbcast:9 row_mask:0xf bank_mask:0xf
v_and_b32_dpp v72, v81, v8 row_newbcast:13 row_mask:0xf bank_mask:0xf
v_and_b32_dpp v73, v81, v9 row_newbcast:13 row_mask:0xf bank_mask:0xf
v_and_b32_dpp v74, v81, v10 row_newbcast:13 row_mask:0xf bank_mask:0xf
v_and_b32_dpp v75, v81, v11 row_newbcast:13 row_mask:0xf bank_mask:0xf
s_waitcnt vmcnt(35)
v_mfma_f32_16x16x32_bf16 v[20:23], v[60:63], v[136:139], v[20:23]
v_mfma_f32_16x16x32_bf16 v[20:23], v[64:67], v[140:143], v[20:23]
v_mfma_f32_16x16x32_bf16 v[20:23], v[68:71], v[144:147], v[20:23]
v_mfma_f32_16x16x32_bf16 v[20:23], v[72:75], v[148:151], v[20:23]
v_add_u32 v117, 1, v117
buffer_store_dword v117, v118, s[64:67], 0 offen
buffer_load_dwordx4 v[136:139], v2, s[52:55], s12 offen offset:0 nt
buffer_load_dwordx4 v[140:143], v2, s[52:55], s12 offen offset:1024 nt
buffer_load_dwordx4 v[144:147], v2, s[52:55], s12 offen offset:2048 nt
buffer_load_dwordx4 v[148:151], v2, s[52:55], s12 offen offset:3072 nt
s_add_u32 s13, s13, 24576
s_min_u32 s12, s13, 2146435072
ds_read_b64_tr_b16 a[176:177], v90 offset:16
ds_read_b64_tr_b16 a[178:179], v90 offset:2320
ds_read_b64_tr_b16 a[180:181], v90 offset:18448
ds_read_b64_tr_b16 a[182:183], v90 offset:20752
v_and_b32_dpp v60, v77, v8 row_newbcast:0 row_mask:0xf bank_mask:0xf
v_and_b32_dpp v61, v77, v9 row_newbcast:0 row_mask:0xf bank_mask:0xf
v_and_b32_dpp v62, v77, v10 row_newbcast:0 row_mask:0xf bank_mask:0xf
v_and_b32_dpp v63, v77, v11 row_newbcast:0 row_mask:0xf bank_mask:0xf
v_and_b32_dpp v64, v77, v8 row_newbcast:4 row_mask:0xf bank_mask:0xf
v_and_b32_dpp v65, v77, v9 row_newbcast:4 row_mask:0xf bank_mask:0xf
v_and_b32_dpp v66, v77, v10 row_newbcast:4 row_mask:0xf bank_mask:0xf
v_and_b32_dpp v67, v77, v11 row_newbcast:4 row_mask:0xf bank_mask:0xf
v_and_b32_dpp v68, v77, v8 row_newbcast:8 row_mask:0xf bank_mask:0xf
v_and_b32_dpp v69, v77, v9 row_newbcast:8 row_mask:0xf bank_mask:0xf
v_and_b32_dpp v70, v77, v10 row_newbcast:8 row_mask:0xf bank_mask:0xf
v_and_b32_dpp v71, v77, v11 row_newbcast:8 row_mask:0xf bank_mask:0xf
v_and_b32_dpp v72, v77, v8 row_newbcast:12 row_mask:0xf bank_mask:0xf
v_and_b32_dpp v73, v77, v9 row_newbcast:12 row_mask:0xf bank_mask:0xf
v_and_b32_dpp v74, v77, v10 row_newbcast:12 row_mask:0xf bank_mask:0xf
v_and_b32_dpp v75, v77, v11 row_newbcast:12 row_mask:0xf bank_mask:0xf
v_mfma_f32_16x16x32_bf16 v[20:23], v[60:63], a[48:51], v[20:23]
v_mfma_f32_16x16x32_bf16 v[20:23], v[64:67], a[52:55], v[20:23]
v_mfma_f32_16x16x32_bf16 v[20:23], v[68:71], a[56:59], v[20:23]
v_mfma_f32_16x16x32_bf16 v[20:23], v[72:75], a[60:63], v[20:23]
s_nop 3
v_and_b32_dpp v60, v81, v8 row_newbcast:2 row_mask:0xf bank_mask:0xf
v_and_b32_dpp v61, v81, v9 row_newbcast:2 row_mask:0xf bank_mask:0xf
v_and_b32_dpp v62, v81, v10 row_newbcast:2 row_mask:0xf bank_mask:0xf
v_and_b32_dpp v63, v81, v11 row_newbcast:2 row_mask:0xf bank_mask:0xf
v_and_b32_dpp v64, v81, v8 row_newbcast:6 row_mask:0xf bank_mask:0xf
v_and_b32_dpp v65, v81, v9 row_newbcast:6 row_mask:0xf bank_mask:0xf
v_and_b32_dpp v66, v81, v10 row_newbcast:6 row_mask:0xf bank_mask:0xf
v_and_b32_dpp v67, v81, v11 row_newbcast:6 row_mask:0xf bank_mask:0xf
v_and_b32_dpp v68, v81, v8 row_newbcast:10 row_mask:0xf bank_mask:0xf
v_and_b32_dpp v69, v81, v9 row_newbcast:10 row_mask:0xf bank_mask:0xf
v_and_b32_dpp v70, v81, v10 row_newbcast:10 row_mask:0xf bank_mask:0xf
v_and_b32_dpp v71, v81, v11 row_newbcast:10 row_mask:0xf bank_mask:0xf
v_and_b32_dpp v72, v81, v8 row_newbcast:14 row_mask:0xf bank_mask:0xf
v_and_b32_dpp v73, v81, v9 row_newbcast:14 row_mask:0xf bank_mask:0xf
v_and_b32_dpp v74, v81, v10 row_newbcast:14 row_mask:0xf bank_mask:0xf
v_and_b32_dpp v75, v81, v11 row_newbcast:14 row_mask:0xf bank_mask:0xf
s_waitcnt vmcnt(35)
v_mfma_f32_16x16x32_bf16 v[20:23], v[60:63], v[152:155], v[20:23]
v_mfma_f32_16x16x32_bf16 v[20:23], v[64:67], v[156:159], v[20:23]
v_mfma_f32_16x16x32_bf16 v[20:23], v[68:71], v[160:163], v[20:23]
v_mfma_f32_16x16x32_bf16 v[20:23], v[72:75], v[164:167], v[20:23]
v_add_u32 v117, 1, v117
buffer_store_dword v117, v118, s[64:67], 0 offen
buffer_load_dwordx4 v[152:155], v2, s[52:55], s12 offen offset:0 nt
buffer_load_dwordx4 v[156:159], v2, s[52:55], s12 offen offset:1024 nt
buffer_load_dwordx4 v[160:163], v2, s[52:55], s12 offen offset:2048 nt
buffer_load_dwordx4 v[164:167], v2, s[52:55], s12 offen offset:3072 nt
s_add_u32 s13, s13, 24576
s_min_u32 s12, s13, 2146435072
ds_read_b64_tr_b16 a[184:185], v90 offset:36880
ds_read_b64_tr_b16 a[186:187], v90 offset:39184
ds_read_b64_tr_b16 a[188:189], v90 offset:55312
ds_read_b64_tr_b16 a[190:191], v90 offset:57616
v_and_b32_dpp v60, v81, v8 row_newbcast:3 row_mask:0xf bank_mask:0xf
v_and_b32_dpp v61, v81, v9 row_newbcast:3 row_mask:0xf bank_mask:0xf
v_and_b32_dpp v62, v81, v10 row_newbcast:3 row_mask:0xf bank_mask:0xf
v_and_b32_dpp v63, v81, v11 row_newbcast:3 row_mask:0xf bank_mask:0xf
v_and_b32_dpp v64, v81, v8 row_newbcast:7 row_mask:0xf bank_mask:0xf
v_and_b32_dpp v65, v81, v9 row_newbcast:7 row_mask:0xf bank_mask:0xf
v_and_b32_dpp v66, v81, v10 row_newbcast:7 row_mask:0xf bank_mask:0xf
v_and_b32_dpp v67, v81, v11 row_newbcast:7 row_mask:0xf bank_mask:0xf
v_and_b32_dpp v68, v81, v8 row_newbcast:11 row_mask:0xf bank_mask:0xf
v_and_b32_dpp v69, v81, v9 row_newbcast:11 row_mask:0xf bank_mask:0xf
v_and_b32_dpp v70, v81, v10 row_newbcast:11 row_mask:0xf bank_mask:0xf
v_and_b32_dpp v71, v81, v11 row_newbcast:11 row_mask:0xf bank_mask:0xf
v_and_b32_dpp v72, v81, v8 row_newbcast:15 row_mask:0xf bank_mask:0xf
v_and_b32_dpp v73, v81, v9 row_newbcast:15 row_mask:0xf bank_mask:0xf
v_and_b32_dpp v74, v81, v10 row_newbcast:15 row_mask:0xf bank_mask:0xf
v_and_b32_dpp v75, v81, v11 row_newbcast:15 row_mask:0xf bank_mask:0xf
s_waitcnt vmcnt(35)
v_mfma_f32_16x16x32_bf16 v[20:23], v[60:63], v[168:171], v[20:23]
v_mfma_f32_16x16x32_bf16 v[20:23], v[64:67], v[172:175], v[20:23]
v_mfma_f32_16x16x32_bf16 v[20:23], v[68:71], v[176:179], v[20:23]
v_mfma_f32_16x16x32_bf16 v[20:23], v[72:75], v[180:183], v[20:23]
v_add_u32 v117, 1, v117
buffer_store_dword v117, v118, s[64:67], 0 offen
buffer_load_dwordx4 v[168:171], v2, s[52:55], s12 offen offset:0 nt
buffer_load_dwordx4 v[172:175], v2, s[52:55], s12 offen offset:1024 nt
buffer_load_dwordx4 v[176:179], v2, s[52:55], s12 offen offset:2048 nt
buffer_load_dwordx4 v[180:183], v2, s[52:55], s12 offen offset:3072 nt
s_add_u32 s13, s13, 24576
s_min_u32 s12, s13, 2146435072
ds_read_b64_tr_b16 a[192:193], v88 offset:24
ds_read_b64_tr_b16 a[194:195], v88 offset:2328
ds_read_b64_tr_b16 a[196:197], v88 offset:18456
ds_read_b64_tr_b16 a[198:199], v88 offset:20760
v_and_b32_dpp v60, v82, v8 row_newbcast:0 row_mask:0xf bank_mask:0xf
v_and_b32_dpp v61, v82, v9 row_newbcast:0 row_mask:0xf bank_mask:0xf
v_and_b32_dpp v62, v82, v10 row_newbcast:0 row_mask:0xf bank_mask:0xf
v_and_b32_dpp v63, v82, v11 row_newbcast:0 row_mask:0xf bank_mask:0xf
v_and_b32_dpp v64, v82, v8 row_newbcast:4 row_mask:0xf bank_mask:0xf
v_and_b32_dpp v65, v82, v9 row_newbcast:4 row_mask:0xf bank_mask:0xf
v_and_b32_dpp v66, v82, v10 row_newbcast:4 row_mask:0xf bank_mask:0xf
v_and_b32_dpp v67, v82, v11 row_newbcast:4 row_mask:0xf bank_mask:0xf
v_and_b32_dpp v68, v82, v8 row_newbcast:8 row_mask:0xf bank_mask:0xf
v_and_b32_dpp v69, v82, v9 row_newbcast:8 row_mask:0xf bank_mask:0xf
v_and_b32_dpp v70, v82, v10 row_newbcast:8 row_mask:0xf bank_mask:0xf
v_and_b32_dpp v71, v82, v11 row_newbcast:8 row_mask:0xf bank_mask:0xf
v_and_b32_dpp v72, v82, v8 row_newbcast:12 row_mask:0xf bank_mask:0xf
v_and_b32_dpp v73, v82, v9 row_newbcast:12 row_mask:0xf bank_mask:0xf
v_and_b32_dpp v74, v82, v10 row_newbcast:12 row_mask:0xf bank_mask:0xf
v_and_b32_dpp v75, v82, v11 row_newbcast:12 row_mask:0xf bank_mask:0xf
s_waitcnt vmcnt(35)
v_mfma_f32_16x16x32_bf16 v[20:23], v[60:63], v[184:187], v[20:23]
v_mfma_f32_16x16x32_bf16 v[20:23], v[64:67], v[188:191], v[20:23]
v_mfma_f32_16x16x32_bf16 v[20:23], v[68:71], v[192:195], v[20:23]
v_mfma_f32_16x16x32_bf16 v[20:23], v[72:75], v[196:199], v[20:23]
v_add_u32 v117, 1, v117
buffer_store_dword v117, v118, s[64:67], 0 offen
buffer_load_dwordx4 v[184:187], v2, s[52:55], s12 offen offset:0 nt
buffer_load_dwordx4 v[188:191], v2, s[52:55], s12 offen offset:1024 nt
buffer_load_dwordx4 v[192:195], v2, s[52:55], s12 offen offset:2048 nt
buffer_load_dwordx4 v[196:199], v2, s[52:55], s12 offen offset:3072 nt
s_add_u32 s13, s13, 24576
s_min_u32 s12, s13, 2146435072
ds_read_b64_tr_b16 a[200:201], v88 offset:36888
ds_read_b64_tr_b16 a[202:203], v88 offset:39192
ds_read_b64_tr_b16 a[204:205], v88 offset:55320
ds_read_b64_tr_b16 a[206:207], v88 offset:57624
v_and_b32_dpp v60, v82, v8 row_newbcast:1 row_mask:0xf bank_mask:0xf
v_and_b32_dpp v61, v82, v9 row_newbcast:1 row_mask:0xf bank_mask:0xf
v_and_b32_dpp v62, v82, v10 row_newbcast:1 row_mask:0xf bank_mask:0xf
v_and_b32_dpp v63, v82, v11 row_newbcast:1 row_mask:0xf bank_mask:0xf
v_and_b32_dpp v64, v82, v8 row_newbcast:5 row_mask:0xf bank_mask:0xf
v_and_b32_dpp v65, v82, v9 row_newbcast:5 row_mask:0xf bank_mask:0xf
v_and_b32_dpp v66, v82, v10 row_newbcast:5 row_mask:0xf bank_mask:0xf
v_and_b32_dpp v67, v82, v11 row_newbcast:5 row_mask:0xf bank_mask:0xf
v_and_b32_dpp v68, v82, v8 row_newbcast:9 row_mask:0xf bank_mask:0xf
v_and_b32_dpp v69, v82, v9 row_newbcast:9 row_mask:0xf bank_mask:0xf
v_and_b32_dpp v70, v82, v10 row_newbcast:9 row_mask:0xf bank_mask:0xf
v_and_b32_dpp v71, v82, v11 row_newbcast:9 row_mask:0xf bank_mask:0xf
v_and_b32_dpp v72, v82, v8 row_newbcast:13 row_mask:0xf bank_mask:0xf
v_and_b32_dpp v73, v82, v9 row_newbcast:13 row_mask:0xf bank_mask:0xf
v_and_b32_dpp v74, v82, v10 row_newbcast:13 row_mask:0xf bank_mask:0xf
v_and_b32_dpp v75, v82, v11 row_newbcast:13 row_mask:0xf bank_mask:0xf
s_waitcnt vmcnt(35)
v_mfma_f32_16x16x32_bf16 v[20:23], v[60:63], v[200:203], v[20:23]
v_mfma_f32_16x16x32_bf16 v[20:23], v[64:67], v[204:207], v[20:23]
v_mfma_f32_16x16x32_bf16 v[20:23], v[68:71], v[208:211], v[20:23]
v_mfma_f32_16x16x32_bf16 v[20:23], v[72:75], v[212:215], v[20:23]
v_add_u32 v117, 1, v117
buffer_store_dword v117, v118, s[64:67], 0 offen
buffer_load_dwordx4 v[200:203], v2, s[52:55], s12 offen offset:0 nt
buffer_load_dwordx4 v[204:207], v2, s[52:55], s12 offen offset:1024 nt
buffer_load_dwordx4 v[208:211], v2, s[52:55], s12 offen offset:2048 nt
buffer_load_dwordx4 v[212:215], v2, s[52:55], s12 offen offset:3072 nt
s_add_u32 s13, s13, 24576
s_min_u32 s12, s13, 2146435072
ds_read_b64_tr_b16 a[208:209], v90 offset:24
ds_read_b64_tr_b16 a[210:211], v90 offset:2328
ds_read_b64_tr_b16 a[212:213], v90 offset:18456
ds_read_b64_tr_b16 a[214:215], v90 offset:20760
v_and_b32_dpp v60, v77, v8 row_newbcast:1 row_mask:0xf bank_mask:0xf
v_and_b32_dpp v61, v77, v9 row_newbcast:1 row_mask:0xf bank_mask:0xf
v_and_b32_dpp v62, v77, v10 row_newbcast:1 row_mask:0xf bank_mask:0xf
v_and_b32_dpp v63, v77, v11 row_newbcast:1 row_mask:0xf bank_mask:0xf
v_and_b32_dpp v64, v77, v8 row_newbcast:5 row_mask:0xf bank_mask:0xf
v_and_b32_dpp v65, v77, v9 row_newbcast:5 row_mask:0xf bank_mask:0xf
v_and_b32_dpp v66, v77, v10 row_newbcast:5 row_mask:0xf bank_mask:0xf
v_and_b32_dpp v67, v77, v11 row_newbcast:5 row_mask:0xf bank_mask:0xf
v_and_b32_dpp v68, v77, v8 row_newbcast:9 row_mask:0xf bank_mask:0xf
v_and_b32_dpp v69, v77, v9 row_newbcast:9 row_mask:0xf bank_mask:0xf
v_and_b32_dpp v70, v77, v10 row_newbcast:9 row_mask:0xf bank_mask:0xf
v_and_b32_dpp v71, v77, v11 row_newbcast:9 row_mask:0xf bank_mask:0xf
v_and_b32_dpp v72, v77, v8 row_newbcast:13 row_mask:0xf bank_mask:0xf
v_and_b32_dpp v73, v77, v9 row_newbcast:13 row_mask:0xf bank_mask:0xf
v_and_b32_dpp v74, v77, v10 row_newbcast:13 row_mask:0xf bank_mask:0xf
v_and_b32_dpp v75, v77, v11 row_newbcast:13 row_mask:0xf bank_mask:0xf
v_mfma_f32_16x16x32_bf16 v[20:23], v[60:63], a[64:67], v[20:23]
v_mfma_f32_16x16x32_bf16 v[20:23], v[64:67], a[68:71], v[20:23]
v_mfma_f32_16x16x32_bf16 v[20:23], v[68:71], a[72:75], v[20:23]
v_mfma_f32_16x16x32_bf16 v[20:23], v[72:75], a[76:79], v[20:23]
s_nop 3
v_and_b32_dpp v60, v82, v8 row_newbcast:2 row_mask:0xf bank_mask:0xf
v_and_b32_dpp v61, v82, v9 row_newbcast:2 row_mask:0xf bank_mask:0xf
v_and_b32_dpp v62, v82, v10 row_newbcast:2 row_mask:0xf bank_mask:0xf
v_and_b32_dpp v63, v82, v11 row_newbcast:2 row_mask:0xf bank_mask:0xf
v_and_b32_dpp v64, v82, v8 row_newbcast:6 row_mask:0xf bank_mask:0xf
v_and_b32_dpp v65, v82, v9 row_newbcast:6 row_mask:0xf bank_mask:0xf
v_and_b32_dpp v66, v82, v10 row_newbcast:6 row_mask:0xf bank_mask:0xf
v_and_b32_dpp v67, v82, v11 row_newbcast:6 row_mask:0xf bank_mask:0xf
v_and_b32_dpp v68, v82, v8 row_newbcast:10 row_mask:0xf bank_mask:0xf
v_and_b32_dpp v69, v82, v9 row_newbcast:10 row_mask:0xf bank_mask:0xf
v_and_b32_dpp v70, v82, v10 row_newbcast:10 row_mask:0xf bank_mask:0xf
v_and_b32_dpp v71, v82, v11 row_newbcast:10 row_mask:0xf bank_mask:0xf
v_and_b32_dpp v72, v82, v8 row_newbcast:14 row_mask:0xf bank_mask:0xf
v_and_b32_dpp v73, v82, v9 row_newbcast:14 row_mask:0xf bank_mask:0xf
v_and_b32_dpp v74, v82, v10 row_newbcast:14 row_mask:0xf bank_mask:0xf
v_and_b32_dpp v75, v82, v11 row_newbcast:14 row_mask:0xf bank_mask:0xf
s_waitcnt vmcnt(35)
v_mfma_f32_16x16x32_bf16 v[20:23], v[60:63], v[216:219], v[20:23]
v_mfma_f32_16x16x32_bf16 v[20:23], v[64:67], v[220:223], v[20:23]
v_mfma_f32_16x16x32_bf16 v[20:23], v[68:71], v[224:227], v[20:23]
v_mfma_f32_16x16x32_bf16 v[20:23], v[72:75], v[228:231], v[20:23]
v_add_u32 v117, 1, v117
buffer_store_dword v117, v118, s[64:67], 0 offen
buffer_load_dwordx4 v[216:219], v2, s[52:55], s12 offen offset:0 nt
buffer_load_dwordx4 v[220:223], v2, s[52:55], s12 offen offset:1024 nt
buffer_load_dwordx4 v[224:227], v2, s[52:55], s12 offen offset:2048 nt
buffer_load_dwordx4 v[228:231], v2, s[52:55], s12 offen offset:3072 nt
s_add_u32 s13, s13, 24576
s_min_u32 s12, s13, 2146435072
ds_read_b64_tr_b16 a[216:217], v90 offset:36888
ds_read_b64_tr_b16 a[218:219], v90 offset:39192
ds_read_b64_tr_b16 a[220:221], v90 offset:55320
ds_read_b64_tr_b16 a[222:223], v90 offset:57624
v_and_b32_dpp v60, v82, v8 row_newbcast:3 row_mask:0xf bank_mask:0xf
v_and_b32_dpp v61, v82, v9 row_newbcast:3 row_mask:0xf bank_mask:0xf
v_and_b32_dpp v62, v82, v10 row_newbcast:3 row_mask:0xf bank_mask:0xf
v_and_b32_dpp v63, v82, v11 row_newbcast:3 row_mask:0xf bank_mask:0xf
v_and_b32_dpp v64, v82, v8 row_newbcast:7 row_mask:0xf bank_mask:0xf
v_and_b32_dpp v65, v82, v9 row_newbcast:7 row_mask:0xf bank_mask:0xf
v_and_b32_dpp v66, v82, v10 row_newbcast:7 row_mask:0xf bank_mask:0xf
v_and_b32_dpp v67, v82, v11 row_newbcast:7 row_mask:0xf bank_mask:0xf
v_and_b32_dpp v68, v82, v8 row_newbcast:11 row_mask:0xf bank_mask:0xf
v_and_b32_dpp v69, v82, v9 row_newbcast:11 row_mask:0xf bank_mask:0xf
v_and_b32_dpp v70, v82, v10 row_newbcast:11 row_mask:0xf bank_mask:0xf
v_and_b32_dpp v71, v82, v11 row_newbcast:11 row_mask:0xf bank_mask:0xf
v_and_b32_dpp v72, v82, v8 row_newbcast:15 row_mask:0xf bank_mask:0xf
v_and_b32_dpp v73, v82, v9 row_newbcast:15 row_mask:0xf bank_mask:0xf
v_and_b32_dpp v74, v82, v10 row_newbcast:15 row_mask:0xf bank_mask:0xf
v_and_b32_dpp v75, v82, v11 row_newbcast:15 row_mask:0xf bank_mask:0xf
s_waitcnt vmcnt(35)
v_mfma_f32_16x16x32_bf16 v[20:23], v[60:63], v[232:235], v[20:23]
v_mfma_f32_16x16x32_bf16 v[20:23], v[64:67], v[236:239], v[20:23]
v_mfma_f32_16x16x32_bf16 v[20:23], v[68:71], v[240:243], v[20:23]
v_mfma_f32_16x16x32_bf16 v[20:23], v[72:75], v[244:247], v[20:23]
v_add_u32 v117, 1, v117
buffer_store_dword v117, v118, s[64:67], 0 offen
buffer_load_dwordx4 v[232:235], v2, s[52:55], s12 offen offset:0 nt
buffer_load_dwordx4 v[236:239], v2, s[52:55], s12 offen offset:1024 nt
buffer_load_dwordx4 v[240:243], v2, s[52:55], s12 offen offset:2048 nt
buffer_load_dwordx4 v[244:247], v2, s[52:55], s12 offen offset:3072 nt
s_add_u32 s13, s13, 24576
s_min_u32 s12, s13, 2146435072
ds_read_b64_tr_b16 a[224:225], v89 offset:0
ds_read_b64_tr_b16 a[226:227], v89 offset:4608
ds_read_b64_tr_b16 a[228:229], v89 offset:36864
ds_read_b64_tr_b16 a[230:231], v89 offset:41472
buffer_load_dwordx4 v[40:43], off, s[64:67], s82 offset:0 sc1
buffer_load_dwordx4 v[44:47], off, s[64:67], s82 offset:16 sc1
buffer_load_dwordx4 v[48:51], off, s[64:67], s82 offset:32 sc1
v_and_b32_dpp v60, v83, v8 row_newbcast:0 row_mask:0xf bank_mask:0xf
v_and_b32_dpp v61, v83, v9 row_newbcast:0 row_mask:0xf bank_mask:0xf
v_and_b32_dpp v62, v83, v10 row_newbcast:0 row_mask:0xf bank_mask:0xf
v_and_b32_dpp v63, v83, v11 row_newbcast:0 row_mask:0xf bank_mask:0xf
v_and_b32_dpp v64, v83, v8 row_newbcast:4 row_mask:0xf bank_mask:0xf
v_and_b32_dpp v65, v83, v9 row_newbcast:4 row_mask:0xf bank_mask:0xf
v_and_b32_dpp v66, v83, v10 row_newbcast:4 row_mask:0xf bank_mask:0xf
v_and_b32_dpp v67, v83, v11 row_newbcast:4 row_mask:0xf bank_mask:0xf
v_and_b32_dpp v68, v83, v8 row_newbcast:8 row_mask:0xf bank_mask:0xf
v_and_b32_dpp v69, v83, v9 row_newbcast:8 row_mask:0xf bank_mask:0xf
v_and_b32_dpp v70, v83, v10 row_newbcast:8 row_mask:0xf bank_mask:0xf
v_and_b32_dpp v71, v83, v11 row_newbcast:8 row_mask:0xf bank_mask:0xf
v_and_b32_dpp v72, v83, v8 row_newbcast:12 row_mask:0xf bank_mask:0xf
v_and_b32_dpp v73, v83, v9 row_newbcast:12 row_mask:0xf bank_mask:0xf
v_and_b32_dpp v74, v83, v10 row_newbcast:12 row_mask:0xf bank_mask:0xf
v_and_b32_dpp v75, v83, v11 row_newbcast:12 row_mask:0xf bank_mask:0xf
s_waitcnt vmcnt(38)
v_mfma_f32_16x16x32_bf16 v[20:23], v[60:63], v[120:123], v[20:23]
v_mfma_f32_16x16x32_bf16 v[20:23], v[64:67], v[124:127], v[20:23]
v_mfma_f32_16x16x32_bf16 v[20:23], v[68:71], v[128:131], v[20:23]
v_mfma_f32_16x16x32_bf16 v[20:23], v[72:75], v[132:135], v[20:23]
v_add_u32 v117, 1, v117
buffer_store_dword v117, v118, s[64:67], 0 offen
buffer_load_dwordx4 v[120:123], v2, s[52:55], s12 offen offset:0 nt
buffer_load_dwordx4 v[124:127], v2, s[52:55], s12 offen offset:1024 nt
buffer_load_dwordx4 v[128:131], v2, s[52:55], s12 offen offset:2048 nt
buffer_load_dwordx4 v[132:135], v2, s[52:55], s12 offen offset:3072 nt
s_add_u32 s13, s13, 24576
s_min_u32 s12, s13, 2146435072
ds_read_b64_tr_b16 a[232:233], v91 offset:0
ds_read_b64_tr_b16 a[234:235], v91 offset:4608
ds_read_b64_tr_b16 a[236:237], v91 offset:36864
ds_read_b64_tr_b16 a[238:239], v91 offset:41472
v_and_b32_dpp v60, v83, v8 row_newbcast:1 row_mask:0xf bank_mask:0xf
v_and_b32_dpp v61, v83, v9 row_newbcast:1 row_mask:0xf bank_mask:0xf
v_and_b32_dpp v62, v83, v10 row_newbcast:1 row_mask:0xf bank_mask:0xf
v_and_b32_dpp v63, v83, v11 row_newbcast:1 row_mask:0xf bank_mask:0xf
v_and_b32_dpp v64, v83, v8 row_newbcast:5 row_mask:0xf bank_mask:0xf
v_and_b32_dpp v65, v83, v9 row_newbcast:5 row_mask:0xf bank_mask:0xf
v_and_b32_dpp v66, v83, v10 row_newbcast:5 row_mask:0xf bank_mask:0xf
v_and_b32_dpp v67, v83, v11 row_newbcast:5 row_mask:0xf bank_mask:0xf
v_and_b32_dpp v68, v83, v8 row_newbcast:9 row_mask:0xf bank_mask:0xf
v_and_b32_dpp v69, v83, v9 row_newbcast:9 row_mask:0xf bank_mask:0xf
v_and_b32_dpp v70, v83, v10 row_newbcast:9 row_mask:0xf bank_mask:0xf
v_and_b32_dpp v71, v83, v11 row_newbcast:9 row_mask:0xf bank_mask:0xf
v_and_b32_dpp v72, v83, v8 row_newbcast:13 row_mask:0xf bank_mask:0xf
v_and_b32_dpp v73, v83, v9 row_newbcast:13 row_mask:0xf bank_mask:0xf
v_and_b32_dpp v74, v83, v10 row_newbcast:13 row_mask:0xf bank_mask:0xf
v_and_b32_dpp v75, v83, v11 row_newbcast:13 row_mask:0xf bank_mask:0xf
s_waitcnt vmcnt(38)
v_mfma_f32_16x16x32_bf16 v[20:23], v[60:63], v[136:139], v[20:23]
v_mfma_f32_16x16x32_bf16 v[20:23], v[64:67], v[140:143], v[20:23]
v_mfma_f32_16x16x32_bf16 v[20:23], v[68:71], v[144:147], v[20:23]
v_mfma_f32_16x16x32_bf16 v[20:23], v[72:75], v[148:151], v[20:23]
s_nop 3
v_and_b32_dpp v60, v83, v8 row_newbcast:2 row_mask:0xf bank_mask:0xf
v_and_b32_dpp v61, v83, v9 row_newbcast:2 row_mask:0xf bank_mask:0xf
v_and_b32_dpp v62, v83, v10 row_newbcast:2 row_mask:0xf bank_mask:0xf
v_and_b32_dpp v63, v83, v11 row_newbcast:2 row_mask:0xf bank_mask:0xf
v_and_b32_dpp v64, v83, v8 row_newbcast:6 row_mask:0xf bank_mask:0xf
v_and_b32_dpp v65, v83, v9 row_newbcast:6 row_mask:0xf bank_mask:0xf
v_and_b32_dpp v66, v83, v10 row_newbcast:6 row_mask:0xf bank_mask:0xf
v_and_b32_dpp v67, v83, v11 row_newbcast:6 row_mask:0xf bank_mask:0xf
v_and_b32_dpp v68, v83, v8 row_newbcast:10 row_mask:0xf bank_mask:0xf
v_and_b32_dpp v69, v83, v9 row_newbcast:10 row_mask:0xf bank_mask:0xf
v_and_b32_dpp v70, v83, v10 row_newbcast:10 row_mask:0xf bank_mask:0xf
v_and_b32_dpp v71, v83, v11 row_newbcast:10 row_mask:0xf bank_mask:0xf
v_and_b32_dpp v72, v83, v8 row_newbcast:14 row_mask:0xf bank_mask:0xf
v_and_b32_dpp v73, v83, v9 row_newbcast:14 row_mask:0xf bank_mask:0xf
v_and_b32_dpp v74, v83, v10 row_newbcast:14 row_mask:0xf bank_mask:0xf
v_and_b32_dpp v75, v83, v11 row_newbcast:14 row_mask:0xf bank_mask:0xf
s_waitcnt vmcnt(33)
v_mfma_f32_16x16x32_bf16 v[20:23], v[60:63], v[152:155], v[20:23]
v_mfma_f32_16x16x32_bf16 v[20:23], v[64:67], v[156:159], v[20:23]
v_mfma_f32_16x16x32_bf16 v[20:23], v[68:71], v[160:163], v[20:23]
v_mfma_f32_16x16x32_bf16 v[20:23], v[72:75], v[164:167], v[20:23]
v_add_u32 v117, 1, v117
buffer_store_dword v117, v118, s[64:67], 0 offen
buffer_load_dwordx4 v[136:139], v2, s[52:55], s12 offen offset:0 nt
buffer_load_dwordx4 v[140:143], v2, s[52:55], s12 offen offset:1024 nt
buffer_load_dwordx4 v[144:147], v2, s[52:55], s12 offen offset:2048 nt
buffer_load_dwordx4 v[148:151], v2, s[52:55], s12 offen offset:3072 nt
s_add_u32 s13, s13, 24576
s_min_u32 s12, s13, 2146435072
v_and_b32_dpp v60, v77, v8 row_newbcast:2 row_mask:0xf bank_mask:0xf
v_and_b32_dpp v61, v77, v9 row_newbcast:2 row_mask:0xf bank_mask:0xf
v_and_b32_dpp v62, v77, v10 row_newbcast:2 row_mask:0xf bank_mask:0xf
v_and_b32_dpp v63, v77, v11 row_newbcast:2 row_mask:0xf bank_mask:0xf
v_and_b32_dpp v64, v77, v8 row_newbcast:6 row_mask:0xf bank_mask:0xf
v_and_b32_dpp v65, v77, v9 row_newbcast:6 row_mask:0xf bank_mask:0xf
v_and_b32_dpp v66, v77, v10 row_newbcast:6 row_mask:0xf bank_mask:0xf
v_and_b32_dpp v67, v77, v11 row_newbcast:6 row_mask:0xf bank_mask:0xf
v_and_b32_dpp v68, v77, v8 row_newbcast:10 row_mask:0xf bank_mask:0xf
v_and_b32_dpp v69, v77, v9 row_newbcast:10 row_mask:0xf bank_mask:0xf
v_and_b32_dpp v70, v77, v10 row_newbcast:10 row_mask:0xf bank_mask:0xf
v_and_b32_dpp v71, v77, v11 row_newbcast:10 row_mask:0xf bank_mask:0xf
v_and_b32_dpp v72, v77, v8 row_newbcast:14 row_mask:0xf bank_mask:0xf
v_and_b32_dpp v73, v77, v9 row_newbcast:14 row_mask:0xf bank_mask:0xf
v_and_b32_dpp v74, v77, v10 row_newbcast:14 row_mask:0xf bank_mask:0xf
v_and_b32_dpp v75, v77, v11 row_newbcast:14 row_mask:0xf bank_mask:0xf
v_mfma_f32_16x16x32_bf16 v[20:23], v[60:63], a[80:83], v[20:23]
v_mfma_f32_16x16x32_bf16 v[20:23], v[64:67], a[84:87], v[20:23]
v_mfma_f32_16x16x32_bf16 v[20:23], v[68:71], a[88:91], v[20:23]
v_mfma_f32_16x16x32_bf16 v[20:23], v[72:75], a[92:95], v[20:23]
s_nop 3
v_and_b32_dpp v60, v83, v8 row_newbcast:3 row_mask:0xf bank_mask:0xf
v_and_b32_dpp v61, v83, v9 row_newbcast:3 row_mask:0xf bank_mask:0xf
v_and_b32_dpp v62, v83, v10 row_newbcast:3 row_mask:0xf bank_mask:0xf
v_and_b32_dpp v63, v83, v11 row_newbcast:3 row_mask:0xf bank_mask:0xf
v_and_b32_dpp v64, v83, v8 row_newbcast:7 row_mask:0xf bank_mask:0xf
v_and_b32_dpp v65, v83, v9 row_newbcast:7 row_mask:0xf bank_mask:0xf
v_and_b32_dpp v66, v83, v10 row_newbcast:7 row_mask:0xf bank_mask:0xf
v_and_b32_dpp v67, v83, v11 row_newbcast:7 row_mask:0xf bank_mask:0xf
v_and_b32_dpp v68, v83, v8 row_newbcast:11 row_mask:0xf bank_mask:0xf
v_and_b32_dpp v69, v83, v9 row_newbcast:11 row_mask:0xf bank_mask:0xf
v_and_b32_dpp v70, v83, v10 row_newbcast:11 row_mask:0xf bank_mask:0xf
v_and_b32_dpp v71, v83, v11 row_newbcast:11 row_mask:0xf bank_mask:0xf
v_and_b32_dpp v72, v83, v8 row_newbcast:15 row_mask:0xf bank_mask:0xf
v_and_b32_dpp v73, v83, v9 row_newbcast:15 row_mask:0xf bank_mask:0xf
v_and_b32_dpp v74, v83, v10 row_newbcast:15 row_mask:0xf bank_mask:0xf
v_and_b32_dpp v75, v83, v11 row_newbcast:15 row_mask:0xf bank_mask:0xf
s_waitcnt vmcnt(33)
v_mfma_f32_16x16x32_bf16 v[20:23], v[60:63], v[168:171], v[20:23]
v_mfma_f32_16x16x32_bf16 v[20:23], v[64:67], v[172:175], v[20:23]
v_mfma_f32_16x16x32_bf16 v[20:23], v[68:71], v[176:179], v[20:23]
v_mfma_f32_16x16x32_bf16 v[20:23], v[72:75], v[180:183], v[20:23]
s_nop 3
v_and_b32_dpp v60, v84, v8 row_newbcast:0 row_mask:0xf bank_mask:0xf
v_and_b32_dpp v61, v84, v9 row_newbcast:0 row_mask:0xf bank_mask:0xf
v_and_b32_dpp v62, v84, v10 row_newbcast:0 row_mask:0xf bank_mask:0xf
v_and_b32_dpp v63, v84, v11 row_newbcast:0 row_mask:0xf bank_mask:0xf
v_and_b32_dpp v64, v84, v8 row_newbcast:4 row_mask:0xf bank_mask:0xf
v_and_b32_dpp v65, v84, v9 row_newbcast:4 row_mask:0xf bank_mask:0xf
v_and_b32_dpp v66, v84, v10 row_newbcast:4 row_mask:0xf bank_mask:0xf
v_and_b32_dpp v67, v84, v11 row_newbcast:4 row_mask:0xf bank_mask:0xf
v_and_b32_dpp v68, v84, v8 row_newbcast:8 row_mask:0xf bank_mask:0xf
v_and_b32_dpp v69, v84, v9 row_newbcast:8 row_mask:0xf bank_mask:0xf
v_and_b32_dpp v70, v84, v10 row_newbcast:8 row_mask:0xf bank_mask:0xf
v_and_b32_dpp v71, v84, v11 row_newbcast:8 row_mask:0xf bank_mask:0xf
v_and_b32_dpp v72, v84, v8 row_newbcast:12 row_mask:0xf bank_mask:0xf
v_and_b32_dpp v73, v84, v9 row_newbcast:12 row_mask:0xf bank_mask:0xf
v_and_b32_dpp v74, v84, v10 row_newbcast:12 row_mask:0xf bank_mask:0xf
v_and_b32_dpp v75, v84, v11 row_newbcast:12 row_mask:0xf bank_mask:0xf
s_waitcnt vmcnt(28)
v_mfma_f32_16x16x32_bf16 v[20:23], v[60:63], v[184:187], v[20:23]
v_mfma_f32_16x16x32_bf16 v[20:23], v[64:67], v[188:191], v[20:23]
v_mfma_f32_16x16x32_bf16 v[20:23], v[68:71], v[192:195], v[20:23]
v_mfma_f32_16x16x32_bf16 v[20:23], v[72:75], v[196:199], v[20:23]
v_add_u32 v117, 1, v117
buffer_store_dword v117, v118, s[64:67], 0 offen
buffer_load_dwordx4 v[152:155], v2, s[52:55], s12 offen offset:0 nt
buffer_load_dwordx4 v[156:159], v2, s[52:55], s12 offen offset:1024 nt
buffer_load_dwordx4 v[160:163], v2, s[52:55], s12 offen offset:2048 nt
buffer_load_dwordx4 v[164:167], v2, s[52:55], s12 offen offset:3072 nt
s_add_u32 s13, s13, 24576
s_min_u32 s12, s13, 2146435072
v_and_b32_dpp v60, v84, v8 row_newbcast:1 row_mask:0xf bank_mask:0xf
v_and_b32_dpp v61, v84, v9 row_newbcast:1 row_mask:0xf bank_mask:0xf
v_and_b32_dpp v62, v84, v10 row_newbcast:1 row_mask:0xf bank_mask:0xf
v_and_b32_dpp v63, v84, v11 row_newbcast:1 row_mask:0xf bank_mask:0xf
v_and_b32_dpp v64, v84, v8 row_newbcast:5 row_mask:0xf bank_mask:0xf
v_and_b32_dpp v65, v84, v9 row_newbcast:5 row_mask:0xf bank_mask:0xf
v_and_b32_dpp v66, v84, v10 row_newbcast:5 row_mask:0xf bank_mask:0xf
v_and_b32_dpp v67, v84, v11 row_newbcast:5 row_mask:0xf bank_mask:0xf
v_and_b32_dpp v68, v84, v8 row_newbcast:9 row_mask:0xf bank_mask:0xf
v_and_b32_dpp v69, v84, v9 row_newbcast:9 row_mask:0xf bank_mask:0xf
v_and_b32_dpp v70, v84, v10 row_newbcast:9 row_mask:0xf bank_mask:0xf
v_and_b32_dpp v71, v84, v11 row_newbcast:9 row_mask:0xf bank_mask:0xf
v_and_b32_dpp v72, v84, v8 row_newbcast:13 row_mask:0xf bank_mask:0xf
v_and_b32_dpp v73, v84, v9 row_newbcast:13 row_mask:0xf bank_mask:0xf
v_and_b32_dpp v74, v84, v10 row_newbcast:13 row_mask:0xf bank_mask:0xf
v_and_b32_dpp v75, v84, v11 row_newbcast:13 row_mask:0xf bank_mask:0xf
s_waitcnt vmcnt(28)
v_mfma_f32_16x16x32_bf16 v[20:23], v[60:63], v[200:203], v[20:23]
v_mfma_f32_16x16x32_bf16 v[20:23], v[64:67], v[204:207], v[20:23]
v_mfma_f32_16x16x32_bf16 v[20:23], v[68:71], v[208:211], v[20:23]
v_mfma_f32_16x16x32_bf16 v[20:23], v[72:75], v[212:215], v[20:23]
s_nop 3
v_and_b32_dpp v60, v84, v8 row_newbcast:2 row_mask:0xf bank_mask:0xf
v_and_b32_dpp v61, v84, v9 row_newbcast:2 row_mask:0xf bank_mask:0xf
v_and_b32_dpp v62, v84, v10 row_newbcast:2 row_mask:0xf bank_mask:0xf
v_and_b32_dpp v63, v84, v11 row_newbcast:2 row_mask:0xf bank_mask:0xf
v_and_b32_dpp v64, v84, v8 row_newbcast:6 row_mask:0xf bank_mask:0xf
v_and_b32_dpp v65, v84, v9 row_newbcast:6 row_mask:0xf bank_mask:0xf
v_and_b32_dpp v66, v84, v10 row_newbcast:6 row_mask:0xf bank_mask:0xf
v_and_b32_dpp v67, v84, v11 row_newbcast:6 row_mask:0xf bank_mask:0xf
v_and_b32_dpp v68, v84, v8 row_newbcast:10 row_mask:0xf bank_mask:0xf
v_and_b32_dpp v69, v84, v9 row_newbcast:10 row_mask:0xf bank_mask:0xf
v_and_b32_dpp v70, v84, v10 row_newbcast:10 row_mask:0xf bank_mask:0xf
v_and_b32_dpp v71, v84, v11 row_newbcast:10 row_mask:0xf bank_mask:0xf
v_and_b32_dpp v72, v84, v8 row_newbcast:14 row_mask:0xf bank_mask:0xf
v_and_b32_dpp v73, v84, v9 row_newbcast:14 row_mask:0xf bank_mask:0xf
v_and_b32_dpp v74, v84, v10 row_newbcast:14 row_mask:0xf bank_mask:0xf
v_and_b32_dpp v75, v84, v11 row_newbcast:14 row_mask:0xf bank_mask:0xf
s_waitcnt vmcnt(23)
v_mfma_f32_16x16x32_bf16 v[20:23], v[60:63], v[216:219], v[20:23]
v_mfma_f32_16x16x32_bf16 v[20:23], v[64:67], v[220:223], v[20:23]
v_mfma_f32_16x16x32_bf16 v[20:23], v[68:71], v[224:227], v[20:23]
v_mfma_f32_16x16x32_bf16 v[20:23], v[72:75], v[228:231], v[20:23]
v_add_u32 v117, 1, v117
buffer_store_dword v117, v118, s[64:67], 0 offen
buffer_load_dwordx4 v[168:171], v2, s[52:55], s12 offen offset:0 nt
buffer_load_dwordx4 v[172:175], v2, s[52:55], s12 offen offset:1024 nt
buffer_load_dwordx4 v[176:179], v2, s[52:55], s12 offen offset:2048 nt
buffer_load_dwordx4 v[180:183], v2, s[52:55], s12 offen offset:3072 nt
s_add_u32 s13, s13, 24576
s_min_u32 s12, s13, 2146435072
v_and_b32_dpp v60, v84, v8 row_newbcast:3 row_mask:0xf bank_mask:0xf
v_and_b32_dpp v61, v84, v9 row_newbcast:3 row_mask:0xf bank_mask:0xf
v_and_b32_dpp v62, v84, v10 row_newbcast:3 row_mask:0xf bank_mask:0xf
v_and_b32_dpp v63, v84, v11 row_newbcast:3 row_mask:0xf bank_mask:0xf
v_and_b32_dpp v64, v84, v8 row_newbcast:7 row_mask:0xf bank_mask:0xf
v_and_b32_dpp v65, v84, v9 row_newbcast:7 row_mask:0xf bank_mask:0xf
v_and_b32_dpp v66, v84, v10 row_newbcast:7 row_mask:0xf bank_mask:0xf
v_and_b32_dpp v67, v84, v11 row_newbcast:7 row_mask:0xf bank_mask:0xf
v_and_b32_dpp v68, v84, v8 row_newbcast:11 row_mask:0xf bank_mask:0xf
v_and_b32_dpp v69, v84, v9 row_newbcast:11 row_mask:0xf bank_mask:0xf
v_and_b32_dpp v70, v84, v10 row_newbcast:11 row_mask:0xf bank_mask:0xf
v_and_b32_dpp v71, v84, v11 row_newbcast:11 row_mask:0xf bank_mask:0xf
v_and_b32_dpp v72, v84, v8 row_newbcast:15 row_mask:0xf bank_mask:0xf
v_and_b32_dpp v73, v84, v9 row_newbcast:15 row_mask:0xf bank_mask:0xf
v_and_b32_dpp v74, v84, v10 row_newbcast:15 row_mask:0xf bank_mask:0xf
v_and_b32_dpp v75, v84, v11 row_newbcast:15 row_mask:0xf bank_mask:0xf
s_waitcnt vmcnt(23)
v_mfma_f32_16x16x32_bf16 v[20:23], v[60:63], v[232:235], v[20:23]
v_mfma_f32_16x16x32_bf16 v[20:23], v[64:67], v[236:239], v[20:23]
v_mfma_f32_16x16x32_bf16 v[20:23], v[68:71], v[240:243], v[20:23]
v_mfma_f32_16x16x32_bf16 v[20:23], v[72:75], v[244:247], v[20:23]
s_nop 3
v_and_b32_dpp v60, v85, v8 row_newbcast:0 row_mask:0xf bank_mask:0xf
v_and_b32_dpp v61, v85, v9 row_newbcast:0 row_mask:0xf bank_mask:0xf
v_and_b32_dpp v62, v85, v10 row_newbcast:0 row_mask:0xf bank_mask:0xf
v_and_b32_dpp v63, v85, v11 row_newbcast:0 row_mask:0xf bank_mask:0xf
v_and_b32_dpp v64, v85, v8 row_newbcast:4 row_mask:0xf bank_mask:0xf
v_and_b32_dpp v65, v85, v9 row_newbcast:4 row_mask:0xf bank_mask:0xf
v_and_b32_dpp v66, v85, v10 row_newbcast:4 row_mask:0xf bank_mask:0xf
v_and_b32_dpp v67, v85, v11 row_newbcast:4 row_mask:0xf bank_mask:0xf
v_and_b32_dpp v68, v85, v8 row_newbcast:8 row_mask:0xf bank_mask:0xf
v_and_b32_dpp v69, v85, v9 row_newbcast:8 row_mask:0xf bank_mask:0xf
v_and_b32_dpp v70, v85, v10 row_newbcast:8 row_mask:0xf bank_mask:0xf
v_and_b32_dpp v71, v85, v11 row_newbcast:8 row_mask:0xf bank_mask:0xf
v_and_b32_dpp v72, v85, v8 row_newbcast:12 row_mask:0xf bank_mask:0xf
v_and_b32_dpp v73, v85, v9 row_newbcast:12 row_mask:0xf bank_mask:0xf
v_and_b32_dpp v74, v85, v10 row_newbcast:12 row_mask:0xf bank_mask:0xf
v_and_b32_dpp v75, v85, v11 row_newbcast:12 row_mask:0xf bank_mask:0xf
s_waitcnt vmcnt(15)
v_mfma_f32_16x16x32_bf16 v[20:23], v[60:63], v[120:123], v[20:23]
v_mfma_f32_16x16x32_bf16 v[20:23], v[64:67], v[124:127], v[20:23]
v_mfma_f32_16x16x32_bf16 v[20:23], v[68:71], v[128:131], v[20:23]
v_mfma_f32_16x16x32_bf16 v[20:23], v[72:75], v[132:135], v[20:23]
v_add_u32 v117, 1, v117
buffer_store_dword v117, v118, s[64:67], 0 offen
buffer_load_dwordx4 v[184:187], v2, s[52:55], s12 offen offset:0 nt
buffer_load_dwordx4 v[188:191], v2, s[52:55], s12 offen offset:1024 nt
buffer_load_dwordx4 v[192:195], v2, s[52:55], s12 offen offset:2048 nt
buffer_load_dwordx4 v[196:199], v2, s[52:55], s12 offen offset:3072 nt
s_add_u32 s13, s13, 24576
s_min_u32 s12, s13, 2146435072
s_mov_b32 s7, 400000
A_ev2_chk:
v_max3_u32 v35, v40, v41, v42
v_max3_u32 v35, v35, v43, v44
v_max3_u32 v35, v35, v45, v46
v_max3_u32 v35, v35, v47, v48
v_max3_u32 v35, v35, v49, v50
v_max_u32 v35, v35, v51
v_cmp_eq_u32 vcc, -1, v35
s_cbranch_vccz A_ev2_ok
buffer_load_dwordx4 v[40:43], off, s[64:67], s82 offset:0 sc1
buffer_load_dwordx4 v[44:47], off, s[64:67], s82 offset:16 sc1
buffer_load_dwordx4 v[48:51], off, s[64:67], s82 offset:32 sc1
s_waitcnt vmcnt(0)
s_sub_u32 s7, s7, 1
s_cmp_lg_u32 s7, 0
s_cbranch_scc1 A_ev2_chk
A_ev2_ok:
v_max3_f32 v35, v40, v42, v44
v_max3_f32 v36, v46, v48, v50
v_max_f32 v35, v35, v36
v_sub_f32 v40, v40, v35
v_sub_f32 v42, v42, v35
v_sub_f32 v44, v44, v35
v_sub_f32 v46, v46, v35
v_sub_f32 v48, v48, v35
v_sub_f32 v50, v50, v35
v_sub_f32 v37, v32, v35
v_exp_f32 v40, v40
v_exp_f32 v42, v42
v_exp_f32 v44, v44
v_exp_f32 v46, v46
v_exp_f32 v48, v48
v_exp_f32 v50, v50
v_exp_f32 v37, v37
v_mul_f32 v35, v40, v41
v_fma_f32 v35, v42, v43, v35
v_fma_f32 v35, v44, v45, v35
v_fma_f32 v35, v46, v47, v35
v_fma_f32 v35, v48, v49, v35
v_fma_f32 v35, v50, v51, v35
v_rcp_f32 v35, v35
s_nop 0
v_mul_f32 v37, v37, v35
v_and_b32_dpp v60, v85, v8 row_newbcast:1 row_mask:0xf bank_mask:0xf
v_and_b32_dpp v61, v85, v9 row_newbcast:1 row_mask:0xf bank_mask:0xf
v_and_b32_dpp v62, v85, v10 row_newbcast:1 row_mask:0xf bank_mask:0xf
v_and_b32_dpp v63, v85, v11 row_newbcast:1 row_mask:0xf bank_mask:0xf
v_and_b32_dpp v64, v85, v8 row_newbcast:5 row_mask:0xf bank_mask:0xf
v_and_b32_dpp v65, v85, v9 row_newbcast:5 row_mask:0xf bank_mask:0xf
v_and_b32_dpp v66, v85, v10 row_newbcast:5 row_mask:0xf bank_mask:0xf
v_and_b32_dpp v67, v85, v11 row_newbcast:5 row_mask:0xf bank_mask:0xf
v_and_b32_dpp v68, v85, v8 row_newbcast:9 row_mask:0xf bank_mask:0xf
v_and_b32_dpp v69, v85, v9 row_newbcast:9 row_mask:0xf bank_mask:0xf
v_and_b32_dpp v70, v85, v10 row_newbcast:9 row_mask:0xf bank_mask:0xf
v_and_b32_dpp v71, v85, v11 row_newbcast:9 row_mask:0xf bank_mask:0xf
v_and_b32_dpp v72, v85, v8 row_newbcast:13 row_mask:0xf bank_mask:0xf
v_and_b32_dpp v73, v85, v9 row_newbcast:13 row_mask:0xf bank_mask:0xf
v_and_b32_dpp v74, v85, v10 row_newbcast:13 row_mask:0xf bank_mask:0xf
v_and_b32_dpp v75, v85, v11 row_newbcast:13 row_mask:0xf bank_mask:0xf
s_waitcnt vmcnt(15)
v_mfma_f32_16x16x32_bf16 v[20:23], v[60:63], v[136:139], v[20:23]
v_mfma_f32_16x16x32_bf16 v[20:23], v[64:67], v[140:143], v[20:23]
v_mfma_f32_16x16x32_bf16 v[20:23], v[68:71], v[144:147], v[20:23]
v_mfma_f32_16x16x32_bf16 v[20:23], v[72:75], v[148:151], v[20:23]
v_add_u32 v117, 1, v117
buffer_store_dword v117, v118, s[64:67], 0 offen
buffer_load_dwordx4 v[200:203], v2, s[52:55], s12 offen offset:0 nt
buffer_load_dwordx4 v[204:207], v2, s[52:55], s12 offen offset:1024 nt
buffer_load_dwordx4 v[208:211], v2, s[52:55], s12 offen offset:2048 nt
buffer_load_dwordx4 v[212:215], v2, s[52:55], s12 offen offset:3072 nt
s_add_u32 s13, s13, 24576
s_min_u32 s12, s13, 2146435072
v_and_b32_dpp v60, v77, v8 row_newbcast:3 row_mask:0xf bank_mask:0xf
v_and_b32_dpp v61, v77, v9 row_newbcast:3 row_mask:0xf bank_mask:0xf
v_and_b32_dpp v62, v77, v10 row_newbcast:3 row_mask:0xf bank_mask:0xf
v_and_b32_dpp v63, v77, v11 row_newbcast:3 row_mask:0xf bank_mask:0xf
v_and_b32_dpp v64, v77, v8 row_newbcast:7 row_mask:0xf bank_mask:0xf
v_and_b32_dpp v65, v77, v9 row_newbcast:7 row_mask:0xf bank_mask:0xf
v_and_b32_dpp v66, v77, v10 row_newbcast:7 row_mask:0xf bank_mask:0xf
v_and_b32_dpp v67, v77, v11 row_newbcast:7 row_mask:0xf bank_mask:0xf
v_and_b32_dpp v68, v77, v8 row_newbcast:11 row_mask:0xf bank_mask:0xf
v_and_b32_dpp v69, v77, v9 row_newbcast:11 row_mask:0xf bank_mask:0xf
v_and_b32_dpp v70, v77, v10 row_newbcast:11 row_mask:0xf bank_mask:0xf
v_and_b32_dpp v71, v77, v11 row_newbcast:11 row_mask:0xf bank_mask:0xf
v_and_b32_dpp v72, v77, v8 row_newbcast:15 row_mask:0xf bank_mask:0xf
v_and_b32_dpp v73, v77, v9 row_newbcast:15 row_mask:0xf bank_mask:0xf
v_and_b32_dpp v74, v77, v10 row_newbcast:15 row_mask:0xf bank_mask:0xf
v_and_b32_dpp v75, v77, v11 row_newbcast:15 row_mask:0xf bank_mask:0xf
v_mfma_f32_16x16x32_bf16 v[20:23], v[60:63], a[240:243], v[20:23]
v_mfma_f32_16x16x32_bf16 v[20:23], v[64:67], a[244:247], v[20:23]
v_mfma_f32_16x16x32_bf16 v[20:23], v[68:71], a[248:251], v[20:23]
v_mfma_f32_16x16x32_bf16 v[20:23], v[72:75], a[252:255], v[20:23]
s_nop 3
v_and_b32_dpp v60, v85, v8 row_newbcast:2 row_mask:0xf bank_mask:0xf
v_and_b32_dpp v61, v85, v9 row_newbcast:2 row_mask:0xf bank_mask:0xf
v_and_b32_dpp v62, v85, v10 row_newbcast:2 row_mask:0xf bank_mask:0xf
v_and_b32_dpp v63, v85, v11 row_newbcast:2 row_mask:0xf bank_mask:0xf
v_and_b32_dpp v64, v85, v8 row_newbcast:6 row_mask:0xf bank_mask:0xf
v_and_b32_dpp v65, v85, v9 row_newbcast:6 row_mask:0xf bank_mask:0xf
v_and_b32_dpp v66, v85, v10 row_newbcast:6 row_mask:0xf bank_mask:0xf
v_and_b32_dpp v67, v85, v11 row_newbcast:6 row_mask:0xf bank_mask:0xf
v_and_b32_dpp v68, v85, v8 row_newbcast:10 row_mask:0xf bank_mask:0xf
v_and_b32_dpp v69, v85, v9 row_newbcast:10 row_mask:0xf bank_mask:0xf
v_and_b32_dpp v70, v85, v10 row_newbcast:10 row_mask:0xf bank_mask:0xf
v_and_b32_dpp v71, v85, v11 row_newbcast:10 row_mask:0xf bank_mask:0xf
v_and_b32_dpp v72, v85, v8 row_newbcast:14 row_mask:0xf bank_mask:0xf
v_and_b32_dpp v73, v85, v9 row_newbcast:14 row_mask:0xf bank_mask:0xf
v_and_b32_dpp v74, v85, v10 row_newbcast:14 row_mask:0xf bank_mask:0xf
v_and_b32_dpp v75, v85, v11 row_newbcast:14 row_mask:0xf bank_mask:0xf
s_waitcnt vmcnt(15)
v_mfma_f32_16x16x32_bf16 v[20:23], v[60:63], v[152:155], v[20:23]
v_mfma_f32_16x16x32_bf16 v[20:23], v[64:67], v[156:159], v[20:23]
v_mfma_f32_16x16x32_bf16 v[20:23], v[68:71], v[160:163], v[20:23]
v_mfma_f32_16x16x32_bf16 v[20:23], v[72:75], v[164:167], v[20:23]
v_add_u32 v117, 1, v117
buffer_store_dword v117, v118, s[64:67], 0 offen
buffer_load_dwordx4 v[216:219], v2, s[52:55], s12 offen offset:0 nt
buffer_load_dwordx4 v[220:223], v2, s[52:55], s12 offen offset:1024 nt
buffer_load_dwordx4 v[224:227], v2, s[52:55], s12 offen offset:2048 nt
buffer_load_dwordx4 v[228:231], v2, s[52:55], s12 offen offset:3072 nt
s_add_u32 s13, s13, 24576
s_min_u32 s12, s13, 2146435072
v_and_b32_dpp v60, v85, v8 row_newbcast:3 row_mask:0xf bank_mask:0xf
v_and_b32_dpp v61, v85, v9 row_newbcast:3 row_mask:0xf bank_mask:0xf
v_and_b32_dpp v62, v85, v10 row_newbcast:3 row_mask:0xf bank_mask:0xf
v_and_b32_dpp v63, v85, v11 row_newbcast:3 row_mask:0xf bank_mask:0xf
v_and_b32_dpp v64, v85, v8 row_newbcast:7 row_mask:0xf bank_mask:0xf
v_and_b32_dpp v65, v85, v9 row_newbcast:7 row_mask:0xf bank_mask:0xf
v_and_b32_dpp v66, v85, v10 row_newbcast:7 row_mask:0xf bank_mask:0xf
v_and_b32_dpp v67, v85, v11 row_newbcast:7 row_mask:0xf bank_mask:0xf
v_and_b32_dpp v68, v85, v8 row_newbcast:11 row_mask:0xf bank_mask:0xf
v_and_b32_dpp v69, v85, v9 row_newbcast:11 row_mask:0xf bank_mask:0xf
v_and_b32_dpp v70, v85, v10 row_newbcast:11 row_mask:0xf bank_mask:0xf
v_and_b32_dpp v71, v85, v11 row_newbcast:11 row_mask:0xf bank_mask:0xf
v_and_b32_dpp v72, v85, v8 row_newbcast:15 row_mask:0xf bank_mask:0xf
v_and_b32_dpp v73, v85, v9 row_newbcast:15 row_mask:0xf bank_mask:0xf
v_and_b32_dpp v74, v85, v10 row_newbcast:15 row_mask:0xf bank_mask:0xf
v_and_b32_dpp v75, v85, v11 row_newbcast:15 row_mask:0xf bank_mask:0xf
s_waitcnt vmcnt(15)
v_mfma_f32_16x16x32_bf16 v[20:23], v[60:63], v[168:171], v[20:23]
v_mfma_f32_16x16x32_bf16 v[20:23], v[64:67], v[172:175], v[20:23]
v_mfma_f32_16x16x32_bf16 v[20:23], v[68:71], v[176:179], v[20:23]
v_mfma_f32_16x16x32_bf16 v[20:23], v[72:75], v[180:183], v[20:23]
v_add_u32 v117, 1, v117
buffer_store_dword v117, v118, s[64:67], 0 offen
buffer_load_dwordx4 v[232:235], v2, s[52:55], s12 offen offset:0 nt
buffer_load_dwordx4 v[236:239], v2, s[52:55], s12 offen offset:1024 nt
buffer_load_dwordx4 v[240:243], v2, s[52:55], s12 offen offset:2048 nt
buffer_load_dwordx4 v[244:247], v2, s[52:55], s12 offen offset:3072 nt
s_add_u32 s13, s13, 24576
s_min_u32 s12, s13, 2146435072
v_mov_b32 v40, 0
v_mov_b32 v41, 0
v_mov_b32 v42, 0
v_mov_b32 v43, 0
v_mov_b32 v44, 0
v_mov_b32 v45, 0
v_mov_b32 v46, 0
v_mov_b32 v47, 0
v_mov_b32 v48, 0
v_mov_b32 v49, 0
v_mov_b32 v50, 0
v_mov_b32 v51, 0
v_mov_b32 v52, 0
v_mov_b32 v53, 0
v_mov_b32 v54, 0
v_mov_b32 v55, 0
v_and_b32_dpp v120, v86, v8 row_newbcast:0 row_mask:0xf bank_mask:0xf
v_and_b32_dpp v121, v86, v9 row_newbcast:0 row_mask:0xf bank_mask:0xf
v_and_b32_dpp v122, v86, v10 row_newbcast:0 row_mask:0xf bank_mask:0xf
v_and_b32_dpp v123, v86, v11 row_newbcast:0 row_mask:0xf bank_mask:0xf
v_and_b32_dpp v124, v86, v8 row_newbcast:4 row_mask:0xf bank_mask:0xf
v_and_b32_dpp v125, v86, v9 row_newbcast:4 row_mask:0xf bank_mask:0xf
v_and_b32_dpp v126, v86, v10 row_newbcast:4 row_mask:0xf bank_mask:0xf
v_and_b32_dpp v127, v86, v11 row_newbcast:4 row_mask:0xf bank_mask:0xf
v_and_b32_dpp v128, v86, v8 row_newbcast:8 row_mask:0xf bank_mask:0xf
v_and_b32_dpp v129, v86, v9 row_newbcast:8 row_mask:0xf bank_mask:0xf
v_and_b32_dpp v130, v86, v10 row_newbcast:8 row_mask:0xf bank_mask:0xf
v_and_b32_dpp v131, v86, v11 row_newbcast:8 row_mask:0xf bank_mask:0xf
v_and_b32_dpp v132, v86, v8 row_newbcast:12 row_mask:0xf bank_mask:0xf
v_and_b32_dpp v133, v86, v9 row_newbcast:12 row_mask:0xf bank_mask:0xf
v_and_b32_dpp v134, v86, v10 row_newbcast:12 row_mask:0xf bank_mask:0xf
v_and_b32_dpp v135, v86, v11 row_newbcast:12 row_mask:0xf bank_mask:0xf
v_and_b32_dpp v136, v86, v8 row_newbcast:1 row_mask:0xf bank_mask:0xf
v_and_b32_dpp v137, v86, v9 row_newbcast:1 row_mask:0xf bank_mask:0xf
v_and_b32_dpp v138, v86, v10 row_newbcast:1 row_mask:0xf bank_mask:0xf
v_and_b32_dpp v139, v86, v11 row_newbcast:1 row_mask:0xf bank_mask:0xf
v_and_b32_dpp v140, v86, v8 row_newbcast:5 row_mask:0xf bank_mask:0xf
v_and_b32_dpp v141, v86, v9 row_newbcast:5 row_mask:0xf bank_mask:0xf
v_and_b32_dpp v142, v86, v10 row_newbcast:5 row_mask:0xf bank_mask:0xf
v_and_b32_dpp v143, v86, v11 row_newbcast:5 row_mask:0xf bank_mask:0xf
v_and_b32_dpp v144, v86, v8 row_newbcast:9 row_mask:0xf bank_mask:0xf
v_and_b32_dpp v145, v86, v9 row_newbcast:9 row_mask:0xf bank_mask:0xf
v_and_b32_dpp v146, v86, v10 row_newbcast:9 row_mask:0xf bank_mask:0xf
v_and_b32_dpp v147, v86, v11 row_newbcast:9 row_mask:0xf bank_mask:0xf
v_and_b32_dpp v148, v86, v8 row_newbcast:13 row_mask:0xf bank_mask:0xf
v_and_b32_dpp v149, v86, v9 row_newbcast:13 row_mask:0xf bank_mask:0xf
v_and_b32_dpp v150, v86, v10 row_newbcast:13 row_mask:0xf bank_mask:0xf
v_and_b32_dpp v151, v86, v11 row_newbcast:13 row_mask:0xf bank_mask:0xf
v_and_b32_dpp v152, v86, v8 row_newbcast:2 row_mask:0xf bank_mask:0xf
v_and_b32_dpp v153, v86, v9 row_newbcast:2 row_mask:0xf bank_mask:0xf
v_and_b32_dpp v154, v86, v10 row_newbcast:2 row_mask:0xf bank_mask:0xf
v_and_b32_dpp v155, v86, v11 row_newbcast:2 row_mask:0xf bank_mask:0xf
v_and_b32_dpp v156, v86, v8 row_newbcast:6 row_mask:0xf bank_mask:0xf
v_and_b32_dpp v157, v86, v9 row_newbcast:6 row_mask:0xf bank_mask:0xf
v_and_b32_dpp v158, v86, v10 row_newbcast:6 row_mask:0xf bank_mask:0xf
v_and_b32_dpp v159, v86, v11 row_newbcast:6 row_mask:0xf bank_mask:0xf
v_and_b32_dpp v160, v86, v8 row_newbcast:10 row_mask:0xf bank_mask:0xf
v_and_b32_dpp v161, v86, v9 row_newbcast:10 row_mask:0xf bank_mask:0xf
v_and_b32_dpp v162, v86, v10 row_newbcast:10 row_mask:0xf bank_mask:0xf
v_and_b32_dpp v163, v86, v11 row_newbcast:10 row_mask:0xf bank_mask:0xf
v_and_b32_dpp v164, v86, v8 row_newbcast:14 row_mask:0xf bank_mask:0xf
v_and_b32_dpp v165, v86, v9 row_newbcast:14 row_mask:0xf bank_mask:0xf
v_and_b32_dpp v166, v86, v10 row_newbcast:14 row_mask:0xf bank_mask:0xf
v_and_b32_dpp v167, v86, v11 row_newbcast:14 row_mask:0xf bank_mask:0xf
v_and_b32_dpp v168, v86, v8 row_newbcast:3 row_mask:0xf bank_mask:0xf
v_and_b32_dpp v169, v86, v9 row_newbcast:3 row_mask:0xf bank_mask:0xf
v_and_b32_dpp v170, v86, v10 row_newbcast:3 row_mask:0xf bank_mask:0xf
v_and_b32_dpp v171, v86, v11 row_newbcast:3 row_mask:0xf bank_mask:0xf
v_and_b32_dpp v172, v86, v8 row_newbcast:7 row_mask:0xf bank_mask:0xf
v_and_b32_dpp v173, v86, v9 row_newbcast:7 row_mask:0xf bank_mask:0xf
v_and_b32_dpp v174, v86, v10 row_newbcast:7 row_mask:0xf bank_mask:0xf
v_and_b32_dpp v175, v86, v11 row_newbcast:7 row_mask:0xf bank_mask:0xf
v_and_b32_dpp v176, v86, v8 row_newbcast:11 row_mask:0xf bank_mask:0xf
v_and_b32_dpp v177, v86, v9 row_newbcast:11 row_mask:0xf bank_mask:0xf
v_and_b32_dpp v178, v86, v10 row_newbcast:11 row_mask:0xf bank_mask:0xf
v_and_b32_dpp v179, v86, v11 row_newbcast:11 row_mask:0xf bank_mask:0xf
v_and_b32_dpp v180, v86, v8 row_newbcast:15 row_mask:0xf bank_mask:0xf
v_and_b32_dpp v181, v86, v9 row_newbcast:15 row_mask:0xf bank_mask:0xf
v_and_b32_dpp v182, v86, v10 row_newbcast:15 row_mask:0xf bank_mask:0xf
v_and_b32_dpp v183, v86, v11 row_newbcast:15 row_mask:0xf bank_mask:0xf
s_waitcnt vmcnt(15)
v_mfma_f32_16x16x32_bf16 v[20:23], v[120:123], v[184:187], v[20:23]
v_mfma_f32_16x16x32_bf16 v[20:23], v[124:127], v[188:191], v[20:23]
v_mfma_f32_16x16x32_bf16 v[20:23], v[128:131], v[192:195], v[20:23]
v_mfma_f32_16x16x32_bf16 v[20:23], v[132:135], v[196:199], v[20:23]
s_waitcnt vmcnt(10)
v_mfma_f32_16x16x32_bf16 v[20:23], v[136:139], v[200:203], v[20:23]
v_mfma_f32_16x16x32_bf16 v[20:23], v[140:143], v[204:207], v[20:23]
v_mfma_f32_16x16x32_bf16 v[20:23], v[144:147], v[208:211], v[20:23]
v_mfma_f32_16x16x32_bf16 v[20:23], v[148:151], v[212:215], v[20:23]
s_waitcnt vmcnt(5)
v_mfma_f32_16x16x32_bf16 v[20:23], v[152:155], v[216:219], v[20:23]
v_mfma_f32_16x16x32_bf16 v[20:23], v[156:159], v[220:223], v[20:23]
v_mfma_f32_16x16x32_bf16 v[20:23], v[160:163], v[224:227], v[20:23]
v_mfma_f32_16x16x32_bf16 v[20:23], v[164:167], v[228:231], v[20:23]
s_waitcnt vmcnt(3)
v_mfma_f32_16x16x32_bf16 v[20:23], v[168:171], v[232:235], v[20:23]
s_waitcnt vmcnt(2)
v_mfma_f32_16x16x32_bf16 v[20:23], v[172:175], v[236:239], v[20:23]
s_waitcnt vmcnt(1)
v_mfma_f32_16x16x32_bf16 v[20:23], v[176:179], v[240:243], v[20:23]
s_waitcnt vmcnt(0)
v_mfma_f32_16x16x32_bf16 v[20:23], v[180:183], v[244:247], v[20:23]
A_tail:
s_nop 7
v_mul_f32 v20, v20, v37
v_mul_f32 v21, v21, v37
v_mul_f32 v22, v22, v37
v_mul_f32 v23, v23, v37
v_cvt_pk_bf16_f32 v28, v20, v21
v_cvt_pk_bf16_f32 v29, v22, v23
ds_write_b64 v94, v[28:29]
s_waitcnt lgkmcnt(0)
s_barrier
ds_read_b128 a[0:3], v95 offset:0
ds_read_b128 a[4:7], v95 offset:64
ds_read_b128 a[8:11], v95 offset:128
ds_read_b128 a[12:15], v95 offset:192
s_waitcnt lgkmcnt(3)
v_mfma_f32_16x16x32_bf16 v[72:75], a[0:3], a[224:227], 0
s_waitcnt lgkmcnt(2)
v_mfma_f32_16x16x32_bf16 v[72:75], a[4:7], a[228:231], v[72:75]
s_waitcnt lgkmcnt(1)
v_mfma_f32_16x16x32_bf16 v[72:75], a[8:11], a[232:235], v[72:75]
s_waitcnt lgkmcnt(0)
v_mfma_f32_16x16x32_bf16 v[72:75], a[12:15], a[236:239], v[72:75]
v_smfmac_f32_16x16x64_bf16 v[40:43], a[0:3], a[96:103], v105
v_smfmac_f32_16x16x64_bf16 v[40:43], a[4:7], a[104:111], v105
v_smfmac_f32_16x16x64_bf16 v[40:43], a[8:11], a[112:119], v105
v_smfmac_f32_16x16x64_bf16 v[40:43], a[12:15], a[120:127], v105
v_smfmac_f32_16x16x64_bf16 v[44:47], a[0:3], a[128:135], v105
v_smfmac_f32_16x16x64_bf16 v[44:47], a[4:7], a[136:143], v105
v_smfmac_f32_16x16x64_bf16 v[44:47], a[8:11], a[144:151], v105
v_smfmac_f32_16x16x64_bf16 v[44:47], a[12:15], a[152:159], v105
v_pk_mul_f32 v[102:103], v[106:107], v[72:73]
v_pk_fma_f32 v[102:103], v[108:109], v[74:75], v[102:103]
v_smfmac_f32_16x16x64_bf16 v[48:51], a[0:3], a[160:167], v105
v_add_f32 v114, v102, v103
v_pk_mul_f32 v[102:103], v[106:107], v[40:41]
v_smfmac_f32_16x16x64_bf16 v[48:51], a[4:7], a[168:175], v105
v_pk_fma_f32 v[102:103], v[108:109], v[42:43], v[102:103]
v_mov_b32_dpp v29, v114 row_shl:2 row_mask:0xf bank_mask:0xf
v_smfmac_f32_16x16x64_bf16 v[48:51], a[8:11], a[176:183], v105
v_cvt_pk_bf16_f32 v28, v114, v29
v_min_u32 v28, -2, v28
v_smfmac_f32_16x16x64_bf16 v[48:51], a[12:15], a[184:191], v105
v_add_f32 v98, v102, v103
v_pk_mul_f32 v[102:103], v[106:107], v[44:45]
v_smfmac_f32_16x16x64_bf16 v[52:55], a[0:3], a[192:199], v105
v_mov_b32_dpp v29, v28 row_shl:4 row_mask:0xf bank_mask:0xf
v_mov_b32_dpp v30, v28 row_shl:8 row_mask:0xf bank_mask:0xf
v_smfmac_f32_16x16x64_bf16 v[52:55], a[4:7], a[200:207], v105
v_mov_b32_dpp v31, v28 row_shl:12 row_mask:0xf bank_mask:0xf
s_mov_b64 exec, 0x00030003
buffer_store_dwordx4 v[28:31], v93, s[64:67], 0 offen offset:1024 sc1
s_mov_b64 exec, -1
v_smfmac_f32_16x16x64_bf16 v[52:55], a[8:11], a[208:215], v105
v_pk_fma_f32 v[102:103], v[108:109], v[46:47], v[102:103]
v_add_f32 v99, v102, v103
v_smfmac_f32_16x16x64_bf16 v[52:55], a[12:15], a[216:223], v105
v_cvt_pk_bf16_f32 v110, v98, v99
v_min_u32 v110, -2, v110
v_pk_mul_f32 v[102:103], v[106:107], v[48:49]
v_pk_fma_f32 v[102:103], v[108:109], v[50:51], v[102:103]
v_add_f32 v100, v102, v103
v_permlane32_swap_b32 v110, v112
s_nop 1
v_pk_mul_f32 v[102:103], v[106:107], v[52:53]
v_pk_fma_f32 v[102:103], v[108:109], v[54:55], v[102:103]
v_add_f32 v101, v102, v103
v_cvt_pk_bf16_f32 v111, v100, v101
v_min_u32 v111, -2, v111
s_nop 1
v_permlane32_swap_b32 v111, v113
s_mov_b64 exec, 0xffffffff
buffer_store_dwordx4 v[110:113], v92, s[64:67], 0 offen sc1
s_mov_b64 exec, -1
s_endpgm
L_exit:
s_endpgm
B_role:
s_load_dwordx8 s[32:39], s[0:1], 64
s_load_dwordx4 s[40:43], s[0:1], 96
s_mov_b32 s8, s5
s_lshl_b32 s9, s4, 1
s_add_u32 s9, s9, s8
v_and_b32 v1, 63, v0
v_lshlrev_b32 v2, 4, v1
v_lshrrev_b32 v9, 4, v1
v_and_b32 v8, 15, v1
v_mul_u32_u24 v3, 294912, v9
v_lshl_add_u32 v3, v8, 4, v3
v_mul_u32_u24 v4, 72, v9
v_lshrrev_b32 v6, 3, v8
v_mul_u32_u24 v6, 1152, v6
v_add_u32 v4, v4, v6
v_lshlrev_b32 v238, 17, v9
v_lshl_add_u32 v238, v8, 4, v238
s_waitcnt lgkmcnt(0)
s_mul_i32 s6, s3, 288
s_sub_u32 s7, 4608, s6
s_add_u32 s44, s26, s6
s_addc_u32 s45, s27, 0
s_mov_b32 s46, s7
s_mov_b32 s47, 0x20000
s_mul_i32 s6, s3, 1179648
s_lshl_b32 s7, s4, 8
s_add_u32 s6, s6, s7
s_sub_u32 s7, 4718592, s6
s_add_u32 s48, s30, s6
s_addc_u32 s49, s31, 0
s_mov_b32 s50, s7
s_mov_b32 s51, 0x20000
buffer_load_dwordx4 v[24:27], v4, s[44:47], 0 offen offset:0
buffer_load_dwordx4 v[28:31], v4, s[44:47], 0 offen offset:16
buffer_load_dwordx4 v[32:35], v4, s[44:47], 0 offen offset:32
buffer_load_dwordx4 v[36:39], v4, s[44:47], 0 offen offset:48
buffer_load_dwordx2 v[40:41], v4, s[44:47], 0 offen offset:64
buffer_load_dwordx4 v[44:47], v4, s[44:47], 0 offen offset:2304
buffer_load_dwordx4 v[48:51], v4, s[44:47], 0 offen offset:2320
buffer_load_dwordx4 v[52:55], v4, s[44:47], 0 offen offset:2336
buffer_load_dwordx4 v[56:59], v4, s[44:47], 0 offen offset:2352
buffer_load_dwordx2 v[60:61], v4, s[44:47], 0 offen offset:2368
s_mov_b32 s6, 0
buffer_load_dwordx4 a[96:99], v3, s[48:51], s6 offen nt
s_mov_b32 s6, 8192
buffer_load_dwordx4 a[100:103], v3, s[48:51], s6 offen nt
s_mov_b32 s6, 16384
buffer_load_dwordx4 a[104:107], v3, s[48:51], s6 offen nt
s_mov_b32 s6, 24576
buffer_load_dwordx4 a[108:111], v3, s[48:51], s6 offen nt
s_mov_b32 s6, 32768
buffer_load_dwordx4 a[112:115], v3, s[48:51], s6 offen nt
s_mov_b32 s6, 40960
buffer_load_dwordx4 a[116:119], v3, s[48:51], s6 offen nt
s_mov_b32 s6, 49152
buffer_load_dwordx4 a[120:123], v3, s[48:51], s6 offen nt
s_mov_b32 s6, 57344
buffer_load_dwordx4 a[124:127], v3, s[48:51], s6 offen nt
s_mov_b32 s6, 65536
buffer_load_dwordx4 a[128:131], v3, s[48:51], s6 offen nt
s_mov_b32 s6, 73728
buffer_load_dwordx4 a[132:135], v3, s[48:51], s6 offen nt
s_mov_b32 s6, 81920
buffer_load_dwordx4 a[136:139], v3, s[48:51], s6 offen nt
s_mov_b32 s6, 90112
buffer_load_dwordx4 a[140:143], v3, s[48:51], s6 offen nt
s_mov_b32 s6, 98304
buffer_load_dwordx4 a[144:147], v3, s[48:51], s6 offen nt
s_mov_b32 s6, 106496
buffer_load_dwordx4 a[148:151], v3, s[48:51], s6 offen nt
s_mov_b32 s6, 114688
buffer_load_dwordx4 a[152:155], v3, s[48:51], s6 offen nt
s_mov_b32 s6, 122880
buffer_load_dwordx4 a[156:159], v3, s[48:51], s6 offen nt
s_mov_b32 s6, 131072
buffer_load_dwordx4 a[160:163], v3, s[48:51], s6 offen nt
s_mov_b32 s6, 139264
buffer_load_dwordx4 a[164:167], v3, s[48:51], s6 offen nt
s_mov_b32 s6, 147456
buffer_load_dwordx4 a[168:171], v3, s[48:51], s6 offen nt
s_mov_b32 s6, 155648
buffer_load_dwordx4 a[172:175], v3, s[48:51], s6 offen nt
s_mov_b32 s6, 163840
buffer_load_dwordx4 a[176:179], v3, s[48:51], s6 offen nt
s_mov_b32 s6, 172032
buffer_load_dwordx4 a[180:183], v3, s[48:51], s6 offen nt
s_mov_b32 s6, 180224
buffer_load_dwordx4 a[184:187], v3, s[48:51], s6 offen nt
s_mov_b32 s6, 188416
buffer_load_dwordx4 a[188:191], v3, s[48:51], s6 offen nt
s_mov_b32 s6, 196608
buffer_load_dwordx4 a[192:195], v3, s[48:51], s6 offen nt
s_mov_b32 s6, 204800
buffer_load_dwordx4 a[196:199], v3, s[48:51], s6 offen nt
s_mov_b32 s6, 212992
buffer_load_dwordx4 a[200:203], v3, s[48:51], s6 offen nt
s_mov_b32 s6, 221184
buffer_load_dwordx4 a[204:207], v3, s[48:51], s6 offen nt
s_mov_b32 s6, 229376
buffer_load_dwordx4 a[208:211], v3, s[48:51], s6 offen nt
s_mov_b32 s6, 237568
buffer_load_dwordx4 a[212:215], v3, s[48:51], s6 offen nt
s_mov_b32 s6, 245760
buffer_load_dwordx4 a[216:219], v3, s[48:51], s6 offen nt
s_mov_b32 s6, 253952
buffer_load_dwordx4 a[220:223], v3, s[48:51], s6 offen nt
s_mov_b32 s6, 262144
buffer_load_dwordx4 a[224:227], v3, s[48:51], s6 offen nt
s_mov_b32 s6, 270336
buffer_load_dwordx4 a[228:231], v3, s[48:51], s6 offen nt
s_mov_b32 s6, 278528
buffer_load_dwordx4 a[232:235], v3, s[48:51], s6 offen nt
s_mov_b32 s6, 286720
buffer_load_dwordx4 a[236:239], v3, s[48:51], s6 offen nt
s_lshl_b32 s6, s3, 20
s_lshl_b32 s7, s4, 8
s_add_u32 s6, s6, s7
s_sub_u32 s7, 4194304, s6
s_add_u32 s76, s32, s6
s_addc_u32 s77, s33, 0
s_mov_b32 s78, s7
s_mov_b32 s79, 0x20000
s_add_u32 s52, s34, s6
s_addc_u32 s53, s35, 0
s_mov_b32 s54, s7
s_mov_b32 s55, 0x20000
s_mov_b32 s6, 0
buffer_load_dwordx4 v[88:91], v238, s[76:79], s6 offen nt
s_mov_b32 s6, 8192
buffer_load_dwordx4 v[92:95], v238, s[76:79], s6 offen nt
s_mov_b32 s6, 16384
buffer_load_dwordx4 v[96:99], v238, s[76:79], s6 offen nt
s_mov_b32 s6, 24576
buffer_load_dwordx4 v[100:103], v238, s[76:79], s6 offen nt
s_mov_b32 s6, 32768
buffer_load_dwordx4 v[104:107], v238, s[76:79], s6 offen nt
s_mov_b32 s6, 40960
buffer_load_dwordx4 v[108:111], v238, s[76:79], s6 offen nt
s_mov_b32 s6, 49152
buffer_load_dwordx4 v[112:115], v238, s[76:79], s6 offen nt
s_mov_b32 s6, 57344
buffer_load_dwordx4 v[116:119], v238, s[76:79], s6 offen nt
s_mov_b32 s6, 65536
buffer_load_dwordx4 v[120:123], v238, s[76:79], s6 offen nt
s_mov_b32 s6, 73728
buffer_load_dwordx4 v[124:127], v238, s[76:79], s6 offen nt
s_mov_b32 s6, 81920
buffer_load_dwordx4 v[128:131], v238, s[76:79], s6 offen nt
s_mov_b32 s6, 90112
buffer_load_dwordx4 v[132:135], v238, s[76:79], s6 offen nt
s_mov_b32 s64, s42
s_mov_b32 s65, s43
s_mov_b32 s66, 16777216
s_mov_b32 s67, 0x20000
s_mov_b32 s68, s40
s_mov_b32 s69, s41
s_mov_b32 s70, 256
s_mov_b32 s71, 0x20000
s_mov_b32 s72, s38
s_mov_b32 s73, s39
s_mov_b32 s74, 9216
s_mov_b32 s75, 0x20000
s_mul_i32 s6, s4, 147456
s_add_u32 s60, s36, s6
s_addc_u32 s61, s37, 0
s_mov_b32 s62, 147456
s_mov_b32 s63, 0x20000
v_and_b32 v5, 1, v1
v_lshlrev_b32 v5, 4, v5
v_mov_b32 v6, 0xffff
v_lshlrev_b32 v5, v5, v6
v_bfe_u32 v6, v1, 1, 2
v_cmp_eq_u32 vcc, 0, v6
s_nop 1
v_cndmask_b32 v12, 0, v5, vcc
v_cmp_eq_u32 vcc, 1, v6
s_nop 1
v_cndmask_b32 v13, 0, v5, vcc
v_cmp_eq_u32 vcc, 2, v6
s_nop 1
v_cndmask_b32 v14, 0, v5, vcc
v_cmp_eq_u32 vcc, 3, v6
s_nop 1
v_cndmask_b32 v15, 0, v5, vcc
v_mov_b32 v5, 0x0c0c0c0c
s_mov_b32 s6, 0x01000100
s_mov_b32 s7, 0x03020302
v_bfi_b32 v16, v12, s6, v5
v_bfi_b32 v17, v13, s6, v5
v_bfi_b32 v18, v14, s6, v5
v_bfi_b32 v19, v15, s6, v5
v_bfi_b32 v20, v12, s7, v5
v_bfi_b32 v21, v13, s7, v5
v_bfi_b32 v22, v14, s7, v5
v_bfi_b32 v23, v15, s7, v5
v_lshrrev_b32 v5, 4, v1
v_lshlrev_b32 v5, 3, v5
v_bfe_u32 v6, v1, 2, 2
v_add_u32 v5, v5, v6
v_mul_u32_u24 v5, 1152, v5
s_mul_i32 s6, s3, 288
v_add_u32 v5, s6, v5
v_and_b32 v6, 3, v1
v_lshl_add_u32 v240, v6, 5, v5
v_lshl_add_u32 v241, v6, 3, v5
v_add_u32 v241, 256, v241
v_add_u32 v242, 73728, v240
v_add_u32 v243, 73728, v241
s_mul_i32 s12, s3, 36864
s_waitcnt vmcnt(47)
v_perm_b32 v64, v24, v24, v16
v_perm_b32 v65, v24, v24, v17
v_perm_b32 v66, v24, v24, v18
v_perm_b32 v67, v24, v24, v19
s_nop 1
v_mfma_f32_16x16x32_bf16 v[80:83], v[64:67], a[96:99], 0
v_perm_b32 v68, v44, v44, v16
v_perm_b32 v69, v44, v44, v17
v_perm_b32 v70, v44, v44, v18
v_perm_b32 v71, v44, v44, v19
s_nop 1
v_mfma_f32_16x16x32_bf16 v[84:87], v[68:71], a[96:99], 0
s_mov_b32 s6, 98304
buffer_load_dwordx4 v[136:139], v238, s[76:79], s6 offen nt
s_waitcnt vmcnt(47)
v_perm_b32 v72, v24, v24, v20
v_perm_b32 v73, v24, v24, v21
v_perm_b32 v74, v24, v24, v22
v_perm_b32 v75, v24, v24, v23
s_nop 1
v_mfma_f32_16x16x32_bf16 v[80:83], v[72:75], a[100:103], v[80:83]
v_perm_b32 v76, v44, v44, v20
v_perm_b32 v77, v44, v44, v21
v_perm_b32 v78, v44, v44, v22
v_perm_b32 v79, v44, v44, v23
s_nop 1
v_mfma_f32_16x16x32_bf16 v[84:87], v[76:79], a[100:103], v[84:87]
s_mov_b32 s6, 106496
buffer_load_dwordx4 v[140:143], v238, s[76:79], s6 offen nt
s_waitcnt vmcnt(47)
v_perm_b32 v64, v25, v25, v16
v_perm_b32 v65, v25, v25, v17
v_perm_b32 v66, v25, v25, v18
v_perm_b32 v67, v25, v25, v19
s_nop 1
v_mfma_f32_16x16x32_bf16 v[80:83], v[64:67], a[104:107], v[80:83]
v_perm_b32 v68, v45, v45, v16
v_perm_b32 v69, v45, v45, v17
v_perm_b32 v70, v45, v45, v18
v_perm_b32 v71, v45, v45, v19
s_nop 1
v_mfma_f32_16x16x32_bf16 v[84:87], v[68:71], a[104:107], v[84:87]
s_mov_b32 s6, 114688
buffer_load_dwordx4 v[144:147], v238, s[76:79], s6 offen nt
s_waitcnt vmcnt(47)
v_perm_b32 v72, v25, v25, v20
v_perm_b32 v73, v25, v25, v21
v_perm_b32 v74, v25, v25, v22
v_perm_b32 v75, v25, v25, v23
s_nop 1
v_mfma_f32_16x16x32_bf16 v[80:83], v[72:75], a[108:111], v[80:83]
v_perm_b32 v76, v45, v45, v20
v_perm_b32 v77, v45, v45, v21
v_perm_b32 v78, v45, v45, v22
v_perm_b32 v79, v45, v45, v23
s_nop 1
v_mfma_f32_16x16x32_bf16 v[84:87], v[76:79], a[108:111], v[84:87]
s_mov_b32 s6, 122880
buffer_load_dwordx4 v[148:151], v238, s[76:79], s6 offen nt
s_waitcnt vmcnt(47)
v_perm_b32 v64, v26, v26, v16
v_perm_b32 v65, v26, v26, v17
v_perm_b32 v66, v26, v26, v18
v_perm_b32 v67, v26, v26, v19
s_nop 1
v_mfma_f32_16x16x32_bf16 v[80:83], v[64:67], a[112:115], v[80:83]
v_perm_b32 v68, v46, v46, v16
v_perm_b32 v69, v46, v46, v17
v_perm_b32 v70, v46, v46, v18
v_perm_b32 v71, v46, v46, v19
s_nop 1
v_mfma_f32_16x16x32_bf16 v[84:87], v[68:71], a[112:115], v[84:87]
s_mov_b32 s6, 524288
buffer_load_dwordx4 v[152:155], v238, s[76:79], s6 offen nt
s_waitcnt vmcnt(47)
v_perm_b32 v72, v26, v26, v20
v_perm_b32 v73, v26, v26, v21
v_perm_b32 v74, v26, v26, v22
v_perm_b32 v75, v26, v26, v23
s_nop 1
v_mfma_f32_16x16x32_bf16 v[80:83], v[72:75], a[116:119], v[80:83]
v_perm_b32 v76, v46, v46, v20
v_perm_b32 v77, v46, v46, v21
v_perm_b32 v78, v46, v46, v22
v_perm_b32 v79, v46, v46, v23
s_nop 1
v_mfma_f32_16x16x32_bf16 v[84:87], v[76:79], a[116:119], v[84:87]
s_mov_b32 s6, 532480
buffer_load_dwordx4 v[156:159], v238, s[76:79], s6 offen nt
s_waitcnt vmcnt(47)
v_perm_b32 v64, v27, v27, v16
v_perm_b32 v65, v27, v27, v17
v_perm_b32 v66, v27, v27, v18
v_perm_b32 v67, v27, v27, v19
s_nop 1
v_mfma_f32_16x16x32_bf16 v[80:83], v[64:67], a[120:123], v[80:83]
v_perm_b32 v68, v47, v47, v16
v_perm_b32 v69, v47, v47, v17
v_perm_b32 v70, v47, v47, v18
v_perm_b32 v71, v47, v47, v19
s_nop 1
v_mfma_f32_16x16x32_bf16 v[84:87], v[68:71], a[120:123], v[84:87]
s_mov_b32 s6, 540672
buffer_load_dwordx4 v[160:163], v238, s[76:79], s6 offen nt
s_waitcnt vmcnt(47)
v_perm_b32 v72, v27, v27, v20
v_perm_b32 v73, v27, v27, v21
v_perm_b32 v74, v27, v27, v22
v_perm_b32 v75, v27, v27, v23
s_nop 1
v_mfma_f32_16x16x32_bf16 v[80:83], v[72:75], a[124:127], v[80:83]
v_perm_b32 v76, v47, v47, v20
v_perm_b32 v77, v47, v47, v21
v_perm_b32 v78, v47, v47, v22
v_perm_b32 v79, v47, v47, v23
s_nop 1
v_mfma_f32_16x16x32_bf16 v[84:87], v[76:79], a[124:127], v[84:87]
s_mov_b32 s6, 548864
buffer_load_dwordx4 v[164:167], v238, s[76:79], s6 offen nt
s_waitcnt vmcnt(47)
v_perm_b32 v64, v28, v28, v16
v_perm_b32 v65, v28, v28, v17
v_perm_b32 v66, v28, v28, v18
v_perm_b32 v67, v28, v28, v19
s_nop 1
v_mfma_f32_16x16x32_bf16 v[80:83], v[64:67], a[128:131], v[80:83]
v_perm_b32 v68, v48, v48, v16
v_perm_b32 v69, v48, v48, v17
v_perm_b32 v70, v48, v48, v18
v_perm_b32 v71, v48, v48, v19
s_nop 1
v_mfma_f32_16x16x32_bf16 v[84:87], v[68:71], a[128:131], v[84:87]
s_mov_b32 s6, 557056
buffer_load_dwordx4 v[168:171], v238, s[76:79], s6 offen nt
s_waitcnt vmcnt(47)
v_perm_b32 v72, v28, v28, v20
v_perm_b32 v73, v28, v28, v21
v_perm_b32 v74, v28, v28, v22
v_perm_b32 v75, v28, v28, v23
s_nop 1
v_mfma_f32_16x16x32_bf16 v[80:83], v[72:75], a[132:135], v[80:83]
v_perm_b32 v76, v48, v48, v20
v_perm_b32 v77, v48, v48, v21
v_perm_b32 v78, v48, v48, v22
v_perm_b32 v79, v48, v48, v23
s_nop 1
v_mfma_f32_16x16x32_bf16 v[84:87], v[76:79], a[132:135], v[84:87]
s_mov_b32 s6, 565248
buffer_load_dwordx4 v[172:175], v238, s[76:79], s6 offen nt
s_waitcnt vmcnt(47)
v_perm_b32 v64, v29, v29, v16
v_perm_b32 v65, v29, v29, v17
v_perm_b32 v66, v29, v29, v18
v_perm_b32 v67, v29, v29, v19
s_nop 1
v_mfma_f32_16x16x32_bf16 v[80:83], v[64:67], a[136:139], v[80:83]
v_perm_b32 v68, v49, v49, v16
v_perm_b32 v69, v49, v49, v17
v_perm_b32 v70, v49, v49, v18
v_perm_b32 v71, v49, v49, v19
s_nop 1
v_mfma_f32_16x16x32_bf16 v[84:87], v[68:71], a[136:139], v[84:87]
s_mov_b32 s6, 573440
buffer_load_dwordx4 v[176:179], v238, s[76:79], s6 offen nt
s_waitcnt vmcnt(47)
v_perm_b32 v72, v29, v29, v20
v_perm_b32 v73, v29, v29, v21
v_perm_b32 v74, v29, v29, v22
v_perm_b32 v75, v29, v29, v23
s_nop 1
v_mfma_f32_16x16x32_bf16 v[80:83], v[72:75], a[140:143], v[80:83]
v_perm_b32 v76, v49, v49, v20
v_perm_b32 v77, v49, v49, v21
v_perm_b32 v78, v49, v49, v22
v_perm_b32 v79, v49, v49, v23
s_nop 1
v_mfma_f32_16x16x32_bf16 v[84:87], v[76:79], a[140:143], v[84:87]
s_mov_b32 s6, 581632
buffer_load_dwordx4 v[180:183], v238, s[76:79], s6 offen nt
s_waitcnt vmcnt(47)
v_perm_b32 v64, v30, v30, v16
v_perm_b32 v65, v30, v30, v17
v_perm_b32 v66, v30, v30, v18
v_perm_b32 v67, v30, v30, v19
s_nop 1
v_mfma_f32_16x16x32_bf16 v[80:83], v[64:67], a[144:147], v[80:83]
v_perm_b32 v68, v50, v50, v16
v_perm_b32 v69, v50, v50, v17
v_perm_b32 v70, v50, v50, v18
v_perm_b32 v71, v50, v50, v19
s_nop 1
v_mfma_f32_16x16x32_bf16 v[84:87], v[68:71], a[144:147], v[84:87]
s_mov_b32 s6, 589824
buffer_load_dwordx4 v[184:187], v238, s[76:79], s6 offen nt
s_waitcnt vmcnt(47)
v_perm_b32 v72, v30, v30, v20
v_perm_b32 v73, v30, v30, v21
v_perm_b32 v74, v30, v30, v22
v_perm_b32 v75, v30, v30, v23
s_nop 1
v_mfma_f32_16x16x32_bf16 v[80:83], v[72:75], a[148:151], v[80:83]
v_perm_b32 v76, v50, v50, v20
v_perm_b32 v77, v50, v50, v21
v_perm_b32 v78, v50, v50, v22
v_perm_b32 v79, v50, v50, v23
s_nop 1
v_mfma_f32_16x16x32_bf16 v[84:87], v[76:79], a[148:151], v[84:87]
s_mov_b32 s6, 598016
buffer_load_dwordx4 v[188:191], v238, s[76:79], s6 offen nt
s_waitcnt vmcnt(47)
v_perm_b32 v64, v31, v31, v16
v_perm_b32 v65, v31, v31, v17
v_perm_b32 v66, v31, v31, v18
v_perm_b32 v67, v31, v31, v19
s_nop 1
v_mfma_f32_16x16x32_bf16 v[80:83], v[64:67], a[152:155], v[80:83]
v_perm_b32 v68, v51, v51, v16
v_perm_b32 v69, v51, v51, v17
v_perm_b32 v70, v51, v51, v18
v_perm_b32 v71, v51, v51, v19
s_nop 1
v_mfma_f32_16x16x32_bf16 v[84:87], v[68:71], a[152:155], v[84:87]
s_mov_b32 s6, 606208
buffer_load_dwordx4 v[192:195], v238, s[76:79], s6 offen nt
s_waitcnt vmcnt(47)
v_perm_b32 v72, v31, v31, v20
v_perm_b32 v73, v31, v31, v21
v_perm_b32 v74, v31, v31, v22
v_perm_b32 v75, v31, v31, v23
s_nop 1
v_mfma_f32_16x16x32_bf16 v[80:83], v[72:75], a[156:159], v[80:83]
v_perm_b32 v76, v51, v51, v20
v_perm_b32 v77, v51, v51, v21
v_perm_b32 v78, v51, v51, v22
v_perm_b32 v79, v51, v51, v23
s_nop 1
v_mfma_f32_16x16x32_bf16 v[84:87], v[76:79], a[156:159], v[84:87]
s_mov_b32 s6, 614400
buffer_load_dwordx4 v[196:199], v238, s[76:79], s6 offen nt
s_waitcnt vmcnt(47)
v_perm_b32 v64, v32, v32, v16
v_perm_b32 v65, v32, v32, v17
v_perm_b32 v66, v32, v32, v18
v_perm_b32 v67, v32, v32, v19
s_nop 1
v_mfma_f32_16x16x32_bf16 v[80:83], v[64:67], a[160:163], v[80:83]
v_perm_b32 v68, v52, v52, v16
v_perm_b32 v69, v52, v52, v17
v_perm_b32 v70, v52, v52, v18
v_perm_b32 v71, v52, v52, v19
s_nop 1
v_mfma_f32_16x16x32_bf16 v[84:87], v[68:71], a[160:163], v[84:87]
s_mov_b32 s6, 622592
buffer_load_dwordx4 v[200:203], v238, s[76:79], s6 offen nt
s_waitcnt vmcnt(47)
v_perm_b32 v72, v32, v32, v20
v_perm_b32 v73, v32, v32, v21
v_perm_b32 v74, v32, v32, v22
v_perm_b32 v75, v32, v32, v23
s_nop 1
v_mfma_f32_16x16x32_bf16 v[80:83], v[72:75], a[164:167], v[80:83]
v_perm_b32 v76, v52, v52, v20
v_perm_b32 v77, v52, v52, v21
v_perm_b32 v78, v52, v52, v22
v_perm_b32 v79, v52, v52, v23
s_nop 1
v_mfma_f32_16x16x32_bf16 v[84:87], v[76:79], a[164:167], v[84:87]
s_mov_b32 s6, 630784
buffer_load_dwordx4 v[204:207], v238, s[76:79], s6 offen nt
s_waitcnt vmcnt(47)
v_perm_b32 v64, v33, v33, v16
v_perm_b32 v65, v33, v33, v17
v_perm_b32 v66, v33, v33, v18
v_perm_b32 v67, v33, v33, v19
s_nop 1
v_mfma_f32_16x16x32_bf16 v[80:83], v[64:67], a[168:171], v[80:83]
v_perm_b32 v68, v53, v53, v16
v_perm_b32 v69, v53, v53, v17
v_perm_b32 v70, v53, v53, v18
v_perm_b32 v71, v53, v53, v19
s_nop 1
v_mfma_f32_16x16x32_bf16 v[84:87], v[68:71], a[168:171], v[84:87]
s_mov_b32 s6, 638976
buffer_load_dwordx4 v[208:211], v238, s[76:79], s6 offen nt
s_waitcnt vmcnt(47)
v_perm_b32 v72, v33, v33, v20
v_perm_b32 v73, v33, v33, v21
v_perm_b32 v74, v33, v33, v22
v_perm_b32 v75, v33, v33, v23
s_nop 1
v_mfma_f32_16x16x32_bf16 v[80:83], v[72:75], a[172:175], v[80:83]
v_perm_b32 v76, v53, v53, v20
v_perm_b32 v77, v53, v53, v21
v_perm_b32 v78, v53, v53, v22
v_perm_b32 v79, v53, v53, v23
s_nop 1
v_mfma_f32_16x16x32_bf16 v[84:87], v[76:79], a[172:175], v[84:87]
s_mov_b32 s6, 647168
buffer_load_dwordx4 v[212:215], v238, s[76:79], s6 offen nt
s_waitcnt vmcnt(47)
v_perm_b32 v64, v34, v34, v16
v_perm_b32 v65, v34, v34, v17
v_perm_b32 v66, v34, v34, v18
v_perm_b32 v67, v34, v34, v19
s_nop 1
v_mfma_f32_16x16x32_bf16 v[80:83], v[64:67], a[176:179], v[80:83]
v_perm_b32 v68, v54, v54, v16
v_perm_b32 v69, v54, v54, v17
v_perm_b32 v70, v54, v54, v18
v_perm_b32 v71, v54, v54, v19
s_nop 1
v_mfma_f32_16x16x32_bf16 v[84:87], v[68:71], a[176:179], v[84:87]
buffer_load_dword v11, off, s[68:71], 0 offset:0 sc1
s_waitcnt vmcnt(47)
v_perm_b32 v72, v34, v34, v20
v_perm_b32 v73, v34, v34, v21
v_perm_b32 v74, v34, v34, v22
v_perm_b32 v75, v34, v34, v23
s_nop 1
v_mfma_f32_16x16x32_bf16 v[80:83], v[72:75], a[180:183], v[80:83]
v_perm_b32 v76, v54, v54, v20
v_perm_b32 v77, v54, v54, v21
v_perm_b32 v78, v54, v54, v22
v_perm_b32 v79, v54, v54, v23
s_nop 1
v_mfma_f32_16x16x32_bf16 v[84:87], v[76:79], a[180:183], v[84:87]
s_waitcnt vmcnt(46)
v_perm_b32 v64, v35, v35, v16
v_perm_b32 v65, v35, v35, v17
v_perm_b32 v66, v35, v35, v18
v_perm_b32 v67, v35, v35, v19
s_nop 1
v_mfma_f32_16x16x32_bf16 v[80:83], v[64:67], a[184:187], v[80:83]
v_perm_b32 v68, v55, v55, v16
v_perm_b32 v69, v55, v55, v17
v_perm_b32 v70, v55, v55, v18
v_perm_b32 v71, v55, v55, v19
s_nop 1
v_mfma_f32_16x16x32_bf16 v[84:87], v[68:71], a[184:187], v[84:87]
s_waitcnt vmcnt(45)
v_perm_b32 v72, v35, v35, v20
v_perm_b32 v73, v35, v35, v21
v_perm_b32 v74, v35, v35, v22
v_perm_b32 v75, v35, v35, v23
s_nop 1
v_mfma_f32_16x16x32_bf16 v[80:83], v[72:75], a[188:191], v[80:83]
v_perm_b32 v76, v55, v55, v20
v_perm_b32 v77, v55, v55, v21
v_perm_b32 v78, v55, v55, v22
v_perm_b32 v79, v55, v55, v23
s_nop 1
v_mfma_f32_16x16x32_bf16 v[84:87], v[76:79], a[188:191], v[84:87]
s_waitcnt vmcnt(44)
v_perm_b32 v64, v36, v36, v16
v_perm_b32 v65, v36, v36, v17
v_perm_b32 v66, v36, v36, v18
v_perm_b32 v67, v36, v36, v19
s_nop 1
v_mfma_f32_16x16x32_bf16 v[80:83], v[64:67], a[192:195], v[80:83]
v_perm_b32 v68, v56, v56, v16
v_perm_b32 v69, v56, v56, v17
v_perm_b32 v70, v56, v56, v18
v_perm_b32 v71, v56, v56, v19
s_nop 1
v_mfma_f32_16x16x32_bf16 v[84:87], v[68:71], a[192:195], v[84:87]
s_waitcnt vmcnt(43)
v_perm_b32 v72, v36, v36, v20
v_perm_b32 v73, v36, v36, v21
v_perm_b32 v74, v36, v36, v22
v_perm_b32 v75, v36, v36, v23
s_nop 1
v_mfma_f32_16x16x32_bf16 v[80:83], v[72:75], a[196:199], v[80:83]
v_perm_b32 v76, v56, v56, v20
v_perm_b32 v77, v56, v56, v21
v_perm_b32 v78, v56, v56, v22
v_perm_b32 v79, v56, v56, v23
s_nop 1
v_mfma_f32_16x16x32_bf16 v[84:87], v[76:79], a[196:199], v[84:87]
s_waitcnt vmcnt(42)
v_perm_b32 v64, v37, v37, v16
v_perm_b32 v65, v37, v37, v17
v_perm_b32 v66, v37, v37, v18
v_perm_b32 v67, v37, v37, v19
s_nop 1
v_mfma_f32_16x16x32_bf16 v[80:83], v[64:67], a[200:203], v[80:83]
v_perm_b32 v68, v57, v57, v16
v_perm_b32 v69, v57, v57, v17
v_perm_b32 v70, v57, v57, v18
v_perm_b32 v71, v57, v57, v19
s_nop 1
v_mfma_f32_16x16x32_bf16 v[84:87], v[68:71], a[200:203], v[84:87]
s_waitcnt vmcnt(41)
v_perm_b32 v72, v37, v37, v20
v_perm_b32 v73, v37, v37, v21
v_perm_b32 v74, v37, v37, v22
v_perm_b32 v75, v37, v37, v23
s_nop 1
v_mfma_f32_16x16x32_bf16 v[80:83], v[72:75], a[204:207], v[80:83]
v_perm_b32 v76, v57, v57, v20
v_perm_b32 v77, v57, v57, v21
v_perm_b32 v78, v57, v57, v22
v_perm_b32 v79, v57, v57, v23
s_nop 1
v_mfma_f32_16x16x32_bf16 v[84:87], v[76:79], a[204:207], v[84:87]
s_waitcnt vmcnt(40)
v_perm_b32 v64, v38, v38, v16
v_perm_b32 v65, v38, v38, v17
v_perm_b32 v66, v38, v38, v18
v_perm_b32 v67, v38, v38, v19
s_nop 1
v_mfma_f32_16x16x32_bf16 v[80:83], v[64:67], a[208:211], v[80:83]
v_perm_b32 v68, v58, v58, v16
v_perm_b32 v69, v58, v58, v17
v_perm_b32 v70, v58, v58, v18
v_perm_b32 v71, v58, v58, v19
s_nop 1
v_mfma_f32_16x16x32_bf16 v[84:87], v[68:71], a[208:211], v[84:87]
s_waitcnt vmcnt(39)
v_perm_b32 v72, v38, v38, v20
v_perm_b32 v73, v38, v38, v21
v_perm_b32 v74, v38, v38, v22
v_perm_b32 v75, v38, v38, v23
s_nop 1
v_mfma_f32_16x16x32_bf16 v[80:83], v[72:75], a[212:215], v[80:83]
v_perm_b32 v76, v58, v58, v20
v_perm_b32 v77, v58, v58, v21
v_perm_b32 v78, v58, v58, v22
v_perm_b32 v79, v58, v58, v23
s_nop 1
v_mfma_f32_16x16x32_bf16 v[84:87], v[76:79], a[212:215], v[84:87]
s_waitcnt vmcnt(38)
v_perm_b32 v64, v39, v39, v16
v_perm_b32 v65, v39, v39, v17
v_perm_b32 v66, v39, v39, v18
v_perm_b32 v67, v39, v39, v19
s_nop 1
v_mfma_f32_16x16x32_bf16 v[80:83], v[64:67], a[216:219], v[80:83]
v_perm_b32 v68, v59, v59, v16
v_perm_b32 v69, v59, v59, v17
v_perm_b32 v70, v59, v59, v18
v_perm_b32 v71, v59, v59, v19
s_nop 1
v_mfma_f32_16x16x32_bf16 v[84:87], v[68:71], a[216:219], v[84:87]
s_waitcnt vmcnt(37)
v_perm_b32 v72, v39, v39, v20
v_perm_b32 v73, v39, v39, v21
v_perm_b32 v74, v39, v39, v22
v_perm_b32 v75, v39, v39, v23
s_nop 1
v_mfma_f32_16x16x32_bf16 v[80:83], v[72:75], a[220:223], v[80:83]
v_perm_b32 v76, v59, v59, v20
v_perm_b32 v77, v59, v59, v21
v_perm_b32 v78, v59, v59, v22
v_perm_b32 v79, v59, v59, v23
s_nop 1
v_mfma_f32_16x16x32_bf16 v[84:87], v[76:79], a[220:223], v[84:87]
s_waitcnt vmcnt(36)
v_perm_b32 v64, v40, v40, v16
v_perm_b32 v65, v40, v40, v17
v_perm_b32 v66, v40, v40, v18
v_perm_b32 v67, v40, v40, v19
s_nop 1
v_mfma_f32_16x16x32_bf16 v[80:83], v[64:67], a[224:227], v[80:83]
v_perm_b32 v68, v60, v60, v16
v_perm_b32 v69, v60, v60, v17
v_perm_b32 v70, v60, v60, v18
v_perm_b32 v71, v60, v60, v19
s_nop 1
v_mfma_f32_16x16x32_bf16 v[84:87], v[68:71], a[224:227], v[84:87]
s_waitcnt vmcnt(35)
v_perm_b32 v72, v40, v40, v20
v_perm_b32 v73, v40, v40, v21
v_perm_b32 v74, v40, v40, v22
v_perm_b32 v75, v40, v40, v23
s_nop 1
v_mfma_f32_16x16x32_bf16 v[80:83], v[72:75], a[228:231], v[80:83]
v_perm_b32 v76, v60, v60, v20
v_perm_b32 v77, v60, v60, v21
v_perm_b32 v78, v60, v60, v22
v_perm_b32 v79, v60, v60, v23
s_nop 1
v_mfma_f32_16x16x32_bf16 v[84:87], v[76:79], a[228:231], v[84:87]
s_waitcnt vmcnt(34)
v_perm_b32 v64, v41, v41, v16
v_perm_b32 v65, v41, v41, v17
v_perm_b32 v66, v41, v41, v18
v_perm_b32 v67, v41, v41, v19
s_nop 1
v_mfma_f32_16x16x32_bf16 v[80:83], v[64:67], a[232:235], v[80:83]
v_perm_b32 v68, v61, v61, v16
v_perm_b32 v69, v61, v61, v17
v_perm_b32 v70, v61, v61, v18
v_perm_b32 v71, v61, v61, v19
s_nop 1
v_mfma_f32_16x16x32_bf16 v[84:87], v[68:71], a[232:235], v[84:87]
s_waitcnt vmcnt(33)
v_perm_b32 v72, v41, v41, v20
v_perm_b32 v73, v41, v41, v21
v_perm_b32 v74, v41, v41, v22
v_perm_b32 v75, v41, v41, v23
s_nop 1
v_mfma_f32_16x16x32_bf16 v[80:83], v[72:75], a[236:239], v[80:83]
v_perm_b32 v76, v61, v61, v20
v_perm_b32 v77, v61, v61, v21
v_perm_b32 v78, v61, v61, v22
v_perm_b32 v79, v61, v61, v23
s_nop 1
v_mfma_f32_16x16x32_bf16 v[84:87], v[76:79], a[236:239], v[84:87]
v_lshlrev_b32 v5, 5, v8
v_and_b32 v6, 1, v9
v_lshl_add_u32 v6, v6, 4, v5
v_lshrrev_b32 v7, 5, v1
v_lshl_add_u32 v6, v7, 9, v6
s_lshl_b32 s6, s3, 11
s_add_u32 s6, s6, 147456
v_add_u32 v6, s6, v6
ds_write_b128 v6, v[80:83]
ds_write_b128 v6, v[84:87] offset:1024
v_add_u32 v5, 147456, v5
s_waitcnt lgkmcnt(0)
s_barrier
ds_read_b128 v[24:27], v5 offset:0
ds_read_b128 v[28:31], v5 offset:16
ds_read_b128 v[32:35], v5 offset:2048
ds_read_b128 v[36:39], v5 offset:2064
ds_read_b128 v[40:43], v5 offset:4096
ds_read_b128 v[44:47], v5 offset:4112
ds_read_b128 v[48:51], v5 offset:6144
ds_read_b128 v[52:55], v5 offset:6160
s_waitcnt lgkmcnt(0)
v_add_f32 v24, v24, v32
v_add_f32 v40, v40, v48
v_add_f32 v25, v25, v33
v_add_f32 v41, v41, v49
v_add_f32 v26, v26, v34
v_add_f32 v42, v42, v50
v_add_f32 v27, v27, v35
v_add_f32 v43, v43, v51
v_add_f32 v28, v28, v36
v_add_f32 v44, v44, v52
v_add_f32 v29, v29, v37
v_add_f32 v45, v45, v53
v_add_f32 v30, v30, v38
v_add_f32 v46, v46, v54
v_add_f32 v31, v31, v39
v_add_f32 v47, v47, v55
v_add_f32 v24, v24, v40
v_add_f32 v25, v25, v41
v_add_f32 v26, v26, v42
v_add_f32 v27, v27, v43
v_add_f32 v28, v28, v44
v_add_f32 v29, v29, v45
v_add_f32 v30, v30, v46
v_add_f32 v31, v31, v47
v_cvt_pk_bf16_f32 v216, v24, v25
v_cvt_pk_bf16_f32 v217, v26, v27
v_cvt_pk_bf16_f32 v218, v28, v29
v_cvt_pk_bf16_f32 v219, v30, v31
ds_read_b128 v[24:27], v5 offset:512
ds_read_b128 v[28:31], v5 offset:528
ds_read_b128 v[32:35], v5 offset:2560
ds_read_b128 v[36:39], v5 offset:2576
ds_read_b128 v[40:43], v5 offset:4608
ds_read_b128 v[44:47], v5 offset:4624
ds_read_b128 v[48:51], v5 offset:6656
ds_read_b128 v[52:55], v5 offset:6672
s_waitcnt lgkmcnt(0)
v_add_f32 v24, v24, v32
v_add_f32 v40, v40, v48
v_add_f32 v25, v25, v33
v_add_f32 v41, v41, v49
v_add_f32 v26, v26, v34
v_add_f32 v42, v42, v50
v_add_f32 v27, v27, v35
v_add_f32 v43, v43, v51
v_add_f32 v28, v28, v36
v_add_f32 v44, v44, v52
v_add_f32 v29, v29, v37
v_add_f32 v45, v45, v53
v_add_f32 v30, v30, v38
v_add_f32 v46, v46, v54
v_add_f32 v31, v31, v39
v_add_f32 v47, v47, v55
v_add_f32 v24, v24, v40
v_add_f32 v25, v25, v41
v_add_f32 v26, v26, v42
v_add_f32 v27, v27, v43
v_add_f32 v28, v28, v44
v_add_f32 v29, v29, v45
v_add_f32 v30, v30, v46
v_add_f32 v31, v31, v47
v_cvt_pk_bf16_f32 v220, v24, v25
v_cvt_pk_bf16_f32 v221, v26, v27
v_cvt_pk_bf16_f32 v222, v28, v29
v_cvt_pk_bf16_f32 v223, v30, v31
ds_read_b128 v[24:27], v5 offset:1024
ds_read_b128 v[28:31], v5 offset:1040
ds_read_b128 v[32:35], v5 offset:3072
ds_read_b128 v[36:39], v5 offset:3088
ds_read_b128 v[40:43], v5 offset:5120
ds_read_b128 v[44:47], v5 offset:5136
ds_read_b128 v[48:51], v5 offset:7168
ds_read_b128 v[52:55], v5 offset:7184
s_waitcnt lgkmcnt(0)
v_add_f32 v24, v24, v32
v_add_f32 v40, v40, v48
v_add_f32 v25, v25, v33
v_add_f32 v41, v41, v49
v_add_f32 v26, v26, v34
v_add_f32 v42, v42, v50
v_add_f32 v27, v27, v35
v_add_f32 v43, v43, v51
v_add_f32 v28, v28, v36
v_add_f32 v44, v44, v52
v_add_f32 v29, v29, v37
v_add_f32 v45, v45, v53
v_add_f32 v30, v30, v38
v_add_f32 v46, v46, v54
v_add_f32 v31, v31, v39
v_add_f32 v47, v47, v55
v_add_f32 v24, v24, v40
v_add_f32 v25, v25, v41
v_add_f32 v26, v26, v42
v_add_f32 v27, v27, v43
v_add_f32 v28, v28, v44
v_add_f32 v29, v29, v45
v_add_f32 v30, v30, v46
v_add_f32 v31, v31, v47
v_cvt_pk_bf16_f32 v224, v24, v25
v_cvt_pk_bf16_f32 v225, v26, v27
v_cvt_pk_bf16_f32 v226, v28, v29
v_cvt_pk_bf16_f32 v227, v30, v31
ds_read_b128 v[24:27], v5 offset:1536
ds_read_b128 v[28:31], v5 offset:1552
ds_read_b128 v[32:35], v5 offset:3584
ds_read_b128 v[36:39], v5 offset:3600
ds_read_b128 v[40:43], v5 offset:5632
ds_read_b128 v[44:47], v5 offset:5648
ds_read_b128 v[48:51], v5 offset:7680
ds_read_b128 v[52:55], v5 offset:7696
s_waitcnt lgkmcnt(0)
v_add_f32 v24, v24, v32
v_add_f32 v40, v40, v48
v_add_f32 v25, v25, v33
v_add_f32 v41, v41, v49
v_add_f32 v26, v26, v34
v_add_f32 v42, v42, v50
v_add_f32 v27, v27, v35
v_add_f32 v43, v43, v51
v_add_f32 v28, v28, v36
v_add_f32 v44, v44, v52
v_add_f32 v29, v29, v37
v_add_f32 v45, v45, v53
v_add_f32 v30, v30, v38
v_add_f32 v46, v46, v54
v_add_f32 v31, v31, v39
v_add_f32 v47, v47, v55
v_add_f32 v24, v24, v40
v_add_f32 v25, v25, v41
v_add_f32 v26, v26, v42
v_add_f32 v27, v27, v43
v_add_f32 v28, v28, v44
v_add_f32 v29, v29, v45
v_add_f32 v30, v30, v46
v_add_f32 v31, v31, v47
v_cvt_pk_bf16_f32 v228, v24, v25
v_cvt_pk_bf16_f32 v229, v26, v27
v_cvt_pk_bf16_f32 v230, v28, v29
v_cvt_pk_bf16_f32 v231, v30, v31
v_bfe_u32 v5, v1, 2, 2
v_mul_u32_u24 v5, 32768, v5
v_lshl_add_u32 v5, v9, 5, v5
v_and_b32 v6, 1, v1
v_lshl_add_u32 v5, v6, 4, v5
v_bfe_u32 v7, v1, 1, 1
v_lshl_add_u32 v5, v7, 7, v5
s_waitcnt vmcnt(32)
v_dot2_f32_bf16 v232, v88, v216, 0
v_dot2_f32_bf16 v233, v88, v220, 0
v_dot2_f32_bf16 v234, v88, v224, 0
v_dot2_f32_bf16 v235, v88, v228, 0
v_dot2_f32_bf16 v232, v89, v217, v232
v_dot2_f32_bf16 v233, v89, v221, v233
v_dot2_f32_bf16 v234, v89, v225, v234
v_dot2_f32_bf16 v235, v89, v229, v235
v_dot2_f32_bf16 v232, v90, v218, v232
v_dot2_f32_bf16 v233, v90, v222, v233
v_dot2_f32_bf16 v234, v90, v226, v234
v_dot2_f32_bf16 v235, v90, v230, v235
v_dot2_f32_bf16 v232, v91, v219, v232
v_dot2_f32_bf16 v233, v91, v223, v233
v_dot2_f32_bf16 v234, v91, v227, v234
v_dot2_f32_bf16 v235, v91, v231, v235
v_add_f32_dpp v236, v232, v232 row_ror:8 row_mask:0xf bank_mask:0x3
v_add_f32_dpp v237, v233, v233 row_ror:8 row_mask:0xf bank_mask:0x3
v_add_f32_dpp v236, v234, v234 row_ror:8 row_mask:0xf bank_mask:0xc
v_add_f32_dpp v237, v235, v235 row_ror:8 row_mask:0xf bank_mask:0xc
s_nop 0
v_add_f32_dpp v64, v236, v236 row_half_mirror row_mask:0xf bank_mask:0x5
v_add_f32_dpp v64, v237, v237 row_half_mirror row_mask:0xf bank_mask:0xa
s_nop 1
v_add_f32_dpp v64, v64, v64 quad_perm:[1,0,3,2] row_mask:0xf bank_mask:0xf
s_nop 1
v_add_f32_dpp v64, v64, v64 quad_perm:[2,3,0,1] row_mask:0xf bank_mask:0xf
s_waitcnt vmcnt(31)
v_dot2_f32_bf16 v232, v92, v216, 0
v_dot2_f32_bf16 v233, v92, v220, 0
v_dot2_f32_bf16 v234, v92, v224, 0
v_dot2_f32_bf16 v235, v92, v228, 0
v_dot2_f32_bf16 v232, v93, v217, v232
v_dot2_f32_bf16 v233, v93, v221, v233
v_dot2_f32_bf16 v234, v93, v225, v234
v_dot2_f32_bf16 v235, v93, v229, v235
v_dot2_f32_bf16 v232, v94, v218, v232
v_dot2_f32_bf16 v233, v94, v222, v233
v_dot2_f32_bf16 v234, v94, v226, v234
v_dot2_f32_bf16 v235, v94, v230, v235
v_dot2_f32_bf16 v232, v95, v219, v232
v_dot2_f32_bf16 v233, v95, v223, v233
v_dot2_f32_bf16 v234, v95, v227, v234
v_dot2_f32_bf16 v235, v95, v231, v235
v_add_f32_dpp v236, v232, v232 row_ror:8 row_mask:0xf bank_mask:0x3
v_add_f32_dpp v237, v233, v233 row_ror:8 row_mask:0xf bank_mask:0x3
v_add_f32_dpp v236, v234, v234 row_ror:8 row_mask:0xf bank_mask:0xc
v_add_f32_dpp v237, v235, v235 row_ror:8 row_mask:0xf bank_mask:0xc
s_nop 0
v_add_f32_dpp v65, v236, v236 row_half_mirror row_mask:0xf bank_mask:0x5
v_add_f32_dpp v65, v237, v237 row_half_mirror row_mask:0xf bank_mask:0xa
s_nop 1
v_add_f32_dpp v65, v65, v65 quad_perm:[1,0,3,2] row_mask:0xf bank_mask:0xf
s_nop 1
v_add_f32_dpp v65, v65, v65 quad_perm:[2,3,0,1] row_mask:0xf bank_mask:0xf
s_waitcnt vmcnt(30)
v_dot2_f32_bf16 v232, v96, v216, 0
v_dot2_f32_bf16 v233, v96, v220, 0
v_dot2_f32_bf16 v234, v96, v224, 0
v_dot2_f32_bf16 v235, v96, v228, 0
v_dot2_f32_bf16 v232, v97, v217, v232
v_dot2_f32_bf16 v233, v97, v221, v233
v_dot2_f32_bf16 v234, v97, v225, v234
v_dot2_f32_bf16 v235, v97, v229, v235
v_dot2_f32_bf16 v232, v98, v218, v232
v_dot2_f32_bf16 v233, v98, v222, v233
v_dot2_f32_bf16 v234, v98, v226, v234
v_dot2_f32_bf16 v235, v98, v230, v235
v_dot2_f32_bf16 v232, v99, v219, v232
v_dot2_f32_bf16 v233, v99, v223, v233
v_dot2_f32_bf16 v234, v99, v227, v234
v_dot2_f32_bf16 v235, v99, v231, v235
v_add_f32_dpp v236, v232, v232 row_ror:8 row_mask:0xf bank_mask:0x3
v_add_f32_dpp v237, v233, v233 row_ror:8 row_mask:0xf bank_mask:0x3
v_add_f32_dpp v236, v234, v234 row_ror:8 row_mask:0xf bank_mask:0xc
v_add_f32_dpp v237, v235, v235 row_ror:8 row_mask:0xf bank_mask:0xc
s_nop 0
v_add_f32_dpp v66, v236, v236 row_half_mirror row_mask:0xf bank_mask:0x5
v_add_f32_dpp v66, v237, v237 row_half_mirror row_mask:0xf bank_mask:0xa
s_nop 1
v_add_f32_dpp v66, v66, v66 quad_perm:[1,0,3,2] row_mask:0xf bank_mask:0xf
s_nop 1
v_add_f32_dpp v66, v66, v66 quad_perm:[2,3,0,1] row_mask:0xf bank_mask:0xf
s_waitcnt vmcnt(29)
v_dot2_f32_bf16 v232, v100, v216, 0
v_dot2_f32_bf16 v233, v100, v220, 0
v_dot2_f32_bf16 v234, v100, v224, 0
v_dot2_f32_bf16 v235, v100, v228, 0
v_dot2_f32_bf16 v232, v101, v217, v232
v_dot2_f32_bf16 v233, v101, v221, v233
v_dot2_f32_bf16 v234, v101, v225, v234
v_dot2_f32_bf16 v235, v101, v229, v235
v_dot2_f32_bf16 v232, v102, v218, v232
v_dot2_f32_bf16 v233, v102, v222, v233
v_dot2_f32_bf16 v234, v102, v226, v234
v_dot2_f32_bf16 v235, v102, v230, v235
v_dot2_f32_bf16 v232, v103, v219, v232
v_dot2_f32_bf16 v233, v103, v223, v233
v_dot2_f32_bf16 v234, v103, v227, v234
v_dot2_f32_bf16 v235, v103, v231, v235
v_add_f32_dpp v236, v232, v232 row_ror:8 row_mask:0xf bank_mask:0x3
v_add_f32_dpp v237, v233, v233 row_ror:8 row_mask:0xf bank_mask:0x3
v_add_f32_dpp v236, v234, v234 row_ror:8 row_mask:0xf bank_mask:0xc
v_add_f32_dpp v237, v235, v235 row_ror:8 row_mask:0xf bank_mask:0xc
s_nop 0
v_add_f32_dpp v67, v236, v236 row_half_mirror row_mask:0xf bank_mask:0x5
v_add_f32_dpp v67, v237, v237 row_half_mirror row_mask:0xf bank_mask:0xa
s_nop 1
v_add_f32_dpp v67, v67, v67 quad_perm:[1,0,3,2] row_mask:0xf bank_mask:0xf
s_nop 1
v_add_f32_dpp v67, v67, v67 quad_perm:[2,3,0,1] row_mask:0xf bank_mask:0xf
s_waitcnt vmcnt(28)
v_dot2_f32_bf16 v232, v104, v216, 0
v_dot2_f32_bf16 v233, v104, v220, 0
v_dot2_f32_bf16 v234, v104, v224, 0
v_dot2_f32_bf16 v235, v104, v228, 0
v_dot2_f32_bf16 v232, v105, v217, v232
v_dot2_f32_bf16 v233, v105, v221, v233
v_dot2_f32_bf16 v234, v105, v225, v234
v_dot2_f32_bf16 v235, v105, v229, v235
v_dot2_f32_bf16 v232, v106, v218, v232
v_dot2_f32_bf16 v233, v106, v222, v233
v_dot2_f32_bf16 v234, v106, v226, v234
v_dot2_f32_bf16 v235, v106, v230, v235
v_dot2_f32_bf16 v232, v107, v219, v232
v_dot2_f32_bf16 v233, v107, v223, v233
v_dot2_f32_bf16 v234, v107, v227, v234
v_dot2_f32_bf16 v235, v107, v231, v235
v_add_f32_dpp v236, v232, v232 row_ror:8 row_mask:0xf bank_mask:0x3
v_add_f32_dpp v237, v233, v233 row_ror:8 row_mask:0xf bank_mask:0x3
v_add_f32_dpp v236, v234, v234 row_ror:8 row_mask:0xf bank_mask:0xc
v_add_f32_dpp v237, v235, v235 row_ror:8 row_mask:0xf bank_mask:0xc
s_nop 0
v_add_f32_dpp v68, v236, v236 row_half_mirror row_mask:0xf bank_mask:0x5
v_add_f32_dpp v68, v237, v237 row_half_mirror row_mask:0xf bank_mask:0xa
s_nop 1
v_add_f32_dpp v68, v68, v68 quad_perm:[1,0,3,2] row_mask:0xf bank_mask:0xf
s_nop 1
v_add_f32_dpp v68, v68, v68 quad_perm:[2,3,0,1] row_mask:0xf bank_mask:0xf
s_waitcnt vmcnt(27)
v_dot2_f32_bf16 v232, v108, v216, 0
v_dot2_f32_bf16 v233, v108, v220, 0
v_dot2_f32_bf16 v234, v108, v224, 0
v_dot2_f32_bf16 v235, v108, v228, 0
v_dot2_f32_bf16 v232, v109, v217, v232
v_dot2_f32_bf16 v233, v109, v221, v233
v_dot2_f32_bf16 v234, v109, v225, v234
v_dot2_f32_bf16 v235, v109, v229, v235
v_dot2_f32_bf16 v232, v110, v218, v232
v_dot2_f32_bf16 v233, v110, v222, v233
v_dot2_f32_bf16 v234, v110, v226, v234
v_dot2_f32_bf16 v235, v110, v230, v235
v_dot2_f32_bf16 v232, v111, v219, v232
v_dot2_f32_bf16 v233, v111, v223, v233
v_dot2_f32_bf16 v234, v111, v227, v234
v_dot2_f32_bf16 v235, v111, v231, v235
v_add_f32_dpp v236, v232, v232 row_ror:8 row_mask:0xf bank_mask:0x3
v_add_f32_dpp v237, v233, v233 row_ror:8 row_mask:0xf bank_mask:0x3
v_add_f32_dpp v236, v234, v234 row_ror:8 row_mask:0xf bank_mask:0xc
v_add_f32_dpp v237, v235, v235 row_ror:8 row_mask:0xf bank_mask:0xc
s_nop 0
v_add_f32_dpp v69, v236, v236 row_half_mirror row_mask:0xf bank_mask:0x5
v_add_f32_dpp v69, v237, v237 row_half_mirror row_mask:0xf bank_mask:0xa
s_nop 1
v_add_f32_dpp v69, v69, v69 quad_perm:[1,0,3,2] row_mask:0xf bank_mask:0xf
s_nop 1
v_add_f32_dpp v69, v69, v69 quad_perm:[2,3,0,1] row_mask:0xf bank_mask:0xf
s_waitcnt vmcnt(26)
v_dot2_f32_bf16 v232, v112, v216, 0
v_dot2_f32_bf16 v233, v112, v220, 0
v_dot2_f32_bf16 v234, v112, v224, 0
v_dot2_f32_bf16 v235, v112, v228, 0
v_dot2_f32_bf16 v232, v113, v217, v232
v_dot2_f32_bf16 v233, v113, v221, v233
v_dot2_f32_bf16 v234, v113, v225, v234
v_dot2_f32_bf16 v235, v113, v229, v235
v_dot2_f32_bf16 v232, v114, v218, v232
v_dot2_f32_bf16 v233, v114, v222, v233
v_dot2_f32_bf16 v234, v114, v226, v234
v_dot2_f32_bf16 v235, v114, v230, v235
v_dot2_f32_bf16 v232, v115, v219, v232
v_dot2_f32_bf16 v233, v115, v223, v233
v_dot2_f32_bf16 v234, v115, v227, v234
v_dot2_f32_bf16 v235, v115, v231, v235
v_add_f32_dpp v236, v232, v232 row_ror:8 row_mask:0xf bank_mask:0x3
v_add_f32_dpp v237, v233, v233 row_ror:8 row_mask:0xf bank_mask:0x3
v_add_f32_dpp v236, v234, v234 row_ror:8 row_mask:0xf bank_mask:0xc
v_add_f32_dpp v237, v235, v235 row_ror:8 row_mask:0xf bank_mask:0xc
s_nop 0
v_add_f32_dpp v70, v236, v236 row_half_mirror row_mask:0xf bank_mask:0x5
v_add_f32_dpp v70, v237, v237 row_half_mirror row_mask:0xf bank_mask:0xa
s_nop 1
v_add_f32_dpp v70, v70, v70 quad_perm:[1,0,3,2] row_mask:0xf bank_mask:0xf
s_nop 1
v_add_f32_dpp v70, v70, v70 quad_perm:[2,3,0,1] row_mask:0xf bank_mask:0xf
s_waitcnt vmcnt(25)
v_dot2_f32_bf16 v232, v116, v216, 0
v_dot2_f32_bf16 v233, v116, v220, 0
v_dot2_f32_bf16 v234, v116, v224, 0
v_dot2_f32_bf16 v235, v116, v228, 0
v_dot2_f32_bf16 v232, v117, v217, v232
v_dot2_f32_bf16 v233, v117, v221, v233
v_dot2_f32_bf16 v234, v117, v225, v234
v_dot2_f32_bf16 v235, v117, v229, v235
v_dot2_f32_bf16 v232, v118, v218, v232
v_dot2_f32_bf16 v233, v118, v222, v233
v_dot2_f32_bf16 v234, v118, v226, v234
v_dot2_f32_bf16 v235, v118, v230, v235
v_dot2_f32_bf16 v232, v119, v219, v232
v_dot2_f32_bf16 v233, v119, v223, v233
v_dot2_f32_bf16 v234, v119, v227, v234
v_dot2_f32_bf16 v235, v119, v231, v235
v_add_f32_dpp v236, v232, v232 row_ror:8 row_mask:0xf bank_mask:0x3
v_add_f32_dpp v237, v233, v233 row_ror:8 row_mask:0xf bank_mask:0x3
v_add_f32_dpp v236, v234, v234 row_ror:8 row_mask:0xf bank_mask:0xc
v_add_f32_dpp v237, v235, v235 row_ror:8 row_mask:0xf bank_mask:0xc
s_nop 0
v_add_f32_dpp v71, v236, v236 row_half_mirror row_mask:0xf bank_mask:0x5
v_add_f32_dpp v71, v237, v237 row_half_mirror row_mask:0xf bank_mask:0xa
s_nop 1
v_add_f32_dpp v71, v71, v71 quad_perm:[1,0,3,2] row_mask:0xf bank_mask:0xf
s_nop 1
v_add_f32_dpp v71, v71, v71 quad_perm:[2,3,0,1] row_mask:0xf bank_mask:0xf
s_waitcnt vmcnt(24)
v_dot2_f32_bf16 v232, v120, v216, 0
v_dot2_f32_bf16 v233, v120, v220, 0
v_dot2_f32_bf16 v234, v120, v224, 0
v_dot2_f32_bf16 v235, v120, v228, 0
v_dot2_f32_bf16 v232, v121, v217, v232
v_dot2_f32_bf16 v233, v121, v221, v233
v_dot2_f32_bf16 v234, v121, v225, v234
v_dot2_f32_bf16 v235, v121, v229, v235
v_dot2_f32_bf16 v232, v122, v218, v232
v_dot2_f32_bf16 v233, v122, v222, v233
v_dot2_f32_bf16 v234, v122, v226, v234
v_dot2_f32_bf16 v235, v122, v230, v235
v_dot2_f32_bf16 v232, v123, v219, v232
v_dot2_f32_bf16 v233, v123, v223, v233
v_dot2_f32_bf16 v234, v123, v227, v234
v_dot2_f32_bf16 v235, v123, v231, v235
v_add_f32_dpp v236, v232, v232 row_ror:8 row_mask:0xf bank_mask:0x3
v_add_f32_dpp v237, v233, v233 row_ror:8 row_mask:0xf bank_mask:0x3
v_add_f32_dpp v236, v234, v234 row_ror:8 row_mask:0xf bank_mask:0xc
v_add_f32_dpp v237, v235, v235 row_ror:8 row_mask:0xf bank_mask:0xc
s_nop 0
v_add_f32_dpp v72, v236, v236 row_half_mirror row_mask:0xf bank_mask:0x5
v_add_f32_dpp v72, v237, v237 row_half_mirror row_mask:0xf bank_mask:0xa
s_nop 1
v_add_f32_dpp v72, v72, v72 quad_perm:[1,0,3,2] row_mask:0xf bank_mask:0xf
s_nop 1
v_add_f32_dpp v72, v72, v72 quad_perm:[2,3,0,1] row_mask:0xf bank_mask:0xf
s_waitcnt vmcnt(23)
v_dot2_f32_bf16 v232, v124, v216, 0
v_dot2_f32_bf16 v233, v124, v220, 0
v_dot2_f32_bf16 v234, v124, v224, 0
v_dot2_f32_bf16 v235, v124, v228, 0
v_dot2_f32_bf16 v232, v125, v217, v232
v_dot2_f32_bf16 v233, v125, v221, v233
v_dot2_f32_bf16 v234, v125, v225, v234
v_dot2_f32_bf16 v235, v125, v229, v235
v_dot2_f32_bf16 v232, v126, v218, v232
v_dot2_f32_bf16 v233, v126, v222, v233
v_dot2_f32_bf16 v234, v126, v226, v234
v_dot2_f32_bf16 v235, v126, v230, v235
v_dot2_f32_bf16 v232, v127, v219, v232
v_dot2_f32_bf16 v233, v127, v223, v233
v_dot2_f32_bf16 v234, v127, v227, v234
v_dot2_f32_bf16 v235, v127, v231, v235
v_add_f32_dpp v236, v232, v232 row_ror:8 row_mask:0xf bank_mask:0x3
v_add_f32_dpp v237, v233, v233 row_ror:8 row_mask:0xf bank_mask:0x3
v_add_f32_dpp v236, v234, v234 row_ror:8 row_mask:0xf bank_mask:0xc
v_add_f32_dpp v237, v235, v235 row_ror:8 row_mask:0xf bank_mask:0xc
s_nop 0
v_add_f32_dpp v73, v236, v236 row_half_mirror row_mask:0xf bank_mask:0x5
v_add_f32_dpp v73, v237, v237 row_half_mirror row_mask:0xf bank_mask:0xa
s_nop 1
v_add_f32_dpp v73, v73, v73 quad_perm:[1,0,3,2] row_mask:0xf bank_mask:0xf
s_nop 1
v_add_f32_dpp v73, v73, v73 quad_perm:[2,3,0,1] row_mask:0xf bank_mask:0xf
s_waitcnt vmcnt(22)
v_dot2_f32_bf16 v232, v128, v216, 0
v_dot2_f32_bf16 v233, v128, v220, 0
v_dot2_f32_bf16 v234, v128, v224, 0
v_dot2_f32_bf16 v235, v128, v228, 0
v_dot2_f32_bf16 v232, v129, v217, v232
v_dot2_f32_bf16 v233, v129, v221, v233
v_dot2_f32_bf16 v234, v129, v225, v234
v_dot2_f32_bf16 v235, v129, v229, v235
v_dot2_f32_bf16 v232, v130, v218, v232
v_dot2_f32_bf16 v233, v130, v222, v233
v_dot2_f32_bf16 v234, v130, v226, v234
v_dot2_f32_bf16 v235, v130, v230, v235
v_dot2_f32_bf16 v232, v131, v219, v232
v_dot2_f32_bf16 v233, v131, v223, v233
v_dot2_f32_bf16 v234, v131, v227, v234
v_dot2_f32_bf16 v235, v131, v231, v235
v_add_f32_dpp v236, v232, v232 row_ror:8 row_mask:0xf bank_mask:0x3
v_add_f32_dpp v237, v233, v233 row_ror:8 row_mask:0xf bank_mask:0x3
v_add_f32_dpp v236, v234, v234 row_ror:8 row_mask:0xf bank_mask:0xc
v_add_f32_dpp v237, v235, v235 row_ror:8 row_mask:0xf bank_mask:0xc
s_nop 0
v_add_f32_dpp v74, v236, v236 row_half_mirror row_mask:0xf bank_mask:0x5
v_add_f32_dpp v74, v237, v237 row_half_mirror row_mask:0xf bank_mask:0xa
s_nop 1
v_add_f32_dpp v74, v74, v74 quad_perm:[1,0,3,2] row_mask:0xf bank_mask:0xf
s_nop 1
v_add_f32_dpp v74, v74, v74 quad_perm:[2,3,0,1] row_mask:0xf bank_mask:0xf
s_waitcnt vmcnt(21)
v_dot2_f32_bf16 v232, v132, v216, 0
v_dot2_f32_bf16 v233, v132, v220, 0
v_dot2_f32_bf16 v234, v132, v224, 0
v_dot2_f32_bf16 v235, v132, v228, 0
v_dot2_f32_bf16 v232, v133, v217, v232
v_dot2_f32_bf16 v233, v133, v221, v233
v_dot2_f32_bf16 v234, v133, v225, v234
v_dot2_f32_bf16 v235, v133, v229, v235
v_dot2_f32_bf16 v232, v134, v218, v232
v_dot2_f32_bf16 v233, v134, v222, v233
v_dot2_f32_bf16 v234, v134, v226, v234
v_dot2_f32_bf16 v235, v134, v230, v235
v_dot2_f32_bf16 v232, v135, v219, v232
v_dot2_f32_bf16 v233, v135, v223, v233
v_dot2_f32_bf16 v234, v135, v227, v234
v_dot2_f32_bf16 v235, v135, v231, v235
v_add_f32_dpp v236, v232, v232 row_ror:8 row_mask:0xf bank_mask:0x3
v_add_f32_dpp v237, v233, v233 row_ror:8 row_mask:0xf bank_mask:0x3
v_add_f32_dpp v236, v234, v234 row_ror:8 row_mask:0xf bank_mask:0xc
v_add_f32_dpp v237, v235, v235 row_ror:8 row_mask:0xf bank_mask:0xc
s_nop 0
v_add_f32_dpp v75, v236, v236 row_half_mirror row_mask:0xf bank_mask:0x5
v_add_f32_dpp v75, v237, v237 row_half_mirror row_mask:0xf bank_mask:0xa
s_nop 1
v_add_f32_dpp v75, v75, v75 quad_perm:[1,0,3,2] row_mask:0xf bank_mask:0xf
s_nop 1
v_add_f32_dpp v75, v75, v75 quad_perm:[2,3,0,1] row_mask:0xf bank_mask:0xf
s_waitcnt vmcnt(20)
v_dot2_f32_bf16 v232, v136, v216, 0
v_dot2_f32_bf16 v233, v136, v220, 0
v_dot2_f32_bf16 v234, v136, v224, 0
v_dot2_f32_bf16 v235, v136, v228, 0
v_dot2_f32_bf16 v232, v137, v217, v232
v_dot2_f32_bf16 v233, v137, v221, v233
v_dot2_f32_bf16 v234, v137, v225, v234
v_dot2_f32_bf16 v235, v137, v229, v235
v_dot2_f32_bf16 v232, v138, v218, v232
v_dot2_f32_bf16 v233, v138, v222, v233
v_dot2_f32_bf16 v234, v138, v226, v234
v_dot2_f32_bf16 v235, v138, v230, v235
v_dot2_f32_bf16 v232, v139, v219, v232
v_dot2_f32_bf16 v233, v139, v223, v233
v_dot2_f32_bf16 v234, v139, v227, v234
v_dot2_f32_bf16 v235, v139, v231, v235
v_add_f32_dpp v236, v232, v232 row_ror:8 row_mask:0xf bank_mask:0x3
v_add_f32_dpp v237, v233, v233 row_ror:8 row_mask:0xf bank_mask:0x3
v_add_f32_dpp v236, v234, v234 row_ror:8 row_mask:0xf bank_mask:0xc
v_add_f32_dpp v237, v235, v235 row_ror:8 row_mask:0xf bank_mask:0xc
s_nop 0
v_add_f32_dpp v76, v236, v236 row_half_mirror row_mask:0xf bank_mask:0x5
v_add_f32_dpp v76, v237, v237 row_half_mirror row_mask:0xf bank_mask:0xa
s_nop 1
v_add_f32_dpp v76, v76, v76 quad_perm:[1,0,3,2] row_mask:0xf bank_mask:0xf
s_nop 1
v_add_f32_dpp v76, v76, v76 quad_perm:[2,3,0,1] row_mask:0xf bank_mask:0xf
s_waitcnt vmcnt(19)
v_dot2_f32_bf16 v232, v140, v216, 0
v_dot2_f32_bf16 v233, v140, v220, 0
v_dot2_f32_bf16 v234, v140, v224, 0
v_dot2_f32_bf16 v235, v140, v228, 0
v_dot2_f32_bf16 v232, v141, v217, v232
v_dot2_f32_bf16 v233, v141, v221, v233
v_dot2_f32_bf16 v234, v141, v225, v234
v_dot2_f32_bf16 v235, v141, v229, v235
v_dot2_f32_bf16 v232, v142, v218, v232
v_dot2_f32_bf16 v233, v142, v222, v233
v_dot2_f32_bf16 v234, v142, v226, v234
v_dot2_f32_bf16 v235, v142, v230, v235
v_dot2_f32_bf16 v232, v143, v219, v232
v_dot2_f32_bf16 v233, v143, v223, v233
v_dot2_f32_bf16 v234, v143, v227, v234
v_dot2_f32_bf16 v235, v143, v231, v235
v_add_f32_dpp v236, v232, v232 row_ror:8 row_mask:0xf bank_mask:0x3
v_add_f32_dpp v237, v233, v233 row_ror:8 row_mask:0xf bank_mask:0x3
v_add_f32_dpp v236, v234, v234 row_ror:8 row_mask:0xf bank_mask:0xc
v_add_f32_dpp v237, v235, v235 row_ror:8 row_mask:0xf bank_mask:0xc
s_nop 0
v_add_f32_dpp v77, v236, v236 row_half_mirror row_mask:0xf bank_mask:0x5
v_add_f32_dpp v77, v237, v237 row_half_mirror row_mask:0xf bank_mask:0xa
s_nop 1
v_add_f32_dpp v77, v77, v77 quad_perm:[1,0,3,2] row_mask:0xf bank_mask:0xf
s_nop 1
v_add_f32_dpp v77, v77, v77 quad_perm:[2,3,0,1] row_mask:0xf bank_mask:0xf
s_waitcnt vmcnt(18)
v_dot2_f32_bf16 v232, v144, v216, 0
v_dot2_f32_bf16 v233, v144, v220, 0
v_dot2_f32_bf16 v234, v144, v224, 0
v_dot2_f32_bf16 v235, v144, v228, 0
v_dot2_f32_bf16 v232, v145, v217, v232
v_dot2_f32_bf16 v233, v145, v221, v233
v_dot2_f32_bf16 v234, v145, v225, v234
v_dot2_f32_bf16 v235, v145, v229, v235
v_dot2_f32_bf16 v232, v146, v218, v232
v_dot2_f32_bf16 v233, v146, v222, v233
v_dot2_f32_bf16 v234, v146, v226, v234
v_dot2_f32_bf16 v235, v146, v230, v235
v_dot2_f32_bf16 v232, v147, v219, v232
v_dot2_f32_bf16 v233, v147, v223, v233
v_dot2_f32_bf16 v234, v147, v227, v234
v_dot2_f32_bf16 v235, v147, v231, v235
v_add_f32_dpp v236, v232, v232 row_ror:8 row_mask:0xf bank_mask:0x3
v_add_f32_dpp v237, v233, v233 row_ror:8 row_mask:0xf bank_mask:0x3
v_add_f32_dpp v236, v234, v234 row_ror:8 row_mask:0xf bank_mask:0xc
v_add_f32_dpp v237, v235, v235 row_ror:8 row_mask:0xf bank_mask:0xc
s_nop 0
v_add_f32_dpp v78, v236, v236 row_half_mirror row_mask:0xf bank_mask:0x5
v_add_f32_dpp v78, v237, v237 row_half_mirror row_mask:0xf bank_mask:0xa
s_nop 1
v_add_f32_dpp v78, v78, v78 quad_perm:[1,0,3,2] row_mask:0xf bank_mask:0xf
s_nop 1
v_add_f32_dpp v78, v78, v78 quad_perm:[2,3,0,1] row_mask:0xf bank_mask:0xf
s_waitcnt vmcnt(17)
v_dot2_f32_bf16 v232, v148, v216, 0
v_dot2_f32_bf16 v233, v148, v220, 0
v_dot2_f32_bf16 v234, v148, v224, 0
v_dot2_f32_bf16 v235, v148, v228, 0
v_dot2_f32_bf16 v232, v149, v217, v232
v_dot2_f32_bf16 v233, v149, v221, v233
v_dot2_f32_bf16 v234, v149, v225, v234
v_dot2_f32_bf16 v235, v149, v229, v235
v_dot2_f32_bf16 v232, v150, v218, v232
v_dot2_f32_bf16 v233, v150, v222, v233
v_dot2_f32_bf16 v234, v150, v226, v234
v_dot2_f32_bf16 v235, v150, v230, v235
v_dot2_f32_bf16 v232, v151, v219, v232
v_dot2_f32_bf16 v233, v151, v223, v233
v_dot2_f32_bf16 v234, v151, v227, v234
v_dot2_f32_bf16 v235, v151, v231, v235
v_add_f32_dpp v236, v232, v232 row_ror:8 row_mask:0xf bank_mask:0x3
v_add_f32_dpp v237, v233, v233 row_ror:8 row_mask:0xf bank_mask:0x3
v_add_f32_dpp v236, v234, v234 row_ror:8 row_mask:0xf bank_mask:0xc
v_add_f32_dpp v237, v235, v235 row_ror:8 row_mask:0xf bank_mask:0xc
s_nop 0
v_add_f32_dpp v79, v236, v236 row_half_mirror row_mask:0xf bank_mask:0x5
v_add_f32_dpp v79, v237, v237 row_half_mirror row_mask:0xf bank_mask:0xa
s_nop 1
v_add_f32_dpp v79, v79, v79 quad_perm:[1,0,3,2] row_mask:0xf bank_mask:0xf
s_nop 1
v_add_f32_dpp v79, v79, v79 quad_perm:[2,3,0,1] row_mask:0xf bank_mask:0xf
v_cvt_pk_bf16_f32 v24, v64, v65
v_cvt_pk_bf16_f32 v25, v66, v67
v_cvt_pk_bf16_f32 v26, v68, v69
v_cvt_pk_bf16_f32 v27, v70, v71
v_cvt_pk_bf16_f32 v28, v72, v73
v_cvt_pk_bf16_f32 v29, v74, v75
v_cvt_pk_bf16_f32 v30, v76, v77
v_cvt_pk_bf16_f32 v31, v78, v79
v_cmp_eq_u32 vcc, 1, v6
s_nop 1
v_cndmask_b32 v244, v24, v28, vcc
v_cndmask_b32 v245, v25, v29, vcc
v_cndmask_b32 v246, v26, v30, vcc
v_cndmask_b32 v247, v27, v31, vcc
s_waitcnt vmcnt(16)
v_dot2_f32_bf16 v232, v152, v216, 0
v_dot2_f32_bf16 v233, v152, v220, 0
v_dot2_f32_bf16 v234, v152, v224, 0
v_dot2_f32_bf16 v235, v152, v228, 0
v_dot2_f32_bf16 v232, v153, v217, v232
v_dot2_f32_bf16 v233, v153, v221, v233
v_dot2_f32_bf16 v234, v153, v225, v234
v_dot2_f32_bf16 v235, v153, v229, v235
v_dot2_f32_bf16 v232, v154, v218, v232
v_dot2_f32_bf16 v233, v154, v222, v233
v_dot2_f32_bf16 v234, v154, v226, v234
v_dot2_f32_bf16 v235, v154, v230, v235
v_dot2_f32_bf16 v232, v155, v219, v232
v_dot2_f32_bf16 v233, v155, v223, v233
v_dot2_f32_bf16 v234, v155, v227, v234
v_dot2_f32_bf16 v235, v155, v231, v235
v_add_f32_dpp v236, v232, v232 row_ror:8 row_mask:0xf bank_mask:0x3
v_add_f32_dpp v237, v233, v233 row_ror:8 row_mask:0xf bank_mask:0x3
v_add_f32_dpp v236, v234, v234 row_ror:8 row_mask:0xf bank_mask:0xc
v_add_f32_dpp v237, v235, v235 row_ror:8 row_mask:0xf bank_mask:0xc
s_nop 0
v_add_f32_dpp v64, v236, v236 row_half_mirror row_mask:0xf bank_mask:0x5
v_add_f32_dpp v64, v237, v237 row_half_mirror row_mask:0xf bank_mask:0xa
s_nop 1
v_add_f32_dpp v64, v64, v64 quad_perm:[1,0,3,2] row_mask:0xf bank_mask:0xf
s_nop 1
v_add_f32_dpp v64, v64, v64 quad_perm:[2,3,0,1] row_mask:0xf bank_mask:0xf
s_waitcnt vmcnt(15)
v_dot2_f32_bf16 v232, v156, v216, 0
v_dot2_f32_bf16 v233, v156, v220, 0
v_dot2_f32_bf16 v234, v156, v224, 0
v_dot2_f32_bf16 v235, v156, v228, 0
v_dot2_f32_bf16 v232, v157, v217, v232
v_dot2_f32_bf16 v233, v157, v221, v233
v_dot2_f32_bf16 v234, v157, v225, v234
v_dot2_f32_bf16 v235, v157, v229, v235
v_dot2_f32_bf16 v232, v158, v218, v232
v_dot2_f32_bf16 v233, v158, v222, v233
v_dot2_f32_bf16 v234, v158, v226, v234
v_dot2_f32_bf16 v235, v158, v230, v235
v_dot2_f32_bf16 v232, v159, v219, v232
v_dot2_f32_bf16 v233, v159, v223, v233
v_dot2_f32_bf16 v234, v159, v227, v234
v_dot2_f32_bf16 v235, v159, v231, v235
v_add_f32_dpp v236, v232, v232 row_ror:8 row_mask:0xf bank_mask:0x3
v_add_f32_dpp v237, v233, v233 row_ror:8 row_mask:0xf bank_mask:0x3
v_add_f32_dpp v236, v234, v234 row_ror:8 row_mask:0xf bank_mask:0xc
v_add_f32_dpp v237, v235, v235 row_ror:8 row_mask:0xf bank_mask:0xc
s_nop 0
v_add_f32_dpp v65, v236, v236 row_half_mirror row_mask:0xf bank_mask:0x5
v_add_f32_dpp v65, v237, v237 row_half_mirror row_mask:0xf bank_mask:0xa
s_nop 1
v_add_f32_dpp v65, v65, v65 quad_perm:[1,0,3,2] row_mask:0xf bank_mask:0xf
s_nop 1
v_add_f32_dpp v65, v65, v65 quad_perm:[2,3,0,1] row_mask:0xf bank_mask:0xf
s_waitcnt vmcnt(14)
v_dot2_f32_bf16 v232, v160, v216, 0
v_dot2_f32_bf16 v233, v160, v220, 0
v_dot2_f32_bf16 v234, v160, v224, 0
v_dot2_f32_bf16 v235, v160, v228, 0
v_dot2_f32_bf16 v232, v161, v217, v232
v_dot2_f32_bf16 v233, v161, v221, v233
v_dot2_f32_bf16 v234, v161, v225, v234
v_dot2_f32_bf16 v235, v161, v229, v235
v_dot2_f32_bf16 v232, v162, v218, v232
v_dot2_f32_bf16 v233, v162, v222, v233
v_dot2_f32_bf16 v234, v162, v226, v234
v_dot2_f32_bf16 v235, v162, v230, v235
v_dot2_f32_bf16 v232, v163, v219, v232
v_dot2_f32_bf16 v233, v163, v223, v233
v_dot2_f32_bf16 v234, v163, v227, v234
v_dot2_f32_bf16 v235, v163, v231, v235
v_add_f32_dpp v236, v232, v232 row_ror:8 row_mask:0xf bank_mask:0x3
v_add_f32_dpp v237, v233, v233 row_ror:8 row_mask:0xf bank_mask:0x3
v_add_f32_dpp v236, v234, v234 row_ror:8 row_mask:0xf bank_mask:0xc
v_add_f32_dpp v237, v235, v235 row_ror:8 row_mask:0xf bank_mask:0xc
s_nop 0
v_add_f32_dpp v66, v236, v236 row_half_mirror row_mask:0xf bank_mask:0x5
v_add_f32_dpp v66, v237, v237 row_half_mirror row_mask:0xf bank_mask:0xa
s_nop 1
v_add_f32_dpp v66, v66, v66 quad_perm:[1,0,3,2] row_mask:0xf bank_mask:0xf
s_nop 1
v_add_f32_dpp v66, v66, v66 quad_perm:[2,3,0,1] row_mask:0xf bank_mask:0xf
s_waitcnt vmcnt(13)
v_dot2_f32_bf16 v232, v164, v216, 0
v_dot2_f32_bf16 v233, v164, v220, 0
v_dot2_f32_bf16 v234, v164, v224, 0
v_dot2_f32_bf16 v235, v164, v228, 0
v_dot2_f32_bf16 v232, v165, v217, v232
v_dot2_f32_bf16 v233, v165, v221, v233
v_dot2_f32_bf16 v234, v165, v225, v234
v_dot2_f32_bf16 v235, v165, v229, v235
v_dot2_f32_bf16 v232, v166, v218, v232
v_dot2_f32_bf16 v233, v166, v222, v233
v_dot2_f32_bf16 v234, v166, v226, v234
v_dot2_f32_bf16 v235, v166, v230, v235
v_dot2_f32_bf16 v232, v167, v219, v232
v_dot2_f32_bf16 v233, v167, v223, v233
v_dot2_f32_bf16 v234, v167, v227, v234
v_dot2_f32_bf16 v235, v167, v231, v235
v_add_f32_dpp v236, v232, v232 row_ror:8 row_mask:0xf bank_mask:0x3
v_add_f32_dpp v237, v233, v233 row_ror:8 row_mask:0xf bank_mask:0x3
v_add_f32_dpp v236, v234, v234 row_ror:8 row_mask:0xf bank_mask:0xc
v_add_f32_dpp v237, v235, v235 row_ror:8 row_mask:0xf bank_mask:0xc
s_nop 0
v_add_f32_dpp v67, v236, v236 row_half_mirror row_mask:0xf bank_mask:0x5
v_add_f32_dpp v67, v237, v237 row_half_mirror row_mask:0xf bank_mask:0xa
s_nop 1
v_add_f32_dpp v67, v67, v67 quad_perm:[1,0,3,2] row_mask:0xf bank_mask:0xf
s_nop 1
v_add_f32_dpp v67, v67, v67 quad_perm:[2,3,0,1] row_mask:0xf bank_mask:0xf
s_waitcnt vmcnt(12)
v_dot2_f32_bf16 v232, v168, v216, 0
v_dot2_f32_bf16 v233, v168, v220, 0
v_dot2_f32_bf16 v234, v168, v224, 0
v_dot2_f32_bf16 v235, v168, v228, 0
v_dot2_f32_bf16 v232, v169, v217, v232
v_dot2_f32_bf16 v233, v169, v221, v233
v_dot2_f32_bf16 v234, v169, v225, v234
v_dot2_f32_bf16 v235, v169, v229, v235
v_dot2_f32_bf16 v232, v170, v218, v232
v_dot2_f32_bf16 v233, v170, v222, v233
v_dot2_f32_bf16 v234, v170, v226, v234
v_dot2_f32_bf16 v235, v170, v230, v235
v_dot2_f32_bf16 v232, v171, v219, v232
v_dot2_f32_bf16 v233, v171, v223, v233
v_dot2_f32_bf16 v234, v171, v227, v234
v_dot2_f32_bf16 v235, v171, v231, v235
v_add_f32_dpp v236, v232, v232 row_ror:8 row_mask:0xf bank_mask:0x3
v_add_f32_dpp v237, v233, v233 row_ror:8 row_mask:0xf bank_mask:0x3
v_add_f32_dpp v236, v234, v234 row_ror:8 row_mask:0xf bank_mask:0xc
v_add_f32_dpp v237, v235, v235 row_ror:8 row_mask:0xf bank_mask:0xc
s_nop 0
v_add_f32_dpp v68, v236, v236 row_half_mirror row_mask:0xf bank_mask:0x5
v_add_f32_dpp v68, v237, v237 row_half_mirror row_mask:0xf bank_mask:0xa
s_nop 1
v_add_f32_dpp v68, v68, v68 quad_perm:[1,0,3,2] row_mask:0xf bank_mask:0xf
s_nop 1
v_add_f32_dpp v68, v68, v68 quad_perm:[2,3,0,1] row_mask:0xf bank_mask:0xf
s_waitcnt vmcnt(11)
v_dot2_f32_bf16 v232, v172, v216, 0
v_dot2_f32_bf16 v233, v172, v220, 0
v_dot2_f32_bf16 v234, v172, v224, 0
v_dot2_f32_bf16 v235, v172, v228, 0
v_dot2_f32_bf16 v232, v173, v217, v232
v_dot2_f32_bf16 v233, v173, v221, v233
v_dot2_f32_bf16 v234, v173, v225, v234
v_dot2_f32_bf16 v235, v173, v229, v235
v_dot2_f32_bf16 v232, v174, v218, v232
v_dot2_f32_bf16 v233, v174, v222, v233
v_dot2_f32_bf16 v234, v174, v226, v234
v_dot2_f32_bf16 v235, v174, v230, v235
v_dot2_f32_bf16 v232, v175, v219, v232
v_dot2_f32_bf16 v233, v175, v223, v233
v_dot2_f32_bf16 v234, v175, v227, v234
v_dot2_f32_bf16 v235, v175, v231, v235
v_add_f32_dpp v236, v232, v232 row_ror:8 row_mask:0xf bank_mask:0x3
v_add_f32_dpp v237, v233, v233 row_ror:8 row_mask:0xf bank_mask:0x3
v_add_f32_dpp v236, v234, v234 row_ror:8 row_mask:0xf bank_mask:0xc
v_add_f32_dpp v237, v235, v235 row_ror:8 row_mask:0xf bank_mask:0xc
s_nop 0
v_add_f32_dpp v69, v236, v236 row_half_mirror row_mask:0xf bank_mask:0x5
v_add_f32_dpp v69, v237, v237 row_half_mirror row_mask:0xf bank_mask:0xa
s_nop 1
v_add_f32_dpp v69, v69, v69 quad_perm:[1,0,3,2] row_mask:0xf bank_mask:0xf
s_nop 1
v_add_f32_dpp v69, v69, v69 quad_perm:[2,3,0,1] row_mask:0xf bank_mask:0xf
s_waitcnt vmcnt(10)
v_dot2_f32_bf16 v232, v176, v216, 0
v_dot2_f32_bf16 v233, v176, v220, 0
v_dot2_f32_bf16 v234, v176, v224, 0
v_dot2_f32_bf16 v235, v176, v228, 0
v_dot2_f32_bf16 v232, v177, v217, v232
v_dot2_f32_bf16 v233, v177, v221, v233
v_dot2_f32_bf16 v234, v177, v225, v234
v_dot2_f32_bf16 v235, v177, v229, v235
v_dot2_f32_bf16 v232, v178, v218, v232
v_dot2_f32_bf16 v233, v178, v222, v233
v_dot2_f32_bf16 v234, v178, v226, v234
v_dot2_f32_bf16 v235, v178, v230, v235
v_dot2_f32_bf16 v232, v179, v219, v232
v_dot2_f32_bf16 v233, v179, v223, v233
v_dot2_f32_bf16 v234, v179, v227, v234
v_dot2_f32_bf16 v235, v179, v231, v235
v_add_f32_dpp v236, v232, v232 row_ror:8 row_mask:0xf bank_mask:0x3
v_add_f32_dpp v237, v233, v233 row_ror:8 row_mask:0xf bank_mask:0x3
v_add_f32_dpp v236, v234, v234 row_ror:8 row_mask:0xf bank_mask:0xc
v_add_f32_dpp v237, v235, v235 row_ror:8 row_mask:0xf bank_mask:0xc
s_nop 0
v_add_f32_dpp v70, v236, v236 row_half_mirror row_mask:0xf bank_mask:0x5
v_add_f32_dpp v70, v237, v237 row_half_mirror row_mask:0xf bank_mask:0xa
s_nop 1
v_add_f32_dpp v70, v70, v70 quad_perm:[1,0,3,2] row_mask:0xf bank_mask:0xf
s_nop 1
v_add_f32_dpp v70, v70, v70 quad_perm:[2,3,0,1] row_mask:0xf bank_mask:0xf
s_waitcnt vmcnt(9)
v_dot2_f32_bf16 v232, v180, v216, 0
v_dot2_f32_bf16 v233, v180, v220, 0
v_dot2_f32_bf16 v234, v180, v224, 0
v_dot2_f32_bf16 v235, v180, v228, 0
v_dot2_f32_bf16 v232, v181, v217, v232
v_dot2_f32_bf16 v233, v181, v221, v233
v_dot2_f32_bf16 v234, v181, v225, v234
v_dot2_f32_bf16 v235, v181, v229, v235
v_dot2_f32_bf16 v232, v182, v218, v232
v_dot2_f32_bf16 v233, v182, v222, v233
v_dot2_f32_bf16 v234, v182, v226, v234
v_dot2_f32_bf16 v235, v182, v230, v235
v_dot2_f32_bf16 v232, v183, v219, v232
v_dot2_f32_bf16 v233, v183, v223, v233
v_dot2_f32_bf16 v234, v183, v227, v234
v_dot2_f32_bf16 v235, v183, v231, v235
v_add_f32_dpp v236, v232, v232 row_ror:8 row_mask:0xf bank_mask:0x3
v_add_f32_dpp v237, v233, v233 row_ror:8 row_mask:0xf bank_mask:0x3
v_add_f32_dpp v236, v234, v234 row_ror:8 row_mask:0xf bank_mask:0xc
v_add_f32_dpp v237, v235, v235 row_ror:8 row_mask:0xf bank_mask:0xc
s_nop 0
v_add_f32_dpp v71, v236, v236 row_half_mirror row_mask:0xf bank_mask:0x5
v_add_f32_dpp v71, v237, v237 row_half_mirror row_mask:0xf bank_mask:0xa
s_nop 1
v_add_f32_dpp v71, v71, v71 quad_perm:[1,0,3,2] row_mask:0xf bank_mask:0xf
s_nop 1
v_add_f32_dpp v71, v71, v71 quad_perm:[2,3,0,1] row_mask:0xf bank_mask:0xf
s_waitcnt vmcnt(8)
v_dot2_f32_bf16 v232, v184, v216, 0
v_dot2_f32_bf16 v233, v184, v220, 0
v_dot2_f32_bf16 v234, v184, v224, 0
v_dot2_f32_bf16 v235, v184, v228, 0
v_dot2_f32_bf16 v232, v185, v217, v232
v_dot2_f32_bf16 v233, v185, v221, v233
v_dot2_f32_bf16 v234, v185, v225, v234
v_dot2_f32_bf16 v235, v185, v229, v235
v_dot2_f32_bf16 v232, v186, v218, v232
v_dot2_f32_bf16 v233, v186, v222, v233
v_dot2_f32_bf16 v234, v186, v226, v234
v_dot2_f32_bf16 v235, v186, v230, v235
v_dot2_f32_bf16 v232, v187, v219, v232
v_dot2_f32_bf16 v233, v187, v223, v233
v_dot2_f32_bf16 v234, v187, v227, v234
v_dot2_f32_bf16 v235, v187, v231, v235
v_add_f32_dpp v236, v232, v232 row_ror:8 row_mask:0xf bank_mask:0x3
v_add_f32_dpp v237, v233, v233 row_ror:8 row_mask:0xf bank_mask:0x3
v_add_f32_dpp v236, v234, v234 row_ror:8 row_mask:0xf bank_mask:0xc
v_add_f32_dpp v237, v235, v235 row_ror:8 row_mask:0xf bank_mask:0xc
s_nop 0
v_add_f32_dpp v72, v236, v236 row_half_mirror row_mask:0xf bank_mask:0x5
v_add_f32_dpp v72, v237, v237 row_half_mirror row_mask:0xf bank_mask:0xa
s_nop 1
v_add_f32_dpp v72, v72, v72 quad_perm:[1,0,3,2] row_mask:0xf bank_mask:0xf
s_nop 1
v_add_f32_dpp v72, v72, v72 quad_perm:[2,3,0,1] row_mask:0xf bank_mask:0xf
s_waitcnt vmcnt(7)
v_dot2_f32_bf16 v232, v188, v216, 0
v_dot2_f32_bf16 v233, v188, v220, 0
v_dot2_f32_bf16 v234, v188, v224, 0
v_dot2_f32_bf16 v235, v188, v228, 0
v_dot2_f32_bf16 v232, v189, v217, v232
v_dot2_f32_bf16 v233, v189, v221, v233
v_dot2_f32_bf16 v234, v189, v225, v234
v_dot2_f32_bf16 v235, v189, v229, v235
v_dot2_f32_bf16 v232, v190, v218, v232
v_dot2_f32_bf16 v233, v190, v222, v233
v_dot2_f32_bf16 v234, v190, v226, v234
v_dot2_f32_bf16 v235, v190, v230, v235
v_dot2_f32_bf16 v232, v191, v219, v232
v_dot2_f32_bf16 v233, v191, v223, v233
v_dot2_f32_bf16 v234, v191, v227, v234
v_dot2_f32_bf16 v235, v191, v231, v235
v_add_f32_dpp v236, v232, v232 row_ror:8 row_mask:0xf bank_mask:0x3
v_add_f32_dpp v237, v233, v233 row_ror:8 row_mask:0xf bank_mask:0x3
v_add_f32_dpp v236, v234, v234 row_ror:8 row_mask:0xf bank_mask:0xc
v_add_f32_dpp v237, v235, v235 row_ror:8 row_mask:0xf bank_mask:0xc
s_nop 0
v_add_f32_dpp v73, v236, v236 row_half_mirror row_mask:0xf bank_mask:0x5
v_add_f32_dpp v73, v237, v237 row_half_mirror row_mask:0xf bank_mask:0xa
s_nop 1
v_add_f32_dpp v73, v73, v73 quad_perm:[1,0,3,2] row_mask:0xf bank_mask:0xf
s_nop 1
v_add_f32_dpp v73, v73, v73 quad_perm:[2,3,0,1] row_mask:0xf bank_mask:0xf
s_waitcnt vmcnt(6)
v_dot2_f32_bf16 v232, v192, v216, 0
v_dot2_f32_bf16 v233, v192, v220, 0
v_dot2_f32_bf16 v234, v192, v224, 0
v_dot2_f32_bf16 v235, v192, v228, 0
v_dot2_f32_bf16 v232, v193, v217, v232
v_dot2_f32_bf16 v233, v193, v221, v233
v_dot2_f32_bf16 v234, v193, v225, v234
v_dot2_f32_bf16 v235, v193, v229, v235
v_dot2_f32_bf16 v232, v194, v218, v232
v_dot2_f32_bf16 v233, v194, v222, v233
v_dot2_f32_bf16 v234, v194, v226, v234
v_dot2_f32_bf16 v235, v194, v230, v235
v_dot2_f32_bf16 v232, v195, v219, v232
v_dot2_f32_bf16 v233, v195, v223, v233
v_dot2_f32_bf16 v234, v195, v227, v234
v_dot2_f32_bf16 v235, v195, v231, v235
v_add_f32_dpp v236, v232, v232 row_ror:8 row_mask:0xf bank_mask:0x3
v_add_f32_dpp v237, v233, v233 row_ror:8 row_mask:0xf bank_mask:0x3
v_add_f32_dpp v236, v234, v234 row_ror:8 row_mask:0xf bank_mask:0xc
v_add_f32_dpp v237, v235, v235 row_ror:8 row_mask:0xf bank_mask:0xc
s_nop 0
v_add_f32_dpp v74, v236, v236 row_half_mirror row_mask:0xf bank_mask:0x5
v_add_f32_dpp v74, v237, v237 row_half_mirror row_mask:0xf bank_mask:0xa
s_nop 1
v_add_f32_dpp v74, v74, v74 quad_perm:[1,0,3,2] row_mask:0xf bank_mask:0xf
s_nop 1
v_add_f32_dpp v74, v74, v74 quad_perm:[2,3,0,1] row_mask:0xf bank_mask:0xf
s_waitcnt vmcnt(5)
v_dot2_f32_bf16 v232, v196, v216, 0
v_dot2_f32_bf16 v233, v196, v220, 0
v_dot2_f32_bf16 v234, v196, v224, 0
v_dot2_f32_bf16 v235, v196, v228, 0
v_dot2_f32_bf16 v232, v197, v217, v232
v_dot2_f32_bf16 v233, v197, v221, v233
v_dot2_f32_bf16 v234, v197, v225, v234
v_dot2_f32_bf16 v235, v197, v229, v235
v_dot2_f32_bf16 v232, v198, v218, v232
v_dot2_f32_bf16 v233, v198, v222, v233
v_dot2_f32_bf16 v234, v198, v226, v234
v_dot2_f32_bf16 v235, v198, v230, v235
v_dot2_f32_bf16 v232, v199, v219, v232
v_dot2_f32_bf16 v233, v199, v223, v233
v_dot2_f32_bf16 v234, v199, v227, v234
v_dot2_f32_bf16 v235, v199, v231, v235
v_add_f32_dpp v236, v232, v232 row_ror:8 row_mask:0xf bank_mask:0x3
v_add_f32_dpp v237, v233, v233 row_ror:8 row_mask:0xf bank_mask:0x3
v_add_f32_dpp v236, v234, v234 row_ror:8 row_mask:0xf bank_mask:0xc
v_add_f32_dpp v237, v235, v235 row_ror:8 row_mask:0xf bank_mask:0xc
s_nop 0
v_add_f32_dpp v75, v236, v236 row_half_mirror row_mask:0xf bank_mask:0x5
v_add_f32_dpp v75, v237, v237 row_half_mirror row_mask:0xf bank_mask:0xa
s_nop 1
v_add_f32_dpp v75, v75, v75 quad_perm:[1,0,3,2] row_mask:0xf bank_mask:0xf
s_nop 1
v_add_f32_dpp v75, v75, v75 quad_perm:[2,3,0,1] row_mask:0xf bank_mask:0xf
s_waitcnt vmcnt(4)
v_dot2_f32_bf16 v232, v200, v216, 0
v_dot2_f32_bf16 v233, v200, v220, 0
v_dot2_f32_bf16 v234, v200, v224, 0
v_dot2_f32_bf16 v235, v200, v228, 0
v_dot2_f32_bf16 v232, v201, v217, v232
v_dot2_f32_bf16 v233, v201, v221, v233
v_dot2_f32_bf16 v234, v201, v225, v234
v_dot2_f32_bf16 v235, v201, v229, v235
v_dot2_f32_bf16 v232, v202, v218, v232
v_dot2_f32_bf16 v233, v202, v222, v233
v_dot2_f32_bf16 v234, v202, v226, v234
v_dot2_f32_bf16 v235, v202, v230, v235
v_dot2_f32_bf16 v232, v203, v219, v232
v_dot2_f32_bf16 v233, v203, v223, v233
v_dot2_f32_bf16 v234, v203, v227, v234
v_dot2_f32_bf16 v235, v203, v231, v235
v_add_f32_dpp v236, v232, v232 row_ror:8 row_mask:0xf bank_mask:0x3
v_add_f32_dpp v237, v233, v233 row_ror:8 row_mask:0xf bank_mask:0x3
v_add_f32_dpp v236, v234, v234 row_ror:8 row_mask:0xf bank_mask:0xc
v_add_f32_dpp v237, v235, v235 row_ror:8 row_mask:0xf bank_mask:0xc
s_nop 0
v_add_f32_dpp v76, v236, v236 row_half_mirror row_mask:0xf bank_mask:0x5
v_add_f32_dpp v76, v237, v237 row_half_mirror row_mask:0xf bank_mask:0xa
s_nop 1
v_add_f32_dpp v76, v76, v76 quad_perm:[1,0,3,2] row_mask:0xf bank_mask:0xf
s_nop 1
v_add_f32_dpp v76, v76, v76 quad_perm:[2,3,0,1] row_mask:0xf bank_mask:0xf
s_waitcnt vmcnt(3)
v_dot2_f32_bf16 v232, v204, v216, 0
v_dot2_f32_bf16 v233, v204, v220, 0
v_dot2_f32_bf16 v234, v204, v224, 0
v_dot2_f32_bf16 v235, v204, v228, 0
v_dot2_f32_bf16 v232, v205, v217, v232
v_dot2_f32_bf16 v233, v205, v221, v233
v_dot2_f32_bf16 v234, v205, v225, v234
v_dot2_f32_bf16 v235, v205, v229, v235
v_dot2_f32_bf16 v232, v206, v218, v232
v_dot2_f32_bf16 v233, v206, v222, v233
v_dot2_f32_bf16 v234, v206, v226, v234
v_dot2_f32_bf16 v235, v206, v230, v235
v_dot2_f32_bf16 v232, v207, v219, v232
v_dot2_f32_bf16 v233, v207, v223, v233
v_dot2_f32_bf16 v234, v207, v227, v234
v_dot2_f32_bf16 v235, v207, v231, v235
v_add_f32_dpp v236, v232, v232 row_ror:8 row_mask:0xf bank_mask:0x3
v_add_f32_dpp v237, v233, v233 row_ror:8 row_mask:0xf bank_mask:0x3
v_add_f32_dpp v236, v234, v234 row_ror:8 row_mask:0xf bank_mask:0xc
v_add_f32_dpp v237, v235, v235 row_ror:8 row_mask:0xf bank_mask:0xc
s_nop 0
v_add_f32_dpp v77, v236, v236 row_half_mirror row_mask:0xf bank_mask:0x5
v_add_f32_dpp v77, v237, v237 row_half_mirror row_mask:0xf bank_mask:0xa
s_nop 1
v_add_f32_dpp v77, v77, v77 quad_perm:[1,0,3,2] row_mask:0xf bank_mask:0xf
s_nop 1
v_add_f32_dpp v77, v77, v77 quad_perm:[2,3,0,1] row_mask:0xf bank_mask:0xf
s_waitcnt vmcnt(2)
v_dot2_f32_bf16 v232, v208, v216, 0
v_dot2_f32_bf16 v233, v208, v220, 0
v_dot2_f32_bf16 v234, v208, v224, 0
v_dot2_f32_bf16 v235, v208, v228, 0
v_dot2_f32_bf16 v232, v209, v217, v232
v_dot2_f32_bf16 v233, v209, v221, v233
v_dot2_f32_bf16 v234, v209, v225, v234
v_dot2_f32_bf16 v235, v209, v229, v235
v_dot2_f32_bf16 v232, v210, v218, v232
v_dot2_f32_bf16 v233, v210, v222, v233
v_dot2_f32_bf16 v234, v210, v226, v234
v_dot2_f32_bf16 v235, v210, v230, v235
v_dot2_f32_bf16 v232, v211, v219, v232
v_dot2_f32_bf16 v233, v211, v223, v233
v_dot2_f32_bf16 v234, v211, v227, v234
v_dot2_f32_bf16 v235, v211, v231, v235
v_add_f32_dpp v236, v232, v232 row_ror:8 row_mask:0xf bank_mask:0x3
v_add_f32_dpp v237, v233, v233 row_ror:8 row_mask:0xf bank_mask:0x3
v_add_f32_dpp v236, v234, v234 row_ror:8 row_mask:0xf bank_mask:0xc
v_add_f32_dpp v237, v235, v235 row_ror:8 row_mask:0xf bank_mask:0xc
s_nop 0
v_add_f32_dpp v78, v236, v236 row_half_mirror row_mask:0xf bank_mask:0x5
v_add_f32_dpp v78, v237, v237 row_half_mirror row_mask:0xf bank_mask:0xa
s_nop 1
v_add_f32_dpp v78, v78, v78 quad_perm:[1,0,3,2] row_mask:0xf bank_mask:0xf
s_nop 1
v_add_f32_dpp v78, v78, v78 quad_perm:[2,3,0,1] row_mask:0xf bank_mask:0xf
s_waitcnt vmcnt(1)
v_dot2_f32_bf16 v232, v212, v216, 0
v_dot2_f32_bf16 v233, v212, v220, 0
v_dot2_f32_bf16 v234, v212, v224, 0
v_dot2_f32_bf16 v235, v212, v228, 0
v_dot2_f32_bf16 v232, v213, v217, v232
v_dot2_f32_bf16 v233, v213, v221, v233
v_dot2_f32_bf16 v234, v213, v225, v234
v_dot2_f32_bf16 v235, v213, v229, v235
v_dot2_f32_bf16 v232, v214, v218, v232
v_dot2_f32_bf16 v233, v214, v222, v233
v_dot2_f32_bf16 v234, v214, v226, v234
v_dot2_f32_bf16 v235, v214, v230, v235
v_dot2_f32_bf16 v232, v215, v219, v232
v_dot2_f32_bf16 v233, v215, v223, v233
v_dot2_f32_bf16 v234, v215, v227, v234
v_dot2_f32_bf16 v235, v215, v231, v235
v_add_f32_dpp v236, v232, v232 row_ror:8 row_mask:0xf bank_mask:0x3
v_add_f32_dpp v237, v233, v233 row_ror:8 row_mask:0xf bank_mask:0x3
v_add_f32_dpp v236, v234, v234 row_ror:8 row_mask:0xf bank_mask:0xc
v_add_f32_dpp v237, v235, v235 row_ror:8 row_mask:0xf bank_mask:0xc
s_nop 0
v_add_f32_dpp v79, v236, v236 row_half_mirror row_mask:0xf bank_mask:0x5
v_add_f32_dpp v79, v237, v237 row_half_mirror row_mask:0xf bank_mask:0xa
s_nop 1
v_add_f32_dpp v79, v79, v79 quad_perm:[1,0,3,2] row_mask:0xf bank_mask:0xf
s_nop 1
v_add_f32_dpp v79, v79, v79 quad_perm:[2,3,0,1] row_mask:0xf bank_mask:0xf
v_cvt_pk_bf16_f32 v24, v64, v65
v_cvt_pk_bf16_f32 v25, v66, v67
v_cvt_pk_bf16_f32 v26, v68, v69
v_cvt_pk_bf16_f32 v27, v70, v71
v_cvt_pk_bf16_f32 v28, v72, v73
v_cvt_pk_bf16_f32 v29, v74, v75
v_cvt_pk_bf16_f32 v30, v76, v77
v_cvt_pk_bf16_f32 v31, v78, v79
v_cmp_eq_u32 vcc, 1, v6
s_nop 1
v_cndmask_b32 v248, v24, v28, vcc
v_cndmask_b32 v249, v25, v29, vcc
v_cndmask_b32 v250, v26, v30, vcc
v_cndmask_b32 v251, v27, v31, vcc
v_cmp_eq_u32 vcc, 1, v7
s_nop 1
v_cndmask_b32 v244, v244, v248, vcc
v_cndmask_b32 v245, v245, v249, vcc
v_cndmask_b32 v246, v246, v250, vcc
v_cndmask_b32 v247, v247, v251, vcc
v_min_u32 v244, -2, v244
v_min_u32 v245, -2, v245
v_min_u32 v246, -2, v246
v_min_u32 v247, -2, v247
s_waitcnt vmcnt(0)
s_mov_b32 s7, 400000
L_ens_15:
v_readfirstlane_b32 s6, v11
s_cmp_ge_u32 s6, 32
s_cbranch_scc1 L_ensd_16
s_sleep 16
buffer_load_dword v11, off, s[68:71], 0 offset:0 sc1
s_waitcnt vmcnt(0)
s_sub_u32 s7, s7, 1
s_cmp_lg_u32 s7, 0
s_cbranch_scc1 L_ens_15
L_ensd_16:
s_lshl_b32 s6, s4, 10
s_lshl_b32 s7, s3, 8
s_add_u32 s6, s6, s7
s_add_u32 s6, s6, 0
buffer_store_dwordx4 v[244:247], v5, s[64:67], s6 offen sc1
s_mov_b32 m0, s12
s_nop 0
buffer_load_dwordx4 v2, s[60:63], s12 offen offset:0 nt lds
buffer_load_dwordx4 v2, s[60:63], s12 offen offset:1024 nt lds
buffer_load_dwordx4 v2, s[60:63], s12 offen offset:2048 nt lds
s_waitcnt vmcnt(3)
buffer_load_dwordx4 v2, s[60:63], s12 offen offset:3072 nt lds
s_add_u32 s12, s12, 4096
s_mov_b32 m0, s12
s_waitcnt vmcnt(3)
buffer_load_dwordx4 v2, s[60:63], s12 offen offset:0 nt lds
s_waitcnt vmcnt(3)
buffer_load_dwordx4 v2, s[60:63], s12 offen offset:1024 nt lds
s_waitcnt vmcnt(3)
buffer_load_dwordx4 v2, s[60:63], s12 offen offset:2048 nt lds
s_waitcnt vmcnt(3)
buffer_load_dwordx4 v2, s[60:63], s12 offen offset:3072 nt lds
s_add_u32 s12, s12, 4096
s_mov_b32 m0, s12
s_waitcnt vmcnt(3)
buffer_load_dwordx4 v2, s[60:63], s12 offen offset:0 nt lds
s_waitcnt vmcnt(3)
buffer_load_dwordx4 v2, s[60:63], s12 offen offset:1024 nt lds
s_waitcnt vmcnt(3)
buffer_load_dwordx4 v2, s[60:63], s12 offen offset:2048 nt lds
s_waitcnt vmcnt(3)
buffer_load_dwordx4 v2, s[60:63], s12 offen offset:3072 nt lds
s_add_u32 s12, s12, 4096
s_mov_b32 m0, s12
s_waitcnt vmcnt(3)
buffer_load_dwordx4 v2, s[60:63], s12 offen offset:0 nt lds
s_waitcnt vmcnt(3)
buffer_load_dwordx4 v2, s[60:63], s12 offen offset:1024 nt lds
s_waitcnt vmcnt(3)
buffer_load_dwordx4 v2, s[60:63], s12 offen offset:2048 nt lds
s_waitcnt vmcnt(3)
buffer_load_dwordx4 v2, s[60:63], s12 offen offset:3072 nt lds
s_add_u32 s12, s12, 4096
s_mov_b32 m0, s12
s_waitcnt vmcnt(3)
buffer_load_dwordx4 v2, s[60:63], s12 offen offset:0 nt lds
s_waitcnt vmcnt(3)
buffer_load_dwordx4 v2, s[60:63], s12 offen offset:1024 nt lds
s_waitcnt vmcnt(3)
buffer_load_dwordx4 v2, s[60:63], s12 offen offset:2048 nt lds
s_waitcnt vmcnt(3)
buffer_load_dwordx4 v2, s[60:63], s12 offen offset:3072 nt lds
s_add_u32 s12, s12, 4096
s_mov_b32 m0, s12
s_waitcnt vmcnt(3)
buffer_load_dwordx4 v2, s[60:63], s12 offen offset:0 nt lds
s_waitcnt vmcnt(3)
buffer_load_dwordx4 v2, s[60:63], s12 offen offset:1024 nt lds
s_waitcnt vmcnt(3)
buffer_load_dwordx4 v2, s[60:63], s12 offen offset:2048 nt lds
s_waitcnt vmcnt(3)
buffer_load_dwordx4 v2, s[60:63], s12 offen offset:3072 nt lds
s_add_u32 s12, s12, 4096
s_mov_b32 m0, s12
s_waitcnt vmcnt(3)
buffer_load_dwordx4 v2, s[60:63], s12 offen offset:0 nt lds
s_waitcnt vmcnt(3)
buffer_load_dwordx4 v2, s[60:63], s12 offen offset:1024 nt lds
s_waitcnt vmcnt(3)
buffer_load_dwordx4 v2, s[60:63], s12 offen offset:2048 nt lds
s_waitcnt vmcnt(3)
buffer_load_dwordx4 v2, s[60:63], s12 offen offset:3072 nt lds
s_add_u32 s12, s12, 4096
s_mov_b32 m0, s12
s_waitcnt vmcnt(3)
buffer_load_dwordx4 v2, s[60:63], s12 offen offset:0 nt lds
s_waitcnt vmcnt(3)
buffer_load_dwordx4 v2, s[60:63], s12 offen offset:1024 nt lds
s_waitcnt vmcnt(3)
buffer_load_dwordx4 v2, s[60:63], s12 offen offset:2048 nt lds
s_waitcnt vmcnt(3)
buffer_load_dwordx4 v2, s[60:63], s12 offen offset:3072 nt lds
s_add_u32 s12, s12, 4096
s_mov_b32 m0, s12
s_waitcnt vmcnt(3)
buffer_load_dwordx4 v2, s[60:63], s12 offen offset:0 nt lds
s_waitcnt vmcnt(3)
buffer_load_dwordx4 v2, s[60:63], s12 offen offset:1024 nt lds
s_waitcnt vmcnt(3)
buffer_load_dwordx4 v2, s[60:63], s12 offen offset:2048 nt lds
s_waitcnt vmcnt(3)
buffer_load_dwordx4 v2, s[60:63], s12 offen offset:3072 nt lds
v_lshlrev_b32 v238, 18, v9
v_lshl_add_u32 v238, v8, 4, v238
s_mov_b32 s6, 0
s_waitcnt vmcnt(3)
buffer_load_dwordx4 v[88:91], v238, s[52:55], s6 offen nt
s_mov_b32 s6, 8192
s_waitcnt vmcnt(3)
buffer_load_dwordx4 v[92:95], v238, s[52:55], s6 offen nt
s_mov_b32 s6, 16384
s_waitcnt vmcnt(3)
buffer_load_dwordx4 v[96:99], v238, s[52:55], s6 offen nt
s_mov_b32 s6, 24576
s_waitcnt vmcnt(3)
buffer_load_dwordx4 v[100:103], v238, s[52:55], s6 offen nt
s_mov_b32 s6, 32768
s_waitcnt vmcnt(3)
buffer_load_dwordx4 v[104:107], v238, s[52:55], s6 offen nt
s_mov_b32 s6, 40960
s_waitcnt vmcnt(3)
buffer_load_dwordx4 v[108:111], v238, s[52:55], s6 offen nt
s_mov_b32 s6, 49152
s_waitcnt vmcnt(3)
buffer_load_dwordx4 v[112:115], v238, s[52:55], s6 offen nt
s_mov_b32 s6, 57344
s_waitcnt vmcnt(3)
buffer_load_dwordx4 v[116:119], v238, s[52:55], s6 offen nt
s_mov_b32 s6, 65536
s_waitcnt vmcnt(3)
buffer_load_dwordx4 v[120:123], v238, s[52:55], s6 offen nt
s_mov_b32 s6, 73728
s_waitcnt vmcnt(3)
buffer_load_dwordx4 v[124:127], v238, s[52:55], s6 offen nt
s_mov_b32 s6, 81920
s_waitcnt vmcnt(3)
buffer_load_dwordx4 v[128:131], v238, s[52:55], s6 offen nt
s_mov_b32 s6, 90112
s_waitcnt vmcnt(3)
buffer_load_dwordx4 v[132:135], v238, s[52:55], s6 offen nt
s_mov_b32 s6, 98304
s_waitcnt vmcnt(3)
buffer_load_dwordx4 v[136:139], v238, s[52:55], s6 offen nt
s_mov_b32 s6, 106496
s_waitcnt vmcnt(3)
buffer_load_dwordx4 v[140:143], v238, s[52:55], s6 offen nt
s_mov_b32 s6, 114688
s_waitcnt vmcnt(3)
buffer_load_dwordx4 v[144:147], v238, s[52:55], s6 offen nt
s_mov_b32 s6, 122880
s_waitcnt vmcnt(3)
buffer_load_dwordx4 v[148:151], v238, s[52:55], s6 offen nt
s_mov_b32 s6, 131072
s_waitcnt vmcnt(3)
buffer_load_dwordx4 v[152:155], v238, s[52:55], s6 offen nt
s_mov_b32 s6, 139264
s_waitcnt vmcnt(3)
buffer_load_dwordx4 v[156:159], v238, s[52:55], s6 offen nt
s_mov_b32 s6, 147456
s_waitcnt vmcnt(3)
buffer_load_dwordx4 v[160:163], v238, s[52:55], s6 offen nt
s_mov_b32 s6, 155648
s_waitcnt vmcnt(3)
buffer_load_dwordx4 v[164:167], v238, s[52:55], s6 offen nt
s_mov_b32 s6, 163840
s_waitcnt vmcnt(3)
buffer_load_dwordx4 v[168:171], v238, s[52:55], s6 offen nt
s_mov_b32 s6, 172032
s_waitcnt vmcnt(3)
buffer_load_dwordx4 v[172:175], v238, s[52:55], s6 offen nt
s_mov_b32 s6, 180224
s_waitcnt vmcnt(3)
buffer_load_dwordx4 v[176:179], v238, s[52:55], s6 offen nt
s_mov_b32 s6, 188416
s_waitcnt vmcnt(3)
buffer_load_dwordx4 v[180:183], v238, s[52:55], s6 offen nt
s_mov_b32 s6, 196608
s_waitcnt vmcnt(3)
buffer_load_dwordx4 v[184:187], v238, s[52:55], s6 offen nt
s_mov_b32 s6, 204800
s_waitcnt vmcnt(3)
buffer_load_dwordx4 v[188:191], v238, s[52:55], s6 offen nt
s_mov_b32 s6, 212992
s_waitcnt vmcnt(3)
buffer_load_dwordx4 v[192:195], v238, s[52:55], s6 offen nt
s_mov_b32 s6, 221184
s_waitcnt vmcnt(3)
buffer_load_dwordx4 v[196:199], v238, s[52:55], s6 offen nt
s_mov_b32 s6, 229376
s_waitcnt vmcnt(3)
buffer_load_dwordx4 v[200:203], v238, s[52:55], s6 offen nt
s_mov_b32 s6, 237568
s_waitcnt vmcnt(3)
buffer_load_dwordx4 v[204:207], v238, s[52:55], s6 offen nt
s_mov_b32 s6, 245760
s_waitcnt vmcnt(3)
buffer_load_dwordx4 v[208:211], v238, s[52:55], s6 offen nt
s_mov_b32 s6, 253952
s_waitcnt vmcnt(3)
buffer_load_dwordx4 v[212:215], v238, s[52:55], s6 offen nt
v_mov_b32 v11, 163824
v_mov_b32 v7, 0
ds_write_b32 v11, v7
s_waitcnt lgkmcnt(0)
s_barrier
ds_read_b64_tr_b16 a[96:97], v240 offset:0
ds_read_b64_tr_b16 a[98:99], v240 offset:4608
ds_read_b64_tr_b16 a[100:101], v240 offset:36864
ds_read_b64_tr_b16 a[102:103], v240 offset:41472
ds_read_b64_tr_b16 a[104:105], v242 offset:0
ds_read_b64_tr_b16 a[106:107], v242 offset:4608
ds_read_b64_tr_b16 a[108:109], v242 offset:36864
ds_read_b64_tr_b16 a[110:111], v242 offset:41472
ds_read_b64_tr_b16 a[112:113], v240 offset:8
ds_read_b64_tr_b16 a[114:115], v240 offset:4616
ds_read_b64_tr_b16 a[116:117], v240 offset:36872
ds_read_b64_tr_b16 a[118:119], v240 offset:41480
ds_read_b64_tr_b16 a[120:121], v242 offset:8
ds_read_b64_tr_b16 a[122:123], v242 offset:4616
ds_read_b64_tr_b16 a[124:125], v242 offset:36872
ds_read_b64_tr_b16 a[126:127], v242 offset:41480
ds_read_b64_tr_b16 a[128:129], v240 offset:16
ds_read_b64_tr_b16 a[130:131], v240 offset:4624
ds_read_b64_tr_b16 a[132:133], v240 offset:36880
ds_read_b64_tr_b16 a[134:135], v240 offset:41488
ds_read_b64_tr_b16 a[136:137], v242 offset:16
ds_read_b64_tr_b16 a[138:139], v242 offset:4624
ds_read_b64_tr_b16 a[140:141], v242 offset:36880
ds_read_b64_tr_b16 a[142:143], v242 offset:41488
ds_read_b64_tr_b16 a[144:145], v240 offset:24
ds_read_b64_tr_b16 a[146:147], v240 offset:4632
ds_read_b64_tr_b16 a[148:149], v240 offset:36888
ds_read_b64_tr_b16 a[150:151], v240 offset:41496
ds_read_b64_tr_b16 a[152:153], v242 offset:24
ds_read_b64_tr_b16 a[154:155], v242 offset:4632
ds_read_b64_tr_b16 a[156:157], v242 offset:36888
ds_read_b64_tr_b16 a[158:159], v242 offset:41496
ds_read_b64_tr_b16 a[160:161], v240 offset:128
ds_read_b64_tr_b16 a[162:163], v240 offset:4736
ds_read_b64_tr_b16 a[164:165], v240 offset:36992
ds_read_b64_tr_b16 a[166:167], v240 offset:41600
ds_read_b64_tr_b16 a[168:169], v242 offset:128
ds_read_b64_tr_b16 a[170:171], v242 offset:4736
ds_read_b64_tr_b16 a[172:173], v242 offset:36992
ds_read_b64_tr_b16 a[174:175], v242 offset:41600
ds_read_b64_tr_b16 a[176:177], v240 offset:136
ds_read_b64_tr_b16 a[178:179], v240 offset:4744
ds_read_b64_tr_b16 a[180:181], v240 offset:37000
ds_read_b64_tr_b16 a[182:183], v240 offset:41608
ds_read_b64_tr_b16 a[184:185], v242 offset:136
ds_read_b64_tr_b16 a[186:187], v242 offset:4744
ds_read_b64_tr_b16 a[188:189], v242 offset:37000
ds_read_b64_tr_b16 a[190:191], v242 offset:41608
ds_read_b64_tr_b16 a[192:193], v240 offset:144
ds_read_b64_tr_b16 a[194:195], v240 offset:4752
ds_read_b64_tr_b16 a[196:197], v240 offset:37008
ds_read_b64_tr_b16 a[198:199], v240 offset:41616
ds_read_b64_tr_b16 a[200:201], v242 offset:144
ds_read_b64_tr_b16 a[202:203], v242 offset:4752
ds_read_b64_tr_b16 a[204:205], v242 offset:37008
ds_read_b64_tr_b16 a[206:207], v242 offset:41616
ds_read_b64_tr_b16 a[208:209], v240 offset:152
ds_read_b64_tr_b16 a[210:211], v240 offset:4760
ds_read_b64_tr_b16 a[212:213], v240 offset:37016
ds_read_b64_tr_b16 a[214:215], v240 offset:41624
ds_read_b64_tr_b16 a[216:217], v242 offset:152
ds_read_b64_tr_b16 a[218:219], v242 offset:4760
ds_read_b64_tr_b16 a[220:221], v242 offset:37016
ds_read_b64_tr_b16 a[222:223], v242 offset:41624
ds_read_b64_tr_b16 a[224:225], v241 offset:0
ds_read_b64_tr_b16 a[226:227], v241 offset:4608
ds_read_b64_tr_b16 a[228:229], v241 offset:36864
ds_read_b64_tr_b16 a[230:231], v241 offset:41472
ds_read_b64_tr_b16 a[232:233], v243 offset:0
ds_read_b64_tr_b16 a[234:235], v243 offset:4608
ds_read_b64_tr_b16 a[236:237], v243 offset:36864
ds_read_b64_tr_b16 a[238:239], v243 offset:41472
v_and_b32 v6, 7, v1
v_mul_u32_u24 v6, 8, v6
s_lshl_b32 s6, s4, 8
s_mul_i32 s7, s3, 64
s_add_u32 s6, s6, s7
s_add_u32 s15, s6, 262144
s_mov_b32 s7, 400000
P_poll:
buffer_load_dwordx2 v[232:233], v6, s[64:67], s15 offen sc1
s_waitcnt vmcnt(0)
v_max_u32 v234, v232, v233
v_cmp_eq_u32 vcc, -1, v234
s_cbranch_vccz P_ok
s_sleep 16
s_sub_u32 s7, s7, 1
s_cmp_lg_u32 s7, 0
s_cbranch_scc1 P_poll
P_ok:
s_lshr_b32 s6, s4, 3
s_mul_i32 s6, s6, 524288
s_bitcmp1_b32 s4, 0
s_cselect_b32 s7, 98304, 0
s_add_u32 s6, s6, s7
s_bitcmp1_b32 s4, 1
s_cselect_b32 s7, 131072, 0
s_add_u32 s6, s6, s7
s_bitcmp1_b32 s4, 2
s_cselect_b32 s7, 262144, 0
s_add_u32 s6, s6, s7
s_lshl_b32 s7, s3, 13
s_add_u32 s6, s6, s7
s_add_u32 s6, s6, 2097152
buffer_load_dwordx4 v[24:27], v2, s[64:67], s6 offen offset:0 sc1
buffer_load_dwordx4 v[28:31], v2, s[64:67], s6 offen offset:1024 sc1
buffer_load_dwordx4 v[32:35], v2, s[64:67], s6 offen offset:2048 sc1
buffer_load_dwordx4 v[36:39], v2, s[64:67], s6 offen offset:3072 sc1
s_add_u32 s6, s6, 4096
buffer_load_dwordx4 v[40:43], v2, s[64:67], s6 offen offset:0 sc1
buffer_load_dwordx4 v[44:47], v2, s[64:67], s6 offen offset:1024 sc1
buffer_load_dwordx4 v[48:51], v2, s[64:67], s6 offen offset:2048 sc1
buffer_load_dwordx4 v[52:55], v2, s[64:67], s6 offen offset:3072 sc1
v_mov_b32 v234, v232
s_nop 1
v_max_f32_dpp v234, v234, v234 row_ror:4 row_mask:0xf bank_mask:0xf
s_nop 1
v_max_f32_dpp v234, v234, v234 row_ror:2 row_mask:0xf bank_mask:0xf
s_nop 1
v_max_f32_dpp v234, v234, v234 row_ror:1 row_mask:0xf bank_mask:0xf
v_sub_f32 v232, v232, v234
v_exp_f32 v232, v232
s_nop 0
v_mul_f32 v235, v232, v233
s_nop 1
v_add_f32_dpp v235, v235, v235 row_ror:4 row_mask:0xf bank_mask:0xf
s_nop 1
v_add_f32_dpp v235, v235, v235 row_ror:2 row_mask:0xf bank_mask:0xf
s_nop 1
v_add_f32_dpp v235, v235, v235 row_ror:1 row_mask:0xf bank_mask:0xf
v_rcp_f32 v235, v235
s_nop 0
v_mul_f32 v232, v232, v235
s_nop 0
v_readlane_b32 s26, v232, 0
v_readlane_b32 s27, v232, 1
v_readlane_b32 s28, v232, 2
v_readlane_b32 s29, v232, 3
v_readlane_b32 s30, v232, 4
v_readlane_b32 s31, v232, 5
v_readlane_b32 s32, v232, 6
v_readlane_b32 s33, v232, 7
s_mul_i32 s6, s3, 1040
s_add_u32 s6, s6, 147456
v_add_u32 v5, s6, v2
v_lshrrev_b32 v6, 3, v8
v_mul_u32_u24 v6, 1040, v6
v_lshl_add_u32 v6, v9, 6, v6
s_lshl_b32 s6, s3, 8
s_add_u32 s6, s6, 147456
v_add_u32 v6, s6, v6
s_waitcnt vmcnt(7)
v_lshlrev_b32 v244, 16, v24
v_and_b32 v245, 0xffff0000, v24
v_lshlrev_b32 v246, 16, v25
v_and_b32 v247, 0xffff0000, v25
v_lshlrev_b32 v248, 16, v26
v_and_b32 v249, 0xffff0000, v26
v_lshlrev_b32 v250, 16, v27
v_and_b32 v251, 0xffff0000, v27
v_mul_f32 v216, s26, v244
v_mul_f32 v217, s26, v245
v_mul_f32 v218, s26, v246
v_mul_f32 v219, s26, v247
v_mul_f32 v220, s26, v248
v_mul_f32 v221, s26, v249
v_mul_f32 v222, s26, v250
v_mul_f32 v223, s26, v251
s_waitcnt vmcnt(6)
v_lshlrev_b32 v244, 16, v28
v_and_b32 v245, 0xffff0000, v28
v_lshlrev_b32 v246, 16, v29
v_and_b32 v247, 0xffff0000, v29
v_lshlrev_b32 v248, 16, v30
v_and_b32 v249, 0xffff0000, v30
v_lshlrev_b32 v250, 16, v31
v_and_b32 v251, 0xffff0000, v31
v_fma_f32 v216, v244, s27, v216
v_fma_f32 v217, v245, s27, v217
v_fma_f32 v218, v246, s27, v218
v_fma_f32 v219, v247, s27, v219
v_fma_f32 v220, v248, s27, v220
v_fma_f32 v221, v249, s27, v221
v_fma_f32 v222, v250, s27, v222
v_fma_f32 v223, v251, s27, v223
s_waitcnt vmcnt(5)
v_lshlrev_b32 v244, 16, v32
v_and_b32 v245, 0xffff0000, v32
v_lshlrev_b32 v246, 16, v33
v_and_b32 v247, 0xffff0000, v33
v_lshlrev_b32 v248, 16, v34
v_and_b32 v249, 0xffff0000, v34
v_lshlrev_b32 v250, 16, v35
v_and_b32 v251, 0xffff0000, v35
v_fma_f32 v216, v244, s28, v216
v_fma_f32 v217, v245, s28, v217
v_fma_f32 v218, v246, s28, v218
v_fma_f32 v219, v247, s28, v219
v_fma_f32 v220, v248, s28, v220
v_fma_f32 v221, v249, s28, v221
v_fma_f32 v222, v250, s28, v222
v_fma_f32 v223, v251, s28, v223
s_waitcnt vmcnt(4)
v_lshlrev_b32 v244, 16, v36
v_and_b32 v245, 0xffff0000, v36
v_lshlrev_b32 v246, 16, v37
v_and_b32 v247, 0xffff0000, v37
v_lshlrev_b32 v248, 16, v38
v_and_b32 v249, 0xffff0000, v38
v_lshlrev_b32 v250, 16, v39
v_and_b32 v251, 0xffff0000, v39
v_fma_f32 v216, v244, s29, v216
v_fma_f32 v217, v245, s29, v217
v_fma_f32 v218, v246, s29, v218
v_fma_f32 v219, v247, s29, v219
v_fma_f32 v220, v248, s29, v220
v_fma_f32 v221, v249, s29, v221
v_fma_f32 v222, v250, s29, v222
v_fma_f32 v223, v251, s29, v223
s_waitcnt vmcnt(3)
v_lshlrev_b32 v244, 16, v40
v_and_b32 v245, 0xffff0000, v40
v_lshlrev_b32 v246, 16, v41
v_and_b32 v247, 0xffff0000, v41
v_lshlrev_b32 v248, 16, v42
v_and_b32 v249, 0xffff0000, v42
v_lshlrev_b32 v250, 16, v43
v_and_b32 v251, 0xffff0000, v43
v_fma_f32 v216, v244, s30, v216
v_fma_f32 v217, v245, s30, v217
v_fma_f32 v218, v246, s30, v218
v_fma_f32 v219, v247, s30, v219
v_fma_f32 v220, v248, s30, v220
v_fma_f32 v221, v249, s30, v221
v_fma_f32 v222, v250, s30, v222
v_fma_f32 v223, v251, s30, v223
s_waitcnt vmcnt(2)
v_lshlrev_b32 v244, 16, v44
v_and_b32 v245, 0xffff0000, v44
v_lshlrev_b32 v246, 16, v45
v_and_b32 v247, 0xffff0000, v45
v_lshlrev_b32 v248, 16, v46
v_and_b32 v249, 0xffff0000, v46
v_lshlrev_b32 v250, 16, v47
v_and_b32 v251, 0xffff0000, v47
v_fma_f32 v216, v244, s31, v216
v_fma_f32 v217, v245, s31, v217
v_fma_f32 v218, v246, s31, v218
v_fma_f32 v219, v247, s31, v219
v_fma_f32 v220, v248, s31, v220
v_fma_f32 v221, v249, s31, v221
v_fma_f32 v222, v250, s31, v222
v_fma_f32 v223, v251, s31, v223
s_waitcnt vmcnt(1)
v_lshlrev_b32 v244, 16, v48
v_and_b32 v245, 0xffff0000, v48
v_lshlrev_b32 v246, 16, v49
v_and_b32 v247, 0xffff0000, v49
v_lshlrev_b32 v248, 16, v50
v_and_b32 v249, 0xffff0000, v50
v_lshlrev_b32 v250, 16, v51
v_and_b32 v251, 0xffff0000, v51
v_fma_f32 v216, v244, s32, v216
v_fma_f32 v217, v245, s32, v217
v_fma_f32 v218, v246, s32, v218
v_fma_f32 v219, v247, s32, v219
v_fma_f32 v220, v248, s32, v220
v_fma_f32 v221, v249, s32, v221
v_fma_f32 v222, v250, s32, v222
v_fma_f32 v223, v251, s32, v223
s_waitcnt vmcnt(0)
v_lshlrev_b32 v244, 16, v52
v_and_b32 v245, 0xffff0000, v52
v_lshlrev_b32 v246, 16, v53
v_and_b32 v247, 0xffff0000, v53
v_lshlrev_b32 v248, 16, v54
v_and_b32 v249, 0xffff0000, v54
v_lshlrev_b32 v250, 16, v55
v_and_b32 v251, 0xffff0000, v55
v_fma_f32 v216, v244, s33, v216
v_fma_f32 v217, v245, s33, v217
v_fma_f32 v218, v246, s33, v218
v_fma_f32 v219, v247, s33, v219
v_fma_f32 v220, v248, s33, v220
v_fma_f32 v221, v249, s33, v221
v_fma_f32 v222, v250, s33, v222
v_fma_f32 v223, v251, s33, v223
v_cvt_pk_bf16_f32 v224, v216, v217
v_cvt_pk_bf16_f32 v225, v218, v219
v_cvt_pk_bf16_f32 v226, v220, v221
v_cvt_pk_bf16_f32 v227, v222, v223
ds_write_b128 v5, v[224:227]
s_waitcnt lgkmcnt(0)
s_barrier
ds_read_b128 v[24:27], v6 offset:0
ds_read_b128 v[44:47], v6 offset:2080
ds_read_b128 v[28:31], v6 offset:16
ds_read_b128 v[48:51], v6 offset:2096
ds_read_b128 v[32:35], v6 offset:32
ds_read_b128 v[52:55], v6 offset:2112
ds_read_b128 v[36:39], v6 offset:48
ds_read_b128 v[56:59], v6 offset:2128
v_lshrrev_b32 v5, 5, v1
v_mul_u32_u24 v5, 1088, v5
v_lshl_add_u32 v5, v8, 4, v5
v_and_b32 v7, 1, v9
v_lshl_add_u32 v5, v7, 3, v5
s_mul_i32 s6, s3, 272
s_add_u32 s6, s6, 155648
v_add_u32 v5, s6, v5
v_mul_u32_u24 v7, 272, v8
v_lshl_add_u32 v7, v9, 4, v7
v_add_u32 v7, 155648, v7
s_waitcnt lgkmcnt(0)
v_perm_b32 v64, v24, v24, v16
v_perm_b32 v65, v24, v24, v17
v_perm_b32 v66, v24, v24, v18
v_perm_b32 v67, v24, v24, v19
s_nop 1
v_mfma_f32_16x16x32_bf16 v[80:83], v[64:67], v[88:91], 0
v_perm_b32 v68, v44, v44, v16
v_perm_b32 v69, v44, v44, v17
v_perm_b32 v70, v44, v44, v18
v_perm_b32 v71, v44, v44, v19
s_nop 1
v_mfma_f32_16x16x32_bf16 v[84:87], v[68:71], v[88:91], 0
v_perm_b32 v72, v24, v24, v20
v_perm_b32 v73, v24, v24, v21
v_perm_b32 v74, v24, v24, v22
v_perm_b32 v75, v24, v24, v23
s_nop 1
v_mfma_f32_16x16x32_bf16 v[80:83], v[72:75], v[92:95], v[80:83]
v_perm_b32 v76, v44, v44, v20
v_perm_b32 v77, v44, v44, v21
v_perm_b32 v78, v44, v44, v22
v_perm_b32 v79, v44, v44, v23
s_nop 1
v_mfma_f32_16x16x32_bf16 v[84:87], v[76:79], v[92:95], v[84:87]
v_perm_b32 v64, v25, v25, v16
v_perm_b32 v65, v25, v25, v17
v_perm_b32 v66, v25, v25, v18
v_perm_b32 v67, v25, v25, v19
s_nop 1
v_mfma_f32_16x16x32_bf16 v[80:83], v[64:67], v[96:99], v[80:83]
v_perm_b32 v68, v45, v45, v16
v_perm_b32 v69, v45, v45, v17
v_perm_b32 v70, v45, v45, v18
v_perm_b32 v71, v45, v45, v19
s_nop 1
v_mfma_f32_16x16x32_bf16 v[84:87], v[68:71], v[96:99], v[84:87]
v_perm_b32 v72, v25, v25, v20
v_perm_b32 v73, v25, v25, v21
v_perm_b32 v74, v25, v25, v22
v_perm_b32 v75, v25, v25, v23
s_nop 1
v_mfma_f32_16x16x32_bf16 v[80:83], v[72:75], v[100:103], v[80:83]
v_perm_b32 v76, v45, v45, v20
v_perm_b32 v77, v45, v45, v21
v_perm_b32 v78, v45, v45, v22
v_perm_b32 v79, v45, v45, v23
s_nop 1
v_mfma_f32_16x16x32_bf16 v[84:87], v[76:79], v[100:103], v[84:87]
v_perm_b32 v64, v26, v26, v16
v_perm_b32 v65, v26, v26, v17
v_perm_b32 v66, v26, v26, v18
v_perm_b32 v67, v26, v26, v19
s_nop 1
v_mfma_f32_16x16x32_bf16 v[80:83], v[64:67], v[104:107], v[80:83]
v_perm_b32 v68, v46, v46, v16
v_perm_b32 v69, v46, v46, v17
v_perm_b32 v70, v46, v46, v18
v_perm_b32 v71, v46, v46, v19
s_nop 1
v_mfma_f32_16x16x32_bf16 v[84:87], v[68:71], v[104:107], v[84:87]
v_perm_b32 v72, v26, v26, v20
v_perm_b32 v73, v26, v26, v21
v_perm_b32 v74, v26, v26, v22
v_perm_b32 v75, v26, v26, v23
s_nop 1
v_mfma_f32_16x16x32_bf16 v[80:83], v[72:75], v[108:111], v[80:83]
v_perm_b32 v76, v46, v46, v20
v_perm_b32 v77, v46, v46, v21
v_perm_b32 v78, v46, v46, v22
v_perm_b32 v79, v46, v46, v23
s_nop 1
v_mfma_f32_16x16x32_bf16 v[84:87], v[76:79], v[108:111], v[84:87]
v_perm_b32 v64, v27, v27, v16
v_perm_b32 v65, v27, v27, v17
v_perm_b32 v66, v27, v27, v18
v_perm_b32 v67, v27, v27, v19
s_nop 1
v_mfma_f32_16x16x32_bf16 v[80:83], v[64:67], v[112:115], v[80:83]
v_perm_b32 v68, v47, v47, v16
v_perm_b32 v69, v47, v47, v17
v_perm_b32 v70, v47, v47, v18
v_perm_b32 v71, v47, v47, v19
s_nop 1
v_mfma_f32_16x16x32_bf16 v[84:87], v[68:71], v[112:115], v[84:87]
v_perm_b32 v72, v27, v27, v20
v_perm_b32 v73, v27, v27, v21
v_perm_b32 v74, v27, v27, v22
v_perm_b32 v75, v27, v27, v23
s_nop 1
v_mfma_f32_16x16x32_bf16 v[80:83], v[72:75], v[116:119], v[80:83]
v_perm_b32 v76, v47, v47, v20
v_perm_b32 v77, v47, v47, v21
v_perm_b32 v78, v47, v47, v22
v_perm_b32 v79, v47, v47, v23
s_nop 1
v_mfma_f32_16x16x32_bf16 v[84:87], v[76:79], v[116:119], v[84:87]
v_perm_b32 v64, v28, v28, v16
v_perm_b32 v65, v28, v28, v17
v_perm_b32 v66, v28, v28, v18
v_perm_b32 v67, v28, v28, v19
s_nop 1
v_mfma_f32_16x16x32_bf16 v[80:83], v[64:67], v[120:123], v[80:83]
v_perm_b32 v68, v48, v48, v16
v_perm_b32 v69, v48, v48, v17
v_perm_b32 v70, v48, v48, v18
v_perm_b32 v71, v48, v48, v19
s_nop 1
v_mfma_f32_16x16x32_bf16 v[84:87], v[68:71], v[120:123], v[84:87]
v_perm_b32 v72, v28, v28, v20
v_perm_b32 v73, v28, v28, v21
v_perm_b32 v74, v28, v28, v22
v_perm_b32 v75, v28, v28, v23
s_nop 1
v_mfma_f32_16x16x32_bf16 v[80:83], v[72:75], v[124:127], v[80:83]
v_perm_b32 v76, v48, v48, v20
v_perm_b32 v77, v48, v48, v21
v_perm_b32 v78, v48, v48, v22
v_perm_b32 v79, v48, v48, v23
s_nop 1
v_mfma_f32_16x16x32_bf16 v[84:87], v[76:79], v[124:127], v[84:87]
v_perm_b32 v64, v29, v29, v16
v_perm_b32 v65, v29, v29, v17
v_perm_b32 v66, v29, v29, v18
v_perm_b32 v67, v29, v29, v19
s_nop 1
v_mfma_f32_16x16x32_bf16 v[80:83], v[64:67], v[128:131], v[80:83]
v_perm_b32 v68, v49, v49, v16
v_perm_b32 v69, v49, v49, v17
v_perm_b32 v70, v49, v49, v18
v_perm_b32 v71, v49, v49, v19
s_nop 1
v_mfma_f32_16x16x32_bf16 v[84:87], v[68:71], v[128:131], v[84:87]
v_perm_b32 v72, v29, v29, v20
v_perm_b32 v73, v29, v29, v21
v_perm_b32 v74, v29, v29, v22
v_perm_b32 v75, v29, v29, v23
s_nop 1
v_mfma_f32_16x16x32_bf16 v[80:83], v[72:75], v[132:135], v[80:83]
v_perm_b32 v76, v49, v49, v20
v_perm_b32 v77, v49, v49, v21
v_perm_b32 v78, v49, v49, v22
v_perm_b32 v79, v49, v49, v23
s_nop 1
v_mfma_f32_16x16x32_bf16 v[84:87], v[76:79], v[132:135], v[84:87]
v_perm_b32 v64, v30, v30, v16
v_perm_b32 v65, v30, v30, v17
v_perm_b32 v66, v30, v30, v18
v_perm_b32 v67, v30, v30, v19
s_nop 1
v_mfma_f32_16x16x32_bf16 v[80:83], v[64:67], v[136:139], v[80:83]
v_perm_b32 v68, v50, v50, v16
v_perm_b32 v69, v50, v50, v17
v_perm_b32 v70, v50, v50, v18
v_perm_b32 v71, v50, v50, v19
s_nop 1
v_mfma_f32_16x16x32_bf16 v[84:87], v[68:71], v[136:139], v[84:87]
v_perm_b32 v72, v30, v30, v20
v_perm_b32 v73, v30, v30, v21
v_perm_b32 v74, v30, v30, v22
v_perm_b32 v75, v30, v30, v23
s_nop 1
v_mfma_f32_16x16x32_bf16 v[80:83], v[72:75], v[140:143], v[80:83]
v_perm_b32 v76, v50, v50, v20
v_perm_b32 v77, v50, v50, v21
v_perm_b32 v78, v50, v50, v22
v_perm_b32 v79, v50, v50, v23
s_nop 1
v_mfma_f32_16x16x32_bf16 v[84:87], v[76:79], v[140:143], v[84:87]
v_perm_b32 v64, v31, v31, v16
v_perm_b32 v65, v31, v31, v17
v_perm_b32 v66, v31, v31, v18
v_perm_b32 v67, v31, v31, v19
s_nop 1
v_mfma_f32_16x16x32_bf16 v[80:83], v[64:67], v[144:147], v[80:83]
v_perm_b32 v68, v51, v51, v16
v_perm_b32 v69, v51, v51, v17
v_perm_b32 v70, v51, v51, v18
v_perm_b32 v71, v51, v51, v19
s_nop 1
v_mfma_f32_16x16x32_bf16 v[84:87], v[68:71], v[144:147], v[84:87]
v_perm_b32 v72, v31, v31, v20
v_perm_b32 v73, v31, v31, v21
v_perm_b32 v74, v31, v31, v22
v_perm_b32 v75, v31, v31, v23
s_nop 1
v_mfma_f32_16x16x32_bf16 v[80:83], v[72:75], v[148:151], v[80:83]
v_perm_b32 v76, v51, v51, v20
v_perm_b32 v77, v51, v51, v21
v_perm_b32 v78, v51, v51, v22
v_perm_b32 v79, v51, v51, v23
s_nop 1
v_mfma_f32_16x16x32_bf16 v[84:87], v[76:79], v[148:151], v[84:87]
v_perm_b32 v64, v32, v32, v16
v_perm_b32 v65, v32, v32, v17
v_perm_b32 v66, v32, v32, v18
v_perm_b32 v67, v32, v32, v19
s_nop 1
v_mfma_f32_16x16x32_bf16 v[80:83], v[64:67], v[152:155], v[80:83]
v_perm_b32 v68, v52, v52, v16
v_perm_b32 v69, v52, v52, v17
v_perm_b32 v70, v52, v52, v18
v_perm_b32 v71, v52, v52, v19
s_nop 1
v_mfma_f32_16x16x32_bf16 v[84:87], v[68:71], v[152:155], v[84:87]
v_perm_b32 v72, v32, v32, v20
v_perm_b32 v73, v32, v32, v21
v_perm_b32 v74, v32, v32, v22
v_perm_b32 v75, v32, v32, v23
s_nop 1
v_mfma_f32_16x16x32_bf16 v[80:83], v[72:75], v[156:159], v[80:83]
v_perm_b32 v76, v52, v52, v20
v_perm_b32 v77, v52, v52, v21
v_perm_b32 v78, v52, v52, v22
v_perm_b32 v79, v52, v52, v23
s_nop 1
v_mfma_f32_16x16x32_bf16 v[84:87], v[76:79], v[156:159], v[84:87]
v_perm_b32 v64, v33, v33, v16
v_perm_b32 v65, v33, v33, v17
v_perm_b32 v66, v33, v33, v18
v_perm_b32 v67, v33, v33, v19
s_nop 1
v_mfma_f32_16x16x32_bf16 v[80:83], v[64:67], v[160:163], v[80:83]
v_perm_b32 v68, v53, v53, v16
v_perm_b32 v69, v53, v53, v17
v_perm_b32 v70, v53, v53, v18
v_perm_b32 v71, v53, v53, v19
s_nop 1
v_mfma_f32_16x16x32_bf16 v[84:87], v[68:71], v[160:163], v[84:87]
v_perm_b32 v72, v33, v33, v20
v_perm_b32 v73, v33, v33, v21
v_perm_b32 v74, v33, v33, v22
v_perm_b32 v75, v33, v33, v23
s_nop 1
v_mfma_f32_16x16x32_bf16 v[80:83], v[72:75], v[164:167], v[80:83]
v_perm_b32 v76, v53, v53, v20
v_perm_b32 v77, v53, v53, v21
v_perm_b32 v78, v53, v53, v22
v_perm_b32 v79, v53, v53, v23
s_nop 1
v_mfma_f32_16x16x32_bf16 v[84:87], v[76:79], v[164:167], v[84:87]
v_perm_b32 v64, v34, v34, v16
v_perm_b32 v65, v34, v34, v17
v_perm_b32 v66, v34, v34, v18
v_perm_b32 v67, v34, v34, v19
s_nop 1
v_mfma_f32_16x16x32_bf16 v[80:83], v[64:67], v[168:171], v[80:83]
v_perm_b32 v68, v54, v54, v16
v_perm_b32 v69, v54, v54, v17
v_perm_b32 v70, v54, v54, v18
v_perm_b32 v71, v54, v54, v19
s_nop 1
v_mfma_f32_16x16x32_bf16 v[84:87], v[68:71], v[168:171], v[84:87]
v_perm_b32 v72, v34, v34, v20
v_perm_b32 v73, v34, v34, v21
v_perm_b32 v74, v34, v34, v22
v_perm_b32 v75, v34, v34, v23
s_nop 1
v_mfma_f32_16x16x32_bf16 v[80:83], v[72:75], v[172:175], v[80:83]
v_perm_b32 v76, v54, v54, v20
v_perm_b32 v77, v54, v54, v21
v_perm_b32 v78, v54, v54, v22
v_perm_b32 v79, v54, v54, v23
s_nop 1
v_mfma_f32_16x16x32_bf16 v[84:87], v[76:79], v[172:175], v[84:87]
v_perm_b32 v64, v35, v35, v16
v_perm_b32 v65, v35, v35, v17
v_perm_b32 v66, v35, v35, v18
v_perm_b32 v67, v35, v35, v19
s_nop 1
v_mfma_f32_16x16x32_bf16 v[80:83], v[64:67], v[176:179], v[80:83]
v_perm_b32 v68, v55, v55, v16
v_perm_b32 v69, v55, v55, v17
v_perm_b32 v70, v55, v55, v18
v_perm_b32 v71, v55, v55, v19
s_nop 1
v_mfma_f32_16x16x32_bf16 v[84:87], v[68:71], v[176:179], v[84:87]
v_perm_b32 v72, v35, v35, v20
v_perm_b32 v73, v35, v35, v21
v_perm_b32 v74, v35, v35, v22
v_perm_b32 v75, v35, v35, v23
s_nop 1
v_mfma_f32_16x16x32_bf16 v[80:83], v[72:75], v[180:183], v[80:83]
v_perm_b32 v76, v55, v55, v20
v_perm_b32 v77, v55, v55, v21
v_perm_b32 v78, v55, v55, v22
v_perm_b32 v79, v55, v55, v23
s_nop 1
v_mfma_f32_16x16x32_bf16 v[84:87], v[76:79], v[180:183], v[84:87]
v_perm_b32 v64, v36, v36, v16
v_perm_b32 v65, v36, v36, v17
v_perm_b32 v66, v36, v36, v18
v_perm_b32 v67, v36, v36, v19
s_nop 1
v_mfma_f32_16x16x32_bf16 v[80:83], v[64:67], v[184:187], v[80:83]
v_perm_b32 v68, v56, v56, v16
v_perm_b32 v69, v56, v56, v17
v_perm_b32 v70, v56, v56, v18
v_perm_b32 v71, v56, v56, v19
s_nop 1
v_mfma_f32_16x16x32_bf16 v[84:87], v[68:71], v[184:187], v[84:87]
v_perm_b32 v72, v36, v36, v20
v_perm_b32 v73, v36, v36, v21
v_perm_b32 v74, v36, v36, v22
v_perm_b32 v75, v36, v36, v23
s_nop 1
v_mfma_f32_16x16x32_bf16 v[80:83], v[72:75], v[188:191], v[80:83]
v_perm_b32 v76, v56, v56, v20
v_perm_b32 v77, v56, v56, v21
v_perm_b32 v78, v56, v56, v22
v_perm_b32 v79, v56, v56, v23
s_nop 1
v_mfma_f32_16x16x32_bf16 v[84:87], v[76:79], v[188:191], v[84:87]
v_perm_b32 v64, v37, v37, v16
v_perm_b32 v65, v37, v37, v17
v_perm_b32 v66, v37, v37, v18
v_perm_b32 v67, v37, v37, v19
s_nop 1
v_mfma_f32_16x16x32_bf16 v[80:83], v[64:67], v[192:195], v[80:83]
v_perm_b32 v68, v57, v57, v16
v_perm_b32 v69, v57, v57, v17
v_perm_b32 v70, v57, v57, v18
v_perm_b32 v71, v57, v57, v19
s_nop 1
v_mfma_f32_16x16x32_bf16 v[84:87], v[68:71], v[192:195], v[84:87]
v_perm_b32 v72, v37, v37, v20
v_perm_b32 v73, v37, v37, v21
v_perm_b32 v74, v37, v37, v22
v_perm_b32 v75, v37, v37, v23
s_nop 1
v_mfma_f32_16x16x32_bf16 v[80:83], v[72:75], v[196:199], v[80:83]
v_perm_b32 v76, v57, v57, v20
v_perm_b32 v77, v57, v57, v21
v_perm_b32 v78, v57, v57, v22
v_perm_b32 v79, v57, v57, v23
s_nop 1
v_mfma_f32_16x16x32_bf16 v[84:87], v[76:79], v[196:199], v[84:87]
v_perm_b32 v64, v38, v38, v16
v_perm_b32 v65, v38, v38, v17
v_perm_b32 v66, v38, v38, v18
v_perm_b32 v67, v38, v38, v19
s_nop 1
v_mfma_f32_16x16x32_bf16 v[80:83], v[64:67], v[200:203], v[80:83]
v_perm_b32 v68, v58, v58, v16
v_perm_b32 v69, v58, v58, v17
v_perm_b32 v70, v58, v58, v18
v_perm_b32 v71, v58, v58, v19
s_nop 1
v_mfma_f32_16x16x32_bf16 v[84:87], v[68:71], v[200:203], v[84:87]
v_perm_b32 v72, v38, v38, v20
v_perm_b32 v73, v38, v38, v21
v_perm_b32 v74, v38, v38, v22
v_perm_b32 v75, v38, v38, v23
s_nop 1
v_mfma_f32_16x16x32_bf16 v[80:83], v[72:75], v[204:207], v[80:83]
v_perm_b32 v76, v58, v58, v20
v_perm_b32 v77, v58, v58, v21
v_perm_b32 v78, v58, v58, v22
v_perm_b32 v79, v58, v58, v23
s_nop 1
v_mfma_f32_16x16x32_bf16 v[84:87], v[76:79], v[204:207], v[84:87]
v_perm_b32 v64, v39, v39, v16
v_perm_b32 v65, v39, v39, v17
v_perm_b32 v66, v39, v39, v18
v_perm_b32 v67, v39, v39, v19
s_nop 1
v_mfma_f32_16x16x32_bf16 v[80:83], v[64:67], v[208:211], v[80:83]
v_perm_b32 v68, v59, v59, v16
v_perm_b32 v69, v59, v59, v17
v_perm_b32 v70, v59, v59, v18
v_perm_b32 v71, v59, v59, v19
s_nop 1
v_mfma_f32_16x16x32_bf16 v[84:87], v[68:71], v[208:211], v[84:87]
v_perm_b32 v72, v39, v39, v20
v_perm_b32 v73, v39, v39, v21
v_perm_b32 v74, v39, v39, v22
v_perm_b32 v75, v39, v39, v23
s_nop 1
v_mfma_f32_16x16x32_bf16 v[80:83], v[72:75], v[212:215], v[80:83]
v_perm_b32 v76, v59, v59, v20
v_perm_b32 v77, v59, v59, v21
v_perm_b32 v78, v59, v59, v22
v_perm_b32 v79, v59, v59, v23
s_nop 1
v_mfma_f32_16x16x32_bf16 v[84:87], v[76:79], v[212:215], v[84:87]
s_nop 0
v_cvt_pk_bf16_f32 v244, v80, v81
v_cvt_pk_bf16_f32 v245, v82, v83
ds_write_b64 v5, v[244:245] offset:0
s_nop 3
v_cvt_pk_bf16_f32 v246, v84, v85
v_cvt_pk_bf16_f32 v247, v86, v87
ds_write_b64 v5, v[246:247] offset:2176
s_waitcnt lgkmcnt(0)
s_barrier
ds_read_b128 v[64:67], v7 offset:0
ds_read_b128 v[68:71], v7 offset:64
ds_read_b128 v[72:75], v7 offset:128
ds_read_b128 v[76:79], v7 offset:192
v_mul_u32_u24 v5, 36864, v9
v_lshl_add_u32 v5, v8, 4, v5
s_mul_i32 s6, s4, 1152
s_add_u32 s6, s6, 5242880
s_lshl_b32 s7, s3, 5
v_add_u32 v6, s7, v5
s_lshl_b32 s7, s3, 8
v_add_u32 v5, s7, v5
s_waitcnt lgkmcnt(0)
v_mfma_f32_16x16x32_bf16 v[24:27], v[64:67], a[96:99], 0
v_mfma_f32_16x16x32_bf16 v[24:27], v[68:71], a[100:103], v[24:27]
v_mfma_f32_16x16x32_bf16 v[24:27], v[72:75], a[104:107], v[24:27]
v_mfma_f32_16x16x32_bf16 v[24:27], v[76:79], a[108:111], v[24:27]
v_mfma_f32_16x16x32_bf16 v[28:31], v[64:67], a[112:115], 0
v_mfma_f32_16x16x32_bf16 v[28:31], v[68:71], a[116:119], v[28:31]
v_mfma_f32_16x16x32_bf16 v[28:31], v[72:75], a[120:123], v[28:31]
v_mfma_f32_16x16x32_bf16 v[28:31], v[76:79], a[124:127], v[28:31]
v_mfma_f32_16x16x32_bf16 v[32:35], v[64:67], a[128:131], 0
v_mfma_f32_16x16x32_bf16 v[32:35], v[68:71], a[132:135], v[32:35]
v_mfma_f32_16x16x32_bf16 v[32:35], v[72:75], a[136:139], v[32:35]
v_mfma_f32_16x16x32_bf16 v[32:35], v[76:79], a[140:143], v[32:35]
v_mfma_f32_16x16x32_bf16 v[36:39], v[64:67], a[144:147], 0
v_mfma_f32_16x16x32_bf16 v[36:39], v[68:71], a[148:151], v[36:39]
v_mfma_f32_16x16x32_bf16 v[36:39], v[72:75], a[152:155], v[36:39]
v_mfma_f32_16x16x32_bf16 v[36:39], v[76:79], a[156:159], v[36:39]
v_mfma_f32_16x16x32_bf16 v[40:43], v[64:67], a[160:163], 0
v_mfma_f32_16x16x32_bf16 v[40:43], v[68:71], a[164:167], v[40:43]
v_mfma_f32_16x16x32_bf16 v[40:43], v[72:75], a[168:171], v[40:43]
v_mfma_f32_16x16x32_bf16 v[40:43], v[76:79], a[172:175], v[40:43]
v_mfma_f32_16x16x32_bf16 v[44:47], v[64:67], a[176:179], 0
v_mfma_f32_16x16x32_bf16 v[44:47], v[68:71], a[180:183], v[44:47]
v_mfma_f32_16x16x32_bf16 v[44:47], v[72:75], a[184:187], v[44:47]
v_mfma_f32_16x16x32_bf16 v[44:47], v[76:79], a[188:191], v[44:47]
v_mfma_f32_16x16x32_bf16 v[48:51], v[64:67], a[192:195], 0
v_mfma_f32_16x16x32_bf16 v[48:51], v[68:71], a[196:199], v[48:51]
v_mfma_f32_16x16x32_bf16 v[48:51], v[72:75], a[200:203], v[48:51]
v_mfma_f32_16x16x32_bf16 v[48:51], v[76:79], a[204:207], v[48:51]
v_mfma_f32_16x16x32_bf16 v[52:55], v[64:67], a[208:211], 0
v_mfma_f32_16x16x32_bf16 v[52:55], v[68:71], a[212:215], v[52:55]
v_mfma_f32_16x16x32_bf16 v[52:55], v[72:75], a[216:219], v[52:55]
v_mfma_f32_16x16x32_bf16 v[52:55], v[76:79], a[220:223], v[52:55]
v_mfma_f32_16x16x32_bf16 v[56:59], v[64:67], a[224:227], 0
v_mfma_f32_16x16x32_bf16 v[56:59], v[68:71], a[228:231], v[56:59]
v_mfma_f32_16x16x32_bf16 v[56:59], v[72:75], a[232:235], v[56:59]
v_mfma_f32_16x16x32_bf16 v[56:59], v[76:79], a[236:239], v[56:59]
v_add_f32 v24, v24, v25
v_add_f32 v26, v26, v27
v_add_f32 v216, v24, v26
v_min_u32 v216, -2, v216
v_add_f32 v28, v28, v29
v_add_f32 v30, v30, v31
v_add_f32 v217, v28, v30
v_min_u32 v217, -2, v217
v_add_f32 v32, v32, v33
v_add_f32 v34, v34, v35
v_add_f32 v218, v32, v34
v_min_u32 v218, -2, v218
v_add_f32 v36, v36, v37
v_add_f32 v38, v38, v39
v_add_f32 v219, v36, v38
v_min_u32 v219, -2, v219
v_add_f32 v40, v40, v41
v_add_f32 v42, v42, v43
v_add_f32 v220, v40, v42
v_min_u32 v220, -2, v220
v_add_f32 v44, v44, v45
v_add_f32 v46, v46, v47
v_add_f32 v221, v44, v46
v_min_u32 v221, -2, v221
v_add_f32 v48, v48, v49
v_add_f32 v50, v50, v51
v_add_f32 v222, v48, v50
v_min_u32 v222, -2, v222
v_add_f32 v52, v52, v53
v_add_f32 v54, v54, v55
v_add_f32 v223, v52, v54
v_min_u32 v223, -2, v223
v_add_f32 v56, v56, v57
v_add_f32 v58, v58, v59
v_add_f32 v224, v56, v58
v_min_u32 v224, -2, v224
v_cvt_pk_bf16_f32 v216, v216, v217
v_min_u32 v216, -2, v216
v_cvt_pk_bf16_f32 v217, v218, v219
v_min_u32 v217, -2, v217
v_cvt_pk_bf16_f32 v218, v220, v221
v_min_u32 v218, -2, v218
v_cvt_pk_bf16_f32 v219, v222, v223
v_min_u32 v219, -2, v219
buffer_store_dwordx4 v[216:219], v5, s[64:67], s6 offen sc1
v_mov_b32_dpp v229, v224 row_shl:2 row_mask:0xf bank_mask:0xf
v_cvt_pk_bf16_f32 v228, v224, v229
v_min_u32 v228, -2, v228
s_nop 1
v_mov_b32_dpp v229, v228 row_shl:4 row_mask:0xf bank_mask:0xf
v_mov_b32_dpp v230, v228 row_shl:8 row_mask:0xf bank_mask:0xf
v_mov_b32_dpp v231, v228 row_shl:12 row_mask:0xf bank_mask:0xf
s_mov_b32 exec_lo, 0x00030003
s_mov_b32 exec_hi, 196611
buffer_store_dwordx4 v[228:231], v6, s[64:67], s6 offen offset:1024 sc1
s_mov_b64 exec, -1
s_nop 1
s_branch B_final
D_role:
s_load_dwordx8 s[32:39], s[0:1], 64
s_load_dwordx4 s[40:43], s[0:1], 96
s_mov_b32 s8, s5
s_lshl_b32 s9, s4, 1
s_add_u32 s9, s9, s8
v_and_b32 v1, 63, v0
v_lshlrev_b32 v2, 4, v1
v_lshrrev_b32 v9, 4, v1
v_and_b32 v8, 15, v1
s_lshr_b32 s10, s4, 3
s_lshr_b32 s80, s4, 0
s_and_b32 s11, s80, 7
v_xor_b32 v10, 32, v2
v_mov_b32 v76, -1
v_mov_b32 v77, -1
v_mov_b32 v78, -1
v_mov_b32 v79, -1
s_waitcnt lgkmcnt(0)
s_mov_b32 s64, s42
s_mov_b32 s65, s43
s_mov_b32 s66, 16777216
s_mov_b32 s67, 0x20000
s_lshl_b32 s6, s10, 22
s_add_u32 s52, s28, s6
s_addc_u32 s53, s29, 0
s_mov_b32 s54, 4194304
s_mov_b32 s55, 0x20000
s_cmp_eq_u32 s3, 3
s_cbranch_scc1 L_clr3_17
s_mul_i32 s6, s4, 9216
s_mul_i32 s7, s3, 4608
s_add_u32 s6, s6, s7
s_add_u32 s6, s6, 4194304
s_mul_i32 s7, s4, 4608
s_add_u32 s7, s7, 5242880
s_cmp_eq_u32 s3, 2
s_cselect_b32 s6, s7, s6
buffer_store_dwordx4 v[76:79], v2, s[64:67], s6 offen offset:0 sc1
buffer_store_dwordx4 v[76:79], v2, s[64:67], s6 offen offset:1024 sc1
buffer_store_dwordx4 v[76:79], v2, s[64:67], s6 offen offset:2048 sc1
buffer_store_dwordx4 v[76:79], v2, s[64:67], s6 offen offset:3072 sc1
s_add_u32 s6, s6, 4096
s_mov_b64 exec, 0xffffffff
buffer_store_dwordx4 v[76:79], v2, s[64:67], s6 offen offset:0 sc1
s_mov_b64 exec, -1
s_branch L_clrd_18
L_clr3_17:
s_mul_i32 s6, s4, 4096
s_add_u32 s6, s6, 0
buffer_store_dwordx4 v[76:79], v2, s[64:67], s6 offen offset:0 sc1
buffer_store_dwordx4 v[76:79], v2, s[64:67], s6 offen offset:1024 sc1
buffer_store_dwordx4 v[76:79], v2, s[64:67], s6 offen offset:2048 sc1
buffer_store_dwordx4 v[76:79], v2, s[64:67], s6 offen offset:3072 sc1
s_mov_b64 exec, 0xffff
s_mul_i32 s6, s4, 256
s_mul_i32 s7, s4, 256
s_add_u32 s7, s7, 327680
s_add_u32 s6, s6, 262144
v_lshrrev_b32 v6, 2, v1
v_mul_u32_u24 v6, 0, v6
v_add_u32 v6, v6, v2
buffer_store_dwordx4 v[76:79], v2, s[64:67], s6 offen sc1
buffer_store_dwordx4 v[76:79], v6, s[64:67], s7 offen sc1
s_mov_b64 exec, 3
s_mul_i32 s6, s4, 32
s_add_u32 s6, s6, 393216
s_lshr_b32 s7, s4, 2
s_mul_i32 s7, s7, 4224
s_add_u32 s6, s6, s7
v_mul_u32_u24 v5, 16, v1
buffer_store_dwordx4 v[76:79], v5, s[64:67], s6 offen sc1
s_mov_b64 exec, -1
L_clrd_18:
s_mov_b32 s68, s40
s_mov_b32 s69, s41
s_mov_b32 s70, 256
s_mov_b32 s71, 0x20000
s_mov_b32 s72, s38
s_mov_b32 s73, s39
s_mov_b32 s74, 9216
s_mov_b32 s75, 0x20000
s_mul_i32 s12, s3, 17408
s_lshl_b32 s13, s11, 2
s_add_u32 s13, s13, s3
s_lshl_b32 s13, s13, 12
s_add_u32 m0, s12, 0
s_add_u32 s6, s13, 0
buffer_load_dwordx4 v2, s[52:55], s6 offen nt lds
s_add_u32 m0, s12, 1088
s_add_u32 s6, s13, 1024
buffer_load_dwordx4 v2, s[52:55], s6 offen nt lds
s_add_u32 m0, s12, 2176
s_add_u32 s6, s13, 2048
buffer_load_dwordx4 v2, s[52:55], s6 offen nt lds
s_add_u32 m0, s12, 3264
s_add_u32 s6, s13, 3072
buffer_load_dwordx4 v2, s[52:55], s6 offen nt lds
s_add_u32 m0, s12, 4352
s_add_u32 s6, s13, 131072
buffer_load_dwordx4 v2, s[52:55], s6 offen nt lds
s_add_u32 m0, s12, 5440
s_add_u32 s6, s13, 132096
buffer_load_dwordx4 v2, s[52:55], s6 offen nt lds
s_add_u32 m0, s12, 6528
s_add_u32 s6, s13, 133120
buffer_load_dwordx4 v2, s[52:55], s6 offen nt lds
s_add_u32 m0, s12, 7616
s_add_u32 s6, s13, 134144
buffer_load_dwordx4 v2, s[52:55], s6 offen nt lds
s_waitcnt vmcnt(8)
s_barrier
s_cmp_lg_u32 s3, 0
s_cbranch_scc1 D_nosig
v_mov_b32 v7, 1
s_mov_b64 exec, 1
buffer_atomic_add v7, off, s[68:71], 0 offset:0
s_mov_b64 exec, -1
D_nosig:
s_add_u32 m0, s12, 8704
s_add_u32 s6, s13, 262144
s_waitcnt vmcnt(5)
buffer_load_dwordx4 v10, s[52:55], s6 offen nt lds
s_add_u32 m0, s12, 9792
s_add_u32 s6, s13, 263168
s_waitcnt vmcnt(5)
buffer_load_dwordx4 v10, s[52:55], s6 offen nt lds
s_add_u32 m0, s12, 10880
s_add_u32 s6, s13, 264192
s_waitcnt vmcnt(5)
buffer_load_dwordx4 v10, s[52:55], s6 offen nt lds
s_add_u32 m0, s12, 11968
s_add_u32 s6, s13, 265216
s_waitcnt vmcnt(5)
buffer_load_dwordx4 v10, s[52:55], s6 offen nt lds
s_add_u32 m0, s12, 13056
s_add_u32 s6, s13, 393216
s_waitcnt vmcnt(5)
buffer_load_dwordx4 v10, s[52:55], s6 offen nt lds
s_add_u32 m0, s12, 14144
s_add_u32 s6, s13, 394240
s_waitcnt vmcnt(5)
buffer_load_dwordx4 v10, s[52:55], s6 offen nt lds
s_add_u32 m0, s12, 15232
s_add_u32 s6, s13, 395264
s_waitcnt vmcnt(5)
buffer_load_dwordx4 v10, s[52:55], s6 offen nt lds
s_add_u32 m0, s12, 16320
s_add_u32 s6, s13, 396288
s_waitcnt vmcnt(5)
buffer_load_dwordx4 v10, s[52:55], s6 offen nt lds
s_add_u32 m0, s12, 69632
s_add_u32 s6, s13, 524288
s_waitcnt vmcnt(5)
buffer_load_dwordx4 v2, s[52:55], s6 offen nt lds
s_add_u32 m0, s12, 70720
s_add_u32 s6, s13, 525312
s_waitcnt vmcnt(5)
buffer_load_dwordx4 v2, s[52:55], s6 offen nt lds
s_add_u32 m0, s12, 71808
s_add_u32 s6, s13, 526336
s_waitcnt vmcnt(5)
buffer_load_dwordx4 v2, s[52:55], s6 offen nt lds
s_add_u32 m0, s12, 72896
s_add_u32 s6, s13, 527360
s_waitcnt vmcnt(5)
buffer_load_dwordx4 v2, s[52:55], s6 offen nt lds
s_add_u32 m0, s12, 73984
s_add_u32 s6, s13, 655360
s_waitcnt vmcnt(5)
buffer_load_dwordx4 v2, s[52:55], s6 offen nt lds
s_add_u32 m0, s12, 75072
s_add_u32 s6, s13, 656384
s_waitcnt vmcnt(5)
buffer_load_dwordx4 v2, s[52:55], s6 offen nt lds
s_add_u32 m0, s12, 76160
s_add_u32 s6, s13, 657408
s_waitcnt vmcnt(5)
buffer_load_dwordx4 v2, s[52:55], s6 offen nt lds
s_add_u32 m0, s12, 77248
s_add_u32 s6, s13, 658432
s_waitcnt vmcnt(5)
buffer_load_dwordx4 v2, s[52:55], s6 offen nt lds
s_add_u32 m0, s12, 78336
s_add_u32 s6, s13, 786432
s_waitcnt vmcnt(5)
buffer_load_dwordx4 v10, s[52:55], s6 offen nt lds
s_add_u32 m0, s12, 79424
s_add_u32 s6, s13, 787456
s_waitcnt vmcnt(5)
buffer_load_dwordx4 v10, s[52:55], s6 offen nt lds
s_add_u32 m0, s12, 80512
s_add_u32 s6, s13, 788480
s_waitcnt vmcnt(5)
buffer_load_dwordx4 v10, s[52:55], s6 offen nt lds
s_add_u32 m0, s12, 81600
s_add_u32 s6, s13, 789504
s_waitcnt vmcnt(5)
buffer_load_dwordx4 v10, s[52:55], s6 offen nt lds
s_add_u32 m0, s12, 82688
s_add_u32 s6, s13, 917504
s_waitcnt vmcnt(5)
buffer_load_dwordx4 v10, s[52:55], s6 offen nt lds
s_add_u32 m0, s12, 83776
s_add_u32 s6, s13, 918528
s_waitcnt vmcnt(5)
buffer_load_dwordx4 v10, s[52:55], s6 offen nt lds
s_add_u32 m0, s12, 84864
s_add_u32 s6, s13, 919552
s_waitcnt vmcnt(5)
buffer_load_dwordx4 v10, s[52:55], s6 offen nt lds
s_add_u32 m0, s12, 85952
s_add_u32 s6, s13, 920576
s_waitcnt vmcnt(5)
buffer_load_dwordx4 v10, s[52:55], s6 offen nt lds
s_add_u32 s6, s13, 1048576
s_waitcnt vmcnt(5)
buffer_load_dwordx4 a[128:131], v2, s[52:55], s6 offen nt
s_add_u32 s6, s13, 1049600
s_waitcnt vmcnt(5)
buffer_load_dwordx4 a[132:135], v2, s[52:55], s6 offen nt
s_add_u32 s6, s13, 1050624
s_waitcnt vmcnt(5)
buffer_load_dwordx4 a[136:139], v2, s[52:55], s6 offen nt
s_add_u32 s6, s13, 1051648
s_waitcnt vmcnt(5)
buffer_load_dwordx4 a[140:143], v2, s[52:55], s6 offen nt
s_add_u32 s6, s13, 1179648
s_waitcnt vmcnt(5)
buffer_load_dwordx4 a[144:147], v2, s[52:55], s6 offen nt
s_add_u32 s6, s13, 1180672
s_waitcnt vmcnt(5)
buffer_load_dwordx4 a[148:151], v2, s[52:55], s6 offen nt
s_add_u32 s6, s13, 1181696
s_waitcnt vmcnt(5)
buffer_load_dwordx4 a[152:155], v2, s[52:55], s6 offen nt
s_add_u32 s6, s13, 1182720
s_waitcnt vmcnt(5)
buffer_load_dwordx4 a[156:159], v2, s[52:55], s6 offen nt
s_add_u32 s6, s13, 1310720
s_waitcnt vmcnt(5)
buffer_load_dwordx4 a[160:163], v10, s[52:55], s6 offen nt
s_add_u32 s6, s13, 1311744
s_waitcnt vmcnt(5)
buffer_load_dwordx4 a[164:167], v10, s[52:55], s6 offen nt
s_add_u32 s6, s13, 1312768
s_waitcnt vmcnt(5)
buffer_load_dwordx4 a[168:171], v10, s[52:55], s6 offen nt
s_add_u32 s6, s13, 1313792
s_waitcnt vmcnt(5)
buffer_load_dwordx4 a[172:175], v10, s[52:55], s6 offen nt
s_add_u32 s6, s13, 1441792
s_waitcnt vmcnt(5)
buffer_load_dwordx4 a[176:179], v10, s[52:55], s6 offen nt
s_add_u32 s6, s13, 1442816
s_waitcnt vmcnt(5)
buffer_load_dwordx4 a[180:183], v10, s[52:55], s6 offen nt
s_add_u32 s6, s13, 1443840
s_waitcnt vmcnt(5)
buffer_load_dwordx4 a[184:187], v10, s[52:55], s6 offen nt
s_add_u32 s6, s13, 1444864
s_waitcnt vmcnt(5)
buffer_load_dwordx4 a[188:191], v10, s[52:55], s6 offen nt
s_add_u32 s6, s13, 1572864
s_waitcnt vmcnt(5)
buffer_load_dwordx4 a[192:195], v2, s[52:55], s6 offen nt
s_add_u32 s6, s13, 1573888
s_waitcnt vmcnt(5)
buffer_load_dwordx4 a[196:199], v2, s[52:55], s6 offen nt
s_add_u32 s6, s13, 1574912
s_waitcnt vmcnt(5)
buffer_load_dwordx4 a[200:203], v2, s[52:55], s6 offen nt
s_add_u32 s6, s13, 1575936
s_waitcnt vmcnt(5)
buffer_load_dwordx4 a[204:207], v2, s[52:55], s6 offen nt
s_add_u32 s6, s13, 1703936
s_waitcnt vmcnt(5)
buffer_load_dwordx4 a[208:211], v2, s[52:55], s6 offen nt
s_add_u32 s6, s13, 1704960
s_waitcnt vmcnt(5)
buffer_load_dwordx4 a[212:215], v2, s[52:55], s6 offen nt
s_add_u32 s6, s13, 1705984
s_waitcnt vmcnt(5)
buffer_load_dwordx4 a[216:219], v2, s[52:55], s6 offen nt
s_add_u32 s6, s13, 1707008
s_waitcnt vmcnt(5)
buffer_load_dwordx4 a[220:223], v2, s[52:55], s6 offen nt
s_add_u32 s6, s13, 1835008
s_waitcnt vmcnt(5)
buffer_load_dwordx4 a[224:227], v10, s[52:55], s6 offen nt
s_add_u32 s6, s13, 1836032
s_waitcnt vmcnt(5)
buffer_load_dwordx4 a[228:231], v10, s[52:55], s6 offen nt
s_add_u32 s6, s13, 1837056
s_waitcnt vmcnt(5)
buffer_load_dwordx4 a[232:235], v10, s[52:55], s6 offen nt
s_add_u32 s6, s13, 1838080
s_waitcnt vmcnt(5)
buffer_load_dwordx4 a[236:239], v10, s[52:55], s6 offen nt
s_add_u32 s6, s13, 1966080
s_waitcnt vmcnt(5)
buffer_load_dwordx4 a[240:243], v10, s[52:55], s6 offen nt
s_add_u32 s6, s13, 1967104
s_waitcnt vmcnt(5)
buffer_load_dwordx4 a[244:247], v10, s[52:55], s6 offen nt
s_add_u32 s6, s13, 1968128
s_waitcnt vmcnt(5)
buffer_load_dwordx4 a[248:251], v10, s[52:55], s6 offen nt
s_add_u32 s6, s13, 1969152
s_waitcnt vmcnt(5)
buffer_load_dwordx4 a[252:255], v10, s[52:55], s6 offen nt
buffer_load_dword v11, off, s[68:71], 0 offset:0 sc1
s_lshl_b32 s14, s10, 3
s_add_u32 s14, s14, s3
s_mul_i32 s14, s14, 4096
s_add_u32 s14, s14, 0
s_add_u32 s15, s14, 16384
s_lshl_b32 s6, s3, 4
v_add_u32 v5, s6, v8
v_mul_u32_u24 v5, 1088, v5
v_lshrrev_b32 v6, 3, v8
v_lshlrev_b32 v6, 1, v6
v_xor_b32 v6, v6, v9
v_lshl_add_u32 v194, v6, 4, v5
v_add_u32 v195, 69632, v194
v_lshrrev_b32 v5, 5, v1
v_lshlrev_b32 v5, 3, v5
v_bfe_u32 v6, v1, 2, 2
v_add_u32 v5, v5, v6
v_mul_u32_u24 v5, 1088, v5
v_lshrrev_b32 v6, 1, v9
v_xor_b32 v6, v6, v9
v_and_b32 v6, 1, v6
v_lshl_add_u32 v5, v6, 5, v5
v_and_b32 v6, 3, v1
v_lshl_add_u32 v5, v6, 3, v5
s_lshl_b32 s6, s3, 8
v_add_u32 v196, s6, v5
v_add_u32 v197, 69632, v196
v_lshlrev_b32 v199, 4, v8
v_add_u32 v199, 160256, v199
s_lshl_b32 s6, s3, 2
v_add_u32 v198, s6, v199
v_and_b32 v5, 31, v1
v_lshlrev_b32 v200, 4, v5
v_add_u32 v200, 160256, v200
v_lshlrev_b32 v202, 5, v5
v_lshrrev_b32 v6, 5, v1
v_lshl_add_u32 v202, v6, 4, v202
v_add_u32 v202, 156160, v202
v_lshlrev_b32 v201, 5, v8
v_lshl_add_u32 v201, v9, 3, v201
s_lshl_b32 s6, s3, 10
s_add_u32 s6, s6, 156160
v_add_u32 v201, s6, v201
v_mul_u32_u24 v203, 1056, v8
v_lshl_add_u32 v203, v9, 4, v203
v_add_u32 v203, 139264, v203
s_mul_i32 s6, s3, 4224
s_add_u32 s6, s6, 139264
v_add_u32 v204, s6, v2
v_add_u32 v206, s12, v2
v_add_u32 v207, 69632, v206
v_mov_b32 v185, 0x3e0293ee
v_mov_b32 v176, 0xff800000
v_mov_b32 v177, 0xff800000
v_mov_b32 v178, 0xff800000
v_mov_b32 v180, 0
v_mov_b32 v181, 0
s_waitcnt vmcnt(0)
s_mov_b32 s7, 400000
L_ens_19:
v_readfirstlane_b32 s6, v11
s_cmp_ge_u32 s6, 32
s_cbranch_scc1 L_ensd_20
s_sleep 16
buffer_load_dword v11, off, s[68:71], 0 offset:0 sc1
s_waitcnt vmcnt(0)
s_sub_u32 s7, s7, 1
s_cmp_lg_u32 s7, 0
s_cbranch_scc1 L_ens_19
L_ensd_20:
s_mov_b32 s7, 400000
v_and_b32 v5, 3, v1
v_bfe_u32 v6, v1, 2, 1
v_mul_u32_u24 v6, 16384, v6
v_lshl_add_u32 v5, v5, 10, v6
Q_slow:
buffer_load_dword v192, v5, s[64:67], s14 offen offset:768 sc1
s_waitcnt vmcnt(0)
v_cmp_eq_u32 vcc, -1, v192
s_cbranch_vccz Q_chk
s_sleep 8
s_sub_u32 s7, s7, 1
s_cmp_lg_u32 s7, 1
s_cbranch_scc1 Q_slow
Q_chk:
buffer_load_dwordx4 v[84:87], v2, s[64:67], s14 offen offset:0 sc1
buffer_load_dwordx4 v[88:91], v2, s[64:67], s14 offen offset:1024 sc1
buffer_load_dwordx4 v[92:95], v2, s[64:67], s14 offen offset:2048 sc1
buffer_load_dwordx4 v[96:99], v2, s[64:67], s14 offen offset:3072 sc1
buffer_load_dwordx4 v[100:103], v2, s[64:67], s15 offen offset:0 sc1
buffer_load_dwordx4 v[104:107], v2, s[64:67], s15 offen offset:1024 sc1
buffer_load_dwordx4 v[108:111], v2, s[64:67], s15 offen offset:2048 sc1
buffer_load_dwordx4 v[112:115], v2, s[64:67], s15 offen offset:3072 sc1
s_waitcnt vmcnt(0)
v_max3_u32 v192, v84, v85, v86
v_max3_u32 v192, v192, v87, v88
v_max3_u32 v192, v192, v89, v90
v_max3_u32 v192, v192, v91, v92
v_max3_u32 v192, v192, v93, v94
v_max3_u32 v192, v192, v95, v96
v_max3_u32 v192, v192, v97, v98
v_max3_u32 v192, v192, v99, v100
v_max3_u32 v192, v192, v101, v102
v_max3_u32 v192, v192, v103, v104
v_max3_u32 v192, v192, v105, v106
v_max3_u32 v192, v192, v107, v108
v_max3_u32 v192, v192, v109, v110
v_max3_u32 v192, v192, v111, v112
v_max3_u32 v192, v192, v113, v114
v_max_u32 v192, v192, v115
v_cmp_eq_u32 vcc, -1, v192
s_cbranch_vccz Q_ok
s_sleep 16
s_sub_u32 s7, s7, 1
s_cmp_lg_u32 s7, 0
s_cbranch_scc1 Q_chk
Q_ok:
ds_write_b128 v204, v[84:87] offset:0
ds_write_b128 v204, v[88:91] offset:1056
ds_write_b128 v204, v[92:95] offset:2112
ds_write_b128 v204, v[96:99] offset:3168
s_waitcnt lgkmcnt(0)
s_barrier
ds_read_b128 a[0:3], v203 offset:0
ds_read_b128 a[4:7], v203 offset:64
ds_read_b128 a[8:11], v203 offset:128
ds_read_b128 a[12:15], v203 offset:192
ds_read_b128 a[16:19], v203 offset:256
ds_read_b128 a[20:23], v203 offset:320
ds_read_b128 a[24:27], v203 offset:384
ds_read_b128 a[28:31], v203 offset:448
ds_read_b128 a[32:35], v203 offset:512
ds_read_b128 a[36:39], v203 offset:576
ds_read_b128 a[40:43], v203 offset:640
ds_read_b128 a[44:47], v203 offset:704
ds_read_b128 a[48:51], v203 offset:768
ds_read_b128 a[52:55], v203 offset:832
ds_read_b128 a[56:59], v203 offset:896
ds_read_b128 a[60:63], v203 offset:960
s_waitcnt lgkmcnt(0)
s_barrier
ds_write_b128 v204, v[100:103] offset:0
ds_write_b128 v204, v[104:107] offset:1056
ds_write_b128 v204, v[108:111] offset:2112
ds_write_b128 v204, v[112:115] offset:3168
s_waitcnt lgkmcnt(0)
s_barrier
ds_read_b128 a[64:67], v203 offset:0
ds_read_b128 a[68:71], v203 offset:64
ds_read_b128 a[72:75], v203 offset:128
ds_read_b128 a[76:79], v203 offset:192
ds_read_b128 a[80:83], v203 offset:256
ds_read_b128 a[84:87], v203 offset:320
ds_read_b128 a[88:91], v203 offset:384
ds_read_b128 a[92:95], v203 offset:448
ds_read_b128 a[96:99], v203 offset:512
ds_read_b128 a[100:103], v203 offset:576
ds_read_b128 a[104:107], v203 offset:640
ds_read_b128 a[108:111], v203 offset:704
ds_read_b128 a[112:115], v203 offset:768
ds_read_b128 a[116:119], v203 offset:832
ds_read_b128 a[120:123], v203 offset:896
ds_read_b128 a[124:127], v203 offset:960
s_waitcnt lgkmcnt(0)
s_mov_b32 s81, 4
ds_read_b128 v[84:87], v194 offset:0
ds_read_b128 v[88:91], v194 offset:64
ds_read_b128 v[92:95], v194 offset:128
ds_read_b128 v[96:99], v194 offset:192
ds_read_b128 v[100:103], v194 offset:256
ds_read_b128 v[104:107], v194 offset:320
ds_read_b128 v[108:111], v194 offset:384
ds_read_b128 v[112:115], v194 offset:448
ds_read_b128 v[116:119], v194 offset:512
ds_read_b128 v[120:123], v194 offset:576
ds_read_b128 v[124:127], v194 offset:640
ds_read_b128 v[128:131], v194 offset:704
ds_read_b128 v[132:135], v194 offset:768
ds_read_b128 v[136:139], v194 offset:832
ds_read_b128 v[140:143], v194 offset:896
ds_read_b128 v[144:147], v194 offset:960
s_waitcnt lgkmcnt(15)
v_mfma_f32_16x16x32_bf16 v[76:79], v[84:87], a[0:3], 0
v_mfma_f32_16x16x32_bf16 v[80:83], v[84:87], a[64:67], 0
s_waitcnt lgkmcnt(14)
v_mfma_f32_16x16x32_bf16 v[76:79], v[88:91], a[4:7], v[76:79]
v_mfma_f32_16x16x32_bf16 v[80:83], v[88:91], a[68:71], v[80:83]
s_waitcnt lgkmcnt(13)
v_mfma_f32_16x16x32_bf16 v[76:79], v[92:95], a[8:11], v[76:79]
v_mfma_f32_16x16x32_bf16 v[80:83], v[92:95], a[72:75], v[80:83]
s_waitcnt lgkmcnt(12)
v_mfma_f32_16x16x32_bf16 v[76:79], v[96:99], a[12:15], v[76:79]
v_mfma_f32_16x16x32_bf16 v[80:83], v[96:99], a[76:79], v[80:83]
s_waitcnt lgkmcnt(11)
v_mfma_f32_16x16x32_bf16 v[76:79], v[100:103], a[16:19], v[76:79]
v_mfma_f32_16x16x32_bf16 v[80:83], v[100:103], a[80:83], v[80:83]
s_waitcnt lgkmcnt(10)
v_mfma_f32_16x16x32_bf16 v[76:79], v[104:107], a[20:23], v[76:79]
v_mfma_f32_16x16x32_bf16 v[80:83], v[104:107], a[84:87], v[80:83]
s_waitcnt lgkmcnt(9)
v_mfma_f32_16x16x32_bf16 v[76:79], v[108:111], a[24:27], v[76:79]
v_mfma_f32_16x16x32_bf16 v[80:83], v[108:111], a[88:91], v[80:83]
s_waitcnt lgkmcnt(8)
v_mfma_f32_16x16x32_bf16 v[76:79], v[112:115], a[28:31], v[76:79]
v_mfma_f32_16x16x32_bf16 v[80:83], v[112:115], a[92:95], v[80:83]
s_waitcnt lgkmcnt(7)
v_mfma_f32_16x16x32_bf16 v[76:79], v[116:119], a[32:35], v[76:79]
v_mfma_f32_16x16x32_bf16 v[80:83], v[116:119], a[96:99], v[80:83]
s_waitcnt lgkmcnt(6)
v_mfma_f32_16x16x32_bf16 v[76:79], v[120:123], a[36:39], v[76:79]
v_mfma_f32_16x16x32_bf16 v[80:83], v[120:123], a[100:103], v[80:83]
s_waitcnt lgkmcnt(5)
v_mfma_f32_16x16x32_bf16 v[76:79], v[124:127], a[40:43], v[76:79]
v_mfma_f32_16x16x32_bf16 v[80:83], v[124:127], a[104:107], v[80:83]
s_waitcnt lgkmcnt(4)
v_mfma_f32_16x16x32_bf16 v[76:79], v[128:131], a[44:47], v[76:79]
v_mfma_f32_16x16x32_bf16 v[80:83], v[128:131], a[108:111], v[80:83]
s_waitcnt lgkmcnt(3)
v_mfma_f32_16x16x32_bf16 v[76:79], v[132:135], a[48:51], v[76:79]
v_mfma_f32_16x16x32_bf16 v[80:83], v[132:135], a[112:115], v[80:83]
s_waitcnt lgkmcnt(2)
v_mfma_f32_16x16x32_bf16 v[76:79], v[136:139], a[52:55], v[76:79]
v_mfma_f32_16x16x32_bf16 v[80:83], v[136:139], a[116:119], v[80:83]
s_waitcnt lgkmcnt(1)
v_mfma_f32_16x16x32_bf16 v[76:79], v[140:143], a[56:59], v[76:79]
v_mfma_f32_16x16x32_bf16 v[80:83], v[140:143], a[120:123], v[80:83]
s_waitcnt lgkmcnt(0)
v_mfma_f32_16x16x32_bf16 v[76:79], v[144:147], a[60:63], v[76:79]
v_mfma_f32_16x16x32_bf16 v[80:83], v[144:147], a[124:127], v[80:83]
s_nop 6
v_max_f32 v190, v76, v77
v_max3_f32 v190, v190, v78, v79
v_mov_b32 v192, v190
s_nop 1
v_permlane16_swap_b32 v190, v192
v_max_f32 v190, v190, v192
v_mov_b32 v192, v190
s_nop 1
v_permlane32_swap_b32 v190, v192
v_max_f32 v190, v190, v192
ds_write_b32 v198, v190 offset:0
v_max_f32 v191, v80, v81
v_max3_f32 v191, v191, v82, v83
v_mov_b32 v192, v191
s_nop 1
v_permlane16_swap_b32 v191, v192
v_max_f32 v191, v191, v192
v_mov_b32 v192, v191
s_nop 1
v_permlane32_swap_b32 v191, v192
v_max_f32 v191, v191, v192
ds_write_b32 v198, v191 offset:256
s_waitcnt lgkmcnt(0)
s_barrier
ds_read_b128 v[164:167], v199
ds_read_b128 v[168:171], v199 offset:256
ds_read_b128 v[172:175], v200
s_waitcnt lgkmcnt(0)
v_max_f32 v164, v164, v165
v_max3_f32 v164, v164, v166, v167
v_mul_f32 v164, v164, v185
v_max_f32 v164, v164, v176
v_sub_f32 v182, v176, v164
v_exp_f32 v182, v182
v_mov_b32 v176, v164
v_max_f32 v168, v168, v169
v_max3_f32 v168, v168, v170, v171
v_mul_f32 v168, v168, v185
v_max_f32 v168, v168, v177
v_sub_f32 v183, v177, v168
v_exp_f32 v183, v183
v_mov_b32 v177, v168
v_max_f32 v172, v172, v173
v_max3_f32 v172, v172, v174, v175
v_mul_f32 v172, v172, v185
v_max_f32 v172, v172, v178
v_sub_f32 v184, v178, v172
v_exp_f32 v184, v184
v_mov_b32 v178, v172
v_fma_f32 v76, v76, v185, -v176
v_fma_f32 v77, v77, v185, -v176
v_fma_f32 v78, v78, v185, -v176
v_fma_f32 v79, v79, v185, -v176
v_exp_f32 v76, v76
v_exp_f32 v77, v77
v_exp_f32 v78, v78
v_exp_f32 v79, v79
v_mul_f32 v180, v180, v182
v_cvt_pk_bf16_f32 v186, v76, v77
v_cvt_pk_bf16_f32 v187, v78, v79
ds_write_b64 v201, v[186:187] offset:0
v_add_f32 v180, v180, v76
v_add_f32 v180, v180, v77
v_add_f32 v180, v180, v78
v_add_f32 v180, v180, v79
v_fma_f32 v80, v80, v185, -v177
v_fma_f32 v81, v81, v185, -v177
v_fma_f32 v82, v82, v185, -v177
v_fma_f32 v83, v83, v185, -v177
v_exp_f32 v80, v80
v_exp_f32 v81, v81
v_exp_f32 v82, v82
v_exp_f32 v83, v83
v_mul_f32 v181, v181, v183
v_cvt_pk_bf16_f32 v188, v80, v81
v_cvt_pk_bf16_f32 v189, v82, v83
ds_write_b64 v201, v[188:189] offset:512
v_add_f32 v181, v181, v80
v_add_f32 v181, v181, v81
v_add_f32 v181, v181, v82
v_add_f32 v181, v181, v83
s_waitcnt lgkmcnt(0)
s_barrier
ds_read_b128 v[148:151], v202 offset:0
ds_read_b128 v[152:155], v202 offset:1024
ds_read_b128 v[156:159], v202 offset:2048
ds_read_b128 v[160:163], v202 offset:3072
ds_read_b64_tr_b16 v[84:85], v196 offset:0
ds_read_b64_tr_b16 v[86:87], v196 offset:4352
ds_read_b64_tr_b16 v[88:89], v196 offset:64
ds_read_b64_tr_b16 v[90:91], v196 offset:4416
ds_read_b64_tr_b16 v[92:93], v196 offset:128
ds_read_b64_tr_b16 v[94:95], v196 offset:4480
ds_read_b64_tr_b16 v[96:97], v196 offset:192
ds_read_b64_tr_b16 v[98:99], v196 offset:4544
ds_read_b64_tr_b16 v[100:101], v196 offset:17408
ds_read_b64_tr_b16 v[102:103], v196 offset:21760
ds_read_b64_tr_b16 v[104:105], v196 offset:17472
ds_read_b64_tr_b16 v[106:107], v196 offset:21824
ds_read_b64_tr_b16 v[108:109], v196 offset:17536
ds_read_b64_tr_b16 v[110:111], v196 offset:21888
ds_read_b64_tr_b16 v[112:113], v196 offset:17600
ds_read_b64_tr_b16 v[114:115], v196 offset:21952
ds_read_b64_tr_b16 v[116:117], v196 offset:34816
ds_read_b64_tr_b16 v[118:119], v196 offset:39168
ds_read_b64_tr_b16 v[120:121], v196 offset:34880
ds_read_b64_tr_b16 v[122:123], v196 offset:39232
ds_read_b64_tr_b16 v[124:125], v196 offset:34944
ds_read_b64_tr_b16 v[126:127], v196 offset:39296
ds_read_b64_tr_b16 v[128:129], v196 offset:35008
ds_read_b64_tr_b16 v[130:131], v196 offset:39360
ds_read_b64_tr_b16 v[132:133], v196 offset:52224
ds_read_b64_tr_b16 v[134:135], v196 offset:56576
ds_read_b64_tr_b16 v[136:137], v196 offset:52288
ds_read_b64_tr_b16 v[138:139], v196 offset:56640
ds_read_b64_tr_b16 v[140:141], v196 offset:52352
ds_read_b64_tr_b16 v[142:143], v196 offset:56704
ds_read_b64_tr_b16 v[144:145], v196 offset:52416
ds_read_b64_tr_b16 v[146:147], v196 offset:56768
s_waitcnt lgkmcnt(15)
v_mfma_f32_32x32x16_bf16 v[12:27], v[84:87], v[148:151], 0
v_mfma_f32_32x32x16_bf16 v[28:43], v[88:91], v[148:151], 0
v_mfma_f32_32x32x16_bf16 v[44:59], v[92:95], v[148:151], 0
v_mfma_f32_32x32x16_bf16 v[60:75], v[96:99], v[148:151], 0
s_waitcnt lgkmcnt(15)
v_mfma_f32_32x32x16_bf16 v[12:27], v[100:103], v[152:155], v[12:27]
v_mfma_f32_32x32x16_bf16 v[28:43], v[104:107], v[152:155], v[28:43]
v_mfma_f32_32x32x16_bf16 v[44:59], v[108:111], v[152:155], v[44:59]
v_mfma_f32_32x32x16_bf16 v[60:75], v[112:115], v[152:155], v[60:75]
s_waitcnt lgkmcnt(8)
v_mfma_f32_32x32x16_bf16 v[12:27], v[116:119], v[156:159], v[12:27]
v_mfma_f32_32x32x16_bf16 v[28:43], v[120:123], v[156:159], v[28:43]
v_mfma_f32_32x32x16_bf16 v[44:59], v[124:127], v[156:159], v[44:59]
v_mfma_f32_32x32x16_bf16 v[60:75], v[128:131], v[156:159], v[60:75]
s_waitcnt lgkmcnt(0)
v_mfma_f32_32x32x16_bf16 v[12:27], v[132:135], v[160:163], v[12:27]
v_mfma_f32_32x32x16_bf16 v[28:43], v[136:139], v[160:163], v[28:43]
v_mfma_f32_32x32x16_bf16 v[44:59], v[140:143], v[160:163], v[44:59]
v_mfma_f32_32x32x16_bf16 v[60:75], v[144:147], v[160:163], v[60:75]
ds_read_b128 v[84:87], v195 offset:0
ds_read_b128 v[88:91], v195 offset:64
ds_read_b128 v[92:95], v195 offset:128
ds_read_b128 v[96:99], v195 offset:192
ds_read_b128 v[100:103], v195 offset:256
ds_read_b128 v[104:107], v195 offset:320
ds_read_b128 v[108:111], v195 offset:384
ds_read_b128 v[112:115], v195 offset:448
ds_read_b128 v[116:119], v195 offset:512
ds_read_b128 v[120:123], v195 offset:576
ds_read_b128 v[124:127], v195 offset:640
ds_read_b128 v[128:131], v195 offset:704
ds_read_b128 v[132:135], v195 offset:768
ds_read_b128 v[136:139], v195 offset:832
ds_read_b128 v[140:143], v195 offset:896
ds_read_b128 v[144:147], v195 offset:960
s_waitcnt lgkmcnt(15)
v_mfma_f32_16x16x32_bf16 v[76:79], v[84:87], a[0:3], 0
v_mfma_f32_16x16x32_bf16 v[80:83], v[84:87], a[64:67], 0
s_waitcnt lgkmcnt(14)
v_mfma_f32_16x16x32_bf16 v[76:79], v[88:91], a[4:7], v[76:79]
v_mfma_f32_16x16x32_bf16 v[80:83], v[88:91], a[68:71], v[80:83]
s_waitcnt lgkmcnt(13)
v_mfma_f32_16x16x32_bf16 v[76:79], v[92:95], a[8:11], v[76:79]
v_mfma_f32_16x16x32_bf16 v[80:83], v[92:95], a[72:75], v[80:83]
s_waitcnt lgkmcnt(12)
v_mfma_f32_16x16x32_bf16 v[76:79], v[96:99], a[12:15], v[76:79]
v_mfma_f32_16x16x32_bf16 v[80:83], v[96:99], a[76:79], v[80:83]
s_waitcnt lgkmcnt(11)
v_mfma_f32_16x16x32_bf16 v[76:79], v[100:103], a[16:19], v[76:79]
v_mfma_f32_16x16x32_bf16 v[80:83], v[100:103], a[80:83], v[80:83]
s_waitcnt lgkmcnt(10)
v_mfma_f32_16x16x32_bf16 v[76:79], v[104:107], a[20:23], v[76:79]
v_mfma_f32_16x16x32_bf16 v[80:83], v[104:107], a[84:87], v[80:83]
s_waitcnt lgkmcnt(9)
v_mfma_f32_16x16x32_bf16 v[76:79], v[108:111], a[24:27], v[76:79]
v_mfma_f32_16x16x32_bf16 v[80:83], v[108:111], a[88:91], v[80:83]
s_waitcnt lgkmcnt(8)
v_mfma_f32_16x16x32_bf16 v[76:79], v[112:115], a[28:31], v[76:79]
v_mfma_f32_16x16x32_bf16 v[80:83], v[112:115], a[92:95], v[80:83]
s_waitcnt lgkmcnt(7)
v_mfma_f32_16x16x32_bf16 v[76:79], v[116:119], a[32:35], v[76:79]
v_mfma_f32_16x16x32_bf16 v[80:83], v[116:119], a[96:99], v[80:83]
s_waitcnt lgkmcnt(6)
v_mfma_f32_16x16x32_bf16 v[76:79], v[120:123], a[36:39], v[76:79]
v_mfma_f32_16x16x32_bf16 v[80:83], v[120:123], a[100:103], v[80:83]
s_waitcnt lgkmcnt(5)
v_mfma_f32_16x16x32_bf16 v[76:79], v[124:127], a[40:43], v[76:79]
v_mfma_f32_16x16x32_bf16 v[80:83], v[124:127], a[104:107], v[80:83]
s_waitcnt lgkmcnt(4)
v_mfma_f32_16x16x32_bf16 v[76:79], v[128:131], a[44:47], v[76:79]
v_mfma_f32_16x16x32_bf16 v[80:83], v[128:131], a[108:111], v[80:83]
s_waitcnt lgkmcnt(3)
v_mfma_f32_16x16x32_bf16 v[76:79], v[132:135], a[48:51], v[76:79]
v_mfma_f32_16x16x32_bf16 v[80:83], v[132:135], a[112:115], v[80:83]
s_waitcnt lgkmcnt(2)
v_mfma_f32_16x16x32_bf16 v[76:79], v[136:139], a[52:55], v[76:79]
v_mfma_f32_16x16x32_bf16 v[80:83], v[136:139], a[116:119], v[80:83]
s_waitcnt lgkmcnt(1)
v_mfma_f32_16x16x32_bf16 v[76:79], v[140:143], a[56:59], v[76:79]
v_mfma_f32_16x16x32_bf16 v[80:83], v[140:143], a[120:123], v[80:83]
s_waitcnt lgkmcnt(0)
v_mfma_f32_16x16x32_bf16 v[76:79], v[144:147], a[60:63], v[76:79]
v_mfma_f32_16x16x32_bf16 v[80:83], v[144:147], a[124:127], v[80:83]
s_nop 6
v_max_f32 v190, v76, v77
v_max3_f32 v190, v190, v78, v79
v_mov_b32 v192, v190
s_nop 1
v_permlane16_swap_b32 v190, v192
v_max_f32 v190, v190, v192
v_mov_b32 v192, v190
s_nop 1
v_permlane32_swap_b32 v190, v192
v_max_f32 v190, v190, v192
ds_write_b32 v198, v190 offset:0
v_max_f32 v191, v80, v81
v_max3_f32 v191, v191, v82, v83
v_mov_b32 v192, v191
s_nop 1
v_permlane16_swap_b32 v191, v192
v_max_f32 v191, v191, v192
v_mov_b32 v192, v191
s_nop 1
v_permlane32_swap_b32 v191, v192
v_max_f32 v191, v191, v192
ds_write_b32 v198, v191 offset:256
s_waitcnt lgkmcnt(0)
s_barrier
ds_read_b128 v[164:167], v199
ds_read_b128 v[168:171], v199 offset:256
ds_read_b128 v[172:175], v200
ds_write_b128 v206, a[128:131] offset:0
ds_write_b128 v206, a[132:135] offset:1088
ds_write_b128 v206, a[136:139] offset:2176
ds_write_b128 v206, a[140:143] offset:3264
ds_write_b128 v206, a[144:147] offset:4352
ds_write_b128 v206, a[148:151] offset:5440
ds_write_b128 v206, a[152:155] offset:6528
ds_write_b128 v206, a[156:159] offset:7616
ds_write_b128 v206, a[160:163] offset:8704
ds_write_b128 v206, a[164:167] offset:9792
ds_write_b128 v206, a[168:171] offset:10880
ds_write_b128 v206, a[172:175] offset:11968
ds_write_b128 v206, a[176:179] offset:13056
ds_write_b128 v206, a[180:183] offset:14144
ds_write_b128 v206, a[184:187] offset:15232
ds_write_b128 v206, a[188:191] offset:16320
s_waitcnt lgkmcnt(15)
v_max_f32 v164, v164, v165
v_max3_f32 v164, v164, v166, v167
v_mul_f32 v164, v164, v185
v_max_f32 v164, v164, v176
v_sub_f32 v182, v176, v164
v_exp_f32 v182, v182
v_mov_b32 v176, v164
v_max_f32 v168, v168, v169
v_max3_f32 v168, v168, v170, v171
v_mul_f32 v168, v168, v185
v_max_f32 v168, v168, v177
v_sub_f32 v183, v177, v168
v_exp_f32 v183, v183
v_mov_b32 v177, v168
v_max_f32 v172, v172, v173
v_max3_f32 v172, v172, v174, v175
v_mul_f32 v172, v172, v185
v_max_f32 v172, v172, v178
v_sub_f32 v184, v178, v172
v_exp_f32 v184, v184
v_mov_b32 v178, v172
v_fma_f32 v76, v76, v185, -v176
v_fma_f32 v77, v77, v185, -v176
v_fma_f32 v78, v78, v185, -v176
v_fma_f32 v79, v79, v185, -v176
v_exp_f32 v76, v76
v_exp_f32 v77, v77
v_exp_f32 v78, v78
v_exp_f32 v79, v79
v_mul_f32 v180, v180, v182
v_cvt_pk_bf16_f32 v186, v76, v77
v_cvt_pk_bf16_f32 v187, v78, v79
ds_write_b64 v201, v[186:187] offset:0
v_add_f32 v180, v180, v76
v_add_f32 v180, v180, v77
v_add_f32 v180, v180, v78
v_add_f32 v180, v180, v79
v_fma_f32 v80, v80, v185, -v177
v_fma_f32 v81, v81, v185, -v177
v_fma_f32 v82, v82, v185, -v177
v_fma_f32 v83, v83, v185, -v177
v_exp_f32 v80, v80
v_exp_f32 v81, v81
v_exp_f32 v82, v82
v_exp_f32 v83, v83
v_mul_f32 v181, v181, v183
v_cvt_pk_bf16_f32 v188, v80, v81
v_cvt_pk_bf16_f32 v189, v82, v83
ds_write_b64 v201, v[188:189] offset:512
v_add_f32 v181, v181, v80
v_add_f32 v181, v181, v81
v_add_f32 v181, v181, v82
v_add_f32 v181, v181, v83
v_mul_f32 v12, v12, v184
v_mul_f32 v13, v13, v184
v_mul_f32 v14, v14, v184
v_mul_f32 v15, v15, v184
v_mul_f32 v16, v16, v184
v_mul_f32 v17, v17, v184
v_mul_f32 v18, v18, v184
v_mul_f32 v19, v19, v184
v_mul_f32 v20, v20, v184
v_mul_f32 v21, v21, v184
v_mul_f32 v22, v22, v184
v_mul_f32 v23, v23, v184
v_mul_f32 v24, v24, v184
v_mul_f32 v25, v25, v184
v_mul_f32 v26, v26, v184
v_mul_f32 v27, v27, v184
v_mul_f32 v28, v28, v184
v_mul_f32 v29, v29, v184
v_mul_f32 v30, v30, v184
v_mul_f32 v31, v31, v184
v_mul_f32 v32, v32, v184
v_mul_f32 v33, v33, v184
v_mul_f32 v34, v34, v184
v_mul_f32 v35, v35, v184
v_mul_f32 v36, v36, v184
v_mul_f32 v37, v37, v184
v_mul_f32 v38, v38, v184
v_mul_f32 v39, v39, v184
v_mul_f32 v40, v40, v184
v_mul_f32 v41, v41, v184
v_mul_f32 v42, v42, v184
v_mul_f32 v43, v43, v184
v_mul_f32 v44, v44, v184
v_mul_f32 v45, v45, v184
v_mul_f32 v46, v46, v184
v_mul_f32 v47, v47, v184
v_mul_f32 v48, v48, v184
v_mul_f32 v49, v49, v184
v_mul_f32 v50, v50, v184
v_mul_f32 v51, v51, v184
v_mul_f32 v52, v52, v184
v_mul_f32 v53, v53, v184
v_mul_f32 v54, v54, v184
v_mul_f32 v55, v55, v184
v_mul_f32 v56, v56, v184
v_mul_f32 v57, v57, v184
v_mul_f32 v58, v58, v184
v_mul_f32 v59, v59, v184
v_mul_f32 v60, v60, v184
v_mul_f32 v61, v61, v184
v_mul_f32 v62, v62, v184
v_mul_f32 v63, v63, v184
v_mul_f32 v64, v64, v184
v_mul_f32 v65, v65, v184
v_mul_f32 v66, v66, v184
v_mul_f32 v67, v67, v184
v_mul_f32 v68, v68, v184
v_mul_f32 v69, v69, v184
v_mul_f32 v70, v70, v184
v_mul_f32 v71, v71, v184
v_mul_f32 v72, v72, v184
v_mul_f32 v73, v73, v184
v_mul_f32 v74, v74, v184
v_mul_f32 v75, v75, v184
s_waitcnt lgkmcnt(0)
s_barrier
ds_read_b128 v[148:151], v202 offset:0
ds_read_b128 v[152:155], v202 offset:1024
ds_read_b128 v[156:159], v202 offset:2048
ds_read_b128 v[160:163], v202 offset:3072
ds_read_b64_tr_b16 v[84:85], v197 offset:0
ds_read_b64_tr_b16 v[86:87], v197 offset:4352
ds_read_b64_tr_b16 v[88:89], v197 offset:64
ds_read_b64_tr_b16 v[90:91], v197 offset:4416
ds_read_b64_tr_b16 v[92:93], v197 offset:128
ds_read_b64_tr_b16 v[94:95], v197 offset:4480
ds_read_b64_tr_b16 v[96:97], v197 offset:192
ds_read_b64_tr_b16 v[98:99], v197 offset:4544
ds_read_b64_tr_b16 v[100:101], v197 offset:17408
ds_read_b64_tr_b16 v[102:103], v197 offset:21760
ds_read_b64_tr_b16 v[104:105], v197 offset:17472
ds_read_b64_tr_b16 v[106:107], v197 offset:21824
ds_read_b64_tr_b16 v[108:109], v197 offset:17536
ds_read_b64_tr_b16 v[110:111], v197 offset:21888
ds_read_b64_tr_b16 v[112:113], v197 offset:17600
ds_read_b64_tr_b16 v[114:115], v197 offset:21952
ds_read_b64_tr_b16 v[116:117], v197 offset:34816
ds_read_b64_tr_b16 v[118:119], v197 offset:39168
ds_read_b64_tr_b16 v[120:121], v197 offset:34880
ds_read_b64_tr_b16 v[122:123], v197 offset:39232
ds_read_b64_tr_b16 v[124:125], v197 offset:34944
ds_read_b64_tr_b16 v[126:127], v197 offset:39296
ds_read_b64_tr_b16 v[128:129], v197 offset:35008
ds_read_b64_tr_b16 v[130:131], v197 offset:39360
ds_read_b64_tr_b16 v[132:133], v197 offset:52224
ds_read_b64_tr_b16 v[134:135], v197 offset:56576
ds_read_b64_tr_b16 v[136:137], v197 offset:52288
ds_read_b64_tr_b16 v[138:139], v197 offset:56640
ds_read_b64_tr_b16 v[140:141], v197 offset:52352
ds_read_b64_tr_b16 v[142:143], v197 offset:56704
ds_read_b64_tr_b16 v[144:145], v197 offset:52416
ds_read_b64_tr_b16 v[146:147], v197 offset:56768
s_waitcnt lgkmcnt(15)
v_mfma_f32_32x32x16_bf16 v[12:27], v[84:87], v[148:151], v[12:27]
v_mfma_f32_32x32x16_bf16 v[28:43], v[88:91], v[148:151], v[28:43]
s_add_u32 s6, s13, 2097152
buffer_load_dwordx4 a[128:131], v2, s[52:55], s6 offen nt
v_mfma_f32_32x32x16_bf16 v[44:59], v[92:95], v[148:151], v[44:59]
v_mfma_f32_32x32x16_bf16 v[60:75], v[96:99], v[148:151], v[60:75]
s_add_u32 s6, s13, 2098176
buffer_load_dwordx4 a[132:135], v2, s[52:55], s6 offen nt
s_waitcnt lgkmcnt(15)
v_mfma_f32_32x32x16_bf16 v[12:27], v[100:103], v[152:155], v[12:27]
v_mfma_f32_32x32x16_bf16 v[28:43], v[104:107], v[152:155], v[28:43]
s_add_u32 s6, s13, 2099200
buffer_load_dwordx4 a[136:139], v2, s[52:55], s6 offen nt
v_mfma_f32_32x32x16_bf16 v[44:59], v[108:111], v[152:155], v[44:59]
v_mfma_f32_32x32x16_bf16 v[60:75], v[112:115], v[152:155], v[60:75]
s_add_u32 s6, s13, 2100224
buffer_load_dwordx4 a[140:143], v2, s[52:55], s6 offen nt
s_waitcnt lgkmcnt(8)
v_mfma_f32_32x32x16_bf16 v[12:27], v[116:119], v[156:159], v[12:27]
v_mfma_f32_32x32x16_bf16 v[28:43], v[120:123], v[156:159], v[28:43]
s_add_u32 s6, s13, 2228224
buffer_load_dwordx4 a[144:147], v2, s[52:55], s6 offen nt
v_mfma_f32_32x32x16_bf16 v[44:59], v[124:127], v[156:159], v[44:59]
v_mfma_f32_32x32x16_bf16 v[60:75], v[128:131], v[156:159], v[60:75]
s_add_u32 s6, s13, 2229248
buffer_load_dwordx4 a[148:151], v2, s[52:55], s6 offen nt
s_waitcnt lgkmcnt(0)
v_mfma_f32_32x32x16_bf16 v[12:27], v[132:135], v[160:163], v[12:27]
v_mfma_f32_32x32x16_bf16 v[28:43], v[136:139], v[160:163], v[28:43]
s_add_u32 s6, s13, 2230272
buffer_load_dwordx4 a[152:155], v2, s[52:55], s6 offen nt
v_mfma_f32_32x32x16_bf16 v[44:59], v[140:143], v[160:163], v[44:59]
v_mfma_f32_32x32x16_bf16 v[60:75], v[144:147], v[160:163], v[60:75]
s_add_u32 s6, s13, 2231296
buffer_load_dwordx4 a[156:159], v2, s[52:55], s6 offen nt
ds_read_b128 v[84:87], v194 offset:0
ds_read_b128 v[88:91], v194 offset:64
ds_read_b128 v[92:95], v194 offset:128
ds_read_b128 v[96:99], v194 offset:192
ds_read_b128 v[100:103], v194 offset:256
ds_read_b128 v[104:107], v194 offset:320
ds_read_b128 v[108:111], v194 offset:384
ds_read_b128 v[112:115], v194 offset:448
ds_read_b128 v[116:119], v194 offset:512
ds_read_b128 v[120:123], v194 offset:576
ds_read_b128 v[124:127], v194 offset:640
ds_read_b128 v[128:131], v194 offset:704
ds_read_b128 v[132:135], v194 offset:768
ds_read_b128 v[136:139], v194 offset:832
ds_read_b128 v[140:143], v194 offset:896
ds_read_b128 v[144:147], v194 offset:960
s_waitcnt lgkmcnt(15)
v_mfma_f32_16x16x32_bf16 v[76:79], v[84:87], a[0:3], 0
v_mfma_f32_16x16x32_bf16 v[80:83], v[84:87], a[64:67], 0
s_waitcnt lgkmcnt(14)
v_mfma_f32_16x16x32_bf16 v[76:79], v[88:91], a[4:7], v[76:79]
v_mfma_f32_16x16x32_bf16 v[80:83], v[88:91], a[68:71], v[80:83]
s_add_u32 s6, s13, 2359296
buffer_load_dwordx4 a[160:163], v10, s[52:55], s6 offen nt
s_waitcnt lgkmcnt(13)
v_mfma_f32_16x16x32_bf16 v[76:79], v[92:95], a[8:11], v[76:79]
v_mfma_f32_16x16x32_bf16 v[80:83], v[92:95], a[72:75], v[80:83]
s_waitcnt lgkmcnt(12)
v_mfma_f32_16x16x32_bf16 v[76:79], v[96:99], a[12:15], v[76:79]
v_mfma_f32_16x16x32_bf16 v[80:83], v[96:99], a[76:79], v[80:83]
s_add_u32 s6, s13, 2360320
buffer_load_dwordx4 a[164:167], v10, s[52:55], s6 offen nt
s_waitcnt lgkmcnt(11)
v_mfma_f32_16x16x32_bf16 v[76:79], v[100:103], a[16:19], v[76:79]
v_mfma_f32_16x16x32_bf16 v[80:83], v[100:103], a[80:83], v[80:83]
s_waitcnt lgkmcnt(10)
v_mfma_f32_16x16x32_bf16 v[76:79], v[104:107], a[20:23], v[76:79]
v_mfma_f32_16x16x32_bf16 v[80:83], v[104:107], a[84:87], v[80:83]
s_add_u32 s6, s13, 2361344
buffer_load_dwordx4 a[168:171], v10, s[52:55], s6 offen nt
s_waitcnt lgkmcnt(9)
v_mfma_f32_16x16x32_bf16 v[76:79], v[108:111], a[24:27], v[76:79]
v_mfma_f32_16x16x32_bf16 v[80:83], v[108:111], a[88:91], v[80:83]
s_waitcnt lgkmcnt(8)
v_mfma_f32_16x16x32_bf16 v[76:79], v[112:115], a[28:31], v[76:79]
v_mfma_f32_16x16x32_bf16 v[80:83], v[112:115], a[92:95], v[80:83]
s_add_u32 s6, s13, 2362368
buffer_load_dwordx4 a[172:175], v10, s[52:55], s6 offen nt
s_waitcnt lgkmcnt(7)
v_mfma_f32_16x16x32_bf16 v[76:79], v[116:119], a[32:35], v[76:79]
v_mfma_f32_16x16x32_bf16 v[80:83], v[116:119], a[96:99], v[80:83]
s_waitcnt lgkmcnt(6)
v_mfma_f32_16x16x32_bf16 v[76:79], v[120:123], a[36:39], v[76:79]
v_mfma_f32_16x16x32_bf16 v[80:83], v[120:123], a[100:103], v[80:83]
s_add_u32 s6, s13, 2490368
buffer_load_dwordx4 a[176:179], v10, s[52:55], s6 offen nt
s_waitcnt lgkmcnt(5)
v_mfma_f32_16x16x32_bf16 v[76:79], v[124:127], a[40:43], v[76:79]
v_mfma_f32_16x16x32_bf16 v[80:83], v[124:127], a[104:107], v[80:83]
s_waitcnt lgkmcnt(4)
v_mfma_f32_16x16x32_bf16 v[76:79], v[128:131], a[44:47], v[76:79]
v_mfma_f32_16x16x32_bf16 v[80:83], v[128:131], a[108:111], v[80:83]
s_add_u32 s6, s13, 2491392
buffer_load_dwordx4 a[180:183], v10, s[52:55], s6 offen nt
s_waitcnt lgkmcnt(3)
v_mfma_f32_16x16x32_bf16 v[76:79], v[132:135], a[48:51], v[76:79]
v_mfma_f32_16x16x32_bf16 v[80:83], v[132:135], a[112:115], v[80:83]
s_waitcnt lgkmcnt(2)
v_mfma_f32_16x16x32_bf16 v[76:79], v[136:139], a[52:55], v[76:79]
v_mfma_f32_16x16x32_bf16 v[80:83], v[136:139], a[116:119], v[80:83]
s_add_u32 s6, s13, 2492416
buffer_load_dwordx4 a[184:187], v10, s[52:55], s6 offen nt
s_waitcnt lgkmcnt(1)
v_mfma_f32_16x16x32_bf16 v[76:79], v[140:143], a[56:59], v[76:79]
v_mfma_f32_16x16x32_bf16 v[80:83], v[140:143], a[120:123], v[80:83]
s_waitcnt lgkmcnt(0)
v_mfma_f32_16x16x32_bf16 v[76:79], v[144:147], a[60:63], v[76:79]
v_mfma_f32_16x16x32_bf16 v[80:83], v[144:147], a[124:127], v[80:83]
s_add_u32 s6, s13, 2493440
buffer_load_dwordx4 a[188:191], v10, s[52:55], s6 offen nt
s_nop 4
v_max_f32 v190, v76, v77
v_max3_f32 v190, v190, v78, v79
v_mov_b32 v192, v190
s_nop 1
v_permlane16_swap_b32 v190, v192
v_max_f32 v190, v190, v192
v_mov_b32 v192, v190
s_nop 1
v_permlane32_swap_b32 v190, v192
v_max_f32 v190, v190, v192
ds_write_b32 v198, v190 offset:0
v_max_f32 v191, v80, v81
v_max3_f32 v191, v191, v82, v83
v_mov_b32 v192, v191
s_nop 1
v_permlane16_swap_b32 v191, v192
v_max_f32 v191, v191, v192
v_mov_b32 v192, v191
s_nop 1
v_permlane32_swap_b32 v191, v192
v_max_f32 v191, v191, v192
ds_write_b32 v198, v191 offset:256
s_waitcnt lgkmcnt(0)
s_barrier
ds_read_b128 v[164:167], v199
ds_read_b128 v[168:171], v199 offset:256
ds_read_b128 v[172:175], v200
ds_write_b128 v207, a[192:195] offset:0
ds_write_b128 v207, a[196:199] offset:1088
ds_write_b128 v207, a[200:203] offset:2176
ds_write_b128 v207, a[204:207] offset:3264
ds_write_b128 v207, a[208:211] offset:4352
ds_write_b128 v207, a[212:215] offset:5440
ds_write_b128 v207, a[216:219] offset:6528
ds_write_b128 v207, a[220:223] offset:7616
ds_write_b128 v207, a[224:227] offset:8704
ds_write_b128 v207, a[228:231] offset:9792
ds_write_b128 v207, a[232:235] offset:10880
ds_write_b128 v207, a[236:239] offset:11968
ds_write_b128 v207, a[240:243] offset:13056
ds_write_b128 v207, a[244:247] offset:14144
ds_write_b128 v207, a[248:251] offset:15232
ds_write_b128 v207, a[252:255] offset:16320
s_waitcnt lgkmcnt(15)
v_max_f32 v164, v164, v165
v_max3_f32 v164, v164, v166, v167
v_mul_f32 v164, v164, v185
v_max_f32 v164, v164, v176
v_sub_f32 v182, v176, v164
v_exp_f32 v182, v182
v_mov_b32 v176, v164
v_max_f32 v168, v168, v169
v_max3_f32 v168, v168, v170, v171
v_mul_f32 v168, v168, v185
v_max_f32 v168, v168, v177
v_sub_f32 v183, v177, v168
v_exp_f32 v183, v183
v_mov_b32 v177, v168
v_max_f32 v172, v172, v173
v_max3_f32 v172, v172, v174, v175
v_mul_f32 v172, v172, v185
v_max_f32 v172, v172, v178
v_sub_f32 v184, v178, v172
v_exp_f32 v184, v184
v_mov_b32 v178, v172
v_fma_f32 v76, v76, v185, -v176
v_fma_f32 v77, v77, v185, -v176
v_fma_f32 v78, v78, v185, -v176
v_fma_f32 v79, v79, v185, -v176
v_exp_f32 v76, v76
v_exp_f32 v77, v77
v_exp_f32 v78, v78
v_exp_f32 v79, v79
v_mul_f32 v180, v180, v182
v_cvt_pk_bf16_f32 v186, v76, v77
v_cvt_pk_bf16_f32 v187, v78, v79
ds_write_b64 v201, v[186:187] offset:0
v_add_f32 v180, v180, v76
v_add_f32 v180, v180, v77
v_add_f32 v180, v180, v78
v_add_f32 v180, v180, v79
v_fma_f32 v80, v80, v185, -v177
v_fma_f32 v81, v81, v185, -v177
v_fma_f32 v82, v82, v185, -v177
v_fma_f32 v83, v83, v185, -v177
v_exp_f32 v80, v80
v_exp_f32 v81, v81
v_exp_f32 v82, v82
v_exp_f32 v83, v83
v_mul_f32 v181, v181, v183
v_cvt_pk_bf16_f32 v188, v80, v81
v_cvt_pk_bf16_f32 v189, v82, v83
ds_write_b64 v201, v[188:189] offset:512
v_add_f32 v181, v181, v80
v_add_f32 v181, v181, v81
v_add_f32 v181, v181, v82
v_add_f32 v181, v181, v83
v_mul_f32 v12, v12, v184
v_mul_f32 v13, v13, v184
v_mul_f32 v14, v14, v184
v_mul_f32 v15, v15, v184
v_mul_f32 v16, v16, v184
v_mul_f32 v17, v17, v184
v_mul_f32 v18, v18, v184
v_mul_f32 v19, v19, v184
v_mul_f32 v20, v20, v184
v_mul_f32 v21, v21, v184
v_mul_f32 v22, v22, v184
v_mul_f32 v23, v23, v184
v_mul_f32 v24, v24, v184
v_mul_f32 v25, v25, v184
v_mul_f32 v26, v26, v184
v_mul_f32 v27, v27, v184
v_mul_f32 v28, v28, v184
v_mul_f32 v29, v29, v184
v_mul_f32 v30, v30, v184
v_mul_f32 v31, v31, v184
v_mul_f32 v32, v32, v184
v_mul_f32 v33, v33, v184
v_mul_f32 v34, v34, v184
v_mul_f32 v35, v35, v184
v_mul_f32 v36, v36, v184
v_mul_f32 v37, v37, v184
v_mul_f32 v38, v38, v184
v_mul_f32 v39, v39, v184
v_mul_f32 v40, v40, v184
v_mul_f32 v41, v41, v184
v_mul_f32 v42, v42, v184
v_mul_f32 v43, v43, v184
v_mul_f32 v44, v44, v184
v_mul_f32 v45, v45, v184
v_mul_f32 v46, v46, v184
v_mul_f32 v47, v47, v184
v_mul_f32 v48, v48, v184
v_mul_f32 v49, v49, v184
v_mul_f32 v50, v50, v184
v_mul_f32 v51, v51, v184
v_mul_f32 v52, v52, v184
v_mul_f32 v53, v53, v184
v_mul_f32 v54, v54, v184
v_mul_f32 v55, v55, v184
v_mul_f32 v56, v56, v184
v_mul_f32 v57, v57, v184
v_mul_f32 v58, v58, v184
v_mul_f32 v59, v59, v184
v_mul_f32 v60, v60, v184
v_mul_f32 v61, v61, v184
v_mul_f32 v62, v62, v184
v_mul_f32 v63, v63, v184
v_mul_f32 v64, v64, v184
v_mul_f32 v65, v65, v184
v_mul_f32 v66, v66, v184
v_mul_f32 v67, v67, v184
v_mul_f32 v68, v68, v184
v_mul_f32 v69, v69, v184
v_mul_f32 v70, v70, v184
v_mul_f32 v71, v71, v184
v_mul_f32 v72, v72, v184
v_mul_f32 v73, v73, v184
v_mul_f32 v74, v74, v184
v_mul_f32 v75, v75, v184
s_waitcnt lgkmcnt(0)
s_barrier
ds_read_b128 v[148:151], v202 offset:0
ds_read_b128 v[152:155], v202 offset:1024
ds_read_b128 v[156:159], v202 offset:2048
ds_read_b128 v[160:163], v202 offset:3072
ds_read_b64_tr_b16 v[84:85], v196 offset:0
ds_read_b64_tr_b16 v[86:87], v196 offset:4352
ds_read_b64_tr_b16 v[88:89], v196 offset:64
ds_read_b64_tr_b16 v[90:91], v196 offset:4416
ds_read_b64_tr_b16 v[92:93], v196 offset:128
ds_read_b64_tr_b16 v[94:95], v196 offset:4480
ds_read_b64_tr_b16 v[96:97], v196 offset:192
ds_read_b64_tr_b16 v[98:99], v196 offset:4544
ds_read_b64_tr_b16 v[100:101], v196 offset:17408
ds_read_b64_tr_b16 v[102:103], v196 offset:21760
ds_read_b64_tr_b16 v[104:105], v196 offset:17472
ds_read_b64_tr_b16 v[106:107], v196 offset:21824
ds_read_b64_tr_b16 v[108:109], v196 offset:17536
ds_read_b64_tr_b16 v[110:111], v196 offset:21888
ds_read_b64_tr_b16 v[112:113], v196 offset:17600
ds_read_b64_tr_b16 v[114:115], v196 offset:21952
ds_read_b64_tr_b16 v[116:117], v196 offset:34816
ds_read_b64_tr_b16 v[118:119], v196 offset:39168
ds_read_b64_tr_b16 v[120:121], v196 offset:34880
ds_read_b64_tr_b16 v[122:123], v196 offset:39232
ds_read_b64_tr_b16 v[124:125], v196 offset:34944
ds_read_b64_tr_b16 v[126:127], v196 offset:39296
ds_read_b64_tr_b16 v[128:129], v196 offset:35008
ds_read_b64_tr_b16 v[130:131], v196 offset:39360
ds_read_b64_tr_b16 v[132:133], v196 offset:52224
ds_read_b64_tr_b16 v[134:135], v196 offset:56576
ds_read_b64_tr_b16 v[136:137], v196 offset:52288
ds_read_b64_tr_b16 v[138:139], v196 offset:56640
ds_read_b64_tr_b16 v[140:141], v196 offset:52352
ds_read_b64_tr_b16 v[142:143], v196 offset:56704
ds_read_b64_tr_b16 v[144:145], v196 offset:52416
ds_read_b64_tr_b16 v[146:147], v196 offset:56768
s_waitcnt lgkmcnt(15)
v_mfma_f32_32x32x16_bf16 v[12:27], v[84:87], v[148:151], v[12:27]
v_mfma_f32_32x32x16_bf16 v[28:43], v[88:91], v[148:151], v[28:43]
s_add_u32 s6, s13, 2621440
buffer_load_dwordx4 a[192:195], v2, s[52:55], s6 offen nt
v_mfma_f32_32x32x16_bf16 v[44:59], v[92:95], v[148:151], v[44:59]
v_mfma_f32_32x32x16_bf16 v[60:75], v[96:99], v[148:151], v[60:75]
s_add_u32 s6, s13, 2622464
buffer_load_dwordx4 a[196:199], v2, s[52:55], s6 offen nt
s_waitcnt lgkmcnt(15)
v_mfma_f32_32x32x16_bf16 v[12:27], v[100:103], v[152:155], v[12:27]
v_mfma_f32_32x32x16_bf16 v[28:43], v[104:107], v[152:155], v[28:43]
s_add_u32 s6, s13, 2623488
buffer_load_dwordx4 a[200:203], v2, s[52:55], s6 offen nt
v_mfma_f32_32x32x16_bf16 v[44:59], v[108:111], v[152:155], v[44:59]
v_mfma_f32_32x32x16_bf16 v[60:75], v[112:115], v[152:155], v[60:75]
s_add_u32 s6, s13, 2624512
buffer_load_dwordx4 a[204:207], v2, s[52:55], s6 offen nt
s_waitcnt lgkmcnt(8)
v_mfma_f32_32x32x16_bf16 v[12:27], v[116:119], v[156:159], v[12:27]
v_mfma_f32_32x32x16_bf16 v[28:43], v[120:123], v[156:159], v[28:43]
s_add_u32 s6, s13, 2752512
buffer_load_dwordx4 a[208:211], v2, s[52:55], s6 offen nt
v_mfma_f32_32x32x16_bf16 v[44:59], v[124:127], v[156:159], v[44:59]
v_mfma_f32_32x32x16_bf16 v[60:75], v[128:131], v[156:159], v[60:75]
s_add_u32 s6, s13, 2753536
buffer_load_dwordx4 a[212:215], v2, s[52:55], s6 offen nt
s_waitcnt lgkmcnt(0)
v_mfma_f32_32x32x16_bf16 v[12:27], v[132:135], v[160:163], v[12:27]
v_mfma_f32_32x32x16_bf16 v[28:43], v[136:139], v[160:163], v[28:43]
s_add_u32 s6, s13, 2754560
buffer_load_dwordx4 a[216:219], v2, s[52:55], s6 offen nt
v_mfma_f32_32x32x16_bf16 v[44:59], v[140:143], v[160:163], v[44:59]
v_mfma_f32_32x32x16_bf16 v[60:75], v[144:147], v[160:163], v[60:75]
s_add_u32 s6, s13, 2755584
buffer_load_dwordx4 a[220:223], v2, s[52:55], s6 offen nt
ds_read_b128 v[84:87], v195 offset:0
ds_read_b128 v[88:91], v195 offset:64
ds_read_b128 v[92:95], v195 offset:128
ds_read_b128 v[96:99], v195 offset:192
ds_read_b128 v[100:103], v195 offset:256
ds_read_b128 v[104:107], v195 offset:320
ds_read_b128 v[108:111], v195 offset:384
ds_read_b128 v[112:115], v195 offset:448
ds_read_b128 v[116:119], v195 offset:512
ds_read_b128 v[120:123], v195 offset:576
ds_read_b128 v[124:127], v195 offset:640
ds_read_b128 v[128:131], v195 offset:704
ds_read_b128 v[132:135], v195 offset:768
ds_read_b128 v[136:139], v195 offset:832
ds_read_b128 v[140:143], v195 offset:896
ds_read_b128 v[144:147], v195 offset:960
s_waitcnt lgkmcnt(15)
v_mfma_f32_16x16x32_bf16 v[76:79], v[84:87], a[0:3], 0
v_mfma_f32_16x16x32_bf16 v[80:83], v[84:87], a[64:67], 0
s_waitcnt lgkmcnt(14)
v_mfma_f32_16x16x32_bf16 v[76:79], v[88:91], a[4:7], v[76:79]
v_mfma_f32_16x16x32_bf16 v[80:83], v[88:91], a[68:71], v[80:83]
s_add_u32 s6, s13, 2883584
buffer_load_dwordx4 a[224:227], v10, s[52:55], s6 offen nt
s_waitcnt lgkmcnt(13)
v_mfma_f32_16x16x32_bf16 v[76:79], v[92:95], a[8:11], v[76:79]
v_mfma_f32_16x16x32_bf16 v[80:83], v[92:95], a[72:75], v[80:83]
s_waitcnt lgkmcnt(12)
v_mfma_f32_16x16x32_bf16 v[76:79], v[96:99], a[12:15], v[76:79]
v_mfma_f32_16x16x32_bf16 v[80:83], v[96:99], a[76:79], v[80:83]
s_add_u32 s6, s13, 2884608
buffer_load_dwordx4 a[228:231], v10, s[52:55], s6 offen nt
s_waitcnt lgkmcnt(11)
v_mfma_f32_16x16x32_bf16 v[76:79], v[100:103], a[16:19], v[76:79]
v_mfma_f32_16x16x32_bf16 v[80:83], v[100:103], a[80:83], v[80:83]
s_waitcnt lgkmcnt(10)
v_mfma_f32_16x16x32_bf16 v[76:79], v[104:107], a[20:23], v[76:79]
v_mfma_f32_16x16x32_bf16 v[80:83], v[104:107], a[84:87], v[80:83]
s_add_u32 s6, s13, 2885632
buffer_load_dwordx4 a[232:235], v10, s[52:55], s6 offen nt
s_waitcnt lgkmcnt(9)
v_mfma_f32_16x16x32_bf16 v[76:79], v[108:111], a[24:27], v[76:79]
v_mfma_f32_16x16x32_bf16 v[80:83], v[108:111], a[88:91], v[80:83]
s_waitcnt lgkmcnt(8)
v_mfma_f32_16x16x32_bf16 v[76:79], v[112:115], a[28:31], v[76:79]
v_mfma_f32_16x16x32_bf16 v[80:83], v[112:115], a[92:95], v[80:83]
s_add_u32 s6, s13, 2886656
buffer_load_dwordx4 a[236:239], v10, s[52:55], s6 offen nt
s_waitcnt lgkmcnt(7)
v_mfma_f32_16x16x32_bf16 v[76:79], v[116:119], a[32:35], v[76:79]
v_mfma_f32_16x16x32_bf16 v[80:83], v[116:119], a[96:99], v[80:83]
s_waitcnt lgkmcnt(6)
v_mfma_f32_16x16x32_bf16 v[76:79], v[120:123], a[36:39], v[76:79]
v_mfma_f32_16x16x32_bf16 v[80:83], v[120:123], a[100:103], v[80:83]
s_add_u32 s6, s13, 3014656
buffer_load_dwordx4 a[240:243], v10, s[52:55], s6 offen nt
s_waitcnt lgkmcnt(5)
v_mfma_f32_16x16x32_bf16 v[76:79], v[124:127], a[40:43], v[76:79]
v_mfma_f32_16x16x32_bf16 v[80:83], v[124:127], a[104:107], v[80:83]
s_waitcnt lgkmcnt(4)
v_mfma_f32_16x16x32_bf16 v[76:79], v[128:131], a[44:47], v[76:79]
v_mfma_f32_16x16x32_bf16 v[80:83], v[128:131], a[108:111], v[80:83]
s_add_u32 s6, s13, 3015680
buffer_load_dwordx4 a[244:247], v10, s[52:55], s6 offen nt
s_waitcnt lgkmcnt(3)
v_mfma_f32_16x16x32_bf16 v[76:79], v[132:135], a[48:51], v[76:79]
v_mfma_f32_16x16x32_bf16 v[80:83], v[132:135], a[112:115], v[80:83]
s_waitcnt lgkmcnt(2)
v_mfma_f32_16x16x32_bf16 v[76:79], v[136:139], a[52:55], v[76:79]
v_mfma_f32_16x16x32_bf16 v[80:83], v[136:139], a[116:119], v[80:83]
s_add_u32 s6, s13, 3016704
buffer_load_dwordx4 a[248:251], v10, s[52:55], s6 offen nt
s_waitcnt lgkmcnt(1)
v_mfma_f32_16x16x32_bf16 v[76:79], v[140:143], a[56:59], v[76:79]
v_mfma_f32_16x16x32_bf16 v[80:83], v[140:143], a[120:123], v[80:83]
s_waitcnt lgkmcnt(0)
v_mfma_f32_16x16x32_bf16 v[76:79], v[144:147], a[60:63], v[76:79]
v_mfma_f32_16x16x32_bf16 v[80:83], v[144:147], a[124:127], v[80:83]
s_add_u32 s6, s13, 3017728
buffer_load_dwordx4 a[252:255], v10, s[52:55], s6 offen nt
s_nop 4
v_max_f32 v190, v76, v77
v_max3_f32 v190, v190, v78, v79
v_mov_b32 v192, v190
s_nop 1
v_permlane16_swap_b32 v190, v192
v_max_f32 v190, v190, v192
v_mov_b32 v192, v190
s_nop 1
v_permlane32_swap_b32 v190, v192
v_max_f32 v190, v190, v192
ds_write_b32 v198, v190 offset:0
v_max_f32 v191, v80, v81
v_max3_f32 v191, v191, v82, v83
v_mov_b32 v192, v191
s_nop 1
v_permlane16_swap_b32 v191, v192
v_max_f32 v191, v191, v192
v_mov_b32 v192, v191
s_nop 1
v_permlane32_swap_b32 v191, v192
v_max_f32 v191, v191, v192
ds_write_b32 v198, v191 offset:256
s_waitcnt lgkmcnt(0)
s_barrier
ds_read_b128 v[164:167], v199
ds_read_b128 v[168:171], v199 offset:256
ds_read_b128 v[172:175], v200
s_waitcnt vmcnt(16)
ds_write_b128 v206, a[128:131] offset:0
ds_write_b128 v206, a[132:135] offset:1088
ds_write_b128 v206, a[136:139] offset:2176
ds_write_b128 v206, a[140:143] offset:3264
ds_write_b128 v206, a[144:147] offset:4352
ds_write_b128 v206, a[148:151] offset:5440
ds_write_b128 v206, a[152:155] offset:6528
ds_write_b128 v206, a[156:159] offset:7616
ds_write_b128 v206, a[160:163] offset:8704
ds_write_b128 v206, a[164:167] offset:9792
ds_write_b128 v206, a[168:171] offset:10880
ds_write_b128 v206, a[172:175] offset:11968
ds_write_b128 v206, a[176:179] offset:13056
ds_write_b128 v206, a[180:183] offset:14144
ds_write_b128 v206, a[184:187] offset:15232
ds_write_b128 v206, a[188:191] offset:16320
s_waitcnt lgkmcnt(15)
v_max_f32 v164, v164, v165
v_max3_f32 v164, v164, v166, v167
v_mul_f32 v164, v164, v185
v_max_f32 v164, v164, v176
v_sub_f32 v182, v176, v164
v_exp_f32 v182, v182
v_mov_b32 v176, v164
v_max_f32 v168, v168, v169
v_max3_f32 v168, v168, v170, v171
v_mul_f32 v168, v168, v185
v_max_f32 v168, v168, v177
v_sub_f32 v183, v177, v168
v_exp_f32 v183, v183
v_mov_b32 v177, v168
v_max_f32 v172, v172, v173
v_max3_f32 v172, v172, v174, v175
v_mul_f32 v172, v172, v185
v_max_f32 v172, v172, v178
v_sub_f32 v184, v178, v172
v_exp_f32 v184, v184
v_mov_b32 v178, v172
v_fma_f32 v76, v76, v185, -v176
v_fma_f32 v77, v77, v185, -v176
v_fma_f32 v78, v78, v185, -v176
v_fma_f32 v79, v79, v185, -v176
v_exp_f32 v76, v76
v_exp_f32 v77, v77
v_exp_f32 v78, v78
v_exp_f32 v79, v79
v_mul_f32 v180, v180, v182
v_cvt_pk_bf16_f32 v186, v76, v77
v_cvt_pk_bf16_f32 v187, v78, v79
ds_write_b64 v201, v[186:187] offset:0
v_add_f32 v180, v180, v76
v_add_f32 v180, v180, v77
v_add_f32 v180, v180, v78
v_add_f32 v180, v180, v79
v_fma_f32 v80, v80, v185, -v177
v_fma_f32 v81, v81, v185, -v177
v_fma_f32 v82, v82, v185, -v177
v_fma_f32 v83, v83, v185, -v177
v_exp_f32 v80, v80
v_exp_f32 v81, v81
v_exp_f32 v82, v82
v_exp_f32 v83, v83
v_mul_f32 v181, v181, v183
v_cvt_pk_bf16_f32 v188, v80, v81
v_cvt_pk_bf16_f32 v189, v82, v83
ds_write_b64 v201, v[188:189] offset:512
v_add_f32 v181, v181, v80
v_add_f32 v181, v181, v81
v_add_f32 v181, v181, v82
v_add_f32 v181, v181, v83
v_mul_f32 v12, v12, v184
v_mul_f32 v13, v13, v184
v_mul_f32 v14, v14, v184
v_mul_f32 v15, v15, v184
v_mul_f32 v16, v16, v184
v_mul_f32 v17, v17, v184
v_mul_f32 v18, v18, v184
v_mul_f32 v19, v19, v184
v_mul_f32 v20, v20, v184
v_mul_f32 v21, v21, v184
v_mul_f32 v22, v22, v184
v_mul_f32 v23, v23, v184
v_mul_f32 v24, v24, v184
v_mul_f32 v25, v25, v184
v_mul_f32 v26, v26, v184
v_mul_f32 v27, v27, v184
v_mul_f32 v28, v28, v184
v_mul_f32 v29, v29, v184
v_mul_f32 v30, v30, v184
v_mul_f32 v31, v31, v184
v_mul_f32 v32, v32, v184
v_mul_f32 v33, v33, v184
v_mul_f32 v34, v34, v184
v_mul_f32 v35, v35, v184
v_mul_f32 v36, v36, v184
v_mul_f32 v37, v37, v184
v_mul_f32 v38, v38, v184
v_mul_f32 v39, v39, v184
v_mul_f32 v40, v40, v184
v_mul_f32 v41, v41, v184
v_mul_f32 v42, v42, v184
v_mul_f32 v43, v43, v184
v_mul_f32 v44, v44, v184
v_mul_f32 v45, v45, v184
v_mul_f32 v46, v46, v184
v_mul_f32 v47, v47, v184
v_mul_f32 v48, v48, v184
v_mul_f32 v49, v49, v184
v_mul_f32 v50, v50, v184
v_mul_f32 v51, v51, v184
v_mul_f32 v52, v52, v184
v_mul_f32 v53, v53, v184
v_mul_f32 v54, v54, v184
v_mul_f32 v55, v55, v184
v_mul_f32 v56, v56, v184
v_mul_f32 v57, v57, v184
v_mul_f32 v58, v58, v184
v_mul_f32 v59, v59, v184
v_mul_f32 v60, v60, v184
v_mul_f32 v61, v61, v184
v_mul_f32 v62, v62, v184
v_mul_f32 v63, v63, v184
v_mul_f32 v64, v64, v184
v_mul_f32 v65, v65, v184
v_mul_f32 v66, v66, v184
v_mul_f32 v67, v67, v184
v_mul_f32 v68, v68, v184
v_mul_f32 v69, v69, v184
v_mul_f32 v70, v70, v184
v_mul_f32 v71, v71, v184
v_mul_f32 v72, v72, v184
v_mul_f32 v73, v73, v184
v_mul_f32 v74, v74, v184
v_mul_f32 v75, v75, v184
s_waitcnt lgkmcnt(0)
s_barrier
ds_read_b128 v[148:151], v202 offset:0
ds_read_b128 v[152:155], v202 offset:1024
ds_read_b128 v[156:159], v202 offset:2048
ds_read_b128 v[160:163], v202 offset:3072
ds_read_b64_tr_b16 v[84:85], v197 offset:0
ds_read_b64_tr_b16 v[86:87], v197 offset:4352
ds_read_b64_tr_b16 v[88:89], v197 offset:64
ds_read_b64_tr_b16 v[90:91], v197 offset:4416
ds_read_b64_tr_b16 v[92:93], v197 offset:128
ds_read_b64_tr_b16 v[94:95], v197 offset:4480
ds_read_b64_tr_b16 v[96:97], v197 offset:192
ds_read_b64_tr_b16 v[98:99], v197 offset:4544
ds_read_b64_tr_b16 v[100:101], v197 offset:17408
ds_read_b64_tr_b16 v[102:103], v197 offset:21760
ds_read_b64_tr_b16 v[104:105], v197 offset:17472
ds_read_b64_tr_b16 v[106:107], v197 offset:21824
ds_read_b64_tr_b16 v[108:109], v197 offset:17536
ds_read_b64_tr_b16 v[110:111], v197 offset:21888
ds_read_b64_tr_b16 v[112:113], v197 offset:17600
ds_read_b64_tr_b16 v[114:115], v197 offset:21952
ds_read_b64_tr_b16 v[116:117], v197 offset:34816
ds_read_b64_tr_b16 v[118:119], v197 offset:39168
ds_read_b64_tr_b16 v[120:121], v197 offset:34880
ds_read_b64_tr_b16 v[122:123], v197 offset:39232
ds_read_b64_tr_b16 v[124:125], v197 offset:34944
ds_read_b64_tr_b16 v[126:127], v197 offset:39296
ds_read_b64_tr_b16 v[128:129], v197 offset:35008
ds_read_b64_tr_b16 v[130:131], v197 offset:39360
ds_read_b64_tr_b16 v[132:133], v197 offset:52224
ds_read_b64_tr_b16 v[134:135], v197 offset:56576
ds_read_b64_tr_b16 v[136:137], v197 offset:52288
ds_read_b64_tr_b16 v[138:139], v197 offset:56640
ds_read_b64_tr_b16 v[140:141], v197 offset:52352
ds_read_b64_tr_b16 v[142:143], v197 offset:56704
ds_read_b64_tr_b16 v[144:145], v197 offset:52416
ds_read_b64_tr_b16 v[146:147], v197 offset:56768
s_waitcnt lgkmcnt(15)
v_mfma_f32_32x32x16_bf16 v[12:27], v[84:87], v[148:151], v[12:27]
v_mfma_f32_32x32x16_bf16 v[28:43], v[88:91], v[148:151], v[28:43]
s_add_u32 s6, s13, 3145728
buffer_load_dwordx4 a[128:131], v2, s[52:55], s6 offen nt
v_mfma_f32_32x32x16_bf16 v[44:59], v[92:95], v[148:151], v[44:59]
v_mfma_f32_32x32x16_bf16 v[60:75], v[96:99], v[148:151], v[60:75]
s_add_u32 s6, s13, 3146752
buffer_load_dwordx4 a[132:135], v2, s[52:55], s6 offen nt
s_waitcnt lgkmcnt(15)
v_mfma_f32_32x32x16_bf16 v[12:27], v[100:103], v[152:155], v[12:27]
v_mfma_f32_32x32x16_bf16 v[28:43], v[104:107], v[152:155], v[28:43]
s_add_u32 s6, s13, 3147776
buffer_load_dwordx4 a[136:139], v2, s[52:55], s6 offen nt
v_mfma_f32_32x32x16_bf16 v[44:59], v[108:111], v[152:155], v[44:59]
v_mfma_f32_32x32x16_bf16 v[60:75], v[112:115], v[152:155], v[60:75]
s_add_u32 s6, s13, 3148800
buffer_load_dwordx4 a[140:143], v2, s[52:55], s6 offen nt
s_waitcnt lgkmcnt(8)
v_mfma_f32_32x32x16_bf16 v[12:27], v[116:119], v[156:159], v[12:27]
v_mfma_f32_32x32x16_bf16 v[28:43], v[120:123], v[156:159], v[28:43]
s_add_u32 s6, s13, 3276800
buffer_load_dwordx4 a[144:147], v2, s[52:55], s6 offen nt
v_mfma_f32_32x32x16_bf16 v[44:59], v[124:127], v[156:159], v[44:59]
v_mfma_f32_32x32x16_bf16 v[60:75], v[128:131], v[156:159], v[60:75]
s_add_u32 s6, s13, 3277824
buffer_load_dwordx4 a[148:151], v2, s[52:55], s6 offen nt
s_waitcnt lgkmcnt(0)
v_mfma_f32_32x32x16_bf16 v[12:27], v[132:135], v[160:163], v[12:27]
v_mfma_f32_32x32x16_bf16 v[28:43], v[136:139], v[160:163], v[28:43]
s_add_u32 s6, s13, 3278848
buffer_load_dwordx4 a[152:155], v2, s[52:55], s6 offen nt
v_mfma_f32_32x32x16_bf16 v[44:59], v[140:143], v[160:163], v[44:59]
v_mfma_f32_32x32x16_bf16 v[60:75], v[144:147], v[160:163], v[60:75]
s_add_u32 s6, s13, 3279872
buffer_load_dwordx4 a[156:159], v2, s[52:55], s6 offen nt
ds_read_b128 v[84:87], v194 offset:0
ds_read_b128 v[88:91], v194 offset:64
ds_read_b128 v[92:95], v194 offset:128
ds_read_b128 v[96:99], v194 offset:192
ds_read_b128 v[100:103], v194 offset:256
ds_read_b128 v[104:107], v194 offset:320
ds_read_b128 v[108:111], v194 offset:384
ds_read_b128 v[112:115], v194 offset:448
ds_read_b128 v[116:119], v194 offset:512
ds_read_b128 v[120:123], v194 offset:576
ds_read_b128 v[124:127], v194 offset:640
ds_read_b128 v[128:131], v194 offset:704
ds_read_b128 v[132:135], v194 offset:768
ds_read_b128 v[136:139], v194 offset:832
ds_read_b128 v[140:143], v194 offset:896
ds_read_b128 v[144:147], v194 offset:960
s_waitcnt lgkmcnt(15)
v_mfma_f32_16x16x32_bf16 v[76:79], v[84:87], a[0:3], 0
v_mfma_f32_16x16x32_bf16 v[80:83], v[84:87], a[64:67], 0
s_waitcnt lgkmcnt(14)
v_mfma_f32_16x16x32_bf16 v[76:79], v[88:91], a[4:7], v[76:79]
v_mfma_f32_16x16x32_bf16 v[80:83], v[88:91], a[68:71], v[80:83]
s_add_u32 s6, s13, 3407872
buffer_load_dwordx4 a[160:163], v10, s[52:55], s6 offen nt
s_waitcnt lgkmcnt(13)
v_mfma_f32_16x16x32_bf16 v[76:79], v[92:95], a[8:11], v[76:79]
v_mfma_f32_16x16x32_bf16 v[80:83], v[92:95], a[72:75], v[80:83]
s_waitcnt lgkmcnt(12)
v_mfma_f32_16x16x32_bf16 v[76:79], v[96:99], a[12:15], v[76:79]
v_mfma_f32_16x16x32_bf16 v[80:83], v[96:99], a[76:79], v[80:83]
s_add_u32 s6, s13, 3408896
buffer_load_dwordx4 a[164:167], v10, s[52:55], s6 offen nt
s_waitcnt lgkmcnt(11)
v_mfma_f32_16x16x32_bf16 v[76:79], v[100:103], a[16:19], v[76:79]
v_mfma_f32_16x16x32_bf16 v[80:83], v[100:103], a[80:83], v[80:83]
s_waitcnt lgkmcnt(10)
v_mfma_f32_16x16x32_bf16 v[76:79], v[104:107], a[20:23], v[76:79]
v_mfma_f32_16x16x32_bf16 v[80:83], v[104:107], a[84:87], v[80:83]
s_add_u32 s6, s13, 3409920
buffer_load_dwordx4 a[168:171], v10, s[52:55], s6 offen nt
s_waitcnt lgkmcnt(9)
v_mfma_f32_16x16x32_bf16 v[76:79], v[108:111], a[24:27], v[76:79]
v_mfma_f32_16x16x32_bf16 v[80:83], v[108:111], a[88:91], v[80:83]
s_waitcnt lgkmcnt(8)
v_mfma_f32_16x16x32_bf16 v[76:79], v[112:115], a[28:31], v[76:79]
v_mfma_f32_16x16x32_bf16 v[80:83], v[112:115], a[92:95], v[80:83]
s_add_u32 s6, s13, 3410944
buffer_load_dwordx4 a[172:175], v10, s[52:55], s6 offen nt
s_waitcnt lgkmcnt(7)
v_mfma_f32_16x16x32_bf16 v[76:79], v[116:119], a[32:35], v[76:79]
v_mfma_f32_16x16x32_bf16 v[80:83], v[116:119], a[96:99], v[80:83]
s_waitcnt lgkmcnt(6)
v_mfma_f32_16x16x32_bf16 v[76:79], v[120:123], a[36:39], v[76:79]
v_mfma_f32_16x16x32_bf16 v[80:83], v[120:123], a[100:103], v[80:83]
s_add_u32 s6, s13, 3538944
buffer_load_dwordx4 a[176:179], v10, s[52:55], s6 offen nt
s_waitcnt lgkmcnt(5)
v_mfma_f32_16x16x32_bf16 v[76:79], v[124:127], a[40:43], v[76:79]
v_mfma_f32_16x16x32_bf16 v[80:83], v[124:127], a[104:107], v[80:83]
s_waitcnt lgkmcnt(4)
v_mfma_f32_16x16x32_bf16 v[76:79], v[128:131], a[44:47], v[76:79]
v_mfma_f32_16x16x32_bf16 v[80:83], v[128:131], a[108:111], v[80:83]
s_add_u32 s6, s13, 3539968
buffer_load_dwordx4 a[180:183], v10, s[52:55], s6 offen nt
s_waitcnt lgkmcnt(3)
v_mfma_f32_16x16x32_bf16 v[76:79], v[132:135], a[48:51], v[76:79]
v_mfma_f32_16x16x32_bf16 v[80:83], v[132:135], a[112:115], v[80:83]
s_waitcnt lgkmcnt(2)
v_mfma_f32_16x16x32_bf16 v[76:79], v[136:139], a[52:55], v[76:79]
v_mfma_f32_16x16x32_bf16 v[80:83], v[136:139], a[116:119], v[80:83]
s_add_u32 s6, s13, 3540992
buffer_load_dwordx4 a[184:187], v10, s[52:55], s6 offen nt
s_waitcnt lgkmcnt(1)
v_mfma_f32_16x16x32_bf16 v[76:79], v[140:143], a[56:59], v[76:79]
v_mfma_f32_16x16x32_bf16 v[80:83], v[140:143], a[120:123], v[80:83]
s_waitcnt lgkmcnt(0)
v_mfma_f32_16x16x32_bf16 v[76:79], v[144:147], a[60:63], v[76:79]
v_mfma_f32_16x16x32_bf16 v[80:83], v[144:147], a[124:127], v[80:83]
s_add_u32 s6, s13, 3542016
buffer_load_dwordx4 a[188:191], v10, s[52:55], s6 offen nt
s_nop 4
v_max_f32 v190, v76, v77
v_max3_f32 v190, v190, v78, v79
v_mov_b32 v192, v190
s_nop 1
v_permlane16_swap_b32 v190, v192
v_max_f32 v190, v190, v192
v_mov_b32 v192, v190
s_nop 1
v_permlane32_swap_b32 v190, v192
v_max_f32 v190, v190, v192
ds_write_b32 v198, v190 offset:0
v_max_f32 v191, v80, v81
v_max3_f32 v191, v191, v82, v83
v_mov_b32 v192, v191
s_nop 1
v_permlane16_swap_b32 v191, v192
v_max_f32 v191, v191, v192
v_mov_b32 v192, v191
s_nop 1
v_permlane32_swap_b32 v191, v192
v_max_f32 v191, v191, v192
ds_write_b32 v198, v191 offset:256
s_waitcnt lgkmcnt(0)
s_barrier
ds_read_b128 v[164:167], v199
ds_read_b128 v[168:171], v199 offset:256
ds_read_b128 v[172:175], v200
s_waitcnt vmcnt(16)
ds_write_b128 v207, a[192:195] offset:0
ds_write_b128 v207, a[196:199] offset:1088
ds_write_b128 v207, a[200:203] offset:2176
ds_write_b128 v207, a[204:207] offset:3264
ds_write_b128 v207, a[208:211] offset:4352
ds_write_b128 v207, a[212:215] offset:5440
ds_write_b128 v207, a[216:219] offset:6528
ds_write_b128 v207, a[220:223] offset:7616
ds_write_b128 v207, a[224:227] offset:8704
ds_write_b128 v207, a[228:231] offset:9792
ds_write_b128 v207, a[232:235] offset:10880
ds_write_b128 v207, a[236:239] offset:11968
ds_write_b128 v207, a[240:243] offset:13056
ds_write_b128 v207, a[244:247] offset:14144
ds_write_b128 v207, a[248:251] offset:15232
ds_write_b128 v207, a[252:255] offset:16320
s_waitcnt lgkmcnt(15)
v_max_f32 v164, v164, v165
v_max3_f32 v164, v164, v166, v167
v_mul_f32 v164, v164, v185
v_max_f32 v164, v164, v176
v_sub_f32 v182, v176, v164
v_exp_f32 v182, v182
v_mov_b32 v176, v164
v_max_f32 v168, v168, v169
v_max3_f32 v168, v168, v170, v171
v_mul_f32 v168, v168, v185
v_max_f32 v168, v168, v177
v_sub_f32 v183, v177, v168
v_exp_f32 v183, v183
v_mov_b32 v177, v168
v_max_f32 v172, v172, v173
v_max3_f32 v172, v172, v174, v175
v_mul_f32 v172, v172, v185
v_max_f32 v172, v172, v178
v_sub_f32 v184, v178, v172
v_exp_f32 v184, v184
v_mov_b32 v178, v172
v_fma_f32 v76, v76, v185, -v176
v_fma_f32 v77, v77, v185, -v176
v_fma_f32 v78, v78, v185, -v176
v_fma_f32 v79, v79, v185, -v176
v_exp_f32 v76, v76
v_exp_f32 v77, v77
v_exp_f32 v78, v78
v_exp_f32 v79, v79
v_mul_f32 v180, v180, v182
v_cvt_pk_bf16_f32 v186, v76, v77
v_cvt_pk_bf16_f32 v187, v78, v79
ds_write_b64 v201, v[186:187] offset:0
v_add_f32 v180, v180, v76
v_add_f32 v180, v180, v77
v_add_f32 v180, v180, v78
v_add_f32 v180, v180, v79
v_fma_f32 v80, v80, v185, -v177
v_fma_f32 v81, v81, v185, -v177
v_fma_f32 v82, v82, v185, -v177
v_fma_f32 v83, v83, v185, -v177
v_exp_f32 v80, v80
v_exp_f32 v81, v81
v_exp_f32 v82, v82
v_exp_f32 v83, v83
v_mul_f32 v181, v181, v183
v_cvt_pk_bf16_f32 v188, v80, v81
v_cvt_pk_bf16_f32 v189, v82, v83
ds_write_b64 v201, v[188:189] offset:512
v_add_f32 v181, v181, v80
v_add_f32 v181, v181, v81
v_add_f32 v181, v181, v82
v_add_f32 v181, v181, v83
v_mul_f32 v12, v12, v184
v_mul_f32 v13, v13, v184
v_mul_f32 v14, v14, v184
v_mul_f32 v15, v15, v184
v_mul_f32 v16, v16, v184
v_mul_f32 v17, v17, v184
v_mul_f32 v18, v18, v184
v_mul_f32 v19, v19, v184
v_mul_f32 v20, v20, v184
v_mul_f32 v21, v21, v184
v_mul_f32 v22, v22, v184
v_mul_f32 v23, v23, v184
v_mul_f32 v24, v24, v184
v_mul_f32 v25, v25, v184
v_mul_f32 v26, v26, v184
v_mul_f32 v27, v27, v184
v_mul_f32 v28, v28, v184
v_mul_f32 v29, v29, v184
v_mul_f32 v30, v30, v184
v_mul_f32 v31, v31, v184
v_mul_f32 v32, v32, v184
v_mul_f32 v33, v33, v184
v_mul_f32 v34, v34, v184
v_mul_f32 v35, v35, v184
v_mul_f32 v36, v36, v184
v_mul_f32 v37, v37, v184
v_mul_f32 v38, v38, v184
v_mul_f32 v39, v39, v184
v_mul_f32 v40, v40, v184
v_mul_f32 v41, v41, v184
v_mul_f32 v42, v42, v184
v_mul_f32 v43, v43, v184
v_mul_f32 v44, v44, v184
v_mul_f32 v45, v45, v184
v_mul_f32 v46, v46, v184
v_mul_f32 v47, v47, v184
v_mul_f32 v48, v48, v184
v_mul_f32 v49, v49, v184
v_mul_f32 v50, v50, v184
v_mul_f32 v51, v51, v184
v_mul_f32 v52, v52, v184
v_mul_f32 v53, v53, v184
v_mul_f32 v54, v54, v184
v_mul_f32 v55, v55, v184
v_mul_f32 v56, v56, v184
v_mul_f32 v57, v57, v184
v_mul_f32 v58, v58, v184
v_mul_f32 v59, v59, v184
v_mul_f32 v60, v60, v184
v_mul_f32 v61, v61, v184
v_mul_f32 v62, v62, v184
v_mul_f32 v63, v63, v184
v_mul_f32 v64, v64, v184
v_mul_f32 v65, v65, v184
v_mul_f32 v66, v66, v184
v_mul_f32 v67, v67, v184
v_mul_f32 v68, v68, v184
v_mul_f32 v69, v69, v184
v_mul_f32 v70, v70, v184
v_mul_f32 v71, v71, v184
v_mul_f32 v72, v72, v184
v_mul_f32 v73, v73, v184
v_mul_f32 v74, v74, v184
v_mul_f32 v75, v75, v184
s_waitcnt lgkmcnt(0)
s_barrier
ds_read_b128 v[148:151], v202 offset:0
ds_read_b128 v[152:155], v202 offset:1024
ds_read_b128 v[156:159], v202 offset:2048
ds_read_b128 v[160:163], v202 offset:3072
ds_read_b64_tr_b16 v[84:85], v196 offset:0
ds_read_b64_tr_b16 v[86:87], v196 offset:4352
ds_read_b64_tr_b16 v[88:89], v196 offset:64
ds_read_b64_tr_b16 v[90:91], v196 offset:4416
ds_read_b64_tr_b16 v[92:93], v196 offset:128
ds_read_b64_tr_b16 v[94:95], v196 offset:4480
ds_read_b64_tr_b16 v[96:97], v196 offset:192
ds_read_b64_tr_b16 v[98:99], v196 offset:4544
ds_read_b64_tr_b16 v[100:101], v196 offset:17408
ds_read_b64_tr_b16 v[102:103], v196 offset:21760
ds_read_b64_tr_b16 v[104:105], v196 offset:17472
ds_read_b64_tr_b16 v[106:107], v196 offset:21824
ds_read_b64_tr_b16 v[108:109], v196 offset:17536
ds_read_b64_tr_b16 v[110:111], v196 offset:21888
ds_read_b64_tr_b16 v[112:113], v196 offset:17600
ds_read_b64_tr_b16 v[114:115], v196 offset:21952
ds_read_b64_tr_b16 v[116:117], v196 offset:34816
ds_read_b64_tr_b16 v[118:119], v196 offset:39168
ds_read_b64_tr_b16 v[120:121], v196 offset:34880
ds_read_b64_tr_b16 v[122:123], v196 offset:39232
ds_read_b64_tr_b16 v[124:125], v196 offset:34944
ds_read_b64_tr_b16 v[126:127], v196 offset:39296
ds_read_b64_tr_b16 v[128:129], v196 offset:35008
ds_read_b64_tr_b16 v[130:131], v196 offset:39360
ds_read_b64_tr_b16 v[132:133], v196 offset:52224
ds_read_b64_tr_b16 v[134:135], v196 offset:56576
ds_read_b64_tr_b16 v[136:137], v196 offset:52288
ds_read_b64_tr_b16 v[138:139], v196 offset:56640
ds_read_b64_tr_b16 v[140:141], v196 offset:52352
ds_read_b64_tr_b16 v[142:143], v196 offset:56704
ds_read_b64_tr_b16 v[144:145], v196 offset:52416
ds_read_b64_tr_b16 v[146:147], v196 offset:56768
s_waitcnt lgkmcnt(15)
v_mfma_f32_32x32x16_bf16 v[12:27], v[84:87], v[148:151], v[12:27]
v_mfma_f32_32x32x16_bf16 v[28:43], v[88:91], v[148:151], v[28:43]
s_add_u32 s6, s13, 3670016
buffer_load_dwordx4 a[192:195], v2, s[52:55], s6 offen nt
v_mfma_f32_32x32x16_bf16 v[44:59], v[92:95], v[148:151], v[44:59]
v_mfma_f32_32x32x16_bf16 v[60:75], v[96:99], v[148:151], v[60:75]
s_add_u32 s6, s13, 3671040
buffer_load_dwordx4 a[196:199], v2, s[52:55], s6 offen nt
s_waitcnt lgkmcnt(15)
v_mfma_f32_32x32x16_bf16 v[12:27], v[100:103], v[152:155], v[12:27]
v_mfma_f32_32x32x16_bf16 v[28:43], v[104:107], v[152:155], v[28:43]
s_add_u32 s6, s13, 3672064
buffer_load_dwordx4 a[200:203], v2, s[52:55], s6 offen nt
v_mfma_f32_32x32x16_bf16 v[44:59], v[108:111], v[152:155], v[44:59]
v_mfma_f32_32x32x16_bf16 v[60:75], v[112:115], v[152:155], v[60:75]
s_add_u32 s6, s13, 3673088
buffer_load_dwordx4 a[204:207], v2, s[52:55], s6 offen nt
s_waitcnt lgkmcnt(8)
v_mfma_f32_32x32x16_bf16 v[12:27], v[116:119], v[156:159], v[12:27]
v_mfma_f32_32x32x16_bf16 v[28:43], v[120:123], v[156:159], v[28:43]
s_add_u32 s6, s13, 3801088
buffer_load_dwordx4 a[208:211], v2, s[52:55], s6 offen nt
v_mfma_f32_32x32x16_bf16 v[44:59], v[124:127], v[156:159], v[44:59]
v_mfma_f32_32x32x16_bf16 v[60:75], v[128:131], v[156:159], v[60:75]
s_add_u32 s6, s13, 3802112
buffer_load_dwordx4 a[212:215], v2, s[52:55], s6 offen nt
s_waitcnt lgkmcnt(0)
v_mfma_f32_32x32x16_bf16 v[12:27], v[132:135], v[160:163], v[12:27]
v_mfma_f32_32x32x16_bf16 v[28:43], v[136:139], v[160:163], v[28:43]
s_add_u32 s6, s13, 3803136
buffer_load_dwordx4 a[216:219], v2, s[52:55], s6 offen nt
v_mfma_f32_32x32x16_bf16 v[44:59], v[140:143], v[160:163], v[44:59]
v_mfma_f32_32x32x16_bf16 v[60:75], v[144:147], v[160:163], v[60:75]
s_add_u32 s6, s13, 3804160
buffer_load_dwordx4 a[220:223], v2, s[52:55], s6 offen nt
ds_read_b128 v[84:87], v195 offset:0
ds_read_b128 v[88:91], v195 offset:64
ds_read_b128 v[92:95], v195 offset:128
ds_read_b128 v[96:99], v195 offset:192
ds_read_b128 v[100:103], v195 offset:256
ds_read_b128 v[104:107], v195 offset:320
ds_read_b128 v[108:111], v195 offset:384
ds_read_b128 v[112:115], v195 offset:448
ds_read_b128 v[116:119], v195 offset:512
ds_read_b128 v[120:123], v195 offset:576
ds_read_b128 v[124:127], v195 offset:640
ds_read_b128 v[128:131], v195 offset:704
ds_read_b128 v[132:135], v195 offset:768
ds_read_b128 v[136:139], v195 offset:832
ds_read_b128 v[140:143], v195 offset:896
ds_read_b128 v[144:147], v195 offset:960
s_waitcnt lgkmcnt(15)
v_mfma_f32_16x16x32_bf16 v[76:79], v[84:87], a[0:3], 0
v_mfma_f32_16x16x32_bf16 v[80:83], v[84:87], a[64:67], 0
s_waitcnt lgkmcnt(14)
v_mfma_f32_16x16x32_bf16 v[76:79], v[88:91], a[4:7], v[76:79]
v_mfma_f32_16x16x32_bf16 v[80:83], v[88:91], a[68:71], v[80:83]
s_add_u32 s6, s13, 3932160
buffer_load_dwordx4 a[224:227], v10, s[52:55], s6 offen nt
s_waitcnt lgkmcnt(13)
v_mfma_f32_16x16x32_bf16 v[76:79], v[92:95], a[8:11], v[76:79]
v_mfma_f32_16x16x32_bf16 v[80:83], v[92:95], a[72:75], v[80:83]
s_waitcnt lgkmcnt(12)
v_mfma_f32_16x16x32_bf16 v[76:79], v[96:99], a[12:15], v[76:79]
v_mfma_f32_16x16x32_bf16 v[80:83], v[96:99], a[76:79], v[80:83]
s_add_u32 s6, s13, 3933184
buffer_load_dwordx4 a[228:231], v10, s[52:55], s6 offen nt
s_waitcnt lgkmcnt(11)
v_mfma_f32_16x16x32_bf16 v[76:79], v[100:103], a[16:19], v[76:79]
v_mfma_f32_16x16x32_bf16 v[80:83], v[100:103], a[80:83], v[80:83]
s_waitcnt lgkmcnt(10)
v_mfma_f32_16x16x32_bf16 v[76:79], v[104:107], a[20:23], v[76:79]
v_mfma_f32_16x16x32_bf16 v[80:83], v[104:107], a[84:87], v[80:83]
s_add_u32 s6, s13, 3934208
buffer_load_dwordx4 a[232:235], v10, s[52:55], s6 offen nt
s_waitcnt lgkmcnt(9)
v_mfma_f32_16x16x32_bf16 v[76:79], v[108:111], a[24:27], v[76:79]
v_mfma_f32_16x16x32_bf16 v[80:83], v[108:111], a[88:91], v[80:83]
s_waitcnt lgkmcnt(8)
v_mfma_f32_16x16x32_bf16 v[76:79], v[112:115], a[28:31], v[76:79]
v_mfma_f32_16x16x32_bf16 v[80:83], v[112:115], a[92:95], v[80:83]
s_add_u32 s6, s13, 3935232
buffer_load_dwordx4 a[236:239], v10, s[52:55], s6 offen nt
s_waitcnt lgkmcnt(7)
v_mfma_f32_16x16x32_bf16 v[76:79], v[116:119], a[32:35], v[76:79]
v_mfma_f32_16x16x32_bf16 v[80:83], v[116:119], a[96:99], v[80:83]
s_waitcnt lgkmcnt(6)
v_mfma_f32_16x16x32_bf16 v[76:79], v[120:123], a[36:39], v[76:79]
v_mfma_f32_16x16x32_bf16 v[80:83], v[120:123], a[100:103], v[80:83]
s_add_u32 s6, s13, 4063232
buffer_load_dwordx4 a[240:243], v10, s[52:55], s6 offen nt
s_waitcnt lgkmcnt(5)
v_mfma_f32_16x16x32_bf16 v[76:79], v[124:127], a[40:43], v[76:79]
v_mfma_f32_16x16x32_bf16 v[80:83], v[124:127], a[104:107], v[80:83]
s_waitcnt lgkmcnt(4)
v_mfma_f32_16x16x32_bf16 v[76:79], v[128:131], a[44:47], v[76:79]
v_mfma_f32_16x16x32_bf16 v[80:83], v[128:131], a[108:111], v[80:83]
s_add_u32 s6, s13, 4064256
buffer_load_dwordx4 a[244:247], v10, s[52:55], s6 offen nt
s_waitcnt lgkmcnt(3)
v_mfma_f32_16x16x32_bf16 v[76:79], v[132:135], a[48:51], v[76:79]
v_mfma_f32_16x16x32_bf16 v[80:83], v[132:135], a[112:115], v[80:83]
s_waitcnt lgkmcnt(2)
v_mfma_f32_16x16x32_bf16 v[76:79], v[136:139], a[52:55], v[76:79]
v_mfma_f32_16x16x32_bf16 v[80:83], v[136:139], a[116:119], v[80:83]
s_add_u32 s6, s13, 4065280
buffer_load_dwordx4 a[248:251], v10, s[52:55], s6 offen nt
s_waitcnt lgkmcnt(1)
v_mfma_f32_16x16x32_bf16 v[76:79], v[140:143], a[56:59], v[76:79]
v_mfma_f32_16x16x32_bf16 v[80:83], v[140:143], a[120:123], v[80:83]
s_waitcnt lgkmcnt(0)
v_mfma_f32_16x16x32_bf16 v[76:79], v[144:147], a[60:63], v[76:79]
v_mfma_f32_16x16x32_bf16 v[80:83], v[144:147], a[124:127], v[80:83]
s_add_u32 s6, s13, 4066304
buffer_load_dwordx4 a[252:255], v10, s[52:55], s6 offen nt
s_nop 4
v_max_f32 v190, v76, v77
v_max3_f32 v190, v190, v78, v79
v_mov_b32 v192, v190
s_nop 1
v_permlane16_swap_b32 v190, v192
v_max_f32 v190, v190, v192
v_mov_b32 v192, v190
s_nop 1
v_permlane32_swap_b32 v190, v192
v_max_f32 v190, v190, v192
ds_write_b32 v198, v190 offset:0
v_max_f32 v191, v80, v81
v_max3_f32 v191, v191, v82, v83
v_mov_b32 v192, v191
s_nop 1
v_permlane16_swap_b32 v191, v192
v_max_f32 v191, v191, v192
v_mov_b32 v192, v191
s_nop 1
v_permlane32_swap_b32 v191, v192
v_max_f32 v191, v191, v192
ds_write_b32 v198, v191 offset:256
s_waitcnt lgkmcnt(0)
s_barrier
ds_read_b128 v[164:167], v199
ds_read_b128 v[168:171], v199 offset:256
ds_read_b128 v[172:175], v200
s_waitcnt vmcnt(16)
ds_write_b128 v206, a[128:131] offset:0
ds_write_b128 v206, a[132:135] offset:1088
ds_write_b128 v206, a[136:139] offset:2176
ds_write_b128 v206, a[140:143] offset:3264
ds_write_b128 v206, a[144:147] offset:4352
ds_write_b128 v206, a[148:151] offset:5440
ds_write_b128 v206, a[152:155] offset:6528
ds_write_b128 v206, a[156:159] offset:7616
ds_write_b128 v206, a[160:163] offset:8704
ds_write_b128 v206, a[164:167] offset:9792
ds_write_b128 v206, a[168:171] offset:10880
ds_write_b128 v206, a[172:175] offset:11968
ds_write_b128 v206, a[176:179] offset:13056
ds_write_b128 v206, a[180:183] offset:14144
ds_write_b128 v206, a[184:187] offset:15232
ds_write_b128 v206, a[188:191] offset:16320
s_waitcnt lgkmcnt(15)
v_max_f32 v164, v164, v165
v_max3_f32 v164, v164, v166, v167
v_mul_f32 v164, v164, v185
v_max_f32 v164, v164, v176
v_sub_f32 v182, v176, v164
v_exp_f32 v182, v182
v_mov_b32 v176, v164
v_max_f32 v168, v168, v169
v_max3_f32 v168, v168, v170, v171
v_mul_f32 v168, v168, v185
v_max_f32 v168, v168, v177
v_sub_f32 v183, v177, v168
v_exp_f32 v183, v183
v_mov_b32 v177, v168
v_max_f32 v172, v172, v173
v_max3_f32 v172, v172, v174, v175
v_mul_f32 v172, v172, v185
v_max_f32 v172, v172, v178
v_sub_f32 v184, v178, v172
v_exp_f32 v184, v184
v_mov_b32 v178, v172
v_fma_f32 v76, v76, v185, -v176
v_fma_f32 v77, v77, v185, -v176
v_fma_f32 v78, v78, v185, -v176
v_fma_f32 v79, v79, v185, -v176
v_exp_f32 v76, v76
v_exp_f32 v77, v77
v_exp_f32 v78, v78
v_exp_f32 v79, v79
v_mul_f32 v180, v180, v182
v_cvt_pk_bf16_f32 v186, v76, v77
v_cvt_pk_bf16_f32 v187, v78, v79
ds_write_b64 v201, v[186:187] offset:0
v_add_f32 v180, v180, v76
v_add_f32 v180, v180, v77
v_add_f32 v180, v180, v78
v_add_f32 v180, v180, v79
v_fma_f32 v80, v80, v185, -v177
v_fma_f32 v81, v81, v185, -v177
v_fma_f32 v82, v82, v185, -v177
v_fma_f32 v83, v83, v185, -v177
v_exp_f32 v80, v80
v_exp_f32 v81, v81
v_exp_f32 v82, v82
v_exp_f32 v83, v83
v_mul_f32 v181, v181, v183
v_cvt_pk_bf16_f32 v188, v80, v81
v_cvt_pk_bf16_f32 v189, v82, v83
ds_write_b64 v201, v[188:189] offset:512
v_add_f32 v181, v181, v80
v_add_f32 v181, v181, v81
v_add_f32 v181, v181, v82
v_add_f32 v181, v181, v83
v_mul_f32 v12, v12, v184
v_mul_f32 v13, v13, v184
v_mul_f32 v14, v14, v184
v_mul_f32 v15, v15, v184
v_mul_f32 v16, v16, v184
v_mul_f32 v17, v17, v184
v_mul_f32 v18, v18, v184
v_mul_f32 v19, v19, v184
v_mul_f32 v20, v20, v184
v_mul_f32 v21, v21, v184
v_mul_f32 v22, v22, v184
v_mul_f32 v23, v23, v184
v_mul_f32 v24, v24, v184
v_mul_f32 v25, v25, v184
v_mul_f32 v26, v26, v184
v_mul_f32 v27, v27, v184
v_mul_f32 v28, v28, v184
v_mul_f32 v29, v29, v184
v_mul_f32 v30, v30, v184
v_mul_f32 v31, v31, v184
v_mul_f32 v32, v32, v184
v_mul_f32 v33, v33, v184
v_mul_f32 v34, v34, v184
v_mul_f32 v35, v35, v184
v_mul_f32 v36, v36, v184
v_mul_f32 v37, v37, v184
v_mul_f32 v38, v38, v184
v_mul_f32 v39, v39, v184
v_mul_f32 v40, v40, v184
v_mul_f32 v41, v41, v184
v_mul_f32 v42, v42, v184
v_mul_f32 v43, v43, v184
v_mul_f32 v44, v44, v184
v_mul_f32 v45, v45, v184
v_mul_f32 v46, v46, v184
v_mul_f32 v47, v47, v184
v_mul_f32 v48, v48, v184
v_mul_f32 v49, v49, v184
v_mul_f32 v50, v50, v184
v_mul_f32 v51, v51, v184
v_mul_f32 v52, v52, v184
v_mul_f32 v53, v53, v184
v_mul_f32 v54, v54, v184
v_mul_f32 v55, v55, v184
v_mul_f32 v56, v56, v184
v_mul_f32 v57, v57, v184
v_mul_f32 v58, v58, v184
v_mul_f32 v59, v59, v184
v_mul_f32 v60, v60, v184
v_mul_f32 v61, v61, v184
v_mul_f32 v62, v62, v184
v_mul_f32 v63, v63, v184
v_mul_f32 v64, v64, v184
v_mul_f32 v65, v65, v184
v_mul_f32 v66, v66, v184
v_mul_f32 v67, v67, v184
v_mul_f32 v68, v68, v184
v_mul_f32 v69, v69, v184
v_mul_f32 v70, v70, v184
v_mul_f32 v71, v71, v184
v_mul_f32 v72, v72, v184
v_mul_f32 v73, v73, v184
v_mul_f32 v74, v74, v184
v_mul_f32 v75, v75, v184
s_waitcnt lgkmcnt(0)
s_barrier
ds_read_b128 v[148:151], v202 offset:0
ds_read_b128 v[152:155], v202 offset:1024
ds_read_b128 v[156:159], v202 offset:2048
ds_read_b128 v[160:163], v202 offset:3072
ds_read_b64_tr_b16 v[84:85], v197 offset:0
ds_read_b64_tr_b16 v[86:87], v197 offset:4352
ds_read_b64_tr_b16 v[88:89], v197 offset:64
ds_read_b64_tr_b16 v[90:91], v197 offset:4416
ds_read_b64_tr_b16 v[92:93], v197 offset:128
ds_read_b64_tr_b16 v[94:95], v197 offset:4480
ds_read_b64_tr_b16 v[96:97], v197 offset:192
ds_read_b64_tr_b16 v[98:99], v197 offset:4544
ds_read_b64_tr_b16 v[100:101], v197 offset:17408
ds_read_b64_tr_b16 v[102:103], v197 offset:21760
ds_read_b64_tr_b16 v[104:105], v197 offset:17472
ds_read_b64_tr_b16 v[106:107], v197 offset:21824
ds_read_b64_tr_b16 v[108:109], v197 offset:17536
ds_read_b64_tr_b16 v[110:111], v197 offset:21888
ds_read_b64_tr_b16 v[112:113], v197 offset:17600
ds_read_b64_tr_b16 v[114:115], v197 offset:21952
ds_read_b64_tr_b16 v[116:117], v197 offset:34816
ds_read_b64_tr_b16 v[118:119], v197 offset:39168
ds_read_b64_tr_b16 v[120:121], v197 offset:34880
ds_read_b64_tr_b16 v[122:123], v197 offset:39232
ds_read_b64_tr_b16 v[124:125], v197 offset:34944
ds_read_b64_tr_b16 v[126:127], v197 offset:39296
ds_read_b64_tr_b16 v[128:129], v197 offset:35008
ds_read_b64_tr_b16 v[130:131], v197 offset:39360
ds_read_b64_tr_b16 v[132:133], v197 offset:52224
ds_read_b64_tr_b16 v[134:135], v197 offset:56576
ds_read_b64_tr_b16 v[136:137], v197 offset:52288
ds_read_b64_tr_b16 v[138:139], v197 offset:56640
ds_read_b64_tr_b16 v[140:141], v197 offset:52352
ds_read_b64_tr_b16 v[142:143], v197 offset:56704
ds_read_b64_tr_b16 v[144:145], v197 offset:52416
ds_read_b64_tr_b16 v[146:147], v197 offset:56768
s_waitcnt lgkmcnt(15)
v_mfma_f32_32x32x16_bf16 v[12:27], v[84:87], v[148:151], v[12:27]
v_mfma_f32_32x32x16_bf16 v[28:43], v[88:91], v[148:151], v[28:43]
v_mfma_f32_32x32x16_bf16 v[44:59], v[92:95], v[148:151], v[44:59]
v_mfma_f32_32x32x16_bf16 v[60:75], v[96:99], v[148:151], v[60:75]
s_waitcnt lgkmcnt(15)
v_mfma_f32_32x32x16_bf16 v[12:27], v[100:103], v[152:155], v[12:27]
v_mfma_f32_32x32x16_bf16 v[28:43], v[104:107], v[152:155], v[28:43]
v_mfma_f32_32x32x16_bf16 v[44:59], v[108:111], v[152:155], v[44:59]
v_mfma_f32_32x32x16_bf16 v[60:75], v[112:115], v[152:155], v[60:75]
s_waitcnt lgkmcnt(8)
v_mfma_f32_32x32x16_bf16 v[12:27], v[116:119], v[156:159], v[12:27]
v_mfma_f32_32x32x16_bf16 v[28:43], v[120:123], v[156:159], v[28:43]
v_mfma_f32_32x32x16_bf16 v[44:59], v[124:127], v[156:159], v[44:59]
v_mfma_f32_32x32x16_bf16 v[60:75], v[128:131], v[156:159], v[60:75]
s_waitcnt lgkmcnt(0)
v_mfma_f32_32x32x16_bf16 v[12:27], v[132:135], v[160:163], v[12:27]
v_mfma_f32_32x32x16_bf16 v[28:43], v[136:139], v[160:163], v[28:43]
v_mfma_f32_32x32x16_bf16 v[44:59], v[140:143], v[160:163], v[44:59]
v_mfma_f32_32x32x16_bf16 v[60:75], v[144:147], v[160:163], v[60:75]
ds_read_b128 v[84:87], v194 offset:0
ds_read_b128 v[88:91], v194 offset:64
ds_read_b128 v[92:95], v194 offset:128
ds_read_b128 v[96:99], v194 offset:192
ds_read_b128 v[100:103], v194 offset:256
ds_read_b128 v[104:107], v194 offset:320
ds_read_b128 v[108:111], v194 offset:384
ds_read_b128 v[112:115], v194 offset:448
ds_read_b128 v[116:119], v194 offset:512
ds_read_b128 v[120:123], v194 offset:576
ds_read_b128 v[124:127], v194 offset:640
ds_read_b128 v[128:131], v194 offset:704
ds_read_b128 v[132:135], v194 offset:768
ds_read_b128 v[136:139], v194 offset:832
ds_read_b128 v[140:143], v194 offset:896
ds_read_b128 v[144:147], v194 offset:960
s_waitcnt lgkmcnt(15)
v_mfma_f32_16x16x32_bf16 v[76:79], v[84:87], a[0:3], 0
v_mfma_f32_16x16x32_bf16 v[80:83], v[84:87], a[64:67], 0
s_waitcnt lgkmcnt(14)
v_mfma_f32_16x16x32_bf16 v[76:79], v[88:91], a[4:7], v[76:79]
v_mfma_f32_16x16x32_bf16 v[80:83], v[88:91], a[68:71], v[80:83]
s_waitcnt lgkmcnt(13)
v_mfma_f32_16x16x32_bf16 v[76:79], v[92:95], a[8:11], v[76:79]
v_mfma_f32_16x16x32_bf16 v[80:83], v[92:95], a[72:75], v[80:83]
s_waitcnt lgkmcnt(12)
v_mfma_f32_16x16x32_bf16 v[76:79], v[96:99], a[12:15], v[76:79]
v_mfma_f32_16x16x32_bf16 v[80:83], v[96:99], a[76:79], v[80:83]
s_waitcnt lgkmcnt(11)
v_mfma_f32_16x16x32_bf16 v[76:79], v[100:103], a[16:19], v[76:79]
v_mfma_f32_16x16x32_bf16 v[80:83], v[100:103], a[80:83], v[80:83]
s_waitcnt lgkmcnt(10)
v_mfma_f32_16x16x32_bf16 v[76:79], v[104:107], a[20:23], v[76:79]
v_mfma_f32_16x16x32_bf16 v[80:83], v[104:107], a[84:87], v[80:83]
s_waitcnt lgkmcnt(9)
v_mfma_f32_16x16x32_bf16 v[76:79], v[108:111], a[24:27], v[76:79]
v_mfma_f32_16x16x32_bf16 v[80:83], v[108:111], a[88:91], v[80:83]
s_waitcnt lgkmcnt(8)
v_mfma_f32_16x16x32_bf16 v[76:79], v[112:115], a[28:31], v[76:79]
v_mfma_f32_16x16x32_bf16 v[80:83], v[112:115], a[92:95], v[80:83]
s_waitcnt lgkmcnt(7)
v_mfma_f32_16x16x32_bf16 v[76:79], v[116:119], a[32:35], v[76:79]
v_mfma_f32_16x16x32_bf16 v[80:83], v[116:119], a[96:99], v[80:83]
s_waitcnt lgkmcnt(6)
v_mfma_f32_16x16x32_bf16 v[76:79], v[120:123], a[36:39], v[76:79]
v_mfma_f32_16x16x32_bf16 v[80:83], v[120:123], a[100:103], v[80:83]
s_waitcnt lgkmcnt(5)
v_mfma_f32_16x16x32_bf16 v[76:79], v[124:127], a[40:43], v[76:79]
v_mfma_f32_16x16x32_bf16 v[80:83], v[124:127], a[104:107], v[80:83]
s_waitcnt lgkmcnt(4)
v_mfma_f32_16x16x32_bf16 v[76:79], v[128:131], a[44:47], v[76:79]
v_mfma_f32_16x16x32_bf16 v[80:83], v[128:131], a[108:111], v[80:83]
s_waitcnt lgkmcnt(3)
v_mfma_f32_16x16x32_bf16 v[76:79], v[132:135], a[48:51], v[76:79]
v_mfma_f32_16x16x32_bf16 v[80:83], v[132:135], a[112:115], v[80:83]
s_waitcnt lgkmcnt(2)
v_mfma_f32_16x16x32_bf16 v[76:79], v[136:139], a[52:55], v[76:79]
v_mfma_f32_16x16x32_bf16 v[80:83], v[136:139], a[116:119], v[80:83]
s_waitcnt lgkmcnt(1)
v_mfma_f32_16x16x32_bf16 v[76:79], v[140:143], a[56:59], v[76:79]
v_mfma_f32_16x16x32_bf16 v[80:83], v[140:143], a[120:123], v[80:83]
s_waitcnt lgkmcnt(0)
v_mfma_f32_16x16x32_bf16 v[76:79], v[144:147], a[60:63], v[76:79]
v_mfma_f32_16x16x32_bf16 v[80:83], v[144:147], a[124:127], v[80:83]
s_nop 6
v_max_f32 v190, v76, v77
v_max3_f32 v190, v190, v78, v79
v_mov_b32 v192, v190
s_nop 1
v_permlane16_swap_b32 v190, v192
v_max_f32 v190, v190, v192
v_mov_b32 v192, v190
s_nop 1
v_permlane32_swap_b32 v190, v192
v_max_f32 v190, v190, v192
ds_write_b32 v198, v190 offset:0
v_max_f32 v191, v80, v81
v_max3_f32 v191, v191, v82, v83
v_mov_b32 v192, v191
s_nop 1
v_permlane16_swap_b32 v191, v192
v_max_f32 v191, v191, v192
v_mov_b32 v192, v191
s_nop 1
v_permlane32_swap_b32 v191, v192
v_max_f32 v191, v191, v192
ds_write_b32 v198, v191 offset:256
s_waitcnt lgkmcnt(0)
s_barrier
ds_read_b128 v[164:167], v199
ds_read_b128 v[168:171], v199 offset:256
ds_read_b128 v[172:175], v200
s_waitcnt vmcnt(0)
ds_write_b128 v207, a[192:195] offset:0
ds_write_b128 v207, a[196:199] offset:1088
ds_write_b128 v207, a[200:203] offset:2176
ds_write_b128 v207, a[204:207] offset:3264
ds_write_b128 v207, a[208:211] offset:4352
ds_write_b128 v207, a[212:215] offset:5440
ds_write_b128 v207, a[216:219] offset:6528
ds_write_b128 v207, a[220:223] offset:7616
ds_write_b128 v207, a[224:227] offset:8704
ds_write_b128 v207, a[228:231] offset:9792
ds_write_b128 v207, a[232:235] offset:10880
ds_write_b128 v207, a[236:239] offset:11968
ds_write_b128 v207, a[240:243] offset:13056
ds_write_b128 v207, a[244:247] offset:14144
ds_write_b128 v207, a[248:251] offset:15232
ds_write_b128 v207, a[252:255] offset:16320
s_waitcnt lgkmcnt(15)
v_max_f32 v164, v164, v165
v_max3_f32 v164, v164, v166, v167
v_mul_f32 v164, v164, v185
v_max_f32 v164, v164, v176
v_sub_f32 v182, v176, v164
v_exp_f32 v182, v182
v_mov_b32 v176, v164
v_max_f32 v168, v168, v169
v_max3_f32 v168, v168, v170, v171
v_mul_f32 v168, v168, v185
v_max_f32 v168, v168, v177
v_sub_f32 v183, v177, v168
v_exp_f32 v183, v183
v_mov_b32 v177, v168
v_max_f32 v172, v172, v173
v_max3_f32 v172, v172, v174, v175
v_mul_f32 v172, v172, v185
v_max_f32 v172, v172, v178
v_sub_f32 v184, v178, v172
v_exp_f32 v184, v184
v_mov_b32 v178, v172
v_fma_f32 v76, v76, v185, -v176
v_fma_f32 v77, v77, v185, -v176
v_fma_f32 v78, v78, v185, -v176
v_fma_f32 v79, v79, v185, -v176
v_exp_f32 v76, v76
v_exp_f32 v77, v77
v_exp_f32 v78, v78
v_exp_f32 v79, v79
v_mul_f32 v180, v180, v182
v_cvt_pk_bf16_f32 v186, v76, v77
v_cvt_pk_bf16_f32 v187, v78, v79
ds_write_b64 v201, v[186:187] offset:0
v_add_f32 v180, v180, v76
v_add_f32 v180, v180, v77
v_add_f32 v180, v180, v78
v_add_f32 v180, v180, v79
v_fma_f32 v80, v80, v185, -v177
v_fma_f32 v81, v81, v185, -v177
v_fma_f32 v82, v82, v185, -v177
v_fma_f32 v83, v83, v185, -v177
v_exp_f32 v80, v80
v_exp_f32 v81, v81
v_exp_f32 v82, v82
v_exp_f32 v83, v83
v_mul_f32 v181, v181, v183
v_cvt_pk_bf16_f32 v188, v80, v81
v_cvt_pk_bf16_f32 v189, v82, v83
ds_write_b64 v201, v[188:189] offset:512
v_add_f32 v181, v181, v80
v_add_f32 v181, v181, v81
v_add_f32 v181, v181, v82
v_add_f32 v181, v181, v83
v_mul_f32 v12, v12, v184
v_mul_f32 v13, v13, v184
v_mul_f32 v14, v14, v184
v_mul_f32 v15, v15, v184
v_mul_f32 v16, v16, v184
v_mul_f32 v17, v17, v184
v_mul_f32 v18, v18, v184
v_mul_f32 v19, v19, v184
v_mul_f32 v20, v20, v184
v_mul_f32 v21, v21, v184
v_mul_f32 v22, v22, v184
v_mul_f32 v23, v23, v184
v_mul_f32 v24, v24, v184
v_mul_f32 v25, v25, v184
v_mul_f32 v26, v26, v184
v_mul_f32 v27, v27, v184
v_mul_f32 v28, v28, v184
v_mul_f32 v29, v29, v184
v_mul_f32 v30, v30, v184
v_mul_f32 v31, v31, v184
v_mul_f32 v32, v32, v184
v_mul_f32 v33, v33, v184
v_mul_f32 v34, v34, v184
v_mul_f32 v35, v35, v184
v_mul_f32 v36, v36, v184
v_mul_f32 v37, v37, v184
v_mul_f32 v38, v38, v184
v_mul_f32 v39, v39, v184
v_mul_f32 v40, v40, v184
v_mul_f32 v41, v41, v184
v_mul_f32 v42, v42, v184
v_mul_f32 v43, v43, v184
v_mul_f32 v44, v44, v184
v_mul_f32 v45, v45, v184
v_mul_f32 v46, v46, v184
v_mul_f32 v47, v47, v184
v_mul_f32 v48, v48, v184
v_mul_f32 v49, v49, v184
v_mul_f32 v50, v50, v184
v_mul_f32 v51, v51, v184
v_mul_f32 v52, v52, v184
v_mul_f32 v53, v53, v184
v_mul_f32 v54, v54, v184
v_mul_f32 v55, v55, v184
v_mul_f32 v56, v56, v184
v_mul_f32 v57, v57, v184
v_mul_f32 v58, v58, v184
v_mul_f32 v59, v59, v184
v_mul_f32 v60, v60, v184
v_mul_f32 v61, v61, v184
v_mul_f32 v62, v62, v184
v_mul_f32 v63, v63, v184
v_mul_f32 v64, v64, v184
v_mul_f32 v65, v65, v184
v_mul_f32 v66, v66, v184
v_mul_f32 v67, v67, v184
v_mul_f32 v68, v68, v184
v_mul_f32 v69, v69, v184
v_mul_f32 v70, v70, v184
v_mul_f32 v71, v71, v184
v_mul_f32 v72, v72, v184
v_mul_f32 v73, v73, v184
v_mul_f32 v74, v74, v184
v_mul_f32 v75, v75, v184
s_waitcnt lgkmcnt(0)
s_barrier
ds_read_b128 v[148:151], v202 offset:0
ds_read_b128 v[152:155], v202 offset:1024
ds_read_b128 v[156:159], v202 offset:2048
ds_read_b128 v[160:163], v202 offset:3072
ds_read_b64_tr_b16 v[84:85], v196 offset:0
ds_read_b64_tr_b16 v[86:87], v196 offset:4352
ds_read_b64_tr_b16 v[88:89], v196 offset:64
ds_read_b64_tr_b16 v[90:91], v196 offset:4416
ds_read_b64_tr_b16 v[92:93], v196 offset:128
ds_read_b64_tr_b16 v[94:95], v196 offset:4480
ds_read_b64_tr_b16 v[96:97], v196 offset:192
ds_read_b64_tr_b16 v[98:99], v196 offset:4544
ds_read_b64_tr_b16 v[100:101], v196 offset:17408
ds_read_b64_tr_b16 v[102:103], v196 offset:21760
ds_read_b64_tr_b16 v[104:105], v196 offset:17472
ds_read_b64_tr_b16 v[106:107], v196 offset:21824
ds_read_b64_tr_b16 v[108:109], v196 offset:17536
ds_read_b64_tr_b16 v[110:111], v196 offset:21888
ds_read_b64_tr_b16 v[112:113], v196 offset:17600
ds_read_b64_tr_b16 v[114:115], v196 offset:21952
ds_read_b64_tr_b16 v[116:117], v196 offset:34816
ds_read_b64_tr_b16 v[118:119], v196 offset:39168
ds_read_b64_tr_b16 v[120:121], v196 offset:34880
ds_read_b64_tr_b16 v[122:123], v196 offset:39232
ds_read_b64_tr_b16 v[124:125], v196 offset:34944
ds_read_b64_tr_b16 v[126:127], v196 offset:39296
ds_read_b64_tr_b16 v[128:129], v196 offset:35008
ds_read_b64_tr_b16 v[130:131], v196 offset:39360
ds_read_b64_tr_b16 v[132:133], v196 offset:52224
ds_read_b64_tr_b16 v[134:135], v196 offset:56576
ds_read_b64_tr_b16 v[136:137], v196 offset:52288
ds_read_b64_tr_b16 v[138:139], v196 offset:56640
ds_read_b64_tr_b16 v[140:141], v196 offset:52352
ds_read_b64_tr_b16 v[142:143], v196 offset:56704
ds_read_b64_tr_b16 v[144:145], v196 offset:52416
ds_read_b64_tr_b16 v[146:147], v196 offset:56768
s_waitcnt lgkmcnt(15)
v_mfma_f32_32x32x16_bf16 v[12:27], v[84:87], v[148:151], v[12:27]
v_mfma_f32_32x32x16_bf16 v[28:43], v[88:91], v[148:151], v[28:43]
v_mfma_f32_32x32x16_bf16 v[44:59], v[92:95], v[148:151], v[44:59]
v_mfma_f32_32x32x16_bf16 v[60:75], v[96:99], v[148:151], v[60:75]
s_waitcnt lgkmcnt(15)
v_mfma_f32_32x32x16_bf16 v[12:27], v[100:103], v[152:155], v[12:27]
v_mfma_f32_32x32x16_bf16 v[28:43], v[104:107], v[152:155], v[28:43]
v_mfma_f32_32x32x16_bf16 v[44:59], v[108:111], v[152:155], v[44:59]
v_mfma_f32_32x32x16_bf16 v[60:75], v[112:115], v[152:155], v[60:75]
s_waitcnt lgkmcnt(8)
v_mfma_f32_32x32x16_bf16 v[12:27], v[116:119], v[156:159], v[12:27]
v_mfma_f32_32x32x16_bf16 v[28:43], v[120:123], v[156:159], v[28:43]
v_mfma_f32_32x32x16_bf16 v[44:59], v[124:127], v[156:159], v[44:59]
v_mfma_f32_32x32x16_bf16 v[60:75], v[128:131], v[156:159], v[60:75]
s_waitcnt lgkmcnt(0)
v_mfma_f32_32x32x16_bf16 v[12:27], v[132:135], v[160:163], v[12:27]
v_mfma_f32_32x32x16_bf16 v[28:43], v[136:139], v[160:163], v[28:43]
v_mfma_f32_32x32x16_bf16 v[44:59], v[140:143], v[160:163], v[44:59]
v_mfma_f32_32x32x16_bf16 v[60:75], v[144:147], v[160:163], v[60:75]
ds_read_b128 v[84:87], v195 offset:0
ds_read_b128 v[88:91], v195 offset:64
ds_read_b128 v[92:95], v195 offset:128
ds_read_b128 v[96:99], v195 offset:192
ds_read_b128 v[100:103], v195 offset:256
ds_read_b128 v[104:107], v195 offset:320
ds_read_b128 v[108:111], v195 offset:384
ds_read_b128 v[112:115], v195 offset:448
ds_read_b128 v[116:119], v195 offset:512
ds_read_b128 v[120:123], v195 offset:576
ds_read_b128 v[124:127], v195 offset:640
ds_read_b128 v[128:131], v195 offset:704
ds_read_b128 v[132:135], v195 offset:768
ds_read_b128 v[136:139], v195 offset:832
ds_read_b128 v[140:143], v195 offset:896
ds_read_b128 v[144:147], v195 offset:960
s_waitcnt lgkmcnt(15)
v_mfma_f32_16x16x32_bf16 v[76:79], v[84:87], a[0:3], 0
v_mfma_f32_16x16x32_bf16 v[80:83], v[84:87], a[64:67], 0
s_waitcnt lgkmcnt(14)
v_mfma_f32_16x16x32_bf16 v[76:79], v[88:91], a[4:7], v[76:79]
v_mfma_f32_16x16x32_bf16 v[80:83], v[88:91], a[68:71], v[80:83]
s_waitcnt lgkmcnt(13)
v_mfma_f32_16x16x32_bf16 v[76:79], v[92:95], a[8:11], v[76:79]
v_mfma_f32_16x16x32_bf16 v[80:83], v[92:95], a[72:75], v[80:83]
s_waitcnt lgkmcnt(12)
v_mfma_f32_16x16x32_bf16 v[76:79], v[96:99], a[12:15], v[76:79]
v_mfma_f32_16x16x32_bf16 v[80:83], v[96:99], a[76:79], v[80:83]
s_waitcnt lgkmcnt(11)
v_mfma_f32_16x16x32_bf16 v[76:79], v[100:103], a[16:19], v[76:79]
v_mfma_f32_16x16x32_bf16 v[80:83], v[100:103], a[80:83], v[80:83]
s_waitcnt lgkmcnt(10)
v_mfma_f32_16x16x32_bf16 v[76:79], v[104:107], a[20:23], v[76:79]
v_mfma_f32_16x16x32_bf16 v[80:83], v[104:107], a[84:87], v[80:83]
s_waitcnt lgkmcnt(9)
v_mfma_f32_16x16x32_bf16 v[76:79], v[108:111], a[24:27], v[76:79]
v_mfma_f32_16x16x32_bf16 v[80:83], v[108:111], a[88:91], v[80:83]
s_waitcnt lgkmcnt(8)
v_mfma_f32_16x16x32_bf16 v[76:79], v[112:115], a[28:31], v[76:79]
v_mfma_f32_16x16x32_bf16 v[80:83], v[112:115], a[92:95], v[80:83]
s_waitcnt lgkmcnt(7)
v_mfma_f32_16x16x32_bf16 v[76:79], v[116:119], a[32:35], v[76:79]
v_mfma_f32_16x16x32_bf16 v[80:83], v[116:119], a[96:99], v[80:83]
s_waitcnt lgkmcnt(6)
v_mfma_f32_16x16x32_bf16 v[76:79], v[120:123], a[36:39], v[76:79]
v_mfma_f32_16x16x32_bf16 v[80:83], v[120:123], a[100:103], v[80:83]
s_waitcnt lgkmcnt(5)
v_mfma_f32_16x16x32_bf16 v[76:79], v[124:127], a[40:43], v[76:79]
v_mfma_f32_16x16x32_bf16 v[80:83], v[124:127], a[104:107], v[80:83]
s_waitcnt lgkmcnt(4)
v_mfma_f32_16x16x32_bf16 v[76:79], v[128:131], a[44:47], v[76:79]
v_mfma_f32_16x16x32_bf16 v[80:83], v[128:131], a[108:111], v[80:83]
s_waitcnt lgkmcnt(3)
v_mfma_f32_16x16x32_bf16 v[76:79], v[132:135], a[48:51], v[76:79]
v_mfma_f32_16x16x32_bf16 v[80:83], v[132:135], a[112:115], v[80:83]
s_waitcnt lgkmcnt(2)
v_mfma_f32_16x16x32_bf16 v[76:79], v[136:139], a[52:55], v[76:79]
v_mfma_f32_16x16x32_bf16 v[80:83], v[136:139], a[116:119], v[80:83]
s_waitcnt lgkmcnt(1)
v_mfma_f32_16x16x32_bf16 v[76:79], v[140:143], a[56:59], v[76:79]
v_mfma_f32_16x16x32_bf16 v[80:83], v[140:143], a[120:123], v[80:83]
s_waitcnt lgkmcnt(0)
v_mfma_f32_16x16x32_bf16 v[76:79], v[144:147], a[60:63], v[76:79]
v_mfma_f32_16x16x32_bf16 v[80:83], v[144:147], a[124:127], v[80:83]
s_nop 6
v_max_f32 v190, v76, v77
v_max3_f32 v190, v190, v78, v79
v_mov_b32 v192, v190
s_nop 1
v_permlane16_swap_b32 v190, v192
v_max_f32 v190, v190, v192
v_mov_b32 v192, v190
s_nop 1
v_permlane32_swap_b32 v190, v192
v_max_f32 v190, v190, v192
ds_write_b32 v198, v190 offset:0
v_max_f32 v191, v80, v81
v_max3_f32 v191, v191, v82, v83
v_mov_b32 v192, v191
s_nop 1
v_permlane16_swap_b32 v191, v192
v_max_f32 v191, v191, v192
v_mov_b32 v192, v191
s_nop 1
v_permlane32_swap_b32 v191, v192
v_max_f32 v191, v191, v192
ds_write_b32 v198, v191 offset:256
s_waitcnt lgkmcnt(0)
s_barrier
ds_read_b128 v[164:167], v199
ds_read_b128 v[168:171], v199 offset:256
ds_read_b128 v[172:175], v200
s_waitcnt lgkmcnt(0)
v_max_f32 v164, v164, v165
v_max3_f32 v164, v164, v166, v167
v_mul_f32 v164, v164, v185
v_max_f32 v164, v164, v176
v_sub_f32 v182, v176, v164
v_exp_f32 v182, v182
v_mov_b32 v176, v164
v_max_f32 v168, v168, v169
v_max3_f32 v168, v168, v170, v171
v_mul_f32 v168, v168, v185
v_max_f32 v168, v168, v177
v_sub_f32 v183, v177, v168
v_exp_f32 v183, v183
v_mov_b32 v177, v168
v_max_f32 v172, v172, v173
v_max3_f32 v172, v172, v174, v175
v_mul_f32 v172, v172, v185
v_max_f32 v172, v172, v178
v_sub_f32 v184, v178, v172
v_exp_f32 v184, v184
v_mov_b32 v178, v172
v_fma_f32 v76, v76, v185, -v176
v_fma_f32 v77, v77, v185, -v176
v_fma_f32 v78, v78, v185, -v176
v_fma_f32 v79, v79, v185, -v176
v_exp_f32 v76, v76
v_exp_f32 v77, v77
v_exp_f32 v78, v78
v_exp_f32 v79, v79
v_mul_f32 v180, v180, v182
v_cvt_pk_bf16_f32 v186, v76, v77
v_cvt_pk_bf16_f32 v187, v78, v79
ds_write_b64 v201, v[186:187] offset:0
v_add_f32 v180, v180, v76
v_add_f32 v180, v180, v77
v_add_f32 v180, v180, v78
v_add_f32 v180, v180, v79
v_fma_f32 v80, v80, v185, -v177
v_fma_f32 v81, v81, v185, -v177
v_fma_f32 v82, v82, v185, -v177
v_fma_f32 v83, v83, v185, -v177
v_exp_f32 v80, v80
v_exp_f32 v81, v81
v_exp_f32 v82, v82
v_exp_f32 v83, v83
v_mul_f32 v181, v181, v183
v_cvt_pk_bf16_f32 v188, v80, v81
v_cvt_pk_bf16_f32 v189, v82, v83
ds_write_b64 v201, v[188:189] offset:512
v_add_f32 v181, v181, v80
v_add_f32 v181, v181, v81
v_add_f32 v181, v181, v82
v_add_f32 v181, v181, v83
v_mul_f32 v12, v12, v184
v_mul_f32 v13, v13, v184
v_mul_f32 v14, v14, v184
v_mul_f32 v15, v15, v184
v_mul_f32 v16, v16, v184
v_mul_f32 v17, v17, v184
v_mul_f32 v18, v18, v184
v_mul_f32 v19, v19, v184
v_mul_f32 v20, v20, v184
v_mul_f32 v21, v21, v184
v_mul_f32 v22, v22, v184
v_mul_f32 v23, v23, v184
v_mul_f32 v24, v24, v184
v_mul_f32 v25, v25, v184
v_mul_f32 v26, v26, v184
v_mul_f32 v27, v27, v184
v_mul_f32 v28, v28, v184
v_mul_f32 v29, v29, v184
v_mul_f32 v30, v30, v184
v_mul_f32 v31, v31, v184
v_mul_f32 v32, v32, v184
v_mul_f32 v33, v33, v184
v_mul_f32 v34, v34, v184
v_mul_f32 v35, v35, v184
v_mul_f32 v36, v36, v184
v_mul_f32 v37, v37, v184
v_mul_f32 v38, v38, v184
v_mul_f32 v39, v39, v184
v_mul_f32 v40, v40, v184
v_mul_f32 v41, v41, v184
v_mul_f32 v42, v42, v184
v_mul_f32 v43, v43, v184
v_mul_f32 v44, v44, v184
v_mul_f32 v45, v45, v184
v_mul_f32 v46, v46, v184
v_mul_f32 v47, v47, v184
v_mul_f32 v48, v48, v184
v_mul_f32 v49, v49, v184
v_mul_f32 v50, v50, v184
v_mul_f32 v51, v51, v184
v_mul_f32 v52, v52, v184
v_mul_f32 v53, v53, v184
v_mul_f32 v54, v54, v184
v_mul_f32 v55, v55, v184
v_mul_f32 v56, v56, v184
v_mul_f32 v57, v57, v184
v_mul_f32 v58, v58, v184
v_mul_f32 v59, v59, v184
v_mul_f32 v60, v60, v184
v_mul_f32 v61, v61, v184
v_mul_f32 v62, v62, v184
v_mul_f32 v63, v63, v184
v_mul_f32 v64, v64, v184
v_mul_f32 v65, v65, v184
v_mul_f32 v66, v66, v184
v_mul_f32 v67, v67, v184
v_mul_f32 v68, v68, v184
v_mul_f32 v69, v69, v184
v_mul_f32 v70, v70, v184
v_mul_f32 v71, v71, v184
v_mul_f32 v72, v72, v184
v_mul_f32 v73, v73, v184
v_mul_f32 v74, v74, v184
v_mul_f32 v75, v75, v184
s_waitcnt lgkmcnt(0)
s_barrier
ds_read_b128 v[148:151], v202 offset:0
ds_read_b128 v[152:155], v202 offset:1024
ds_read_b128 v[156:159], v202 offset:2048
ds_read_b128 v[160:163], v202 offset:3072
ds_read_b64_tr_b16 v[84:85], v197 offset:0
ds_read_b64_tr_b16 v[86:87], v197 offset:4352
ds_read_b64_tr_b16 v[88:89], v197 offset:64
ds_read_b64_tr_b16 v[90:91], v197 offset:4416
ds_read_b64_tr_b16 v[92:93], v197 offset:128
ds_read_b64_tr_b16 v[94:95], v197 offset:4480
ds_read_b64_tr_b16 v[96:97], v197 offset:192
ds_read_b64_tr_b16 v[98:99], v197 offset:4544
ds_read_b64_tr_b16 v[100:101], v197 offset:17408
ds_read_b64_tr_b16 v[102:103], v197 offset:21760
ds_read_b64_tr_b16 v[104:105], v197 offset:17472
ds_read_b64_tr_b16 v[106:107], v197 offset:21824
ds_read_b64_tr_b16 v[108:109], v197 offset:17536
ds_read_b64_tr_b16 v[110:111], v197 offset:21888
ds_read_b64_tr_b16 v[112:113], v197 offset:17600
ds_read_b64_tr_b16 v[114:115], v197 offset:21952
ds_read_b64_tr_b16 v[116:117], v197 offset:34816
ds_read_b64_tr_b16 v[118:119], v197 offset:39168
ds_read_b64_tr_b16 v[120:121], v197 offset:34880
ds_read_b64_tr_b16 v[122:123], v197 offset:39232
ds_read_b64_tr_b16 v[124:125], v197 offset:34944
ds_read_b64_tr_b16 v[126:127], v197 offset:39296
ds_read_b64_tr_b16 v[128:129], v197 offset:35008
ds_read_b64_tr_b16 v[130:131], v197 offset:39360
ds_read_b64_tr_b16 v[132:133], v197 offset:52224
ds_read_b64_tr_b16 v[134:135], v197 offset:56576
ds_read_b64_tr_b16 v[136:137], v197 offset:52288
ds_read_b64_tr_b16 v[138:139], v197 offset:56640
ds_read_b64_tr_b16 v[140:141], v197 offset:52352
ds_read_b64_tr_b16 v[142:143], v197 offset:56704
ds_read_b64_tr_b16 v[144:145], v197 offset:52416
ds_read_b64_tr_b16 v[146:147], v197 offset:56768
s_waitcnt lgkmcnt(15)
v_mfma_f32_32x32x16_bf16 v[12:27], v[84:87], v[148:151], v[12:27]
v_mfma_f32_32x32x16_bf16 v[28:43], v[88:91], v[148:151], v[28:43]
v_mfma_f32_32x32x16_bf16 v[44:59], v[92:95], v[148:151], v[44:59]
v_mfma_f32_32x32x16_bf16 v[60:75], v[96:99], v[148:151], v[60:75]
s_waitcnt lgkmcnt(15)
v_mfma_f32_32x32x16_bf16 v[12:27], v[100:103], v[152:155], v[12:27]
v_mfma_f32_32x32x16_bf16 v[28:43], v[104:107], v[152:155], v[28:43]
v_mfma_f32_32x32x16_bf16 v[44:59], v[108:111], v[152:155], v[44:59]
v_mfma_f32_32x32x16_bf16 v[60:75], v[112:115], v[152:155], v[60:75]
s_waitcnt lgkmcnt(8)
v_mfma_f32_32x32x16_bf16 v[12:27], v[116:119], v[156:159], v[12:27]
v_mfma_f32_32x32x16_bf16 v[28:43], v[120:123], v[156:159], v[28:43]
v_mfma_f32_32x32x16_bf16 v[44:59], v[124:127], v[156:159], v[44:59]
v_mfma_f32_32x32x16_bf16 v[60:75], v[128:131], v[156:159], v[60:75]
s_waitcnt lgkmcnt(0)
v_mfma_f32_32x32x16_bf16 v[12:27], v[132:135], v[160:163], v[12:27]
v_mfma_f32_32x32x16_bf16 v[28:43], v[136:139], v[160:163], v[28:43]
v_mfma_f32_32x32x16_bf16 v[44:59], v[140:143], v[160:163], v[44:59]
v_mfma_f32_32x32x16_bf16 v[60:75], v[144:147], v[160:163], v[60:75]
v_mov_b32 v192, v180
s_nop 1
v_permlane16_swap_b32 v180, v192
v_add_f32 v180, v180, v192
v_mov_b32 v192, v180
s_nop 1
v_permlane32_swap_b32 v180, v192
v_add_f32 v180, v180, v192
ds_write_b32 v198, v180 offset:512
v_mov_b32 v192, v181
s_nop 1
v_permlane16_swap_b32 v181, v192
v_add_f32 v181, v181, v192
v_mov_b32 v192, v181
s_nop 1
v_permlane32_swap_b32 v181, v192
v_add_f32 v181, v181, v192
ds_write_b32 v198, v181 offset:768
v_and_b32 v5, 31, v1
v_mul_u32_u24 v5, 1040, v5
v_lshrrev_b32 v6, 5, v1
v_lshl_add_u32 v5, v6, 3, v5
s_lshl_b32 s6, s3, 8
v_add_u32 v5, s6, v5
v_cvt_pk_bf16_f32 v84, v12, v13
v_cvt_pk_bf16_f32 v85, v14, v15
ds_write_b64 v5, v[84:85] offset:0
v_cvt_pk_bf16_f32 v86, v16, v17
v_cvt_pk_bf16_f32 v87, v18, v19
ds_write_b64 v5, v[86:87] offset:16
v_cvt_pk_bf16_f32 v88, v20, v21
v_cvt_pk_bf16_f32 v89, v22, v23
ds_write_b64 v5, v[88:89] offset:32
v_cvt_pk_bf16_f32 v90, v24, v25
v_cvt_pk_bf16_f32 v91, v26, v27
ds_write_b64 v5, v[90:91] offset:48
v_cvt_pk_bf16_f32 v92, v28, v29
v_cvt_pk_bf16_f32 v93, v30, v31
ds_write_b64 v5, v[92:93] offset:64
v_cvt_pk_bf16_f32 v94, v32, v33
v_cvt_pk_bf16_f32 v95, v34, v35
ds_write_b64 v5, v[94:95] offset:80
v_cvt_pk_bf16_f32 v96, v36, v37
v_cvt_pk_bf16_f32 v97, v38, v39
ds_write_b64 v5, v[96:97] offset:96
v_cvt_pk_bf16_f32 v98, v40, v41
v_cvt_pk_bf16_f32 v99, v42, v43
ds_write_b64 v5, v[98:99] offset:112
v_cvt_pk_bf16_f32 v100, v44, v45
v_cvt_pk_bf16_f32 v101, v46, v47
ds_write_b64 v5, v[100:101] offset:128
v_cvt_pk_bf16_f32 v102, v48, v49
v_cvt_pk_bf16_f32 v103, v50, v51
ds_write_b64 v5, v[102:103] offset:144
v_cvt_pk_bf16_f32 v104, v52, v53
v_cvt_pk_bf16_f32 v105, v54, v55
ds_write_b64 v5, v[104:105] offset:160
v_cvt_pk_bf16_f32 v106, v56, v57
v_cvt_pk_bf16_f32 v107, v58, v59
ds_write_b64 v5, v[106:107] offset:176
v_cvt_pk_bf16_f32 v108, v60, v61
v_cvt_pk_bf16_f32 v109, v62, v63
ds_write_b64 v5, v[108:109] offset:192
v_cvt_pk_bf16_f32 v110, v64, v65
v_cvt_pk_bf16_f32 v111, v66, v67
ds_write_b64 v5, v[110:111] offset:208
v_cvt_pk_bf16_f32 v112, v68, v69
v_cvt_pk_bf16_f32 v113, v70, v71
ds_write_b64 v5, v[112:113] offset:224
v_cvt_pk_bf16_f32 v114, v72, v73
v_cvt_pk_bf16_f32 v115, v74, v75
ds_write_b64 v5, v[114:115] offset:240
v_mov_b32 v11, 163824
v_mov_b32 v7, 0
ds_write_b32 v11, v7
s_waitcnt lgkmcnt(0)
s_barrier
s_mul_i32 s6, s3, 8320
v_add_u32 v5, s6, v2
ds_read_b128 v[116:119], v5 offset:0
ds_read_b128 v[120:123], v5 offset:1040
ds_read_b128 v[124:127], v5 offset:2080
ds_read_b128 v[128:131], v5 offset:3120
ds_read_b128 v[132:135], v5 offset:4160
ds_read_b128 v[136:139], v5 offset:5200
ds_read_b128 v[140:143], v5 offset:6240
ds_read_b128 v[144:147], v5 offset:7280
ds_read_b128 v[164:167], v200 offset:512
s_mul_i32 s7, s3, 524288
s_lshl_b32 s6, s80, 10
s_add_u32 s7, s7, s6
s_add_u32 s7, s7, 2097152
s_waitcnt lgkmcnt(8)
s_add_u32 s6, s7, 0
buffer_store_dwordx4 v[116:119], v2, s[64:67], s6 offen sc1
s_waitcnt lgkmcnt(7)
s_add_u32 s6, s7, 98304
buffer_store_dwordx4 v[120:123], v2, s[64:67], s6 offen sc1
s_waitcnt lgkmcnt(6)
s_add_u32 s6, s7, 131072
buffer_store_dwordx4 v[124:127], v2, s[64:67], s6 offen sc1
s_waitcnt lgkmcnt(5)
s_add_u32 s6, s7, 229376
buffer_store_dwordx4 v[128:131], v2, s[64:67], s6 offen sc1
s_waitcnt lgkmcnt(4)
s_add_u32 s6, s7, 262144
buffer_store_dwordx4 v[132:135], v2, s[64:67], s6 offen sc1
s_waitcnt lgkmcnt(3)
s_add_u32 s6, s7, 360448
buffer_store_dwordx4 v[136:139], v2, s[64:67], s6 offen sc1
s_waitcnt lgkmcnt(2)
s_add_u32 s6, s7, 393216
buffer_store_dwordx4 v[140:143], v2, s[64:67], s6 offen sc1
s_waitcnt lgkmcnt(1)
s_add_u32 s6, s7, 491520
buffer_store_dwordx4 v[144:147], v2, s[64:67], s6 offen sc1
s_waitcnt lgkmcnt(0)
v_add_f32 v164, v164, v165
v_add_f32 v166, v166, v167
v_add_f32 v187, v164, v166
v_mov_b32 v186, v178
v_lshlrev_b32 v5, 8, v1
s_mul_i32 s6, s80, 8
s_add_u32 s6, s6, 262144
v_min_u32 v186, -2, v186
v_min_u32 v187, -2, v187
s_waitcnt vmcnt(0)
s_barrier
s_cmp_lg_u32 s3, 0
s_cbranch_scc1 L_nops_21
s_mov_b64 exec, 0xffffffff
buffer_store_dwordx2 v[186:187], v5, s[64:67], s6 offen sc1
s_mov_b64 exec, -1
L_nops_21:
B_final:
s_cmp_eq_u32 s3, 3
s_cbranch_scc1 H_start
s_mov_b32 s14, s9
s_lshr_b32 s7, s3, 1
s_cmp_lg_u32 s3, 1
s_cbranch_scc1 L_w1_22
s_and_b32 s7, s9, 7
s_cmp_ge_u32 s7, 2
s_cbranch_scc1 B_end
s_lshr_b32 s14, s9, 3
s_add_u32 s14, s14, 64
L_w1_22:
s_mul_i32 s15, s14, 57
s_lshr_b32 s15, s15, 10
s_mul_i32 s6, s15, 18
s_sub_u32 s80, s14, s6
s_mul_i32 s81, s15, 73728
s_lshr_b32 s81, s81, s7
s_lshl_b32 s6, s80, 6
s_add_u32 s81, s81, s6
s_mul_i32 s6, s7, 1048576
s_add_u32 s81, s81, s6
s_add_u32 s81, s81, 4194304
v_lshrrev_b32 v5, 2, v1
v_and_b32 v6, 3, v1
v_mul_u32_u24 v44, 1152, v5
v_lshl_add_u32 v44, v6, 4, v44
v_bfe_u32 v5, v1, 2, 2
v_lshl_add_u32 v5, v5, 2, v6
v_lshrrev_b32 v46, 4, v1
v_lshl_add_u32 v45, v46, 6, v5
v_lshrrev_b32 v5, 1, v6
v_mul_u32_u24 v5, 142, v5
v_add_u32 v5, v5, v6
v_lshrrev_b32 v46, 2, v1
v_lshl_add_u32 v5, v46, 1, v5
s_lshr_b32 s6, s80, 2
s_mul_i32 s6, s6, 80
s_lshl_b32 s83, s80, 4
s_add_u32 s83, s83, s6
s_mul_i32 s6, s80, 288
s_sub_u32 s6, s6, 4480
s_cmp_ge_u32 s80, 16
s_cselect_b32 s83, s6, s83
s_cselect_b64 vcc, -1, 0
v_cndmask_b32 v45, v45, v5, vcc
v_lshlrev_b32 v45, 1, v45
s_lshl_b32 s83, s83, 1
s_mul_i32 s6, s15, 2304
s_add_u32 s83, s83, s6
s_mul_i32 s6, s7, 1152
s_add_u32 s83, s83, s6
v_and_b32 v6, 1, v1
v_lshlrev_b32 v6, 4, v6
v_mov_b32 v46, 0x3f80
v_lshlrev_b32 v46, v6, v46
v_bfe_u32 v6, v1, 1, 3
v_cmp_eq_u32 vcc, 0, v6
s_nop 1
v_cndmask_b32 v20, 0, v46, vcc
v_cmp_eq_u32 vcc, 1, v6
s_nop 1
v_cndmask_b32 v21, 0, v46, vcc
v_cmp_eq_u32 vcc, 2, v6
s_nop 1
v_cndmask_b32 v22, 0, v46, vcc
v_cmp_eq_u32 vcc, 3, v6
s_nop 1
v_cndmask_b32 v23, 0, v46, vcc
s_sub_u32 s6, s7, 1
s_mov_b32 s16, -1
s_mov_b32 s17, -1
s_mov_b32 s18, -1
s_mov_b32 s19, -1
s_mov_b32 s20, s6
s_mov_b32 s21, s6
s_mov_b32 s22, s6
s_mov_b32 s23, s6
v_mov_b32 v48, -1
v_mov_b32 v49, -1
v_mov_b32 v50, -1
v_mov_b32 v51, -1
v_mov_b32 v52, -1
v_mov_b32 v53, -1
v_mov_b32 v54, -1
v_mov_b32 v55, -1
v_mov_b32 v56, s6
v_mov_b32 v57, s6
v_mov_b32 v58, s6
v_mov_b32 v59, s6
v_mov_b32 v60, s6
v_mov_b32 v61, s6
v_mov_b32 v62, s6
v_mov_b32 v63, s6
v_mov_b32 v64, -1
v_mov_b32 v65, -1
v_mov_b32 v66, -1
v_mov_b32 v67, -1
v_mov_b32 v68, -1
v_mov_b32 v69, -1
v_mov_b32 v70, -1
v_mov_b32 v71, -1
v_mov_b32 v72, -1
v_mov_b32 v73, -1
v_mov_b32 v74, -1
v_mov_b32 v75, -1
v_mov_b32 v76, -1
v_mov_b32 v77, -1
v_mov_b32 v78, -1
v_mov_b32 v79, -1
v_mov_b32 v80, -1
v_mov_b32 v81, -1
v_mov_b32 v82, -1
v_mov_b32 v83, -1
v_mov_b32 v84, -1
v_mov_b32 v85, -1
v_mov_b32 v86, -1
v_mov_b32 v87, -1
v_mov_b32 v88, -1
v_mov_b32 v89, -1
v_mov_b32 v90, -1
v_mov_b32 v91, -1
v_mov_b32 v92, -1
v_mov_b32 v93, -1
v_mov_b32 v94, -1
v_mov_b32 v95, -1
s_add_u32 s24, s81, 0
s_add_u32 s25, s81, 18432
s_add_u32 s26, s81, 36864
s_add_u32 s27, s81, 55296
s_mov_b32 s7, 400000
v_lshrrev_b32 v5, 3, v1
v_mul_u32_u24 v5, 4608, v5
s_and_b32 s6, s20, 1
v_lshlrev_b32 v5, s6, v5
R_slow:
buffer_load_dword v46, v5, s[64:67], s81 offen sc1
s_waitcnt vmcnt(0)
v_cmp_ne_u32 vcc, -1, v46
s_bcnt1_i32_b64 s6, vcc
s_cmp_ge_u32 s6, 32
s_cbranch_scc1 R_pass
s_sleep 8
s_sub_u32 s7, s7, 1
s_cmp_lg_u32 s7, 1
s_cbranch_scc1 R_slow
R_pass:
s_mov_b64 exec, s[16:17]
s_cbranch_execz L_ld_23
buffer_load_dwordx4 v[64:67], v44, s[64:67], s24 offen sc1
L_ld_23:
s_mov_b64 exec, s[18:19]
s_cbranch_execz L_ld_24
buffer_load_dwordx4 v[68:71], v44, s[64:67], s25 offen sc1
L_ld_24:
s_mov_b64 exec, s[20:21]
s_cbranch_execz L_ld_25
buffer_load_dwordx4 v[72:75], v44, s[64:67], s26 offen sc1
L_ld_25:
s_mov_b64 exec, s[22:23]
s_cbranch_execz L_ld_26
buffer_load_dwordx4 v[76:79], v44, s[64:67], s27 offen sc1
L_ld_26:
s_mov_b64 exec, -1
s_waitcnt vmcnt(0)
s_cmp_eq_u64 s[16:17], 0
s_cbranch_scc1 L_ck_27
v_min_u32 v48, v48, v64
v_min_u32 v49, v49, v65
v_min_u32 v50, v50, v66
v_min_u32 v51, v51, v67
v_max3_u32 v46, v48, v49, v50
v_max_u32 v46, v46, v51
v_cmp_eq_u32 s[16:17], -1, v46
L_ck_27:
s_cmp_eq_u64 s[18:19], 0
s_cbranch_scc1 L_ck_28
v_min_u32 v52, v52, v68
v_min_u32 v53, v53, v69
v_min_u32 v54, v54, v70
v_min_u32 v55, v55, v71
v_max3_u32 v46, v52, v53, v54
v_max_u32 v46, v46, v55
v_cmp_eq_u32 s[18:19], -1, v46
L_ck_28:
s_cmp_eq_u64 s[20:21], 0
s_cbranch_scc1 L_ck_29
v_min_u32 v56, v56, v72
v_min_u32 v57, v57, v73
v_min_u32 v58, v58, v74
v_min_u32 v59, v59, v75
v_max3_u32 v46, v56, v57, v58
v_max_u32 v46, v46, v59
v_cmp_eq_u32 s[20:21], -1, v46
L_ck_29:
s_cmp_eq_u64 s[22:23], 0
s_cbranch_scc1 L_ck_30
v_min_u32 v60, v60, v76
v_min_u32 v61, v61, v77
v_min_u32 v62, v62, v78
v_min_u32 v63, v63, v79
v_max3_u32 v46, v60, v61, v62
v_max_u32 v46, v46, v63
v_cmp_eq_u32 s[22:23], -1, v46
L_ck_30:
s_or_b64 s[28:29], s[16:17], s[18:19]
s_or_b64 s[30:31], s[20:21], s[22:23]
s_or_b64 s[28:29], s[28:29], s[30:31]
s_cbranch_scc0 R_done
s_bcnt1_i32_b64 s6, s[16:17]
s_bcnt1_i32_b64 s28, s[18:19]
s_add_u32 s6, s6, s28
s_bcnt1_i32_b64 s28, s[20:21]
s_add_u32 s6, s6, s28
s_bcnt1_i32_b64 s28, s[22:23]
s_add_u32 s6, s6, s28
s_cmp_le_u32 s6, 48
s_cbranch_scc1 R_fast
s_sub_u32 s7, s7, 1
s_cmp_gt_u32 s7, 1
s_cbranch_scc1 R_pass
R_fast:
s_or_b64 exec, s[16:17], 1
buffer_load_dwordx4 v[64:67], v44, s[64:67], s24 offen sc1
s_or_b64 exec, s[18:19], 1
buffer_load_dwordx4 v[68:71], v44, s[64:67], s25 offen sc1
s_or_b64 exec, s[20:21], 1
buffer_load_dwordx4 v[72:75], v44, s[64:67], s26 offen sc1
s_or_b64 exec, s[22:23], 1
buffer_load_dwordx4 v[76:79], v44, s[64:67], s27 offen sc1
s_mov_b64 exec, -1
s_sleep 5
s_or_b64 exec, s[16:17], 1
buffer_load_dwordx4 v[80:83], v44, s[64:67], s24 offen sc1
s_or_b64 exec, s[18:19], 1
buffer_load_dwordx4 v[84:87], v44, s[64:67], s25 offen sc1
s_or_b64 exec, s[20:21], 1
buffer_load_dwordx4 v[88:91], v44, s[64:67], s26 offen sc1
s_or_b64 exec, s[22:23], 1
buffer_load_dwordx4 v[92:95], v44, s[64:67], s27 offen sc1
s_mov_b64 exec, -1
R_loop:
s_waitcnt vmcnt(4)
s_cmp_eq_u64 s[16:17], 0
s_cbranch_scc1 L_ck_31
v_min_u32 v48, v48, v64
v_min_u32 v49, v49, v65
v_min_u32 v50, v50, v66
v_min_u32 v51, v51, v67
v_max3_u32 v46, v48, v49, v50
v_max_u32 v46, v46, v51
v_cmp_eq_u32 s[16:17], -1, v46
L_ck_31:
s_cmp_eq_u64 s[18:19], 0
s_cbranch_scc1 L_ck_32
v_min_u32 v52, v52, v68
v_min_u32 v53, v53, v69
v_min_u32 v54, v54, v70
v_min_u32 v55, v55, v71
v_max3_u32 v46, v52, v53, v54
v_max_u32 v46, v46, v55
v_cmp_eq_u32 s[18:19], -1, v46
L_ck_32:
s_cmp_eq_u64 s[20:21], 0
s_cbranch_scc1 L_ck_33
v_min_u32 v56, v56, v72
v_min_u32 v57, v57, v73
v_min_u32 v58, v58, v74
v_min_u32 v59, v59, v75
v_max3_u32 v46, v56, v57, v58
v_max_u32 v46, v46, v59
v_cmp_eq_u32 s[20:21], -1, v46
L_ck_33:
s_cmp_eq_u64 s[22:23], 0
s_cbranch_scc1 L_ck_34
v_min_u32 v60, v60, v76
v_min_u32 v61, v61, v77
v_min_u32 v62, v62, v78
v_min_u32 v63, v63, v79
v_max3_u32 v46, v60, v61, v62
v_max_u32 v46, v46, v63
v_cmp_eq_u32 s[22:23], -1, v46
L_ck_34:
s_or_b64 s[28:29], s[16:17], s[18:19]
s_or_b64 s[30:31], s[20:21], s[22:23]
s_or_b64 s[28:29], s[28:29], s[30:31]
s_cbranch_scc0 R_done
s_or_b64 exec, s[16:17], 1
buffer_load_dwordx4 v[64:67], v44, s[64:67], s24 offen sc1
s_or_b64 exec, s[18:19], 1
buffer_load_dwordx4 v[68:71], v44, s[64:67], s25 offen sc1
s_or_b64 exec, s[20:21], 1
buffer_load_dwordx4 v[72:75], v44, s[64:67], s26 offen sc1
s_or_b64 exec, s[22:23], 1
buffer_load_dwordx4 v[76:79], v44, s[64:67], s27 offen sc1
s_mov_b64 exec, -1
s_waitcnt vmcnt(4)
s_cmp_eq_u64 s[16:17], 0
s_cbranch_scc1 L_ck_35
v_min_u32 v48, v48, v80
v_min_u32 v49, v49, v81
v_min_u32 v50, v50, v82
v_min_u32 v51, v51, v83
v_max3_u32 v46, v48, v49, v50
v_max_u32 v46, v46, v51
v_cmp_eq_u32 s[16:17], -1, v46
L_ck_35:
s_cmp_eq_u64 s[18:19], 0
s_cbranch_scc1 L_ck_36
v_min_u32 v52, v52, v84
v_min_u32 v53, v53, v85
v_min_u32 v54, v54, v86
v_min_u32 v55, v55, v87
v_max3_u32 v46, v52, v53, v54
v_max_u32 v46, v46, v55
v_cmp_eq_u32 s[18:19], -1, v46
L_ck_36:
s_cmp_eq_u64 s[20:21], 0
s_cbranch_scc1 L_ck_37
v_min_u32 v56, v56, v88
v_min_u32 v57, v57, v89
v_min_u32 v58, v58, v90
v_min_u32 v59, v59, v91
v_max3_u32 v46, v56, v57, v58
v_max_u32 v46, v46, v59
v_cmp_eq_u32 s[20:21], -1, v46
L_ck_37:
s_cmp_eq_u64 s[22:23], 0
s_cbranch_scc1 L_ck_38
v_min_u32 v60, v60, v92
v_min_u32 v61, v61, v93
v_min_u32 v62, v62, v94
v_min_u32 v63, v63, v95
v_max3_u32 v46, v60, v61, v62
v_max_u32 v46, v46, v63
v_cmp_eq_u32 s[22:23], -1, v46
L_ck_38:
s_or_b64 s[28:29], s[16:17], s[18:19]
s_or_b64 s[30:31], s[20:21], s[22:23]
s_or_b64 s[28:29], s[28:29], s[30:31]
s_cbranch_scc0 R_done
s_or_b64 exec, s[16:17], 1
buffer_load_dwordx4 v[80:83], v44, s[64:67], s24 offen sc1
s_or_b64 exec, s[18:19], 1
buffer_load_dwordx4 v[84:87], v44, s[64:67], s25 offen sc1
s_or_b64 exec, s[20:21], 1
buffer_load_dwordx4 v[88:91], v44, s[64:67], s26 offen sc1
s_or_b64 exec, s[22:23], 1
buffer_load_dwordx4 v[92:95], v44, s[64:67], s27 offen sc1
s_mov_b64 exec, -1
s_sub_u32 s7, s7, 1
s_cmp_gt_i32 s7, 0
s_cbranch_scc1 R_loop
R_done:
v_mfma_f32_16x16x32_bf16 v[12:15], v[20:23], v[48:51], 0
v_mfma_f32_16x16x32_bf16 v[12:15], v[20:23], v[52:55], v[12:15]
v_mfma_f32_16x16x32_bf16 v[12:15], v[20:23], v[56:59], v[12:15]
v_mfma_f32_16x16x32_bf16 v[12:15], v[20:23], v[60:63], v[12:15]
s_nop 7
v_add_f32_dpp v16, v12, v12 row_ror:8 row_mask:0xf bank_mask:0x3
v_add_f32_dpp v17, v13, v13 row_ror:8 row_mask:0xf bank_mask:0x3
v_add_f32_dpp v16, v14, v14 row_ror:8 row_mask:0xf bank_mask:0xc
v_add_f32_dpp v17, v15, v15 row_ror:8 row_mask:0xf bank_mask:0xc
s_nop 0
v_add_f32_dpp v46, v16, v16 row_shl:4 row_mask:0xf bank_mask:0x5
v_add_f32_dpp v46, v17, v17 row_shr:4 row_mask:0xf bank_mask:0xa
s_mov_b64 exec, 0xffffffff
v_cvt_pk_bf16_f32 v46, v46, v46
buffer_store_short v46, v45, s[72:75], s83 offen
s_mov_b64 exec, -1
s_cmp_lg_u32 s3, 0
s_cbranch_scc1 B_fin
ds_write_b32 v11, v11
s_waitcnt lgkmcnt(0)
B_fin:
B_end:
s_endpgm
H_start:
s_lshl_b32 s6, s8, 6
s_add_u32 s6, s6, s4
s_lshl_b32 s6, s6, 20
s_add_u32 s56, s20, s6
s_addc_u32 s57, s21, 0
s_mov_b32 s58, 34603008
s_mov_b32 s59, 0x20000
v_lshlrev_b32 v16, 7, v1
v_and_b32 v17, 4095, v16
v_add_u32 v16, 4096, v16
v_lshrrev_b32 v21, 5, v1
v_mul_u32_u24 v21, 20480, v21
v_add_u32 v17, v17, v21
s_and_b32 s6, s9, 56
v_and_b32 v19, 7, v1
v_add_u32 v19, s6, v19
v_mul_u32_u24 v19, 16, v19
v_add_u32 v19, 393216, v19
s_lshr_b32 s7, s4, 2
s_mul_i32 s7, s7, 4224
v_add_u32 v19, s7, v19
s_mov_b32 s16, 43
s_mov_b32 s17, 43
s_mov_b32 s18, 43
s_mov_b32 s31, 400000
buffer_load_dwordx3 v[12:14], v19, s[64:67], 0 offen sc1
s_waitcnt vmcnt(0)
H_loop:
v_med3_i32 v12, v12, -1, 31
v_med3_i32 v13, v13, -1, 31
v_med3_i32 v14, v14, -1, 31
v_add3_u32 v20, v12, v13, v14
s_nop 1
v_add_u32_dpp v20, v20, v20 row_ror:4 row_mask:0xf bank_mask:0xf
s_nop 1
v_add_u32_dpp v20, v20, v20 row_ror:2 row_mask:0xf bank_mask:0xf
s_nop 1
v_add_u32_dpp v20, v20, v20 row_ror:1 row_mask:0xf bank_mask:0xf
v_lshlrev_b32 v20, 3, v20
s_nop 0
v_readfirstlane_b32 s28, v20
v_readlane_b32 s20, v12, s9
v_readlane_b32 s21, v13, s9
v_readlane_b32 s22, v14, s9
buffer_load_dwordx3 v[12:14], v19, s[64:67], 0 offen sc1
s_mul_i32 s6, s20, 192
s_sub_i32 s24, s28, s6
s_mul_i32 s6, s16, 24
s_add_i32 s24, s24, s6
s_add_i32 s6, s16, -15
s_cmp_ge_i32 s6, s20
s_cselect_b32 s24, s24, -1048576
s_mul_i32 s6, s21, 192
s_sub_i32 s25, s28, s6
s_mul_i32 s6, s17, 24
s_add_i32 s25, s25, s6
s_add_i32 s6, s17, -15
s_cmp_ge_i32 s6, s21
s_cselect_b32 s25, s25, -1048576
s_mul_i32 s6, s22, 192
s_sub_i32 s26, s28, s6
s_mul_i32 s6, s18, 24
s_add_i32 s26, s26, s6
s_add_i32 s6, s18, -15
s_cmp_ge_i32 s6, s22
s_cselect_b32 s26, s26, -1048576
s_cmp_ge_i32 s24, s25
s_cselect_b32 s29, 0, 1
s_max_i32 s30, s24, s25
s_cmp_ge_i32 s30, s26
s_cselect_b32 s29, s29, 2
s_max_i32 s30, s30, s26
s_cmp_eq_i32 s30, -1048576
s_cbranch_scc1 H_end
s_sub_u32 s31, s31, 1
s_cmp_eq_u32 s31, 0
s_cbranch_scc1 H_end
s_cmp_lt_i32 s30, 1416
s_cbranch_scc1 H_idle
s_cmp_eq_u32 s29, 0
s_cselect_b32 s6, s16, s6
s_subb_u32 s16, s16, 0
s_cmp_eq_u32 s29, 1
s_cselect_b32 s6, s17, s6
s_subb_u32 s17, s17, 0
s_cmp_eq_u32 s29, 2
s_cselect_b32 s6, s18, s6
s_subb_u32 s18, s18, 0
s_mul_i32 s6, s6, 24576
s_sub_u32 s6, s6, 32768
s_cmp_eq_u32 s29, 2
s_cselect_b32 s7, 33554432, 0
s_add_u32 s6, s6, s7
s_cmp_eq_u32 s29, 1
s_cselect_b64 vcc, -1, 0
s_cselect_b32 s7, 25, 13
s_lshl_b32 s7, 1, s7
s_add_u32 s7, s7, s6
v_cndmask_b32 v18, v16, v17, vcc
buffer_load_dword v22, v18, s[56:59], s6 offen
buffer_load_dword v23, v18, s[56:59], s7 offen
s_waitcnt vmcnt(2)
s_branch H_loop
H_idle:
ds_read_b32 v21, v11
s_waitcnt vmcnt(0) lgkmcnt(0)
s_sleep 4
v_cmp_eq_u32 vcc, 0, v21
s_cbranch_vccnz H_loop
H_end:
s_branch B_end
.section .rodata,"a"
.p2align 6
.amdhsa_kernel concat_heads__mha_block_cached__compressed_kv_cla__decode_kernel
  .amdhsa_next_free_vgpr 512
  .amdhsa_next_free_sgpr 102
  .amdhsa_accum_offset 256
  .amdhsa_group_segment_fixed_size 0
  .amdhsa_kernarg_size 112
  .amdhsa_user_sgpr_count 2
  .amdhsa_user_sgpr_kernarg_segment_ptr 1
  .amdhsa_system_sgpr_workgroup_id_x 1
.end_amdhsa_kernel
```
